```python
import torch

def _softmax(x, axis=-1):
    return torch.softmax(x, dim=axis)
def _gelu(x):
    return torch.nn.functional.gelu(x, approximate="tanh")
def _silu(x):
    return torch.nn.functional.silu(x)
def _sigmoid(x):
    return torch.sigmoid(x)
def _layernorm(x, axis=-1, eps=1e-5):
    m = x.mean(dim=axis, keepdim=True)
    v = x.var(dim=axis, keepdim=True, unbiased=False)
    return (x - m) / torch.sqrt(v + eps)
def _scatter_add(tgt, idx, src, axis=0):
    return tgt.clone().index_add_(axis, idx, src)
def _segment_sum(src, seg, n):
    out = torch.zeros((n,) + src.shape[1:], dtype=src.dtype)
    return out.index_add_(0, seg, src)
def _pad(x, pw):
    flat = tuple(v for pair in reversed(pw) for v in pair)
    return torch.nn.functional.pad(x, flat)

kernel_name = 'recurrent_scan__sliding_local_dilated__glu_gated_geglu__prompt'

def setup_inputs():

    _w = (lambda a: (lambda t: t.to(torch.bfloat16) if t.is_floating_point() else t)(torch.as_tensor(a)))
    def _A_setup():
        B, S, D = 1, 2048, 1024
        return {
            "x": _w((lambda *s: torch.randn(*s, dtype=torch.bfloat16) * 0.05)(B, S, D)),
            "wqkv": _w((lambda *s: torch.randn(*s, dtype=torch.bfloat16) * 0.2)(D, 3 * D)),
            "wo": _w((lambda *s: torch.randn(*s, dtype=torch.bfloat16) * 0.2)(D, D)),
        }
    _A_in = _A_setup()

    def _B_setup():
        B, S, Dm, Df = 1, 2048, 1024, 3584
        return {
            "x": _w((lambda *s: torch.randn(*s, dtype=torch.bfloat16) * 0.05)(B, S, Dm)),
            "w_gate": _w((lambda *s: torch.randn(*s, dtype=torch.bfloat16) * 0.1)(Dm, Df) * (Dm ** -0.5)),
            "w_up": _w((lambda *s: torch.randn(*s, dtype=torch.bfloat16) * 0.1)(Dm, Df) * (Dm ** -0.5)),
            "w_down": _w((lambda *s: torch.randn(*s, dtype=torch.bfloat16) * 0.1)(Df, Dm) * (Df ** -0.5)),
        }
    _B_in = _B_setup()

    return {
        "A_x": _A_in["x"],
        "A_wqkv": _A_in["wqkv"],
        "A_wo": _A_in["wo"],
        "B_x": _B_in["x"],
        "B_w_gate": _B_in["w_gate"],
        "B_w_up": _B_in["w_up"],
        "B_w_down": _B_in["w_down"],
    }

def reference(A_x, A_wqkv, A_wo, B_x, B_w_gate, B_w_up, B_w_down):
    def _A_ref(x, wqkv, wo):
        B, S, D = x.shape
        H = 32; Dh = D // H
        W, dil = 8, 2
        qkv = (lambda x, *d: x.permute(*d))((x @ wqkv).reshape(B, S, 3, H, Dh), 2, 0, 3, 1, 4)
        q, k, v = qkv[0], qkv[1], qkv[2]
        scale = Dh ** -0.5
        pos = torch.arange(S)
        off = torch.arange(W) * dil
        idx = pos[:, None] - off[None, :]
        mask = idx >= 0
        idx_c = torch.where(mask, idx, 0).reshape(-1)
        kg = k[:, :, idx_c, :].reshape(B, H, S, W, Dh)
        vg = v[:, :, idx_c, :].reshape(B, H, S, W, Dh)
        logits = torch.einsum("bhsd,bhswd->bhsw", q, kg) * scale
        logits = torch.where(mask[None, None, :, :], logits, -1e9)
        attn = _softmax(logits, axis=-1)
        o = torch.einsum("bhsw,bhswd->bhsd", attn, vg)
        return (lambda x, *d: x.permute(*d))(o, 0, 2, 1, 3).reshape(B, S, D) @ wo

    def _B_ref(x, w_gate, w_up, w_down):
        g = torch.einsum("bsd,df->bsf", x, w_gate)
        u = torch.einsum("bsd,df->bsf", x, w_up)
        h = _gelu(g) * u
        return torch.einsum("bsf,fd->bsd", h, w_down)

    x = A_x
    xn = _layernorm(x, axis=-1)
    s = _A_ref(xn, A_wqkv, A_wo)
    g = _silu(_B_ref(xn, B_w_gate, B_w_up, B_w_down))
    return x + s * g
```

```asm
; @launch grid=(256,1,1) block=(256,1,1) lds=163840
.amdgcn_target "amdgcn-amd-amdhsa--gfx950"
.text
.p2align 8
.globl recurrent_scan__sliding_local_dilated__glu_gated_geglu__prompt_kernel
.type recurrent_scan__sliding_local_dilated__glu_gated_geglu__prompt_kernel,@function
recurrent_scan__sliding_local_dilated__glu_gated_geglu__prompt_kernel:
    s_cmp_ge_u32 s2, 256
    s_cbranch_scc1 L_end
    s_load_dwordx16 s[8:23], s[0:1], 0
    s_load_dwordx4 s[24:27], s[0:1], 64
    v_lshrrev_b32 v1, 6, v0
    v_and_b32 v0, 63, v0
    v_readfirstlane_b32 s60, v1
    s_and_b32 s82, s2, 7
    s_lshr_b32 s83, s2, 3
    s_lshr_b32 s65, s82, 1
    s_and_b32 s63, s82, 1
    s_lshl_b32 s63, s63, 2
    s_and_b32 s84, s83, 3
    s_add_u32 s63, s63, s84
    s_lshr_b32 s66, s83, 2
    s_lshl_b32 s64, s65, 3
    s_add_u32 s64, s64, s66
    s_lshr_b32 s61, s60, 1
    s_and_b32 s62, s60, 1
    v_lshlrev_b32 v16, 4, v0
    s_lshl_b32 s84, s64, 2
    s_add_u32 s84, s84, s60
    s_lshl_b32 s85, s63, 7
    s_add_u32 s84, s84, s85
    s_lshl_b32 s85, s84, 12
    v_add_u32 v36, s85, v16
    s_lshl_b32 s84, s84, 2
    s_add_u32 s84, s84, 39845888
    v_mov_b32 v37, s84
    s_waitcnt lgkmcnt(0)
    global_load_dwordx4 v[48:51], v36, s[8:9] offset:0
    global_load_dwordx4 v[52:55], v36, s[8:9] offset:1024
    global_load_dwordx4 v[56:59], v36, s[8:9] offset:2048
    global_load_dwordx4 v[60:63], v36, s[8:9] offset:3072
    s_lshl_b32 s84, s63, 9
    s_lshl_b32 s85, s61, 8
    s_add_u32 s85, s85, s84
    s_sub_u32 s84, s84, 32
    s_max_i32 s84, s84, 0
    s_cmp_eq_u32 s62, 0
    s_cselect_b32 s85, s85, s84
    s_cselect_b32 s84, 63, 7
    s_add_u32 s85, s85, 39845888
    v_and_b32 v38, s84, v0
    v_lshlrev_b32 v38, 2, v38
    v_add_u32 v38, s85, v38
    global_load_dword v39, v38, s[26:27] sc1
    global_load_dword v40, v37, s[26:27] sc1
    v_lshlrev_b32 v2, 6, v0
    v_sub_u32 v2, v2, v16
    v_add_u32 v2, v2, v36
    global_load_dword v7, v2, s[26:27] sc1
    s_sub_u32 s84, s63, s62
    s_max_i32 s84, s84, 0
    s_lshl_b32 s84, s84, 5
    v_mov_b32 v41, s84
    s_mov_b32 s56, s26
    s_and_b32 s57, s27, 0xffff
    s_mov_b32 s58, 0x10000000
    s_mov_b32 s59, 0x20000
    s_lshl_b32 s84, s63, 2
    s_add_u32 s84, s84, s65
    s_lshl_b32 s92, s84, 8
    s_add_u32 s92, s92, 39849984
    s_mul_i32 s88, s84, 458752
    s_add_u32 s88, s88, 8388608
    s_lshl_b32 s93, s63, 8
    s_add_u32 s93, s93, 39858176
    s_cmp_lg_u32 s60, 3
    s_cbranch_scc1 L_nozero
    s_lshl_b32 s84, s63, 3
    s_add_u32 s84, s84, s66
    s_lshl_b32 s84, s84, 2
    s_add_u32 s84, s84, s65
    s_lshl_b32 s84, s84, 8
    s_add_u32 s84, s84, 39862272
    v_mov_b32 v2, s84
    v_writelane_b32 v2, s92, 1
    v_writelane_b32 v2, s93, 2
    s_cmp_eq_u32 s66, 0
    s_cselect_b32 s84, 3, 1
    s_cmp_eq_u32 s64, 0
    s_cselect_b32 s84, 7, s84
    v_mov_b32 v3, 0
    s_mov_b32 exec_hi, 0
    s_mov_b32 exec_lo, s84
    global_store_dword v2, v3, s[26:27] sc1
    s_mov_b64 exec, -1
L_nozero:
    v_lshrrev_b32 v20, 2, v0
    v_and_b32 v21, 3, v0
    v_lshrrev_b32 v22, 4, v0
    v_and_b32 v23, 15, v0
    v_lshrrev_b32 v24, 3, v20
    v_lshlrev_b32 v24, 1, v24
    v_xor_b32 v24, v21, v24
    v_mul_u32_u24 v2, 6144, v20
    v_lshl_add_u32 v2, v24, 4, v2
    v_mul_u32_u24 v25, 7168, v20
    v_lshl_add_u32 v3, v24, 4, v25
    s_mul_i32 s84, s61, 98304
    s_lshl_b32 s85, s64, 6
    s_add_u32 s84, s84, s85
    s_add_u32 s32, s10, s84
    s_addc_u32 s33, s11, 0
    s_sub_u32 s32, s32, 4096
    s_subb_u32 s33, s33, 0
    s_and_b32 s33, s33, 0xffff
    s_sub_u32 s34, 6295552, s84
    s_mov_b32 s35, 0x20000
    s_mul_i32 s84, s61, 114688
    s_mul_i32 s85, s64, 224
    s_add_u32 s84, s84, s85
    s_add_u32 s36, s16, s84
    s_addc_u32 s37, s17, 0
    s_sub_u32 s36, s36, 4096
    s_subb_u32 s37, s37, 0
    s_and_b32 s37, s37, 0xffff
    s_sub_u32 s38, 7344128, s84
    s_mov_b32 s39, 0x20000
    s_add_u32 s40, s18, s84
    s_addc_u32 s41, s19, 0
    s_sub_u32 s40, s40, 4096
    s_subb_u32 s41, s41, 0
    s_and_b32 s41, s41, 0xffff
    s_sub_u32 s42, 7344128, s84
    s_mov_b32 s43, 0x20000
    v_cmp_lt_u32 vcc, 1, v24
    v_and_b32 v24, 1, v24
    v_lshl_add_u32 v24, v24, 4, v25
    v_add_u32 v24, 3264, v24
    v_mov_b32 v25, 0
    s_add_u32 s82, s16, s84
    s_addc_u32 s83, s17, 0
    s_sub_u32 s82, s82, 4096
    s_subb_u32 s83, s83, 0
    v_lshl_add_u64 v[4:5], v[24:25], 0, s[82:83]
    s_add_u32 s82, s18, s84
    s_addc_u32 s83, s19, 0
    s_sub_u32 s82, s82, 4096
    s_subb_u32 s83, s83, 0
    v_lshl_add_u64 v[24:25], v[24:25], 0, s[82:83]
    v_cndmask_b32 v4, v4, v24, vcc
    v_cndmask_b32 v5, v5, v25, vcc
    s_mov_b32 s80, 229376
    s_mov_b32 s81, 0
    s_cmp_eq_u32 s62, 1
    s_cbranch_scc1 L_init1
    s_lshl_b32 s78, s61, 13
    s_mov_b32 s68, 4096
    s_mov_b32 s69, 35840
    s_mov_b32 s70, 67584
    s_mov_b32 s71, 99328
    s_mov_b32 s72, 135168
    s_mov_b32 s73, 166912
    s_mov_b32 s74, 198656
    s_mov_b32 s75, 230400
    s_lshl_b32 s84, s63, 1
    s_add_u32 s84, s84, s61
    s_lshl_b32 s84, s84, 18
    s_branch L_init2
L_init1:
    s_mul_i32 s78, s61, 11264
    s_add_u32 s78, s78, 16384
    s_mov_b32 s68, 6144
    s_mov_b32 s69, 7168
    s_mov_b32 s70, 2048
    s_mov_b32 s71, 1024
    s_mov_b32 s72, 4096
    s_mov_b32 s73, 3136
    s_mov_b32 s74, 2112
    s_mov_b32 s75, 1152
    s_mov_b32 s76, 4224
    s_mov_b32 s77, 2048
    s_lshl_b32 s84, s63, 19
    s_sub_u32 s84, s84, 32768
    s_max_i32 s84, s84, 0
L_init2:
    s_add_u32 s28, s26, s84
    s_addc_u32 s29, s27, 0
    s_sub_u32 s28, s28, 4096
    s_subb_u32 s29, s29, 0
    s_and_b32 s29, s29, 0xffff
    s_sub_u32 s30, 4198400, s84
    s_mov_b32 s31, 0x20000
    v_mov_b32 v25, 0x78
    v_lshlrev_b32 v24, 1, v22
    v_lshrrev_b32 v24, v24, v25
    v_and_b32 v24, 3, v24
    v_xor_b32 v24, v24, v21
    v_lshlrev_b32 v24, 4, v24
    v_lshl_add_u32 v1, v20, 11, v24
    s_cmp_eq_u32 s63, 0
    s_cselect_b32 s84, 1, 3
    s_and_b32 s85, s60, s84
    s_cmp_eq_u32 s85, s84
    s_cselect_b32 s85, 0x40000000, 0
    s_cselect_b32 s87, 1, 0
    v_add_u32 v1, s85, v1
    s_lshr_b32 s83, s2, 3
    v_lshrrev_b32 v24, 3, v0
    v_and_b32 v25, 7, v0
    s_and_b32 s84, s63, 3
    s_lshl_b32 s84, s84, 3
    s_add_u32 s84, s84, 128
    v_add_u32 v24, s84, v24
    s_cmp_eq_u32 s60, 3
    s_cbranch_scc1 L_pf3
    s_cmp_eq_u32 s60, 0
    s_cbranch_scc1 L_pf0
    s_cmp_eq_u32 s60, 1
    s_cselect_b32 s44, s16, s18
    s_cselect_b32 s45, s17, s19
    s_mov_b32 s46, 7340032
    s_mov_b32 s79, 229376
    s_mul_i32 s85, s64, 224
    v_mul_u32_u24 v25, 56, v25
    v_min_u32 v25, 220, v25
    v_mul_u32_u24 v24, 7168, v24
    v_add3_u32 v6, v24, v25, s85
    s_branch L_pfd
L_pf0:
    s_mov_b32 s44, s10
    s_mov_b32 s45, s11
    s_mov_b32 s46, 6291456
    s_mov_b32 s79, 196608
    s_lshl_b32 s85, s64, 6
    v_min_u32 v25, 2, v25
    v_lshlrev_b32 v25, 11, v25
    v_mul_u32_u24 v24, 6144, v24
    v_add3_u32 v6, v24, v25, s85
    s_branch L_pfd
L_pf3:
    s_lshl_b32 s85, s65, 5
    s_add_u32 s85, s85, s83
    s_mul_i32 s85, s85, 57344
    s_add_u32 s44, s20, s85
    s_addc_u32 s45, s21, 0
    s_mov_b32 s46, 57344
    s_mov_b32 s79, 4096
    v_lshlrev_b32 v6, 6, v0
    v_add_u32 v6, 0xffff0000, v6
L_pfd:
    s_and_b32 s45, s45, 0xffff
    s_mov_b32 s47, 0x20000
    v_mov_b32 v25, 0x78
    v_lshrrev_b32 v24, 2, v23
    v_lshlrev_b32 v24, 1, v24
    v_lshrrev_b32 v24, v24, v25
    v_and_b32 v24, 3, v24
    v_xor_b32 v24, v24, v22
    v_lshlrev_b32 v24, 4, v24
    v_lshl_add_u32 v24, v23, 6, v24
    s_lshl_b32 s84, s61, 13
    v_add_u32 v8, s84, v24
    v_add_u32 v9, 77824, v8
    s_mul_i32 s84, s61, -19456
    s_add_u32 s84, s84, 26624
    v_add_u32 v10, s84, v24
    v_add_u32 v11, 77824, v10
    v_lshrrev_b32 v24, 5, v0
    v_mul_u32_u24 v24, 11264, v24
    v_and_b32 v26, 1, v22
    v_bfe_u32 v25, v0, 2, 2
    v_lshl_add_u32 v25, v26, 3, v25
    v_lshl_add_u32 v24, v25, 6, v24
    v_and_b32 v25, 1, v0
    v_lshl_add_u32 v24, v25, 3, v24
    v_bfe_u32 v27, v0, 1, 1
    v_lshlrev_b32 v26, 1, v26
    s_mul_i32 s84, s62, 5120
    s_add_u32 s84, s84, 16384
    v_add_u32 v24, s84, v24
    v_add_u32 v25, 0, v27
    v_xor_b32 v25, v25, v26
    v_lshl_add_u32 v12, v25, 4, v24
    v_add_u32 v13, 77824, v12
    v_add_u32 v25, 2, v27
    v_xor_b32 v25, v25, v26
    v_lshl_add_u32 v14, v25, 4, v24
    v_add_u32 v15, 77824, v14
    v_mov_b32 v28, 0
    v_mov_b32 v29, 0
    v_mov_b32 v30, 0
    v_mov_b32 v31, 0
    s_cmp_eq_u32 s62, 1
    s_cbranch_scc1 L_early1
    buffer_load_dword v7, v6, s[44:47], 0 offen
    v_add_u32_e64 v6, s79, v6
    buffer_load_dword v7, v6, s[44:47], 0 offen
    v_add_u32_e64 v6, s79, v6
    buffer_load_dword v7, v6, s[44:47], 0 offen
    v_add_u32_e64 v6, s79, v6
    buffer_load_dword v7, v6, s[44:47], 0 offen
    v_add_u32_e64 v6, s79, v6
    v_mfma_f32_32x32x16_bf16 a[128:143], v[28:31], v[28:31], 0
    v_mfma_f32_32x32x16_bf16 a[144:159], v[28:31], v[28:31], 0
    v_mfma_f32_32x32x16_bf16 a[160:175], v[28:31], v[28:31], 0
    v_mfma_f32_32x32x16_bf16 a[176:191], v[28:31], v[28:31], 0
    v_mfma_f32_32x32x16_bf16 a[192:207], v[28:31], v[28:31], 0
    v_mfma_f32_32x32x16_bf16 a[208:223], v[28:31], v[28:31], 0
    v_mfma_f32_32x32x16_bf16 a[224:239], v[28:31], v[28:31], 0
    v_mfma_f32_32x32x16_bf16 a[240:255], v[28:31], v[28:31], 0
    v_mfma_f32_32x32x16_bf16 v[128:143], v[28:31], v[28:31], 0
    v_mfma_f32_32x32x16_bf16 v[144:159], v[28:31], v[28:31], 0
    v_mfma_f32_32x32x16_bf16 v[160:175], v[28:31], v[28:31], 0
    v_mfma_f32_32x32x16_bf16 v[176:191], v[28:31], v[28:31], 0
    v_mfma_f32_32x32x16_bf16 v[192:207], v[28:31], v[28:31], 0
    v_mfma_f32_32x32x16_bf16 v[208:223], v[28:31], v[28:31], 0
    v_mfma_f32_32x32x16_bf16 v[224:239], v[28:31], v[28:31], 0
    v_mfma_f32_32x32x16_bf16 v[240:255], v[28:31], v[28:31], 0
    s_waitcnt vmcnt(7)
    s_branch L_ln
L_early1:
    s_add_u32 m0, s78, 0
    s_nop 0
    buffer_load_dwordx4 v2, s[32:35], s68 offen offset:0 lds
    buffer_load_dwordx4 v2, s[32:35], s69 offen offset:1024 lds
    buffer_load_dwordx4 v2, s[32:35], s70 offen offset:2048 lds
    v_add_u32 v2, 196608, v2
    buffer_load_dwordx4 v3, s[36:39], s71 offen offset:3072 lds
    s_add_u32 m0, s78, 4096
    s_nop 0
    buffer_load_dwordx4 v3, s[40:43], s72 offen offset:0 lds
    buffer_load_dwordx4 v3, s[36:39], s73 offen offset:1024 lds
    buffer_load_dwordx4 v3, s[40:43], s74 offen offset:2048 lds
    buffer_load_dwordx4 v3, s[36:39], s75 offen offset:3072 lds
    s_add_u32 m0, s78, 8192
    s_nop 0
    buffer_load_dwordx4 v3, s[40:43], s76 offen offset:0 lds
    v_add_u32 v3, 229376, v3
    global_load_lds_dwordx4 v[4:5], off offset:1024
    v_lshl_add_u64 v[4:5], v[4:5], 0, s[80:81]
    s_add_u32 m0, s78, 38912
    s_nop 0
    buffer_load_dwordx4 v2, s[32:35], s68 offen offset:0 lds
    buffer_load_dwordx4 v2, s[32:35], s69 offen offset:1024 lds
    buffer_load_dwordx4 v2, s[32:35], s70 offen offset:2048 lds
    v_add_u32 v2, 196608, v2
    buffer_load_dwordx4 v3, s[36:39], s71 offen offset:3072 lds
    s_add_u32 m0, s78, 43008
    s_nop 0
    buffer_load_dwordx4 v3, s[40:43], s72 offen offset:0 lds
    buffer_load_dwordx4 v3, s[36:39], s73 offen offset:1024 lds
    buffer_load_dwordx4 v3, s[40:43], s74 offen offset:2048 lds
    buffer_load_dwordx4 v3, s[36:39], s75 offen offset:3072 lds
    s_add_u32 m0, s78, 47104
    s_nop 0
    buffer_load_dwordx4 v3, s[40:43], s76 offen offset:0 lds
    v_add_u32 v3, 229376, v3
    global_load_lds_dwordx4 v[4:5], off offset:1024
    v_lshl_add_u64 v[4:5], v[4:5], 0, s[80:81]
    s_add_u32 m0, s78, 77824
    s_nop 0
    buffer_load_dwordx4 v2, s[32:35], s68 offen offset:0 lds
    buffer_load_dwordx4 v2, s[32:35], s69 offen offset:1024 lds
    buffer_load_dwordx4 v2, s[32:35], s70 offen offset:2048 lds
    v_add_u32 v2, 196608, v2
    buffer_load_dwordx4 v3, s[36:39], s71 offen offset:3072 lds
    s_add_u32 m0, s78, 81920
    s_nop 0
    buffer_load_dwordx4 v3, s[40:43], s72 offen offset:0 lds
    buffer_load_dwordx4 v3, s[36:39], s73 offen offset:1024 lds
    buffer_load_dwordx4 v3, s[40:43], s74 offen offset:2048 lds
    buffer_load_dwordx4 v3, s[36:39], s75 offen offset:3072 lds
    s_add_u32 m0, s78, 86016
    s_nop 0
    buffer_load_dwordx4 v3, s[40:43], s76 offen offset:0 lds
    v_add_u32 v3, 229376, v3
    global_load_lds_dwordx4 v[4:5], off offset:1024
    v_lshl_add_u64 v[4:5], v[4:5], 0, s[80:81]
    s_add_u32 m0, s78, 116736
    s_nop 0
    buffer_load_dwordx4 v2, s[32:35], s68 offen offset:0 lds
    buffer_load_dwordx4 v2, s[32:35], s69 offen offset:1024 lds
    buffer_load_dwordx4 v2, s[32:35], s70 offen offset:2048 lds
    v_add_u32 v2, 196608, v2
    buffer_load_dwordx4 v3, s[36:39], s71 offen offset:3072 lds
    s_add_u32 m0, s78, 120832
    s_nop 0
    buffer_load_dwordx4 v3, s[40:43], s72 offen offset:0 lds
    buffer_load_dwordx4 v3, s[36:39], s73 offen offset:1024 lds
    buffer_load_dwordx4 v3, s[40:43], s74 offen offset:2048 lds
    buffer_load_dwordx4 v3, s[36:39], s75 offen offset:3072 lds
    s_add_u32 m0, s78, 124928
    s_nop 0
    buffer_load_dwordx4 v3, s[40:43], s76 offen offset:0 lds
    v_add_u32 v3, 229376, v3
    global_load_lds_dwordx4 v[4:5], off offset:1024
    v_lshl_add_u64 v[4:5], v[4:5], 0, s[80:81]
    buffer_load_dword v7, v6, s[44:47], 0 offen
    v_add_u32_e64 v6, s79, v6
    buffer_load_dword v7, v6, s[44:47], 0 offen
    v_add_u32_e64 v6, s79, v6
    buffer_load_dword v7, v6, s[44:47], 0 offen
    v_add_u32_e64 v6, s79, v6
    buffer_load_dword v7, v6, s[44:47], 0 offen
    v_add_u32_e64 v6, s79, v6
    v_mfma_f32_32x32x16_bf16 a[128:143], v[28:31], v[28:31], 0
    v_mfma_f32_32x32x16_bf16 a[144:159], v[28:31], v[28:31], 0
    v_mfma_f32_32x32x16_bf16 a[160:175], v[28:31], v[28:31], 0
    v_mfma_f32_32x32x16_bf16 a[176:191], v[28:31], v[28:31], 0
    v_mfma_f32_32x32x16_bf16 a[192:207], v[28:31], v[28:31], 0
    v_mfma_f32_32x32x16_bf16 a[208:223], v[28:31], v[28:31], 0
    v_mfma_f32_32x32x16_bf16 a[224:239], v[28:31], v[28:31], 0
    v_mfma_f32_32x32x16_bf16 a[240:255], v[28:31], v[28:31], 0
    v_mfma_f32_32x32x16_bf16 v[128:143], v[28:31], v[28:31], 0
    v_mfma_f32_32x32x16_bf16 v[144:159], v[28:31], v[28:31], 0
    v_mfma_f32_32x32x16_bf16 v[160:175], v[28:31], v[28:31], 0
    v_mfma_f32_32x32x16_bf16 v[176:191], v[28:31], v[28:31], 0
    v_mfma_f32_32x32x16_bf16 v[192:207], v[28:31], v[28:31], 0
    v_mfma_f32_32x32x16_bf16 v[208:223], v[28:31], v[28:31], 0
    v_mfma_f32_32x32x16_bf16 v[224:239], v[28:31], v[28:31], 0
    v_mfma_f32_32x32x16_bf16 v[240:255], v[28:31], v[28:31], 0
    s_waitcnt vmcnt(47)
L_ln:
    v_lshlrev_b32 v64, 16, v48
    v_and_b32 v65, 0xffff0000, v48
    v_lshlrev_b32 v66, 16, v49
    v_and_b32 v67, 0xffff0000, v49
    v_lshlrev_b32 v68, 16, v50
    v_and_b32 v69, 0xffff0000, v50
    v_lshlrev_b32 v70, 16, v51
    v_and_b32 v71, 0xffff0000, v51
    v_lshlrev_b32 v72, 16, v52
    v_and_b32 v73, 0xffff0000, v52
    v_lshlrev_b32 v74, 16, v53
    v_and_b32 v75, 0xffff0000, v53
    v_lshlrev_b32 v76, 16, v54
    v_and_b32 v77, 0xffff0000, v54
    v_lshlrev_b32 v78, 16, v55
    v_and_b32 v79, 0xffff0000, v55
    v_lshlrev_b32 v80, 16, v56
    v_and_b32 v81, 0xffff0000, v56
    v_lshlrev_b32 v82, 16, v57
    v_and_b32 v83, 0xffff0000, v57
    v_lshlrev_b32 v84, 16, v58
    v_and_b32 v85, 0xffff0000, v58
    v_lshlrev_b32 v86, 16, v59
    v_and_b32 v87, 0xffff0000, v59
    v_lshlrev_b32 v88, 16, v60
    v_and_b32 v89, 0xffff0000, v60
    v_lshlrev_b32 v90, 16, v61
    v_and_b32 v91, 0xffff0000, v61
    v_lshlrev_b32 v92, 16, v62
    v_and_b32 v93, 0xffff0000, v62
    v_lshlrev_b32 v94, 16, v63
    v_and_b32 v95, 0xffff0000, v63
    v_pk_add_f32 v[96:97], v[64:65], v[66:67]
    v_pk_add_f32 v[98:99], v[80:81], v[82:83]
    v_pk_add_f32 v[96:97], v[96:97], v[68:69]
    v_pk_add_f32 v[98:99], v[98:99], v[84:85]
    v_pk_add_f32 v[96:97], v[96:97], v[70:71]
    v_pk_add_f32 v[98:99], v[98:99], v[86:87]
    v_pk_add_f32 v[96:97], v[96:97], v[72:73]
    v_pk_add_f32 v[98:99], v[98:99], v[88:89]
    v_pk_add_f32 v[96:97], v[96:97], v[74:75]
    v_pk_add_f32 v[98:99], v[98:99], v[90:91]
    v_pk_add_f32 v[96:97], v[96:97], v[76:77]
    v_pk_add_f32 v[98:99], v[98:99], v[92:93]
    v_pk_add_f32 v[96:97], v[96:97], v[78:79]
    v_pk_add_f32 v[98:99], v[98:99], v[94:95]
    v_add_f32 v102, v96, v97
    v_add_f32 v103, v98, v99
    s_nop 1
    v_permlane32_swap_b32 v102, v103
    v_add_f32 v102, v102, v103
    v_mov_b32 v100, v102
    s_nop 1
    v_permlane16_swap_b32 v102, v100
    v_add_f32 v102, v102, v100
    s_nop 1
    v_add_f32_dpp v102, v102, v102 quad_perm:[1,0,3,2] row_mask:0xf bank_mask:0xf
    s_nop 1
    v_add_f32_dpp v102, v102, v102 quad_perm:[2,3,0,1] row_mask:0xf bank_mask:0xf
    s_nop 1
    v_add_f32_dpp v102, v102, v102 row_half_mirror row_mask:0xf bank_mask:0xf
    s_nop 1
    v_add_f32_dpp v102, v102, v102 row_mirror row_mask:0xf bank_mask:0xf
    v_mul_f32 v102, 0xba800000, v102
    v_cvt_pk_bf16_f32 v106, v102, v102
    v_lshlrev_b32 v106, 16, v106
    v_mov_b32 v103, v102
    s_nop 1
    v_permlane32_swap_b32 v102, v103
    v_mov_b32 v107, v106
    s_nop 1
    v_permlane32_swap_b32 v106, v107
    v_pk_add_f32 v[108:109], v[64:65], v[102:103] op_sel_hi:[1,0]
    v_pk_add_f32 v[110:111], v[80:81], v[102:103] op_sel:[0,1] op_sel_hi:[1,1]
    v_pk_mul_f32 v[96:97], v[108:109], v[108:109]
    v_pk_mul_f32 v[98:99], v[110:111], v[110:111]
    v_pk_add_f32 v[108:109], v[66:67], v[102:103] op_sel_hi:[1,0]
    v_pk_add_f32 v[110:111], v[82:83], v[102:103] op_sel:[0,1] op_sel_hi:[1,1]
    v_pk_fma_f32 v[96:97], v[108:109], v[108:109], v[96:97]
    v_pk_fma_f32 v[98:99], v[110:111], v[110:111], v[98:99]
    v_pk_add_f32 v[108:109], v[68:69], v[102:103] op_sel_hi:[1,0]
    v_pk_add_f32 v[110:111], v[84:85], v[102:103] op_sel:[0,1] op_sel_hi:[1,1]
    v_pk_fma_f32 v[96:97], v[108:109], v[108:109], v[96:97]
    v_pk_fma_f32 v[98:99], v[110:111], v[110:111], v[98:99]
    v_pk_add_f32 v[108:109], v[70:71], v[102:103] op_sel_hi:[1,0]
    v_pk_add_f32 v[110:111], v[86:87], v[102:103] op_sel:[0,1] op_sel_hi:[1,1]
    v_pk_fma_f32 v[96:97], v[108:109], v[108:109], v[96:97]
    v_pk_fma_f32 v[98:99], v[110:111], v[110:111], v[98:99]
    v_pk_add_f32 v[108:109], v[72:73], v[102:103] op_sel_hi:[1,0]
    v_pk_add_f32 v[110:111], v[88:89], v[102:103] op_sel:[0,1] op_sel_hi:[1,1]
    v_pk_fma_f32 v[96:97], v[108:109], v[108:109], v[96:97]
    v_pk_fma_f32 v[98:99], v[110:111], v[110:111], v[98:99]
    v_pk_add_f32 v[108:109], v[74:75], v[102:103] op_sel_hi:[1,0]
    v_pk_add_f32 v[110:111], v[90:91], v[102:103] op_sel:[0,1] op_sel_hi:[1,1]
    v_pk_fma_f32 v[96:97], v[108:109], v[108:109], v[96:97]
    v_pk_fma_f32 v[98:99], v[110:111], v[110:111], v[98:99]
    v_pk_add_f32 v[108:109], v[76:77], v[102:103] op_sel_hi:[1,0]
    v_pk_add_f32 v[110:111], v[92:93], v[102:103] op_sel:[0,1] op_sel_hi:[1,1]
    v_pk_fma_f32 v[96:97], v[108:109], v[108:109], v[96:97]
    v_pk_fma_f32 v[98:99], v[110:111], v[110:111], v[98:99]
    v_pk_add_f32 v[108:109], v[78:79], v[102:103] op_sel_hi:[1,0]
    v_pk_add_f32 v[110:111], v[94:95], v[102:103] op_sel:[0,1] op_sel_hi:[1,1]
    v_pk_fma_f32 v[96:97], v[108:109], v[108:109], v[96:97]
    v_pk_fma_f32 v[98:99], v[110:111], v[110:111], v[98:99]
    v_add_f32 v104, v96, v97
    v_add_f32 v105, v98, v99
    s_nop 1
    v_permlane32_swap_b32 v104, v105
    v_add_f32 v104, v104, v105
    v_mov_b32 v100, v104
    s_nop 1
    v_permlane16_swap_b32 v104, v100
    v_add_f32 v104, v104, v100
    s_nop 1
    v_add_f32_dpp v104, v104, v104 quad_perm:[1,0,3,2] row_mask:0xf bank_mask:0xf
    s_nop 1
    v_add_f32_dpp v104, v104, v104 quad_perm:[2,3,0,1] row_mask:0xf bank_mask:0xf
    s_nop 1
    v_add_f32_dpp v104, v104, v104 row_half_mirror row_mask:0xf bank_mask:0xf
    s_nop 1
    v_add_f32_dpp v104, v104, v104 row_mirror row_mask:0xf bank_mask:0xf
    v_mul_f32 v104, 0x3a800000, v104
    v_cvt_pk_bf16_f32 v104, v104, v104
    v_lshlrev_b32 v104, 16, v104
    v_add_f32 v104, 0x3727c5ac, v104
    v_cvt_pk_bf16_f32 v104, v104, v104
    v_lshlrev_b32 v104, 16, v104
    v_sqrt_f32 v104, v104
    s_nop 0
    v_cvt_pk_bf16_f32 v104, v104, v104
    v_lshlrev_b32 v104, 16, v104
    v_rcp_f32 v100, v104
    s_nop 0
    v_fma_f32 v104, -v104, v100, 1.0
    v_fma_f32 v104, v104, v100, v100
    v_mov_b32 v105, v104
    s_nop 1
    v_permlane32_swap_b32 v104, v105
    v_pk_add_f32 v[64:65], v[64:65], v[106:107] op_sel_hi:[1,0]
    v_pk_add_f32 v[66:67], v[66:67], v[106:107] op_sel_hi:[1,0]
    v_pk_add_f32 v[68:69], v[68:69], v[106:107] op_sel_hi:[1,0]
    v_pk_add_f32 v[70:71], v[70:71], v[106:107] op_sel_hi:[1,0]
    v_cvt_pk_bf16_f32 v65, v64, v65
    v_cvt_pk_bf16_f32 v67, v66, v67
    v_cvt_pk_bf16_f32 v69, v68, v69
    v_cvt_pk_bf16_f32 v71, v70, v71
    v_lshlrev_b32 v64, 16, v65
    v_and_b32 v65, 0xffff0000, v65
    v_lshlrev_b32 v66, 16, v67
    v_and_b32 v67, 0xffff0000, v67
    v_lshlrev_b32 v68, 16, v69
    v_and_b32 v69, 0xffff0000, v69
    v_lshlrev_b32 v70, 16, v71
    v_and_b32 v71, 0xffff0000, v71
    v_pk_mul_f32 v[64:65], v[64:65], v[104:105] op_sel_hi:[1,0]
    v_pk_mul_f32 v[66:67], v[66:67], v[104:105] op_sel_hi:[1,0]
    v_pk_mul_f32 v[68:69], v[68:69], v[104:105] op_sel_hi:[1,0]
    v_pk_mul_f32 v[70:71], v[70:71], v[104:105] op_sel_hi:[1,0]
    s_waitcnt vmcnt(4)
    v_cvt_pk_bf16_f32 v48, v64, v65
    v_cvt_pk_bf16_f32 v49, v66, v67
    v_cvt_pk_bf16_f32 v50, v68, v69
    v_cvt_pk_bf16_f32 v51, v70, v71
    global_store_dwordx4 v36, v[48:51], s[26:27] offset:0 sc1
    v_pk_add_f32 v[72:73], v[72:73], v[106:107] op_sel_hi:[1,0]
    v_pk_add_f32 v[74:75], v[74:75], v[106:107] op_sel_hi:[1,0]
    v_pk_add_f32 v[76:77], v[76:77], v[106:107] op_sel_hi:[1,0]
    v_pk_add_f32 v[78:79], v[78:79], v[106:107] op_sel_hi:[1,0]
    v_cvt_pk_bf16_f32 v73, v72, v73
    v_cvt_pk_bf16_f32 v75, v74, v75
    v_cvt_pk_bf16_f32 v77, v76, v77
    v_cvt_pk_bf16_f32 v79, v78, v79
    v_lshlrev_b32 v72, 16, v73
    v_and_b32 v73, 0xffff0000, v73
    v_lshlrev_b32 v74, 16, v75
    v_and_b32 v75, 0xffff0000, v75
    v_lshlrev_b32 v76, 16, v77
    v_and_b32 v77, 0xffff0000, v77
    v_lshlrev_b32 v78, 16, v79
    v_and_b32 v79, 0xffff0000, v79
    v_pk_mul_f32 v[72:73], v[72:73], v[104:105] op_sel_hi:[1,0]
    v_pk_mul_f32 v[74:75], v[74:75], v[104:105] op_sel_hi:[1,0]
    v_pk_mul_f32 v[76:77], v[76:77], v[104:105] op_sel_hi:[1,0]
    v_pk_mul_f32 v[78:79], v[78:79], v[104:105] op_sel_hi:[1,0]
    v_cvt_pk_bf16_f32 v52, v72, v73
    v_cvt_pk_bf16_f32 v53, v74, v75
    v_cvt_pk_bf16_f32 v54, v76, v77
    v_cvt_pk_bf16_f32 v55, v78, v79
    global_store_dwordx4 v36, v[52:55], s[26:27] offset:1024 sc1
    v_pk_add_f32 v[80:81], v[80:81], v[106:107] op_sel:[0,1] op_sel_hi:[1,1]
    v_pk_add_f32 v[82:83], v[82:83], v[106:107] op_sel:[0,1] op_sel_hi:[1,1]
    v_pk_add_f32 v[84:85], v[84:85], v[106:107] op_sel:[0,1] op_sel_hi:[1,1]
    v_pk_add_f32 v[86:87], v[86:87], v[106:107] op_sel:[0,1] op_sel_hi:[1,1]
    v_cvt_pk_bf16_f32 v81, v80, v81
    v_cvt_pk_bf16_f32 v83, v82, v83
    v_cvt_pk_bf16_f32 v85, v84, v85
    v_cvt_pk_bf16_f32 v87, v86, v87
    v_lshlrev_b32 v80, 16, v81
    v_and_b32 v81, 0xffff0000, v81
    v_lshlrev_b32 v82, 16, v83
    v_and_b32 v83, 0xffff0000, v83
    v_lshlrev_b32 v84, 16, v85
    v_and_b32 v85, 0xffff0000, v85
    v_lshlrev_b32 v86, 16, v87
    v_and_b32 v87, 0xffff0000, v87
    v_pk_mul_f32 v[80:81], v[80:81], v[104:105] op_sel:[0,1] op_sel_hi:[1,1]
    v_pk_mul_f32 v[82:83], v[82:83], v[104:105] op_sel:[0,1] op_sel_hi:[1,1]
    v_pk_mul_f32 v[84:85], v[84:85], v[104:105] op_sel:[0,1] op_sel_hi:[1,1]
    v_pk_mul_f32 v[86:87], v[86:87], v[104:105] op_sel:[0,1] op_sel_hi:[1,1]
    v_cvt_pk_bf16_f32 v56, v80, v81
    v_cvt_pk_bf16_f32 v57, v82, v83
    v_cvt_pk_bf16_f32 v58, v84, v85
    v_cvt_pk_bf16_f32 v59, v86, v87
    global_store_dwordx4 v36, v[56:59], s[26:27] offset:2048 sc1
    v_pk_add_f32 v[88:89], v[88:89], v[106:107] op_sel:[0,1] op_sel_hi:[1,1]
    v_pk_add_f32 v[90:91], v[90:91], v[106:107] op_sel:[0,1] op_sel_hi:[1,1]
    v_pk_add_f32 v[92:93], v[92:93], v[106:107] op_sel:[0,1] op_sel_hi:[1,1]
    v_pk_add_f32 v[94:95], v[94:95], v[106:107] op_sel:[0,1] op_sel_hi:[1,1]
    v_cvt_pk_bf16_f32 v89, v88, v89
    v_cvt_pk_bf16_f32 v91, v90, v91
    v_cvt_pk_bf16_f32 v93, v92, v93
    v_cvt_pk_bf16_f32 v95, v94, v95
    v_lshlrev_b32 v88, 16, v89
    v_and_b32 v89, 0xffff0000, v89
    v_lshlrev_b32 v90, 16, v91
    v_and_b32 v91, 0xffff0000, v91
    v_lshlrev_b32 v92, 16, v93
    v_and_b32 v93, 0xffff0000, v93
    v_lshlrev_b32 v94, 16, v95
    v_and_b32 v95, 0xffff0000, v95
    v_pk_mul_f32 v[88:89], v[88:89], v[104:105] op_sel:[0,1] op_sel_hi:[1,1]
    v_pk_mul_f32 v[90:91], v[90:91], v[104:105] op_sel:[0,1] op_sel_hi:[1,1]
    v_pk_mul_f32 v[92:93], v[92:93], v[104:105] op_sel:[0,1] op_sel_hi:[1,1]
    v_pk_mul_f32 v[94:95], v[94:95], v[104:105] op_sel:[0,1] op_sel_hi:[1,1]
    v_cvt_pk_bf16_f32 v60, v88, v89
    v_cvt_pk_bf16_f32 v61, v90, v91
    v_cvt_pk_bf16_f32 v62, v92, v93
    v_cvt_pk_bf16_f32 v63, v94, v95
    global_store_dwordx4 v36, v[60:63], s[26:27] offset:3072 sc1
    v_add_u32 v40, 1, v40
    s_waitcnt vmcnt(0)
    s_mov_b64 exec, 1
    global_store_dword v37, v40, s[26:27] sc1
    s_mov_b64 exec, -1
    s_barrier
    v_mfma_f32_32x32x16_bf16 v[48:63], v[28:31], v[28:31], 0
    v_mfma_f32_32x32x16_bf16 v[64:79], v[28:31], v[28:31], 0
    v_mfma_f32_32x32x16_bf16 v[80:95], v[28:31], v[28:31], 0
    v_mfma_f32_32x32x16_bf16 v[96:111], v[28:31], v[28:31], 0
    v_mfma_f32_32x32x16_bf16 v[112:127], v[28:31], v[28:31], 0
    s_mov_b32 s67, 0
    s_cmp_lg_u32 s60, 3
    s_cbranch_scc1 L_noarr
    s_lshl_b32 s84, s63, 5
    v_mov_b32 v20, s84
    v_mov_b32 v21, 1
    s_mov_b64 exec, 1
    global_atomic_add v20, v21, s[24:25] sc1
    s_mov_b64 exec, -1
L_noarr:
    s_cmp_eq_u32 s87, 1
    s_cbranch_scc1 L_lnok
L_lnpoll:
    global_load_dword v20, v38, s[26:27] sc1
    s_waitcnt vmcnt(0)
    v_cmp_ne_u32 vcc, v20, v39
    s_cmp_eq_u64 vcc, -1
    s_cbranch_scc1 L_lnok
    s_add_u32 s67, s67, 1
    s_and_b32 s84, s67, 3
    s_cbranch_scc1 L_lnpoll
    global_load_dword v20, v41, s[24:25] sc1
    s_waitcnt vmcnt(0)
    v_readfirstlane_b32 s84, v20
    s_cmp_ge_u32 s84, 32
    s_cbranch_scc1 L_lnok
    s_cmp_lt_u32 s67, 0x40000
    s_cbranch_scc1 L_lnpoll
L_lnok:
    s_cmp_eq_u32 s62, 1
    s_cbranch_scc1 L_g1_1
    v_mov_b32 v20, 0x7ff00000
    s_add_u32 m0, s78, 0
    s_nop 0
    buffer_load_dwordx4 v1, s[28:31], s68 offen offset:0 sc1 lds
    buffer_load_dwordx4 v1, s[28:31], s69 offen offset:1024 sc1 lds
    buffer_load_dwordx4 v1, s[28:31], s70 offen offset:2048 sc1 lds
    buffer_load_dwordx4 v1, s[28:31], s71 offen offset:3072 sc1 lds
    s_add_u32 m0, s78, 4096
    s_nop 0
    buffer_load_dwordx4 v1, s[28:31], s72 offen offset:0 sc1 lds
    buffer_load_dwordx4 v1, s[28:31], s73 offen offset:1024 sc1 lds
    buffer_load_dwordx4 v1, s[28:31], s74 offen offset:2048 sc1 lds
    buffer_load_dwordx4 v1, s[28:31], s75 offen offset:3072 sc1 lds
    v_add_u32_e64 v1, 64, v1
    buffer_load_dword v7, v20, s[44:47], 0 offen
    s_add_u32 m0, s78, 38912
    s_nop 0
    buffer_load_dwordx4 v1, s[28:31], s68 offen offset:0 sc1 lds
    buffer_load_dwordx4 v1, s[28:31], s69 offen offset:1024 sc1 lds
    buffer_load_dwordx4 v1, s[28:31], s70 offen offset:2048 sc1 lds
    buffer_load_dwordx4 v1, s[28:31], s71 offen offset:3072 sc1 lds
    s_add_u32 m0, s78, 43008
    s_nop 0
    buffer_load_dwordx4 v1, s[28:31], s72 offen offset:0 sc1 lds
    buffer_load_dwordx4 v1, s[28:31], s73 offen offset:1024 sc1 lds
    buffer_load_dwordx4 v1, s[28:31], s74 offen offset:2048 sc1 lds
    buffer_load_dwordx4 v1, s[28:31], s75 offen offset:3072 sc1 lds
    v_add_u32_e64 v1, 64, v1
    buffer_load_dword v7, v20, s[44:47], 0 offen
    s_add_u32 m0, s78, 77824
    s_nop 0
    buffer_load_dwordx4 v1, s[28:31], s68 offen offset:0 sc1 lds
    buffer_load_dwordx4 v1, s[28:31], s69 offen offset:1024 sc1 lds
    buffer_load_dwordx4 v1, s[28:31], s70 offen offset:2048 sc1 lds
    buffer_load_dwordx4 v1, s[28:31], s71 offen offset:3072 sc1 lds
    s_add_u32 m0, s78, 81920
    s_nop 0
    buffer_load_dwordx4 v1, s[28:31], s72 offen offset:0 sc1 lds
    buffer_load_dwordx4 v1, s[28:31], s73 offen offset:1024 sc1 lds
    buffer_load_dwordx4 v1, s[28:31], s74 offen offset:2048 sc1 lds
    buffer_load_dwordx4 v1, s[28:31], s75 offen offset:3072 sc1 lds
    v_add_u32_e64 v1, 64, v1
    buffer_load_dword v7, v20, s[44:47], 0 offen
    s_add_u32 m0, s78, 116736
    s_nop 0
    buffer_load_dwordx4 v1, s[28:31], s68 offen offset:0 sc1 lds
    buffer_load_dwordx4 v1, s[28:31], s69 offen offset:1024 sc1 lds
    buffer_load_dwordx4 v1, s[28:31], s70 offen offset:2048 sc1 lds
    buffer_load_dwordx4 v1, s[28:31], s71 offen offset:3072 sc1 lds
    s_add_u32 m0, s78, 120832
    s_nop 0
    buffer_load_dwordx4 v1, s[28:31], s72 offen offset:0 sc1 lds
    buffer_load_dwordx4 v1, s[28:31], s73 offen offset:1024 sc1 lds
    buffer_load_dwordx4 v1, s[28:31], s74 offen offset:2048 sc1 lds
    buffer_load_dwordx4 v1, s[28:31], s75 offen offset:3072 sc1 lds
    v_add_u32_e64 v1, 64, v1
    buffer_load_dword v7, v20, s[44:47], 0 offen
    s_waitcnt vmcnt(28)
    s_barrier
    ds_read_b64_tr_b16 a[64:65], v12 offset:0
    ds_read_b64_tr_b16 a[66:67], v12 offset:256
    ds_read_b64_tr_b16 a[68:69], v14 offset:0
    ds_read_b64_tr_b16 a[70:71], v14 offset:256
    ds_read_b64_tr_b16 a[72:73], v12 offset:1024
    ds_read_b64_tr_b16 a[74:75], v12 offset:1280
    ds_read_b64_tr_b16 a[76:77], v14 offset:1024
    ds_read_b64_tr_b16 a[78:79], v14 offset:1280
    ds_read_b64_tr_b16 a[80:81], v12 offset:2048
    ds_read_b64_tr_b16 a[82:83], v12 offset:2304
    ds_read_b64_tr_b16 a[84:85], v14 offset:2048
    ds_read_b64_tr_b16 a[86:87], v14 offset:2304
    ds_read_b64_tr_b16 a[88:89], v12 offset:3072
    ds_read_b64_tr_b16 a[90:91], v12 offset:3328
    ds_read_b64_tr_b16 a[92:93], v14 offset:3072
    ds_read_b64_tr_b16 a[94:95], v14 offset:3328
    ds_read_b64_tr_b16 a[96:97], v12 offset:4096
    ds_read_b64_tr_b16 a[98:99], v12 offset:4352
    ds_read_b64_tr_b16 a[100:101], v14 offset:4096
    ds_read_b64_tr_b16 a[102:103], v14 offset:4352
    ds_read_b128 a[0:3], v8 offset:0
    ds_read_b128 a[4:7], v8 offset:1024
    ds_read_b128 a[8:11], v8 offset:2048
    ds_read_b128 a[12:15], v8 offset:3072
    ds_read_b128 a[16:19], v8 offset:4096
    ds_read_b128 a[20:23], v8 offset:5120
    ds_read_b128 a[24:27], v8 offset:6144
    ds_read_b128 a[28:31], v8 offset:7168
    ds_read_b128 a[112:115], v10 offset:0
    s_mov_b32 s67, 7
.p2align 3
L_loop0:
    s_waitcnt vmcnt(19) lgkmcnt(0)
    s_barrier
    v_mfma_f32_16x16x32_bf16 a[128:131], a[64:67], a[0:3], a[128:131]
    s_add_u32 m0, s78, 0
    v_mfma_f32_16x16x32_bf16 a[136:139], a[64:67], a[4:7], a[136:139]
    buffer_load_dwordx4 v1, s[28:31], s68 offen offset:0 sc1 lds
    v_mfma_f32_16x16x32_bf16 a[144:147], a[64:67], a[8:11], a[144:147]
    ds_read_b128 a[32:35], v8 offset:38912
    v_mfma_f32_16x16x32_bf16 a[152:155], a[64:67], a[12:15], a[152:155]
    v_mfma_f32_16x16x32_bf16 a[160:163], a[64:67], a[16:19], a[160:163]
    v_mfma_f32_16x16x32_bf16 a[168:171], a[64:67], a[20:23], a[168:171]
    v_mfma_f32_16x16x32_bf16 a[176:179], a[64:67], a[24:27], a[176:179]
    ds_read_b128 a[36:39], v8 offset:39936
    v_mfma_f32_16x16x32_bf16 a[184:187], a[64:67], a[28:31], a[184:187]
    v_mfma_f32_16x16x32_bf16 v[120:123], a[64:67], a[112:115], v[120:123]
    ds_read_b64_tr_b16 a[64:65], v12 offset:38912
    v_mfma_f32_16x16x32_bf16 a[132:135], a[68:71], a[0:3], a[132:135]
    ds_read_b64_tr_b16 a[66:67], v12 offset:39168
    buffer_load_dwordx4 v1, s[28:31], s69 offen offset:1024 sc1 lds
    v_mfma_f32_16x16x32_bf16 a[140:143], a[68:71], a[4:7], a[140:143]
    ds_read_b128 a[40:43], v8 offset:40960
    v_mfma_f32_16x16x32_bf16 a[148:151], a[68:71], a[8:11], a[148:151]
    v_mfma_f32_16x16x32_bf16 a[156:159], a[68:71], a[12:15], a[156:159]
    v_mfma_f32_16x16x32_bf16 a[164:167], a[68:71], a[16:19], a[164:167]
    v_mfma_f32_16x16x32_bf16 a[172:175], a[68:71], a[20:23], a[172:175]
    ds_read_b128 a[44:47], v8 offset:41984
    v_mfma_f32_16x16x32_bf16 a[180:183], a[68:71], a[24:27], a[180:183]
    v_mfma_f32_16x16x32_bf16 a[188:191], a[68:71], a[28:31], a[188:191]
    v_mfma_f32_16x16x32_bf16 v[124:127], a[68:71], a[112:115], v[124:127]
    ds_read_b64_tr_b16 a[68:69], v14 offset:38912
    buffer_load_dwordx4 v1, s[28:31], s70 offen offset:2048 sc1 lds
    v_mfma_f32_16x16x32_bf16 v[52:55], a[0:3], a[72:75], v[52:55]
    ds_read_b64_tr_b16 a[70:71], v14 offset:39168
    v_mfma_f32_16x16x32_bf16 v[56:59], a[4:7], a[72:75], v[56:59]
    v_mfma_f32_16x16x32_bf16 v[60:63], a[8:11], a[72:75], v[60:63]
    ds_read_b128 a[48:51], v8 offset:43008
    v_mfma_f32_16x16x32_bf16 v[64:67], a[12:15], a[72:75], v[64:67]
    v_mfma_f32_16x16x32_bf16 v[68:71], a[16:19], a[72:75], v[68:71]
    ds_read_b128 a[52:55], v8 offset:44032
    v_mfma_f32_16x16x32_bf16 v[72:75], a[20:23], a[72:75], v[72:75]
    v_mfma_f32_16x16x32_bf16 v[76:79], a[24:27], a[72:75], v[76:79]
    v_mfma_f32_16x16x32_bf16 v[80:83], a[28:31], a[72:75], v[80:83]
    buffer_load_dwordx4 v1, s[28:31], s71 offen offset:3072 sc1 lds
    v_mfma_f32_16x16x32_bf16 v[48:51], a[112:115], a[72:75], v[48:51]
    ds_read_b64_tr_b16 a[72:73], v12 offset:39936
    v_mfma_f32_16x16x32_bf16 v[88:91], a[0:3], a[76:79], v[88:91]
    ds_read_b64_tr_b16 a[74:75], v12 offset:40192
    v_mfma_f32_16x16x32_bf16 v[92:95], a[4:7], a[76:79], v[92:95]
    ds_read_b128 a[56:59], v8 offset:45056
    v_mfma_f32_16x16x32_bf16 v[96:99], a[8:11], a[76:79], v[96:99]
    v_mfma_f32_16x16x32_bf16 v[100:103], a[12:15], a[76:79], v[100:103]
    ds_read_b128 a[60:63], v8 offset:46080
    v_mfma_f32_16x16x32_bf16 v[104:107], a[16:19], a[76:79], v[104:107]
    v_mfma_f32_16x16x32_bf16 v[108:111], a[20:23], a[76:79], v[108:111]
    s_add_u32 m0, s78, 4096
    v_mfma_f32_16x16x32_bf16 v[112:115], a[24:27], a[76:79], v[112:115]
    buffer_load_dwordx4 v1, s[28:31], s72 offen offset:0 sc1 lds
    v_mfma_f32_16x16x32_bf16 v[116:119], a[28:31], a[76:79], v[116:119]
    ds_read_b128 a[116:119], v10 offset:38912
    v_mfma_f32_16x16x32_bf16 v[84:87], a[112:115], a[76:79], v[84:87]
    ds_read_b64_tr_b16 a[76:77], v14 offset:39936
    v_mfma_f32_16x16x32_bf16 a[192:195], a[80:83], a[0:3], a[192:195]
    ds_read_b64_tr_b16 a[78:79], v14 offset:40192
    v_mfma_f32_16x16x32_bf16 a[200:203], a[80:83], a[4:7], a[200:203]
    v_mfma_f32_16x16x32_bf16 a[208:211], a[80:83], a[8:11], a[208:211]
    ds_read_b64_tr_b16 a[104:105], v12 offset:43008
    v_mfma_f32_16x16x32_bf16 a[216:219], a[80:83], a[12:15], a[216:219]
    v_mfma_f32_16x16x32_bf16 a[224:227], a[80:83], a[16:19], a[224:227]
    v_mfma_f32_16x16x32_bf16 a[232:235], a[80:83], a[20:23], a[232:235]
    buffer_load_dwordx4 v1, s[28:31], s73 offen offset:1024 sc1 lds
    v_mfma_f32_16x16x32_bf16 a[240:243], a[80:83], a[24:27], a[240:243]
    ds_read_b64_tr_b16 a[106:107], v12 offset:43264
    v_mfma_f32_16x16x32_bf16 a[248:251], a[80:83], a[28:31], a[248:251]
    ds_read_b64_tr_b16 a[80:81], v12 offset:40960
    v_mfma_f32_16x16x32_bf16 a[196:199], a[84:87], a[0:3], a[196:199]
    ds_read_b64_tr_b16 a[82:83], v12 offset:41216
    v_mfma_f32_16x16x32_bf16 a[204:207], a[84:87], a[4:7], a[204:207]
    v_mfma_f32_16x16x32_bf16 a[212:215], a[84:87], a[8:11], a[212:215]
    ds_read_b64_tr_b16 a[108:109], v14 offset:43008
    v_mfma_f32_16x16x32_bf16 a[220:223], a[84:87], a[12:15], a[220:223]
    v_mfma_f32_16x16x32_bf16 a[228:231], a[84:87], a[16:19], a[228:231]
    v_mfma_f32_16x16x32_bf16 a[236:239], a[84:87], a[20:23], a[236:239]
    buffer_load_dwordx4 v1, s[28:31], s74 offen offset:2048 sc1 lds
    v_mfma_f32_16x16x32_bf16 a[244:247], a[84:87], a[24:27], a[244:247]
    ds_read_b64_tr_b16 a[110:111], v14 offset:43264
    v_mfma_f32_16x16x32_bf16 a[252:255], a[84:87], a[28:31], a[252:255]
    ds_read_b64_tr_b16 a[84:85], v14 offset:40960
    v_mfma_f32_16x16x32_bf16 v[128:131], a[88:91], a[0:3], v[128:131]
    ds_read_b64_tr_b16 a[86:87], v14 offset:41216
    v_mfma_f32_16x16x32_bf16 v[144:147], a[88:91], a[4:7], v[144:147]
    v_mfma_f32_16x16x32_bf16 v[160:163], a[88:91], a[8:11], v[160:163]
    v_mfma_f32_16x16x32_bf16 v[176:179], a[88:91], a[12:15], v[176:179]
    v_mfma_f32_16x16x32_bf16 v[192:195], a[88:91], a[16:19], v[192:195]
    v_mfma_f32_16x16x32_bf16 v[208:211], a[88:91], a[20:23], v[208:211]
    buffer_load_dwordx4 v1, s[28:31], s75 offen offset:3072 sc1 lds
    v_add_u32_e64 v1, 64, v1
    v_mfma_f32_16x16x32_bf16 v[224:227], a[88:91], a[24:27], v[224:227]
    v_mfma_f32_16x16x32_bf16 v[240:243], a[88:91], a[28:31], v[240:243]
    ds_read_b64_tr_b16 a[88:89], v12 offset:41984
    v_mfma_f32_16x16x32_bf16 v[132:135], a[92:95], a[0:3], v[132:135]
    ds_read_b64_tr_b16 a[90:91], v12 offset:42240
    v_mfma_f32_16x16x32_bf16 v[148:151], a[92:95], a[4:7], v[148:151]
    v_mfma_f32_16x16x32_bf16 v[164:167], a[92:95], a[8:11], v[164:167]
    v_mfma_f32_16x16x32_bf16 v[180:183], a[92:95], a[12:15], v[180:183]
    v_mfma_f32_16x16x32_bf16 v[196:199], a[92:95], a[16:19], v[196:199]
    v_mfma_f32_16x16x32_bf16 v[212:215], a[92:95], a[20:23], v[212:215]
    v_mfma_f32_16x16x32_bf16 v[228:231], a[92:95], a[24:27], v[228:231]
    v_mfma_f32_16x16x32_bf16 v[244:247], a[92:95], a[28:31], v[244:247]
    ds_read_b64_tr_b16 a[92:93], v14 offset:41984
    v_mfma_f32_16x16x32_bf16 v[136:139], a[96:99], a[0:3], v[136:139]
    ds_read_b64_tr_b16 a[94:95], v14 offset:42240
    v_mfma_f32_16x16x32_bf16 v[152:155], a[96:99], a[4:7], v[152:155]
    v_mfma_f32_16x16x32_bf16 v[168:171], a[96:99], a[8:11], v[168:171]
    v_mfma_f32_16x16x32_bf16 v[184:187], a[96:99], a[12:15], v[184:187]
    v_mfma_f32_16x16x32_bf16 v[200:203], a[96:99], a[16:19], v[200:203]
    v_mfma_f32_16x16x32_bf16 v[216:219], a[96:99], a[20:23], v[216:219]
    v_mfma_f32_16x16x32_bf16 v[232:235], a[96:99], a[24:27], v[232:235]
    v_mfma_f32_16x16x32_bf16 v[248:251], a[96:99], a[28:31], v[248:251]
    v_mfma_f32_16x16x32_bf16 v[140:143], a[100:103], a[0:3], v[140:143]
    v_mfma_f32_16x16x32_bf16 v[156:159], a[100:103], a[4:7], v[156:159]
    v_mfma_f32_16x16x32_bf16 v[172:175], a[100:103], a[8:11], v[172:175]
    buffer_load_dword v7, v6, s[44:47], 0 offen
    v_add_u32_e64 v6, s79, v6
    v_mfma_f32_16x16x32_bf16 v[188:191], a[100:103], a[12:15], v[188:191]
    v_mfma_f32_16x16x32_bf16 v[204:207], a[100:103], a[16:19], v[204:207]
    v_mfma_f32_16x16x32_bf16 v[220:223], a[100:103], a[20:23], v[220:223]
    v_mfma_f32_16x16x32_bf16 v[236:239], a[100:103], a[24:27], v[236:239]
    v_mfma_f32_16x16x32_bf16 v[252:255], a[100:103], a[28:31], v[252:255]
    s_waitcnt vmcnt(19) lgkmcnt(0)
    s_barrier
    v_mfma_f32_16x16x32_bf16 a[128:131], a[64:67], a[32:35], a[128:131]
    s_add_u32 m0, s78, 38912
    v_mfma_f32_16x16x32_bf16 a[136:139], a[64:67], a[36:39], a[136:139]
    buffer_load_dwordx4 v1, s[28:31], s68 offen offset:0 sc1 lds
    v_mfma_f32_16x16x32_bf16 a[144:147], a[64:67], a[40:43], a[144:147]
    ds_read_b128 a[0:3], v9 offset:0
    v_mfma_f32_16x16x32_bf16 a[152:155], a[64:67], a[44:47], a[152:155]
    v_mfma_f32_16x16x32_bf16 a[160:163], a[64:67], a[48:51], a[160:163]
    v_mfma_f32_16x16x32_bf16 a[168:171], a[64:67], a[52:55], a[168:171]
    v_mfma_f32_16x16x32_bf16 a[176:179], a[64:67], a[56:59], a[176:179]
    ds_read_b128 a[4:7], v9 offset:1024
    v_mfma_f32_16x16x32_bf16 a[184:187], a[64:67], a[60:63], a[184:187]
    v_mfma_f32_16x16x32_bf16 v[120:123], a[64:67], a[116:119], v[120:123]
    ds_read_b64_tr_b16 a[64:65], v13 offset:0
    v_mfma_f32_16x16x32_bf16 a[132:135], a[68:71], a[32:35], a[132:135]
    ds_read_b64_tr_b16 a[66:67], v13 offset:256
    buffer_load_dwordx4 v1, s[28:31], s69 offen offset:1024 sc1 lds
    v_mfma_f32_16x16x32_bf16 a[140:143], a[68:71], a[36:39], a[140:143]
    ds_read_b128 a[8:11], v9 offset:2048
    v_mfma_f32_16x16x32_bf16 a[148:151], a[68:71], a[40:43], a[148:151]
    v_mfma_f32_16x16x32_bf16 a[156:159], a[68:71], a[44:47], a[156:159]
    v_mfma_f32_16x16x32_bf16 a[164:167], a[68:71], a[48:51], a[164:167]
    v_mfma_f32_16x16x32_bf16 a[172:175], a[68:71], a[52:55], a[172:175]
    ds_read_b128 a[12:15], v9 offset:3072
    v_mfma_f32_16x16x32_bf16 a[180:183], a[68:71], a[56:59], a[180:183]
    v_mfma_f32_16x16x32_bf16 a[188:191], a[68:71], a[60:63], a[188:191]
    v_mfma_f32_16x16x32_bf16 v[124:127], a[68:71], a[116:119], v[124:127]
    ds_read_b64_tr_b16 a[68:69], v15 offset:0
    buffer_load_dwordx4 v1, s[28:31], s70 offen offset:2048 sc1 lds
    v_mfma_f32_16x16x32_bf16 v[52:55], a[32:35], a[72:75], v[52:55]
    ds_read_b64_tr_b16 a[70:71], v15 offset:256
    v_mfma_f32_16x16x32_bf16 v[56:59], a[36:39], a[72:75], v[56:59]
    v_mfma_f32_16x16x32_bf16 v[60:63], a[40:43], a[72:75], v[60:63]
    ds_read_b128 a[16:19], v9 offset:4096
    v_mfma_f32_16x16x32_bf16 v[64:67], a[44:47], a[72:75], v[64:67]
    v_mfma_f32_16x16x32_bf16 v[68:71], a[48:51], a[72:75], v[68:71]
    ds_read_b128 a[20:23], v9 offset:5120
    v_mfma_f32_16x16x32_bf16 v[72:75], a[52:55], a[72:75], v[72:75]
    v_mfma_f32_16x16x32_bf16 v[76:79], a[56:59], a[72:75], v[76:79]
    v_mfma_f32_16x16x32_bf16 v[80:83], a[60:63], a[72:75], v[80:83]
    buffer_load_dwordx4 v1, s[28:31], s71 offen offset:3072 sc1 lds
    v_mfma_f32_16x16x32_bf16 v[48:51], a[116:119], a[72:75], v[48:51]
    ds_read_b64_tr_b16 a[72:73], v13 offset:1024
    v_mfma_f32_16x16x32_bf16 v[88:91], a[32:35], a[76:79], v[88:91]
    ds_read_b64_tr_b16 a[74:75], v13 offset:1280
    v_mfma_f32_16x16x32_bf16 v[92:95], a[36:39], a[76:79], v[92:95]
    ds_read_b128 a[24:27], v9 offset:6144
    v_mfma_f32_16x16x32_bf16 v[96:99], a[40:43], a[76:79], v[96:99]
    v_mfma_f32_16x16x32_bf16 v[100:103], a[44:47], a[76:79], v[100:103]
    ds_read_b128 a[28:31], v9 offset:7168
    v_mfma_f32_16x16x32_bf16 v[104:107], a[48:51], a[76:79], v[104:107]
    v_mfma_f32_16x16x32_bf16 v[108:111], a[52:55], a[76:79], v[108:111]
    s_add_u32 m0, s78, 43008
    v_mfma_f32_16x16x32_bf16 v[112:115], a[56:59], a[76:79], v[112:115]
    buffer_load_dwordx4 v1, s[28:31], s72 offen offset:0 sc1 lds
    v_mfma_f32_16x16x32_bf16 v[116:119], a[60:63], a[76:79], v[116:119]
    ds_read_b128 a[112:115], v11 offset:0
    v_mfma_f32_16x16x32_bf16 v[84:87], a[116:119], a[76:79], v[84:87]
    ds_read_b64_tr_b16 a[76:77], v15 offset:1024
    v_mfma_f32_16x16x32_bf16 a[192:195], a[80:83], a[32:35], a[192:195]
    ds_read_b64_tr_b16 a[78:79], v15 offset:1280
    v_mfma_f32_16x16x32_bf16 a[200:203], a[80:83], a[36:39], a[200:203]
    v_mfma_f32_16x16x32_bf16 a[208:211], a[80:83], a[40:43], a[208:211]
    ds_read_b64_tr_b16 a[96:97], v13 offset:4096
    v_mfma_f32_16x16x32_bf16 a[216:219], a[80:83], a[44:47], a[216:219]
    v_mfma_f32_16x16x32_bf16 a[224:227], a[80:83], a[48:51], a[224:227]
    v_mfma_f32_16x16x32_bf16 a[232:235], a[80:83], a[52:55], a[232:235]
    buffer_load_dwordx4 v1, s[28:31], s73 offen offset:1024 sc1 lds
    v_mfma_f32_16x16x32_bf16 a[240:243], a[80:83], a[56:59], a[240:243]
    ds_read_b64_tr_b16 a[98:99], v13 offset:4352
    v_mfma_f32_16x16x32_bf16 a[248:251], a[80:83], a[60:63], a[248:251]
    ds_read_b64_tr_b16 a[80:81], v13 offset:2048
    v_mfma_f32_16x16x32_bf16 a[196:199], a[84:87], a[32:35], a[196:199]
    ds_read_b64_tr_b16 a[82:83], v13 offset:2304
    v_mfma_f32_16x16x32_bf16 a[204:207], a[84:87], a[36:39], a[204:207]
    v_mfma_f32_16x16x32_bf16 a[212:215], a[84:87], a[40:43], a[212:215]
    ds_read_b64_tr_b16 a[100:101], v15 offset:4096
    v_mfma_f32_16x16x32_bf16 a[220:223], a[84:87], a[44:47], a[220:223]
    v_mfma_f32_16x16x32_bf16 a[228:231], a[84:87], a[48:51], a[228:231]
    v_mfma_f32_16x16x32_bf16 a[236:239], a[84:87], a[52:55], a[236:239]
    buffer_load_dwordx4 v1, s[28:31], s74 offen offset:2048 sc1 lds
    v_mfma_f32_16x16x32_bf16 a[244:247], a[84:87], a[56:59], a[244:247]
    ds_read_b64_tr_b16 a[102:103], v15 offset:4352
    v_mfma_f32_16x16x32_bf16 a[252:255], a[84:87], a[60:63], a[252:255]
    ds_read_b64_tr_b16 a[84:85], v15 offset:2048
    v_mfma_f32_16x16x32_bf16 v[128:131], a[88:91], a[32:35], v[128:131]
    ds_read_b64_tr_b16 a[86:87], v15 offset:2304
    v_mfma_f32_16x16x32_bf16 v[144:147], a[88:91], a[36:39], v[144:147]
    v_mfma_f32_16x16x32_bf16 v[160:163], a[88:91], a[40:43], v[160:163]
    v_mfma_f32_16x16x32_bf16 v[176:179], a[88:91], a[44:47], v[176:179]
    v_mfma_f32_16x16x32_bf16 v[192:195], a[88:91], a[48:51], v[192:195]
    v_mfma_f32_16x16x32_bf16 v[208:211], a[88:91], a[52:55], v[208:211]
    buffer_load_dwordx4 v1, s[28:31], s75 offen offset:3072 sc1 lds
    v_add_u32_e64 v1, 64, v1
    v_mfma_f32_16x16x32_bf16 v[224:227], a[88:91], a[56:59], v[224:227]
    v_mfma_f32_16x16x32_bf16 v[240:243], a[88:91], a[60:63], v[240:243]
    ds_read_b64_tr_b16 a[88:89], v13 offset:3072
    v_mfma_f32_16x16x32_bf16 v[132:135], a[92:95], a[32:35], v[132:135]
    ds_read_b64_tr_b16 a[90:91], v13 offset:3328
    v_mfma_f32_16x16x32_bf16 v[148:151], a[92:95], a[36:39], v[148:151]
    v_mfma_f32_16x16x32_bf16 v[164:167], a[92:95], a[40:43], v[164:167]
    v_mfma_f32_16x16x32_bf16 v[180:183], a[92:95], a[44:47], v[180:183]
    v_mfma_f32_16x16x32_bf16 v[196:199], a[92:95], a[48:51], v[196:199]
    v_mfma_f32_16x16x32_bf16 v[212:215], a[92:95], a[52:55], v[212:215]
    v_mfma_f32_16x16x32_bf16 v[228:231], a[92:95], a[56:59], v[228:231]
    v_mfma_f32_16x16x32_bf16 v[244:247], a[92:95], a[60:63], v[244:247]
    ds_read_b64_tr_b16 a[92:93], v15 offset:3072
    v_mfma_f32_16x16x32_bf16 v[136:139], a[104:107], a[32:35], v[136:139]
    ds_read_b64_tr_b16 a[94:95], v15 offset:3328
    v_mfma_f32_16x16x32_bf16 v[152:155], a[104:107], a[36:39], v[152:155]
    v_mfma_f32_16x16x32_bf16 v[168:171], a[104:107], a[40:43], v[168:171]
    v_mfma_f32_16x16x32_bf16 v[184:187], a[104:107], a[44:47], v[184:187]
    v_mfma_f32_16x16x32_bf16 v[200:203], a[104:107], a[48:51], v[200:203]
    v_mfma_f32_16x16x32_bf16 v[216:219], a[104:107], a[52:55], v[216:219]
    v_mfma_f32_16x16x32_bf16 v[232:235], a[104:107], a[56:59], v[232:235]
    v_mfma_f32_16x16x32_bf16 v[248:251], a[104:107], a[60:63], v[248:251]
    v_mfma_f32_16x16x32_bf16 v[140:143], a[108:111], a[32:35], v[140:143]
    v_mfma_f32_16x16x32_bf16 v[156:159], a[108:111], a[36:39], v[156:159]
    v_mfma_f32_16x16x32_bf16 v[172:175], a[108:111], a[40:43], v[172:175]
    buffer_load_dword v7, v6, s[44:47], 0 offen
    v_add_u32_e64 v6, s79, v6
    v_mfma_f32_16x16x32_bf16 v[188:191], a[108:111], a[44:47], v[188:191]
    v_mfma_f32_16x16x32_bf16 v[204:207], a[108:111], a[48:51], v[204:207]
    v_mfma_f32_16x16x32_bf16 v[220:223], a[108:111], a[52:55], v[220:223]
    v_mfma_f32_16x16x32_bf16 v[236:239], a[108:111], a[56:59], v[236:239]
    v_mfma_f32_16x16x32_bf16 v[252:255], a[108:111], a[60:63], v[252:255]
    s_waitcnt vmcnt(19) lgkmcnt(0)
    s_barrier
    v_mfma_f32_16x16x32_bf16 a[128:131], a[64:67], a[0:3], a[128:131]
    s_add_u32 m0, s78, 77824
    v_mfma_f32_16x16x32_bf16 a[136:139], a[64:67], a[4:7], a[136:139]
    buffer_load_dwordx4 v1, s[28:31], s68 offen offset:0 sc1 lds
    v_mfma_f32_16x16x32_bf16 a[144:147], a[64:67], a[8:11], a[144:147]
    ds_read_b128 a[32:35], v9 offset:38912
    v_mfma_f32_16x16x32_bf16 a[152:155], a[64:67], a[12:15], a[152:155]
    v_mfma_f32_16x16x32_bf16 a[160:163], a[64:67], a[16:19], a[160:163]
    v_mfma_f32_16x16x32_bf16 a[168:171], a[64:67], a[20:23], a[168:171]
    v_mfma_f32_16x16x32_bf16 a[176:179], a[64:67], a[24:27], a[176:179]
    ds_read_b128 a[36:39], v9 offset:39936
    v_mfma_f32_16x16x32_bf16 a[184:187], a[64:67], a[28:31], a[184:187]
    v_mfma_f32_16x16x32_bf16 v[120:123], a[64:67], a[112:115], v[120:123]
    ds_read_b64_tr_b16 a[64:65], v13 offset:38912
    v_mfma_f32_16x16x32_bf16 a[132:135], a[68:71], a[0:3], a[132:135]
    ds_read_b64_tr_b16 a[66:67], v13 offset:39168
    buffer_load_dwordx4 v1, s[28:31], s69 offen offset:1024 sc1 lds
    v_mfma_f32_16x16x32_bf16 a[140:143], a[68:71], a[4:7], a[140:143]
    ds_read_b128 a[40:43], v9 offset:40960
    v_mfma_f32_16x16x32_bf16 a[148:151], a[68:71], a[8:11], a[148:151]
    v_mfma_f32_16x16x32_bf16 a[156:159], a[68:71], a[12:15], a[156:159]
    v_mfma_f32_16x16x32_bf16 a[164:167], a[68:71], a[16:19], a[164:167]
    v_mfma_f32_16x16x32_bf16 a[172:175], a[68:71], a[20:23], a[172:175]
    ds_read_b128 a[44:47], v9 offset:41984
    v_mfma_f32_16x16x32_bf16 a[180:183], a[68:71], a[24:27], a[180:183]
    v_mfma_f32_16x16x32_bf16 a[188:191], a[68:71], a[28:31], a[188:191]
    v_mfma_f32_16x16x32_bf16 v[124:127], a[68:71], a[112:115], v[124:127]
    ds_read_b64_tr_b16 a[68:69], v15 offset:38912
    buffer_load_dwordx4 v1, s[28:31], s70 offen offset:2048 sc1 lds
    v_mfma_f32_16x16x32_bf16 v[52:55], a[0:3], a[72:75], v[52:55]
    ds_read_b64_tr_b16 a[70:71], v15 offset:39168
    v_mfma_f32_16x16x32_bf16 v[56:59], a[4:7], a[72:75], v[56:59]
    v_mfma_f32_16x16x32_bf16 v[60:63], a[8:11], a[72:75], v[60:63]
    ds_read_b128 a[48:51], v9 offset:43008
    v_mfma_f32_16x16x32_bf16 v[64:67], a[12:15], a[72:75], v[64:67]
    v_mfma_f32_16x16x32_bf16 v[68:71], a[16:19], a[72:75], v[68:71]
    ds_read_b128 a[52:55], v9 offset:44032
    v_mfma_f32_16x16x32_bf16 v[72:75], a[20:23], a[72:75], v[72:75]
    v_mfma_f32_16x16x32_bf16 v[76:79], a[24:27], a[72:75], v[76:79]
    v_mfma_f32_16x16x32_bf16 v[80:83], a[28:31], a[72:75], v[80:83]
    buffer_load_dwordx4 v1, s[28:31], s71 offen offset:3072 sc1 lds
    v_mfma_f32_16x16x32_bf16 v[48:51], a[112:115], a[72:75], v[48:51]
    ds_read_b64_tr_b16 a[72:73], v13 offset:39936
    v_mfma_f32_16x16x32_bf16 v[88:91], a[0:3], a[76:79], v[88:91]
    ds_read_b64_tr_b16 a[74:75], v13 offset:40192
    v_mfma_f32_16x16x32_bf16 v[92:95], a[4:7], a[76:79], v[92:95]
    ds_read_b128 a[56:59], v9 offset:45056
    v_mfma_f32_16x16x32_bf16 v[96:99], a[8:11], a[76:79], v[96:99]
    v_mfma_f32_16x16x32_bf16 v[100:103], a[12:15], a[76:79], v[100:103]
    ds_read_b128 a[60:63], v9 offset:46080
    v_mfma_f32_16x16x32_bf16 v[104:107], a[16:19], a[76:79], v[104:107]
    v_mfma_f32_16x16x32_bf16 v[108:111], a[20:23], a[76:79], v[108:111]
    s_add_u32 m0, s78, 81920
    v_mfma_f32_16x16x32_bf16 v[112:115], a[24:27], a[76:79], v[112:115]
    buffer_load_dwordx4 v1, s[28:31], s72 offen offset:0 sc1 lds
    v_mfma_f32_16x16x32_bf16 v[116:119], a[28:31], a[76:79], v[116:119]
    ds_read_b128 a[116:119], v11 offset:38912
    v_mfma_f32_16x16x32_bf16 v[84:87], a[112:115], a[76:79], v[84:87]
    ds_read_b64_tr_b16 a[76:77], v15 offset:39936
    v_mfma_f32_16x16x32_bf16 a[192:195], a[80:83], a[0:3], a[192:195]
    ds_read_b64_tr_b16 a[78:79], v15 offset:40192
    v_mfma_f32_16x16x32_bf16 a[200:203], a[80:83], a[4:7], a[200:203]
    v_mfma_f32_16x16x32_bf16 a[208:211], a[80:83], a[8:11], a[208:211]
    ds_read_b64_tr_b16 a[104:105], v13 offset:43008
    v_mfma_f32_16x16x32_bf16 a[216:219], a[80:83], a[12:15], a[216:219]
    v_mfma_f32_16x16x32_bf16 a[224:227], a[80:83], a[16:19], a[224:227]
    v_mfma_f32_16x16x32_bf16 a[232:235], a[80:83], a[20:23], a[232:235]
    buffer_load_dwordx4 v1, s[28:31], s73 offen offset:1024 sc1 lds
    v_mfma_f32_16x16x32_bf16 a[240:243], a[80:83], a[24:27], a[240:243]
    ds_read_b64_tr_b16 a[106:107], v13 offset:43264
    v_mfma_f32_16x16x32_bf16 a[248:251], a[80:83], a[28:31], a[248:251]
    ds_read_b64_tr_b16 a[80:81], v13 offset:40960
    v_mfma_f32_16x16x32_bf16 a[196:199], a[84:87], a[0:3], a[196:199]
    ds_read_b64_tr_b16 a[82:83], v13 offset:41216
    v_mfma_f32_16x16x32_bf16 a[204:207], a[84:87], a[4:7], a[204:207]
    v_mfma_f32_16x16x32_bf16 a[212:215], a[84:87], a[8:11], a[212:215]
    ds_read_b64_tr_b16 a[108:109], v15 offset:43008
    v_mfma_f32_16x16x32_bf16 a[220:223], a[84:87], a[12:15], a[220:223]
    v_mfma_f32_16x16x32_bf16 a[228:231], a[84:87], a[16:19], a[228:231]
    v_mfma_f32_16x16x32_bf16 a[236:239], a[84:87], a[20:23], a[236:239]
    buffer_load_dwordx4 v1, s[28:31], s74 offen offset:2048 sc1 lds
    v_mfma_f32_16x16x32_bf16 a[244:247], a[84:87], a[24:27], a[244:247]
    ds_read_b64_tr_b16 a[110:111], v15 offset:43264
    v_mfma_f32_16x16x32_bf16 a[252:255], a[84:87], a[28:31], a[252:255]
    ds_read_b64_tr_b16 a[84:85], v15 offset:40960
    v_mfma_f32_16x16x32_bf16 v[128:131], a[88:91], a[0:3], v[128:131]
    ds_read_b64_tr_b16 a[86:87], v15 offset:41216
    v_mfma_f32_16x16x32_bf16 v[144:147], a[88:91], a[4:7], v[144:147]
    v_mfma_f32_16x16x32_bf16 v[160:163], a[88:91], a[8:11], v[160:163]
    v_mfma_f32_16x16x32_bf16 v[176:179], a[88:91], a[12:15], v[176:179]
    v_mfma_f32_16x16x32_bf16 v[192:195], a[88:91], a[16:19], v[192:195]
    v_mfma_f32_16x16x32_bf16 v[208:211], a[88:91], a[20:23], v[208:211]
    buffer_load_dwordx4 v1, s[28:31], s75 offen offset:3072 sc1 lds
    v_add_u32_e64 v1, 64, v1
    v_mfma_f32_16x16x32_bf16 v[224:227], a[88:91], a[24:27], v[224:227]
    v_mfma_f32_16x16x32_bf16 v[240:243], a[88:91], a[28:31], v[240:243]
    ds_read_b64_tr_b16 a[88:89], v13 offset:41984
    v_mfma_f32_16x16x32_bf16 v[132:135], a[92:95], a[0:3], v[132:135]
    ds_read_b64_tr_b16 a[90:91], v13 offset:42240
    v_mfma_f32_16x16x32_bf16 v[148:151], a[92:95], a[4:7], v[148:151]
    v_mfma_f32_16x16x32_bf16 v[164:167], a[92:95], a[8:11], v[164:167]
    v_mfma_f32_16x16x32_bf16 v[180:183], a[92:95], a[12:15], v[180:183]
    v_mfma_f32_16x16x32_bf16 v[196:199], a[92:95], a[16:19], v[196:199]
    v_mfma_f32_16x16x32_bf16 v[212:215], a[92:95], a[20:23], v[212:215]
    v_mfma_f32_16x16x32_bf16 v[228:231], a[92:95], a[24:27], v[228:231]
    v_mfma_f32_16x16x32_bf16 v[244:247], a[92:95], a[28:31], v[244:247]
    ds_read_b64_tr_b16 a[92:93], v15 offset:41984
    v_mfma_f32_16x16x32_bf16 v[136:139], a[96:99], a[0:3], v[136:139]
    ds_read_b64_tr_b16 a[94:95], v15 offset:42240
    v_mfma_f32_16x16x32_bf16 v[152:155], a[96:99], a[4:7], v[152:155]
    v_mfma_f32_16x16x32_bf16 v[168:171], a[96:99], a[8:11], v[168:171]
    v_mfma_f32_16x16x32_bf16 v[184:187], a[96:99], a[12:15], v[184:187]
    v_mfma_f32_16x16x32_bf16 v[200:203], a[96:99], a[16:19], v[200:203]
    v_mfma_f32_16x16x32_bf16 v[216:219], a[96:99], a[20:23], v[216:219]
    v_mfma_f32_16x16x32_bf16 v[232:235], a[96:99], a[24:27], v[232:235]
    v_mfma_f32_16x16x32_bf16 v[248:251], a[96:99], a[28:31], v[248:251]
    v_mfma_f32_16x16x32_bf16 v[140:143], a[100:103], a[0:3], v[140:143]
    v_mfma_f32_16x16x32_bf16 v[156:159], a[100:103], a[4:7], v[156:159]
    v_mfma_f32_16x16x32_bf16 v[172:175], a[100:103], a[8:11], v[172:175]
    buffer_load_dword v7, v6, s[44:47], 0 offen
    v_add_u32_e64 v6, s79, v6
    v_mfma_f32_16x16x32_bf16 v[188:191], a[100:103], a[12:15], v[188:191]
    v_mfma_f32_16x16x32_bf16 v[204:207], a[100:103], a[16:19], v[204:207]
    v_mfma_f32_16x16x32_bf16 v[220:223], a[100:103], a[20:23], v[220:223]
    v_mfma_f32_16x16x32_bf16 v[236:239], a[100:103], a[24:27], v[236:239]
    v_mfma_f32_16x16x32_bf16 v[252:255], a[100:103], a[28:31], v[252:255]
    s_waitcnt vmcnt(19) lgkmcnt(0)
    s_barrier
    v_mfma_f32_16x16x32_bf16 a[128:131], a[64:67], a[32:35], a[128:131]
    s_add_u32 m0, s78, 116736
    v_mfma_f32_16x16x32_bf16 a[136:139], a[64:67], a[36:39], a[136:139]
    buffer_load_dwordx4 v1, s[28:31], s68 offen offset:0 sc1 lds
    v_mfma_f32_16x16x32_bf16 a[144:147], a[64:67], a[40:43], a[144:147]
    ds_read_b128 a[0:3], v8 offset:0
    v_mfma_f32_16x16x32_bf16 a[152:155], a[64:67], a[44:47], a[152:155]
    v_mfma_f32_16x16x32_bf16 a[160:163], a[64:67], a[48:51], a[160:163]
    v_mfma_f32_16x16x32_bf16 a[168:171], a[64:67], a[52:55], a[168:171]
    v_mfma_f32_16x16x32_bf16 a[176:179], a[64:67], a[56:59], a[176:179]
    ds_read_b128 a[4:7], v8 offset:1024
    v_mfma_f32_16x16x32_bf16 a[184:187], a[64:67], a[60:63], a[184:187]
    v_mfma_f32_16x16x32_bf16 v[120:123], a[64:67], a[116:119], v[120:123]
    ds_read_b64_tr_b16 a[64:65], v12 offset:0
    v_mfma_f32_16x16x32_bf16 a[132:135], a[68:71], a[32:35], a[132:135]
    ds_read_b64_tr_b16 a[66:67], v12 offset:256
    buffer_load_dwordx4 v1, s[28:31], s69 offen offset:1024 sc1 lds
    v_mfma_f32_16x16x32_bf16 a[140:143], a[68:71], a[36:39], a[140:143]
    ds_read_b128 a[8:11], v8 offset:2048
    v_mfma_f32_16x16x32_bf16 a[148:151], a[68:71], a[40:43], a[148:151]
    v_mfma_f32_16x16x32_bf16 a[156:159], a[68:71], a[44:47], a[156:159]
    v_mfma_f32_16x16x32_bf16 a[164:167], a[68:71], a[48:51], a[164:167]
    v_mfma_f32_16x16x32_bf16 a[172:175], a[68:71], a[52:55], a[172:175]
    ds_read_b128 a[12:15], v8 offset:3072
    v_mfma_f32_16x16x32_bf16 a[180:183], a[68:71], a[56:59], a[180:183]
    v_mfma_f32_16x16x32_bf16 a[188:191], a[68:71], a[60:63], a[188:191]
    v_mfma_f32_16x16x32_bf16 v[124:127], a[68:71], a[116:119], v[124:127]
    ds_read_b64_tr_b16 a[68:69], v14 offset:0
    buffer_load_dwordx4 v1, s[28:31], s70 offen offset:2048 sc1 lds
    v_mfma_f32_16x16x32_bf16 v[52:55], a[32:35], a[72:75], v[52:55]
    ds_read_b64_tr_b16 a[70:71], v14 offset:256
    v_mfma_f32_16x16x32_bf16 v[56:59], a[36:39], a[72:75], v[56:59]
    v_mfma_f32_16x16x32_bf16 v[60:63], a[40:43], a[72:75], v[60:63]
    ds_read_b128 a[16:19], v8 offset:4096
    v_mfma_f32_16x16x32_bf16 v[64:67], a[44:47], a[72:75], v[64:67]
    v_mfma_f32_16x16x32_bf16 v[68:71], a[48:51], a[72:75], v[68:71]
    ds_read_b128 a[20:23], v8 offset:5120
    v_mfma_f32_16x16x32_bf16 v[72:75], a[52:55], a[72:75], v[72:75]
    v_mfma_f32_16x16x32_bf16 v[76:79], a[56:59], a[72:75], v[76:79]
    v_mfma_f32_16x16x32_bf16 v[80:83], a[60:63], a[72:75], v[80:83]
    buffer_load_dwordx4 v1, s[28:31], s71 offen offset:3072 sc1 lds
    v_mfma_f32_16x16x32_bf16 v[48:51], a[116:119], a[72:75], v[48:51]
    ds_read_b64_tr_b16 a[72:73], v12 offset:1024
    v_mfma_f32_16x16x32_bf16 v[88:91], a[32:35], a[76:79], v[88:91]
    ds_read_b64_tr_b16 a[74:75], v12 offset:1280
    v_mfma_f32_16x16x32_bf16 v[92:95], a[36:39], a[76:79], v[92:95]
    ds_read_b128 a[24:27], v8 offset:6144
    v_mfma_f32_16x16x32_bf16 v[96:99], a[40:43], a[76:79], v[96:99]
    v_mfma_f32_16x16x32_bf16 v[100:103], a[44:47], a[76:79], v[100:103]
    ds_read_b128 a[28:31], v8 offset:7168
    v_mfma_f32_16x16x32_bf16 v[104:107], a[48:51], a[76:79], v[104:107]
    v_mfma_f32_16x16x32_bf16 v[108:111], a[52:55], a[76:79], v[108:111]
    s_add_u32 m0, s78, 120832
    v_mfma_f32_16x16x32_bf16 v[112:115], a[56:59], a[76:79], v[112:115]
    buffer_load_dwordx4 v1, s[28:31], s72 offen offset:0 sc1 lds
    v_mfma_f32_16x16x32_bf16 v[116:119], a[60:63], a[76:79], v[116:119]
    ds_read_b128 a[112:115], v10 offset:0
    v_mfma_f32_16x16x32_bf16 v[84:87], a[116:119], a[76:79], v[84:87]
    ds_read_b64_tr_b16 a[76:77], v14 offset:1024
    v_mfma_f32_16x16x32_bf16 a[192:195], a[80:83], a[32:35], a[192:195]
    ds_read_b64_tr_b16 a[78:79], v14 offset:1280
    v_mfma_f32_16x16x32_bf16 a[200:203], a[80:83], a[36:39], a[200:203]
    v_mfma_f32_16x16x32_bf16 a[208:211], a[80:83], a[40:43], a[208:211]
    ds_read_b64_tr_b16 a[96:97], v12 offset:4096
    v_mfma_f32_16x16x32_bf16 a[216:219], a[80:83], a[44:47], a[216:219]
    v_mfma_f32_16x16x32_bf16 a[224:227], a[80:83], a[48:51], a[224:227]
    v_mfma_f32_16x16x32_bf16 a[232:235], a[80:83], a[52:55], a[232:235]
    buffer_load_dwordx4 v1, s[28:31], s73 offen offset:1024 sc1 lds
    v_mfma_f32_16x16x32_bf16 a[240:243], a[80:83], a[56:59], a[240:243]
    ds_read_b64_tr_b16 a[98:99], v12 offset:4352
    v_mfma_f32_16x16x32_bf16 a[248:251], a[80:83], a[60:63], a[248:251]
    ds_read_b64_tr_b16 a[80:81], v12 offset:2048
    v_mfma_f32_16x16x32_bf16 a[196:199], a[84:87], a[32:35], a[196:199]
    ds_read_b64_tr_b16 a[82:83], v12 offset:2304
    v_mfma_f32_16x16x32_bf16 a[204:207], a[84:87], a[36:39], a[204:207]
    v_mfma_f32_16x16x32_bf16 a[212:215], a[84:87], a[40:43], a[212:215]
    ds_read_b64_tr_b16 a[100:101], v14 offset:4096
    v_mfma_f32_16x16x32_bf16 a[220:223], a[84:87], a[44:47], a[220:223]
    v_mfma_f32_16x16x32_bf16 a[228:231], a[84:87], a[48:51], a[228:231]
    v_mfma_f32_16x16x32_bf16 a[236:239], a[84:87], a[52:55], a[236:239]
    buffer_load_dwordx4 v1, s[28:31], s74 offen offset:2048 sc1 lds
    v_mfma_f32_16x16x32_bf16 a[244:247], a[84:87], a[56:59], a[244:247]
    ds_read_b64_tr_b16 a[102:103], v14 offset:4352
    v_mfma_f32_16x16x32_bf16 a[252:255], a[84:87], a[60:63], a[252:255]
    ds_read_b64_tr_b16 a[84:85], v14 offset:2048
    v_mfma_f32_16x16x32_bf16 v[128:131], a[88:91], a[32:35], v[128:131]
    ds_read_b64_tr_b16 a[86:87], v14 offset:2304
    v_mfma_f32_16x16x32_bf16 v[144:147], a[88:91], a[36:39], v[144:147]
    v_mfma_f32_16x16x32_bf16 v[160:163], a[88:91], a[40:43], v[160:163]
    v_mfma_f32_16x16x32_bf16 v[176:179], a[88:91], a[44:47], v[176:179]
    v_mfma_f32_16x16x32_bf16 v[192:195], a[88:91], a[48:51], v[192:195]
    v_mfma_f32_16x16x32_bf16 v[208:211], a[88:91], a[52:55], v[208:211]
    buffer_load_dwordx4 v1, s[28:31], s75 offen offset:3072 sc1 lds
    v_add_u32_e64 v1, 64, v1
    v_mfma_f32_16x16x32_bf16 v[224:227], a[88:91], a[56:59], v[224:227]
    v_mfma_f32_16x16x32_bf16 v[240:243], a[88:91], a[60:63], v[240:243]
    ds_read_b64_tr_b16 a[88:89], v12 offset:3072
    v_mfma_f32_16x16x32_bf16 v[132:135], a[92:95], a[32:35], v[132:135]
    ds_read_b64_tr_b16 a[90:91], v12 offset:3328
    v_mfma_f32_16x16x32_bf16 v[148:151], a[92:95], a[36:39], v[148:151]
    v_mfma_f32_16x16x32_bf16 v[164:167], a[92:95], a[40:43], v[164:167]
    v_mfma_f32_16x16x32_bf16 v[180:183], a[92:95], a[44:47], v[180:183]
    v_mfma_f32_16x16x32_bf16 v[196:199], a[92:95], a[48:51], v[196:199]
    v_mfma_f32_16x16x32_bf16 v[212:215], a[92:95], a[52:55], v[212:215]
    v_mfma_f32_16x16x32_bf16 v[228:231], a[92:95], a[56:59], v[228:231]
    v_mfma_f32_16x16x32_bf16 v[244:247], a[92:95], a[60:63], v[244:247]
    ds_read_b64_tr_b16 a[92:93], v14 offset:3072
    v_mfma_f32_16x16x32_bf16 v[136:139], a[104:107], a[32:35], v[136:139]
    ds_read_b64_tr_b16 a[94:95], v14 offset:3328
    v_mfma_f32_16x16x32_bf16 v[152:155], a[104:107], a[36:39], v[152:155]
    v_mfma_f32_16x16x32_bf16 v[168:171], a[104:107], a[40:43], v[168:171]
    v_mfma_f32_16x16x32_bf16 v[184:187], a[104:107], a[44:47], v[184:187]
    v_mfma_f32_16x16x32_bf16 v[200:203], a[104:107], a[48:51], v[200:203]
    v_mfma_f32_16x16x32_bf16 v[216:219], a[104:107], a[52:55], v[216:219]
    v_mfma_f32_16x16x32_bf16 v[232:235], a[104:107], a[56:59], v[232:235]
    v_mfma_f32_16x16x32_bf16 v[248:251], a[104:107], a[60:63], v[248:251]
    v_mfma_f32_16x16x32_bf16 v[140:143], a[108:111], a[32:35], v[140:143]
    v_mfma_f32_16x16x32_bf16 v[156:159], a[108:111], a[36:39], v[156:159]
    v_mfma_f32_16x16x32_bf16 v[172:175], a[108:111], a[40:43], v[172:175]
    buffer_load_dword v7, v6, s[44:47], 0 offen
    v_add_u32_e64 v6, s79, v6
    v_mfma_f32_16x16x32_bf16 v[188:191], a[108:111], a[44:47], v[188:191]
    v_mfma_f32_16x16x32_bf16 v[204:207], a[108:111], a[48:51], v[204:207]
    v_mfma_f32_16x16x32_bf16 v[220:223], a[108:111], a[52:55], v[220:223]
    v_mfma_f32_16x16x32_bf16 v[236:239], a[108:111], a[56:59], v[236:239]
    v_mfma_f32_16x16x32_bf16 v[252:255], a[108:111], a[60:63], v[252:255]
    s_sub_u32 s67, s67, 1
    s_cmp_lg_u32 s67, 0
    s_cbranch_scc1 L_loop0
    s_waitcnt vmcnt(19) lgkmcnt(0)
    s_barrier
    v_mfma_f32_16x16x32_bf16 a[128:131], a[64:67], a[0:3], a[128:131]
    v_mfma_f32_16x16x32_bf16 a[136:139], a[64:67], a[4:7], a[136:139]
    v_mfma_f32_16x16x32_bf16 a[144:147], a[64:67], a[8:11], a[144:147]
    ds_read_b128 a[32:35], v8 offset:38912
    v_mfma_f32_16x16x32_bf16 a[152:155], a[64:67], a[12:15], a[152:155]
    v_mfma_f32_16x16x32_bf16 a[160:163], a[64:67], a[16:19], a[160:163]
    v_mfma_f32_16x16x32_bf16 a[168:171], a[64:67], a[20:23], a[168:171]
    v_mfma_f32_16x16x32_bf16 a[176:179], a[64:67], a[24:27], a[176:179]
    ds_read_b128 a[36:39], v8 offset:39936
    v_mfma_f32_16x16x32_bf16 a[184:187], a[64:67], a[28:31], a[184:187]
    v_mfma_f32_16x16x32_bf16 v[120:123], a[64:67], a[112:115], v[120:123]
    ds_read_b64_tr_b16 a[64:65], v12 offset:38912
    v_mfma_f32_16x16x32_bf16 a[132:135], a[68:71], a[0:3], a[132:135]
    ds_read_b64_tr_b16 a[66:67], v12 offset:39168
    v_mfma_f32_16x16x32_bf16 a[140:143], a[68:71], a[4:7], a[140:143]
    ds_read_b128 a[40:43], v8 offset:40960
    v_mfma_f32_16x16x32_bf16 a[148:151], a[68:71], a[8:11], a[148:151]
    v_mfma_f32_16x16x32_bf16 a[156:159], a[68:71], a[12:15], a[156:159]
    v_mfma_f32_16x16x32_bf16 a[164:167], a[68:71], a[16:19], a[164:167]
    v_mfma_f32_16x16x32_bf16 a[172:175], a[68:71], a[20:23], a[172:175]
    ds_read_b128 a[44:47], v8 offset:41984
    v_mfma_f32_16x16x32_bf16 a[180:183], a[68:71], a[24:27], a[180:183]
    v_mfma_f32_16x16x32_bf16 a[188:191], a[68:71], a[28:31], a[188:191]
    v_mfma_f32_16x16x32_bf16 v[124:127], a[68:71], a[112:115], v[124:127]
    ds_read_b64_tr_b16 a[68:69], v14 offset:38912
    v_mfma_f32_16x16x32_bf16 v[52:55], a[0:3], a[72:75], v[52:55]
    ds_read_b64_tr_b16 a[70:71], v14 offset:39168
    v_mfma_f32_16x16x32_bf16 v[56:59], a[4:7], a[72:75], v[56:59]
    v_mfma_f32_16x16x32_bf16 v[60:63], a[8:11], a[72:75], v[60:63]
    ds_read_b128 a[48:51], v8 offset:43008
    v_mfma_f32_16x16x32_bf16 v[64:67], a[12:15], a[72:75], v[64:67]
    v_mfma_f32_16x16x32_bf16 v[68:71], a[16:19], a[72:75], v[68:71]
    ds_read_b128 a[52:55], v8 offset:44032
    v_mfma_f32_16x16x32_bf16 v[72:75], a[20:23], a[72:75], v[72:75]
    v_mfma_f32_16x16x32_bf16 v[76:79], a[24:27], a[72:75], v[76:79]
    v_mfma_f32_16x16x32_bf16 v[80:83], a[28:31], a[72:75], v[80:83]
    v_mfma_f32_16x16x32_bf16 v[48:51], a[112:115], a[72:75], v[48:51]
    ds_read_b64_tr_b16 a[72:73], v12 offset:39936
    v_mfma_f32_16x16x32_bf16 v[88:91], a[0:3], a[76:79], v[88:91]
    ds_read_b64_tr_b16 a[74:75], v12 offset:40192
    v_mfma_f32_16x16x32_bf16 v[92:95], a[4:7], a[76:79], v[92:95]
    ds_read_b128 a[56:59], v8 offset:45056
    v_mfma_f32_16x16x32_bf16 v[96:99], a[8:11], a[76:79], v[96:99]
    v_mfma_f32_16x16x32_bf16 v[100:103], a[12:15], a[76:79], v[100:103]
    ds_read_b128 a[60:63], v8 offset:46080
    v_mfma_f32_16x16x32_bf16 v[104:107], a[16:19], a[76:79], v[104:107]
    v_mfma_f32_16x16x32_bf16 v[108:111], a[20:23], a[76:79], v[108:111]
    v_mfma_f32_16x16x32_bf16 v[112:115], a[24:27], a[76:79], v[112:115]
    v_mfma_f32_16x16x32_bf16 v[116:119], a[28:31], a[76:79], v[116:119]
    ds_read_b128 a[116:119], v10 offset:38912
    v_mfma_f32_16x16x32_bf16 v[84:87], a[112:115], a[76:79], v[84:87]
    ds_read_b64_tr_b16 a[76:77], v14 offset:39936
    v_mfma_f32_16x16x32_bf16 a[192:195], a[80:83], a[0:3], a[192:195]
    ds_read_b64_tr_b16 a[78:79], v14 offset:40192
    v_mfma_f32_16x16x32_bf16 a[200:203], a[80:83], a[4:7], a[200:203]
    v_mfma_f32_16x16x32_bf16 a[208:211], a[80:83], a[8:11], a[208:211]
    ds_read_b64_tr_b16 a[104:105], v12 offset:43008
    v_mfma_f32_16x16x32_bf16 a[216:219], a[80:83], a[12:15], a[216:219]
    v_mfma_f32_16x16x32_bf16 a[224:227], a[80:83], a[16:19], a[224:227]
    v_mfma_f32_16x16x32_bf16 a[232:235], a[80:83], a[20:23], a[232:235]
    v_mfma_f32_16x16x32_bf16 a[240:243], a[80:83], a[24:27], a[240:243]
    ds_read_b64_tr_b16 a[106:107], v12 offset:43264
    v_mfma_f32_16x16x32_bf16 a[248:251], a[80:83], a[28:31], a[248:251]
    ds_read_b64_tr_b16 a[80:81], v12 offset:40960
    v_mfma_f32_16x16x32_bf16 a[196:199], a[84:87], a[0:3], a[196:199]
    ds_read_b64_tr_b16 a[82:83], v12 offset:41216
    v_mfma_f32_16x16x32_bf16 a[204:207], a[84:87], a[4:7], a[204:207]
    v_mfma_f32_16x16x32_bf16 a[212:215], a[84:87], a[8:11], a[212:215]
    ds_read_b64_tr_b16 a[108:109], v14 offset:43008
    v_mfma_f32_16x16x32_bf16 a[220:223], a[84:87], a[12:15], a[220:223]
    v_mfma_f32_16x16x32_bf16 a[228:231], a[84:87], a[16:19], a[228:231]
    v_mfma_f32_16x16x32_bf16 a[236:239], a[84:87], a[20:23], a[236:239]
    v_mfma_f32_16x16x32_bf16 a[244:247], a[84:87], a[24:27], a[244:247]
    ds_read_b64_tr_b16 a[110:111], v14 offset:43264
    v_mfma_f32_16x16x32_bf16 a[252:255], a[84:87], a[28:31], a[252:255]
    ds_read_b64_tr_b16 a[84:85], v14 offset:40960
    v_mfma_f32_16x16x32_bf16 v[128:131], a[88:91], a[0:3], v[128:131]
    ds_read_b64_tr_b16 a[86:87], v14 offset:41216
    v_mfma_f32_16x16x32_bf16 v[144:147], a[88:91], a[4:7], v[144:147]
    v_mfma_f32_16x16x32_bf16 v[160:163], a[88:91], a[8:11], v[160:163]
    v_mfma_f32_16x16x32_bf16 v[176:179], a[88:91], a[12:15], v[176:179]
    v_mfma_f32_16x16x32_bf16 v[192:195], a[88:91], a[16:19], v[192:195]
    v_mfma_f32_16x16x32_bf16 v[208:211], a[88:91], a[20:23], v[208:211]
    v_mfma_f32_16x16x32_bf16 v[224:227], a[88:91], a[24:27], v[224:227]
    v_mfma_f32_16x16x32_bf16 v[240:243], a[88:91], a[28:31], v[240:243]
    ds_read_b64_tr_b16 a[88:89], v12 offset:41984
    v_mfma_f32_16x16x32_bf16 v[132:135], a[92:95], a[0:3], v[132:135]
    ds_read_b64_tr_b16 a[90:91], v12 offset:42240
    v_mfma_f32_16x16x32_bf16 v[148:151], a[92:95], a[4:7], v[148:151]
    v_mfma_f32_16x16x32_bf16 v[164:167], a[92:95], a[8:11], v[164:167]
    v_mfma_f32_16x16x32_bf16 v[180:183], a[92:95], a[12:15], v[180:183]
    v_mfma_f32_16x16x32_bf16 v[196:199], a[92:95], a[16:19], v[196:199]
    v_mfma_f32_16x16x32_bf16 v[212:215], a[92:95], a[20:23], v[212:215]
    v_mfma_f32_16x16x32_bf16 v[228:231], a[92:95], a[24:27], v[228:231]
    v_mfma_f32_16x16x32_bf16 v[244:247], a[92:95], a[28:31], v[244:247]
    ds_read_b64_tr_b16 a[92:93], v14 offset:41984
    v_mfma_f32_16x16x32_bf16 v[136:139], a[96:99], a[0:3], v[136:139]
    ds_read_b64_tr_b16 a[94:95], v14 offset:42240
    v_mfma_f32_16x16x32_bf16 v[152:155], a[96:99], a[4:7], v[152:155]
    v_mfma_f32_16x16x32_bf16 v[168:171], a[96:99], a[8:11], v[168:171]
    s_getpc_b64 s[86:87]
L_pc0:
    s_add_u32 s86, s86, L_epi-L_pc0
    s_addc_u32 s87, s87, 0
    s_lshr_b32 s82, s2, 3
    s_lshl_b32 s82, s82, 2
    s_add_u32 s82, s82, s60
    s_lshl_b32 s82, s82, 10
    v_add_u32 v34, s82, v16
    v_min_u32 v34, L_code_end-L_epi-4, v34
    global_load_dword v7, v34, s[86:87]
    s_lshl_b32 s82, s2, 2
    s_add_u32 s82, s82, s60
    s_lshl_b32 s82, s82, 11
    v_and_b32 v35, 31, v0
    v_lshlrev_b32 v35, 6, v35
    v_add_u32 v35, s82, v35
    global_load_dword v7, v35, s[12:13]
    v_mfma_f32_16x16x32_bf16 v[184:187], a[96:99], a[12:15], v[184:187]
    v_mfma_f32_16x16x32_bf16 v[200:203], a[96:99], a[16:19], v[200:203]
    v_mfma_f32_16x16x32_bf16 v[216:219], a[96:99], a[20:23], v[216:219]
    v_mfma_f32_16x16x32_bf16 v[232:235], a[96:99], a[24:27], v[232:235]
    v_mfma_f32_16x16x32_bf16 v[248:251], a[96:99], a[28:31], v[248:251]
    v_mfma_f32_16x16x32_bf16 v[140:143], a[100:103], a[0:3], v[140:143]
    v_mfma_f32_16x16x32_bf16 v[156:159], a[100:103], a[4:7], v[156:159]
    v_mfma_f32_16x16x32_bf16 v[172:175], a[100:103], a[8:11], v[172:175]
    v_mfma_f32_16x16x32_bf16 v[188:191], a[100:103], a[12:15], v[188:191]
    v_mfma_f32_16x16x32_bf16 v[204:207], a[100:103], a[16:19], v[204:207]
    v_mfma_f32_16x16x32_bf16 v[220:223], a[100:103], a[20:23], v[220:223]
    v_mfma_f32_16x16x32_bf16 v[236:239], a[100:103], a[24:27], v[236:239]
    v_mfma_f32_16x16x32_bf16 v[252:255], a[100:103], a[28:31], v[252:255]
    s_waitcnt vmcnt(12) lgkmcnt(0)
    s_barrier
    v_mfma_f32_16x16x32_bf16 a[128:131], a[64:67], a[32:35], a[128:131]
    v_mfma_f32_16x16x32_bf16 a[136:139], a[64:67], a[36:39], a[136:139]
    v_mfma_f32_16x16x32_bf16 a[144:147], a[64:67], a[40:43], a[144:147]
    ds_read_b128 a[0:3], v9 offset:0
    v_mfma_f32_16x16x32_bf16 a[152:155], a[64:67], a[44:47], a[152:155]
    v_mfma_f32_16x16x32_bf16 a[160:163], a[64:67], a[48:51], a[160:163]
    s_mul_i32 s82, s65, 1835008
    s_lshl_b32 s83, s66, 8
    v_mfma_f32_16x16x32_bf16 a[168:171], a[64:67], a[52:55], a[168:171]
    s_add_u32 s82, s82, s83
    s_add_u32 s48, s20, s82
    v_mfma_f32_16x16x32_bf16 a[176:179], a[64:67], a[56:59], a[176:179]
    ds_read_b128 a[4:7], v9 offset:1024
    s_addc_u32 s49, s21, 0
    s_and_b32 s49, s49, 0xffff
    v_mfma_f32_16x16x32_bf16 a[184:187], a[64:67], a[60:63], a[184:187]
    s_sub_u32 s50, 7340032, s82
    s_mov_b32 s51, 0x20000
    v_mfma_f32_16x16x32_bf16 v[120:123], a[64:67], a[116:119], v[120:123]
    ds_read_b64_tr_b16 a[64:65], v13 offset:0
    s_add_u32 s52, s12, s83
    s_addc_u32 s53, s13, 0
    v_mfma_f32_16x16x32_bf16 a[132:135], a[68:71], a[32:35], a[132:135]
    ds_read_b64_tr_b16 a[66:67], v13 offset:256
    s_and_b32 s53, s53, 0xffff
    s_sub_u32 s54, 2097152, s83
    v_mfma_f32_16x16x32_bf16 a[140:143], a[68:71], a[36:39], a[140:143]
    ds_read_b128 a[8:11], v9 offset:2048
    s_mov_b32 s55, 0x20000
    s_lshl_b32 s3, s60, 11
    v_mfma_f32_16x16x32_bf16 a[148:151], a[68:71], a[40:43], a[148:151]
    v_lshrrev_b32 v34, 4, v0
    v_and_b32 v35, 15, v0
    v_mfma_f32_16x16x32_bf16 a[156:159], a[68:71], a[44:47], a[156:159]
    v_lshlrev_b32 v36, 1, v34
    v_add_u32 v36, 0, v36
    v_mfma_f32_16x16x32_bf16 a[164:167], a[68:71], a[48:51], a[164:167]
    v_xor_b32 v36, v36, v35
    v_lshlrev_b32 v36, 4, v36
    v_mfma_f32_16x16x32_bf16 a[172:175], a[68:71], a[52:55], a[172:175]
    ds_read_b128 a[12:15], v9 offset:3072
    v_lshl_add_u32 v36, v34, 11, v36
    s_lshl_b32 s82, s60, 14
    v_mfma_f32_16x16x32_bf16 a[180:183], a[68:71], a[56:59], a[180:183]
    s_add_u32 s82, s82, 0
    v_add_u32 v17, s82, v36
    v_mfma_f32_16x16x32_bf16 a[188:191], a[68:71], a[60:63], a[188:191]
    s_lshl_b32 s82, s62, 1
    s_add_u32 s82, s82, 0
    v_mfma_f32_16x16x32_bf16 v[124:127], a[68:71], a[116:119], v[124:127]
    ds_read_b64_tr_b16 a[68:69], v15 offset:0
    s_lshl_b32 s82, s82, 3
    s_lshl_b32 s83, s61, 2
    v_mfma_f32_16x16x32_bf16 v[52:55], a[32:35], a[72:75], v[52:55]
    ds_read_b64_tr_b16 a[70:71], v15 offset:256
    s_add_u32 s82, s82, s83
    s_mul_i32 s83, s62, 96
    v_mfma_f32_16x16x32_bf16 v[56:59], a[36:39], a[72:75], v[56:59]
    s_add_u32 s82, s82, s83
    s_lshl_b32 s82, s82, 11
    v_mfma_f32_16x16x32_bf16 v[60:63], a[40:43], a[72:75], v[60:63]
    ds_read_b128 a[16:19], v9 offset:4096
    s_sub_u32 s82, s82, 0
    v_add_u32 v19, s82, v36
    v_mfma_f32_16x16x32_bf16 v[64:67], a[44:47], a[72:75], v[64:67]
    v_lshlrev_b32 v36, 1, v34
    v_add_u32 v36, 8, v36
    v_mfma_f32_16x16x32_bf16 v[68:71], a[48:51], a[72:75], v[68:71]
    ds_read_b128 a[20:23], v9 offset:5120
    v_xor_b32 v36, v36, v35
    v_lshlrev_b32 v36, 4, v36
    v_mfma_f32_16x16x32_bf16 v[72:75], a[52:55], a[72:75], v[72:75]
    v_lshl_add_u32 v36, v34, 11, v36
    s_lshl_b32 s82, s60, 14
    v_mfma_f32_16x16x32_bf16 v[76:79], a[56:59], a[72:75], v[76:79]
    s_add_u32 s82, s82, 7168
    v_add_u32 v18, s82, v36
    v_mfma_f32_16x16x32_bf16 v[80:83], a[60:63], a[72:75], v[80:83]
    s_lshl_b32 s82, s62, 1
    s_add_u32 s82, s82, 1
    v_mfma_f32_16x16x32_bf16 v[48:51], a[116:119], a[72:75], v[48:51]
    ds_read_b64_tr_b16 a[72:73], v13 offset:1024
    s_lshl_b32 s82, s82, 3
    s_lshl_b32 s83, s61, 2
    v_mfma_f32_16x16x32_bf16 v[88:91], a[32:35], a[76:79], v[88:91]
    ds_read_b64_tr_b16 a[74:75], v13 offset:1280
    s_add_u32 s82, s82, s83
    s_mul_i32 s83, s62, 96
    v_mfma_f32_16x16x32_bf16 v[92:95], a[36:39], a[76:79], v[92:95]
    ds_read_b128 a[24:27], v9 offset:6144
    s_add_u32 s82, s82, s83
    s_lshl_b32 s82, s82, 11
    v_mfma_f32_16x16x32_bf16 v[96:99], a[40:43], a[76:79], v[96:99]
    s_sub_u32 s82, s82, 1024
    v_add_u32 v20, s82, v36
    v_mfma_f32_16x16x32_bf16 v[100:103], a[44:47], a[76:79], v[100:103]
    ds_read_b128 a[28:31], v9 offset:7168
    s_xor_b32 s82, s65, 0
    s_lshl_b32 s82, s82, 10
    v_mfma_f32_16x16x32_bf16 v[104:107], a[48:51], a[76:79], v[104:107]
    v_add_u32 v21, s82, v16
    s_xor_b32 s82, s65, 1
    v_mfma_f32_16x16x32_bf16 v[108:111], a[52:55], a[76:79], v[108:111]
    s_lshl_b32 s82, s82, 10
    v_add_u32 v22, s82, v16
    v_mfma_f32_16x16x32_bf16 v[112:115], a[56:59], a[76:79], v[112:115]
    s_xor_b32 s82, s65, 2
    s_lshl_b32 s82, s82, 10
    v_mfma_f32_16x16x32_bf16 v[116:119], a[60:63], a[76:79], v[116:119]
    ds_read_b128 a[112:115], v11 offset:0
    v_add_u32 v23, s82, v16
    s_xor_b32 s82, s65, 3
    v_mfma_f32_16x16x32_bf16 v[84:87], a[116:119], a[76:79], v[84:87]
    ds_read_b64_tr_b16 a[76:77], v15 offset:1024
    s_lshl_b32 s82, s82, 10
    v_add_u32 v24, s82, v16
    v_mfma_f32_16x16x32_bf16 a[192:195], a[80:83], a[32:35], a[192:195]
    ds_read_b64_tr_b16 a[78:79], v15 offset:1280
    s_mov_b32 s94, 0xbdd2d3e8
    s_mov_b32 s95, 0xbdd2d3e8
    v_mfma_f32_16x16x32_bf16 a[200:203], a[80:83], a[36:39], a[200:203]
    v_mov_b32 v26, 0xc0135761
    v_mov_b32 v27, 0xc0135761
    v_mfma_f32_16x16x32_bf16 a[208:211], a[80:83], a[40:43], a[208:211]
    ds_read_b64_tr_b16 a[96:97], v13 offset:4096
    v_mov_b32 v25, 1
    s_lshl_b32 s82, s60, 12
    v_mfma_f32_16x16x32_bf16 a[216:219], a[80:83], a[44:47], a[216:219]
    s_add_u32 s68, s88, s82
    s_lshl_b32 s82, s61, 13
    v_mfma_f32_16x16x32_bf16 a[224:227], a[80:83], a[48:51], a[224:227]
    s_add_u32 s88, s88, s82
    s_lshr_b32 s82, s66, 1
    v_mfma_f32_16x16x32_bf16 a[232:235], a[80:83], a[52:55], a[232:235]
    s_add_u32 s82, s82, 24
    s_lshl_b32 s82, s82, 14
    v_mfma_f32_16x16x32_bf16 a[240:243], a[80:83], a[56:59], a[240:243]
    ds_read_b64_tr_b16 a[98:99], v13 offset:4352
    s_add_u32 s90, s88, s82
    s_lshl_b32 s82, s66, 14
    v_mfma_f32_16x16x32_bf16 a[248:251], a[80:83], a[60:63], a[248:251]
    ds_read_b64_tr_b16 a[80:81], v13 offset:2048
    v_mfma_f32_16x16x32_bf16 a[196:199], a[84:87], a[32:35], a[196:199]
    ds_read_b64_tr_b16 a[82:83], v13 offset:2304
    v_mfma_f32_16x16x32_bf16 a[204:207], a[84:87], a[36:39], a[204:207]
    v_mfma_f32_16x16x32_bf16 a[212:215], a[84:87], a[40:43], a[212:215]
    ds_read_b64_tr_b16 a[100:101], v15 offset:4096
    v_mfma_f32_16x16x32_bf16 a[220:223], a[84:87], a[44:47], a[220:223]
    v_mfma_f32_16x16x32_bf16 a[228:231], a[84:87], a[48:51], a[228:231]
    v_mfma_f32_16x16x32_bf16 a[236:239], a[84:87], a[52:55], a[236:239]
    v_mfma_f32_16x16x32_bf16 a[244:247], a[84:87], a[56:59], a[244:247]
    ds_read_b64_tr_b16 a[102:103], v15 offset:4352
    v_mfma_f32_16x16x32_bf16 a[252:255], a[84:87], a[60:63], a[252:255]
    ds_read_b64_tr_b16 a[84:85], v15 offset:2048
    v_mfma_f32_16x16x32_bf16 v[128:131], a[88:91], a[32:35], v[128:131]
    ds_read_b64_tr_b16 a[86:87], v15 offset:2304
    v_mfma_f32_16x16x32_bf16 v[144:147], a[88:91], a[36:39], v[144:147]
    v_mfma_f32_16x16x32_bf16 v[160:163], a[88:91], a[40:43], v[160:163]
    v_mfma_f32_16x16x32_bf16 v[176:179], a[88:91], a[44:47], v[176:179]
    v_mfma_f32_16x16x32_bf16 v[192:195], a[88:91], a[48:51], v[192:195]
    v_mfma_f32_16x16x32_bf16 v[208:211], a[88:91], a[52:55], v[208:211]
    v_mfma_f32_16x16x32_bf16 v[224:227], a[88:91], a[56:59], v[224:227]
    v_mfma_f32_16x16x32_bf16 v[240:243], a[88:91], a[60:63], v[240:243]
    ds_read_b64_tr_b16 a[88:89], v13 offset:3072
    v_mfma_f32_16x16x32_bf16 v[132:135], a[92:95], a[32:35], v[132:135]
    ds_read_b64_tr_b16 a[90:91], v13 offset:3328
    v_mfma_f32_16x16x32_bf16 v[148:151], a[92:95], a[36:39], v[148:151]
    v_mfma_f32_16x16x32_bf16 v[164:167], a[92:95], a[40:43], v[164:167]
    v_mfma_f32_16x16x32_bf16 v[180:183], a[92:95], a[44:47], v[180:183]
    v_mfma_f32_16x16x32_bf16 v[196:199], a[92:95], a[48:51], v[196:199]
    v_mfma_f32_16x16x32_bf16 v[212:215], a[92:95], a[52:55], v[212:215]
    v_mfma_f32_16x16x32_bf16 v[228:231], a[92:95], a[56:59], v[228:231]
    v_mfma_f32_16x16x32_bf16 v[244:247], a[92:95], a[60:63], v[244:247]
    ds_read_b64_tr_b16 a[92:93], v15 offset:3072
    v_mfma_f32_16x16x32_bf16 v[136:139], a[104:107], a[32:35], v[136:139]
    ds_read_b64_tr_b16 a[94:95], v15 offset:3328
    v_mfma_f32_16x16x32_bf16 v[152:155], a[104:107], a[36:39], v[152:155]
    v_mfma_f32_16x16x32_bf16 v[168:171], a[104:107], a[40:43], v[168:171]
    v_mfma_f32_16x16x32_bf16 v[184:187], a[104:107], a[44:47], v[184:187]
    v_mfma_f32_16x16x32_bf16 v[200:203], a[104:107], a[48:51], v[200:203]
    v_mfma_f32_16x16x32_bf16 v[216:219], a[104:107], a[52:55], v[216:219]
    v_mfma_f32_16x16x32_bf16 v[232:235], a[104:107], a[56:59], v[232:235]
    v_mfma_f32_16x16x32_bf16 v[248:251], a[104:107], a[60:63], v[248:251]
    v_mfma_f32_16x16x32_bf16 v[140:143], a[108:111], a[32:35], v[140:143]
    v_mfma_f32_16x16x32_bf16 v[156:159], a[108:111], a[36:39], v[156:159]
    v_mfma_f32_16x16x32_bf16 v[172:175], a[108:111], a[40:43], v[172:175]
    v_mfma_f32_16x16x32_bf16 v[188:191], a[108:111], a[44:47], v[188:191]
    v_mfma_f32_16x16x32_bf16 v[204:207], a[108:111], a[48:51], v[204:207]
    v_mfma_f32_16x16x32_bf16 v[220:223], a[108:111], a[52:55], v[220:223]
    v_mfma_f32_16x16x32_bf16 v[236:239], a[108:111], a[56:59], v[236:239]
    v_mfma_f32_16x16x32_bf16 v[252:255], a[108:111], a[60:63], v[252:255]
    s_waitcnt vmcnt(3) lgkmcnt(0)
    s_barrier
    v_mfma_f32_16x16x32_bf16 a[128:131], a[64:67], a[0:3], a[128:131]
    v_mfma_f32_16x16x32_bf16 a[136:139], a[64:67], a[4:7], a[136:139]
    v_mfma_f32_16x16x32_bf16 a[144:147], a[64:67], a[8:11], a[144:147]
    ds_read_b128 a[32:35], v9 offset:38912
    v_mfma_f32_16x16x32_bf16 a[152:155], a[64:67], a[12:15], a[152:155]
    v_mfma_f32_16x16x32_bf16 a[160:163], a[64:67], a[16:19], a[160:163]
    s_add_u32 s88, s88, s82
    s_add_u32 s89, s88, 262144
    v_mfma_f32_16x16x32_bf16 a[168:171], a[64:67], a[20:23], a[168:171]
    s_mov_b32 s76, s93
    s_lshl_b32 s82, s63, 4
    v_mfma_f32_16x16x32_bf16 a[176:179], a[64:67], a[24:27], a[176:179]
    ds_read_b128 a[36:39], v9 offset:39936
    s_lshl_b32 s83, s60, 2
    s_add_u32 s83, s83, s82
    v_mfma_f32_16x16x32_bf16 a[184:187], a[64:67], a[28:31], a[184:187]
    s_add_u32 s83, s83, s65
    s_lshl_b32 s83, s83, 15
    v_mfma_f32_16x16x32_bf16 v[120:123], a[64:67], a[112:115], v[120:123]
    ds_read_b64_tr_b16 a[64:65], v13 offset:38912
    s_add_u32 s69, s83, 4194304
    s_lshl_b32 s84, s63, 3
    v_mfma_f32_16x16x32_bf16 a[132:135], a[68:71], a[0:3], a[132:135]
    ds_read_b64_tr_b16 a[66:67], v13 offset:39168
    s_add_u32 s84, s84, s66
    s_lshl_b32 s85, s84, 2
    v_mfma_f32_16x16x32_bf16 a[140:143], a[68:71], a[4:7], a[140:143]
    ds_read_b128 a[40:43], v9 offset:40960
    s_add_u32 s85, s85, s60
    s_lshl_b32 s85, s85, 8
    v_mfma_f32_16x16x32_bf16 a[148:151], a[68:71], a[8:11], a[148:151]
    s_add_u32 s77, s85, 39862272
    s_lshl_b32 s84, s84, 18
    v_mfma_f32_16x16x32_bf16 a[156:159], a[68:71], a[12:15], a[156:159]
    s_lshl_b32 s85, s60, 12
    s_add_u32 s84, s84, s85
    v_mfma_f32_16x16x32_bf16 a[164:167], a[68:71], a[16:19], a[164:167]
    s_add_u32 s84, s84, 23068672
    s_xor_b32 s85, s65, 1
    v_mfma_f32_16x16x32_bf16 a[172:175], a[68:71], a[20:23], a[172:175]
    ds_read_b128 a[44:47], v9 offset:41984
    s_lshl_b32 s85, s85, 16
    s_add_u32 s70, s84, s85
    v_mfma_f32_16x16x32_bf16 a[180:183], a[68:71], a[24:27], a[180:183]
    s_add_u32 s70, s70, 16384
    s_lshl_b32 s85, s65, 16
    v_mfma_f32_16x16x32_bf16 a[188:191], a[68:71], a[28:31], a[188:191]
    s_add_u32 s73, s84, s85
    s_add_u32 s73, s73, 16384
    v_mfma_f32_16x16x32_bf16 v[124:127], a[68:71], a[112:115], v[124:127]
    ds_read_b64_tr_b16 a[68:69], v15 offset:38912
    s_xor_b32 s85, s65, 2
    s_lshl_b32 s85, s85, 16
    v_mfma_f32_16x16x32_bf16 v[52:55], a[0:3], a[72:75], v[52:55]
    ds_read_b64_tr_b16 a[70:71], v15 offset:39168
    s_add_u32 s71, s84, s85
    s_add_u32 s71, s71, 32768
    v_mfma_f32_16x16x32_bf16 v[56:59], a[4:7], a[72:75], v[56:59]
    s_lshl_b32 s85, s65, 16
    s_add_u32 s74, s84, s85
    v_mfma_f32_16x16x32_bf16 v[60:63], a[8:11], a[72:75], v[60:63]
    ds_read_b128 a[48:51], v9 offset:43008
    s_add_u32 s74, s74, 32768
    s_xor_b32 s85, s65, 3
    v_mfma_f32_16x16x32_bf16 v[64:67], a[12:15], a[72:75], v[64:67]
    s_lshl_b32 s85, s85, 16
    s_add_u32 s72, s84, s85
    v_mfma_f32_16x16x32_bf16 v[68:71], a[16:19], a[72:75], v[68:71]
    ds_read_b128 a[52:55], v9 offset:44032
    s_add_u32 s72, s72, 49152
    s_lshl_b32 s85, s65, 16
    v_mfma_f32_16x16x32_bf16 v[72:75], a[20:23], a[72:75], v[72:75]
    s_add_u32 s75, s84, s85
    s_add_u32 s75, s75, 49152
    v_mfma_f32_16x16x32_bf16 v[76:79], a[24:27], a[72:75], v[76:79]
    s_lshl_b32 s83, s61, 3
    s_add_u32 s82, s82, s83
    v_mfma_f32_16x16x32_bf16 v[80:83], a[28:31], a[72:75], v[80:83]
    s_lshl_b32 s82, s82, 5
    s_add_u32 s82, s82, s64
    v_mfma_f32_16x16x32_bf16 v[48:51], a[112:115], a[72:75], v[48:51]
    ds_read_b64_tr_b16 a[72:73], v13 offset:39936
    s_lshl_b32 s82, s82, 10
    s_add_u32 s91, s82, 4194304
    v_mfma_f32_16x16x32_bf16 v[88:91], a[0:3], a[76:79], v[88:91]
    ds_read_b64_tr_b16 a[74:75], v13 offset:40192
    v_mov_b32 v42, 1
    v_and_b32 v37, 1, v35
    v_mfma_f32_16x16x32_bf16 v[92:95], a[4:7], a[76:79], v[92:95]
    ds_read_b128 a[56:59], v9 offset:45056
    v_lshl_add_u32 v36, v34, 2, v37
    v_cmp_le_u32 s[4:5], v36, v35
    v_mfma_f32_16x16x32_bf16 v[96:99], a[8:11], a[76:79], v[96:99]
    v_add_u32 v36, 2, v36
    v_cmp_le_u32 s[6:7], v36, v35
    v_mfma_f32_16x16x32_bf16 v[100:103], a[12:15], a[76:79], v[100:103]
    ds_read_b128 a[60:63], v9 offset:46080
    v_mul_u32_u24 v36, 0x0202, v37
    v_lshlrev_b32 v36, 16, v36
    v_mfma_f32_16x16x32_bf16 v[104:107], a[16:19], a[76:79], v[104:107]
    v_add_u32 v36, 0x01000c0c, v36
    v_add_u32 v38, 0x04040000, v36
    v_mfma_f32_16x16x32_bf16 v[108:111], a[20:23], a[76:79], v[108:111]
    v_cndmask_b32 v28, v36, v38, s[4:5]
    v_cndmask_b32 v29, v36, v38, s[6:7]
    v_mfma_f32_16x16x32_bf16 v[112:115], a[24:27], a[76:79], v[112:115]
    v_cmp_eq_u32 vcc, 1, v37
    v_mov_b32 v36, 0x0c0c0100
    v_mfma_f32_16x16x32_bf16 v[116:119], a[28:31], a[76:79], v[116:119]
    ds_read_b128 a[116:119], v11 offset:38912
    v_mov_b32 v38, 0x01000c0c
    v_cndmask_b32 v36, v36, v38, vcc
    v_mfma_f32_16x16x32_bf16 v[84:87], a[112:115], a[76:79], v[84:87]
    ds_read_b64_tr_b16 a[76:77], v15 offset:39936
    v_mov_b32 v38, 0x0c0c0302
    v_mov_b32 v39, 0x03020c0c
    v_mfma_f32_16x16x32_bf16 a[192:195], a[80:83], a[0:3], a[192:195]
    ds_read_b64_tr_b16 a[78:79], v15 offset:40192
    v_cndmask_b32 v38, v38, v39, vcc
    v_mov_b32 v39, 0x0c0c0c0c
    v_mfma_f32_16x16x32_bf16 a[200:203], a[80:83], a[4:7], a[200:203]
    v_cndmask_b32 v30, v36, v39, s[4:5]
    v_cndmask_b32 v31, v38, v39, s[6:7]
    v_mfma_f32_16x16x32_bf16 a[208:211], a[80:83], a[8:11], a[208:211]
    ds_read_b64_tr_b16 a[104:105], v13 offset:43008
    v_cndmask_b32 v32, v39, v36, s[4:5]
    v_cndmask_b32 v33, v39, v38, s[6:7]
    v_mfma_f32_16x16x32_bf16 a[216:219], a[80:83], a[12:15], a[216:219]
    s_or_b32 s82, s63, s61
    s_cmp_eq_u32 s82, 0
    v_mfma_f32_16x16x32_bf16 a[224:227], a[80:83], a[16:19], a[224:227]
    s_cselect_b64 s[4:5], s[4:5], -1
    s_cselect_b64 s[6:7], s[6:7], -1
    v_mfma_f32_16x16x32_bf16 a[232:235], a[80:83], a[20:23], a[232:235]
    s_mov_b32 s14, 0x3e3504f3
    s_mov_b32 s15, 0x3e3504f3
    v_mfma_f32_16x16x32_bf16 a[240:243], a[80:83], a[24:27], a[240:243]
    ds_read_b64_tr_b16 a[106:107], v13 offset:43264
    s_mov_b32 s98, 0x3fb8aa3b
    s_mov_b32 s99, 0x3fb8aa3b
    v_mfma_f32_16x16x32_bf16 a[248:251], a[80:83], a[28:31], a[248:251]
    ds_read_b64_tr_b16 a[80:81], v13 offset:40960
    v_mfma_f32_16x16x32_bf16 a[196:199], a[84:87], a[0:3], a[196:199]
    ds_read_b64_tr_b16 a[82:83], v13 offset:41216
    v_mfma_f32_16x16x32_bf16 a[204:207], a[84:87], a[4:7], a[204:207]
    v_mfma_f32_16x16x32_bf16 a[212:215], a[84:87], a[8:11], a[212:215]
    ds_read_b64_tr_b16 a[108:109], v15 offset:43008
    v_mfma_f32_16x16x32_bf16 a[220:223], a[84:87], a[12:15], a[220:223]
    v_mfma_f32_16x16x32_bf16 a[228:231], a[84:87], a[16:19], a[228:231]
    v_mfma_f32_16x16x32_bf16 a[236:239], a[84:87], a[20:23], a[236:239]
    v_mfma_f32_16x16x32_bf16 a[244:247], a[84:87], a[24:27], a[244:247]
    ds_read_b64_tr_b16 a[110:111], v15 offset:43264
    v_mfma_f32_16x16x32_bf16 a[252:255], a[84:87], a[28:31], a[252:255]
    ds_read_b64_tr_b16 a[84:85], v15 offset:40960
    v_mfma_f32_16x16x32_bf16 v[128:131], a[88:91], a[0:3], v[128:131]
    ds_read_b64_tr_b16 a[86:87], v15 offset:41216
    v_mfma_f32_16x16x32_bf16 v[144:147], a[88:91], a[4:7], v[144:147]
    v_mfma_f32_16x16x32_bf16 v[160:163], a[88:91], a[8:11], v[160:163]
    v_mfma_f32_16x16x32_bf16 v[176:179], a[88:91], a[12:15], v[176:179]
    v_mfma_f32_16x16x32_bf16 v[192:195], a[88:91], a[16:19], v[192:195]
    v_mfma_f32_16x16x32_bf16 v[208:211], a[88:91], a[20:23], v[208:211]
    v_mfma_f32_16x16x32_bf16 v[224:227], a[88:91], a[24:27], v[224:227]
    v_mfma_f32_16x16x32_bf16 v[240:243], a[88:91], a[28:31], v[240:243]
    ds_read_b64_tr_b16 a[88:89], v13 offset:41984
    v_mfma_f32_16x16x32_bf16 v[132:135], a[92:95], a[0:3], v[132:135]
    ds_read_b64_tr_b16 a[90:91], v13 offset:42240
    v_mfma_f32_16x16x32_bf16 v[148:151], a[92:95], a[4:7], v[148:151]
    v_mfma_f32_16x16x32_bf16 v[164:167], a[92:95], a[8:11], v[164:167]
    v_mfma_f32_16x16x32_bf16 v[180:183], a[92:95], a[12:15], v[180:183]
    v_mfma_f32_16x16x32_bf16 v[196:199], a[92:95], a[16:19], v[196:199]
    v_mfma_f32_16x16x32_bf16 v[212:215], a[92:95], a[20:23], v[212:215]
    v_mfma_f32_16x16x32_bf16 v[228:231], a[92:95], a[24:27], v[228:231]
    v_mfma_f32_16x16x32_bf16 v[244:247], a[92:95], a[28:31], v[244:247]
    ds_read_b64_tr_b16 a[92:93], v15 offset:41984
    v_mfma_f32_16x16x32_bf16 v[136:139], a[96:99], a[0:3], v[136:139]
    ds_read_b64_tr_b16 a[94:95], v15 offset:42240
    v_mfma_f32_16x16x32_bf16 v[152:155], a[96:99], a[4:7], v[152:155]
    v_mfma_f32_16x16x32_bf16 v[168:171], a[96:99], a[8:11], v[168:171]
    v_mfma_f32_16x16x32_bf16 v[184:187], a[96:99], a[12:15], v[184:187]
    v_mfma_f32_16x16x32_bf16 v[200:203], a[96:99], a[16:19], v[200:203]
    v_mfma_f32_16x16x32_bf16 v[216:219], a[96:99], a[20:23], v[216:219]
    v_mfma_f32_16x16x32_bf16 v[232:235], a[96:99], a[24:27], v[232:235]
    v_mfma_f32_16x16x32_bf16 v[248:251], a[96:99], a[28:31], v[248:251]
    v_mfma_f32_16x16x32_bf16 v[140:143], a[100:103], a[0:3], v[140:143]
    v_mfma_f32_16x16x32_bf16 v[156:159], a[100:103], a[4:7], v[156:159]
    v_mfma_f32_16x16x32_bf16 v[172:175], a[100:103], a[8:11], v[172:175]
    v_mfma_f32_16x16x32_bf16 v[188:191], a[100:103], a[12:15], v[188:191]
    v_mfma_f32_16x16x32_bf16 v[204:207], a[100:103], a[16:19], v[204:207]
    v_mfma_f32_16x16x32_bf16 v[220:223], a[100:103], a[20:23], v[220:223]
    v_mfma_f32_16x16x32_bf16 v[236:239], a[100:103], a[24:27], v[236:239]
    v_mfma_f32_16x16x32_bf16 v[252:255], a[100:103], a[28:31], v[252:255]
    s_waitcnt lgkmcnt(0)
    s_barrier
    v_mfma_f32_16x16x32_bf16 a[128:131], a[64:67], a[32:35], a[128:131]
    v_mfma_f32_16x16x32_bf16 a[136:139], a[64:67], a[36:39], a[136:139]
    v_mfma_f32_16x16x32_bf16 a[144:147], a[64:67], a[40:43], a[144:147]
    s_mov_b32 s82, 0
    s_add_u32 m0, s3, 0
    v_mfma_f32_16x16x32_bf16 a[152:155], a[64:67], a[44:47], a[152:155]
    buffer_load_dwordx4 v17, s[48:51], s82 offen lds
    v_mfma_f32_16x16x32_bf16 a[160:163], a[64:67], a[48:51], a[160:163]
    v_mfma_f32_16x16x32_bf16 a[168:171], a[64:67], a[52:55], a[168:171]
    v_mfma_f32_16x16x32_bf16 a[176:179], a[64:67], a[56:59], a[176:179]
    v_mfma_f32_16x16x32_bf16 a[184:187], a[64:67], a[60:63], a[184:187]
    buffer_load_dwordx4 v18, s[48:51], s82 offen offset:1024 lds
    v_mfma_f32_16x16x32_bf16 v[120:123], a[64:67], a[116:119], v[120:123]
    v_mfma_f32_16x16x32_bf16 a[132:135], a[68:71], a[32:35], a[132:135]
    v_mfma_f32_16x16x32_bf16 a[140:143], a[68:71], a[36:39], a[140:143]
    v_mfma_f32_16x16x32_bf16 a[148:151], a[68:71], a[40:43], a[148:151]
    s_mov_b32 s83, 229376
    s_add_u32 m0, s3, 8192
    v_mfma_f32_16x16x32_bf16 a[156:159], a[68:71], a[44:47], a[156:159]
    buffer_load_dwordx4 v17, s[48:51], s83 offen lds
    v_mfma_f32_16x16x32_bf16 a[164:167], a[68:71], a[48:51], a[164:167]
    v_mfma_f32_16x16x32_bf16 a[172:175], a[68:71], a[52:55], a[172:175]
    v_mfma_f32_16x16x32_bf16 a[180:183], a[68:71], a[56:59], a[180:183]
    v_mfma_f32_16x16x32_bf16 a[188:191], a[68:71], a[60:63], a[188:191]
    buffer_load_dwordx4 v18, s[48:51], s83 offen offset:1024 lds
    v_mfma_f32_16x16x32_bf16 v[124:127], a[68:71], a[116:119], v[124:127]
    v_mfma_f32_16x16x32_bf16 v[52:55], a[32:35], a[72:75], v[52:55]
    v_mfma_f32_16x16x32_bf16 v[56:59], a[36:39], a[72:75], v[56:59]
    v_mfma_f32_16x16x32_bf16 v[60:63], a[40:43], a[72:75], v[60:63]
    s_mov_b32 s82, 458752
    s_add_u32 m0, s3, 16384
    v_mfma_f32_16x16x32_bf16 v[64:67], a[44:47], a[72:75], v[64:67]
    buffer_load_dwordx4 v17, s[48:51], s82 offen lds
    v_mfma_f32_16x16x32_bf16 v[68:71], a[48:51], a[72:75], v[68:71]
    v_mfma_f32_16x16x32_bf16 v[72:75], a[52:55], a[72:75], v[72:75]
    v_mfma_f32_16x16x32_bf16 v[76:79], a[56:59], a[72:75], v[76:79]
    v_mfma_f32_16x16x32_bf16 v[80:83], a[60:63], a[72:75], v[80:83]
    buffer_load_dwordx4 v18, s[48:51], s82 offen offset:1024 lds
    v_mfma_f32_16x16x32_bf16 v[48:51], a[116:119], a[72:75], v[48:51]
    v_mfma_f32_16x16x32_bf16 v[88:91], a[32:35], a[76:79], v[88:91]
    v_mfma_f32_16x16x32_bf16 v[92:95], a[36:39], a[76:79], v[92:95]
    v_mfma_f32_16x16x32_bf16 v[96:99], a[40:43], a[76:79], v[96:99]
    s_mov_b32 s83, 688128
    s_add_u32 m0, s3, 24576
    v_mfma_f32_16x16x32_bf16 v[100:103], a[44:47], a[76:79], v[100:103]
    buffer_load_dwordx4 v17, s[48:51], s83 offen lds
    v_mfma_f32_16x16x32_bf16 v[104:107], a[48:51], a[76:79], v[104:107]
    v_mfma_f32_16x16x32_bf16 v[108:111], a[52:55], a[76:79], v[108:111]
    v_mfma_f32_16x16x32_bf16 v[112:115], a[56:59], a[76:79], v[112:115]
    v_mfma_f32_16x16x32_bf16 v[116:119], a[60:63], a[76:79], v[116:119]
    buffer_load_dwordx4 v18, s[48:51], s83 offen offset:1024 lds
    v_mfma_f32_16x16x32_bf16 v[84:87], a[116:119], a[76:79], v[84:87]
    v_mfma_f32_16x16x32_bf16 a[192:195], a[80:83], a[32:35], a[192:195]
    v_mfma_f32_16x16x32_bf16 a[200:203], a[80:83], a[36:39], a[200:203]
    v_mfma_f32_16x16x32_bf16 a[208:211], a[80:83], a[40:43], a[208:211]
    s_mov_b32 s82, 917504
    s_add_u32 m0, s3, 32768
    v_mfma_f32_16x16x32_bf16 a[216:219], a[80:83], a[44:47], a[216:219]
    buffer_load_dwordx4 v17, s[48:51], s82 offen lds
    v_mfma_f32_16x16x32_bf16 a[224:227], a[80:83], a[48:51], a[224:227]
    v_mfma_f32_16x16x32_bf16 a[232:235], a[80:83], a[52:55], a[232:235]
    v_mfma_f32_16x16x32_bf16 a[240:243], a[80:83], a[56:59], a[240:243]
    v_mfma_f32_16x16x32_bf16 a[248:251], a[80:83], a[60:63], a[248:251]
    buffer_load_dwordx4 v18, s[48:51], s82 offen offset:1024 lds
    v_mfma_f32_16x16x32_bf16 a[196:199], a[84:87], a[32:35], a[196:199]
    v_mfma_f32_16x16x32_bf16 a[204:207], a[84:87], a[36:39], a[204:207]
    v_mfma_f32_16x16x32_bf16 a[212:215], a[84:87], a[40:43], a[212:215]
    v_mfma_f32_16x16x32_bf16 a[220:223], a[84:87], a[44:47], a[220:223]
    s_mov_b32 s83, 1146880
    s_add_u32 m0, s3, 40960
    v_mfma_f32_16x16x32_bf16 a[228:231], a[84:87], a[48:51], a[228:231]
    buffer_load_dwordx4 v17, s[48:51], s83 offen lds
    v_mfma_f32_16x16x32_bf16 a[236:239], a[84:87], a[52:55], a[236:239]
    v_mfma_f32_16x16x32_bf16 a[244:247], a[84:87], a[56:59], a[244:247]
    v_mfma_f32_16x16x32_bf16 a[252:255], a[84:87], a[60:63], a[252:255]
    v_mfma_f32_16x16x32_bf16 v[128:131], a[88:91], a[32:35], v[128:131]
    buffer_load_dwordx4 v18, s[48:51], s83 offen offset:1024 lds
    v_mfma_f32_16x16x32_bf16 v[144:147], a[88:91], a[36:39], v[144:147]
    v_mfma_f32_16x16x32_bf16 v[160:163], a[88:91], a[40:43], v[160:163]
    v_mfma_f32_16x16x32_bf16 v[176:179], a[88:91], a[44:47], v[176:179]
    v_mfma_f32_16x16x32_bf16 v[192:195], a[88:91], a[48:51], v[192:195]
    s_mov_b32 s82, 1376256
    s_add_u32 m0, s3, 49152
    v_mfma_f32_16x16x32_bf16 v[208:211], a[88:91], a[52:55], v[208:211]
    buffer_load_dwordx4 v17, s[48:51], s82 offen lds
    v_mfma_f32_16x16x32_bf16 v[224:227], a[88:91], a[56:59], v[224:227]
    v_mfma_f32_16x16x32_bf16 v[240:243], a[88:91], a[60:63], v[240:243]
    v_mfma_f32_16x16x32_bf16 v[132:135], a[92:95], a[32:35], v[132:135]
    v_mfma_f32_16x16x32_bf16 v[148:151], a[92:95], a[36:39], v[148:151]
    buffer_load_dwordx4 v18, s[48:51], s82 offen offset:1024 lds
    v_mfma_f32_16x16x32_bf16 v[164:167], a[92:95], a[40:43], v[164:167]
    v_mfma_f32_16x16x32_bf16 v[180:183], a[92:95], a[44:47], v[180:183]
    v_mfma_f32_16x16x32_bf16 v[196:199], a[92:95], a[48:51], v[196:199]
    v_mfma_f32_16x16x32_bf16 v[212:215], a[92:95], a[52:55], v[212:215]
    s_mov_b32 s83, 1605632
    s_add_u32 m0, s3, 57344
    v_mfma_f32_16x16x32_bf16 v[228:231], a[92:95], a[56:59], v[228:231]
    buffer_load_dwordx4 v17, s[48:51], s83 offen lds
    v_mfma_f32_16x16x32_bf16 v[244:247], a[92:95], a[60:63], v[244:247]
    v_mfma_f32_16x16x32_bf16 v[136:139], a[104:107], a[32:35], v[136:139]
    v_mfma_f32_16x16x32_bf16 v[152:155], a[104:107], a[36:39], v[152:155]
    v_mfma_f32_16x16x32_bf16 v[168:171], a[104:107], a[40:43], v[168:171]
    buffer_load_dwordx4 v18, s[48:51], s83 offen offset:1024 lds
    v_mfma_f32_16x16x32_bf16 v[184:187], a[104:107], a[44:47], v[184:187]
    v_mfma_f32_16x16x32_bf16 v[200:203], a[104:107], a[48:51], v[200:203]
    v_mfma_f32_16x16x32_bf16 v[216:219], a[104:107], a[52:55], v[216:219]
    v_mfma_f32_16x16x32_bf16 v[232:235], a[104:107], a[56:59], v[232:235]
    v_mfma_f32_16x16x32_bf16 v[248:251], a[104:107], a[60:63], v[248:251]
    v_mfma_f32_16x16x32_bf16 v[140:143], a[108:111], a[32:35], v[140:143]
    v_mfma_f32_16x16x32_bf16 v[156:159], a[108:111], a[36:39], v[156:159]
    v_mfma_f32_16x16x32_bf16 v[172:175], a[108:111], a[40:43], v[172:175]
    v_mfma_f32_16x16x32_bf16 v[188:191], a[108:111], a[44:47], v[188:191]
    v_mfma_f32_16x16x32_bf16 v[204:207], a[108:111], a[48:51], v[204:207]
    v_mfma_f32_16x16x32_bf16 v[220:223], a[108:111], a[52:55], v[220:223]
    v_mfma_f32_16x16x32_bf16 v[236:239], a[108:111], a[56:59], v[236:239]
    v_mfma_f32_16x16x32_bf16 v[252:255], a[108:111], a[60:63], v[252:255]
    s_branch L_epi
L_g1_1:
    s_add_u32 m0, s78, 8192
    s_nop 0
    buffer_load_dwordx4 v1, s[28:31], s77 offen offset:2048 sc1 lds
    v_add_u32_e64 v1, 64, v1
    s_add_u32 m0, s78, 47104
    s_nop 0
    buffer_load_dwordx4 v1, s[28:31], s77 offen offset:2048 sc1 lds
    v_add_u32_e64 v1, 64, v1
    s_add_u32 m0, s78, 86016
    s_nop 0
    buffer_load_dwordx4 v1, s[28:31], s77 offen offset:2048 sc1 lds
    v_add_u32_e64 v1, 64, v1
    s_add_u32 m0, s78, 124928
    s_nop 0
    buffer_load_dwordx4 v1, s[28:31], s77 offen offset:2048 sc1 lds
    v_add_u32_e64 v1, 64, v1
    s_waitcnt vmcnt(0)
    s_barrier
    ds_read_b64_tr_b16 a[64:65], v12 offset:0
    ds_read_b64_tr_b16 a[66:67], v12 offset:256
    ds_read_b64_tr_b16 a[68:69], v14 offset:0
    ds_read_b64_tr_b16 a[70:71], v14 offset:256
    ds_read_b64_tr_b16 a[72:73], v12 offset:1024
    ds_read_b64_tr_b16 a[74:75], v12 offset:1280
    ds_read_b64_tr_b16 a[76:77], v14 offset:1024
    ds_read_b64_tr_b16 a[78:79], v14 offset:1280
    ds_read_b64_tr_b16 a[80:81], v12 offset:2048
    ds_read_b64_tr_b16 a[82:83], v12 offset:2304
    ds_read_b64_tr_b16 a[84:85], v14 offset:2048
    ds_read_b64_tr_b16 a[86:87], v14 offset:2304
    ds_read_b64_tr_b16 a[88:89], v12 offset:3072
    ds_read_b64_tr_b16 a[90:91], v12 offset:3328
    ds_read_b64_tr_b16 a[92:93], v14 offset:3072
    ds_read_b64_tr_b16 a[94:95], v14 offset:3328
    ds_read_b64_tr_b16 a[96:97], v12 offset:4096
    ds_read_b64_tr_b16 a[98:99], v12 offset:4352
    ds_read_b64_tr_b16 a[100:101], v14 offset:4096
    ds_read_b64_tr_b16 a[102:103], v14 offset:4352
    ds_read_b128 a[0:3], v8 offset:0
    ds_read_b128 a[4:7], v8 offset:1024
    ds_read_b128 a[8:11], v8 offset:2048
    ds_read_b128 a[12:15], v8 offset:3072
    ds_read_b128 a[16:19], v8 offset:4096
    ds_read_b128 a[20:23], v8 offset:5120
    ds_read_b128 a[24:27], v8 offset:6144
    ds_read_b128 a[28:31], v8 offset:7168
    s_mov_b32 s67, 7
.p2align 3
L_loop1:
    s_waitcnt vmcnt(25) lgkmcnt(0)
    s_barrier
    v_mfma_f32_16x16x32_bf16 v[128:131], a[64:67], a[0:3], v[128:131]
    s_add_u32 m0, s78, 0
    v_mfma_f32_16x16x32_bf16 v[144:147], a[64:67], a[4:7], v[144:147]
    buffer_load_dwordx4 v2, s[32:35], s68 offen offset:0 lds
    v_mfma_f32_16x16x32_bf16 v[160:163], a[64:67], a[8:11], v[160:163]
    ds_read_b128 a[32:35], v8 offset:38912
    v_mfma_f32_16x16x32_bf16 v[176:179], a[64:67], a[12:15], v[176:179]
    v_mfma_f32_16x16x32_bf16 v[192:195], a[64:67], a[16:19], v[192:195]
    v_mfma_f32_16x16x32_bf16 v[208:211], a[64:67], a[20:23], v[208:211]
    v_mfma_f32_16x16x32_bf16 v[224:227], a[64:67], a[24:27], v[224:227]
    ds_read_b128 a[36:39], v8 offset:39936
    v_mfma_f32_16x16x32_bf16 v[240:243], a[64:67], a[28:31], v[240:243]
    ds_read_b64_tr_b16 a[64:65], v12 offset:38912
    buffer_load_dwordx4 v2, s[32:35], s69 offen offset:1024 lds
    v_mfma_f32_16x16x32_bf16 v[132:135], a[68:71], a[0:3], v[132:135]
    ds_read_b64_tr_b16 a[66:67], v12 offset:39168
    v_mfma_f32_16x16x32_bf16 v[148:151], a[68:71], a[4:7], v[148:151]
    v_mfma_f32_16x16x32_bf16 v[164:167], a[68:71], a[8:11], v[164:167]
    ds_read_b128 a[40:43], v8 offset:40960
    v_mfma_f32_16x16x32_bf16 v[180:183], a[68:71], a[12:15], v[180:183]
    v_mfma_f32_16x16x32_bf16 v[196:199], a[68:71], a[16:19], v[196:199]
    v_mfma_f32_16x16x32_bf16 v[212:215], a[68:71], a[20:23], v[212:215]
    buffer_load_dwordx4 v2, s[32:35], s70 offen offset:2048 lds
    v_add_u32 v2, 196608, v2
    v_mfma_f32_16x16x32_bf16 v[228:231], a[68:71], a[24:27], v[228:231]
    ds_read_b128 a[44:47], v8 offset:41984
    v_mfma_f32_16x16x32_bf16 v[244:247], a[68:71], a[28:31], v[244:247]
    ds_read_b64_tr_b16 a[68:69], v14 offset:38912
    v_mfma_f32_16x16x32_bf16 v[136:139], a[72:75], a[0:3], v[136:139]
    ds_read_b64_tr_b16 a[70:71], v14 offset:39168
    v_mfma_f32_16x16x32_bf16 v[152:155], a[72:75], a[4:7], v[152:155]
    v_mfma_f32_16x16x32_bf16 v[168:171], a[72:75], a[8:11], v[168:171]
    ds_read_b128 a[48:51], v8 offset:43008
    v_mfma_f32_16x16x32_bf16 v[184:187], a[72:75], a[12:15], v[184:187]
    buffer_load_dwordx4 v3, s[36:39], s71 offen offset:3072 lds
    v_mfma_f32_16x16x32_bf16 v[200:203], a[72:75], a[16:19], v[200:203]
    v_mfma_f32_16x16x32_bf16 v[216:219], a[72:75], a[20:23], v[216:219]
    v_mfma_f32_16x16x32_bf16 v[232:235], a[72:75], a[24:27], v[232:235]
    ds_read_b128 a[52:55], v8 offset:44032
    v_mfma_f32_16x16x32_bf16 v[248:251], a[72:75], a[28:31], v[248:251]
    ds_read_b64_tr_b16 a[72:73], v12 offset:39936
    v_mfma_f32_16x16x32_bf16 v[140:143], a[76:79], a[0:3], v[140:143]
    ds_read_b64_tr_b16 a[74:75], v12 offset:40192
    s_add_u32 m0, s78, 4096
    v_mfma_f32_16x16x32_bf16 v[156:159], a[76:79], a[4:7], v[156:159]
    buffer_load_dwordx4 v3, s[40:43], s72 offen offset:0 lds
    v_mfma_f32_16x16x32_bf16 v[172:175], a[76:79], a[8:11], v[172:175]
    ds_read_b128 a[56:59], v8 offset:45056
    v_mfma_f32_16x16x32_bf16 v[188:191], a[76:79], a[12:15], v[188:191]
    v_mfma_f32_16x16x32_bf16 v[204:207], a[76:79], a[16:19], v[204:207]
    v_mfma_f32_16x16x32_bf16 v[220:223], a[76:79], a[20:23], v[220:223]
    v_mfma_f32_16x16x32_bf16 v[236:239], a[76:79], a[24:27], v[236:239]
    ds_read_b128 a[60:63], v8 offset:46080
    v_mfma_f32_16x16x32_bf16 v[252:255], a[76:79], a[28:31], v[252:255]
    ds_read_b64_tr_b16 a[76:77], v14 offset:39936
    buffer_load_dwordx4 v3, s[36:39], s73 offen offset:1024 lds
    v_mfma_f32_16x16x32_bf16 a[128:131], a[80:83], a[0:3], a[128:131]
    ds_read_b64_tr_b16 a[78:79], v14 offset:40192
    v_mfma_f32_16x16x32_bf16 a[144:147], a[80:83], a[4:7], a[144:147]
    v_mfma_f32_16x16x32_bf16 a[160:163], a[80:83], a[8:11], a[160:163]
    ds_read_b64_tr_b16 a[104:105], v12 offset:43008
    v_mfma_f32_16x16x32_bf16 a[176:179], a[80:83], a[12:15], a[176:179]
    v_mfma_f32_16x16x32_bf16 a[192:195], a[80:83], a[16:19], a[192:195]
    v_mfma_f32_16x16x32_bf16 a[208:211], a[80:83], a[20:23], a[208:211]
    buffer_load_dwordx4 v3, s[40:43], s74 offen offset:2048 lds
    v_mfma_f32_16x16x32_bf16 a[224:227], a[80:83], a[24:27], a[224:227]
    ds_read_b64_tr_b16 a[106:107], v12 offset:43264
    v_mfma_f32_16x16x32_bf16 a[240:243], a[80:83], a[28:31], a[240:243]
    ds_read_b64_tr_b16 a[80:81], v12 offset:40960
    v_mfma_f32_16x16x32_bf16 a[132:135], a[84:87], a[0:3], a[132:135]
    ds_read_b64_tr_b16 a[82:83], v12 offset:41216
    v_mfma_f32_16x16x32_bf16 a[148:151], a[84:87], a[4:7], a[148:151]
    v_mfma_f32_16x16x32_bf16 a[164:167], a[84:87], a[8:11], a[164:167]
    ds_read_b64_tr_b16 a[108:109], v14 offset:43008
    v_mfma_f32_16x16x32_bf16 a[180:183], a[84:87], a[12:15], a[180:183]
    buffer_load_dwordx4 v3, s[36:39], s75 offen offset:3072 lds
    v_mfma_f32_16x16x32_bf16 a[196:199], a[84:87], a[16:19], a[196:199]
    v_mfma_f32_16x16x32_bf16 a[212:215], a[84:87], a[20:23], a[212:215]
    v_mfma_f32_16x16x32_bf16 a[228:231], a[84:87], a[24:27], a[228:231]
    ds_read_b64_tr_b16 a[110:111], v14 offset:43264
    v_mfma_f32_16x16x32_bf16 a[244:247], a[84:87], a[28:31], a[244:247]
    ds_read_b64_tr_b16 a[84:85], v14 offset:40960
    v_mfma_f32_16x16x32_bf16 a[136:139], a[88:91], a[0:3], a[136:139]
    ds_read_b64_tr_b16 a[86:87], v14 offset:41216
    s_add_u32 m0, s78, 8192
    v_mfma_f32_16x16x32_bf16 a[152:155], a[88:91], a[4:7], a[152:155]
    buffer_load_dwordx4 v3, s[40:43], s76 offen offset:0 lds
    v_add_u32 v3, 229376, v3
    v_mfma_f32_16x16x32_bf16 a[168:171], a[88:91], a[8:11], a[168:171]
    v_mfma_f32_16x16x32_bf16 a[184:187], a[88:91], a[12:15], a[184:187]
    v_mfma_f32_16x16x32_bf16 a[200:203], a[88:91], a[16:19], a[200:203]
    v_mfma_f32_16x16x32_bf16 a[216:219], a[88:91], a[20:23], a[216:219]
    v_mfma_f32_16x16x32_bf16 a[232:235], a[88:91], a[24:27], a[232:235]
    v_mfma_f32_16x16x32_bf16 a[248:251], a[88:91], a[28:31], a[248:251]
    ds_read_b64_tr_b16 a[88:89], v12 offset:41984
    global_load_lds_dwordx4 v[4:5], off offset:1024
    v_lshl_add_u64 v[4:5], v[4:5], 0, s[80:81]
    v_mfma_f32_16x16x32_bf16 a[140:143], a[92:95], a[0:3], a[140:143]
    ds_read_b64_tr_b16 a[90:91], v12 offset:42240
    v_mfma_f32_16x16x32_bf16 a[156:159], a[92:95], a[4:7], a[156:159]
    v_mfma_f32_16x16x32_bf16 a[172:175], a[92:95], a[8:11], a[172:175]
    v_mfma_f32_16x16x32_bf16 a[188:191], a[92:95], a[12:15], a[188:191]
    v_mfma_f32_16x16x32_bf16 a[204:207], a[92:95], a[16:19], a[204:207]
    v_mfma_f32_16x16x32_bf16 a[220:223], a[92:95], a[20:23], a[220:223]
    buffer_load_dwordx4 v1, s[28:31], s77 offen offset:2048 sc1 lds
    v_add_u32_e64 v1, 64, v1
    v_mfma_f32_16x16x32_bf16 a[236:239], a[92:95], a[24:27], a[236:239]
    v_mfma_f32_16x16x32_bf16 a[252:255], a[92:95], a[28:31], a[252:255]
    ds_read_b64_tr_b16 a[92:93], v14 offset:41984
    v_mfma_f32_16x16x32_bf16 v[48:51], a[96:99], a[0:3], v[48:51]
    ds_read_b64_tr_b16 a[94:95], v14 offset:42240
    v_mfma_f32_16x16x32_bf16 v[52:55], a[96:99], a[4:7], v[52:55]
    v_mfma_f32_16x16x32_bf16 v[64:67], a[96:99], a[8:11], v[64:67]
    v_mfma_f32_16x16x32_bf16 v[68:71], a[96:99], a[12:15], v[68:71]
    v_mfma_f32_16x16x32_bf16 v[80:83], a[96:99], a[16:19], v[80:83]
    v_mfma_f32_16x16x32_bf16 v[84:87], a[96:99], a[20:23], v[84:87]
    v_mfma_f32_16x16x32_bf16 v[96:99], a[96:99], a[24:27], v[96:99]
    v_mfma_f32_16x16x32_bf16 v[100:103], a[96:99], a[28:31], v[100:103]
    v_mfma_f32_16x16x32_bf16 v[56:59], a[100:103], a[0:3], v[56:59]
    v_mfma_f32_16x16x32_bf16 v[60:63], a[100:103], a[4:7], v[60:63]
    v_mfma_f32_16x16x32_bf16 v[72:75], a[100:103], a[8:11], v[72:75]
    buffer_load_dword v7, v6, s[44:47], 0 offen
    v_add_u32_e64 v6, s79, v6
    v_mfma_f32_16x16x32_bf16 v[76:79], a[100:103], a[12:15], v[76:79]
    v_mfma_f32_16x16x32_bf16 v[88:91], a[100:103], a[16:19], v[88:91]
    v_mfma_f32_16x16x32_bf16 v[92:95], a[100:103], a[20:23], v[92:95]
    v_mfma_f32_16x16x32_bf16 v[104:107], a[100:103], a[24:27], v[104:107]
    v_mfma_f32_16x16x32_bf16 v[108:111], a[100:103], a[28:31], v[108:111]
    s_waitcnt vmcnt(25) lgkmcnt(0)
    s_barrier
    v_mfma_f32_16x16x32_bf16 v[128:131], a[64:67], a[32:35], v[128:131]
    s_add_u32 m0, s78, 38912
    v_mfma_f32_16x16x32_bf16 v[144:147], a[64:67], a[36:39], v[144:147]
    buffer_load_dwordx4 v2, s[32:35], s68 offen offset:0 lds
    v_mfma_f32_16x16x32_bf16 v[160:163], a[64:67], a[40:43], v[160:163]
    ds_read_b128 a[0:3], v9 offset:0
    v_mfma_f32_16x16x32_bf16 v[176:179], a[64:67], a[44:47], v[176:179]
    v_mfma_f32_16x16x32_bf16 v[192:195], a[64:67], a[48:51], v[192:195]
    v_mfma_f32_16x16x32_bf16 v[208:211], a[64:67], a[52:55], v[208:211]
    v_mfma_f32_16x16x32_bf16 v[224:227], a[64:67], a[56:59], v[224:227]
    ds_read_b128 a[4:7], v9 offset:1024
    v_mfma_f32_16x16x32_bf16 v[240:243], a[64:67], a[60:63], v[240:243]
    ds_read_b64_tr_b16 a[64:65], v13 offset:0
    buffer_load_dwordx4 v2, s[32:35], s69 offen offset:1024 lds
    v_mfma_f32_16x16x32_bf16 v[132:135], a[68:71], a[32:35], v[132:135]
    ds_read_b64_tr_b16 a[66:67], v13 offset:256
    v_mfma_f32_16x16x32_bf16 v[148:151], a[68:71], a[36:39], v[148:151]
    v_mfma_f32_16x16x32_bf16 v[164:167], a[68:71], a[40:43], v[164:167]
    ds_read_b128 a[8:11], v9 offset:2048
    v_mfma_f32_16x16x32_bf16 v[180:183], a[68:71], a[44:47], v[180:183]
    v_mfma_f32_16x16x32_bf16 v[196:199], a[68:71], a[48:51], v[196:199]
    v_mfma_f32_16x16x32_bf16 v[212:215], a[68:71], a[52:55], v[212:215]
    buffer_load_dwordx4 v2, s[32:35], s70 offen offset:2048 lds
    v_add_u32 v2, 196608, v2
    v_mfma_f32_16x16x32_bf16 v[228:231], a[68:71], a[56:59], v[228:231]
    ds_read_b128 a[12:15], v9 offset:3072
    v_mfma_f32_16x16x32_bf16 v[244:247], a[68:71], a[60:63], v[244:247]
    ds_read_b64_tr_b16 a[68:69], v15 offset:0
    v_mfma_f32_16x16x32_bf16 v[136:139], a[72:75], a[32:35], v[136:139]
    ds_read_b64_tr_b16 a[70:71], v15 offset:256
    v_mfma_f32_16x16x32_bf16 v[152:155], a[72:75], a[36:39], v[152:155]
    v_mfma_f32_16x16x32_bf16 v[168:171], a[72:75], a[40:43], v[168:171]
    ds_read_b128 a[16:19], v9 offset:4096
    v_mfma_f32_16x16x32_bf16 v[184:187], a[72:75], a[44:47], v[184:187]
    buffer_load_dwordx4 v3, s[36:39], s71 offen offset:3072 lds
    v_mfma_f32_16x16x32_bf16 v[200:203], a[72:75], a[48:51], v[200:203]
    v_mfma_f32_16x16x32_bf16 v[216:219], a[72:75], a[52:55], v[216:219]
    v_mfma_f32_16x16x32_bf16 v[232:235], a[72:75], a[56:59], v[232:235]
    ds_read_b128 a[20:23], v9 offset:5120
    v_mfma_f32_16x16x32_bf16 v[248:251], a[72:75], a[60:63], v[248:251]
    ds_read_b64_tr_b16 a[72:73], v13 offset:1024
    v_mfma_f32_16x16x32_bf16 v[140:143], a[76:79], a[32:35], v[140:143]
    ds_read_b64_tr_b16 a[74:75], v13 offset:1280
    s_add_u32 m0, s78, 43008
    v_mfma_f32_16x16x32_bf16 v[156:159], a[76:79], a[36:39], v[156:159]
    buffer_load_dwordx4 v3, s[40:43], s72 offen offset:0 lds
    v_mfma_f32_16x16x32_bf16 v[172:175], a[76:79], a[40:43], v[172:175]
    ds_read_b128 a[24:27], v9 offset:6144
    v_mfma_f32_16x16x32_bf16 v[188:191], a[76:79], a[44:47], v[188:191]
    v_mfma_f32_16x16x32_bf16 v[204:207], a[76:79], a[48:51], v[204:207]
    v_mfma_f32_16x16x32_bf16 v[220:223], a[76:79], a[52:55], v[220:223]
    v_mfma_f32_16x16x32_bf16 v[236:239], a[76:79], a[56:59], v[236:239]
    ds_read_b128 a[28:31], v9 offset:7168
    v_mfma_f32_16x16x32_bf16 v[252:255], a[76:79], a[60:63], v[252:255]
    ds_read_b64_tr_b16 a[76:77], v15 offset:1024
    buffer_load_dwordx4 v3, s[36:39], s73 offen offset:1024 lds
    v_mfma_f32_16x16x32_bf16 a[128:131], a[80:83], a[32:35], a[128:131]
    ds_read_b64_tr_b16 a[78:79], v15 offset:1280
    v_mfma_f32_16x16x32_bf16 a[144:147], a[80:83], a[36:39], a[144:147]
    v_mfma_f32_16x16x32_bf16 a[160:163], a[80:83], a[40:43], a[160:163]
    ds_read_b64_tr_b16 a[96:97], v13 offset:4096
    v_mfma_f32_16x16x32_bf16 a[176:179], a[80:83], a[44:47], a[176:179]
    v_mfma_f32_16x16x32_bf16 a[192:195], a[80:83], a[48:51], a[192:195]
    v_mfma_f32_16x16x32_bf16 a[208:211], a[80:83], a[52:55], a[208:211]
    buffer_load_dwordx4 v3, s[40:43], s74 offen offset:2048 lds
    v_mfma_f32_16x16x32_bf16 a[224:227], a[80:83], a[56:59], a[224:227]
    ds_read_b64_tr_b16 a[98:99], v13 offset:4352
    v_mfma_f32_16x16x32_bf16 a[240:243], a[80:83], a[60:63], a[240:243]
    ds_read_b64_tr_b16 a[80:81], v13 offset:2048
    v_mfma_f32_16x16x32_bf16 a[132:135], a[84:87], a[32:35], a[132:135]
    ds_read_b64_tr_b16 a[82:83], v13 offset:2304
    v_mfma_f32_16x16x32_bf16 a[148:151], a[84:87], a[36:39], a[148:151]
    v_mfma_f32_16x16x32_bf16 a[164:167], a[84:87], a[40:43], a[164:167]
    ds_read_b64_tr_b16 a[100:101], v15 offset:4096
    v_mfma_f32_16x16x32_bf16 a[180:183], a[84:87], a[44:47], a[180:183]
    buffer_load_dwordx4 v3, s[36:39], s75 offen offset:3072 lds
    v_mfma_f32_16x16x32_bf16 a[196:199], a[84:87], a[48:51], a[196:199]
    v_mfma_f32_16x16x32_bf16 a[212:215], a[84:87], a[52:55], a[212:215]
    v_mfma_f32_16x16x32_bf16 a[228:231], a[84:87], a[56:59], a[228:231]
    ds_read_b64_tr_b16 a[102:103], v15 offset:4352
    v_mfma_f32_16x16x32_bf16 a[244:247], a[84:87], a[60:63], a[244:247]
    ds_read_b64_tr_b16 a[84:85], v15 offset:2048
    v_mfma_f32_16x16x32_bf16 a[136:139], a[88:91], a[32:35], a[136:139]
    ds_read_b64_tr_b16 a[86:87], v15 offset:2304
    s_add_u32 m0, s78, 47104
    v_mfma_f32_16x16x32_bf16 a[152:155], a[88:91], a[36:39], a[152:155]
    buffer_load_dwordx4 v3, s[40:43], s76 offen offset:0 lds
    v_add_u32 v3, 229376, v3
    v_mfma_f32_16x16x32_bf16 a[168:171], a[88:91], a[40:43], a[168:171]
    v_mfma_f32_16x16x32_bf16 a[184:187], a[88:91], a[44:47], a[184:187]
    v_mfma_f32_16x16x32_bf16 a[200:203], a[88:91], a[48:51], a[200:203]
    v_mfma_f32_16x16x32_bf16 a[216:219], a[88:91], a[52:55], a[216:219]
    v_mfma_f32_16x16x32_bf16 a[232:235], a[88:91], a[56:59], a[232:235]
    v_mfma_f32_16x16x32_bf16 a[248:251], a[88:91], a[60:63], a[248:251]
    ds_read_b64_tr_b16 a[88:89], v13 offset:3072
    global_load_lds_dwordx4 v[4:5], off offset:1024
    v_lshl_add_u64 v[4:5], v[4:5], 0, s[80:81]
    v_mfma_f32_16x16x32_bf16 a[140:143], a[92:95], a[32:35], a[140:143]
    ds_read_b64_tr_b16 a[90:91], v13 offset:3328
    v_mfma_f32_16x16x32_bf16 a[156:159], a[92:95], a[36:39], a[156:159]
    v_mfma_f32_16x16x32_bf16 a[172:175], a[92:95], a[40:43], a[172:175]
    v_mfma_f32_16x16x32_bf16 a[188:191], a[92:95], a[44:47], a[188:191]
    v_mfma_f32_16x16x32_bf16 a[204:207], a[92:95], a[48:51], a[204:207]
    v_mfma_f32_16x16x32_bf16 a[220:223], a[92:95], a[52:55], a[220:223]
    buffer_load_dwordx4 v1, s[28:31], s77 offen offset:2048 sc1 lds
    v_add_u32_e64 v1, 64, v1
    v_mfma_f32_16x16x32_bf16 a[236:239], a[92:95], a[56:59], a[236:239]
    v_mfma_f32_16x16x32_bf16 a[252:255], a[92:95], a[60:63], a[252:255]
    ds_read_b64_tr_b16 a[92:93], v15 offset:3072
    v_mfma_f32_16x16x32_bf16 v[48:51], a[104:107], a[32:35], v[48:51]
    ds_read_b64_tr_b16 a[94:95], v15 offset:3328
    v_mfma_f32_16x16x32_bf16 v[52:55], a[104:107], a[36:39], v[52:55]
    v_mfma_f32_16x16x32_bf16 v[64:67], a[104:107], a[40:43], v[64:67]
    v_mfma_f32_16x16x32_bf16 v[68:71], a[104:107], a[44:47], v[68:71]
    v_mfma_f32_16x16x32_bf16 v[80:83], a[104:107], a[48:51], v[80:83]
    v_mfma_f32_16x16x32_bf16 v[84:87], a[104:107], a[52:55], v[84:87]
    v_mfma_f32_16x16x32_bf16 v[96:99], a[104:107], a[56:59], v[96:99]
    v_mfma_f32_16x16x32_bf16 v[100:103], a[104:107], a[60:63], v[100:103]
    v_mfma_f32_16x16x32_bf16 v[56:59], a[108:111], a[32:35], v[56:59]
    v_mfma_f32_16x16x32_bf16 v[60:63], a[108:111], a[36:39], v[60:63]
    v_mfma_f32_16x16x32_bf16 v[72:75], a[108:111], a[40:43], v[72:75]
    buffer_load_dword v7, v6, s[44:47], 0 offen
    v_add_u32_e64 v6, s79, v6
    v_mfma_f32_16x16x32_bf16 v[76:79], a[108:111], a[44:47], v[76:79]
    v_mfma_f32_16x16x32_bf16 v[88:91], a[108:111], a[48:51], v[88:91]
    v_mfma_f32_16x16x32_bf16 v[92:95], a[108:111], a[52:55], v[92:95]
    v_mfma_f32_16x16x32_bf16 v[104:107], a[108:111], a[56:59], v[104:107]
    v_mfma_f32_16x16x32_bf16 v[108:111], a[108:111], a[60:63], v[108:111]
    s_waitcnt vmcnt(25) lgkmcnt(0)
    s_barrier
    v_mfma_f32_16x16x32_bf16 v[128:131], a[64:67], a[0:3], v[128:131]
    s_add_u32 m0, s78, 77824
    v_mfma_f32_16x16x32_bf16 v[144:147], a[64:67], a[4:7], v[144:147]
    buffer_load_dwordx4 v2, s[32:35], s68 offen offset:0 lds
    v_mfma_f32_16x16x32_bf16 v[160:163], a[64:67], a[8:11], v[160:163]
    ds_read_b128 a[32:35], v9 offset:38912
    v_mfma_f32_16x16x32_bf16 v[176:179], a[64:67], a[12:15], v[176:179]
    v_mfma_f32_16x16x32_bf16 v[192:195], a[64:67], a[16:19], v[192:195]
    v_mfma_f32_16x16x32_bf16 v[208:211], a[64:67], a[20:23], v[208:211]
    v_mfma_f32_16x16x32_bf16 v[224:227], a[64:67], a[24:27], v[224:227]
    ds_read_b128 a[36:39], v9 offset:39936
    v_mfma_f32_16x16x32_bf16 v[240:243], a[64:67], a[28:31], v[240:243]
    ds_read_b64_tr_b16 a[64:65], v13 offset:38912
    buffer_load_dwordx4 v2, s[32:35], s69 offen offset:1024 lds
    v_mfma_f32_16x16x32_bf16 v[132:135], a[68:71], a[0:3], v[132:135]
    ds_read_b64_tr_b16 a[66:67], v13 offset:39168
    v_mfma_f32_16x16x32_bf16 v[148:151], a[68:71], a[4:7], v[148:151]
    v_mfma_f32_16x16x32_bf16 v[164:167], a[68:71], a[8:11], v[164:167]
    ds_read_b128 a[40:43], v9 offset:40960
    v_mfma_f32_16x16x32_bf16 v[180:183], a[68:71], a[12:15], v[180:183]
    v_mfma_f32_16x16x32_bf16 v[196:199], a[68:71], a[16:19], v[196:199]
    v_mfma_f32_16x16x32_bf16 v[212:215], a[68:71], a[20:23], v[212:215]
    buffer_load_dwordx4 v2, s[32:35], s70 offen offset:2048 lds
    v_add_u32 v2, 196608, v2
    v_mfma_f32_16x16x32_bf16 v[228:231], a[68:71], a[24:27], v[228:231]
    ds_read_b128 a[44:47], v9 offset:41984
    v_mfma_f32_16x16x32_bf16 v[244:247], a[68:71], a[28:31], v[244:247]
    ds_read_b64_tr_b16 a[68:69], v15 offset:38912
    v_mfma_f32_16x16x32_bf16 v[136:139], a[72:75], a[0:3], v[136:139]
    ds_read_b64_tr_b16 a[70:71], v15 offset:39168
    v_mfma_f32_16x16x32_bf16 v[152:155], a[72:75], a[4:7], v[152:155]
    v_mfma_f32_16x16x32_bf16 v[168:171], a[72:75], a[8:11], v[168:171]
    ds_read_b128 a[48:51], v9 offset:43008
    v_mfma_f32_16x16x32_bf16 v[184:187], a[72:75], a[12:15], v[184:187]
    buffer_load_dwordx4 v3, s[36:39], s71 offen offset:3072 lds
    v_mfma_f32_16x16x32_bf16 v[200:203], a[72:75], a[16:19], v[200:203]
    v_mfma_f32_16x16x32_bf16 v[216:219], a[72:75], a[20:23], v[216:219]
    v_mfma_f32_16x16x32_bf16 v[232:235], a[72:75], a[24:27], v[232:235]
    ds_read_b128 a[52:55], v9 offset:44032
    v_mfma_f32_16x16x32_bf16 v[248:251], a[72:75], a[28:31], v[248:251]
    ds_read_b64_tr_b16 a[72:73], v13 offset:39936
    v_mfma_f32_16x16x32_bf16 v[140:143], a[76:79], a[0:3], v[140:143]
    ds_read_b64_tr_b16 a[74:75], v13 offset:40192
    s_add_u32 m0, s78, 81920
    v_mfma_f32_16x16x32_bf16 v[156:159], a[76:79], a[4:7], v[156:159]
    buffer_load_dwordx4 v3, s[40:43], s72 offen offset:0 lds
    v_mfma_f32_16x16x32_bf16 v[172:175], a[76:79], a[8:11], v[172:175]
    ds_read_b128 a[56:59], v9 offset:45056
    v_mfma_f32_16x16x32_bf16 v[188:191], a[76:79], a[12:15], v[188:191]
    v_mfma_f32_16x16x32_bf16 v[204:207], a[76:79], a[16:19], v[204:207]
    v_mfma_f32_16x16x32_bf16 v[220:223], a[76:79], a[20:23], v[220:223]
    v_mfma_f32_16x16x32_bf16 v[236:239], a[76:79], a[24:27], v[236:239]
    ds_read_b128 a[60:63], v9 offset:46080
    v_mfma_f32_16x16x32_bf16 v[252:255], a[76:79], a[28:31], v[252:255]
    ds_read_b64_tr_b16 a[76:77], v15 offset:39936
    buffer_load_dwordx4 v3, s[36:39], s73 offen offset:1024 lds
    v_mfma_f32_16x16x32_bf16 a[128:131], a[80:83], a[0:3], a[128:131]
    ds_read_b64_tr_b16 a[78:79], v15 offset:40192
    v_mfma_f32_16x16x32_bf16 a[144:147], a[80:83], a[4:7], a[144:147]
    v_mfma_f32_16x16x32_bf16 a[160:163], a[80:83], a[8:11], a[160:163]
    ds_read_b64_tr_b16 a[104:105], v13 offset:43008
    v_mfma_f32_16x16x32_bf16 a[176:179], a[80:83], a[12:15], a[176:179]
    v_mfma_f32_16x16x32_bf16 a[192:195], a[80:83], a[16:19], a[192:195]
    v_mfma_f32_16x16x32_bf16 a[208:211], a[80:83], a[20:23], a[208:211]
    buffer_load_dwordx4 v3, s[40:43], s74 offen offset:2048 lds
    v_mfma_f32_16x16x32_bf16 a[224:227], a[80:83], a[24:27], a[224:227]
    ds_read_b64_tr_b16 a[106:107], v13 offset:43264
    v_mfma_f32_16x16x32_bf16 a[240:243], a[80:83], a[28:31], a[240:243]
    ds_read_b64_tr_b16 a[80:81], v13 offset:40960
    v_mfma_f32_16x16x32_bf16 a[132:135], a[84:87], a[0:3], a[132:135]
    ds_read_b64_tr_b16 a[82:83], v13 offset:41216
    v_mfma_f32_16x16x32_bf16 a[148:151], a[84:87], a[4:7], a[148:151]
    v_mfma_f32_16x16x32_bf16 a[164:167], a[84:87], a[8:11], a[164:167]
    ds_read_b64_tr_b16 a[108:109], v15 offset:43008
    v_mfma_f32_16x16x32_bf16 a[180:183], a[84:87], a[12:15], a[180:183]
    buffer_load_dwordx4 v3, s[36:39], s75 offen offset:3072 lds
    v_mfma_f32_16x16x32_bf16 a[196:199], a[84:87], a[16:19], a[196:199]
    v_mfma_f32_16x16x32_bf16 a[212:215], a[84:87], a[20:23], a[212:215]
    v_mfma_f32_16x16x32_bf16 a[228:231], a[84:87], a[24:27], a[228:231]
    ds_read_b64_tr_b16 a[110:111], v15 offset:43264
    v_mfma_f32_16x16x32_bf16 a[244:247], a[84:87], a[28:31], a[244:247]
    ds_read_b64_tr_b16 a[84:85], v15 offset:40960
    v_mfma_f32_16x16x32_bf16 a[136:139], a[88:91], a[0:3], a[136:139]
    ds_read_b64_tr_b16 a[86:87], v15 offset:41216
    s_add_u32 m0, s78, 86016
    v_mfma_f32_16x16x32_bf16 a[152:155], a[88:91], a[4:7], a[152:155]
    buffer_load_dwordx4 v3, s[40:43], s76 offen offset:0 lds
    v_add_u32 v3, 229376, v3
    v_mfma_f32_16x16x32_bf16 a[168:171], a[88:91], a[8:11], a[168:171]
    v_mfma_f32_16x16x32_bf16 a[184:187], a[88:91], a[12:15], a[184:187]
    v_mfma_f32_16x16x32_bf16 a[200:203], a[88:91], a[16:19], a[200:203]
    v_mfma_f32_16x16x32_bf16 a[216:219], a[88:91], a[20:23], a[216:219]
    v_mfma_f32_16x16x32_bf16 a[232:235], a[88:91], a[24:27], a[232:235]
    v_mfma_f32_16x16x32_bf16 a[248:251], a[88:91], a[28:31], a[248:251]
    ds_read_b64_tr_b16 a[88:89], v13 offset:41984
    global_load_lds_dwordx4 v[4:5], off offset:1024
    v_lshl_add_u64 v[4:5], v[4:5], 0, s[80:81]
    v_mfma_f32_16x16x32_bf16 a[140:143], a[92:95], a[0:3], a[140:143]
    ds_read_b64_tr_b16 a[90:91], v13 offset:42240
    v_mfma_f32_16x16x32_bf16 a[156:159], a[92:95], a[4:7], a[156:159]
    v_mfma_f32_16x16x32_bf16 a[172:175], a[92:95], a[8:11], a[172:175]
    v_mfma_f32_16x16x32_bf16 a[188:191], a[92:95], a[12:15], a[188:191]
    v_mfma_f32_16x16x32_bf16 a[204:207], a[92:95], a[16:19], a[204:207]
    v_mfma_f32_16x16x32_bf16 a[220:223], a[92:95], a[20:23], a[220:223]
    buffer_load_dwordx4 v1, s[28:31], s77 offen offset:2048 sc1 lds
    v_add_u32_e64 v1, 64, v1
    v_mfma_f32_16x16x32_bf16 a[236:239], a[92:95], a[24:27], a[236:239]
    v_mfma_f32_16x16x32_bf16 a[252:255], a[92:95], a[28:31], a[252:255]
    ds_read_b64_tr_b16 a[92:93], v15 offset:41984
    v_mfma_f32_16x16x32_bf16 v[48:51], a[96:99], a[0:3], v[48:51]
    ds_read_b64_tr_b16 a[94:95], v15 offset:42240
    v_mfma_f32_16x16x32_bf16 v[52:55], a[96:99], a[4:7], v[52:55]
    v_mfma_f32_16x16x32_bf16 v[64:67], a[96:99], a[8:11], v[64:67]
    v_mfma_f32_16x16x32_bf16 v[68:71], a[96:99], a[12:15], v[68:71]
    v_mfma_f32_16x16x32_bf16 v[80:83], a[96:99], a[16:19], v[80:83]
    v_mfma_f32_16x16x32_bf16 v[84:87], a[96:99], a[20:23], v[84:87]
    v_mfma_f32_16x16x32_bf16 v[96:99], a[96:99], a[24:27], v[96:99]
    v_mfma_f32_16x16x32_bf16 v[100:103], a[96:99], a[28:31], v[100:103]
    v_mfma_f32_16x16x32_bf16 v[56:59], a[100:103], a[0:3], v[56:59]
    v_mfma_f32_16x16x32_bf16 v[60:63], a[100:103], a[4:7], v[60:63]
    v_mfma_f32_16x16x32_bf16 v[72:75], a[100:103], a[8:11], v[72:75]
    buffer_load_dword v7, v6, s[44:47], 0 offen
    v_add_u32_e64 v6, s79, v6
    v_mfma_f32_16x16x32_bf16 v[76:79], a[100:103], a[12:15], v[76:79]
    v_mfma_f32_16x16x32_bf16 v[88:91], a[100:103], a[16:19], v[88:91]
    v_mfma_f32_16x16x32_bf16 v[92:95], a[100:103], a[20:23], v[92:95]
    v_mfma_f32_16x16x32_bf16 v[104:107], a[100:103], a[24:27], v[104:107]
    v_mfma_f32_16x16x32_bf16 v[108:111], a[100:103], a[28:31], v[108:111]
    s_waitcnt vmcnt(25) lgkmcnt(0)
    s_barrier
    v_mfma_f32_16x16x32_bf16 v[128:131], a[64:67], a[32:35], v[128:131]
    s_add_u32 m0, s78, 116736
    v_mfma_f32_16x16x32_bf16 v[144:147], a[64:67], a[36:39], v[144:147]
    buffer_load_dwordx4 v2, s[32:35], s68 offen offset:0 lds
    v_mfma_f32_16x16x32_bf16 v[160:163], a[64:67], a[40:43], v[160:163]
    ds_read_b128 a[0:3], v8 offset:0
    v_mfma_f32_16x16x32_bf16 v[176:179], a[64:67], a[44:47], v[176:179]
    v_mfma_f32_16x16x32_bf16 v[192:195], a[64:67], a[48:51], v[192:195]
    v_mfma_f32_16x16x32_bf16 v[208:211], a[64:67], a[52:55], v[208:211]
    v_mfma_f32_16x16x32_bf16 v[224:227], a[64:67], a[56:59], v[224:227]
    ds_read_b128 a[4:7], v8 offset:1024
    v_mfma_f32_16x16x32_bf16 v[240:243], a[64:67], a[60:63], v[240:243]
    ds_read_b64_tr_b16 a[64:65], v12 offset:0
    buffer_load_dwordx4 v2, s[32:35], s69 offen offset:1024 lds
    v_mfma_f32_16x16x32_bf16 v[132:135], a[68:71], a[32:35], v[132:135]
    ds_read_b64_tr_b16 a[66:67], v12 offset:256
    v_mfma_f32_16x16x32_bf16 v[148:151], a[68:71], a[36:39], v[148:151]
    v_mfma_f32_16x16x32_bf16 v[164:167], a[68:71], a[40:43], v[164:167]
    ds_read_b128 a[8:11], v8 offset:2048
    v_mfma_f32_16x16x32_bf16 v[180:183], a[68:71], a[44:47], v[180:183]
    v_mfma_f32_16x16x32_bf16 v[196:199], a[68:71], a[48:51], v[196:199]
    v_mfma_f32_16x16x32_bf16 v[212:215], a[68:71], a[52:55], v[212:215]
    buffer_load_dwordx4 v2, s[32:35], s70 offen offset:2048 lds
    v_add_u32 v2, 196608, v2
    v_mfma_f32_16x16x32_bf16 v[228:231], a[68:71], a[56:59], v[228:231]
    ds_read_b128 a[12:15], v8 offset:3072
    v_mfma_f32_16x16x32_bf16 v[244:247], a[68:71], a[60:63], v[244:247]
    ds_read_b64_tr_b16 a[68:69], v14 offset:0
    v_mfma_f32_16x16x32_bf16 v[136:139], a[72:75], a[32:35], v[136:139]
    ds_read_b64_tr_b16 a[70:71], v14 offset:256
    v_mfma_f32_16x16x32_bf16 v[152:155], a[72:75], a[36:39], v[152:155]
    v_mfma_f32_16x16x32_bf16 v[168:171], a[72:75], a[40:43], v[168:171]
    ds_read_b128 a[16:19], v8 offset:4096
    v_mfma_f32_16x16x32_bf16 v[184:187], a[72:75], a[44:47], v[184:187]
    buffer_load_dwordx4 v3, s[36:39], s71 offen offset:3072 lds
    v_mfma_f32_16x16x32_bf16 v[200:203], a[72:75], a[48:51], v[200:203]
    v_mfma_f32_16x16x32_bf16 v[216:219], a[72:75], a[52:55], v[216:219]
    v_mfma_f32_16x16x32_bf16 v[232:235], a[72:75], a[56:59], v[232:235]
    ds_read_b128 a[20:23], v8 offset:5120
    v_mfma_f32_16x16x32_bf16 v[248:251], a[72:75], a[60:63], v[248:251]
    ds_read_b64_tr_b16 a[72:73], v12 offset:1024
    v_mfma_f32_16x16x32_bf16 v[140:143], a[76:79], a[32:35], v[140:143]
    ds_read_b64_tr_b16 a[74:75], v12 offset:1280
    s_add_u32 m0, s78, 120832
    v_mfma_f32_16x16x32_bf16 v[156:159], a[76:79], a[36:39], v[156:159]
    buffer_load_dwordx4 v3, s[40:43], s72 offen offset:0 lds
    v_mfma_f32_16x16x32_bf16 v[172:175], a[76:79], a[40:43], v[172:175]
    ds_read_b128 a[24:27], v8 offset:6144
    v_mfma_f32_16x16x32_bf16 v[188:191], a[76:79], a[44:47], v[188:191]
    v_mfma_f32_16x16x32_bf16 v[204:207], a[76:79], a[48:51], v[204:207]
    v_mfma_f32_16x16x32_bf16 v[220:223], a[76:79], a[52:55], v[220:223]
    v_mfma_f32_16x16x32_bf16 v[236:239], a[76:79], a[56:59], v[236:239]
    ds_read_b128 a[28:31], v8 offset:7168
    v_mfma_f32_16x16x32_bf16 v[252:255], a[76:79], a[60:63], v[252:255]
    ds_read_b64_tr_b16 a[76:77], v14 offset:1024
    buffer_load_dwordx4 v3, s[36:39], s73 offen offset:1024 lds
    v_mfma_f32_16x16x32_bf16 a[128:131], a[80:83], a[32:35], a[128:131]
    ds_read_b64_tr_b16 a[78:79], v14 offset:1280
    v_mfma_f32_16x16x32_bf16 a[144:147], a[80:83], a[36:39], a[144:147]
    v_mfma_f32_16x16x32_bf16 a[160:163], a[80:83], a[40:43], a[160:163]
    ds_read_b64_tr_b16 a[96:97], v12 offset:4096
    v_mfma_f32_16x16x32_bf16 a[176:179], a[80:83], a[44:47], a[176:179]
    v_mfma_f32_16x16x32_bf16 a[192:195], a[80:83], a[48:51], a[192:195]
    v_mfma_f32_16x16x32_bf16 a[208:211], a[80:83], a[52:55], a[208:211]
    buffer_load_dwordx4 v3, s[40:43], s74 offen offset:2048 lds
    v_mfma_f32_16x16x32_bf16 a[224:227], a[80:83], a[56:59], a[224:227]
    ds_read_b64_tr_b16 a[98:99], v12 offset:4352
    v_mfma_f32_16x16x32_bf16 a[240:243], a[80:83], a[60:63], a[240:243]
    ds_read_b64_tr_b16 a[80:81], v12 offset:2048
    v_mfma_f32_16x16x32_bf16 a[132:135], a[84:87], a[32:35], a[132:135]
    ds_read_b64_tr_b16 a[82:83], v12 offset:2304
    v_mfma_f32_16x16x32_bf16 a[148:151], a[84:87], a[36:39], a[148:151]
    v_mfma_f32_16x16x32_bf16 a[164:167], a[84:87], a[40:43], a[164:167]
    ds_read_b64_tr_b16 a[100:101], v14 offset:4096
    v_mfma_f32_16x16x32_bf16 a[180:183], a[84:87], a[44:47], a[180:183]
    buffer_load_dwordx4 v3, s[36:39], s75 offen offset:3072 lds
    v_mfma_f32_16x16x32_bf16 a[196:199], a[84:87], a[48:51], a[196:199]
    v_mfma_f32_16x16x32_bf16 a[212:215], a[84:87], a[52:55], a[212:215]
    v_mfma_f32_16x16x32_bf16 a[228:231], a[84:87], a[56:59], a[228:231]
    ds_read_b64_tr_b16 a[102:103], v14 offset:4352
    v_mfma_f32_16x16x32_bf16 a[244:247], a[84:87], a[60:63], a[244:247]
    ds_read_b64_tr_b16 a[84:85], v14 offset:2048
    v_mfma_f32_16x16x32_bf16 a[136:139], a[88:91], a[32:35], a[136:139]
    ds_read_b64_tr_b16 a[86:87], v14 offset:2304
    s_add_u32 m0, s78, 124928
    v_mfma_f32_16x16x32_bf16 a[152:155], a[88:91], a[36:39], a[152:155]
    buffer_load_dwordx4 v3, s[40:43], s76 offen offset:0 lds
    v_add_u32 v3, 229376, v3
    v_mfma_f32_16x16x32_bf16 a[168:171], a[88:91], a[40:43], a[168:171]
    v_mfma_f32_16x16x32_bf16 a[184:187], a[88:91], a[44:47], a[184:187]
    v_mfma_f32_16x16x32_bf16 a[200:203], a[88:91], a[48:51], a[200:203]
    v_mfma_f32_16x16x32_bf16 a[216:219], a[88:91], a[52:55], a[216:219]
    v_mfma_f32_16x16x32_bf16 a[232:235], a[88:91], a[56:59], a[232:235]
    v_mfma_f32_16x16x32_bf16 a[248:251], a[88:91], a[60:63], a[248:251]
    ds_read_b64_tr_b16 a[88:89], v12 offset:3072
    global_load_lds_dwordx4 v[4:5], off offset:1024
    v_lshl_add_u64 v[4:5], v[4:5], 0, s[80:81]
    v_mfma_f32_16x16x32_bf16 a[140:143], a[92:95], a[32:35], a[140:143]
    ds_read_b64_tr_b16 a[90:91], v12 offset:3328
    v_mfma_f32_16x16x32_bf16 a[156:159], a[92:95], a[36:39], a[156:159]
    v_mfma_f32_16x16x32_bf16 a[172:175], a[92:95], a[40:43], a[172:175]
    v_mfma_f32_16x16x32_bf16 a[188:191], a[92:95], a[44:47], a[188:191]
    v_mfma_f32_16x16x32_bf16 a[204:207], a[92:95], a[48:51], a[204:207]
    v_mfma_f32_16x16x32_bf16 a[220:223], a[92:95], a[52:55], a[220:223]
    buffer_load_dwordx4 v1, s[28:31], s77 offen offset:2048 sc1 lds
    v_add_u32_e64 v1, 64, v1
    v_mfma_f32_16x16x32_bf16 a[236:239], a[92:95], a[56:59], a[236:239]
    v_mfma_f32_16x16x32_bf16 a[252:255], a[92:95], a[60:63], a[252:255]
    ds_read_b64_tr_b16 a[92:93], v14 offset:3072
    v_mfma_f32_16x16x32_bf16 v[48:51], a[104:107], a[32:35], v[48:51]
    ds_read_b64_tr_b16 a[94:95], v14 offset:3328
    v_mfma_f32_16x16x32_bf16 v[52:55], a[104:107], a[36:39], v[52:55]
    v_mfma_f32_16x16x32_bf16 v[64:67], a[104:107], a[40:43], v[64:67]
    v_mfma_f32_16x16x32_bf16 v[68:71], a[104:107], a[44:47], v[68:71]
    v_mfma_f32_16x16x32_bf16 v[80:83], a[104:107], a[48:51], v[80:83]
    v_mfma_f32_16x16x32_bf16 v[84:87], a[104:107], a[52:55], v[84:87]
    v_mfma_f32_16x16x32_bf16 v[96:99], a[104:107], a[56:59], v[96:99]
    v_mfma_f32_16x16x32_bf16 v[100:103], a[104:107], a[60:63], v[100:103]
    v_mfma_f32_16x16x32_bf16 v[56:59], a[108:111], a[32:35], v[56:59]
    v_mfma_f32_16x16x32_bf16 v[60:63], a[108:111], a[36:39], v[60:63]
    v_mfma_f32_16x16x32_bf16 v[72:75], a[108:111], a[40:43], v[72:75]
    buffer_load_dword v7, v6, s[44:47], 0 offen
    v_add_u32_e64 v6, s79, v6
    v_mfma_f32_16x16x32_bf16 v[76:79], a[108:111], a[44:47], v[76:79]
    v_mfma_f32_16x16x32_bf16 v[88:91], a[108:111], a[48:51], v[88:91]
    v_mfma_f32_16x16x32_bf16 v[92:95], a[108:111], a[52:55], v[92:95]
    v_mfma_f32_16x16x32_bf16 v[104:107], a[108:111], a[56:59], v[104:107]
    v_mfma_f32_16x16x32_bf16 v[108:111], a[108:111], a[60:63], v[108:111]
    s_sub_u32 s67, s67, 1
    s_cmp_lg_u32 s67, 0
    s_cbranch_scc1 L_loop1
    s_waitcnt vmcnt(25) lgkmcnt(0)
    s_barrier
    v_mfma_f32_16x16x32_bf16 v[128:131], a[64:67], a[0:3], v[128:131]
    v_mfma_f32_16x16x32_bf16 v[144:147], a[64:67], a[4:7], v[144:147]
    v_mfma_f32_16x16x32_bf16 v[160:163], a[64:67], a[8:11], v[160:163]
    ds_read_b128 a[32:35], v8 offset:38912
    v_mfma_f32_16x16x32_bf16 v[176:179], a[64:67], a[12:15], v[176:179]
    v_mfma_f32_16x16x32_bf16 v[192:195], a[64:67], a[16:19], v[192:195]
    v_mfma_f32_16x16x32_bf16 v[208:211], a[64:67], a[20:23], v[208:211]
    v_mfma_f32_16x16x32_bf16 v[224:227], a[64:67], a[24:27], v[224:227]
    ds_read_b128 a[36:39], v8 offset:39936
    v_mfma_f32_16x16x32_bf16 v[240:243], a[64:67], a[28:31], v[240:243]
    ds_read_b64_tr_b16 a[64:65], v12 offset:38912
    v_mfma_f32_16x16x32_bf16 v[132:135], a[68:71], a[0:3], v[132:135]
    ds_read_b64_tr_b16 a[66:67], v12 offset:39168
    v_mfma_f32_16x16x32_bf16 v[148:151], a[68:71], a[4:7], v[148:151]
    v_mfma_f32_16x16x32_bf16 v[164:167], a[68:71], a[8:11], v[164:167]
    ds_read_b128 a[40:43], v8 offset:40960
    v_mfma_f32_16x16x32_bf16 v[180:183], a[68:71], a[12:15], v[180:183]
    v_mfma_f32_16x16x32_bf16 v[196:199], a[68:71], a[16:19], v[196:199]
    v_mfma_f32_16x16x32_bf16 v[212:215], a[68:71], a[20:23], v[212:215]
    v_mfma_f32_16x16x32_bf16 v[228:231], a[68:71], a[24:27], v[228:231]
    ds_read_b128 a[44:47], v8 offset:41984
    v_mfma_f32_16x16x32_bf16 v[244:247], a[68:71], a[28:31], v[244:247]
    ds_read_b64_tr_b16 a[68:69], v14 offset:38912
    v_mfma_f32_16x16x32_bf16 v[136:139], a[72:75], a[0:3], v[136:139]
    ds_read_b64_tr_b16 a[70:71], v14 offset:39168
    v_mfma_f32_16x16x32_bf16 v[152:155], a[72:75], a[4:7], v[152:155]
    v_mfma_f32_16x16x32_bf16 v[168:171], a[72:75], a[8:11], v[168:171]
    ds_read_b128 a[48:51], v8 offset:43008
    v_mfma_f32_16x16x32_bf16 v[184:187], a[72:75], a[12:15], v[184:187]
    v_mfma_f32_16x16x32_bf16 v[200:203], a[72:75], a[16:19], v[200:203]
    v_mfma_f32_16x16x32_bf16 v[216:219], a[72:75], a[20:23], v[216:219]
    v_mfma_f32_16x16x32_bf16 v[232:235], a[72:75], a[24:27], v[232:235]
    ds_read_b128 a[52:55], v8 offset:44032
    v_mfma_f32_16x16x32_bf16 v[248:251], a[72:75], a[28:31], v[248:251]
    ds_read_b64_tr_b16 a[72:73], v12 offset:39936
    v_mfma_f32_16x16x32_bf16 v[140:143], a[76:79], a[0:3], v[140:143]
    ds_read_b64_tr_b16 a[74:75], v12 offset:40192
    v_mfma_f32_16x16x32_bf16 v[156:159], a[76:79], a[4:7], v[156:159]
    v_mfma_f32_16x16x32_bf16 v[172:175], a[76:79], a[8:11], v[172:175]
    ds_read_b128 a[56:59], v8 offset:45056
    v_mfma_f32_16x16x32_bf16 v[188:191], a[76:79], a[12:15], v[188:191]
    v_mfma_f32_16x16x32_bf16 v[204:207], a[76:79], a[16:19], v[204:207]
    v_mfma_f32_16x16x32_bf16 v[220:223], a[76:79], a[20:23], v[220:223]
    v_mfma_f32_16x16x32_bf16 v[236:239], a[76:79], a[24:27], v[236:239]
    ds_read_b128 a[60:63], v8 offset:46080
    v_mfma_f32_16x16x32_bf16 v[252:255], a[76:79], a[28:31], v[252:255]
    ds_read_b64_tr_b16 a[76:77], v14 offset:39936
    v_mfma_f32_16x16x32_bf16 a[128:131], a[80:83], a[0:3], a[128:131]
    ds_read_b64_tr_b16 a[78:79], v14 offset:40192
    v_mfma_f32_16x16x32_bf16 a[144:147], a[80:83], a[4:7], a[144:147]
    v_mfma_f32_16x16x32_bf16 a[160:163], a[80:83], a[8:11], a[160:163]
    ds_read_b64_tr_b16 a[104:105], v12 offset:43008
    v_mfma_f32_16x16x32_bf16 a[176:179], a[80:83], a[12:15], a[176:179]
    v_mfma_f32_16x16x32_bf16 a[192:195], a[80:83], a[16:19], a[192:195]
    v_mfma_f32_16x16x32_bf16 a[208:211], a[80:83], a[20:23], a[208:211]
    v_mfma_f32_16x16x32_bf16 a[224:227], a[80:83], a[24:27], a[224:227]
    ds_read_b64_tr_b16 a[106:107], v12 offset:43264
    v_mfma_f32_16x16x32_bf16 a[240:243], a[80:83], a[28:31], a[240:243]
    ds_read_b64_tr_b16 a[80:81], v12 offset:40960
    v_mfma_f32_16x16x32_bf16 a[132:135], a[84:87], a[0:3], a[132:135]
    ds_read_b64_tr_b16 a[82:83], v12 offset:41216
    v_mfma_f32_16x16x32_bf16 a[148:151], a[84:87], a[4:7], a[148:151]
    v_mfma_f32_16x16x32_bf16 a[164:167], a[84:87], a[8:11], a[164:167]
    ds_read_b64_tr_b16 a[108:109], v14 offset:43008
    v_mfma_f32_16x16x32_bf16 a[180:183], a[84:87], a[12:15], a[180:183]
    v_mfma_f32_16x16x32_bf16 a[196:199], a[84:87], a[16:19], a[196:199]
    v_mfma_f32_16x16x32_bf16 a[212:215], a[84:87], a[20:23], a[212:215]
    v_mfma_f32_16x16x32_bf16 a[228:231], a[84:87], a[24:27], a[228:231]
    ds_read_b64_tr_b16 a[110:111], v14 offset:43264
    v_mfma_f32_16x16x32_bf16 a[244:247], a[84:87], a[28:31], a[244:247]
    ds_read_b64_tr_b16 a[84:85], v14 offset:40960
    v_mfma_f32_16x16x32_bf16 a[136:139], a[88:91], a[0:3], a[136:139]
    ds_read_b64_tr_b16 a[86:87], v14 offset:41216
    v_mfma_f32_16x16x32_bf16 a[152:155], a[88:91], a[4:7], a[152:155]
    v_mfma_f32_16x16x32_bf16 a[168:171], a[88:91], a[8:11], a[168:171]
    v_mfma_f32_16x16x32_bf16 a[184:187], a[88:91], a[12:15], a[184:187]
    v_mfma_f32_16x16x32_bf16 a[200:203], a[88:91], a[16:19], a[200:203]
    v_mfma_f32_16x16x32_bf16 a[216:219], a[88:91], a[20:23], a[216:219]
    v_mfma_f32_16x16x32_bf16 a[232:235], a[88:91], a[24:27], a[232:235]
    v_mfma_f32_16x16x32_bf16 a[248:251], a[88:91], a[28:31], a[248:251]
    ds_read_b64_tr_b16 a[88:89], v12 offset:41984
    v_mfma_f32_16x16x32_bf16 a[140:143], a[92:95], a[0:3], a[140:143]
    ds_read_b64_tr_b16 a[90:91], v12 offset:42240
    v_mfma_f32_16x16x32_bf16 a[156:159], a[92:95], a[4:7], a[156:159]
    v_mfma_f32_16x16x32_bf16 a[172:175], a[92:95], a[8:11], a[172:175]
    v_mfma_f32_16x16x32_bf16 a[188:191], a[92:95], a[12:15], a[188:191]
    v_mfma_f32_16x16x32_bf16 a[204:207], a[92:95], a[16:19], a[204:207]
    v_mfma_f32_16x16x32_bf16 a[220:223], a[92:95], a[20:23], a[220:223]
    v_mfma_f32_16x16x32_bf16 a[236:239], a[92:95], a[24:27], a[236:239]
    v_mfma_f32_16x16x32_bf16 a[252:255], a[92:95], a[28:31], a[252:255]
    ds_read_b64_tr_b16 a[92:93], v14 offset:41984
    v_mfma_f32_16x16x32_bf16 v[48:51], a[96:99], a[0:3], v[48:51]
    ds_read_b64_tr_b16 a[94:95], v14 offset:42240
    v_mfma_f32_16x16x32_bf16 v[52:55], a[96:99], a[4:7], v[52:55]
    v_mfma_f32_16x16x32_bf16 v[64:67], a[96:99], a[8:11], v[64:67]
    v_mfma_f32_16x16x32_bf16 v[68:71], a[96:99], a[12:15], v[68:71]
    v_mfma_f32_16x16x32_bf16 v[80:83], a[96:99], a[16:19], v[80:83]
    v_mfma_f32_16x16x32_bf16 v[84:87], a[96:99], a[20:23], v[84:87]
    v_mfma_f32_16x16x32_bf16 v[96:99], a[96:99], a[24:27], v[96:99]
    s_getpc_b64 s[86:87]
L_pc1:
    s_add_u32 s86, s86, L_epi-L_pc1
    s_addc_u32 s87, s87, 0
    s_lshr_b32 s82, s2, 3
    s_lshl_b32 s82, s82, 2
    s_add_u32 s82, s82, s60
    s_lshl_b32 s82, s82, 10
    v_add_u32 v34, s82, v16
    v_min_u32 v34, L_code_end-L_epi-4, v34
    global_load_dword v7, v34, s[86:87]
    s_lshl_b32 s82, s2, 2
    s_add_u32 s82, s82, s60
    s_lshl_b32 s82, s82, 11
    v_and_b32 v35, 31, v0
    v_lshlrev_b32 v35, 6, v35
    v_add_u32 v35, s82, v35
    global_load_dword v7, v35, s[12:13]
    v_mfma_f32_16x16x32_bf16 v[100:103], a[96:99], a[28:31], v[100:103]
    v_mfma_f32_16x16x32_bf16 v[56:59], a[100:103], a[0:3], v[56:59]
    v_mfma_f32_16x16x32_bf16 v[60:63], a[100:103], a[4:7], v[60:63]
    v_mfma_f32_16x16x32_bf16 v[72:75], a[100:103], a[8:11], v[72:75]
    v_mfma_f32_16x16x32_bf16 v[76:79], a[100:103], a[12:15], v[76:79]
    v_mfma_f32_16x16x32_bf16 v[88:91], a[100:103], a[16:19], v[88:91]
    v_mfma_f32_16x16x32_bf16 v[92:95], a[100:103], a[20:23], v[92:95]
    v_mfma_f32_16x16x32_bf16 v[104:107], a[100:103], a[24:27], v[104:107]
    v_mfma_f32_16x16x32_bf16 v[108:111], a[100:103], a[28:31], v[108:111]
    s_waitcnt vmcnt(15) lgkmcnt(0)
    s_barrier
    v_mfma_f32_16x16x32_bf16 v[128:131], a[64:67], a[32:35], v[128:131]
    v_mfma_f32_16x16x32_bf16 v[144:147], a[64:67], a[36:39], v[144:147]
    v_mfma_f32_16x16x32_bf16 v[160:163], a[64:67], a[40:43], v[160:163]
    ds_read_b128 a[0:3], v9 offset:0
    v_mfma_f32_16x16x32_bf16 v[176:179], a[64:67], a[44:47], v[176:179]
    v_mfma_f32_16x16x32_bf16 v[192:195], a[64:67], a[48:51], v[192:195]
    s_mul_i32 s82, s65, 1835008
    v_mfma_f32_16x16x32_bf16 v[208:211], a[64:67], a[52:55], v[208:211]
    s_lshl_b32 s83, s66, 8
    v_mfma_f32_16x16x32_bf16 v[224:227], a[64:67], a[56:59], v[224:227]
    ds_read_b128 a[4:7], v9 offset:1024
    s_add_u32 s82, s82, s83
    v_mfma_f32_16x16x32_bf16 v[240:243], a[64:67], a[60:63], v[240:243]
    ds_read_b64_tr_b16 a[64:65], v13 offset:0
    s_add_u32 s48, s20, s82
    v_mfma_f32_16x16x32_bf16 v[132:135], a[68:71], a[32:35], v[132:135]
    ds_read_b64_tr_b16 a[66:67], v13 offset:256
    s_addc_u32 s49, s21, 0
    v_mfma_f32_16x16x32_bf16 v[148:151], a[68:71], a[36:39], v[148:151]
    s_and_b32 s49, s49, 0xffff
    v_mfma_f32_16x16x32_bf16 v[164:167], a[68:71], a[40:43], v[164:167]
    ds_read_b128 a[8:11], v9 offset:2048
    s_sub_u32 s50, 7340032, s82
    v_mfma_f32_16x16x32_bf16 v[180:183], a[68:71], a[44:47], v[180:183]
    s_mov_b32 s51, 0x20000
    v_mfma_f32_16x16x32_bf16 v[196:199], a[68:71], a[48:51], v[196:199]
    s_add_u32 s52, s12, s83
    v_mfma_f32_16x16x32_bf16 v[212:215], a[68:71], a[52:55], v[212:215]
    s_addc_u32 s53, s13, 0
    v_mfma_f32_16x16x32_bf16 v[228:231], a[68:71], a[56:59], v[228:231]
    ds_read_b128 a[12:15], v9 offset:3072
    s_and_b32 s53, s53, 0xffff
    v_mfma_f32_16x16x32_bf16 v[244:247], a[68:71], a[60:63], v[244:247]
    ds_read_b64_tr_b16 a[68:69], v15 offset:0
    s_sub_u32 s54, 2097152, s83
    v_mfma_f32_16x16x32_bf16 v[136:139], a[72:75], a[32:35], v[136:139]
    ds_read_b64_tr_b16 a[70:71], v15 offset:256
    s_mov_b32 s55, 0x20000
    v_mfma_f32_16x16x32_bf16 v[152:155], a[72:75], a[36:39], v[152:155]
    s_lshl_b32 s3, s60, 11
    v_mfma_f32_16x16x32_bf16 v[168:171], a[72:75], a[40:43], v[168:171]
    ds_read_b128 a[16:19], v9 offset:4096
    v_lshrrev_b32 v34, 4, v0
    v_mfma_f32_16x16x32_bf16 v[184:187], a[72:75], a[44:47], v[184:187]
    v_and_b32 v35, 15, v0
    v_mfma_f32_16x16x32_bf16 v[200:203], a[72:75], a[48:51], v[200:203]
    v_lshlrev_b32 v36, 1, v34
    v_mfma_f32_16x16x32_bf16 v[216:219], a[72:75], a[52:55], v[216:219]
    v_add_u32 v36, 0, v36
    v_mfma_f32_16x16x32_bf16 v[232:235], a[72:75], a[56:59], v[232:235]
    ds_read_b128 a[20:23], v9 offset:5120
    v_xor_b32 v36, v36, v35
    v_mfma_f32_16x16x32_bf16 v[248:251], a[72:75], a[60:63], v[248:251]
    ds_read_b64_tr_b16 a[72:73], v13 offset:1024
    v_lshlrev_b32 v36, 4, v36
    v_mfma_f32_16x16x32_bf16 v[140:143], a[76:79], a[32:35], v[140:143]
    ds_read_b64_tr_b16 a[74:75], v13 offset:1280
    v_lshl_add_u32 v36, v34, 11, v36
    v_mfma_f32_16x16x32_bf16 v[156:159], a[76:79], a[36:39], v[156:159]
    s_lshl_b32 s82, s60, 14
    v_mfma_f32_16x16x32_bf16 v[172:175], a[76:79], a[40:43], v[172:175]
    ds_read_b128 a[24:27], v9 offset:6144
    s_add_u32 s82, s82, 0
    v_mfma_f32_16x16x32_bf16 v[188:191], a[76:79], a[44:47], v[188:191]
    v_add_u32 v17, s82, v36
    v_mfma_f32_16x16x32_bf16 v[204:207], a[76:79], a[48:51], v[204:207]
    s_lshl_b32 s82, s62, 1
    v_mfma_f32_16x16x32_bf16 v[220:223], a[76:79], a[52:55], v[220:223]
    s_add_u32 s82, s82, 0
    v_mfma_f32_16x16x32_bf16 v[236:239], a[76:79], a[56:59], v[236:239]
    ds_read_b128 a[28:31], v9 offset:7168
    s_lshl_b32 s82, s82, 3
    v_mfma_f32_16x16x32_bf16 v[252:255], a[76:79], a[60:63], v[252:255]
    ds_read_b64_tr_b16 a[76:77], v15 offset:1024
    s_lshl_b32 s83, s61, 2
    v_mfma_f32_16x16x32_bf16 a[128:131], a[80:83], a[32:35], a[128:131]
    ds_read_b64_tr_b16 a[78:79], v15 offset:1280
    s_add_u32 s82, s82, s83
    v_mfma_f32_16x16x32_bf16 a[144:147], a[80:83], a[36:39], a[144:147]
    s_mul_i32 s83, s62, 96
    v_mfma_f32_16x16x32_bf16 a[160:163], a[80:83], a[40:43], a[160:163]
    ds_read_b64_tr_b16 a[96:97], v13 offset:4096
    s_add_u32 s82, s82, s83
    v_mfma_f32_16x16x32_bf16 a[176:179], a[80:83], a[44:47], a[176:179]
    s_lshl_b32 s82, s82, 11
    v_mfma_f32_16x16x32_bf16 a[192:195], a[80:83], a[48:51], a[192:195]
    s_sub_u32 s82, s82, 0
    v_mfma_f32_16x16x32_bf16 a[208:211], a[80:83], a[52:55], a[208:211]
    v_add_u32 v19, s82, v36
    v_mfma_f32_16x16x32_bf16 a[224:227], a[80:83], a[56:59], a[224:227]
    ds_read_b64_tr_b16 a[98:99], v13 offset:4352
    v_lshlrev_b32 v36, 1, v34
    v_mfma_f32_16x16x32_bf16 a[240:243], a[80:83], a[60:63], a[240:243]
    ds_read_b64_tr_b16 a[80:81], v13 offset:2048
    v_add_u32 v36, 8, v36
    v_mfma_f32_16x16x32_bf16 a[132:135], a[84:87], a[32:35], a[132:135]
    ds_read_b64_tr_b16 a[82:83], v13 offset:2304
    v_xor_b32 v36, v36, v35
    v_mfma_f32_16x16x32_bf16 a[148:151], a[84:87], a[36:39], a[148:151]
    v_lshlrev_b32 v36, 4, v36
    v_mfma_f32_16x16x32_bf16 a[164:167], a[84:87], a[40:43], a[164:167]
    ds_read_b64_tr_b16 a[100:101], v15 offset:4096
    v_lshl_add_u32 v36, v34, 11, v36
    v_mfma_f32_16x16x32_bf16 a[180:183], a[84:87], a[44:47], a[180:183]
    s_lshl_b32 s82, s60, 14
    v_mfma_f32_16x16x32_bf16 a[196:199], a[84:87], a[48:51], a[196:199]
    s_add_u32 s82, s82, 7168
    v_mfma_f32_16x16x32_bf16 a[212:215], a[84:87], a[52:55], a[212:215]
    v_add_u32 v18, s82, v36
    v_mfma_f32_16x16x32_bf16 a[228:231], a[84:87], a[56:59], a[228:231]
    ds_read_b64_tr_b16 a[102:103], v15 offset:4352
    s_lshl_b32 s82, s62, 1
    v_mfma_f32_16x16x32_bf16 a[244:247], a[84:87], a[60:63], a[244:247]
    ds_read_b64_tr_b16 a[84:85], v15 offset:2048
    s_add_u32 s82, s82, 1
    v_mfma_f32_16x16x32_bf16 a[136:139], a[88:91], a[32:35], a[136:139]
    ds_read_b64_tr_b16 a[86:87], v15 offset:2304
    s_lshl_b32 s82, s82, 3
    v_mfma_f32_16x16x32_bf16 a[152:155], a[88:91], a[36:39], a[152:155]
    s_lshl_b32 s83, s61, 2
    v_mfma_f32_16x16x32_bf16 a[168:171], a[88:91], a[40:43], a[168:171]
    s_add_u32 s82, s82, s83
    v_mfma_f32_16x16x32_bf16 a[184:187], a[88:91], a[44:47], a[184:187]
    s_mul_i32 s83, s62, 96
    v_mfma_f32_16x16x32_bf16 a[200:203], a[88:91], a[48:51], a[200:203]
    s_add_u32 s82, s82, s83
    v_mfma_f32_16x16x32_bf16 a[216:219], a[88:91], a[52:55], a[216:219]
    s_lshl_b32 s82, s82, 11
    v_mfma_f32_16x16x32_bf16 a[232:235], a[88:91], a[56:59], a[232:235]
    s_sub_u32 s82, s82, 1024
    v_mfma_f32_16x16x32_bf16 a[248:251], a[88:91], a[60:63], a[248:251]
    ds_read_b64_tr_b16 a[88:89], v13 offset:3072
    v_add_u32 v20, s82, v36
    v_mfma_f32_16x16x32_bf16 a[140:143], a[92:95], a[32:35], a[140:143]
    ds_read_b64_tr_b16 a[90:91], v13 offset:3328
    s_xor_b32 s82, s65, 0
    v_mfma_f32_16x16x32_bf16 a[156:159], a[92:95], a[36:39], a[156:159]
    s_lshl_b32 s82, s82, 10
    v_mfma_f32_16x16x32_bf16 a[172:175], a[92:95], a[40:43], a[172:175]
    v_add_u32 v21, s82, v16
    v_mfma_f32_16x16x32_bf16 a[188:191], a[92:95], a[44:47], a[188:191]
    s_xor_b32 s82, s65, 1
    v_mfma_f32_16x16x32_bf16 a[204:207], a[92:95], a[48:51], a[204:207]
    s_lshl_b32 s82, s82, 10
    v_mfma_f32_16x16x32_bf16 a[220:223], a[92:95], a[52:55], a[220:223]
    v_add_u32 v22, s82, v16
    v_mfma_f32_16x16x32_bf16 a[236:239], a[92:95], a[56:59], a[236:239]
    s_xor_b32 s82, s65, 2
    v_mfma_f32_16x16x32_bf16 a[252:255], a[92:95], a[60:63], a[252:255]
    ds_read_b64_tr_b16 a[92:93], v15 offset:3072
    s_lshl_b32 s82, s82, 10
    v_mfma_f32_16x16x32_bf16 v[48:51], a[104:107], a[32:35], v[48:51]
    ds_read_b64_tr_b16 a[94:95], v15 offset:3328
    v_add_u32 v23, s82, v16
    v_mfma_f32_16x16x32_bf16 v[52:55], a[104:107], a[36:39], v[52:55]
    s_xor_b32 s82, s65, 3
    v_mfma_f32_16x16x32_bf16 v[64:67], a[104:107], a[40:43], v[64:67]
    s_lshl_b32 s82, s82, 10
    v_mfma_f32_16x16x32_bf16 v[68:71], a[104:107], a[44:47], v[68:71]
    v_add_u32 v24, s82, v16
    v_mfma_f32_16x16x32_bf16 v[80:83], a[104:107], a[48:51], v[80:83]
    s_mov_b32 s94, 0xbdd2d3e8
    v_mfma_f32_16x16x32_bf16 v[84:87], a[104:107], a[52:55], v[84:87]
    v_mfma_f32_16x16x32_bf16 v[96:99], a[104:107], a[56:59], v[96:99]
    v_mfma_f32_16x16x32_bf16 v[100:103], a[104:107], a[60:63], v[100:103]
    v_mfma_f32_16x16x32_bf16 v[56:59], a[108:111], a[32:35], v[56:59]
    v_mfma_f32_16x16x32_bf16 v[60:63], a[108:111], a[36:39], v[60:63]
    v_mfma_f32_16x16x32_bf16 v[72:75], a[108:111], a[40:43], v[72:75]
    v_mfma_f32_16x16x32_bf16 v[76:79], a[108:111], a[44:47], v[76:79]
    v_mfma_f32_16x16x32_bf16 v[88:91], a[108:111], a[48:51], v[88:91]
    v_mfma_f32_16x16x32_bf16 v[92:95], a[108:111], a[52:55], v[92:95]
    v_mfma_f32_16x16x32_bf16 v[104:107], a[108:111], a[56:59], v[104:107]
    v_mfma_f32_16x16x32_bf16 v[108:111], a[108:111], a[60:63], v[108:111]
    s_waitcnt vmcnt(3) lgkmcnt(0)
    s_barrier
    v_mfma_f32_16x16x32_bf16 v[128:131], a[64:67], a[0:3], v[128:131]
    v_mfma_f32_16x16x32_bf16 v[144:147], a[64:67], a[4:7], v[144:147]
    v_mfma_f32_16x16x32_bf16 v[160:163], a[64:67], a[8:11], v[160:163]
    ds_read_b128 a[32:35], v9 offset:38912
    v_mfma_f32_16x16x32_bf16 v[176:179], a[64:67], a[12:15], v[176:179]
    v_mfma_f32_16x16x32_bf16 v[192:195], a[64:67], a[16:19], v[192:195]
    s_mov_b32 s95, 0xbdd2d3e8
    v_mfma_f32_16x16x32_bf16 v[208:211], a[64:67], a[20:23], v[208:211]
    v_mov_b32 v26, 0xc0135761
    v_mfma_f32_16x16x32_bf16 v[224:227], a[64:67], a[24:27], v[224:227]
    ds_read_b128 a[36:39], v9 offset:39936
    v_mov_b32 v27, 0xc0135761
    v_mfma_f32_16x16x32_bf16 v[240:243], a[64:67], a[28:31], v[240:243]
    ds_read_b64_tr_b16 a[64:65], v13 offset:38912
    v_mov_b32 v25, 1
    v_mfma_f32_16x16x32_bf16 v[132:135], a[68:71], a[0:3], v[132:135]
    ds_read_b64_tr_b16 a[66:67], v13 offset:39168
    s_lshl_b32 s82, s60, 12
    v_mfma_f32_16x16x32_bf16 v[148:151], a[68:71], a[4:7], v[148:151]
    s_add_u32 s68, s88, s82
    v_mfma_f32_16x16x32_bf16 v[164:167], a[68:71], a[8:11], v[164:167]
    ds_read_b128 a[40:43], v9 offset:40960
    s_lshl_b32 s82, s61, 13
    v_mfma_f32_16x16x32_bf16 v[180:183], a[68:71], a[12:15], v[180:183]
    s_add_u32 s88, s88, s82
    v_mfma_f32_16x16x32_bf16 v[196:199], a[68:71], a[16:19], v[196:199]
    s_lshr_b32 s82, s66, 1
    v_mfma_f32_16x16x32_bf16 v[212:215], a[68:71], a[20:23], v[212:215]
    s_add_u32 s82, s82, 24
    v_mfma_f32_16x16x32_bf16 v[228:231], a[68:71], a[24:27], v[228:231]
    ds_read_b128 a[44:47], v9 offset:41984
    s_lshl_b32 s82, s82, 14
    v_mfma_f32_16x16x32_bf16 v[244:247], a[68:71], a[28:31], v[244:247]
    ds_read_b64_tr_b16 a[68:69], v15 offset:38912
    s_add_u32 s90, s88, s82
    v_mfma_f32_16x16x32_bf16 v[136:139], a[72:75], a[0:3], v[136:139]
    ds_read_b64_tr_b16 a[70:71], v15 offset:39168
    s_lshl_b32 s82, s66, 14
    v_mfma_f32_16x16x32_bf16 v[152:155], a[72:75], a[4:7], v[152:155]
    s_add_u32 s88, s88, s82
    v_mfma_f32_16x16x32_bf16 v[168:171], a[72:75], a[8:11], v[168:171]
    ds_read_b128 a[48:51], v9 offset:43008
    s_add_u32 s89, s88, 262144
    v_mfma_f32_16x16x32_bf16 v[184:187], a[72:75], a[12:15], v[184:187]
    s_add_u32 s88, s88, 131072
    v_mfma_f32_16x16x32_bf16 v[200:203], a[72:75], a[16:19], v[200:203]
    s_mov_b32 s76, s93
    v_mfma_f32_16x16x32_bf16 v[216:219], a[72:75], a[20:23], v[216:219]
    s_lshl_b32 s82, s63, 4
    v_mfma_f32_16x16x32_bf16 v[232:235], a[72:75], a[24:27], v[232:235]
    ds_read_b128 a[52:55], v9 offset:44032
    s_lshl_b32 s83, s60, 2
    v_mfma_f32_16x16x32_bf16 v[248:251], a[72:75], a[28:31], v[248:251]
    ds_read_b64_tr_b16 a[72:73], v13 offset:39936
    s_add_u32 s83, s83, s82
    v_mfma_f32_16x16x32_bf16 v[140:143], a[76:79], a[0:3], v[140:143]
    ds_read_b64_tr_b16 a[74:75], v13 offset:40192
    s_add_u32 s83, s83, s65
    v_mfma_f32_16x16x32_bf16 v[156:159], a[76:79], a[4:7], v[156:159]
    s_lshl_b32 s83, s83, 15
    v_mfma_f32_16x16x32_bf16 v[172:175], a[76:79], a[8:11], v[172:175]
    ds_read_b128 a[56:59], v9 offset:45056
    s_add_u32 s69, s83, 4194304
    v_mfma_f32_16x16x32_bf16 v[188:191], a[76:79], a[12:15], v[188:191]
    s_lshl_b32 s84, s63, 3
    v_mfma_f32_16x16x32_bf16 v[204:207], a[76:79], a[16:19], v[204:207]
    s_add_u32 s84, s84, s66
    v_mfma_f32_16x16x32_bf16 v[220:223], a[76:79], a[20:23], v[220:223]
    s_lshl_b32 s85, s84, 2
    v_mfma_f32_16x16x32_bf16 v[236:239], a[76:79], a[24:27], v[236:239]
    ds_read_b128 a[60:63], v9 offset:46080
    s_add_u32 s85, s85, s60
    v_mfma_f32_16x16x32_bf16 v[252:255], a[76:79], a[28:31], v[252:255]
    ds_read_b64_tr_b16 a[76:77], v15 offset:39936
    s_lshl_b32 s85, s85, 8
    v_mfma_f32_16x16x32_bf16 a[128:131], a[80:83], a[0:3], a[128:131]
    ds_read_b64_tr_b16 a[78:79], v15 offset:40192
    s_add_u32 s77, s85, 39862272
    v_mfma_f32_16x16x32_bf16 a[144:147], a[80:83], a[4:7], a[144:147]
    s_lshl_b32 s84, s84, 18
    v_mfma_f32_16x16x32_bf16 a[160:163], a[80:83], a[8:11], a[160:163]
    ds_read_b64_tr_b16 a[104:105], v13 offset:43008
    s_lshl_b32 s85, s60, 12
    v_mfma_f32_16x16x32_bf16 a[176:179], a[80:83], a[12:15], a[176:179]
    s_add_u32 s84, s84, s85
    v_mfma_f32_16x16x32_bf16 a[192:195], a[80:83], a[16:19], a[192:195]
    s_add_u32 s84, s84, 23068672
    v_mfma_f32_16x16x32_bf16 a[208:211], a[80:83], a[20:23], a[208:211]
    s_xor_b32 s85, s65, 1
    v_mfma_f32_16x16x32_bf16 a[224:227], a[80:83], a[24:27], a[224:227]
    ds_read_b64_tr_b16 a[106:107], v13 offset:43264
    s_lshl_b32 s85, s85, 16
    v_mfma_f32_16x16x32_bf16 a[240:243], a[80:83], a[28:31], a[240:243]
    ds_read_b64_tr_b16 a[80:81], v13 offset:40960
    s_add_u32 s70, s84, s85
    v_mfma_f32_16x16x32_bf16 a[132:135], a[84:87], a[0:3], a[132:135]
    ds_read_b64_tr_b16 a[82:83], v13 offset:41216
    s_add_u32 s70, s70, 16384
    v_mfma_f32_16x16x32_bf16 a[148:151], a[84:87], a[4:7], a[148:151]
    s_lshl_b32 s85, s65, 16
    v_mfma_f32_16x16x32_bf16 a[164:167], a[84:87], a[8:11], a[164:167]
    ds_read_b64_tr_b16 a[108:109], v15 offset:43008
    s_add_u32 s73, s84, s85
    v_mfma_f32_16x16x32_bf16 a[180:183], a[84:87], a[12:15], a[180:183]
    s_add_u32 s73, s73, 16384
    v_mfma_f32_16x16x32_bf16 a[196:199], a[84:87], a[16:19], a[196:199]
    s_xor_b32 s85, s65, 2
    v_mfma_f32_16x16x32_bf16 a[212:215], a[84:87], a[20:23], a[212:215]
    s_lshl_b32 s85, s85, 16
    v_mfma_f32_16x16x32_bf16 a[228:231], a[84:87], a[24:27], a[228:231]
    ds_read_b64_tr_b16 a[110:111], v15 offset:43264
    s_add_u32 s71, s84, s85
    v_mfma_f32_16x16x32_bf16 a[244:247], a[84:87], a[28:31], a[244:247]
    ds_read_b64_tr_b16 a[84:85], v15 offset:40960
    s_add_u32 s71, s71, 32768
    v_mfma_f32_16x16x32_bf16 a[136:139], a[88:91], a[0:3], a[136:139]
    ds_read_b64_tr_b16 a[86:87], v15 offset:41216
    s_lshl_b32 s85, s65, 16
    v_mfma_f32_16x16x32_bf16 a[152:155], a[88:91], a[4:7], a[152:155]
    s_add_u32 s74, s84, s85
    v_mfma_f32_16x16x32_bf16 a[168:171], a[88:91], a[8:11], a[168:171]
    s_add_u32 s74, s74, 32768
    v_mfma_f32_16x16x32_bf16 a[184:187], a[88:91], a[12:15], a[184:187]
    s_xor_b32 s85, s65, 3
    v_mfma_f32_16x16x32_bf16 a[200:203], a[88:91], a[16:19], a[200:203]
    s_lshl_b32 s85, s85, 16
    v_mfma_f32_16x16x32_bf16 a[216:219], a[88:91], a[20:23], a[216:219]
    s_add_u32 s72, s84, s85
    v_mfma_f32_16x16x32_bf16 a[232:235], a[88:91], a[24:27], a[232:235]
    s_add_u32 s72, s72, 49152
    v_mfma_f32_16x16x32_bf16 a[248:251], a[88:91], a[28:31], a[248:251]
    ds_read_b64_tr_b16 a[88:89], v13 offset:41984
    s_lshl_b32 s85, s65, 16
    v_mfma_f32_16x16x32_bf16 a[140:143], a[92:95], a[0:3], a[140:143]
    ds_read_b64_tr_b16 a[90:91], v13 offset:42240
    s_add_u32 s75, s84, s85
    v_mfma_f32_16x16x32_bf16 a[156:159], a[92:95], a[4:7], a[156:159]
    s_add_u32 s75, s75, 49152
    v_mfma_f32_16x16x32_bf16 a[172:175], a[92:95], a[8:11], a[172:175]
    v_and_b32 v36, 1, v34
    v_mfma_f32_16x16x32_bf16 a[188:191], a[92:95], a[12:15], a[188:191]
    v_lshlrev_b32 v36, 10, v36
    v_mfma_f32_16x16x32_bf16 a[204:207], a[92:95], a[16:19], a[204:207]
    v_lshrrev_b32 v34, 1, v34
    v_mfma_f32_16x16x32_bf16 a[220:223], a[92:95], a[20:23], a[220:223]
    v_lshl_add_u32 v36, v34, 8, v36
    v_mfma_f32_16x16x32_bf16 a[236:239], a[92:95], a[24:27], a[236:239]
    v_lshl_add_u32 v36, v35, 4, v36
    v_mfma_f32_16x16x32_bf16 a[252:255], a[92:95], a[28:31], a[252:255]
    ds_read_b64_tr_b16 a[92:93], v15 offset:41984
    s_and_b32 s82, s66, 1
    v_mfma_f32_16x16x32_bf16 v[48:51], a[96:99], a[0:3], v[48:51]
    ds_read_b64_tr_b16 a[94:95], v15 offset:42240
    s_lshl_b32 s82, s82, 9
    v_mfma_f32_16x16x32_bf16 v[52:55], a[96:99], a[4:7], v[52:55]
    v_add_u32 v28, s82, v36
    v_mfma_f32_16x16x32_bf16 v[64:67], a[96:99], a[8:11], v[64:67]
    v_mov_b32 v29, 0x100
    v_mfma_f32_16x16x32_bf16 v[68:71], a[96:99], a[12:15], v[68:71]
    v_mov_b32 v42, 0x10000
    v_mfma_f32_16x16x32_bf16 v[80:83], a[96:99], a[16:19], v[80:83]
    s_mov_b32 s93, s92
    v_mfma_f32_16x16x32_bf16 v[84:87], a[96:99], a[20:23], v[84:87]
    v_mfma_f32_16x16x32_bf16 v[96:99], a[96:99], a[24:27], v[96:99]
    v_mfma_f32_16x16x32_bf16 v[100:103], a[96:99], a[28:31], v[100:103]
    v_mfma_f32_16x16x32_bf16 v[56:59], a[100:103], a[0:3], v[56:59]
    v_mfma_f32_16x16x32_bf16 v[60:63], a[100:103], a[4:7], v[60:63]
    v_mfma_f32_16x16x32_bf16 v[72:75], a[100:103], a[8:11], v[72:75]
    v_mfma_f32_16x16x32_bf16 v[76:79], a[100:103], a[12:15], v[76:79]
    v_mfma_f32_16x16x32_bf16 v[88:91], a[100:103], a[16:19], v[88:91]
    v_mfma_f32_16x16x32_bf16 v[92:95], a[100:103], a[20:23], v[92:95]
    v_mfma_f32_16x16x32_bf16 v[104:107], a[100:103], a[24:27], v[104:107]
    v_mfma_f32_16x16x32_bf16 v[108:111], a[100:103], a[28:31], v[108:111]
    s_waitcnt lgkmcnt(0)
    s_barrier
    v_mfma_f32_16x16x32_bf16 v[128:131], a[64:67], a[32:35], v[128:131]
    v_mfma_f32_16x16x32_bf16 v[144:147], a[64:67], a[36:39], v[144:147]
    v_mfma_f32_16x16x32_bf16 v[160:163], a[64:67], a[40:43], v[160:163]
    s_mov_b32 s82, 0
    s_add_u32 m0, s3, 0
    v_mfma_f32_16x16x32_bf16 v[176:179], a[64:67], a[44:47], v[176:179]
    buffer_load_dwordx4 v17, s[48:51], s82 offen lds
    v_mfma_f32_16x16x32_bf16 v[192:195], a[64:67], a[48:51], v[192:195]
    v_mfma_f32_16x16x32_bf16 v[208:211], a[64:67], a[52:55], v[208:211]
    v_mfma_f32_16x16x32_bf16 v[224:227], a[64:67], a[56:59], v[224:227]
    v_mfma_f32_16x16x32_bf16 v[240:243], a[64:67], a[60:63], v[240:243]
    buffer_load_dwordx4 v18, s[48:51], s82 offen offset:1024 lds
    v_mfma_f32_16x16x32_bf16 v[132:135], a[68:71], a[32:35], v[132:135]
    v_mfma_f32_16x16x32_bf16 v[148:151], a[68:71], a[36:39], v[148:151]
    v_mfma_f32_16x16x32_bf16 v[164:167], a[68:71], a[40:43], v[164:167]
    v_mfma_f32_16x16x32_bf16 v[180:183], a[68:71], a[44:47], v[180:183]
    s_mov_b32 s83, 229376
    s_add_u32 m0, s3, 8192
    v_mfma_f32_16x16x32_bf16 v[196:199], a[68:71], a[48:51], v[196:199]
    buffer_load_dwordx4 v17, s[48:51], s83 offen lds
    v_mfma_f32_16x16x32_bf16 v[212:215], a[68:71], a[52:55], v[212:215]
    v_mfma_f32_16x16x32_bf16 v[228:231], a[68:71], a[56:59], v[228:231]
    v_mfma_f32_16x16x32_bf16 v[244:247], a[68:71], a[60:63], v[244:247]
    v_mfma_f32_16x16x32_bf16 v[136:139], a[72:75], a[32:35], v[136:139]
    buffer_load_dwordx4 v18, s[48:51], s83 offen offset:1024 lds
    v_mfma_f32_16x16x32_bf16 v[152:155], a[72:75], a[36:39], v[152:155]
    v_mfma_f32_16x16x32_bf16 v[168:171], a[72:75], a[40:43], v[168:171]
    v_mfma_f32_16x16x32_bf16 v[184:187], a[72:75], a[44:47], v[184:187]
    v_mfma_f32_16x16x32_bf16 v[200:203], a[72:75], a[48:51], v[200:203]
    s_mov_b32 s82, 458752
    s_add_u32 m0, s3, 16384
    v_mfma_f32_16x16x32_bf16 v[216:219], a[72:75], a[52:55], v[216:219]
    buffer_load_dwordx4 v17, s[48:51], s82 offen lds
    v_mfma_f32_16x16x32_bf16 v[232:235], a[72:75], a[56:59], v[232:235]
    v_mfma_f32_16x16x32_bf16 v[248:251], a[72:75], a[60:63], v[248:251]
    v_mfma_f32_16x16x32_bf16 v[140:143], a[76:79], a[32:35], v[140:143]
    v_mfma_f32_16x16x32_bf16 v[156:159], a[76:79], a[36:39], v[156:159]
    buffer_load_dwordx4 v18, s[48:51], s82 offen offset:1024 lds
    v_mfma_f32_16x16x32_bf16 v[172:175], a[76:79], a[40:43], v[172:175]
    v_mfma_f32_16x16x32_bf16 v[188:191], a[76:79], a[44:47], v[188:191]
    v_mfma_f32_16x16x32_bf16 v[204:207], a[76:79], a[48:51], v[204:207]
    v_mfma_f32_16x16x32_bf16 v[220:223], a[76:79], a[52:55], v[220:223]
    s_mov_b32 s83, 688128
    s_add_u32 m0, s3, 24576
    v_mfma_f32_16x16x32_bf16 v[236:239], a[76:79], a[56:59], v[236:239]
    buffer_load_dwordx4 v17, s[48:51], s83 offen lds
    v_mfma_f32_16x16x32_bf16 v[252:255], a[76:79], a[60:63], v[252:255]
    v_mfma_f32_16x16x32_bf16 a[128:131], a[80:83], a[32:35], a[128:131]
    v_mfma_f32_16x16x32_bf16 a[144:147], a[80:83], a[36:39], a[144:147]
    v_mfma_f32_16x16x32_bf16 a[160:163], a[80:83], a[40:43], a[160:163]
    buffer_load_dwordx4 v18, s[48:51], s83 offen offset:1024 lds
    v_mfma_f32_16x16x32_bf16 a[176:179], a[80:83], a[44:47], a[176:179]
    v_mfma_f32_16x16x32_bf16 a[192:195], a[80:83], a[48:51], a[192:195]
    v_mfma_f32_16x16x32_bf16 a[208:211], a[80:83], a[52:55], a[208:211]
    v_mfma_f32_16x16x32_bf16 a[224:227], a[80:83], a[56:59], a[224:227]
    s_mov_b32 s82, 917504
    s_add_u32 m0, s3, 32768
    v_mfma_f32_16x16x32_bf16 a[240:243], a[80:83], a[60:63], a[240:243]
    buffer_load_dwordx4 v17, s[48:51], s82 offen lds
    v_mfma_f32_16x16x32_bf16 a[132:135], a[84:87], a[32:35], a[132:135]
    v_mfma_f32_16x16x32_bf16 a[148:151], a[84:87], a[36:39], a[148:151]
    v_mfma_f32_16x16x32_bf16 a[164:167], a[84:87], a[40:43], a[164:167]
    v_mfma_f32_16x16x32_bf16 a[180:183], a[84:87], a[44:47], a[180:183]
    buffer_load_dwordx4 v18, s[48:51], s82 offen offset:1024 lds
    v_mfma_f32_16x16x32_bf16 a[196:199], a[84:87], a[48:51], a[196:199]
    v_mfma_f32_16x16x32_bf16 a[212:215], a[84:87], a[52:55], a[212:215]
    v_mfma_f32_16x16x32_bf16 a[228:231], a[84:87], a[56:59], a[228:231]
    v_mfma_f32_16x16x32_bf16 a[244:247], a[84:87], a[60:63], a[244:247]
    s_mov_b32 s83, 1146880
    s_add_u32 m0, s3, 40960
    v_mfma_f32_16x16x32_bf16 a[136:139], a[88:91], a[32:35], a[136:139]
    buffer_load_dwordx4 v17, s[48:51], s83 offen lds
    v_mfma_f32_16x16x32_bf16 a[152:155], a[88:91], a[36:39], a[152:155]
    v_mfma_f32_16x16x32_bf16 a[168:171], a[88:91], a[40:43], a[168:171]
    v_mfma_f32_16x16x32_bf16 a[184:187], a[88:91], a[44:47], a[184:187]
    v_mfma_f32_16x16x32_bf16 a[200:203], a[88:91], a[48:51], a[200:203]
    buffer_load_dwordx4 v18, s[48:51], s83 offen offset:1024 lds
    v_mfma_f32_16x16x32_bf16 a[216:219], a[88:91], a[52:55], a[216:219]
    v_mfma_f32_16x16x32_bf16 a[232:235], a[88:91], a[56:59], a[232:235]
    v_mfma_f32_16x16x32_bf16 a[248:251], a[88:91], a[60:63], a[248:251]
    v_mfma_f32_16x16x32_bf16 a[140:143], a[92:95], a[32:35], a[140:143]
    s_mov_b32 s82, 1376256
    s_add_u32 m0, s3, 49152
    v_mfma_f32_16x16x32_bf16 a[156:159], a[92:95], a[36:39], a[156:159]
    buffer_load_dwordx4 v17, s[48:51], s82 offen lds
    v_mfma_f32_16x16x32_bf16 a[172:175], a[92:95], a[40:43], a[172:175]
    v_mfma_f32_16x16x32_bf16 a[188:191], a[92:95], a[44:47], a[188:191]
    v_mfma_f32_16x16x32_bf16 a[204:207], a[92:95], a[48:51], a[204:207]
    v_mfma_f32_16x16x32_bf16 a[220:223], a[92:95], a[52:55], a[220:223]
    buffer_load_dwordx4 v18, s[48:51], s82 offen offset:1024 lds
    v_mfma_f32_16x16x32_bf16 a[236:239], a[92:95], a[56:59], a[236:239]
    v_mfma_f32_16x16x32_bf16 a[252:255], a[92:95], a[60:63], a[252:255]
    v_mfma_f32_16x16x32_bf16 v[48:51], a[104:107], a[32:35], v[48:51]
    v_mfma_f32_16x16x32_bf16 v[52:55], a[104:107], a[36:39], v[52:55]
    s_mov_b32 s83, 1605632
    s_add_u32 m0, s3, 57344
    v_mfma_f32_16x16x32_bf16 v[64:67], a[104:107], a[40:43], v[64:67]
    buffer_load_dwordx4 v17, s[48:51], s83 offen lds
    v_mfma_f32_16x16x32_bf16 v[68:71], a[104:107], a[44:47], v[68:71]
    v_mfma_f32_16x16x32_bf16 v[80:83], a[104:107], a[48:51], v[80:83]
    v_mfma_f32_16x16x32_bf16 v[84:87], a[104:107], a[52:55], v[84:87]
    v_mfma_f32_16x16x32_bf16 v[96:99], a[104:107], a[56:59], v[96:99]
    buffer_load_dwordx4 v18, s[48:51], s83 offen offset:1024 lds
    v_mfma_f32_16x16x32_bf16 v[100:103], a[104:107], a[60:63], v[100:103]
    v_mfma_f32_16x16x32_bf16 v[56:59], a[108:111], a[32:35], v[56:59]
    v_mfma_f32_16x16x32_bf16 v[60:63], a[108:111], a[36:39], v[60:63]
    v_mfma_f32_16x16x32_bf16 v[72:75], a[108:111], a[40:43], v[72:75]
    v_mfma_f32_16x16x32_bf16 v[76:79], a[108:111], a[44:47], v[76:79]
    v_mfma_f32_16x16x32_bf16 v[88:91], a[108:111], a[48:51], v[88:91]
    v_mfma_f32_16x16x32_bf16 v[92:95], a[108:111], a[52:55], v[92:95]
    v_mfma_f32_16x16x32_bf16 v[104:107], a[108:111], a[56:59], v[104:107]
    v_mfma_f32_16x16x32_bf16 v[108:111], a[108:111], a[60:63], v[108:111]
L_epi:
    v_pk_mul_f32 v[34:35], v[128:129], v[128:129]
    v_pk_mul_f32 v[36:37], v[130:131], v[130:131]
    v_pk_mul_f32 v[38:39], v[132:133], v[132:133]
    v_pk_mul_f32 v[40:41], v[134:135], v[134:135]
    v_pk_fma_f32 v[34:35], v[34:35], s[94:95], v[26:27]
    v_pk_fma_f32 v[36:37], v[36:37], s[94:95], v[26:27]
    v_pk_fma_f32 v[38:39], v[38:39], s[94:95], v[26:27]
    v_pk_fma_f32 v[40:41], v[40:41], s[94:95], v[26:27]
    v_pk_mul_f32 v[34:35], v[34:35], v[128:129]
    v_pk_mul_f32 v[36:37], v[36:37], v[130:131]
    v_pk_mul_f32 v[38:39], v[38:39], v[132:133]
    v_pk_mul_f32 v[40:41], v[40:41], v[134:135]
    v_exp_f32 v34, v34
    v_exp_f32 v35, v35
    v_exp_f32 v36, v36
    v_exp_f32 v37, v37
    v_exp_f32 v38, v38
    v_exp_f32 v39, v39
    v_exp_f32 v40, v40
    v_exp_f32 v41, v41
    v_pk_mul_f32 v[136:137], v[136:137], v[128:129]
    v_pk_mul_f32 v[138:139], v[138:139], v[130:131]
    v_pk_mul_f32 v[140:141], v[140:141], v[132:133]
    v_pk_mul_f32 v[142:143], v[142:143], v[134:135]
    v_pk_add_f32 v[34:35], v[34:35], 1.0 op_sel_hi:[1,0]
    v_pk_add_f32 v[36:37], v[36:37], 1.0 op_sel_hi:[1,0]
    v_pk_add_f32 v[38:39], v[38:39], 1.0 op_sel_hi:[1,0]
    v_pk_add_f32 v[40:41], v[40:41], 1.0 op_sel_hi:[1,0]
    v_rcp_f32 v34, v34
    v_rcp_f32 v35, v35
    v_rcp_f32 v36, v36
    v_rcp_f32 v37, v37
    v_rcp_f32 v38, v38
    v_rcp_f32 v39, v39
    v_rcp_f32 v40, v40
    v_rcp_f32 v41, v41
    v_pk_mul_f32 v[136:137], v[136:137], v[34:35]
    v_pk_mul_f32 v[138:139], v[138:139], v[36:37]
    v_pk_mul_f32 v[140:141], v[140:141], v[38:39]
    v_pk_mul_f32 v[142:143], v[142:143], v[40:41]
    v_cvt_pk_bf16_f32 v128, v136, v137
    v_cvt_pk_bf16_f32 v129, v138, v139
    v_cvt_pk_bf16_f32 v130, v140, v141
    v_cvt_pk_bf16_f32 v131, v142, v143
    buffer_store_dwordx4 v[128:131], v16, s[56:59], s88 offen offset:0 sc1
    v_pk_mul_f32 v[34:35], v[144:145], v[144:145]
    v_pk_mul_f32 v[36:37], v[146:147], v[146:147]
    v_pk_mul_f32 v[38:39], v[148:149], v[148:149]
    v_pk_mul_f32 v[40:41], v[150:151], v[150:151]
    v_pk_fma_f32 v[34:35], v[34:35], s[94:95], v[26:27]
    v_pk_fma_f32 v[36:37], v[36:37], s[94:95], v[26:27]
    v_pk_fma_f32 v[38:39], v[38:39], s[94:95], v[26:27]
    v_pk_fma_f32 v[40:41], v[40:41], s[94:95], v[26:27]
    v_pk_mul_f32 v[34:35], v[34:35], v[144:145]
    v_pk_mul_f32 v[36:37], v[36:37], v[146:147]
    v_pk_mul_f32 v[38:39], v[38:39], v[148:149]
    v_pk_mul_f32 v[40:41], v[40:41], v[150:151]
    v_exp_f32 v34, v34
    v_exp_f32 v35, v35
    v_exp_f32 v36, v36
    v_exp_f32 v37, v37
    v_exp_f32 v38, v38
    v_exp_f32 v39, v39
    v_exp_f32 v40, v40
    v_exp_f32 v41, v41
    v_pk_mul_f32 v[152:153], v[152:153], v[144:145]
    v_pk_mul_f32 v[154:155], v[154:155], v[146:147]
    v_pk_mul_f32 v[156:157], v[156:157], v[148:149]
    v_pk_mul_f32 v[158:159], v[158:159], v[150:151]
    v_pk_add_f32 v[34:35], v[34:35], 1.0 op_sel_hi:[1,0]
    v_pk_add_f32 v[36:37], v[36:37], 1.0 op_sel_hi:[1,0]
    v_pk_add_f32 v[38:39], v[38:39], 1.0 op_sel_hi:[1,0]
    v_pk_add_f32 v[40:41], v[40:41], 1.0 op_sel_hi:[1,0]
    v_rcp_f32 v34, v34
    v_rcp_f32 v35, v35
    v_rcp_f32 v36, v36
    v_rcp_f32 v37, v37
    v_rcp_f32 v38, v38
    v_rcp_f32 v39, v39
    v_rcp_f32 v40, v40
    v_rcp_f32 v41, v41
    v_pk_mul_f32 v[152:153], v[152:153], v[34:35]
    v_pk_mul_f32 v[154:155], v[154:155], v[36:37]
    v_pk_mul_f32 v[156:157], v[156:157], v[38:39]
    v_pk_mul_f32 v[158:159], v[158:159], v[40:41]
    v_cvt_pk_bf16_f32 v144, v152, v153
    v_cvt_pk_bf16_f32 v145, v154, v155
    v_cvt_pk_bf16_f32 v146, v156, v157
    v_cvt_pk_bf16_f32 v147, v158, v159
    buffer_store_dwordx4 v[144:147], v16, s[56:59], s88 offen offset:1024 sc1
    v_pk_mul_f32 v[34:35], v[160:161], v[160:161]
    v_pk_mul_f32 v[36:37], v[162:163], v[162:163]
    v_pk_mul_f32 v[38:39], v[164:165], v[164:165]
    v_pk_mul_f32 v[40:41], v[166:167], v[166:167]
    v_pk_fma_f32 v[34:35], v[34:35], s[94:95], v[26:27]
    v_pk_fma_f32 v[36:37], v[36:37], s[94:95], v[26:27]
    v_pk_fma_f32 v[38:39], v[38:39], s[94:95], v[26:27]
    v_pk_fma_f32 v[40:41], v[40:41], s[94:95], v[26:27]
    v_pk_mul_f32 v[34:35], v[34:35], v[160:161]
    v_pk_mul_f32 v[36:37], v[36:37], v[162:163]
    v_pk_mul_f32 v[38:39], v[38:39], v[164:165]
    v_pk_mul_f32 v[40:41], v[40:41], v[166:167]
    v_exp_f32 v34, v34
    v_exp_f32 v35, v35
    v_exp_f32 v36, v36
    v_exp_f32 v37, v37
    v_exp_f32 v38, v38
    v_exp_f32 v39, v39
    v_exp_f32 v40, v40
    v_exp_f32 v41, v41
    v_pk_mul_f32 v[168:169], v[168:169], v[160:161]
    v_pk_mul_f32 v[170:171], v[170:171], v[162:163]
    v_pk_mul_f32 v[172:173], v[172:173], v[164:165]
    v_pk_mul_f32 v[174:175], v[174:175], v[166:167]
    v_pk_add_f32 v[34:35], v[34:35], 1.0 op_sel_hi:[1,0]
    v_pk_add_f32 v[36:37], v[36:37], 1.0 op_sel_hi:[1,0]
    v_pk_add_f32 v[38:39], v[38:39], 1.0 op_sel_hi:[1,0]
    v_pk_add_f32 v[40:41], v[40:41], 1.0 op_sel_hi:[1,0]
    v_rcp_f32 v34, v34
    v_rcp_f32 v35, v35
    v_rcp_f32 v36, v36
    v_rcp_f32 v37, v37
    v_rcp_f32 v38, v38
    v_rcp_f32 v39, v39
    v_rcp_f32 v40, v40
    v_rcp_f32 v41, v41
    v_pk_mul_f32 v[168:169], v[168:169], v[34:35]
    v_pk_mul_f32 v[170:171], v[170:171], v[36:37]
    v_pk_mul_f32 v[172:173], v[172:173], v[38:39]
    v_pk_mul_f32 v[174:175], v[174:175], v[40:41]
    v_cvt_pk_bf16_f32 v160, v168, v169
    v_cvt_pk_bf16_f32 v161, v170, v171
    v_cvt_pk_bf16_f32 v162, v172, v173
    v_cvt_pk_bf16_f32 v163, v174, v175
    buffer_store_dwordx4 v[160:163], v16, s[56:59], s88 offen offset:2048 sc1
    v_pk_mul_f32 v[34:35], v[176:177], v[176:177]
    v_pk_mul_f32 v[36:37], v[178:179], v[178:179]
    v_pk_mul_f32 v[38:39], v[180:181], v[180:181]
    v_pk_mul_f32 v[40:41], v[182:183], v[182:183]
    v_pk_fma_f32 v[34:35], v[34:35], s[94:95], v[26:27]
    v_pk_fma_f32 v[36:37], v[36:37], s[94:95], v[26:27]
    v_pk_fma_f32 v[38:39], v[38:39], s[94:95], v[26:27]
    v_pk_fma_f32 v[40:41], v[40:41], s[94:95], v[26:27]
    v_pk_mul_f32 v[34:35], v[34:35], v[176:177]
    v_pk_mul_f32 v[36:37], v[36:37], v[178:179]
    v_pk_mul_f32 v[38:39], v[38:39], v[180:181]
    v_pk_mul_f32 v[40:41], v[40:41], v[182:183]
    v_exp_f32 v34, v34
    v_exp_f32 v35, v35
    v_exp_f32 v36, v36
    v_exp_f32 v37, v37
    v_exp_f32 v38, v38
    v_exp_f32 v39, v39
    v_exp_f32 v40, v40
    v_exp_f32 v41, v41
    v_pk_mul_f32 v[184:185], v[184:185], v[176:177]
    v_pk_mul_f32 v[186:187], v[186:187], v[178:179]
    v_pk_mul_f32 v[188:189], v[188:189], v[180:181]
    v_pk_mul_f32 v[190:191], v[190:191], v[182:183]
    v_pk_add_f32 v[34:35], v[34:35], 1.0 op_sel_hi:[1,0]
    v_pk_add_f32 v[36:37], v[36:37], 1.0 op_sel_hi:[1,0]
    v_pk_add_f32 v[38:39], v[38:39], 1.0 op_sel_hi:[1,0]
    v_pk_add_f32 v[40:41], v[40:41], 1.0 op_sel_hi:[1,0]
    v_rcp_f32 v34, v34
    v_rcp_f32 v35, v35
    v_rcp_f32 v36, v36
    v_rcp_f32 v37, v37
    v_rcp_f32 v38, v38
    v_rcp_f32 v39, v39
    v_rcp_f32 v40, v40
    v_rcp_f32 v41, v41
    v_pk_mul_f32 v[184:185], v[184:185], v[34:35]
    v_pk_mul_f32 v[186:187], v[186:187], v[36:37]
    v_pk_mul_f32 v[188:189], v[188:189], v[38:39]
    v_pk_mul_f32 v[190:191], v[190:191], v[40:41]
    v_cvt_pk_bf16_f32 v176, v184, v185
    v_cvt_pk_bf16_f32 v177, v186, v187
    v_cvt_pk_bf16_f32 v178, v188, v189
    v_cvt_pk_bf16_f32 v179, v190, v191
    buffer_store_dwordx4 v[176:179], v16, s[56:59], s88 offen offset:3072 sc1
    v_pk_mul_f32 v[34:35], v[192:193], v[192:193]
    v_pk_mul_f32 v[36:37], v[194:195], v[194:195]
    v_pk_mul_f32 v[38:39], v[196:197], v[196:197]
    v_pk_mul_f32 v[40:41], v[198:199], v[198:199]
    v_pk_fma_f32 v[34:35], v[34:35], s[94:95], v[26:27]
    v_pk_fma_f32 v[36:37], v[36:37], s[94:95], v[26:27]
    v_pk_fma_f32 v[38:39], v[38:39], s[94:95], v[26:27]
    v_pk_fma_f32 v[40:41], v[40:41], s[94:95], v[26:27]
    v_pk_mul_f32 v[34:35], v[34:35], v[192:193]
    v_pk_mul_f32 v[36:37], v[36:37], v[194:195]
    v_pk_mul_f32 v[38:39], v[38:39], v[196:197]
    v_pk_mul_f32 v[40:41], v[40:41], v[198:199]
    v_exp_f32 v34, v34
    v_exp_f32 v35, v35
    v_exp_f32 v36, v36
    v_exp_f32 v37, v37
    v_exp_f32 v38, v38
    v_exp_f32 v39, v39
    v_exp_f32 v40, v40
    v_exp_f32 v41, v41
    v_pk_mul_f32 v[200:201], v[200:201], v[192:193]
    v_pk_mul_f32 v[202:203], v[202:203], v[194:195]
    v_pk_mul_f32 v[204:205], v[204:205], v[196:197]
    v_pk_mul_f32 v[206:207], v[206:207], v[198:199]
    v_pk_add_f32 v[34:35], v[34:35], 1.0 op_sel_hi:[1,0]
    v_pk_add_f32 v[36:37], v[36:37], 1.0 op_sel_hi:[1,0]
    v_pk_add_f32 v[38:39], v[38:39], 1.0 op_sel_hi:[1,0]
    v_pk_add_f32 v[40:41], v[40:41], 1.0 op_sel_hi:[1,0]
    v_rcp_f32 v34, v34
    v_rcp_f32 v35, v35
    v_rcp_f32 v36, v36
    v_rcp_f32 v37, v37
    v_rcp_f32 v38, v38
    v_rcp_f32 v39, v39
    v_rcp_f32 v40, v40
    v_rcp_f32 v41, v41
    v_pk_mul_f32 v[200:201], v[200:201], v[34:35]
    v_pk_mul_f32 v[202:203], v[202:203], v[36:37]
    v_pk_mul_f32 v[204:205], v[204:205], v[38:39]
    v_pk_mul_f32 v[206:207], v[206:207], v[40:41]
    v_cvt_pk_bf16_f32 v192, v200, v201
    v_cvt_pk_bf16_f32 v193, v202, v203
    v_cvt_pk_bf16_f32 v194, v204, v205
    v_cvt_pk_bf16_f32 v195, v206, v207
    s_add_u32 s88, s88, 4096
    buffer_store_dwordx4 v[192:195], v16, s[56:59], s88 offen offset:0 sc1
    v_pk_mul_f32 v[34:35], v[208:209], v[208:209]
    v_pk_mul_f32 v[36:37], v[210:211], v[210:211]
    v_pk_mul_f32 v[38:39], v[212:213], v[212:213]
    v_pk_mul_f32 v[40:41], v[214:215], v[214:215]
    v_pk_fma_f32 v[34:35], v[34:35], s[94:95], v[26:27]
    v_pk_fma_f32 v[36:37], v[36:37], s[94:95], v[26:27]
    v_pk_fma_f32 v[38:39], v[38:39], s[94:95], v[26:27]
    v_pk_fma_f32 v[40:41], v[40:41], s[94:95], v[26:27]
    v_pk_mul_f32 v[34:35], v[34:35], v[208:209]
    v_pk_mul_f32 v[36:37], v[36:37], v[210:211]
    v_pk_mul_f32 v[38:39], v[38:39], v[212:213]
    v_pk_mul_f32 v[40:41], v[40:41], v[214:215]
    v_exp_f32 v34, v34
    v_exp_f32 v35, v35
    v_exp_f32 v36, v36
    v_exp_f32 v37, v37
    v_exp_f32 v38, v38
    v_exp_f32 v39, v39
    v_exp_f32 v40, v40
    v_exp_f32 v41, v41
    v_pk_mul_f32 v[216:217], v[216:217], v[208:209]
    v_pk_mul_f32 v[218:219], v[218:219], v[210:211]
    v_pk_mul_f32 v[220:221], v[220:221], v[212:213]
    v_pk_mul_f32 v[222:223], v[222:223], v[214:215]
    v_pk_add_f32 v[34:35], v[34:35], 1.0 op_sel_hi:[1,0]
    v_pk_add_f32 v[36:37], v[36:37], 1.0 op_sel_hi:[1,0]
    v_pk_add_f32 v[38:39], v[38:39], 1.0 op_sel_hi:[1,0]
    v_pk_add_f32 v[40:41], v[40:41], 1.0 op_sel_hi:[1,0]
    v_rcp_f32 v34, v34
    v_rcp_f32 v35, v35
    v_rcp_f32 v36, v36
    v_rcp_f32 v37, v37
    v_rcp_f32 v38, v38
    v_rcp_f32 v39, v39
    v_rcp_f32 v40, v40
    v_rcp_f32 v41, v41
    v_pk_mul_f32 v[216:217], v[216:217], v[34:35]
    v_pk_mul_f32 v[218:219], v[218:219], v[36:37]
    v_pk_mul_f32 v[220:221], v[220:221], v[38:39]
    v_pk_mul_f32 v[222:223], v[222:223], v[40:41]
    v_cvt_pk_bf16_f32 v208, v216, v217
    v_cvt_pk_bf16_f32 v209, v218, v219
    v_cvt_pk_bf16_f32 v210, v220, v221
    v_cvt_pk_bf16_f32 v211, v222, v223
    buffer_store_dwordx4 v[208:211], v16, s[56:59], s88 offen offset:1024 sc1
    v_pk_mul_f32 v[34:35], v[224:225], v[224:225]
    v_pk_mul_f32 v[36:37], v[226:227], v[226:227]
    v_pk_mul_f32 v[38:39], v[228:229], v[228:229]
    v_pk_mul_f32 v[40:41], v[230:231], v[230:231]
    v_pk_fma_f32 v[34:35], v[34:35], s[94:95], v[26:27]
    v_pk_fma_f32 v[36:37], v[36:37], s[94:95], v[26:27]
    v_pk_fma_f32 v[38:39], v[38:39], s[94:95], v[26:27]
    v_pk_fma_f32 v[40:41], v[40:41], s[94:95], v[26:27]
    v_pk_mul_f32 v[34:35], v[34:35], v[224:225]
    v_pk_mul_f32 v[36:37], v[36:37], v[226:227]
    v_pk_mul_f32 v[38:39], v[38:39], v[228:229]
    v_pk_mul_f32 v[40:41], v[40:41], v[230:231]
    v_exp_f32 v34, v34
    v_exp_f32 v35, v35
    v_exp_f32 v36, v36
    v_exp_f32 v37, v37
    v_exp_f32 v38, v38
    v_exp_f32 v39, v39
    v_exp_f32 v40, v40
    v_exp_f32 v41, v41
    v_pk_mul_f32 v[232:233], v[232:233], v[224:225]
    v_pk_mul_f32 v[234:235], v[234:235], v[226:227]
    v_pk_mul_f32 v[236:237], v[236:237], v[228:229]
    v_pk_mul_f32 v[238:239], v[238:239], v[230:231]
    v_pk_add_f32 v[34:35], v[34:35], 1.0 op_sel_hi:[1,0]
    v_pk_add_f32 v[36:37], v[36:37], 1.0 op_sel_hi:[1,0]
    v_pk_add_f32 v[38:39], v[38:39], 1.0 op_sel_hi:[1,0]
    v_pk_add_f32 v[40:41], v[40:41], 1.0 op_sel_hi:[1,0]
    v_rcp_f32 v34, v34
    v_rcp_f32 v35, v35
    v_rcp_f32 v36, v36
    v_rcp_f32 v37, v37
    v_rcp_f32 v38, v38
    v_rcp_f32 v39, v39
    v_rcp_f32 v40, v40
    v_rcp_f32 v41, v41
    v_pk_mul_f32 v[232:233], v[232:233], v[34:35]
    v_pk_mul_f32 v[234:235], v[234:235], v[36:37]
    v_pk_mul_f32 v[236:237], v[236:237], v[38:39]
    v_pk_mul_f32 v[238:239], v[238:239], v[40:41]
    v_cvt_pk_bf16_f32 v224, v232, v233
    v_cvt_pk_bf16_f32 v225, v234, v235
    v_cvt_pk_bf16_f32 v226, v236, v237
    v_cvt_pk_bf16_f32 v227, v238, v239
    buffer_store_dwordx4 v[224:227], v16, s[56:59], s88 offen offset:2048 sc1
    v_pk_mul_f32 v[34:35], v[240:241], v[240:241]
    v_pk_mul_f32 v[36:37], v[242:243], v[242:243]
    v_pk_mul_f32 v[38:39], v[244:245], v[244:245]
    v_pk_mul_f32 v[40:41], v[246:247], v[246:247]
    v_pk_fma_f32 v[34:35], v[34:35], s[94:95], v[26:27]
    v_pk_fma_f32 v[36:37], v[36:37], s[94:95], v[26:27]
    v_pk_fma_f32 v[38:39], v[38:39], s[94:95], v[26:27]
    v_pk_fma_f32 v[40:41], v[40:41], s[94:95], v[26:27]
    v_pk_mul_f32 v[34:35], v[34:35], v[240:241]
    v_pk_mul_f32 v[36:37], v[36:37], v[242:243]
    v_pk_mul_f32 v[38:39], v[38:39], v[244:245]
    v_pk_mul_f32 v[40:41], v[40:41], v[246:247]
    v_exp_f32 v34, v34
    v_exp_f32 v35, v35
    v_exp_f32 v36, v36
    v_exp_f32 v37, v37
    v_exp_f32 v38, v38
    v_exp_f32 v39, v39
    v_exp_f32 v40, v40
    v_exp_f32 v41, v41
    v_pk_mul_f32 v[248:249], v[248:249], v[240:241]
    v_pk_mul_f32 v[250:251], v[250:251], v[242:243]
    v_pk_mul_f32 v[252:253], v[252:253], v[244:245]
    v_pk_mul_f32 v[254:255], v[254:255], v[246:247]
    v_pk_add_f32 v[34:35], v[34:35], 1.0 op_sel_hi:[1,0]
    v_pk_add_f32 v[36:37], v[36:37], 1.0 op_sel_hi:[1,0]
    v_pk_add_f32 v[38:39], v[38:39], 1.0 op_sel_hi:[1,0]
    v_pk_add_f32 v[40:41], v[40:41], 1.0 op_sel_hi:[1,0]
    v_rcp_f32 v34, v34
    v_rcp_f32 v35, v35
    v_rcp_f32 v36, v36
    v_rcp_f32 v37, v37
    v_rcp_f32 v38, v38
    v_rcp_f32 v39, v39
    v_rcp_f32 v40, v40
    v_rcp_f32 v41, v41
    v_pk_mul_f32 v[248:249], v[248:249], v[34:35]
    v_pk_mul_f32 v[250:251], v[250:251], v[36:37]
    v_pk_mul_f32 v[252:253], v[252:253], v[38:39]
    v_pk_mul_f32 v[254:255], v[254:255], v[40:41]
    v_cvt_pk_bf16_f32 v240, v248, v249
    v_cvt_pk_bf16_f32 v241, v250, v251
    v_cvt_pk_bf16_f32 v242, v252, v253
    v_cvt_pk_bf16_f32 v243, v254, v255
    buffer_store_dwordx4 v[240:243], v16, s[56:59], s88 offen offset:3072 sc1
    s_cmp_eq_u32 s62, 1
    s_cbranch_scc1 L_epi1
    v_mov_b32 v244, 0xce6e6b28
    v_cvt_pk_bf16_f32 v128, v120, v121
    v_cvt_pk_bf16_f32 v129, v122, v123
    v_cvt_pk_bf16_f32 v130, v124, v125
    v_cvt_pk_bf16_f32 v131, v126, v127
    v_accvgpr_read_b32 v34, a128
    v_accvgpr_read_b32 v35, a129
    v_accvgpr_read_b32 v36, a130
    v_accvgpr_read_b32 v37, a131
    v_accvgpr_read_b32 v38, a132
    v_accvgpr_read_b32 v39, a133
    v_accvgpr_read_b32 v40, a134
    v_accvgpr_read_b32 v41, a135
    v_cvt_pk_bf16_f32 v132, v34, v35
    s_mov_b32 s82, 65536
    s_add_u32 m0, s3, 65536
    s_nop 0
    buffer_load_dwordx4 v17, s[48:51], s82 offen lds
    buffer_load_dwordx4 v18, s[48:51], s82 offen offset:1024 lds
    v_cvt_pk_bf16_f32 v133, v36, v37
    v_cvt_pk_bf16_f32 v134, v38, v39
    v_cvt_pk_bf16_f32 v135, v40, v41
    v_accvgpr_read_b32 v246, a192
    v_accvgpr_read_b32 v247, a193
    v_accvgpr_read_b32 v248, a194
    v_accvgpr_read_b32 v249, a195
    v_accvgpr_read_b32 v250, a196
    v_accvgpr_read_b32 v251, a197
    v_accvgpr_read_b32 v252, a198
    v_accvgpr_read_b32 v253, a199
    v_cvt_pk_bf16_f32 v164, v246, v247
    v_cvt_pk_bf16_f32 v165, v248, v249
    v_cvt_pk_bf16_f32 v166, v250, v251
    v_cvt_pk_bf16_f32 v167, v252, v253
    v_accvgpr_read_b32 v34, a136
    v_accvgpr_read_b32 v35, a137
    v_accvgpr_read_b32 v36, a138
    v_accvgpr_read_b32 v37, a139
    v_accvgpr_read_b32 v38, a140
    v_accvgpr_read_b32 v39, a141
    v_accvgpr_read_b32 v40, a142
    s_mov_b32 s83, 294912
    s_add_u32 m0, s3, 73728
    s_nop 0
    buffer_load_dwordx4 v17, s[48:51], s83 offen lds
    buffer_load_dwordx4 v18, s[48:51], s83 offen offset:1024 lds
    v_accvgpr_read_b32 v41, a143
    v_cvt_pk_bf16_f32 v136, v34, v35
    v_cvt_pk_bf16_f32 v137, v36, v37
    v_cvt_pk_bf16_f32 v138, v38, v39
    v_cvt_pk_bf16_f32 v139, v40, v41
    v_accvgpr_read_b32 v246, a200
    v_accvgpr_read_b32 v247, a201
    v_accvgpr_read_b32 v248, a202
    v_accvgpr_read_b32 v249, a203
    v_accvgpr_read_b32 v250, a204
    v_accvgpr_read_b32 v251, a205
    v_accvgpr_read_b32 v252, a206
    v_accvgpr_read_b32 v253, a207
    v_cvt_pk_bf16_f32 v168, v246, v247
    v_cvt_pk_bf16_f32 v169, v248, v249
    v_cvt_pk_bf16_f32 v170, v250, v251
    v_cvt_pk_bf16_f32 v171, v252, v253
    v_accvgpr_read_b32 v34, a144
    v_accvgpr_read_b32 v35, a145
    v_accvgpr_read_b32 v36, a146
    v_accvgpr_read_b32 v37, a147
    v_accvgpr_read_b32 v38, a148
    s_mov_b32 s82, 524288
    s_add_u32 m0, s3, 81920
    s_nop 0
    buffer_load_dwordx4 v17, s[48:51], s82 offen lds
    buffer_load_dwordx4 v18, s[48:51], s82 offen offset:1024 lds
    v_accvgpr_read_b32 v39, a149
    v_accvgpr_read_b32 v40, a150
    v_accvgpr_read_b32 v41, a151
    v_cvt_pk_bf16_f32 v140, v34, v35
    v_cvt_pk_bf16_f32 v141, v36, v37
    v_cvt_pk_bf16_f32 v142, v38, v39
    v_cvt_pk_bf16_f32 v143, v40, v41
    v_accvgpr_read_b32 v246, a208
    v_accvgpr_read_b32 v247, a209
    v_accvgpr_read_b32 v248, a210
    v_accvgpr_read_b32 v249, a211
    v_accvgpr_read_b32 v250, a212
    v_accvgpr_read_b32 v251, a213
    v_accvgpr_read_b32 v252, a214
    v_accvgpr_read_b32 v253, a215
    v_cvt_pk_bf16_f32 v172, v246, v247
    v_cvt_pk_bf16_f32 v173, v248, v249
    v_cvt_pk_bf16_f32 v174, v250, v251
    v_cvt_pk_bf16_f32 v175, v252, v253
    v_accvgpr_read_b32 v34, a152
    v_accvgpr_read_b32 v35, a153
    v_accvgpr_read_b32 v36, a154
    s_mov_b32 s83, 753664
    s_add_u32 m0, s3, 90112
    s_nop 0
    buffer_load_dwordx4 v17, s[48:51], s83 offen lds
    buffer_load_dwordx4 v18, s[48:51], s83 offen offset:1024 lds
    v_accvgpr_read_b32 v37, a155
    v_accvgpr_read_b32 v38, a156
    v_accvgpr_read_b32 v39, a157
    v_accvgpr_read_b32 v40, a158
    v_accvgpr_read_b32 v41, a159
    v_cvt_pk_bf16_f32 v144, v34, v35
    v_cvt_pk_bf16_f32 v145, v36, v37
    v_cvt_pk_bf16_f32 v146, v38, v39
    v_cvt_pk_bf16_f32 v147, v40, v41
    v_accvgpr_read_b32 v246, a216
    v_accvgpr_read_b32 v247, a217
    v_accvgpr_read_b32 v248, a218
    v_accvgpr_read_b32 v249, a219
    v_accvgpr_read_b32 v250, a220
    v_accvgpr_read_b32 v251, a221
    v_accvgpr_read_b32 v252, a222
    v_accvgpr_read_b32 v253, a223
    v_cvt_pk_bf16_f32 v176, v246, v247
    v_cvt_pk_bf16_f32 v177, v248, v249
    v_cvt_pk_bf16_f32 v178, v250, v251
    v_cvt_pk_bf16_f32 v179, v252, v253
    v_mfma_f32_16x16x32_bf16 v[196:199], v[128:131], v[164:167], 0
    v_mfma_f32_16x16x32_bf16 v[200:203], v[132:135], v[164:167], 0
    v_mfma_f32_16x16x32_bf16 v[204:207], v[132:135], v[168:171], 0
    v_mfma_f32_16x16x32_bf16 v[208:211], v[136:139], v[168:171], 0
    v_mfma_f32_16x16x32_bf16 v[212:215], v[136:139], v[172:175], 0
    v_mfma_f32_16x16x32_bf16 v[216:219], v[140:143], v[172:175], 0
    v_mfma_f32_16x16x32_bf16 v[220:223], v[140:143], v[176:179], 0
    v_mfma_f32_16x16x32_bf16 v[224:227], v[144:147], v[176:179], 0
    s_waitcnt vmcnt(8)
    s_mov_b64 exec, 1
    buffer_atomic_add v25, off, s[56:59], s92 sc1
    s_mov_b64 exec, -1
    v_cvt_pk_bf16_f32 v48, v48, v49
    v_cvt_pk_bf16_f32 v49, v50, v51
    v_cvt_pk_bf16_f32 v84, v84, v85
    v_cvt_pk_bf16_f32 v85, v86, v87
    v_cvt_pk_bf16_f32 v50, v52, v53
    v_cvt_pk_bf16_f32 v51, v54, v55
    v_cvt_pk_bf16_f32 v86, v88, v89
    v_cvt_pk_bf16_f32 v87, v90, v91
    v_cvt_pk_bf16_f32 v52, v56, v57
    v_cvt_pk_bf16_f32 v53, v58, v59
    v_cvt_pk_bf16_f32 v88, v92, v93
    v_cvt_pk_bf16_f32 v89, v94, v95
    v_cvt_pk_bf16_f32 v54, v60, v61
    v_cvt_pk_bf16_f32 v55, v62, v63
    v_cvt_pk_bf16_f32 v90, v96, v97
    v_cvt_pk_bf16_f32 v91, v98, v99
    v_cvt_pk_bf16_f32 v56, v64, v65
    v_cvt_pk_bf16_f32 v57, v66, v67
    v_cvt_pk_bf16_f32 v92, v100, v101
    v_cvt_pk_bf16_f32 v93, v102, v103
    v_cvt_pk_bf16_f32 v58, v68, v69
    v_cvt_pk_bf16_f32 v59, v70, v71
    v_cvt_pk_bf16_f32 v94, v104, v105
    v_cvt_pk_bf16_f32 v95, v106, v107
    v_cvt_pk_bf16_f32 v60, v72, v73
    v_cvt_pk_bf16_f32 v61, v74, v75
    v_cvt_pk_bf16_f32 v96, v108, v109
    v_cvt_pk_bf16_f32 v97, v110, v111
    v_cvt_pk_bf16_f32 v62, v76, v77
    v_cvt_pk_bf16_f32 v63, v78, v79
    v_cvt_pk_bf16_f32 v98, v112, v113
    v_cvt_pk_bf16_f32 v99, v114, v115
    v_cvt_pk_bf16_f32 v64, v80, v81
    v_cvt_pk_bf16_f32 v65, v82, v83
    v_cvt_pk_bf16_f32 v100, v116, v117
    v_cvt_pk_bf16_f32 v101, v118, v119
    v_cvt_pk_bf16_f32 v196, v196, v197
    s_mov_b32 s82, 983040
    s_add_u32 m0, s3, 98304
    s_nop 0
    buffer_load_dwordx4 v17, s[48:51], s82 offen lds
    buffer_load_dwordx4 v18, s[48:51], s82 offen offset:1024 lds
    v_cvt_pk_bf16_f32 v198, v198, v199
    v_cvt_pk_bf16_f32 v200, v200, v201
    v_cvt_pk_bf16_f32 v202, v202, v203
    v_cvt_pk_bf16_f32 v204, v204, v205
    v_cvt_pk_bf16_f32 v206, v206, v207
    v_cvt_pk_bf16_f32 v208, v208, v209
    v_cvt_pk_bf16_f32 v210, v210, v211
    v_cvt_pk_bf16_f32 v212, v212, v213
    v_cvt_pk_bf16_f32 v214, v214, v215
    v_cvt_pk_bf16_f32 v216, v216, v217
    v_cvt_pk_bf16_f32 v218, v218, v219
    v_cvt_pk_bf16_f32 v220, v220, v221
    v_cvt_pk_bf16_f32 v222, v222, v223
    v_cvt_pk_bf16_f32 v224, v224, v225
    v_cvt_pk_bf16_f32 v226, v226, v227
    v_perm_b32 v228, v200, v196, v28
    v_perm_b32 v229, v202, v198, v29
    v_perm_b32 v230, v208, v204, v28
    v_perm_b32 v231, v210, v206, v29
    v_perm_b32 v232, v216, v212, v28
    v_perm_b32 v233, v218, v214, v29
    v_perm_b32 v234, v224, v220, v28
    v_perm_b32 v235, v226, v222, v29
    v_pk_mul_f32 v[228:229], v[228:229], s[14:15]
    v_pk_mul_f32 v[230:231], v[230:231], s[14:15]
    v_pk_mul_f32 v[232:233], v[232:233], s[14:15]
    v_pk_mul_f32 v[234:235], v[234:235], s[14:15]
    v_cvt_pk_bf16_f32 v229, v228, v229
    s_mov_b32 s83, 1212416
    s_add_u32 m0, s3, 106496
    s_nop 0
    buffer_load_dwordx4 v17, s[48:51], s83 offen lds
    buffer_load_dwordx4 v18, s[48:51], s83 offen offset:1024 lds
    v_cvt_pk_bf16_f32 v231, v230, v231
    v_cvt_pk_bf16_f32 v233, v232, v233
    v_cvt_pk_bf16_f32 v235, v234, v235
    v_lshlrev_b32 v228, 16, v229
    v_and_b32 v229, 0xffff0000, v229
    v_lshlrev_b32 v230, 16, v231
    v_and_b32 v231, 0xffff0000, v231
    v_lshlrev_b32 v232, 16, v233
    v_and_b32 v233, 0xffff0000, v233
    v_lshlrev_b32 v234, 16, v235
    v_and_b32 v235, 0xffff0000, v235
    v_cndmask_b32 v228, v244, v228, s[4:5]
    v_cndmask_b32 v229, v244, v229, s[6:7]
    v_max_f32 v236, v228, v229
    v_max_f32 v238, v230, v231
    v_max_f32 v240, v232, v233
    v_max_f32 v242, v234, v235
    v_permlane16_swap_b32 v236, v238
    s_nop 0
    v_permlane16_swap_b32 v240, v242
    v_max_f32 v236, v236, v238
    v_max_f32 v240, v240, v242
    s_nop 1
    v_permlane32_swap_b32 v236, v240
    v_max_f32 v236, v236, v240
    v_mul_f32 v236, 0xbfb8aa3b, v236
    v_mov_b32 v240, v236
    s_nop 1
    v_permlane32_swap_b32 v236, v240
    v_mov_b32 v238, v236
    v_mov_b32 v242, v240
    s_mov_b32 s82, 1441792
    s_add_u32 m0, s3, 114688
    s_nop 0
    buffer_load_dwordx4 v17, s[48:51], s82 offen lds
    buffer_load_dwordx4 v18, s[48:51], s82 offen offset:1024 lds
    v_permlane16_swap_b32 v236, v238
    v_permlane16_swap_b32 v240, v242
    v_pk_fma_f32 v[228:229], v[228:229], s[98:99], v[236:237] op_sel_hi:[1,1,0]
    v_pk_fma_f32 v[230:231], v[230:231], s[98:99], v[238:239] op_sel_hi:[1,1,0]
    v_pk_fma_f32 v[232:233], v[232:233], s[98:99], v[240:241] op_sel_hi:[1,1,0]
    v_pk_fma_f32 v[234:235], v[234:235], s[98:99], v[242:243] op_sel_hi:[1,1,0]
    v_exp_f32 v228, v228
    v_exp_f32 v229, v229
    v_exp_f32 v230, v230
    v_exp_f32 v231, v231
    v_exp_f32 v232, v232
    v_exp_f32 v233, v233
    v_exp_f32 v234, v234
    v_exp_f32 v235, v235
    v_add_f32 v236, v228, v229
    v_add_f32 v238, v230, v231
    v_add_f32 v240, v232, v233
    v_add_f32 v242, v234, v235
    v_permlane16_swap_b32 v236, v238
    s_nop 0
    v_permlane16_swap_b32 v240, v242
    v_add_f32 v236, v236, v238
    v_add_f32 v240, v240, v242
    s_nop 1
    v_permlane32_swap_b32 v236, v240
    v_add_f32 v236, v236, v240
    v_rcp_f32 v236, v236
    s_nop 0
    v_mov_b32 v240, v236
    s_nop 1
    v_permlane32_swap_b32 v236, v240
    v_mov_b32 v238, v236
    s_mov_b32 s83, 1671168
    s_add_u32 m0, s3, 122880
    s_nop 0
    buffer_load_dwordx4 v17, s[48:51], s83 offen lds
    buffer_load_dwordx4 v18, s[48:51], s83 offen offset:1024 lds
    v_mov_b32 v242, v240
    v_permlane16_swap_b32 v236, v238
    s_nop 0
    v_permlane16_swap_b32 v240, v242
    v_pk_mul_f32 v[228:229], v[228:229], v[236:237] op_sel_hi:[1,0]
    v_pk_mul_f32 v[230:231], v[230:231], v[238:239] op_sel_hi:[1,0]
    v_pk_mul_f32 v[232:233], v[232:233], v[240:241] op_sel_hi:[1,0]
    v_pk_mul_f32 v[234:235], v[234:235], v[242:243] op_sel_hi:[1,0]
    v_cvt_pk_bf16_f32 v228, v228, v229
    v_cvt_pk_bf16_f32 v230, v230, v231
    v_cvt_pk_bf16_f32 v232, v232, v233
    v_cvt_pk_bf16_f32 v234, v234, v235
    v_perm_b32 v164, v228, v228, v30
    v_perm_b32 v165, v228, v228, v31
    v_perm_b32 v166, v228, v228, v32
    v_perm_b32 v167, v228, v228, v33
    v_perm_b32 v168, v230, v230, v30
    v_perm_b32 v169, v230, v230, v31
    v_perm_b32 v170, v230, v230, v32
    v_perm_b32 v171, v230, v230, v33
    v_perm_b32 v172, v232, v232, v30
    v_perm_b32 v173, v232, v232, v31
    v_perm_b32 v174, v232, v232, v32
    v_perm_b32 v175, v232, v232, v33
    v_perm_b32 v176, v234, v234, v30
    v_perm_b32 v177, v234, v234, v31
    v_perm_b32 v178, v234, v234, v32
    v_perm_b32 v179, v234, v234, v33
    v_mfma_f32_16x16x32_bf16 v[196:199], v[48:51], v[164:167], 0
    v_mfma_f32_16x16x32_bf16 v[200:203], v[84:87], v[164:167], 0
    v_mfma_f32_16x16x32_bf16 v[204:207], v[50:53], v[168:171], 0
    v_mfma_f32_16x16x32_bf16 v[208:211], v[86:89], v[168:171], 0
    v_mfma_f32_16x16x32_bf16 v[212:215], v[52:55], v[172:175], 0
    v_mfma_f32_16x16x32_bf16 v[216:219], v[88:91], v[172:175], 0
    v_mfma_f32_16x16x32_bf16 v[220:223], v[54:57], v[176:179], 0
    v_mfma_f32_16x16x32_bf16 v[224:227], v[90:93], v[176:179], 0
    v_accvgpr_read_b32 v34, a160
    s_mov_b32 s82, 131072
    s_add_u32 m0, s3, 131072
    s_nop 0
    buffer_load_dwordx4 v17, s[48:51], s82 offen lds
    buffer_load_dwordx4 v18, s[48:51], s82 offen offset:1024 lds
    v_accvgpr_read_b32 v35, a161
    v_accvgpr_read_b32 v36, a162
    v_accvgpr_read_b32 v37, a163
    v_accvgpr_read_b32 v38, a164
    v_accvgpr_read_b32 v39, a165
    v_accvgpr_read_b32 v40, a166
    v_accvgpr_read_b32 v41, a167
    v_cvt_pk_bf16_f32 v148, v34, v35
    v_cvt_pk_bf16_f32 v149, v36, v37
    v_cvt_pk_bf16_f32 v150, v38, v39
    v_cvt_pk_bf16_f32 v151, v40, v41
    v_accvgpr_read_b32 v246, a224
    v_accvgpr_read_b32 v247, a225
    v_accvgpr_read_b32 v248, a226
    v_accvgpr_read_b32 v249, a227
    v_accvgpr_read_b32 v250, a228
    v_accvgpr_read_b32 v251, a229
    v_accvgpr_read_b32 v252, a230
    v_accvgpr_read_b32 v253, a231
    v_cvt_pk_bf16_f32 v180, v246, v247
    v_cvt_pk_bf16_f32 v181, v248, v249
    v_cvt_pk_bf16_f32 v182, v250, v251
    v_cvt_pk_bf16_f32 v183, v252, v253
    v_accvgpr_read_b32 v34, a168
    s_mov_b32 s83, 360448
    s_add_u32 m0, s3, 139264
    s_nop 0
    buffer_load_dwordx4 v17, s[48:51], s83 offen lds
    buffer_load_dwordx4 v18, s[48:51], s83 offen offset:1024 lds
    v_accvgpr_read_b32 v35, a169
    v_accvgpr_read_b32 v36, a170
    v_accvgpr_read_b32 v37, a171
    v_accvgpr_read_b32 v38, a172
    v_accvgpr_read_b32 v39, a173
    v_accvgpr_read_b32 v40, a174
    v_accvgpr_read_b32 v41, a175
    v_cvt_pk_bf16_f32 v152, v34, v35
    v_cvt_pk_bf16_f32 v153, v36, v37
    v_cvt_pk_bf16_f32 v154, v38, v39
    v_cvt_pk_bf16_f32 v155, v40, v41
    v_accvgpr_read_b32 v246, a232
    v_accvgpr_read_b32 v247, a233
    v_accvgpr_read_b32 v248, a234
    v_accvgpr_read_b32 v249, a235
    v_accvgpr_read_b32 v250, a236
    v_accvgpr_read_b32 v251, a237
    v_accvgpr_read_b32 v252, a238
    v_accvgpr_read_b32 v253, a239
    v_cvt_pk_bf16_f32 v184, v246, v247
    v_cvt_pk_bf16_f32 v185, v248, v249
    v_cvt_pk_bf16_f32 v186, v250, v251
    v_cvt_pk_bf16_f32 v187, v252, v253
    v_accvgpr_read_b32 v34, a176
    s_mov_b32 s82, 589824
    s_add_u32 m0, s3, 147456
    s_nop 0
    buffer_load_dwordx4 v17, s[48:51], s82 offen lds
    buffer_load_dwordx4 v18, s[48:51], s82 offen offset:1024 lds
    v_accvgpr_read_b32 v35, a177
    v_accvgpr_read_b32 v36, a178
    v_accvgpr_read_b32 v37, a179
    v_accvgpr_read_b32 v38, a180
    v_accvgpr_read_b32 v39, a181
    v_accvgpr_read_b32 v40, a182
    v_accvgpr_read_b32 v41, a183
    v_cvt_pk_bf16_f32 v156, v34, v35
    v_cvt_pk_bf16_f32 v157, v36, v37
    v_cvt_pk_bf16_f32 v158, v38, v39
    v_cvt_pk_bf16_f32 v159, v40, v41
    v_accvgpr_read_b32 v246, a240
    v_accvgpr_read_b32 v247, a241
    v_accvgpr_read_b32 v248, a242
    v_accvgpr_read_b32 v249, a243
    v_accvgpr_read_b32 v250, a244
    v_accvgpr_read_b32 v251, a245
    v_accvgpr_read_b32 v252, a246
    v_accvgpr_read_b32 v253, a247
    v_cvt_pk_bf16_f32 v188, v246, v247
    v_cvt_pk_bf16_f32 v189, v248, v249
    v_cvt_pk_bf16_f32 v190, v250, v251
    v_cvt_pk_bf16_f32 v191, v252, v253
    v_accvgpr_read_b32 v34, a184
    s_mov_b32 s83, 819200
    s_add_u32 m0, s3, 155648
    s_nop 0
    buffer_load_dwordx4 v17, s[48:51], s83 offen lds
    buffer_load_dwordx4 v18, s[48:51], s83 offen offset:1024 lds
    v_accvgpr_read_b32 v35, a185
    v_accvgpr_read_b32 v36, a186
    v_accvgpr_read_b32 v37, a187
    v_accvgpr_read_b32 v38, a188
    v_accvgpr_read_b32 v39, a189
    v_accvgpr_read_b32 v40, a190
    v_accvgpr_read_b32 v41, a191
    v_cvt_pk_bf16_f32 v160, v34, v35
    v_cvt_pk_bf16_f32 v161, v36, v37
    v_cvt_pk_bf16_f32 v162, v38, v39
    v_cvt_pk_bf16_f32 v163, v40, v41
    v_accvgpr_read_b32 v246, a248
    v_accvgpr_read_b32 v247, a249
    v_accvgpr_read_b32 v248, a250
    v_accvgpr_read_b32 v249, a251
    v_accvgpr_read_b32 v250, a252
    v_accvgpr_read_b32 v251, a253
    v_accvgpr_read_b32 v252, a254
    v_accvgpr_read_b32 v253, a255
    v_cvt_pk_bf16_f32 v192, v246, v247
    v_cvt_pk_bf16_f32 v193, v248, v249
    v_cvt_pk_bf16_f32 v194, v250, v251
    v_cvt_pk_bf16_f32 v195, v252, v253
    v_cvt_pk_bf16_f32 v196, v196, v197
    v_cvt_pk_bf16_f32 v197, v198, v199
    v_cvt_pk_bf16_f32 v198, v200, v201
    v_cvt_pk_bf16_f32 v199, v202, v203
    buffer_store_dwordx4 v[196:199], v16, s[56:59], s91 offen offset:0 sc1
    s_add_u32 s91, s91, 32768
    v_cvt_pk_bf16_f32 v204, v204, v205
    v_cvt_pk_bf16_f32 v205, v206, v207
    v_cvt_pk_bf16_f32 v206, v208, v209
    v_cvt_pk_bf16_f32 v207, v210, v211
    buffer_store_dwordx4 v[204:207], v16, s[56:59], s91 offen offset:0 sc1
    s_add_u32 s91, s91, 32768
    v_cvt_pk_bf16_f32 v212, v212, v213
    v_cvt_pk_bf16_f32 v213, v214, v215
    v_cvt_pk_bf16_f32 v214, v216, v217
    v_cvt_pk_bf16_f32 v215, v218, v219
    buffer_store_dwordx4 v[212:215], v16, s[56:59], s91 offen offset:0 sc1
    s_add_u32 s91, s91, 32768
    v_cvt_pk_bf16_f32 v220, v220, v221
    v_cvt_pk_bf16_f32 v221, v222, v223
    v_cvt_pk_bf16_f32 v222, v224, v225
    v_cvt_pk_bf16_f32 v223, v226, v227
    buffer_store_dwordx4 v[220:223], v16, s[56:59], s91 offen offset:0 sc1
    s_add_u32 s91, s91, 32768
    v_mfma_f32_16x16x32_bf16 v[196:199], v[144:147], v[180:183], 0
    v_mfma_f32_16x16x32_bf16 v[200:203], v[148:151], v[180:183], 0
    v_mfma_f32_16x16x32_bf16 v[204:207], v[148:151], v[184:187], 0
    v_mfma_f32_16x16x32_bf16 v[208:211], v[152:155], v[184:187], 0
    v_mfma_f32_16x16x32_bf16 v[212:215], v[152:155], v[188:191], 0
    v_mfma_f32_16x16x32_bf16 v[216:219], v[156:159], v[188:191], 0
    v_mfma_f32_16x16x32_bf16 v[220:223], v[156:159], v[192:195], 0
    v_mfma_f32_16x16x32_bf16 v[224:227], v[160:163], v[192:195], 0
    s_nop 0
    v_cvt_pk_bf16_f32 v196, v196, v197
    v_cvt_pk_bf16_f32 v198, v198, v199
    v_cvt_pk_bf16_f32 v200, v200, v201
    v_cvt_pk_bf16_f32 v202, v202, v203
    v_cvt_pk_bf16_f32 v204, v204, v205
    v_cvt_pk_bf16_f32 v206, v206, v207
    v_cvt_pk_bf16_f32 v208, v208, v209
    v_cvt_pk_bf16_f32 v210, v210, v211
    v_cvt_pk_bf16_f32 v212, v212, v213
    v_cvt_pk_bf16_f32 v214, v214, v215
    v_cvt_pk_bf16_f32 v216, v216, v217
    v_cvt_pk_bf16_f32 v218, v218, v219
    v_cvt_pk_bf16_f32 v220, v220, v221
    v_cvt_pk_bf16_f32 v222, v222, v223
    v_cvt_pk_bf16_f32 v224, v224, v225
    v_cvt_pk_bf16_f32 v226, v226, v227
    v_perm_b32 v228, v200, v196, v28
    v_perm_b32 v229, v202, v198, v29
    v_perm_b32 v230, v208, v204, v28
    v_perm_b32 v231, v210, v206, v29
    v_perm_b32 v232, v216, v212, v28
    v_perm_b32 v233, v218, v214, v29
    v_perm_b32 v234, v224, v220, v28
    v_perm_b32 v235, v226, v222, v29
    v_pk_mul_f32 v[228:229], v[228:229], s[14:15]
    v_pk_mul_f32 v[230:231], v[230:231], s[14:15]
    v_pk_mul_f32 v[232:233], v[232:233], s[14:15]
    v_pk_mul_f32 v[234:235], v[234:235], s[14:15]
    v_cvt_pk_bf16_f32 v229, v228, v229
    v_cvt_pk_bf16_f32 v231, v230, v231
    v_cvt_pk_bf16_f32 v233, v232, v233
    v_cvt_pk_bf16_f32 v235, v234, v235
    v_lshlrev_b32 v228, 16, v229
    v_and_b32 v229, 0xffff0000, v229
    v_lshlrev_b32 v230, 16, v231
    v_and_b32 v231, 0xffff0000, v231
    v_lshlrev_b32 v232, 16, v233
    v_and_b32 v233, 0xffff0000, v233
    v_lshlrev_b32 v234, 16, v235
    v_and_b32 v235, 0xffff0000, v235
    v_max_f32 v236, v228, v229
    v_max_f32 v238, v230, v231
    v_max_f32 v240, v232, v233
    v_max_f32 v242, v234, v235
    v_permlane16_swap_b32 v236, v238
    s_nop 0
    v_permlane16_swap_b32 v240, v242
    v_max_f32 v236, v236, v238
    v_max_f32 v240, v240, v242
    s_nop 1
    v_permlane32_swap_b32 v236, v240
    v_max_f32 v236, v236, v240
    v_mul_f32 v236, 0xbfb8aa3b, v236
    v_mov_b32 v240, v236
    s_nop 1
    v_permlane32_swap_b32 v236, v240
    v_mov_b32 v238, v236
    v_mov_b32 v242, v240
    s_nop 0
    v_permlane16_swap_b32 v236, v238
    v_permlane16_swap_b32 v240, v242
    v_pk_fma_f32 v[228:229], v[228:229], s[98:99], v[236:237] op_sel_hi:[1,1,0]
    v_pk_fma_f32 v[230:231], v[230:231], s[98:99], v[238:239] op_sel_hi:[1,1,0]
    v_pk_fma_f32 v[232:233], v[232:233], s[98:99], v[240:241] op_sel_hi:[1,1,0]
    v_pk_fma_f32 v[234:235], v[234:235], s[98:99], v[242:243] op_sel_hi:[1,1,0]
    v_exp_f32 v228, v228
    v_exp_f32 v229, v229
    v_exp_f32 v230, v230
    v_exp_f32 v231, v231
    v_exp_f32 v232, v232
    v_exp_f32 v233, v233
    v_exp_f32 v234, v234
    v_exp_f32 v235, v235
    v_add_f32 v236, v228, v229
    v_add_f32 v238, v230, v231
    v_add_f32 v240, v232, v233
    v_add_f32 v242, v234, v235
    v_permlane16_swap_b32 v236, v238
    s_nop 0
    v_permlane16_swap_b32 v240, v242
    v_add_f32 v236, v236, v238
    v_add_f32 v240, v240, v242
    s_nop 1
    v_permlane32_swap_b32 v236, v240
    v_add_f32 v236, v236, v240
    v_rcp_f32 v236, v236
    s_nop 0
    v_mov_b32 v240, v236
    s_nop 1
    v_permlane32_swap_b32 v236, v240
    v_mov_b32 v238, v236
    v_mov_b32 v242, v240
    s_nop 0
    v_permlane16_swap_b32 v236, v238
    v_permlane16_swap_b32 v240, v242
    v_pk_mul_f32 v[228:229], v[228:229], v[236:237] op_sel_hi:[1,0]
    v_pk_mul_f32 v[230:231], v[230:231], v[238:239] op_sel_hi:[1,0]
    v_pk_mul_f32 v[232:233], v[232:233], v[240:241] op_sel_hi:[1,0]
    v_pk_mul_f32 v[234:235], v[234:235], v[242:243] op_sel_hi:[1,0]
    v_cvt_pk_bf16_f32 v228, v228, v229
    v_cvt_pk_bf16_f32 v230, v230, v231
    v_cvt_pk_bf16_f32 v232, v232, v233
    v_cvt_pk_bf16_f32 v234, v234, v235
    v_perm_b32 v180, v228, v228, v30
    v_perm_b32 v181, v228, v228, v31
    v_perm_b32 v182, v228, v228, v32
    v_perm_b32 v183, v228, v228, v33
    v_perm_b32 v184, v230, v230, v30
    v_perm_b32 v185, v230, v230, v31
    v_perm_b32 v186, v230, v230, v32
    v_perm_b32 v187, v230, v230, v33
    v_perm_b32 v188, v232, v232, v30
    v_perm_b32 v189, v232, v232, v31
    v_perm_b32 v190, v232, v232, v32
    v_perm_b32 v191, v232, v232, v33
    v_perm_b32 v192, v234, v234, v30
    v_perm_b32 v193, v234, v234, v31
    v_perm_b32 v194, v234, v234, v32
    v_perm_b32 v195, v234, v234, v33
    v_mfma_f32_16x16x32_bf16 v[196:199], v[56:59], v[180:183], 0
    v_mfma_f32_16x16x32_bf16 v[200:203], v[92:95], v[180:183], 0
    v_mfma_f32_16x16x32_bf16 v[204:207], v[58:61], v[184:187], 0
    v_mfma_f32_16x16x32_bf16 v[208:211], v[94:97], v[184:187], 0
    v_mfma_f32_16x16x32_bf16 v[212:215], v[60:63], v[188:191], 0
    v_mfma_f32_16x16x32_bf16 v[216:219], v[96:99], v[188:191], 0
    v_mfma_f32_16x16x32_bf16 v[220:223], v[62:65], v[192:195], 0
    v_mfma_f32_16x16x32_bf16 v[224:227], v[98:101], v[192:195], 0
    s_nop 0
    v_cvt_pk_bf16_f32 v196, v196, v197
    v_cvt_pk_bf16_f32 v197, v198, v199
    v_cvt_pk_bf16_f32 v198, v200, v201
    v_cvt_pk_bf16_f32 v199, v202, v203
    buffer_store_dwordx4 v[196:199], v16, s[56:59], s91 offen offset:0 sc1
    s_add_u32 s91, s91, 32768
    v_cvt_pk_bf16_f32 v204, v204, v205
    v_cvt_pk_bf16_f32 v205, v206, v207
    v_cvt_pk_bf16_f32 v206, v208, v209
    v_cvt_pk_bf16_f32 v207, v210, v211
    buffer_store_dwordx4 v[204:207], v16, s[56:59], s91 offen offset:0 sc1
    s_add_u32 s91, s91, 32768
    v_cvt_pk_bf16_f32 v212, v212, v213
    v_cvt_pk_bf16_f32 v213, v214, v215
    v_cvt_pk_bf16_f32 v214, v216, v217
    v_cvt_pk_bf16_f32 v215, v218, v219
    buffer_store_dwordx4 v[212:215], v16, s[56:59], s91 offen offset:0 sc1
    s_add_u32 s91, s91, 32768
    v_cvt_pk_bf16_f32 v220, v220, v221
    v_cvt_pk_bf16_f32 v221, v222, v223
    v_cvt_pk_bf16_f32 v222, v224, v225
    v_cvt_pk_bf16_f32 v223, v226, v227
    buffer_store_dwordx4 v[220:223], v16, s[56:59], s91 offen offset:0 sc1
    s_add_u32 s91, s91, 32768
    s_mov_b32 s67, 0
L_spA:
    buffer_load_dword v43, off, s[56:59], s92 sc1
    s_waitcnt vmcnt(0)
    v_readfirstlane_b32 s86, v43
    s_bfe_u32 s86, s86, 0x80000
    s_cmp_eq_u32 s86, 32
    s_cbranch_scc1 L_okA
    s_add_u32 s67, s67, 1
    s_cmp_lt_u32 s67, 0x40000
    s_cbranch_scc1 L_spA
L_okA:
    buffer_load_dwordx4 a[0:3], v21, s[56:59], s68 offen sc1
    buffer_load_dwordx4 a[4:7], v22, s[56:59], s68 offen sc1
    buffer_load_dwordx4 a[8:11], v23, s[56:59], s68 offen sc1
    buffer_load_dwordx4 a[12:15], v24, s[56:59], s68 offen sc1
    s_add_u32 s68, s68, 16384
    buffer_load_dwordx4 a[16:19], v21, s[56:59], s68 offen sc1
    buffer_load_dwordx4 a[20:23], v22, s[56:59], s68 offen sc1
    buffer_load_dwordx4 a[24:27], v23, s[56:59], s68 offen sc1
    buffer_load_dwordx4 a[28:31], v24, s[56:59], s68 offen sc1
    s_add_u32 s68, s68, 16384
    buffer_load_dwordx4 a[32:35], v21, s[56:59], s68 offen sc1
    buffer_load_dwordx4 a[36:39], v22, s[56:59], s68 offen sc1
    buffer_load_dwordx4 a[40:43], v23, s[56:59], s68 offen sc1
    buffer_load_dwordx4 a[44:47], v24, s[56:59], s68 offen sc1
    s_add_u32 s68, s68, 16384
    buffer_load_dwordx4 a[48:51], v21, s[56:59], s68 offen sc1
    buffer_load_dwordx4 a[52:55], v22, s[56:59], s68 offen sc1
    buffer_load_dwordx4 a[56:59], v23, s[56:59], s68 offen sc1
    buffer_load_dwordx4 a[60:63], v24, s[56:59], s68 offen sc1
    s_add_u32 s68, s68, 16384
    buffer_load_dwordx4 a[64:67], v21, s[56:59], s68 offen sc1
    buffer_load_dwordx4 a[68:71], v22, s[56:59], s68 offen sc1
    buffer_load_dwordx4 a[72:75], v23, s[56:59], s68 offen sc1
    buffer_load_dwordx4 a[76:79], v24, s[56:59], s68 offen sc1
    s_add_u32 s68, s68, 16384
    buffer_load_dwordx4 a[80:83], v21, s[56:59], s68 offen sc1
    buffer_load_dwordx4 a[84:87], v22, s[56:59], s68 offen sc1
    buffer_load_dwordx4 a[88:91], v23, s[56:59], s68 offen sc1
    buffer_load_dwordx4 a[92:95], v24, s[56:59], s68 offen sc1
    s_add_u32 s68, s68, 16384
    buffer_load_dwordx4 a[96:99], v21, s[56:59], s68 offen sc1
    buffer_load_dwordx4 a[100:103], v22, s[56:59], s68 offen sc1
    buffer_load_dwordx4 a[104:107], v23, s[56:59], s68 offen sc1
    buffer_load_dwordx4 a[108:111], v24, s[56:59], s68 offen sc1
    s_add_u32 s68, s68, 16384
    buffer_load_dwordx4 a[112:115], v21, s[56:59], s68 offen sc1
    buffer_load_dwordx4 a[116:119], v22, s[56:59], s68 offen sc1
    buffer_load_dwordx4 a[120:123], v23, s[56:59], s68 offen sc1
    buffer_load_dwordx4 a[124:127], v24, s[56:59], s68 offen sc1
    s_add_u32 s68, s68, 16384
    s_barrier
    s_branch L_D
L_epi1:
    v_accvgpr_read_b32 v128, a128
    v_accvgpr_read_b32 v129, a129
    v_accvgpr_read_b32 v130, a130
    v_accvgpr_read_b32 v131, a131
    v_accvgpr_read_b32 v132, a132
    s_mov_b32 s82, 65536
    s_add_u32 m0, s3, 65536
    s_nop 0
    buffer_load_dwordx4 v17, s[48:51], s82 offen lds
    buffer_load_dwordx4 v18, s[48:51], s82 offen offset:1024 lds
    v_accvgpr_read_b32 v133, a133
    v_accvgpr_read_b32 v134, a134
    v_accvgpr_read_b32 v135, a135
    v_accvgpr_read_b32 v136, a136
    v_accvgpr_read_b32 v137, a137
    v_accvgpr_read_b32 v138, a138
    v_accvgpr_read_b32 v139, a139
    v_accvgpr_read_b32 v140, a140
    v_accvgpr_read_b32 v141, a141
    v_accvgpr_read_b32 v142, a142
    v_accvgpr_read_b32 v143, a143
    v_pk_mul_f32 v[34:35], v[128:129], v[128:129]
    v_pk_mul_f32 v[36:37], v[130:131], v[130:131]
    v_pk_mul_f32 v[38:39], v[132:133], v[132:133]
    v_pk_mul_f32 v[40:41], v[134:135], v[134:135]
    v_pk_fma_f32 v[34:35], v[34:35], s[94:95], v[26:27]
    v_pk_fma_f32 v[36:37], v[36:37], s[94:95], v[26:27]
    v_pk_fma_f32 v[38:39], v[38:39], s[94:95], v[26:27]
    v_pk_fma_f32 v[40:41], v[40:41], s[94:95], v[26:27]
    v_pk_mul_f32 v[34:35], v[34:35], v[128:129]
    v_pk_mul_f32 v[36:37], v[36:37], v[130:131]
    v_pk_mul_f32 v[38:39], v[38:39], v[132:133]
    v_pk_mul_f32 v[40:41], v[40:41], v[134:135]
    v_exp_f32 v34, v34
    v_exp_f32 v35, v35
    v_exp_f32 v36, v36
    v_exp_f32 v37, v37
    v_exp_f32 v38, v38
    s_mov_b32 s83, 294912
    s_add_u32 m0, s3, 73728
    s_nop 0
    buffer_load_dwordx4 v17, s[48:51], s83 offen lds
    buffer_load_dwordx4 v18, s[48:51], s83 offen offset:1024 lds
    v_exp_f32 v39, v39
    v_exp_f32 v40, v40
    v_exp_f32 v41, v41
    v_pk_mul_f32 v[136:137], v[136:137], v[128:129]
    v_pk_mul_f32 v[138:139], v[138:139], v[130:131]
    v_pk_mul_f32 v[140:141], v[140:141], v[132:133]
    v_pk_mul_f32 v[142:143], v[142:143], v[134:135]
    v_pk_add_f32 v[34:35], v[34:35], 1.0 op_sel_hi:[1,0]
    v_pk_add_f32 v[36:37], v[36:37], 1.0 op_sel_hi:[1,0]
    v_pk_add_f32 v[38:39], v[38:39], 1.0 op_sel_hi:[1,0]
    v_pk_add_f32 v[40:41], v[40:41], 1.0 op_sel_hi:[1,0]
    v_rcp_f32 v34, v34
    v_rcp_f32 v35, v35
    v_rcp_f32 v36, v36
    v_rcp_f32 v37, v37
    v_rcp_f32 v38, v38
    v_rcp_f32 v39, v39
    v_rcp_f32 v40, v40
    v_rcp_f32 v41, v41
    v_pk_mul_f32 v[136:137], v[136:137], v[34:35]
    v_pk_mul_f32 v[138:139], v[138:139], v[36:37]
    v_pk_mul_f32 v[140:141], v[140:141], v[38:39]
    v_pk_mul_f32 v[142:143], v[142:143], v[40:41]
    v_cvt_pk_bf16_f32 v128, v136, v137
    v_cvt_pk_bf16_f32 v129, v138, v139
    v_cvt_pk_bf16_f32 v130, v140, v141
    v_cvt_pk_bf16_f32 v131, v142, v143
    buffer_store_dwordx4 v[128:131], v16, s[56:59], s89 offen offset:0 sc1
    s_waitcnt vmcnt(5)
    s_mov_b64 exec, 1
    buffer_atomic_add v25, off, s[56:59], s92 sc1
    s_mov_b64 exec, -1
    v_accvgpr_read_b32 v144, a144
    v_accvgpr_read_b32 v145, a145
    v_accvgpr_read_b32 v146, a146
    v_accvgpr_read_b32 v147, a147
    v_accvgpr_read_b32 v148, a148
    s_mov_b32 s82, 524288
    s_add_u32 m0, s3, 81920
    s_nop 0
    buffer_load_dwordx4 v17, s[48:51], s82 offen lds
    buffer_load_dwordx4 v18, s[48:51], s82 offen offset:1024 lds
    v_accvgpr_read_b32 v149, a149
    v_accvgpr_read_b32 v150, a150
    v_accvgpr_read_b32 v151, a151
    v_accvgpr_read_b32 v152, a152
    v_accvgpr_read_b32 v153, a153
    v_accvgpr_read_b32 v154, a154
    v_accvgpr_read_b32 v155, a155
    v_accvgpr_read_b32 v156, a156
    v_accvgpr_read_b32 v157, a157
    v_accvgpr_read_b32 v158, a158
    v_accvgpr_read_b32 v159, a159
    v_pk_mul_f32 v[34:35], v[144:145], v[144:145]
    v_pk_mul_f32 v[36:37], v[146:147], v[146:147]
    v_pk_mul_f32 v[38:39], v[148:149], v[148:149]
    v_pk_mul_f32 v[40:41], v[150:151], v[150:151]
    v_pk_fma_f32 v[34:35], v[34:35], s[94:95], v[26:27]
    v_pk_fma_f32 v[36:37], v[36:37], s[94:95], v[26:27]
    v_pk_fma_f32 v[38:39], v[38:39], s[94:95], v[26:27]
    v_pk_fma_f32 v[40:41], v[40:41], s[94:95], v[26:27]
    v_pk_mul_f32 v[34:35], v[34:35], v[144:145]
    v_pk_mul_f32 v[36:37], v[36:37], v[146:147]
    v_pk_mul_f32 v[38:39], v[38:39], v[148:149]
    v_pk_mul_f32 v[40:41], v[40:41], v[150:151]
    v_exp_f32 v34, v34
    v_exp_f32 v35, v35
    v_exp_f32 v36, v36
    v_exp_f32 v37, v37
    v_exp_f32 v38, v38
    s_mov_b32 s83, 753664
    s_add_u32 m0, s3, 90112
    s_nop 0
    buffer_load_dwordx4 v17, s[48:51], s83 offen lds
    buffer_load_dwordx4 v18, s[48:51], s83 offen offset:1024 lds
    v_exp_f32 v39, v39
    v_exp_f32 v40, v40
    v_exp_f32 v41, v41
    v_pk_mul_f32 v[152:153], v[152:153], v[144:145]
    v_pk_mul_f32 v[154:155], v[154:155], v[146:147]
    v_pk_mul_f32 v[156:157], v[156:157], v[148:149]
    v_pk_mul_f32 v[158:159], v[158:159], v[150:151]
    v_pk_add_f32 v[34:35], v[34:35], 1.0 op_sel_hi:[1,0]
    v_pk_add_f32 v[36:37], v[36:37], 1.0 op_sel_hi:[1,0]
    v_pk_add_f32 v[38:39], v[38:39], 1.0 op_sel_hi:[1,0]
    v_pk_add_f32 v[40:41], v[40:41], 1.0 op_sel_hi:[1,0]
    v_rcp_f32 v34, v34
    v_rcp_f32 v35, v35
    v_rcp_f32 v36, v36
    v_rcp_f32 v37, v37
    v_rcp_f32 v38, v38
    v_rcp_f32 v39, v39
    v_rcp_f32 v40, v40
    v_rcp_f32 v41, v41
    v_pk_mul_f32 v[152:153], v[152:153], v[34:35]
    v_pk_mul_f32 v[154:155], v[154:155], v[36:37]
    v_pk_mul_f32 v[156:157], v[156:157], v[38:39]
    v_pk_mul_f32 v[158:159], v[158:159], v[40:41]
    v_cvt_pk_bf16_f32 v144, v152, v153
    v_cvt_pk_bf16_f32 v145, v154, v155
    v_cvt_pk_bf16_f32 v146, v156, v157
    v_cvt_pk_bf16_f32 v147, v158, v159
    buffer_store_dwordx4 v[144:147], v16, s[56:59], s89 offen offset:1024 sc1
    v_accvgpr_read_b32 v160, a160
    v_accvgpr_read_b32 v161, a161
    v_accvgpr_read_b32 v162, a162
    v_accvgpr_read_b32 v163, a163
    v_accvgpr_read_b32 v164, a164
    s_mov_b32 s82, 983040
    s_add_u32 m0, s3, 98304
    s_nop 0
    buffer_load_dwordx4 v17, s[48:51], s82 offen lds
    buffer_load_dwordx4 v18, s[48:51], s82 offen offset:1024 lds
    v_accvgpr_read_b32 v165, a165
    v_accvgpr_read_b32 v166, a166
    v_accvgpr_read_b32 v167, a167
    v_accvgpr_read_b32 v168, a168
    v_accvgpr_read_b32 v169, a169
    v_accvgpr_read_b32 v170, a170
    v_accvgpr_read_b32 v171, a171
    v_accvgpr_read_b32 v172, a172
    v_accvgpr_read_b32 v173, a173
    v_accvgpr_read_b32 v174, a174
    v_accvgpr_read_b32 v175, a175
    v_pk_mul_f32 v[34:35], v[160:161], v[160:161]
    v_pk_mul_f32 v[36:37], v[162:163], v[162:163]
    v_pk_mul_f32 v[38:39], v[164:165], v[164:165]
    v_pk_mul_f32 v[40:41], v[166:167], v[166:167]
    v_pk_fma_f32 v[34:35], v[34:35], s[94:95], v[26:27]
    v_pk_fma_f32 v[36:37], v[36:37], s[94:95], v[26:27]
    v_pk_fma_f32 v[38:39], v[38:39], s[94:95], v[26:27]
    v_pk_fma_f32 v[40:41], v[40:41], s[94:95], v[26:27]
    v_pk_mul_f32 v[34:35], v[34:35], v[160:161]
    v_pk_mul_f32 v[36:37], v[36:37], v[162:163]
    v_pk_mul_f32 v[38:39], v[38:39], v[164:165]
    v_pk_mul_f32 v[40:41], v[40:41], v[166:167]
    v_exp_f32 v34, v34
    v_exp_f32 v35, v35
    v_exp_f32 v36, v36
    v_exp_f32 v37, v37
    v_exp_f32 v38, v38
    s_mov_b32 s83, 1212416
    s_add_u32 m0, s3, 106496
    s_nop 0
    buffer_load_dwordx4 v17, s[48:51], s83 offen lds
    buffer_load_dwordx4 v18, s[48:51], s83 offen offset:1024 lds
    v_exp_f32 v39, v39
    v_exp_f32 v40, v40
    v_exp_f32 v41, v41
    v_pk_mul_f32 v[168:169], v[168:169], v[160:161]
    v_pk_mul_f32 v[170:171], v[170:171], v[162:163]
    v_pk_mul_f32 v[172:173], v[172:173], v[164:165]
    v_pk_mul_f32 v[174:175], v[174:175], v[166:167]
    v_pk_add_f32 v[34:35], v[34:35], 1.0 op_sel_hi:[1,0]
    v_pk_add_f32 v[36:37], v[36:37], 1.0 op_sel_hi:[1,0]
    v_pk_add_f32 v[38:39], v[38:39], 1.0 op_sel_hi:[1,0]
    v_pk_add_f32 v[40:41], v[40:41], 1.0 op_sel_hi:[1,0]
    v_rcp_f32 v34, v34
    v_rcp_f32 v35, v35
    v_rcp_f32 v36, v36
    v_rcp_f32 v37, v37
    v_rcp_f32 v38, v38
    v_rcp_f32 v39, v39
    v_rcp_f32 v40, v40
    v_rcp_f32 v41, v41
    v_pk_mul_f32 v[168:169], v[168:169], v[34:35]
    v_pk_mul_f32 v[170:171], v[170:171], v[36:37]
    v_pk_mul_f32 v[172:173], v[172:173], v[38:39]
    v_pk_mul_f32 v[174:175], v[174:175], v[40:41]
    v_cvt_pk_bf16_f32 v160, v168, v169
    v_cvt_pk_bf16_f32 v161, v170, v171
    v_cvt_pk_bf16_f32 v162, v172, v173
    v_cvt_pk_bf16_f32 v163, v174, v175
    buffer_store_dwordx4 v[160:163], v16, s[56:59], s89 offen offset:2048 sc1
    v_accvgpr_read_b32 v176, a176
    v_accvgpr_read_b32 v177, a177
    v_accvgpr_read_b32 v178, a178
    v_accvgpr_read_b32 v179, a179
    v_accvgpr_read_b32 v180, a180
    s_mov_b32 s82, 1441792
    s_add_u32 m0, s3, 114688
    s_nop 0
    buffer_load_dwordx4 v17, s[48:51], s82 offen lds
    buffer_load_dwordx4 v18, s[48:51], s82 offen offset:1024 lds
    v_accvgpr_read_b32 v181, a181
    v_accvgpr_read_b32 v182, a182
    v_accvgpr_read_b32 v183, a183
    v_accvgpr_read_b32 v184, a184
    v_accvgpr_read_b32 v185, a185
    v_accvgpr_read_b32 v186, a186
    v_accvgpr_read_b32 v187, a187
    v_accvgpr_read_b32 v188, a188
    v_accvgpr_read_b32 v189, a189
    v_accvgpr_read_b32 v190, a190
    v_accvgpr_read_b32 v191, a191
    v_pk_mul_f32 v[34:35], v[176:177], v[176:177]
    v_pk_mul_f32 v[36:37], v[178:179], v[178:179]
    v_pk_mul_f32 v[38:39], v[180:181], v[180:181]
    v_pk_mul_f32 v[40:41], v[182:183], v[182:183]
    v_pk_fma_f32 v[34:35], v[34:35], s[94:95], v[26:27]
    v_pk_fma_f32 v[36:37], v[36:37], s[94:95], v[26:27]
    v_pk_fma_f32 v[38:39], v[38:39], s[94:95], v[26:27]
    v_pk_fma_f32 v[40:41], v[40:41], s[94:95], v[26:27]
    v_pk_mul_f32 v[34:35], v[34:35], v[176:177]
    v_pk_mul_f32 v[36:37], v[36:37], v[178:179]
    v_pk_mul_f32 v[38:39], v[38:39], v[180:181]
    v_pk_mul_f32 v[40:41], v[40:41], v[182:183]
    v_exp_f32 v34, v34
    v_exp_f32 v35, v35
    v_exp_f32 v36, v36
    v_exp_f32 v37, v37
    v_exp_f32 v38, v38
    s_mov_b32 s83, 1671168
    s_add_u32 m0, s3, 122880
    s_nop 0
    buffer_load_dwordx4 v17, s[48:51], s83 offen lds
    buffer_load_dwordx4 v18, s[48:51], s83 offen offset:1024 lds
    v_exp_f32 v39, v39
    v_exp_f32 v40, v40
    v_exp_f32 v41, v41
    v_pk_mul_f32 v[184:185], v[184:185], v[176:177]
    v_pk_mul_f32 v[186:187], v[186:187], v[178:179]
    v_pk_mul_f32 v[188:189], v[188:189], v[180:181]
    v_pk_mul_f32 v[190:191], v[190:191], v[182:183]
    v_pk_add_f32 v[34:35], v[34:35], 1.0 op_sel_hi:[1,0]
    v_pk_add_f32 v[36:37], v[36:37], 1.0 op_sel_hi:[1,0]
    v_pk_add_f32 v[38:39], v[38:39], 1.0 op_sel_hi:[1,0]
    v_pk_add_f32 v[40:41], v[40:41], 1.0 op_sel_hi:[1,0]
    v_rcp_f32 v34, v34
    v_rcp_f32 v35, v35
    v_rcp_f32 v36, v36
    v_rcp_f32 v37, v37
    v_rcp_f32 v38, v38
    v_rcp_f32 v39, v39
    v_rcp_f32 v40, v40
    v_rcp_f32 v41, v41
    v_pk_mul_f32 v[184:185], v[184:185], v[34:35]
    v_pk_mul_f32 v[186:187], v[186:187], v[36:37]
    v_pk_mul_f32 v[188:189], v[188:189], v[38:39]
    v_pk_mul_f32 v[190:191], v[190:191], v[40:41]
    v_cvt_pk_bf16_f32 v176, v184, v185
    v_cvt_pk_bf16_f32 v177, v186, v187
    v_cvt_pk_bf16_f32 v178, v188, v189
    v_cvt_pk_bf16_f32 v179, v190, v191
    buffer_store_dwordx4 v[176:179], v16, s[56:59], s89 offen offset:3072 sc1
    v_accvgpr_read_b32 v128, a192
    v_accvgpr_read_b32 v129, a193
    v_accvgpr_read_b32 v130, a194
    v_accvgpr_read_b32 v131, a195
    v_accvgpr_read_b32 v132, a196
    s_mov_b32 s82, 131072
    s_add_u32 m0, s3, 131072
    s_nop 0
    buffer_load_dwordx4 v17, s[48:51], s82 offen lds
    buffer_load_dwordx4 v18, s[48:51], s82 offen offset:1024 lds
    v_accvgpr_read_b32 v133, a197
    v_accvgpr_read_b32 v134, a198
    v_accvgpr_read_b32 v135, a199
    v_accvgpr_read_b32 v136, a200
    v_accvgpr_read_b32 v137, a201
    v_accvgpr_read_b32 v138, a202
    v_accvgpr_read_b32 v139, a203
    v_accvgpr_read_b32 v140, a204
    v_accvgpr_read_b32 v141, a205
    v_accvgpr_read_b32 v142, a206
    v_accvgpr_read_b32 v143, a207
    v_pk_mul_f32 v[34:35], v[128:129], v[128:129]
    v_pk_mul_f32 v[36:37], v[130:131], v[130:131]
    v_pk_mul_f32 v[38:39], v[132:133], v[132:133]
    v_pk_mul_f32 v[40:41], v[134:135], v[134:135]
    v_pk_fma_f32 v[34:35], v[34:35], s[94:95], v[26:27]
    v_pk_fma_f32 v[36:37], v[36:37], s[94:95], v[26:27]
    v_pk_fma_f32 v[38:39], v[38:39], s[94:95], v[26:27]
    v_pk_fma_f32 v[40:41], v[40:41], s[94:95], v[26:27]
    v_pk_mul_f32 v[34:35], v[34:35], v[128:129]
    v_pk_mul_f32 v[36:37], v[36:37], v[130:131]
    v_pk_mul_f32 v[38:39], v[38:39], v[132:133]
    v_pk_mul_f32 v[40:41], v[40:41], v[134:135]
    v_exp_f32 v34, v34
    v_exp_f32 v35, v35
    v_exp_f32 v36, v36
    v_exp_f32 v37, v37
    v_exp_f32 v38, v38
    s_mov_b32 s83, 360448
    s_add_u32 m0, s3, 139264
    s_nop 0
    buffer_load_dwordx4 v17, s[48:51], s83 offen lds
    buffer_load_dwordx4 v18, s[48:51], s83 offen offset:1024 lds
    v_exp_f32 v39, v39
    v_exp_f32 v40, v40
    v_exp_f32 v41, v41
    v_pk_mul_f32 v[136:137], v[136:137], v[128:129]
    v_pk_mul_f32 v[138:139], v[138:139], v[130:131]
    v_pk_mul_f32 v[140:141], v[140:141], v[132:133]
    v_pk_mul_f32 v[142:143], v[142:143], v[134:135]
    v_pk_add_f32 v[34:35], v[34:35], 1.0 op_sel_hi:[1,0]
    v_pk_add_f32 v[36:37], v[36:37], 1.0 op_sel_hi:[1,0]
    v_pk_add_f32 v[38:39], v[38:39], 1.0 op_sel_hi:[1,0]
    v_pk_add_f32 v[40:41], v[40:41], 1.0 op_sel_hi:[1,0]
    v_rcp_f32 v34, v34
    v_rcp_f32 v35, v35
    v_rcp_f32 v36, v36
    v_rcp_f32 v37, v37
    v_rcp_f32 v38, v38
    v_rcp_f32 v39, v39
    v_rcp_f32 v40, v40
    v_rcp_f32 v41, v41
    v_pk_mul_f32 v[136:137], v[136:137], v[34:35]
    v_pk_mul_f32 v[138:139], v[138:139], v[36:37]
    v_pk_mul_f32 v[140:141], v[140:141], v[38:39]
    v_pk_mul_f32 v[142:143], v[142:143], v[40:41]
    v_cvt_pk_bf16_f32 v128, v136, v137
    v_cvt_pk_bf16_f32 v129, v138, v139
    v_cvt_pk_bf16_f32 v130, v140, v141
    v_cvt_pk_bf16_f32 v131, v142, v143
    s_add_u32 s89, s89, 4096
    buffer_store_dwordx4 v[128:131], v16, s[56:59], s89 offen offset:0 sc1
    v_accvgpr_read_b32 v144, a208
    v_accvgpr_read_b32 v145, a209
    v_accvgpr_read_b32 v146, a210
    v_accvgpr_read_b32 v147, a211
    v_accvgpr_read_b32 v148, a212
    s_mov_b32 s82, 589824
    s_add_u32 m0, s3, 147456
    s_nop 0
    buffer_load_dwordx4 v17, s[48:51], s82 offen lds
    buffer_load_dwordx4 v18, s[48:51], s82 offen offset:1024 lds
    v_accvgpr_read_b32 v149, a213
    v_accvgpr_read_b32 v150, a214
    v_accvgpr_read_b32 v151, a215
    v_accvgpr_read_b32 v152, a216
    v_accvgpr_read_b32 v153, a217
    v_accvgpr_read_b32 v154, a218
    v_accvgpr_read_b32 v155, a219
    v_accvgpr_read_b32 v156, a220
    v_accvgpr_read_b32 v157, a221
    v_accvgpr_read_b32 v158, a222
    v_accvgpr_read_b32 v159, a223
    v_pk_mul_f32 v[34:35], v[144:145], v[144:145]
    v_pk_mul_f32 v[36:37], v[146:147], v[146:147]
    v_pk_mul_f32 v[38:39], v[148:149], v[148:149]
    v_pk_mul_f32 v[40:41], v[150:151], v[150:151]
    v_pk_fma_f32 v[34:35], v[34:35], s[94:95], v[26:27]
    v_pk_fma_f32 v[36:37], v[36:37], s[94:95], v[26:27]
    v_pk_fma_f32 v[38:39], v[38:39], s[94:95], v[26:27]
    v_pk_fma_f32 v[40:41], v[40:41], s[94:95], v[26:27]
    v_pk_mul_f32 v[34:35], v[34:35], v[144:145]
    v_pk_mul_f32 v[36:37], v[36:37], v[146:147]
    v_pk_mul_f32 v[38:39], v[38:39], v[148:149]
    v_pk_mul_f32 v[40:41], v[40:41], v[150:151]
    v_exp_f32 v34, v34
    v_exp_f32 v35, v35
    v_exp_f32 v36, v36
    v_exp_f32 v37, v37
    v_exp_f32 v38, v38
    s_mov_b32 s83, 819200
    s_add_u32 m0, s3, 155648
    s_nop 0
    buffer_load_dwordx4 v17, s[48:51], s83 offen lds
    buffer_load_dwordx4 v18, s[48:51], s83 offen offset:1024 lds
    v_exp_f32 v39, v39
    v_exp_f32 v40, v40
    v_exp_f32 v41, v41
    v_pk_mul_f32 v[152:153], v[152:153], v[144:145]
    v_pk_mul_f32 v[154:155], v[154:155], v[146:147]
    v_pk_mul_f32 v[156:157], v[156:157], v[148:149]
    v_pk_mul_f32 v[158:159], v[158:159], v[150:151]
    v_pk_add_f32 v[34:35], v[34:35], 1.0 op_sel_hi:[1,0]
    v_pk_add_f32 v[36:37], v[36:37], 1.0 op_sel_hi:[1,0]
    v_pk_add_f32 v[38:39], v[38:39], 1.0 op_sel_hi:[1,0]
    v_pk_add_f32 v[40:41], v[40:41], 1.0 op_sel_hi:[1,0]
    v_rcp_f32 v34, v34
    v_rcp_f32 v35, v35
    v_rcp_f32 v36, v36
    v_rcp_f32 v37, v37
    v_rcp_f32 v38, v38
    v_rcp_f32 v39, v39
    v_rcp_f32 v40, v40
    v_rcp_f32 v41, v41
    v_pk_mul_f32 v[152:153], v[152:153], v[34:35]
    v_pk_mul_f32 v[154:155], v[154:155], v[36:37]
    v_pk_mul_f32 v[156:157], v[156:157], v[38:39]
    v_pk_mul_f32 v[158:159], v[158:159], v[40:41]
    v_cvt_pk_bf16_f32 v144, v152, v153
    v_cvt_pk_bf16_f32 v145, v154, v155
    v_cvt_pk_bf16_f32 v146, v156, v157
    v_cvt_pk_bf16_f32 v147, v158, v159
    buffer_store_dwordx4 v[144:147], v16, s[56:59], s89 offen offset:1024 sc1
    v_accvgpr_read_b32 v160, a224
    v_accvgpr_read_b32 v161, a225
    v_accvgpr_read_b32 v162, a226
    v_accvgpr_read_b32 v163, a227
    v_accvgpr_read_b32 v164, a228
    v_accvgpr_read_b32 v165, a229
    v_accvgpr_read_b32 v166, a230
    v_accvgpr_read_b32 v167, a231
    v_accvgpr_read_b32 v168, a232
    v_accvgpr_read_b32 v169, a233
    v_accvgpr_read_b32 v170, a234
    v_accvgpr_read_b32 v171, a235
    v_accvgpr_read_b32 v172, a236
    v_accvgpr_read_b32 v173, a237
    v_accvgpr_read_b32 v174, a238
    v_accvgpr_read_b32 v175, a239
    v_pk_mul_f32 v[34:35], v[160:161], v[160:161]
    v_pk_mul_f32 v[36:37], v[162:163], v[162:163]
    v_pk_mul_f32 v[38:39], v[164:165], v[164:165]
    v_pk_mul_f32 v[40:41], v[166:167], v[166:167]
    v_pk_fma_f32 v[34:35], v[34:35], s[94:95], v[26:27]
    v_pk_fma_f32 v[36:37], v[36:37], s[94:95], v[26:27]
    v_pk_fma_f32 v[38:39], v[38:39], s[94:95], v[26:27]
    v_pk_fma_f32 v[40:41], v[40:41], s[94:95], v[26:27]
    v_pk_mul_f32 v[34:35], v[34:35], v[160:161]
    v_pk_mul_f32 v[36:37], v[36:37], v[162:163]
    v_pk_mul_f32 v[38:39], v[38:39], v[164:165]
    v_pk_mul_f32 v[40:41], v[40:41], v[166:167]
    v_exp_f32 v34, v34
    v_exp_f32 v35, v35
    v_exp_f32 v36, v36
    v_exp_f32 v37, v37
    v_exp_f32 v38, v38
    v_exp_f32 v39, v39
    v_exp_f32 v40, v40
    v_exp_f32 v41, v41
    v_pk_mul_f32 v[168:169], v[168:169], v[160:161]
    v_pk_mul_f32 v[170:171], v[170:171], v[162:163]
    v_pk_mul_f32 v[172:173], v[172:173], v[164:165]
    v_pk_mul_f32 v[174:175], v[174:175], v[166:167]
    v_pk_add_f32 v[34:35], v[34:35], 1.0 op_sel_hi:[1,0]
    v_pk_add_f32 v[36:37], v[36:37], 1.0 op_sel_hi:[1,0]
    v_pk_add_f32 v[38:39], v[38:39], 1.0 op_sel_hi:[1,0]
    v_pk_add_f32 v[40:41], v[40:41], 1.0 op_sel_hi:[1,0]
    v_rcp_f32 v34, v34
    v_rcp_f32 v35, v35
    v_rcp_f32 v36, v36
    v_rcp_f32 v37, v37
    v_rcp_f32 v38, v38
    v_rcp_f32 v39, v39
    v_rcp_f32 v40, v40
    v_rcp_f32 v41, v41
    v_pk_mul_f32 v[168:169], v[168:169], v[34:35]
    v_pk_mul_f32 v[170:171], v[170:171], v[36:37]
    v_pk_mul_f32 v[172:173], v[172:173], v[38:39]
    v_pk_mul_f32 v[174:175], v[174:175], v[40:41]
    v_cvt_pk_bf16_f32 v160, v168, v169
    v_cvt_pk_bf16_f32 v161, v170, v171
    v_cvt_pk_bf16_f32 v162, v172, v173
    v_cvt_pk_bf16_f32 v163, v174, v175
    buffer_store_dwordx4 v[160:163], v16, s[56:59], s89 offen offset:2048 sc1
    v_accvgpr_read_b32 v176, a240
    v_accvgpr_read_b32 v177, a241
    v_accvgpr_read_b32 v178, a242
    v_accvgpr_read_b32 v179, a243
    v_accvgpr_read_b32 v180, a244
    v_accvgpr_read_b32 v181, a245
    v_accvgpr_read_b32 v182, a246
    v_accvgpr_read_b32 v183, a247
    v_accvgpr_read_b32 v184, a248
    v_accvgpr_read_b32 v185, a249
    v_accvgpr_read_b32 v186, a250
    v_accvgpr_read_b32 v187, a251
    v_accvgpr_read_b32 v188, a252
    v_accvgpr_read_b32 v189, a253
    v_accvgpr_read_b32 v190, a254
    v_accvgpr_read_b32 v191, a255
    v_pk_mul_f32 v[34:35], v[176:177], v[176:177]
    v_pk_mul_f32 v[36:37], v[178:179], v[178:179]
    v_pk_mul_f32 v[38:39], v[180:181], v[180:181]
    v_pk_mul_f32 v[40:41], v[182:183], v[182:183]
    v_pk_fma_f32 v[34:35], v[34:35], s[94:95], v[26:27]
    v_pk_fma_f32 v[36:37], v[36:37], s[94:95], v[26:27]
    v_pk_fma_f32 v[38:39], v[38:39], s[94:95], v[26:27]
    v_pk_fma_f32 v[40:41], v[40:41], s[94:95], v[26:27]
    v_pk_mul_f32 v[34:35], v[34:35], v[176:177]
    v_pk_mul_f32 v[36:37], v[36:37], v[178:179]
    v_pk_mul_f32 v[38:39], v[38:39], v[180:181]
    v_pk_mul_f32 v[40:41], v[40:41], v[182:183]
    v_exp_f32 v34, v34
    v_exp_f32 v35, v35
    v_exp_f32 v36, v36
    v_exp_f32 v37, v37
    v_exp_f32 v38, v38
    v_exp_f32 v39, v39
    v_exp_f32 v40, v40
    v_exp_f32 v41, v41
    v_pk_mul_f32 v[184:185], v[184:185], v[176:177]
    v_pk_mul_f32 v[186:187], v[186:187], v[178:179]
    v_pk_mul_f32 v[188:189], v[188:189], v[180:181]
    v_pk_mul_f32 v[190:191], v[190:191], v[182:183]
    v_pk_add_f32 v[34:35], v[34:35], 1.0 op_sel_hi:[1,0]
    v_pk_add_f32 v[36:37], v[36:37], 1.0 op_sel_hi:[1,0]
    v_pk_add_f32 v[38:39], v[38:39], 1.0 op_sel_hi:[1,0]
    v_pk_add_f32 v[40:41], v[40:41], 1.0 op_sel_hi:[1,0]
    v_rcp_f32 v34, v34
    v_rcp_f32 v35, v35
    v_rcp_f32 v36, v36
    v_rcp_f32 v37, v37
    v_rcp_f32 v38, v38
    v_rcp_f32 v39, v39
    v_rcp_f32 v40, v40
    v_rcp_f32 v41, v41
    v_pk_mul_f32 v[184:185], v[184:185], v[34:35]
    v_pk_mul_f32 v[186:187], v[186:187], v[36:37]
    v_pk_mul_f32 v[188:189], v[188:189], v[38:39]
    v_pk_mul_f32 v[190:191], v[190:191], v[40:41]
    v_cvt_pk_bf16_f32 v176, v184, v185
    v_cvt_pk_bf16_f32 v177, v186, v187
    v_cvt_pk_bf16_f32 v178, v188, v189
    v_cvt_pk_bf16_f32 v179, v190, v191
    buffer_store_dwordx4 v[176:179], v16, s[56:59], s89 offen offset:3072 sc1
    v_pk_mul_f32 v[34:35], v[48:49], v[48:49]
    v_pk_mul_f32 v[36:37], v[50:51], v[50:51]
    v_pk_mul_f32 v[38:39], v[52:53], v[52:53]
    v_pk_mul_f32 v[40:41], v[54:55], v[54:55]
    v_pk_fma_f32 v[34:35], v[34:35], s[94:95], v[26:27]
    v_pk_fma_f32 v[36:37], v[36:37], s[94:95], v[26:27]
    v_pk_fma_f32 v[38:39], v[38:39], s[94:95], v[26:27]
    v_pk_fma_f32 v[40:41], v[40:41], s[94:95], v[26:27]
    v_pk_mul_f32 v[34:35], v[34:35], v[48:49]
    v_pk_mul_f32 v[36:37], v[36:37], v[50:51]
    v_pk_mul_f32 v[38:39], v[38:39], v[52:53]
    v_pk_mul_f32 v[40:41], v[40:41], v[54:55]
    v_exp_f32 v34, v34
    v_exp_f32 v35, v35
    v_exp_f32 v36, v36
    v_exp_f32 v37, v37
    v_exp_f32 v38, v38
    v_exp_f32 v39, v39
    v_exp_f32 v40, v40
    v_exp_f32 v41, v41
    v_pk_mul_f32 v[56:57], v[56:57], v[48:49]
    v_pk_mul_f32 v[58:59], v[58:59], v[50:51]
    v_pk_mul_f32 v[60:61], v[60:61], v[52:53]
    v_pk_mul_f32 v[62:63], v[62:63], v[54:55]
    v_pk_add_f32 v[34:35], v[34:35], 1.0 op_sel_hi:[1,0]
    v_pk_add_f32 v[36:37], v[36:37], 1.0 op_sel_hi:[1,0]
    v_pk_add_f32 v[38:39], v[38:39], 1.0 op_sel_hi:[1,0]
    v_pk_add_f32 v[40:41], v[40:41], 1.0 op_sel_hi:[1,0]
    v_rcp_f32 v34, v34
    v_rcp_f32 v35, v35
    v_rcp_f32 v36, v36
    v_rcp_f32 v37, v37
    v_rcp_f32 v38, v38
    v_rcp_f32 v39, v39
    v_rcp_f32 v40, v40
    v_rcp_f32 v41, v41
    v_pk_mul_f32 v[56:57], v[56:57], v[34:35]
    v_pk_mul_f32 v[58:59], v[58:59], v[36:37]
    v_pk_mul_f32 v[60:61], v[60:61], v[38:39]
    v_pk_mul_f32 v[62:63], v[62:63], v[40:41]
    v_cvt_pk_bf16_f32 v48, v56, v57
    v_cvt_pk_bf16_f32 v49, v58, v59
    v_cvt_pk_bf16_f32 v50, v60, v61
    v_cvt_pk_bf16_f32 v51, v62, v63
    s_nop 0
    v_permlane16_swap_b32 v48, v50
    v_permlane16_swap_b32 v49, v51
    buffer_store_dwordx4 v[48:51], v28, s[56:59], s90 offen offset:0 sc1
    v_pk_mul_f32 v[34:35], v[64:65], v[64:65]
    v_pk_mul_f32 v[36:37], v[66:67], v[66:67]
    v_pk_mul_f32 v[38:39], v[68:69], v[68:69]
    v_pk_mul_f32 v[40:41], v[70:71], v[70:71]
    v_pk_fma_f32 v[34:35], v[34:35], s[94:95], v[26:27]
    v_pk_fma_f32 v[36:37], v[36:37], s[94:95], v[26:27]
    v_pk_fma_f32 v[38:39], v[38:39], s[94:95], v[26:27]
    v_pk_fma_f32 v[40:41], v[40:41], s[94:95], v[26:27]
    v_pk_mul_f32 v[34:35], v[34:35], v[64:65]
    v_pk_mul_f32 v[36:37], v[36:37], v[66:67]
    v_pk_mul_f32 v[38:39], v[38:39], v[68:69]
    v_pk_mul_f32 v[40:41], v[40:41], v[70:71]
    v_exp_f32 v34, v34
    v_exp_f32 v35, v35
    v_exp_f32 v36, v36
    v_exp_f32 v37, v37
    v_exp_f32 v38, v38
    v_exp_f32 v39, v39
    v_exp_f32 v40, v40
    v_exp_f32 v41, v41
    v_pk_mul_f32 v[72:73], v[72:73], v[64:65]
    v_pk_mul_f32 v[74:75], v[74:75], v[66:67]
    v_pk_mul_f32 v[76:77], v[76:77], v[68:69]
    v_pk_mul_f32 v[78:79], v[78:79], v[70:71]
    v_pk_add_f32 v[34:35], v[34:35], 1.0 op_sel_hi:[1,0]
    v_pk_add_f32 v[36:37], v[36:37], 1.0 op_sel_hi:[1,0]
    v_pk_add_f32 v[38:39], v[38:39], 1.0 op_sel_hi:[1,0]
    v_pk_add_f32 v[40:41], v[40:41], 1.0 op_sel_hi:[1,0]
    v_rcp_f32 v34, v34
    v_rcp_f32 v35, v35
    v_rcp_f32 v36, v36
    v_rcp_f32 v37, v37
    v_rcp_f32 v38, v38
    v_rcp_f32 v39, v39
    v_rcp_f32 v40, v40
    v_rcp_f32 v41, v41
    v_pk_mul_f32 v[72:73], v[72:73], v[34:35]
    v_pk_mul_f32 v[74:75], v[74:75], v[36:37]
    v_pk_mul_f32 v[76:77], v[76:77], v[38:39]
    v_pk_mul_f32 v[78:79], v[78:79], v[40:41]
    v_cvt_pk_bf16_f32 v64, v72, v73
    v_cvt_pk_bf16_f32 v65, v74, v75
    v_cvt_pk_bf16_f32 v66, v76, v77
    v_cvt_pk_bf16_f32 v67, v78, v79
    s_nop 0
    v_permlane16_swap_b32 v64, v66
    v_permlane16_swap_b32 v65, v67
    buffer_store_dwordx4 v[64:67], v28, s[56:59], s90 offen offset:2048 sc1
    s_waitcnt vmcnt(2)
    s_mov_b64 exec, 1
    buffer_atomic_add v29, off, s[56:59], s92 sc1
    s_mov_b64 exec, -1
    v_pk_mul_f32 v[34:35], v[80:81], v[80:81]
    v_pk_mul_f32 v[36:37], v[82:83], v[82:83]
    v_pk_mul_f32 v[38:39], v[84:85], v[84:85]
    v_pk_mul_f32 v[40:41], v[86:87], v[86:87]
    v_pk_fma_f32 v[34:35], v[34:35], s[94:95], v[26:27]
    v_pk_fma_f32 v[36:37], v[36:37], s[94:95], v[26:27]
    v_pk_fma_f32 v[38:39], v[38:39], s[94:95], v[26:27]
    v_pk_fma_f32 v[40:41], v[40:41], s[94:95], v[26:27]
    v_pk_mul_f32 v[34:35], v[34:35], v[80:81]
    v_pk_mul_f32 v[36:37], v[36:37], v[82:83]
    v_pk_mul_f32 v[38:39], v[38:39], v[84:85]
    v_pk_mul_f32 v[40:41], v[40:41], v[86:87]
    v_exp_f32 v34, v34
    v_exp_f32 v35, v35
    v_exp_f32 v36, v36
    v_exp_f32 v37, v37
    v_exp_f32 v38, v38
    v_exp_f32 v39, v39
    v_exp_f32 v40, v40
    v_exp_f32 v41, v41
    v_pk_mul_f32 v[88:89], v[88:89], v[80:81]
    v_pk_mul_f32 v[90:91], v[90:91], v[82:83]
    v_pk_mul_f32 v[92:93], v[92:93], v[84:85]
    v_pk_mul_f32 v[94:95], v[94:95], v[86:87]
    v_pk_add_f32 v[34:35], v[34:35], 1.0 op_sel_hi:[1,0]
    v_pk_add_f32 v[36:37], v[36:37], 1.0 op_sel_hi:[1,0]
    v_pk_add_f32 v[38:39], v[38:39], 1.0 op_sel_hi:[1,0]
    v_pk_add_f32 v[40:41], v[40:41], 1.0 op_sel_hi:[1,0]
    v_rcp_f32 v34, v34
    v_rcp_f32 v35, v35
    v_rcp_f32 v36, v36
    v_rcp_f32 v37, v37
    v_rcp_f32 v38, v38
    v_rcp_f32 v39, v39
    v_rcp_f32 v40, v40
    v_rcp_f32 v41, v41
    v_pk_mul_f32 v[88:89], v[88:89], v[34:35]
    v_pk_mul_f32 v[90:91], v[90:91], v[36:37]
    v_pk_mul_f32 v[92:93], v[92:93], v[38:39]
    v_pk_mul_f32 v[94:95], v[94:95], v[40:41]
    v_cvt_pk_bf16_f32 v80, v88, v89
    v_cvt_pk_bf16_f32 v81, v90, v91
    v_cvt_pk_bf16_f32 v82, v92, v93
    v_cvt_pk_bf16_f32 v83, v94, v95
    s_nop 0
    v_permlane16_swap_b32 v80, v82
    v_permlane16_swap_b32 v81, v83
    s_add_u32 s90, s90, 4096
    buffer_store_dwordx4 v[80:83], v28, s[56:59], s90 offen offset:0 sc1
    v_pk_mul_f32 v[34:35], v[96:97], v[96:97]
    v_pk_mul_f32 v[36:37], v[98:99], v[98:99]
    v_pk_mul_f32 v[38:39], v[100:101], v[100:101]
    v_pk_mul_f32 v[40:41], v[102:103], v[102:103]
    v_pk_fma_f32 v[34:35], v[34:35], s[94:95], v[26:27]
    v_pk_fma_f32 v[36:37], v[36:37], s[94:95], v[26:27]
    v_pk_fma_f32 v[38:39], v[38:39], s[94:95], v[26:27]
    v_pk_fma_f32 v[40:41], v[40:41], s[94:95], v[26:27]
    v_pk_mul_f32 v[34:35], v[34:35], v[96:97]
    v_pk_mul_f32 v[36:37], v[36:37], v[98:99]
    v_pk_mul_f32 v[38:39], v[38:39], v[100:101]
    v_pk_mul_f32 v[40:41], v[40:41], v[102:103]
    v_exp_f32 v34, v34
    v_exp_f32 v35, v35
    v_exp_f32 v36, v36
    v_exp_f32 v37, v37
    v_exp_f32 v38, v38
    v_exp_f32 v39, v39
    v_exp_f32 v40, v40
    v_exp_f32 v41, v41
    v_pk_mul_f32 v[104:105], v[104:105], v[96:97]
    v_pk_mul_f32 v[106:107], v[106:107], v[98:99]
    v_pk_mul_f32 v[108:109], v[108:109], v[100:101]
    v_pk_mul_f32 v[110:111], v[110:111], v[102:103]
    v_pk_add_f32 v[34:35], v[34:35], 1.0 op_sel_hi:[1,0]
    v_pk_add_f32 v[36:37], v[36:37], 1.0 op_sel_hi:[1,0]
    v_pk_add_f32 v[38:39], v[38:39], 1.0 op_sel_hi:[1,0]
    v_pk_add_f32 v[40:41], v[40:41], 1.0 op_sel_hi:[1,0]
    v_rcp_f32 v34, v34
    v_rcp_f32 v35, v35
    v_rcp_f32 v36, v36
    v_rcp_f32 v37, v37
    v_rcp_f32 v38, v38
    v_rcp_f32 v39, v39
    v_rcp_f32 v40, v40
    v_rcp_f32 v41, v41
    v_pk_mul_f32 v[104:105], v[104:105], v[34:35]
    v_pk_mul_f32 v[106:107], v[106:107], v[36:37]
    v_pk_mul_f32 v[108:109], v[108:109], v[38:39]
    v_pk_mul_f32 v[110:111], v[110:111], v[40:41]
    v_cvt_pk_bf16_f32 v96, v104, v105
    v_cvt_pk_bf16_f32 v97, v106, v107
    v_cvt_pk_bf16_f32 v98, v108, v109
    v_cvt_pk_bf16_f32 v99, v110, v111
    s_nop 0
    v_permlane16_swap_b32 v96, v98
    v_permlane16_swap_b32 v97, v99
    buffer_store_dwordx4 v[96:99], v28, s[56:59], s90 offen offset:2048 sc1
    s_mov_b32 s67, 0
    s_barrier
    buffer_load_dwordx4 a[0:3], v21, s[56:59], s68 offen sc1
    buffer_load_dwordx4 a[4:7], v22, s[56:59], s68 offen sc1
    buffer_load_dwordx4 a[8:11], v23, s[56:59], s68 offen sc1
    buffer_load_dwordx4 a[12:15], v24, s[56:59], s68 offen sc1
    s_add_u32 s68, s68, 16384
    buffer_load_dwordx4 a[16:19], v21, s[56:59], s68 offen sc1
    buffer_load_dwordx4 a[20:23], v22, s[56:59], s68 offen sc1
    buffer_load_dwordx4 a[24:27], v23, s[56:59], s68 offen sc1
    buffer_load_dwordx4 a[28:31], v24, s[56:59], s68 offen sc1
    s_add_u32 s68, s68, 16384
    buffer_load_dwordx4 a[32:35], v21, s[56:59], s68 offen sc1
    buffer_load_dwordx4 a[36:39], v22, s[56:59], s68 offen sc1
    buffer_load_dwordx4 a[40:43], v23, s[56:59], s68 offen sc1
    buffer_load_dwordx4 a[44:47], v24, s[56:59], s68 offen sc1
    s_add_u32 s68, s68, 16384
    buffer_load_dwordx4 a[48:51], v21, s[56:59], s68 offen sc1
    buffer_load_dwordx4 a[52:55], v22, s[56:59], s68 offen sc1
    buffer_load_dwordx4 a[56:59], v23, s[56:59], s68 offen sc1
    buffer_load_dwordx4 a[60:63], v24, s[56:59], s68 offen sc1
    s_add_u32 s68, s68, 16384
    buffer_load_dwordx4 a[64:67], v21, s[56:59], s68 offen sc1
    buffer_load_dwordx4 a[68:71], v22, s[56:59], s68 offen sc1
    buffer_load_dwordx4 a[72:75], v23, s[56:59], s68 offen sc1
    buffer_load_dwordx4 a[76:79], v24, s[56:59], s68 offen sc1
    s_add_u32 s68, s68, 16384
    buffer_load_dwordx4 a[80:83], v21, s[56:59], s68 offen sc1
    buffer_load_dwordx4 a[84:87], v22, s[56:59], s68 offen sc1
    buffer_load_dwordx4 a[88:91], v23, s[56:59], s68 offen sc1
    buffer_load_dwordx4 a[92:95], v24, s[56:59], s68 offen sc1
    s_add_u32 s68, s68, 16384
    buffer_load_dwordx4 a[96:99], v21, s[56:59], s68 offen sc1
    buffer_load_dwordx4 a[100:103], v22, s[56:59], s68 offen sc1
    buffer_load_dwordx4 a[104:107], v23, s[56:59], s68 offen sc1
    buffer_load_dwordx4 a[108:111], v24, s[56:59], s68 offen sc1
    s_add_u32 s68, s68, 16384
    buffer_load_dwordx4 a[112:115], v21, s[56:59], s68 offen sc1
    buffer_load_dwordx4 a[116:119], v22, s[56:59], s68 offen sc1
    buffer_load_dwordx4 a[120:123], v23, s[56:59], s68 offen sc1
    buffer_load_dwordx4 a[124:127], v24, s[56:59], s68 offen sc1
    s_add_u32 s68, s68, 16384
L_D:
    v_lshrrev_b32 v34, 2, v0
    v_and_b32 v35, 3, v0
    v_lshlrev_b32 v35, 3, v35
    v_lshl_add_u32 v35, v34, 8, v35
    v_and_b32 v34, 7, v34
    v_xor_b32 v36, 0, v34
    v_lshl_add_u32 v8, v36, 5, v35
    v_xor_b32 v36, 1, v34
    v_lshl_add_u32 v9, v36, 5, v35
    v_xor_b32 v36, 2, v34
    v_lshl_add_u32 v10, v36, 5, v35
    v_xor_b32 v36, 3, v34
    v_lshl_add_u32 v11, v36, 5, v35
    v_xor_b32 v36, 4, v34
    v_lshl_add_u32 v12, v36, 5, v35
    v_xor_b32 v36, 5, v34
    v_lshl_add_u32 v13, v36, 5, v35
    v_xor_b32 v36, 6, v34
    v_lshl_add_u32 v14, v36, 5, v35
    v_xor_b32 v36, 7, v34
    v_lshl_add_u32 v15, v36, 5, v35
    ds_read_b64_tr_b16 a[128:129], v8 offset:0
    ds_read_b64_tr_b16 a[130:131], v8 offset:4096
    ds_read_b64_tr_b16 a[132:133], v9 offset:0
    ds_read_b64_tr_b16 a[134:135], v9 offset:4096
    ds_read_b64_tr_b16 a[136:137], v10 offset:0
    ds_read_b64_tr_b16 a[138:139], v10 offset:4096
    ds_read_b64_tr_b16 a[140:141], v11 offset:0
    ds_read_b64_tr_b16 a[142:143], v11 offset:4096
    ds_read_b64_tr_b16 a[144:145], v12 offset:0
    ds_read_b64_tr_b16 a[146:147], v12 offset:4096
    ds_read_b64_tr_b16 a[148:149], v13 offset:0
    ds_read_b64_tr_b16 a[150:151], v13 offset:4096
    ds_read_b64_tr_b16 a[152:153], v14 offset:0
    ds_read_b64_tr_b16 a[154:155], v14 offset:4096
    ds_read_b64_tr_b16 a[156:157], v15 offset:0
    ds_read_b64_tr_b16 a[158:159], v15 offset:4096
    v_add_u32 v48, 0x10000, v8
    v_add_u32 v56, 0x20000, v8
    v_add_u32 v49, 0x10000, v9
    v_add_u32 v57, 0x20000, v9
    v_add_u32 v50, 0x10000, v10
    v_add_u32 v58, 0x20000, v10
    v_add_u32 v51, 0x10000, v11
    v_add_u32 v59, 0x20000, v11
    v_add_u32 v52, 0x10000, v12
    v_add_u32 v60, 0x20000, v12
    v_add_u32 v53, 0x10000, v13
    v_add_u32 v61, 0x20000, v13
    v_add_u32 v54, 0x10000, v14
    v_add_u32 v62, 0x20000, v14
    v_add_u32 v55, 0x10000, v15
    v_add_u32 v63, 0x20000, v15
    s_lshl_b32 s84, s63, 2
    s_add_u32 s84, s84, s60
    s_lshl_b32 s84, s84, 2
    s_add_u32 s84, s84, s65
    s_lshl_b32 s84, s84, 15
    s_lshl_b32 s85, s66, 8
    s_add_u32 s84, s84, s85
    v_and_b32 v34, 15, v0
    v_lshrrev_b32 v35, 4, v0
    v_lshlrev_b32 v36, 11, v34
    v_add_u32 v36, s84, v36
    v_lshl_add_u32 v1, v35, 3, v36
    v_and_b32 v2, 1, v35
    v_lshl_add_u32 v36, v2, 5, v36
    v_lshrrev_b32 v2, 1, v35
    v_lshl_add_u32 v2, v2, 4, v36
    v_lshlrev_b32 v35, 2, v35
    v_sub_u32 v34, v34, v35
    v_mov_b32 v26, 0
    v_mov_b32 v27, 0
    v_mov_b32 v30, 0
    v_mov_b32 v31, 0
    v_mov_b32 v35, 0x3f80
    v_mov_b32 v36, 0x3f800000
    v_cmp_eq_u32 vcc, 0, v34
    s_nop 1
    v_cndmask_b32 v28, v26, v35, vcc
    v_cmp_eq_u32 vcc, 1, v34
    s_nop 1
    v_cndmask_b32 v28, v28, v36, vcc
    v_cmp_eq_u32 vcc, 2, v34
    s_nop 1
    v_cndmask_b32 v29, v26, v35, vcc
    v_cmp_eq_u32 vcc, 3, v34
    s_nop 1
    v_cndmask_b32 v29, v29, v36, vcc
    s_mov_b32 s14, 0xbfb8aa3b
    s_mov_b32 s15, 0xbfb8aa3b
    s_waitcnt vmcnt(31) lgkmcnt(14)
    v_mfma_f32_16x16x32_bf16 v[128:131], a[128:131], a[0:3], 0
    s_waitcnt vmcnt(30)
    v_mfma_f32_16x16x32_bf16 v[160:163], a[128:131], a[4:7], 0
    ds_read_b64_tr_b16 a[160:161], v8 offset:8192
    s_waitcnt vmcnt(29)
    v_mfma_f32_16x16x32_bf16 v[192:195], a[128:131], a[8:11], 0
    ds_read_b64_tr_b16 a[162:163], v8 offset:12288
    s_waitcnt vmcnt(28)
    v_mfma_f32_16x16x32_bf16 v[224:227], a[128:131], a[12:15], 0
    s_waitcnt lgkmcnt(14)
    v_mfma_f32_16x16x32_bf16 v[132:135], a[132:135], a[0:3], 0
    ds_read_b64_tr_b16 a[164:165], v9 offset:8192
    v_mfma_f32_16x16x32_bf16 v[164:167], a[132:135], a[4:7], 0
    ds_read_b64_tr_b16 a[166:167], v9 offset:12288
    v_mfma_f32_16x16x32_bf16 v[196:199], a[132:135], a[8:11], 0
    v_mfma_f32_16x16x32_bf16 v[228:231], a[132:135], a[12:15], 0
    ds_read_b64_tr_b16 a[168:169], v10 offset:8192
    s_waitcnt lgkmcnt(15)
    v_mfma_f32_16x16x32_bf16 v[136:139], a[136:139], a[0:3], 0
    ds_read_b64_tr_b16 a[170:171], v10 offset:12288
    v_mfma_f32_16x16x32_bf16 v[168:171], a[136:139], a[4:7], 0
    v_mfma_f32_16x16x32_bf16 v[200:203], a[136:139], a[8:11], 0
    ds_read_b64_tr_b16 a[172:173], v11 offset:8192
    v_mfma_f32_16x16x32_bf16 v[232:235], a[136:139], a[12:15], 0
    ds_read_b64_tr_b16 a[174:175], v11 offset:12288
    s_waitcnt lgkmcnt(15)
    v_mfma_f32_16x16x32_bf16 v[140:143], a[140:143], a[0:3], 0
    v_mfma_f32_16x16x32_bf16 v[172:175], a[140:143], a[4:7], 0
    ds_read_b64_tr_b16 a[176:177], v12 offset:8192
    v_mfma_f32_16x16x32_bf16 v[204:207], a[140:143], a[8:11], 0
    ds_read_b64_tr_b16 a[178:179], v12 offset:12288
    v_mfma_f32_16x16x32_bf16 v[236:239], a[140:143], a[12:15], 0
    s_waitcnt lgkmcnt(15)
    v_mfma_f32_16x16x32_bf16 v[144:147], a[144:147], a[0:3], 0
    ds_read_b64_tr_b16 a[180:181], v13 offset:8192
    v_mfma_f32_16x16x32_bf16 v[176:179], a[144:147], a[4:7], 0
    ds_read_b64_tr_b16 a[182:183], v13 offset:12288
    v_mfma_f32_16x16x32_bf16 v[208:211], a[144:147], a[8:11], 0
    v_mfma_f32_16x16x32_bf16 v[240:243], a[144:147], a[12:15], 0
    ds_read_b64_tr_b16 a[184:185], v14 offset:8192
    s_waitcnt lgkmcnt(15)
    v_mfma_f32_16x16x32_bf16 v[148:151], a[148:151], a[0:3], 0
    ds_read_b64_tr_b16 a[186:187], v14 offset:12288
    s_mov_b64 exec, 1
    buffer_atomic_add v42, off, s[56:59], s93 sc1
    s_mov_b64 exec, -1
    v_mfma_f32_16x16x32_bf16 v[180:183], a[148:151], a[4:7], 0
    v_mfma_f32_16x16x32_bf16 v[212:215], a[148:151], a[8:11], 0
    ds_read_b64_tr_b16 a[188:189], v15 offset:8192
    v_mfma_f32_16x16x32_bf16 v[244:247], a[148:151], a[12:15], 0
    ds_read_b64_tr_b16 a[190:191], v15 offset:12288
    v_mfma_f32_16x16x32_bf16 v[152:155], a[152:155], a[0:3], 0
    v_mfma_f32_16x16x32_bf16 v[184:187], a[152:155], a[4:7], 0
    v_mfma_f32_16x16x32_bf16 v[216:219], a[152:155], a[8:11], 0
    v_mfma_f32_16x16x32_bf16 v[248:251], a[152:155], a[12:15], 0
    s_waitcnt lgkmcnt(15)
    v_mfma_f32_16x16x32_bf16 v[156:159], a[156:159], a[0:3], 0
    v_mfma_f32_16x16x32_bf16 v[188:191], a[156:159], a[4:7], 0
    v_mfma_f32_16x16x32_bf16 v[220:223], a[156:159], a[8:11], 0
    v_mfma_f32_16x16x32_bf16 v[252:255], a[156:159], a[12:15], 0
    s_waitcnt vmcnt(28) lgkmcnt(14)
    v_mfma_f32_16x16x32_bf16 v[128:131], a[160:163], a[16:19], v[128:131]
    buffer_load_dwordx4 a[0:3], v21, s[56:59], s68 offen sc1
    s_waitcnt vmcnt(28)
    v_mfma_f32_16x16x32_bf16 v[160:163], a[160:163], a[20:23], v[160:163]
    ds_read_b64_tr_b16 a[128:129], v8 offset:16384
    s_waitcnt vmcnt(27)
    v_mfma_f32_16x16x32_bf16 v[192:195], a[160:163], a[24:27], v[192:195]
    ds_read_b64_tr_b16 a[130:131], v8 offset:20480
    buffer_load_dwordx4 a[4:7], v22, s[56:59], s68 offen sc1
    s_waitcnt vmcnt(27)
    v_mfma_f32_16x16x32_bf16 v[224:227], a[160:163], a[28:31], v[224:227]
    s_waitcnt lgkmcnt(14)
    v_mfma_f32_16x16x32_bf16 v[132:135], a[164:167], a[16:19], v[132:135]
    ds_read_b64_tr_b16 a[132:133], v9 offset:16384
    buffer_load_dwordx4 a[8:11], v23, s[56:59], s68 offen sc1
    v_mfma_f32_16x16x32_bf16 v[164:167], a[164:167], a[20:23], v[164:167]
    ds_read_b64_tr_b16 a[134:135], v9 offset:20480
    v_mfma_f32_16x16x32_bf16 v[196:199], a[164:167], a[24:27], v[196:199]
    buffer_load_dwordx4 a[12:15], v24, s[56:59], s68 offen sc1
    v_mfma_f32_16x16x32_bf16 v[228:231], a[164:167], a[28:31], v[228:231]
    ds_read_b64_tr_b16 a[136:137], v10 offset:16384
    s_waitcnt lgkmcnt(15)
    v_mfma_f32_16x16x32_bf16 v[136:139], a[168:171], a[16:19], v[136:139]
    ds_read_b64_tr_b16 a[138:139], v10 offset:20480
    s_add_u32 s68, s68, 16384
    v_mfma_f32_16x16x32_bf16 v[168:171], a[168:171], a[20:23], v[168:171]
    v_mfma_f32_16x16x32_bf16 v[200:203], a[168:171], a[24:27], v[200:203]
    ds_read_b64_tr_b16 a[140:141], v11 offset:16384
    v_mfma_f32_16x16x32_bf16 v[232:235], a[168:171], a[28:31], v[232:235]
    ds_read_b64_tr_b16 a[142:143], v11 offset:20480
    s_waitcnt lgkmcnt(15)
    v_mfma_f32_16x16x32_bf16 v[140:143], a[172:175], a[16:19], v[140:143]
    v_mfma_f32_16x16x32_bf16 v[172:175], a[172:175], a[20:23], v[172:175]
    ds_read_b64_tr_b16 a[144:145], v12 offset:16384
    v_mfma_f32_16x16x32_bf16 v[204:207], a[172:175], a[24:27], v[204:207]
    ds_read_b64_tr_b16 a[146:147], v12 offset:20480
    v_mfma_f32_16x16x32_bf16 v[236:239], a[172:175], a[28:31], v[236:239]
    s_waitcnt lgkmcnt(15)
    v_mfma_f32_16x16x32_bf16 v[144:147], a[176:179], a[16:19], v[144:147]
    ds_read_b64_tr_b16 a[148:149], v13 offset:16384
    v_mfma_f32_16x16x32_bf16 v[176:179], a[176:179], a[20:23], v[176:179]
    ds_read_b64_tr_b16 a[150:151], v13 offset:20480
    v_mfma_f32_16x16x32_bf16 v[208:211], a[176:179], a[24:27], v[208:211]
    v_mfma_f32_16x16x32_bf16 v[240:243], a[176:179], a[28:31], v[240:243]
    ds_read_b64_tr_b16 a[152:153], v14 offset:16384
    s_waitcnt lgkmcnt(15)
    v_mfma_f32_16x16x32_bf16 v[148:151], a[180:183], a[16:19], v[148:151]
    ds_read_b64_tr_b16 a[154:155], v14 offset:20480
    v_mfma_f32_16x16x32_bf16 v[180:183], a[180:183], a[20:23], v[180:183]
    v_mfma_f32_16x16x32_bf16 v[212:215], a[180:183], a[24:27], v[212:215]
    ds_read_b64_tr_b16 a[156:157], v15 offset:16384
    v_mfma_f32_16x16x32_bf16 v[244:247], a[180:183], a[28:31], v[244:247]
    ds_read_b64_tr_b16 a[158:159], v15 offset:20480
    v_mfma_f32_16x16x32_bf16 v[152:155], a[184:187], a[16:19], v[152:155]
    v_mfma_f32_16x16x32_bf16 v[184:187], a[184:187], a[20:23], v[184:187]
    v_mfma_f32_16x16x32_bf16 v[216:219], a[184:187], a[24:27], v[216:219]
    v_mfma_f32_16x16x32_bf16 v[248:251], a[184:187], a[28:31], v[248:251]
    s_waitcnt lgkmcnt(15)
    v_mfma_f32_16x16x32_bf16 v[156:159], a[188:191], a[16:19], v[156:159]
    v_mfma_f32_16x16x32_bf16 v[188:191], a[188:191], a[20:23], v[188:191]
    v_mfma_f32_16x16x32_bf16 v[220:223], a[188:191], a[24:27], v[220:223]
    v_mfma_f32_16x16x32_bf16 v[252:255], a[188:191], a[28:31], v[252:255]
    s_waitcnt vmcnt(28) lgkmcnt(14)
    v_mfma_f32_16x16x32_bf16 v[128:131], a[128:131], a[32:35], v[128:131]
    buffer_load_dwordx4 a[16:19], v21, s[56:59], s68 offen sc1
    s_waitcnt vmcnt(28)
    v_mfma_f32_16x16x32_bf16 v[160:163], a[128:131], a[36:39], v[160:163]
    ds_read_b64_tr_b16 a[160:161], v8 offset:24576
    s_waitcnt vmcnt(27)
    v_mfma_f32_16x16x32_bf16 v[192:195], a[128:131], a[40:43], v[192:195]
    ds_read_b64_tr_b16 a[162:163], v8 offset:28672
    buffer_load_dwordx4 a[20:23], v22, s[56:59], s68 offen sc1
    s_waitcnt vmcnt(27)
    v_mfma_f32_16x16x32_bf16 v[224:227], a[128:131], a[44:47], v[224:227]
    s_waitcnt lgkmcnt(14)
    v_mfma_f32_16x16x32_bf16 v[132:135], a[132:135], a[32:35], v[132:135]
    ds_read_b64_tr_b16 a[164:165], v9 offset:24576
    buffer_load_dwordx4 a[24:27], v23, s[56:59], s68 offen sc1
    v_mfma_f32_16x16x32_bf16 v[164:167], a[132:135], a[36:39], v[164:167]
    ds_read_b64_tr_b16 a[166:167], v9 offset:28672
    v_mfma_f32_16x16x32_bf16 v[196:199], a[132:135], a[40:43], v[196:199]
    buffer_load_dwordx4 a[28:31], v24, s[56:59], s68 offen sc1
    v_mfma_f32_16x16x32_bf16 v[228:231], a[132:135], a[44:47], v[228:231]
    ds_read_b64_tr_b16 a[168:169], v10 offset:24576
    s_waitcnt lgkmcnt(15)
    v_mfma_f32_16x16x32_bf16 v[136:139], a[136:139], a[32:35], v[136:139]
    ds_read_b64_tr_b16 a[170:171], v10 offset:28672
    s_add_u32 s68, s68, 16384
    v_mfma_f32_16x16x32_bf16 v[168:171], a[136:139], a[36:39], v[168:171]
    v_mfma_f32_16x16x32_bf16 v[200:203], a[136:139], a[40:43], v[200:203]
    ds_read_b64_tr_b16 a[172:173], v11 offset:24576
    global_load_dwordx2 v[66:67], v1, s[8:9] offset:0
    v_mfma_f32_16x16x32_bf16 v[232:235], a[136:139], a[44:47], v[232:235]
    ds_read_b64_tr_b16 a[174:175], v11 offset:28672
    s_waitcnt lgkmcnt(15)
    v_mfma_f32_16x16x32_bf16 v[140:143], a[140:143], a[32:35], v[140:143]
    global_load_dwordx2 v[70:71], v1, s[8:9] offset:32
    v_mfma_f32_16x16x32_bf16 v[172:175], a[140:143], a[36:39], v[172:175]
    ds_read_b64_tr_b16 a[176:177], v12 offset:24576
    v_mfma_f32_16x16x32_bf16 v[204:207], a[140:143], a[40:43], v[204:207]
    ds_read_b64_tr_b16 a[178:179], v12 offset:28672
    global_load_dwordx2 v[74:75], v1, s[8:9] offset:64
    v_mfma_f32_16x16x32_bf16 v[236:239], a[140:143], a[44:47], v[236:239]
    s_waitcnt lgkmcnt(15)
    v_mfma_f32_16x16x32_bf16 v[144:147], a[144:147], a[32:35], v[144:147]
    ds_read_b64_tr_b16 a[180:181], v13 offset:24576
    global_load_dwordx2 v[78:79], v1, s[8:9] offset:96
    v_mfma_f32_16x16x32_bf16 v[176:179], a[144:147], a[36:39], v[176:179]
    ds_read_b64_tr_b16 a[182:183], v13 offset:28672
    v_mfma_f32_16x16x32_bf16 v[208:211], a[144:147], a[40:43], v[208:211]
    global_load_dwordx2 v[82:83], v1, s[8:9] offset:128
    v_mfma_f32_16x16x32_bf16 v[240:243], a[144:147], a[44:47], v[240:243]
    ds_read_b64_tr_b16 a[184:185], v14 offset:24576
    s_waitcnt lgkmcnt(15)
    v_mfma_f32_16x16x32_bf16 v[148:151], a[148:151], a[32:35], v[148:151]
    ds_read_b64_tr_b16 a[186:187], v14 offset:28672
    global_load_dwordx2 v[86:87], v1, s[8:9] offset:160
    v_mfma_f32_16x16x32_bf16 v[180:183], a[148:151], a[36:39], v[180:183]
    v_mfma_f32_16x16x32_bf16 v[212:215], a[148:151], a[40:43], v[212:215]
    ds_read_b64_tr_b16 a[188:189], v15 offset:24576
    global_load_dwordx2 v[90:91], v1, s[8:9] offset:192
    v_mfma_f32_16x16x32_bf16 v[244:247], a[148:151], a[44:47], v[244:247]
    ds_read_b64_tr_b16 a[190:191], v15 offset:28672
    v_mfma_f32_16x16x32_bf16 v[152:155], a[152:155], a[32:35], v[152:155]
    global_load_dwordx2 v[94:95], v1, s[8:9] offset:224
    v_mfma_f32_16x16x32_bf16 v[184:187], a[152:155], a[36:39], v[184:187]
    v_mfma_f32_16x16x32_bf16 v[216:219], a[152:155], a[40:43], v[216:219]
    v_mfma_f32_16x16x32_bf16 v[248:251], a[152:155], a[44:47], v[248:251]
    s_waitcnt lgkmcnt(15)
    v_mfma_f32_16x16x32_bf16 v[156:159], a[156:159], a[32:35], v[156:159]
    v_mfma_f32_16x16x32_bf16 v[188:191], a[156:159], a[36:39], v[188:191]
    v_mfma_f32_16x16x32_bf16 v[220:223], a[156:159], a[40:43], v[220:223]
    v_mfma_f32_16x16x32_bf16 v[252:255], a[156:159], a[44:47], v[252:255]
    s_waitcnt vmcnt(36) lgkmcnt(14)
    v_mfma_f32_16x16x32_bf16 v[128:131], a[160:163], a[48:51], v[128:131]
    buffer_load_dwordx4 a[32:35], v21, s[56:59], s68 offen sc1
    s_waitcnt vmcnt(36)
    v_mfma_f32_16x16x32_bf16 v[160:163], a[160:163], a[52:55], v[160:163]
    ds_read_b64_tr_b16 a[128:129], v8 offset:32768
    s_waitcnt vmcnt(35)
    v_mfma_f32_16x16x32_bf16 v[192:195], a[160:163], a[56:59], v[192:195]
    ds_read_b64_tr_b16 a[130:131], v8 offset:36864
    buffer_load_dwordx4 a[36:39], v22, s[56:59], s68 offen sc1
    s_waitcnt vmcnt(35)
    v_mfma_f32_16x16x32_bf16 v[224:227], a[160:163], a[60:63], v[224:227]
    s_waitcnt lgkmcnt(14)
    v_mfma_f32_16x16x32_bf16 v[132:135], a[164:167], a[48:51], v[132:135]
    ds_read_b64_tr_b16 a[132:133], v9 offset:32768
    buffer_load_dwordx4 a[40:43], v23, s[56:59], s68 offen sc1
    v_mfma_f32_16x16x32_bf16 v[164:167], a[164:167], a[52:55], v[164:167]
    ds_read_b64_tr_b16 a[134:135], v9 offset:36864
    v_mfma_f32_16x16x32_bf16 v[196:199], a[164:167], a[56:59], v[196:199]
    buffer_load_dwordx4 a[44:47], v24, s[56:59], s68 offen sc1
    v_mfma_f32_16x16x32_bf16 v[228:231], a[164:167], a[60:63], v[228:231]
    ds_read_b64_tr_b16 a[136:137], v10 offset:32768
    s_waitcnt lgkmcnt(15)
    v_mfma_f32_16x16x32_bf16 v[136:139], a[168:171], a[48:51], v[136:139]
    ds_read_b64_tr_b16 a[138:139], v10 offset:36864
    s_add_u32 s68, s68, 16384
    v_mfma_f32_16x16x32_bf16 v[168:171], a[168:171], a[52:55], v[168:171]
    v_mfma_f32_16x16x32_bf16 v[200:203], a[168:171], a[56:59], v[200:203]
    ds_read_b64_tr_b16 a[140:141], v11 offset:32768
    v_mfma_f32_16x16x32_bf16 v[232:235], a[168:171], a[60:63], v[232:235]
    ds_read_b64_tr_b16 a[142:143], v11 offset:36864
    s_waitcnt lgkmcnt(15)
    v_mfma_f32_16x16x32_bf16 v[140:143], a[172:175], a[48:51], v[140:143]
    v_mfma_f32_16x16x32_bf16 v[172:175], a[172:175], a[52:55], v[172:175]
    ds_read_b64_tr_b16 a[144:145], v12 offset:32768
    v_mfma_f32_16x16x32_bf16 v[204:207], a[172:175], a[56:59], v[204:207]
    ds_read_b64_tr_b16 a[146:147], v12 offset:36864
    v_mfma_f32_16x16x32_bf16 v[236:239], a[172:175], a[60:63], v[236:239]
    s_waitcnt lgkmcnt(15)
    v_mfma_f32_16x16x32_bf16 v[144:147], a[176:179], a[48:51], v[144:147]
    ds_read_b64_tr_b16 a[148:149], v13 offset:32768
    v_mfma_f32_16x16x32_bf16 v[176:179], a[176:179], a[52:55], v[176:179]
    ds_read_b64_tr_b16 a[150:151], v13 offset:36864
    v_mfma_f32_16x16x32_bf16 v[208:211], a[176:179], a[56:59], v[208:211]
    v_mfma_f32_16x16x32_bf16 v[240:243], a[176:179], a[60:63], v[240:243]
    ds_read_b64_tr_b16 a[152:153], v14 offset:32768
    s_waitcnt lgkmcnt(15)
    v_mfma_f32_16x16x32_bf16 v[148:151], a[180:183], a[48:51], v[148:151]
    ds_read_b64_tr_b16 a[154:155], v14 offset:36864
    v_mfma_f32_16x16x32_bf16 v[180:183], a[180:183], a[52:55], v[180:183]
    v_mfma_f32_16x16x32_bf16 v[212:215], a[180:183], a[56:59], v[212:215]
    ds_read_b64_tr_b16 a[156:157], v15 offset:32768
    v_mfma_f32_16x16x32_bf16 v[244:247], a[180:183], a[60:63], v[244:247]
    ds_read_b64_tr_b16 a[158:159], v15 offset:36864
    v_mfma_f32_16x16x32_bf16 v[152:155], a[184:187], a[48:51], v[152:155]
    v_mfma_f32_16x16x32_bf16 v[184:187], a[184:187], a[52:55], v[184:187]
    v_mfma_f32_16x16x32_bf16 v[216:219], a[184:187], a[56:59], v[216:219]
    v_mfma_f32_16x16x32_bf16 v[248:251], a[184:187], a[60:63], v[248:251]
    s_waitcnt lgkmcnt(15)
    v_mfma_f32_16x16x32_bf16 v[156:159], a[188:191], a[48:51], v[156:159]
    buffer_load_dword v43, off, s[56:59], s92 sc1
    v_mfma_f32_16x16x32_bf16 v[188:191], a[188:191], a[52:55], v[188:191]
    v_mfma_f32_16x16x32_bf16 v[220:223], a[188:191], a[56:59], v[220:223]
    v_mfma_f32_16x16x32_bf16 v[252:255], a[188:191], a[60:63], v[252:255]
    s_waitcnt vmcnt(37) lgkmcnt(14)
    v_mfma_f32_16x16x32_bf16 v[128:131], a[128:131], a[64:67], v[128:131]
    buffer_load_dwordx4 a[48:51], v21, s[56:59], s68 offen sc1
    s_waitcnt vmcnt(37)
    v_mfma_f32_16x16x32_bf16 v[160:163], a[128:131], a[68:71], v[160:163]
    ds_read_b64_tr_b16 a[160:161], v8 offset:40960
    s_waitcnt vmcnt(36)
    v_mfma_f32_16x16x32_bf16 v[192:195], a[128:131], a[72:75], v[192:195]
    ds_read_b64_tr_b16 a[162:163], v8 offset:45056
    buffer_load_dwordx4 a[52:55], v22, s[56:59], s68 offen sc1
    s_waitcnt vmcnt(36)
    v_mfma_f32_16x16x32_bf16 v[224:227], a[128:131], a[76:79], v[224:227]
    s_waitcnt lgkmcnt(14)
    v_mfma_f32_16x16x32_bf16 v[132:135], a[132:135], a[64:67], v[132:135]
    ds_read_b64_tr_b16 a[164:165], v9 offset:40960
    buffer_load_dwordx4 a[56:59], v23, s[56:59], s68 offen sc1
    v_mfma_f32_16x16x32_bf16 v[164:167], a[132:135], a[68:71], v[164:167]
    ds_read_b64_tr_b16 a[166:167], v9 offset:45056
    v_mfma_f32_16x16x32_bf16 v[196:199], a[132:135], a[72:75], v[196:199]
    buffer_load_dwordx4 a[60:63], v24, s[56:59], s68 offen sc1
    v_mfma_f32_16x16x32_bf16 v[228:231], a[132:135], a[76:79], v[228:231]
    ds_read_b64_tr_b16 a[168:169], v10 offset:40960
    s_waitcnt lgkmcnt(15)
    v_mfma_f32_16x16x32_bf16 v[136:139], a[136:139], a[64:67], v[136:139]
    ds_read_b64_tr_b16 a[170:171], v10 offset:45056
    s_add_u32 s68, s68, 16384
    v_mfma_f32_16x16x32_bf16 v[168:171], a[136:139], a[68:71], v[168:171]
    v_mfma_f32_16x16x32_bf16 v[200:203], a[136:139], a[72:75], v[200:203]
    ds_read_b64_tr_b16 a[172:173], v11 offset:40960
    v_mfma_f32_16x16x32_bf16 v[232:235], a[136:139], a[76:79], v[232:235]
    ds_read_b64_tr_b16 a[174:175], v11 offset:45056
    s_waitcnt lgkmcnt(15)
    v_mfma_f32_16x16x32_bf16 v[140:143], a[140:143], a[64:67], v[140:143]
    v_mfma_f32_16x16x32_bf16 v[172:175], a[140:143], a[68:71], v[172:175]
    ds_read_b64_tr_b16 a[176:177], v12 offset:40960
    v_mfma_f32_16x16x32_bf16 v[204:207], a[140:143], a[72:75], v[204:207]
    ds_read_b64_tr_b16 a[178:179], v12 offset:45056
    v_mfma_f32_16x16x32_bf16 v[236:239], a[140:143], a[76:79], v[236:239]
    s_waitcnt lgkmcnt(15)
    v_mfma_f32_16x16x32_bf16 v[144:147], a[144:147], a[64:67], v[144:147]
    ds_read_b64_tr_b16 a[180:181], v13 offset:40960
    v_mfma_f32_16x16x32_bf16 v[176:179], a[144:147], a[68:71], v[176:179]
    ds_read_b64_tr_b16 a[182:183], v13 offset:45056
    v_mfma_f32_16x16x32_bf16 v[208:211], a[144:147], a[72:75], v[208:211]
    v_mfma_f32_16x16x32_bf16 v[240:243], a[144:147], a[76:79], v[240:243]
    ds_read_b64_tr_b16 a[184:185], v14 offset:40960
    s_waitcnt lgkmcnt(15)
    v_mfma_f32_16x16x32_bf16 v[148:151], a[148:151], a[64:67], v[148:151]
    ds_read_b64_tr_b16 a[186:187], v14 offset:45056
    v_mfma_f32_16x16x32_bf16 v[180:183], a[148:151], a[68:71], v[180:183]
    v_mfma_f32_16x16x32_bf16 v[212:215], a[148:151], a[72:75], v[212:215]
    ds_read_b64_tr_b16 a[188:189], v15 offset:40960
    v_mfma_f32_16x16x32_bf16 v[244:247], a[148:151], a[76:79], v[244:247]
    ds_read_b64_tr_b16 a[190:191], v15 offset:45056
    v_mfma_f32_16x16x32_bf16 v[152:155], a[152:155], a[64:67], v[152:155]
    v_mfma_f32_16x16x32_bf16 v[184:187], a[152:155], a[68:71], v[184:187]
    v_mfma_f32_16x16x32_bf16 v[216:219], a[152:155], a[72:75], v[216:219]
    v_mfma_f32_16x16x32_bf16 v[248:251], a[152:155], a[76:79], v[248:251]
    s_waitcnt lgkmcnt(15)
    v_mfma_f32_16x16x32_bf16 v[156:159], a[156:159], a[64:67], v[156:159]
    v_mfma_f32_16x16x32_bf16 v[188:191], a[156:159], a[68:71], v[188:191]
    v_mfma_f32_16x16x32_bf16 v[220:223], a[156:159], a[72:75], v[220:223]
    v_mfma_f32_16x16x32_bf16 v[252:255], a[156:159], a[76:79], v[252:255]
    s_waitcnt vmcnt(37) lgkmcnt(14)
    v_mfma_f32_16x16x32_bf16 v[128:131], a[160:163], a[80:83], v[128:131]
    buffer_load_dwordx4 a[64:67], v21, s[56:59], s68 offen sc1
    s_waitcnt vmcnt(37)
    v_mfma_f32_16x16x32_bf16 v[160:163], a[160:163], a[84:87], v[160:163]
    ds_read_b64_tr_b16 a[128:129], v8 offset:49152
    s_waitcnt vmcnt(36)
    v_mfma_f32_16x16x32_bf16 v[192:195], a[160:163], a[88:91], v[192:195]
    ds_read_b64_tr_b16 a[130:131], v8 offset:53248
    buffer_load_dwordx4 a[68:71], v22, s[56:59], s68 offen sc1
    s_waitcnt vmcnt(36)
    v_mfma_f32_16x16x32_bf16 v[224:227], a[160:163], a[92:95], v[224:227]
    s_waitcnt lgkmcnt(14)
    v_mfma_f32_16x16x32_bf16 v[132:135], a[164:167], a[80:83], v[132:135]
    ds_read_b64_tr_b16 a[132:133], v9 offset:49152
    buffer_load_dwordx4 a[72:75], v23, s[56:59], s68 offen sc1
    v_mfma_f32_16x16x32_bf16 v[164:167], a[164:167], a[84:87], v[164:167]
    ds_read_b64_tr_b16 a[134:135], v9 offset:53248
    v_mfma_f32_16x16x32_bf16 v[196:199], a[164:167], a[88:91], v[196:199]
    buffer_load_dwordx4 a[76:79], v24, s[56:59], s68 offen sc1
    v_mfma_f32_16x16x32_bf16 v[228:231], a[164:167], a[92:95], v[228:231]
    ds_read_b64_tr_b16 a[136:137], v10 offset:49152
    s_waitcnt lgkmcnt(15)
    v_mfma_f32_16x16x32_bf16 v[136:139], a[168:171], a[80:83], v[136:139]
    ds_read_b64_tr_b16 a[138:139], v10 offset:53248
    s_add_u32 s68, s68, 16384
    v_mfma_f32_16x16x32_bf16 v[168:171], a[168:171], a[84:87], v[168:171]
    v_mfma_f32_16x16x32_bf16 v[200:203], a[168:171], a[88:91], v[200:203]
    ds_read_b64_tr_b16 a[140:141], v11 offset:49152
    v_mfma_f32_16x16x32_bf16 v[232:235], a[168:171], a[92:95], v[232:235]
    ds_read_b64_tr_b16 a[142:143], v11 offset:53248
    s_waitcnt lgkmcnt(15)
    v_mfma_f32_16x16x32_bf16 v[140:143], a[172:175], a[80:83], v[140:143]
    v_mfma_f32_16x16x32_bf16 v[172:175], a[172:175], a[84:87], v[172:175]
    ds_read_b64_tr_b16 a[144:145], v12 offset:49152
    v_mfma_f32_16x16x32_bf16 v[204:207], a[172:175], a[88:91], v[204:207]
    ds_read_b64_tr_b16 a[146:147], v12 offset:53248
    v_mfma_f32_16x16x32_bf16 v[236:239], a[172:175], a[92:95], v[236:239]
    s_waitcnt lgkmcnt(15)
    v_mfma_f32_16x16x32_bf16 v[144:147], a[176:179], a[80:83], v[144:147]
    ds_read_b64_tr_b16 a[148:149], v13 offset:49152
    v_mfma_f32_16x16x32_bf16 v[176:179], a[176:179], a[84:87], v[176:179]
    ds_read_b64_tr_b16 a[150:151], v13 offset:53248
    v_mfma_f32_16x16x32_bf16 v[208:211], a[176:179], a[88:91], v[208:211]
    v_mfma_f32_16x16x32_bf16 v[240:243], a[176:179], a[92:95], v[240:243]
    ds_read_b64_tr_b16 a[152:153], v14 offset:49152
    s_waitcnt lgkmcnt(15)
    v_mfma_f32_16x16x32_bf16 v[148:151], a[180:183], a[80:83], v[148:151]
    ds_read_b64_tr_b16 a[154:155], v14 offset:53248
    v_mfma_f32_16x16x32_bf16 v[180:183], a[180:183], a[84:87], v[180:183]
    v_mfma_f32_16x16x32_bf16 v[212:215], a[180:183], a[88:91], v[212:215]
    ds_read_b64_tr_b16 a[156:157], v15 offset:49152
    v_mfma_f32_16x16x32_bf16 v[244:247], a[180:183], a[92:95], v[244:247]
    ds_read_b64_tr_b16 a[158:159], v15 offset:53248
    v_mfma_f32_16x16x32_bf16 v[152:155], a[184:187], a[80:83], v[152:155]
    v_mfma_f32_16x16x32_bf16 v[184:187], a[184:187], a[84:87], v[184:187]
    v_mfma_f32_16x16x32_bf16 v[216:219], a[184:187], a[88:91], v[216:219]
    v_mfma_f32_16x16x32_bf16 v[248:251], a[184:187], a[92:95], v[248:251]
    s_waitcnt lgkmcnt(15)
    v_mfma_f32_16x16x32_bf16 v[156:159], a[188:191], a[80:83], v[156:159]
    v_mfma_f32_16x16x32_bf16 v[188:191], a[188:191], a[84:87], v[188:191]
    v_mfma_f32_16x16x32_bf16 v[220:223], a[188:191], a[88:91], v[220:223]
    v_mfma_f32_16x16x32_bf16 v[252:255], a[188:191], a[92:95], v[252:255]
    s_waitcnt vmcnt(37) lgkmcnt(14)
    v_mfma_f32_16x16x32_bf16 v[128:131], a[128:131], a[96:99], v[128:131]
    buffer_load_dwordx4 a[80:83], v21, s[56:59], s68 offen sc1
    s_waitcnt vmcnt(37)
    v_mfma_f32_16x16x32_bf16 v[160:163], a[128:131], a[100:103], v[160:163]
    ds_read_b64_tr_b16 a[160:161], v8 offset:57344
    s_waitcnt vmcnt(36)
    v_mfma_f32_16x16x32_bf16 v[192:195], a[128:131], a[104:107], v[192:195]
    ds_read_b64_tr_b16 a[162:163], v8 offset:61440
    buffer_load_dwordx4 a[84:87], v22, s[56:59], s68 offen sc1
    s_waitcnt vmcnt(36)
    v_mfma_f32_16x16x32_bf16 v[224:227], a[128:131], a[108:111], v[224:227]
    s_waitcnt lgkmcnt(14)
    v_mfma_f32_16x16x32_bf16 v[132:135], a[132:135], a[96:99], v[132:135]
    ds_read_b64_tr_b16 a[164:165], v9 offset:57344
    buffer_load_dwordx4 a[88:91], v23, s[56:59], s68 offen sc1
    v_mfma_f32_16x16x32_bf16 v[164:167], a[132:135], a[100:103], v[164:167]
    ds_read_b64_tr_b16 a[166:167], v9 offset:61440
    v_mfma_f32_16x16x32_bf16 v[196:199], a[132:135], a[104:107], v[196:199]
    buffer_load_dwordx4 a[92:95], v24, s[56:59], s68 offen sc1
    v_mfma_f32_16x16x32_bf16 v[228:231], a[132:135], a[108:111], v[228:231]
    ds_read_b64_tr_b16 a[168:169], v10 offset:57344
    s_waitcnt lgkmcnt(15)
    v_mfma_f32_16x16x32_bf16 v[136:139], a[136:139], a[96:99], v[136:139]
    ds_read_b64_tr_b16 a[170:171], v10 offset:61440
    s_add_u32 s68, s68, 16384
    v_mfma_f32_16x16x32_bf16 v[168:171], a[136:139], a[100:103], v[168:171]
    v_mfma_f32_16x16x32_bf16 v[200:203], a[136:139], a[104:107], v[200:203]
    ds_read_b64_tr_b16 a[172:173], v11 offset:57344
    v_mfma_f32_16x16x32_bf16 v[232:235], a[136:139], a[108:111], v[232:235]
    ds_read_b64_tr_b16 a[174:175], v11 offset:61440
    s_waitcnt lgkmcnt(15)
    v_mfma_f32_16x16x32_bf16 v[140:143], a[140:143], a[96:99], v[140:143]
    v_mfma_f32_16x16x32_bf16 v[172:175], a[140:143], a[100:103], v[172:175]
    ds_read_b64_tr_b16 a[176:177], v12 offset:57344
    v_mfma_f32_16x16x32_bf16 v[204:207], a[140:143], a[104:107], v[204:207]
    ds_read_b64_tr_b16 a[178:179], v12 offset:61440
    v_mfma_f32_16x16x32_bf16 v[236:239], a[140:143], a[108:111], v[236:239]
    s_waitcnt lgkmcnt(15)
    v_mfma_f32_16x16x32_bf16 v[144:147], a[144:147], a[96:99], v[144:147]
    ds_read_b64_tr_b16 a[180:181], v13 offset:57344
    v_mfma_f32_16x16x32_bf16 v[176:179], a[144:147], a[100:103], v[176:179]
    ds_read_b64_tr_b16 a[182:183], v13 offset:61440
    v_mfma_f32_16x16x32_bf16 v[208:211], a[144:147], a[104:107], v[208:211]
    v_mfma_f32_16x16x32_bf16 v[240:243], a[144:147], a[108:111], v[240:243]
    ds_read_b64_tr_b16 a[184:185], v14 offset:57344
    s_waitcnt lgkmcnt(15)
    v_mfma_f32_16x16x32_bf16 v[148:151], a[148:151], a[96:99], v[148:151]
    ds_read_b64_tr_b16 a[186:187], v14 offset:61440
    v_mfma_f32_16x16x32_bf16 v[180:183], a[148:151], a[100:103], v[180:183]
    v_mfma_f32_16x16x32_bf16 v[212:215], a[148:151], a[104:107], v[212:215]
    ds_read_b64_tr_b16 a[188:189], v15 offset:57344
    v_mfma_f32_16x16x32_bf16 v[244:247], a[148:151], a[108:111], v[244:247]
    ds_read_b64_tr_b16 a[190:191], v15 offset:61440
    v_mfma_f32_16x16x32_bf16 v[152:155], a[152:155], a[96:99], v[152:155]
    v_mfma_f32_16x16x32_bf16 v[184:187], a[152:155], a[100:103], v[184:187]
    v_mfma_f32_16x16x32_bf16 v[216:219], a[152:155], a[104:107], v[216:219]
    v_mfma_f32_16x16x32_bf16 v[248:251], a[152:155], a[108:111], v[248:251]
    s_waitcnt lgkmcnt(15)
    v_mfma_f32_16x16x32_bf16 v[156:159], a[156:159], a[96:99], v[156:159]
    v_mfma_f32_16x16x32_bf16 v[188:191], a[156:159], a[100:103], v[188:191]
    v_mfma_f32_16x16x32_bf16 v[220:223], a[156:159], a[104:107], v[220:223]
    v_mfma_f32_16x16x32_bf16 v[252:255], a[156:159], a[108:111], v[252:255]
    s_waitcnt vmcnt(37) lgkmcnt(14)
    v_mfma_f32_16x16x32_bf16 v[128:131], a[160:163], a[112:115], v[128:131]
    buffer_load_dwordx4 a[96:99], v21, s[56:59], s68 offen sc1
    s_waitcnt vmcnt(37)
    v_mfma_f32_16x16x32_bf16 v[160:163], a[160:163], a[116:119], v[160:163]
    ds_read_b64_tr_b16 a[128:129], v48 offset:0
    s_waitcnt vmcnt(36)
    v_mfma_f32_16x16x32_bf16 v[192:195], a[160:163], a[120:123], v[192:195]
    ds_read_b64_tr_b16 a[130:131], v48 offset:4096
    buffer_load_dwordx4 a[100:103], v22, s[56:59], s68 offen sc1
    s_waitcnt vmcnt(36)
    v_mfma_f32_16x16x32_bf16 v[224:227], a[160:163], a[124:127], v[224:227]
    s_waitcnt lgkmcnt(14)
    v_mfma_f32_16x16x32_bf16 v[132:135], a[164:167], a[112:115], v[132:135]
    ds_read_b64_tr_b16 a[132:133], v49 offset:0
    buffer_load_dwordx4 a[104:107], v23, s[56:59], s68 offen sc1
    v_mfma_f32_16x16x32_bf16 v[164:167], a[164:167], a[116:119], v[164:167]
    ds_read_b64_tr_b16 a[134:135], v49 offset:4096
    v_mfma_f32_16x16x32_bf16 v[196:199], a[164:167], a[120:123], v[196:199]
    buffer_load_dwordx4 a[108:111], v24, s[56:59], s68 offen sc1
    v_mfma_f32_16x16x32_bf16 v[228:231], a[164:167], a[124:127], v[228:231]
    ds_read_b64_tr_b16 a[136:137], v50 offset:0
    s_waitcnt lgkmcnt(15)
    v_mfma_f32_16x16x32_bf16 v[136:139], a[168:171], a[112:115], v[136:139]
    ds_read_b64_tr_b16 a[138:139], v50 offset:4096
    s_add_u32 s68, s68, 16384
    v_mfma_f32_16x16x32_bf16 v[168:171], a[168:171], a[116:119], v[168:171]
    v_mfma_f32_16x16x32_bf16 v[200:203], a[168:171], a[120:123], v[200:203]
    ds_read_b64_tr_b16 a[140:141], v51 offset:0
    v_mfma_f32_16x16x32_bf16 v[232:235], a[168:171], a[124:127], v[232:235]
    ds_read_b64_tr_b16 a[142:143], v51 offset:4096
    s_waitcnt lgkmcnt(15)
    v_mfma_f32_16x16x32_bf16 v[140:143], a[172:175], a[112:115], v[140:143]
    v_mfma_f32_16x16x32_bf16 v[172:175], a[172:175], a[116:119], v[172:175]
    ds_read_b64_tr_b16 a[144:145], v52 offset:0
    v_mfma_f32_16x16x32_bf16 v[204:207], a[172:175], a[120:123], v[204:207]
    ds_read_b64_tr_b16 a[146:147], v52 offset:4096
    v_mfma_f32_16x16x32_bf16 v[236:239], a[172:175], a[124:127], v[236:239]
    s_waitcnt lgkmcnt(15)
    v_mfma_f32_16x16x32_bf16 v[144:147], a[176:179], a[112:115], v[144:147]
    ds_read_b64_tr_b16 a[148:149], v53 offset:0
    v_mfma_f32_16x16x32_bf16 v[176:179], a[176:179], a[116:119], v[176:179]
    ds_read_b64_tr_b16 a[150:151], v53 offset:4096
    v_mfma_f32_16x16x32_bf16 v[208:211], a[176:179], a[120:123], v[208:211]
    v_mfma_f32_16x16x32_bf16 v[240:243], a[176:179], a[124:127], v[240:243]
    ds_read_b64_tr_b16 a[152:153], v54 offset:0
    s_waitcnt lgkmcnt(15)
    v_mfma_f32_16x16x32_bf16 v[148:151], a[180:183], a[112:115], v[148:151]
    ds_read_b64_tr_b16 a[154:155], v54 offset:4096
    v_mfma_f32_16x16x32_bf16 v[180:183], a[180:183], a[116:119], v[180:183]
    v_mfma_f32_16x16x32_bf16 v[212:215], a[180:183], a[120:123], v[212:215]
    ds_read_b64_tr_b16 a[156:157], v55 offset:0
    v_mfma_f32_16x16x32_bf16 v[244:247], a[180:183], a[124:127], v[244:247]
    ds_read_b64_tr_b16 a[158:159], v55 offset:4096
    v_mfma_f32_16x16x32_bf16 v[152:155], a[184:187], a[112:115], v[152:155]
    v_mfma_f32_16x16x32_bf16 v[184:187], a[184:187], a[116:119], v[184:187]
    v_mfma_f32_16x16x32_bf16 v[216:219], a[184:187], a[120:123], v[216:219]
    v_mfma_f32_16x16x32_bf16 v[248:251], a[184:187], a[124:127], v[248:251]
    s_waitcnt lgkmcnt(15)
    v_mfma_f32_16x16x32_bf16 v[156:159], a[188:191], a[112:115], v[156:159]
    v_mfma_f32_16x16x32_bf16 v[188:191], a[188:191], a[116:119], v[188:191]
    v_mfma_f32_16x16x32_bf16 v[220:223], a[188:191], a[120:123], v[220:223]
    v_mfma_f32_16x16x32_bf16 v[252:255], a[188:191], a[124:127], v[252:255]
    s_barrier
    s_waitcnt vmcnt(36) lgkmcnt(14)
    v_mfma_f32_16x16x32_bf16 v[128:131], a[128:131], a[0:3], v[128:131]
    buffer_load_dwordx4 a[112:115], v21, s[56:59], s68 offen sc1
    s_waitcnt vmcnt(36)
    v_mfma_f32_16x16x32_bf16 v[160:163], a[128:131], a[4:7], v[160:163]
    ds_read_b64_tr_b16 a[160:161], v48 offset:8192
    s_waitcnt vmcnt(35)
    v_mfma_f32_16x16x32_bf16 v[192:195], a[128:131], a[8:11], v[192:195]
    ds_read_b64_tr_b16 a[162:163], v48 offset:12288
    buffer_load_dwordx4 a[116:119], v22, s[56:59], s68 offen sc1
    s_waitcnt vmcnt(35)
    v_mfma_f32_16x16x32_bf16 v[224:227], a[128:131], a[12:15], v[224:227]
    s_waitcnt lgkmcnt(14)
    v_mfma_f32_16x16x32_bf16 v[132:135], a[132:135], a[0:3], v[132:135]
    ds_read_b64_tr_b16 a[164:165], v49 offset:8192
    buffer_load_dwordx4 a[120:123], v23, s[56:59], s68 offen sc1
    v_mfma_f32_16x16x32_bf16 v[164:167], a[132:135], a[4:7], v[164:167]
    ds_read_b64_tr_b16 a[166:167], v49 offset:12288
    v_mfma_f32_16x16x32_bf16 v[196:199], a[132:135], a[8:11], v[196:199]
    buffer_load_dwordx4 a[124:127], v24, s[56:59], s68 offen sc1
    v_mfma_f32_16x16x32_bf16 v[228:231], a[132:135], a[12:15], v[228:231]
    ds_read_b64_tr_b16 a[168:169], v50 offset:8192
    s_waitcnt lgkmcnt(15)
    v_mfma_f32_16x16x32_bf16 v[136:139], a[136:139], a[0:3], v[136:139]
    ds_read_b64_tr_b16 a[170:171], v50 offset:12288
    s_add_u32 s68, s68, 16384
    v_mfma_f32_16x16x32_bf16 v[168:171], a[136:139], a[4:7], v[168:171]
    v_mfma_f32_16x16x32_bf16 v[200:203], a[136:139], a[8:11], v[200:203]
    ds_read_b64_tr_b16 a[172:173], v51 offset:8192
    v_mfma_f32_16x16x32_bf16 v[232:235], a[136:139], a[12:15], v[232:235]
    ds_read_b64_tr_b16 a[174:175], v51 offset:12288
    s_mov_b32 s82, 1048576
    s_add_u32 m0, s3, 0
    s_waitcnt lgkmcnt(15)
    v_mfma_f32_16x16x32_bf16 v[140:143], a[140:143], a[0:3], v[140:143]
    buffer_load_dwordx4 v17, s[48:51], s82 offen lds
    v_mfma_f32_16x16x32_bf16 v[172:175], a[140:143], a[4:7], v[172:175]
    ds_read_b64_tr_b16 a[176:177], v52 offset:8192
    v_mfma_f32_16x16x32_bf16 v[204:207], a[140:143], a[8:11], v[204:207]
    ds_read_b64_tr_b16 a[178:179], v52 offset:12288
    v_mfma_f32_16x16x32_bf16 v[236:239], a[140:143], a[12:15], v[236:239]
    s_waitcnt lgkmcnt(15)
    v_mfma_f32_16x16x32_bf16 v[144:147], a[144:147], a[0:3], v[144:147]
    ds_read_b64_tr_b16 a[180:181], v53 offset:8192
    buffer_load_dwordx4 v18, s[48:51], s82 offen offset:1024 lds
    v_mfma_f32_16x16x32_bf16 v[176:179], a[144:147], a[4:7], v[176:179]
    ds_read_b64_tr_b16 a[182:183], v53 offset:12288
    v_mfma_f32_16x16x32_bf16 v[208:211], a[144:147], a[8:11], v[208:211]
    v_mfma_f32_16x16x32_bf16 v[240:243], a[144:147], a[12:15], v[240:243]
    ds_read_b64_tr_b16 a[184:185], v54 offset:8192
    s_waitcnt lgkmcnt(15)
    v_mfma_f32_16x16x32_bf16 v[148:151], a[148:151], a[0:3], v[148:151]
    ds_read_b64_tr_b16 a[186:187], v54 offset:12288
    v_mfma_f32_16x16x32_bf16 v[180:183], a[148:151], a[4:7], v[180:183]
    s_mov_b32 s83, 1277952
    s_add_u32 m0, s3, 8192
    v_mfma_f32_16x16x32_bf16 v[212:215], a[148:151], a[8:11], v[212:215]
    ds_read_b64_tr_b16 a[188:189], v55 offset:8192
    buffer_load_dwordx4 v17, s[48:51], s83 offen lds
    v_mfma_f32_16x16x32_bf16 v[244:247], a[148:151], a[12:15], v[244:247]
    ds_read_b64_tr_b16 a[190:191], v55 offset:12288
    v_mfma_f32_16x16x32_bf16 v[152:155], a[152:155], a[0:3], v[152:155]
    v_mfma_f32_16x16x32_bf16 v[184:187], a[152:155], a[4:7], v[184:187]
    v_mfma_f32_16x16x32_bf16 v[216:219], a[152:155], a[8:11], v[216:219]
    buffer_load_dwordx4 v18, s[48:51], s83 offen offset:1024 lds
    v_mfma_f32_16x16x32_bf16 v[248:251], a[152:155], a[12:15], v[248:251]
    s_waitcnt lgkmcnt(15)
    v_mfma_f32_16x16x32_bf16 v[156:159], a[156:159], a[0:3], v[156:159]
    v_mfma_f32_16x16x32_bf16 v[188:191], a[156:159], a[4:7], v[188:191]
    v_mfma_f32_16x16x32_bf16 v[220:223], a[156:159], a[8:11], v[220:223]
    v_mfma_f32_16x16x32_bf16 v[252:255], a[156:159], a[12:15], v[252:255]
    s_waitcnt vmcnt(40) lgkmcnt(14)
    v_mfma_f32_16x16x32_bf16 v[128:131], a[160:163], a[16:19], v[128:131]
    s_waitcnt vmcnt(24)
    v_readfirstlane_b32 s86, v43
    s_bfe_u32 s86, s86, 0x80008
    s_cmp_eq_u32 s86, 16
    s_cbranch_scc0 L_spB
L_okB:
    buffer_load_dwordx4 a[0:3], v21, s[56:59], s68 offen sc1
    v_mfma_f32_16x16x32_bf16 v[160:163], a[160:163], a[20:23], v[160:163]
    ds_read_b64_tr_b16 a[128:129], v48 offset:16384
    v_mfma_f32_16x16x32_bf16 v[192:195], a[160:163], a[24:27], v[192:195]
    ds_read_b64_tr_b16 a[130:131], v48 offset:20480
    buffer_load_dwordx4 a[4:7], v22, s[56:59], s68 offen sc1
    v_mfma_f32_16x16x32_bf16 v[224:227], a[160:163], a[28:31], v[224:227]
    s_waitcnt lgkmcnt(14)
    v_mfma_f32_16x16x32_bf16 v[132:135], a[164:167], a[16:19], v[132:135]
    ds_read_b64_tr_b16 a[132:133], v49 offset:16384
    buffer_load_dwordx4 a[8:11], v23, s[56:59], s68 offen sc1
    v_mfma_f32_16x16x32_bf16 v[164:167], a[164:167], a[20:23], v[164:167]
    ds_read_b64_tr_b16 a[134:135], v49 offset:20480
    v_mfma_f32_16x16x32_bf16 v[196:199], a[164:167], a[24:27], v[196:199]
    buffer_load_dwordx4 a[12:15], v24, s[56:59], s68 offen sc1
    v_mfma_f32_16x16x32_bf16 v[228:231], a[164:167], a[28:31], v[228:231]
    ds_read_b64_tr_b16 a[136:137], v50 offset:16384
    s_waitcnt lgkmcnt(15)
    v_mfma_f32_16x16x32_bf16 v[136:139], a[168:171], a[16:19], v[136:139]
    ds_read_b64_tr_b16 a[138:139], v50 offset:20480
    s_add_u32 s68, s68, 16384
    v_mfma_f32_16x16x32_bf16 v[168:171], a[168:171], a[20:23], v[168:171]
    v_mfma_f32_16x16x32_bf16 v[200:203], a[168:171], a[24:27], v[200:203]
    ds_read_b64_tr_b16 a[140:141], v51 offset:16384
    v_mfma_f32_16x16x32_bf16 v[232:235], a[168:171], a[28:31], v[232:235]
    ds_read_b64_tr_b16 a[142:143], v51 offset:20480
    s_mov_b32 s82, 1507328
    s_add_u32 m0, s3, 16384
    s_waitcnt lgkmcnt(15)
    v_mfma_f32_16x16x32_bf16 v[140:143], a[172:175], a[16:19], v[140:143]
    buffer_load_dwordx4 v17, s[48:51], s82 offen lds
    v_mfma_f32_16x16x32_bf16 v[172:175], a[172:175], a[20:23], v[172:175]
    ds_read_b64_tr_b16 a[144:145], v52 offset:16384
    v_mfma_f32_16x16x32_bf16 v[204:207], a[172:175], a[24:27], v[204:207]
    ds_read_b64_tr_b16 a[146:147], v52 offset:20480
    v_mfma_f32_16x16x32_bf16 v[236:239], a[172:175], a[28:31], v[236:239]
    s_waitcnt lgkmcnt(15)
    v_mfma_f32_16x16x32_bf16 v[144:147], a[176:179], a[16:19], v[144:147]
    ds_read_b64_tr_b16 a[148:149], v53 offset:16384
    buffer_load_dwordx4 v18, s[48:51], s82 offen offset:1024 lds
    v_mfma_f32_16x16x32_bf16 v[176:179], a[176:179], a[20:23], v[176:179]
    ds_read_b64_tr_b16 a[150:151], v53 offset:20480
    v_mfma_f32_16x16x32_bf16 v[208:211], a[176:179], a[24:27], v[208:211]
    v_mfma_f32_16x16x32_bf16 v[240:243], a[176:179], a[28:31], v[240:243]
    ds_read_b64_tr_b16 a[152:153], v54 offset:16384
    s_waitcnt lgkmcnt(15)
    v_mfma_f32_16x16x32_bf16 v[148:151], a[180:183], a[16:19], v[148:151]
    ds_read_b64_tr_b16 a[154:155], v54 offset:20480
    v_mfma_f32_16x16x32_bf16 v[180:183], a[180:183], a[20:23], v[180:183]
    s_mov_b32 s83, 1736704
    s_add_u32 m0, s3, 24576
    v_mfma_f32_16x16x32_bf16 v[212:215], a[180:183], a[24:27], v[212:215]
    ds_read_b64_tr_b16 a[156:157], v55 offset:16384
    buffer_load_dwordx4 v17, s[48:51], s83 offen lds
    v_mfma_f32_16x16x32_bf16 v[244:247], a[180:183], a[28:31], v[244:247]
    ds_read_b64_tr_b16 a[158:159], v55 offset:20480
    v_mfma_f32_16x16x32_bf16 v[152:155], a[184:187], a[16:19], v[152:155]
    v_mfma_f32_16x16x32_bf16 v[184:187], a[184:187], a[20:23], v[184:187]
    v_mfma_f32_16x16x32_bf16 v[216:219], a[184:187], a[24:27], v[216:219]
    buffer_load_dwordx4 v18, s[48:51], s83 offen offset:1024 lds
    v_mfma_f32_16x16x32_bf16 v[248:251], a[184:187], a[28:31], v[248:251]
    s_waitcnt lgkmcnt(15)
    v_mfma_f32_16x16x32_bf16 v[156:159], a[188:191], a[16:19], v[156:159]
    v_mfma_f32_16x16x32_bf16 v[188:191], a[188:191], a[20:23], v[188:191]
    v_mfma_f32_16x16x32_bf16 v[220:223], a[188:191], a[24:27], v[220:223]
    v_mfma_f32_16x16x32_bf16 v[252:255], a[188:191], a[28:31], v[252:255]
    s_waitcnt lgkmcnt(14)
    v_mfma_f32_16x16x32_bf16 v[128:131], a[128:131], a[32:35], v[128:131]
    buffer_load_dwordx4 a[16:19], v21, s[56:59], s68 offen sc1
    v_mfma_f32_16x16x32_bf16 v[160:163], a[128:131], a[36:39], v[160:163]
    ds_read_b64_tr_b16 a[160:161], v48 offset:24576
    v_mfma_f32_16x16x32_bf16 v[192:195], a[128:131], a[40:43], v[192:195]
    ds_read_b64_tr_b16 a[162:163], v48 offset:28672
    buffer_load_dwordx4 a[20:23], v22, s[56:59], s68 offen sc1
    v_mfma_f32_16x16x32_bf16 v[224:227], a[128:131], a[44:47], v[224:227]
    s_waitcnt lgkmcnt(14)
    v_mfma_f32_16x16x32_bf16 v[132:135], a[132:135], a[32:35], v[132:135]
    ds_read_b64_tr_b16 a[164:165], v49 offset:24576
    buffer_load_dwordx4 a[24:27], v23, s[56:59], s68 offen sc1
    v_mfma_f32_16x16x32_bf16 v[164:167], a[132:135], a[36:39], v[164:167]
    ds_read_b64_tr_b16 a[166:167], v49 offset:28672
    v_mfma_f32_16x16x32_bf16 v[196:199], a[132:135], a[40:43], v[196:199]
    buffer_load_dwordx4 a[28:31], v24, s[56:59], s68 offen sc1
    v_mfma_f32_16x16x32_bf16 v[228:231], a[132:135], a[44:47], v[228:231]
    ds_read_b64_tr_b16 a[168:169], v50 offset:24576
    s_waitcnt lgkmcnt(15)
    v_mfma_f32_16x16x32_bf16 v[136:139], a[136:139], a[32:35], v[136:139]
    ds_read_b64_tr_b16 a[170:171], v50 offset:28672
    s_add_u32 s68, s68, 16384
    v_mfma_f32_16x16x32_bf16 v[168:171], a[136:139], a[36:39], v[168:171]
    v_mfma_f32_16x16x32_bf16 v[200:203], a[136:139], a[40:43], v[200:203]
    ds_read_b64_tr_b16 a[172:173], v51 offset:24576
    v_mfma_f32_16x16x32_bf16 v[232:235], a[136:139], a[44:47], v[232:235]
    ds_read_b64_tr_b16 a[174:175], v51 offset:28672
    s_mov_b32 s82, 196608
    s_add_u32 m0, s3, 32768
    s_waitcnt lgkmcnt(15)
    v_mfma_f32_16x16x32_bf16 v[140:143], a[140:143], a[32:35], v[140:143]
    buffer_load_dwordx4 v19, s[48:51], s82 offen lds
    v_mfma_f32_16x16x32_bf16 v[172:175], a[140:143], a[36:39], v[172:175]
    ds_read_b64_tr_b16 a[176:177], v52 offset:24576
    v_mfma_f32_16x16x32_bf16 v[204:207], a[140:143], a[40:43], v[204:207]
    ds_read_b64_tr_b16 a[178:179], v52 offset:28672
    v_mfma_f32_16x16x32_bf16 v[236:239], a[140:143], a[44:47], v[236:239]
    s_waitcnt lgkmcnt(15)
    v_mfma_f32_16x16x32_bf16 v[144:147], a[144:147], a[32:35], v[144:147]
    ds_read_b64_tr_b16 a[180:181], v53 offset:24576
    buffer_load_dwordx4 v20, s[48:51], s82 offen offset:1024 lds
    v_mfma_f32_16x16x32_bf16 v[176:179], a[144:147], a[36:39], v[176:179]
    ds_read_b64_tr_b16 a[182:183], v53 offset:28672
    v_mfma_f32_16x16x32_bf16 v[208:211], a[144:147], a[40:43], v[208:211]
    v_mfma_f32_16x16x32_bf16 v[240:243], a[144:147], a[44:47], v[240:243]
    ds_read_b64_tr_b16 a[184:185], v54 offset:24576
    s_waitcnt lgkmcnt(15)
    v_mfma_f32_16x16x32_bf16 v[148:151], a[148:151], a[32:35], v[148:151]
    ds_read_b64_tr_b16 a[186:187], v54 offset:28672
    v_mfma_f32_16x16x32_bf16 v[180:183], a[148:151], a[36:39], v[180:183]
    s_mov_b32 s83, 655360
    s_add_u32 m0, s3, 40960
    v_mfma_f32_16x16x32_bf16 v[212:215], a[148:151], a[40:43], v[212:215]
    ds_read_b64_tr_b16 a[188:189], v55 offset:24576
    buffer_load_dwordx4 v19, s[48:51], s83 offen lds
    v_mfma_f32_16x16x32_bf16 v[244:247], a[148:151], a[44:47], v[244:247]
    ds_read_b64_tr_b16 a[190:191], v55 offset:28672
    v_mfma_f32_16x16x32_bf16 v[152:155], a[152:155], a[32:35], v[152:155]
    v_mfma_f32_16x16x32_bf16 v[184:187], a[152:155], a[36:39], v[184:187]
    v_mfma_f32_16x16x32_bf16 v[216:219], a[152:155], a[40:43], v[216:219]
    buffer_load_dwordx4 v20, s[48:51], s83 offen offset:1024 lds
    v_mfma_f32_16x16x32_bf16 v[248:251], a[152:155], a[44:47], v[248:251]
    s_waitcnt lgkmcnt(15)
    v_mfma_f32_16x16x32_bf16 v[156:159], a[156:159], a[32:35], v[156:159]
    buffer_load_dword v43, off, s[56:59], s92 sc1
    v_mfma_f32_16x16x32_bf16 v[188:191], a[156:159], a[36:39], v[188:191]
    v_mfma_f32_16x16x32_bf16 v[220:223], a[156:159], a[40:43], v[220:223]
    v_mfma_f32_16x16x32_bf16 v[252:255], a[156:159], a[44:47], v[252:255]
    s_waitcnt vmcnt(40) lgkmcnt(14)
    v_mfma_f32_16x16x32_bf16 v[128:131], a[160:163], a[48:51], v[128:131]
    buffer_load_dwordx4 a[32:35], v21, s[56:59], s68 offen sc1
    s_waitcnt vmcnt(40)
    v_mfma_f32_16x16x32_bf16 v[160:163], a[160:163], a[52:55], v[160:163]
    ds_read_b64_tr_b16 a[128:129], v48 offset:32768
    s_waitcnt vmcnt(39)
    v_mfma_f32_16x16x32_bf16 v[192:195], a[160:163], a[56:59], v[192:195]
    ds_read_b64_tr_b16 a[130:131], v48 offset:36864
    buffer_load_dwordx4 a[36:39], v22, s[56:59], s68 offen sc1
    s_waitcnt vmcnt(39)
    v_mfma_f32_16x16x32_bf16 v[224:227], a[160:163], a[60:63], v[224:227]
    s_waitcnt lgkmcnt(14)
    v_mfma_f32_16x16x32_bf16 v[132:135], a[164:167], a[48:51], v[132:135]
    ds_read_b64_tr_b16 a[132:133], v49 offset:32768
    buffer_load_dwordx4 a[40:43], v23, s[56:59], s68 offen sc1
    v_mfma_f32_16x16x32_bf16 v[164:167], a[164:167], a[52:55], v[164:167]
    ds_read_b64_tr_b16 a[134:135], v49 offset:36864
    v_mfma_f32_16x16x32_bf16 v[196:199], a[164:167], a[56:59], v[196:199]
    buffer_load_dwordx4 a[44:47], v24, s[56:59], s68 offen sc1
    v_mfma_f32_16x16x32_bf16 v[228:231], a[164:167], a[60:63], v[228:231]
    ds_read_b64_tr_b16 a[136:137], v50 offset:32768
    s_waitcnt lgkmcnt(15)
    v_mfma_f32_16x16x32_bf16 v[136:139], a[168:171], a[48:51], v[136:139]
    ds_read_b64_tr_b16 a[138:139], v50 offset:36864
    s_add_u32 s68, s68, 16384
    v_mfma_f32_16x16x32_bf16 v[168:171], a[168:171], a[52:55], v[168:171]
    v_mfma_f32_16x16x32_bf16 v[200:203], a[168:171], a[56:59], v[200:203]
    ds_read_b64_tr_b16 a[140:141], v51 offset:32768
    v_mfma_f32_16x16x32_bf16 v[232:235], a[168:171], a[60:63], v[232:235]
    ds_read_b64_tr_b16 a[142:143], v51 offset:36864
    s_mov_b32 s82, 1114112
    s_add_u32 m0, s3, 49152
    s_waitcnt lgkmcnt(15)
    v_mfma_f32_16x16x32_bf16 v[140:143], a[172:175], a[48:51], v[140:143]
    buffer_load_dwordx4 v19, s[48:51], s82 offen lds
    v_mfma_f32_16x16x32_bf16 v[172:175], a[172:175], a[52:55], v[172:175]
    ds_read_b64_tr_b16 a[144:145], v52 offset:32768
    v_mfma_f32_16x16x32_bf16 v[204:207], a[172:175], a[56:59], v[204:207]
    ds_read_b64_tr_b16 a[146:147], v52 offset:36864
    v_mfma_f32_16x16x32_bf16 v[236:239], a[172:175], a[60:63], v[236:239]
    s_waitcnt lgkmcnt(15)
    v_mfma_f32_16x16x32_bf16 v[144:147], a[176:179], a[48:51], v[144:147]
    ds_read_b64_tr_b16 a[148:149], v53 offset:32768
    buffer_load_dwordx4 v20, s[48:51], s82 offen offset:1024 lds
    v_mfma_f32_16x16x32_bf16 v[176:179], a[176:179], a[52:55], v[176:179]
    ds_read_b64_tr_b16 a[150:151], v53 offset:36864
    v_mfma_f32_16x16x32_bf16 v[208:211], a[176:179], a[56:59], v[208:211]
    v_mfma_f32_16x16x32_bf16 v[240:243], a[176:179], a[60:63], v[240:243]
    ds_read_b64_tr_b16 a[152:153], v54 offset:32768
    s_waitcnt lgkmcnt(15)
    v_mfma_f32_16x16x32_bf16 v[148:151], a[180:183], a[48:51], v[148:151]
    ds_read_b64_tr_b16 a[154:155], v54 offset:36864
    v_mfma_f32_16x16x32_bf16 v[180:183], a[180:183], a[52:55], v[180:183]
    s_mov_b32 s83, 1572864
    s_add_u32 m0, s3, 57344
    v_mfma_f32_16x16x32_bf16 v[212:215], a[180:183], a[56:59], v[212:215]
    ds_read_b64_tr_b16 a[156:157], v55 offset:32768
    buffer_load_dwordx4 v19, s[48:51], s83 offen lds
    v_mfma_f32_16x16x32_bf16 v[244:247], a[180:183], a[60:63], v[244:247]
    ds_read_b64_tr_b16 a[158:159], v55 offset:36864
    v_mfma_f32_16x16x32_bf16 v[152:155], a[184:187], a[48:51], v[152:155]
    v_mfma_f32_16x16x32_bf16 v[184:187], a[184:187], a[52:55], v[184:187]
    v_mfma_f32_16x16x32_bf16 v[216:219], a[184:187], a[56:59], v[216:219]
    buffer_load_dwordx4 v20, s[48:51], s83 offen offset:1024 lds
    v_mfma_f32_16x16x32_bf16 v[248:251], a[184:187], a[60:63], v[248:251]
    s_waitcnt lgkmcnt(15)
    v_mfma_f32_16x16x32_bf16 v[156:159], a[188:191], a[48:51], v[156:159]
    v_mfma_f32_16x16x32_bf16 v[188:191], a[188:191], a[52:55], v[188:191]
    v_mfma_f32_16x16x32_bf16 v[220:223], a[188:191], a[56:59], v[220:223]
    v_mfma_f32_16x16x32_bf16 v[252:255], a[188:191], a[60:63], v[252:255]
    s_waitcnt vmcnt(44) lgkmcnt(14)
    v_mfma_f32_16x16x32_bf16 v[128:131], a[128:131], a[64:67], v[128:131]
    buffer_load_dwordx4 a[48:51], v21, s[56:59], s68 offen sc1
    s_waitcnt vmcnt(44)
    v_mfma_f32_16x16x32_bf16 v[160:163], a[128:131], a[68:71], v[160:163]
    ds_read_b64_tr_b16 a[160:161], v48 offset:40960
    s_waitcnt vmcnt(43)
    v_mfma_f32_16x16x32_bf16 v[192:195], a[128:131], a[72:75], v[192:195]
    ds_read_b64_tr_b16 a[162:163], v48 offset:45056
    buffer_load_dwordx4 a[52:55], v22, s[56:59], s68 offen sc1
    s_waitcnt vmcnt(43)
    v_mfma_f32_16x16x32_bf16 v[224:227], a[128:131], a[76:79], v[224:227]
    s_waitcnt lgkmcnt(14)
    v_mfma_f32_16x16x32_bf16 v[132:135], a[132:135], a[64:67], v[132:135]
    ds_read_b64_tr_b16 a[164:165], v49 offset:40960
    buffer_load_dwordx4 a[56:59], v23, s[56:59], s68 offen sc1
    v_mfma_f32_16x16x32_bf16 v[164:167], a[132:135], a[68:71], v[164:167]
    ds_read_b64_tr_b16 a[166:167], v49 offset:45056
    v_mfma_f32_16x16x32_bf16 v[196:199], a[132:135], a[72:75], v[196:199]
    buffer_load_dwordx4 a[60:63], v24, s[56:59], s68 offen sc1
    v_mfma_f32_16x16x32_bf16 v[228:231], a[132:135], a[76:79], v[228:231]
    ds_read_b64_tr_b16 a[168:169], v50 offset:40960
    s_waitcnt lgkmcnt(15)
    v_mfma_f32_16x16x32_bf16 v[136:139], a[136:139], a[64:67], v[136:139]
    ds_read_b64_tr_b16 a[170:171], v50 offset:45056
    s_add_u32 s68, s68, 16384
    v_mfma_f32_16x16x32_bf16 v[168:171], a[136:139], a[68:71], v[168:171]
    v_mfma_f32_16x16x32_bf16 v[200:203], a[136:139], a[72:75], v[200:203]
    ds_read_b64_tr_b16 a[172:173], v51 offset:40960
    v_lshlrev_b32 v64, 16, v66
    v_mfma_f32_16x16x32_bf16 v[232:235], a[136:139], a[76:79], v[232:235]
    ds_read_b64_tr_b16 a[174:175], v51 offset:45056
    v_and_b32 v65, 0xffff0000, v66
    s_waitcnt lgkmcnt(15)
    v_mfma_f32_16x16x32_bf16 v[140:143], a[140:143], a[64:67], v[140:143]
    v_lshlrev_b32 v66, 16, v67
    v_mfma_f32_16x16x32_bf16 v[172:175], a[140:143], a[68:71], v[172:175]
    ds_read_b64_tr_b16 a[176:177], v52 offset:40960
    v_and_b32 v67, 0xffff0000, v67
    v_mfma_f32_16x16x32_bf16 v[204:207], a[140:143], a[72:75], v[204:207]
    ds_read_b64_tr_b16 a[178:179], v52 offset:45056
    v_lshlrev_b32 v68, 16, v70
    v_mfma_f32_16x16x32_bf16 v[236:239], a[140:143], a[76:79], v[236:239]
    v_and_b32 v69, 0xffff0000, v70
    s_waitcnt lgkmcnt(15)
    v_mfma_f32_16x16x32_bf16 v[144:147], a[144:147], a[64:67], v[144:147]
    ds_read_b64_tr_b16 a[180:181], v53 offset:40960
    v_lshlrev_b32 v70, 16, v71
    v_mfma_f32_16x16x32_bf16 v[176:179], a[144:147], a[68:71], v[176:179]
    ds_read_b64_tr_b16 a[182:183], v53 offset:45056
    v_and_b32 v71, 0xffff0000, v71
    v_mfma_f32_16x16x32_bf16 v[208:211], a[144:147], a[72:75], v[208:211]
    v_lshlrev_b32 v72, 16, v74
    v_mfma_f32_16x16x32_bf16 v[240:243], a[144:147], a[76:79], v[240:243]
    ds_read_b64_tr_b16 a[184:185], v54 offset:40960
    v_and_b32 v73, 0xffff0000, v74
    s_waitcnt lgkmcnt(15)
    v_mfma_f32_16x16x32_bf16 v[148:151], a[148:151], a[64:67], v[148:151]
    ds_read_b64_tr_b16 a[186:187], v54 offset:45056
    v_lshlrev_b32 v74, 16, v75
    v_mfma_f32_16x16x32_bf16 v[180:183], a[148:151], a[68:71], v[180:183]
    v_and_b32 v75, 0xffff0000, v75
    v_mfma_f32_16x16x32_bf16 v[212:215], a[148:151], a[72:75], v[212:215]
    ds_read_b64_tr_b16 a[188:189], v55 offset:40960
    v_lshlrev_b32 v76, 16, v78
    v_mfma_f32_16x16x32_bf16 v[244:247], a[148:151], a[76:79], v[244:247]
    ds_read_b64_tr_b16 a[190:191], v55 offset:45056
    v_and_b32 v77, 0xffff0000, v78
    v_mfma_f32_16x16x32_bf16 v[152:155], a[152:155], a[64:67], v[152:155]
    v_lshlrev_b32 v78, 16, v79
    v_mfma_f32_16x16x32_bf16 v[184:187], a[152:155], a[68:71], v[184:187]
    v_and_b32 v79, 0xffff0000, v79
    v_mfma_f32_16x16x32_bf16 v[216:219], a[152:155], a[72:75], v[216:219]
    v_mfma_f32_16x16x32_bf16 v[248:251], a[152:155], a[76:79], v[248:251]
    s_waitcnt lgkmcnt(15)
    v_mfma_f32_16x16x32_bf16 v[156:159], a[156:159], a[64:67], v[156:159]
    v_mfma_f32_16x16x32_bf16 v[188:191], a[156:159], a[68:71], v[188:191]
    v_mfma_f32_16x16x32_bf16 v[220:223], a[156:159], a[72:75], v[220:223]
    v_mfma_f32_16x16x32_bf16 v[252:255], a[156:159], a[76:79], v[252:255]
    s_waitcnt vmcnt(44) lgkmcnt(14)
    v_mfma_f32_16x16x32_bf16 v[128:131], a[160:163], a[80:83], v[128:131]
    buffer_load_dwordx4 a[64:67], v21, s[56:59], s68 offen sc1
    s_waitcnt vmcnt(44)
    v_mfma_f32_16x16x32_bf16 v[160:163], a[160:163], a[84:87], v[160:163]
    ds_read_b64_tr_b16 a[128:129], v48 offset:49152
    s_waitcnt vmcnt(43)
    v_mfma_f32_16x16x32_bf16 v[192:195], a[160:163], a[88:91], v[192:195]
    ds_read_b64_tr_b16 a[130:131], v48 offset:53248
    buffer_load_dwordx4 a[68:71], v22, s[56:59], s68 offen sc1
    s_waitcnt vmcnt(43)
    v_mfma_f32_16x16x32_bf16 v[224:227], a[160:163], a[92:95], v[224:227]
    s_waitcnt lgkmcnt(14)
    v_mfma_f32_16x16x32_bf16 v[132:135], a[164:167], a[80:83], v[132:135]
    ds_read_b64_tr_b16 a[132:133], v49 offset:49152
    buffer_load_dwordx4 a[72:75], v23, s[56:59], s68 offen sc1
    v_mfma_f32_16x16x32_bf16 v[164:167], a[164:167], a[84:87], v[164:167]
    ds_read_b64_tr_b16 a[134:135], v49 offset:53248
    v_mfma_f32_16x16x32_bf16 v[196:199], a[164:167], a[88:91], v[196:199]
    buffer_load_dwordx4 a[76:79], v24, s[56:59], s68 offen sc1
    v_mfma_f32_16x16x32_bf16 v[228:231], a[164:167], a[92:95], v[228:231]
    ds_read_b64_tr_b16 a[136:137], v50 offset:49152
    s_waitcnt lgkmcnt(15)
    v_mfma_f32_16x16x32_bf16 v[136:139], a[168:171], a[80:83], v[136:139]
    ds_read_b64_tr_b16 a[138:139], v50 offset:53248
    s_add_u32 s68, s68, 16384
    v_mfma_f32_16x16x32_bf16 v[168:171], a[168:171], a[84:87], v[168:171]
    v_mfma_f32_16x16x32_bf16 v[200:203], a[168:171], a[88:91], v[200:203]
    ds_read_b64_tr_b16 a[140:141], v51 offset:49152
    v_lshlrev_b32 v80, 16, v82
    v_mfma_f32_16x16x32_bf16 v[232:235], a[168:171], a[92:95], v[232:235]
    ds_read_b64_tr_b16 a[142:143], v51 offset:53248
    v_and_b32 v81, 0xffff0000, v82
    s_waitcnt lgkmcnt(15)
    v_mfma_f32_16x16x32_bf16 v[140:143], a[172:175], a[80:83], v[140:143]
    v_lshlrev_b32 v82, 16, v83
    v_mfma_f32_16x16x32_bf16 v[172:175], a[172:175], a[84:87], v[172:175]
    ds_read_b64_tr_b16 a[144:145], v52 offset:49152
    v_and_b32 v83, 0xffff0000, v83
    v_mfma_f32_16x16x32_bf16 v[204:207], a[172:175], a[88:91], v[204:207]
    ds_read_b64_tr_b16 a[146:147], v52 offset:53248
    v_lshlrev_b32 v84, 16, v86
    v_mfma_f32_16x16x32_bf16 v[236:239], a[172:175], a[92:95], v[236:239]
    v_and_b32 v85, 0xffff0000, v86
    s_waitcnt lgkmcnt(15)
    v_mfma_f32_16x16x32_bf16 v[144:147], a[176:179], a[80:83], v[144:147]
    ds_read_b64_tr_b16 a[148:149], v53 offset:49152
    v_lshlrev_b32 v86, 16, v87
    v_mfma_f32_16x16x32_bf16 v[176:179], a[176:179], a[84:87], v[176:179]
    ds_read_b64_tr_b16 a[150:151], v53 offset:53248
    v_and_b32 v87, 0xffff0000, v87
    v_mfma_f32_16x16x32_bf16 v[208:211], a[176:179], a[88:91], v[208:211]
    v_lshlrev_b32 v88, 16, v90
    v_mfma_f32_16x16x32_bf16 v[240:243], a[176:179], a[92:95], v[240:243]
    ds_read_b64_tr_b16 a[152:153], v54 offset:49152
    v_and_b32 v89, 0xffff0000, v90
    s_waitcnt lgkmcnt(15)
    v_mfma_f32_16x16x32_bf16 v[148:151], a[180:183], a[80:83], v[148:151]
    ds_read_b64_tr_b16 a[154:155], v54 offset:53248
    v_lshlrev_b32 v90, 16, v91
    v_mfma_f32_16x16x32_bf16 v[180:183], a[180:183], a[84:87], v[180:183]
    v_and_b32 v91, 0xffff0000, v91
    v_mfma_f32_16x16x32_bf16 v[212:215], a[180:183], a[88:91], v[212:215]
    ds_read_b64_tr_b16 a[156:157], v55 offset:49152
    v_lshlrev_b32 v92, 16, v94
    v_mfma_f32_16x16x32_bf16 v[244:247], a[180:183], a[92:95], v[244:247]
    ds_read_b64_tr_b16 a[158:159], v55 offset:53248
    v_and_b32 v93, 0xffff0000, v94
    v_mfma_f32_16x16x32_bf16 v[152:155], a[184:187], a[80:83], v[152:155]
    v_lshlrev_b32 v94, 16, v95
    v_mfma_f32_16x16x32_bf16 v[184:187], a[184:187], a[84:87], v[184:187]
    v_and_b32 v95, 0xffff0000, v95
    v_mfma_f32_16x16x32_bf16 v[216:219], a[184:187], a[88:91], v[216:219]
    v_mfma_f32_16x16x32_bf16 v[248:251], a[184:187], a[92:95], v[248:251]
    s_waitcnt lgkmcnt(15)
    v_mfma_f32_16x16x32_bf16 v[156:159], a[188:191], a[80:83], v[156:159]
    buffer_load_dword v44, off, s[56:59], s76 sc1
    v_mfma_f32_16x16x32_bf16 v[188:191], a[188:191], a[84:87], v[188:191]
    v_mfma_f32_16x16x32_bf16 v[220:223], a[188:191], a[88:91], v[220:223]
    v_mfma_f32_16x16x32_bf16 v[252:255], a[188:191], a[92:95], v[252:255]
    s_waitcnt vmcnt(45) lgkmcnt(14)
    v_mfma_f32_16x16x32_bf16 v[128:131], a[128:131], a[96:99], v[128:131]
    buffer_load_dwordx4 a[80:83], v21, s[56:59], s68 offen sc1
    s_waitcnt vmcnt(45)
    v_mfma_f32_16x16x32_bf16 v[160:163], a[128:131], a[100:103], v[160:163]
    ds_read_b64_tr_b16 a[160:161], v48 offset:57344
    s_waitcnt vmcnt(44)
    v_mfma_f32_16x16x32_bf16 v[192:195], a[128:131], a[104:107], v[192:195]
    ds_read_b64_tr_b16 a[162:163], v48 offset:61440
    buffer_load_dwordx4 a[84:87], v22, s[56:59], s68 offen sc1
    s_waitcnt vmcnt(44)
    v_mfma_f32_16x16x32_bf16 v[224:227], a[128:131], a[108:111], v[224:227]
    s_waitcnt lgkmcnt(14)
    v_mfma_f32_16x16x32_bf16 v[132:135], a[132:135], a[96:99], v[132:135]
    ds_read_b64_tr_b16 a[164:165], v49 offset:57344
    buffer_load_dwordx4 a[88:91], v23, s[56:59], s68 offen sc1
    v_mfma_f32_16x16x32_bf16 v[164:167], a[132:135], a[100:103], v[164:167]
    ds_read_b64_tr_b16 a[166:167], v49 offset:61440
    v_mfma_f32_16x16x32_bf16 v[196:199], a[132:135], a[104:107], v[196:199]
    buffer_load_dwordx4 a[92:95], v24, s[56:59], s68 offen sc1
    v_mfma_f32_16x16x32_bf16 v[228:231], a[132:135], a[108:111], v[228:231]
    ds_read_b64_tr_b16 a[168:169], v50 offset:57344
    s_waitcnt lgkmcnt(15)
    v_mfma_f32_16x16x32_bf16 v[136:139], a[136:139], a[96:99], v[136:139]
    ds_read_b64_tr_b16 a[170:171], v50 offset:61440
    s_add_u32 s68, s68, 16384
    v_mfma_f32_16x16x32_bf16 v[168:171], a[136:139], a[100:103], v[168:171]
    v_mfma_f32_16x16x32_bf16 v[200:203], a[136:139], a[104:107], v[200:203]
    ds_read_b64_tr_b16 a[172:173], v51 offset:57344
    v_mfma_f32_16x16x32_bf16 v[232:235], a[136:139], a[108:111], v[232:235]
    ds_read_b64_tr_b16 a[174:175], v51 offset:61440
    s_waitcnt lgkmcnt(15)
    v_mfma_f32_16x16x32_bf16 v[140:143], a[140:143], a[96:99], v[140:143]
    v_mfma_f32_16x16x32_bf16 v[172:175], a[140:143], a[100:103], v[172:175]
    ds_read_b64_tr_b16 a[176:177], v52 offset:57344
    v_mfma_f32_16x16x32_bf16 v[204:207], a[140:143], a[104:107], v[204:207]
    ds_read_b64_tr_b16 a[178:179], v52 offset:61440
    v_mfma_f32_16x16x32_bf16 v[236:239], a[140:143], a[108:111], v[236:239]
    s_waitcnt lgkmcnt(15)
    v_mfma_f32_16x16x32_bf16 v[144:147], a[144:147], a[96:99], v[144:147]
    ds_read_b64_tr_b16 a[180:181], v53 offset:57344
    v_mfma_f32_16x16x32_bf16 v[176:179], a[144:147], a[100:103], v[176:179]
    ds_read_b64_tr_b16 a[182:183], v53 offset:61440
    v_mfma_f32_16x16x32_bf16 v[208:211], a[144:147], a[104:107], v[208:211]
    v_mfma_f32_16x16x32_bf16 v[240:243], a[144:147], a[108:111], v[240:243]
    ds_read_b64_tr_b16 a[184:185], v54 offset:57344
    s_waitcnt lgkmcnt(15)
    v_mfma_f32_16x16x32_bf16 v[148:151], a[148:151], a[96:99], v[148:151]
    ds_read_b64_tr_b16 a[186:187], v54 offset:61440
    v_mfma_f32_16x16x32_bf16 v[180:183], a[148:151], a[100:103], v[180:183]
    v_mfma_f32_16x16x32_bf16 v[212:215], a[148:151], a[104:107], v[212:215]
    ds_read_b64_tr_b16 a[188:189], v55 offset:57344
    v_mfma_f32_16x16x32_bf16 v[244:247], a[148:151], a[108:111], v[244:247]
    ds_read_b64_tr_b16 a[190:191], v55 offset:61440
    v_mfma_f32_16x16x32_bf16 v[152:155], a[152:155], a[96:99], v[152:155]
    v_mfma_f32_16x16x32_bf16 v[184:187], a[152:155], a[100:103], v[184:187]
    v_mfma_f32_16x16x32_bf16 v[216:219], a[152:155], a[104:107], v[216:219]
    v_mfma_f32_16x16x32_bf16 v[248:251], a[152:155], a[108:111], v[248:251]
    s_waitcnt lgkmcnt(15)
    v_mfma_f32_16x16x32_bf16 v[156:159], a[156:159], a[96:99], v[156:159]
    v_mfma_f32_16x16x32_bf16 v[188:191], a[156:159], a[100:103], v[188:191]
    v_mfma_f32_16x16x32_bf16 v[220:223], a[156:159], a[104:107], v[220:223]
    v_mfma_f32_16x16x32_bf16 v[252:255], a[156:159], a[108:111], v[252:255]
    s_waitcnt vmcnt(45) lgkmcnt(14)
    v_mfma_f32_16x16x32_bf16 v[128:131], a[160:163], a[112:115], v[128:131]
    buffer_load_dwordx4 a[96:99], v21, s[56:59], s68 offen sc1
    s_waitcnt vmcnt(45)
    v_mfma_f32_16x16x32_bf16 v[160:163], a[160:163], a[116:119], v[160:163]
    ds_read_b64_tr_b16 a[128:129], v56 offset:0
    s_waitcnt vmcnt(44)
    v_mfma_f32_16x16x32_bf16 v[192:195], a[160:163], a[120:123], v[192:195]
    ds_read_b64_tr_b16 a[130:131], v56 offset:4096
    buffer_load_dwordx4 a[100:103], v22, s[56:59], s68 offen sc1
    s_waitcnt vmcnt(44)
    v_mfma_f32_16x16x32_bf16 v[224:227], a[160:163], a[124:127], v[224:227]
    s_waitcnt lgkmcnt(14)
    v_mfma_f32_16x16x32_bf16 v[132:135], a[164:167], a[112:115], v[132:135]
    ds_read_b64_tr_b16 a[132:133], v57 offset:0
    buffer_load_dwordx4 a[104:107], v23, s[56:59], s68 offen sc1
    v_mfma_f32_16x16x32_bf16 v[164:167], a[164:167], a[116:119], v[164:167]
    ds_read_b64_tr_b16 a[134:135], v57 offset:4096
    v_mfma_f32_16x16x32_bf16 v[196:199], a[164:167], a[120:123], v[196:199]
    buffer_load_dwordx4 a[108:111], v24, s[56:59], s68 offen sc1
    v_mfma_f32_16x16x32_bf16 v[228:231], a[164:167], a[124:127], v[228:231]
    ds_read_b64_tr_b16 a[136:137], v58 offset:0
    s_waitcnt lgkmcnt(15)
    v_mfma_f32_16x16x32_bf16 v[136:139], a[168:171], a[112:115], v[136:139]
    ds_read_b64_tr_b16 a[138:139], v58 offset:4096
    s_add_u32 s68, s68, 16384
    v_mfma_f32_16x16x32_bf16 v[168:171], a[168:171], a[116:119], v[168:171]
    v_mfma_f32_16x16x32_bf16 v[200:203], a[168:171], a[120:123], v[200:203]
    ds_read_b64_tr_b16 a[140:141], v59 offset:0
    v_mfma_f32_16x16x32_bf16 v[232:235], a[168:171], a[124:127], v[232:235]
    ds_read_b64_tr_b16 a[142:143], v59 offset:4096
    s_waitcnt lgkmcnt(15)
    v_mfma_f32_16x16x32_bf16 v[140:143], a[172:175], a[112:115], v[140:143]
    v_mfma_f32_16x16x32_bf16 v[172:175], a[172:175], a[116:119], v[172:175]
    ds_read_b64_tr_b16 a[144:145], v60 offset:0
    v_mfma_f32_16x16x32_bf16 v[204:207], a[172:175], a[120:123], v[204:207]
    ds_read_b64_tr_b16 a[146:147], v60 offset:4096
    v_mfma_f32_16x16x32_bf16 v[236:239], a[172:175], a[124:127], v[236:239]
    s_waitcnt lgkmcnt(15)
    v_mfma_f32_16x16x32_bf16 v[144:147], a[176:179], a[112:115], v[144:147]
    ds_read_b64_tr_b16 a[148:149], v61 offset:0
    v_mfma_f32_16x16x32_bf16 v[176:179], a[176:179], a[116:119], v[176:179]
    ds_read_b64_tr_b16 a[150:151], v61 offset:4096
    v_mfma_f32_16x16x32_bf16 v[208:211], a[176:179], a[120:123], v[208:211]
    v_mfma_f32_16x16x32_bf16 v[240:243], a[176:179], a[124:127], v[240:243]
    ds_read_b64_tr_b16 a[152:153], v62 offset:0
    s_waitcnt lgkmcnt(15)
    v_mfma_f32_16x16x32_bf16 v[148:151], a[180:183], a[112:115], v[148:151]
    ds_read_b64_tr_b16 a[154:155], v62 offset:4096
    v_mfma_f32_16x16x32_bf16 v[180:183], a[180:183], a[116:119], v[180:183]
    v_mfma_f32_16x16x32_bf16 v[212:215], a[180:183], a[120:123], v[212:215]
    ds_read_b64_tr_b16 a[156:157], v63 offset:0
    v_mfma_f32_16x16x32_bf16 v[244:247], a[180:183], a[124:127], v[244:247]
    ds_read_b64_tr_b16 a[158:159], v63 offset:4096
    v_mfma_f32_16x16x32_bf16 v[152:155], a[184:187], a[112:115], v[152:155]
    v_mfma_f32_16x16x32_bf16 v[184:187], a[184:187], a[116:119], v[184:187]
    v_mfma_f32_16x16x32_bf16 v[216:219], a[184:187], a[120:123], v[216:219]
    v_mfma_f32_16x16x32_bf16 v[248:251], a[184:187], a[124:127], v[248:251]
    s_waitcnt lgkmcnt(15)
    v_mfma_f32_16x16x32_bf16 v[156:159], a[188:191], a[112:115], v[156:159]
    v_mfma_f32_16x16x32_bf16 v[188:191], a[188:191], a[116:119], v[188:191]
    v_mfma_f32_16x16x32_bf16 v[220:223], a[188:191], a[120:123], v[220:223]
    v_mfma_f32_16x16x32_bf16 v[252:255], a[188:191], a[124:127], v[252:255]
    s_waitcnt vmcnt(17)
    s_barrier
    s_waitcnt lgkmcnt(14)
    v_mfma_f32_16x16x32_bf16 v[128:131], a[128:131], a[0:3], v[128:131]
    buffer_load_dwordx4 a[112:115], v21, s[56:59], s68 offen sc1
    v_mfma_f32_16x16x32_bf16 v[160:163], a[128:131], a[4:7], v[160:163]
    ds_read_b64_tr_b16 a[160:161], v56 offset:8192
    v_mfma_f32_16x16x32_bf16 v[192:195], a[128:131], a[8:11], v[192:195]
    ds_read_b64_tr_b16 a[162:163], v56 offset:12288
    buffer_load_dwordx4 a[116:119], v22, s[56:59], s68 offen sc1
    v_mfma_f32_16x16x32_bf16 v[224:227], a[128:131], a[12:15], v[224:227]
    s_waitcnt lgkmcnt(14)
    v_mfma_f32_16x16x32_bf16 v[132:135], a[132:135], a[0:3], v[132:135]
    ds_read_b64_tr_b16 a[164:165], v57 offset:8192
    buffer_load_dwordx4 a[120:123], v23, s[56:59], s68 offen sc1
    v_mfma_f32_16x16x32_bf16 v[164:167], a[132:135], a[4:7], v[164:167]
    ds_read_b64_tr_b16 a[166:167], v57 offset:12288
    v_mfma_f32_16x16x32_bf16 v[196:199], a[132:135], a[8:11], v[196:199]
    buffer_load_dwordx4 a[124:127], v24, s[56:59], s68 offen sc1
    v_mfma_f32_16x16x32_bf16 v[228:231], a[132:135], a[12:15], v[228:231]
    ds_read_b64_tr_b16 a[168:169], v58 offset:8192
    s_waitcnt lgkmcnt(15)
    v_mfma_f32_16x16x32_bf16 v[136:139], a[136:139], a[0:3], v[136:139]
    ds_read_b64_tr_b16 a[170:171], v58 offset:12288
    s_add_u32 s68, s68, 16384
    v_mfma_f32_16x16x32_bf16 v[168:171], a[136:139], a[4:7], v[168:171]
    v_mfma_f32_16x16x32_bf16 v[200:203], a[136:139], a[8:11], v[200:203]
    ds_read_b64_tr_b16 a[172:173], v59 offset:8192
    v_mfma_f32_16x16x32_bf16 v[232:235], a[136:139], a[12:15], v[232:235]
    ds_read_b64_tr_b16 a[174:175], v59 offset:12288
    s_mov_b32 s82, 0
    s_add_u32 m0, s3, 65536
    s_waitcnt lgkmcnt(15)
    v_mfma_f32_16x16x32_bf16 v[140:143], a[140:143], a[0:3], v[140:143]
    buffer_load_dwordx4 v17, s[52:55], s82 offen lds
    v_mfma_f32_16x16x32_bf16 v[172:175], a[140:143], a[4:7], v[172:175]
    ds_read_b64_tr_b16 a[176:177], v60 offset:8192
    v_mfma_f32_16x16x32_bf16 v[204:207], a[140:143], a[8:11], v[204:207]
    ds_read_b64_tr_b16 a[178:179], v60 offset:12288
    v_mfma_f32_16x16x32_bf16 v[236:239], a[140:143], a[12:15], v[236:239]
    s_waitcnt lgkmcnt(15)
    v_mfma_f32_16x16x32_bf16 v[144:147], a[144:147], a[0:3], v[144:147]
    ds_read_b64_tr_b16 a[180:181], v61 offset:8192
    buffer_load_dwordx4 v18, s[52:55], s82 offen offset:1024 lds
    v_mfma_f32_16x16x32_bf16 v[176:179], a[144:147], a[4:7], v[176:179]
    ds_read_b64_tr_b16 a[182:183], v61 offset:12288
    v_mfma_f32_16x16x32_bf16 v[208:211], a[144:147], a[8:11], v[208:211]
    v_mfma_f32_16x16x32_bf16 v[240:243], a[144:147], a[12:15], v[240:243]
    ds_read_b64_tr_b16 a[184:185], v62 offset:8192
    s_waitcnt lgkmcnt(15)
    v_mfma_f32_16x16x32_bf16 v[148:151], a[148:151], a[0:3], v[148:151]
    ds_read_b64_tr_b16 a[186:187], v62 offset:12288
    v_mfma_f32_16x16x32_bf16 v[180:183], a[148:151], a[4:7], v[180:183]
    s_mov_b32 s83, 65536
    s_add_u32 m0, s3, 73728
    v_mfma_f32_16x16x32_bf16 v[212:215], a[148:151], a[8:11], v[212:215]
    ds_read_b64_tr_b16 a[188:189], v63 offset:8192
    buffer_load_dwordx4 v17, s[52:55], s83 offen lds
    v_mfma_f32_16x16x32_bf16 v[244:247], a[148:151], a[12:15], v[244:247]
    ds_read_b64_tr_b16 a[190:191], v63 offset:12288
    v_mfma_f32_16x16x32_bf16 v[152:155], a[152:155], a[0:3], v[152:155]
    v_mfma_f32_16x16x32_bf16 v[184:187], a[152:155], a[4:7], v[184:187]
    v_mfma_f32_16x16x32_bf16 v[216:219], a[152:155], a[8:11], v[216:219]
    buffer_load_dwordx4 v18, s[52:55], s83 offen offset:1024 lds
    v_mfma_f32_16x16x32_bf16 v[248:251], a[152:155], a[12:15], v[248:251]
    s_waitcnt lgkmcnt(15)
    v_mfma_f32_16x16x32_bf16 v[156:159], a[156:159], a[0:3], v[156:159]
    v_mfma_f32_16x16x32_bf16 v[188:191], a[156:159], a[4:7], v[188:191]
    v_mfma_f32_16x16x32_bf16 v[220:223], a[156:159], a[8:11], v[220:223]
    v_mfma_f32_16x16x32_bf16 v[252:255], a[156:159], a[12:15], v[252:255]
    s_waitcnt lgkmcnt(14)
    v_mfma_f32_16x16x32_bf16 v[128:131], a[160:163], a[16:19], v[128:131]
    v_readfirstlane_b32 s86, v43
    s_bfe_u32 s86, s86, 0x80010
    s_cmp_eq_u32 s86, 16
    s_cbranch_scc0 L_spC
L_okC:
    buffer_load_dwordx4 a[0:3], v21, s[56:59], s68 offen sc1
    v_mfma_f32_16x16x32_bf16 v[160:163], a[160:163], a[20:23], v[160:163]
    ds_read_b64_tr_b16 a[128:129], v56 offset:16384
    v_mfma_f32_16x16x32_bf16 v[192:195], a[160:163], a[24:27], v[192:195]
    ds_read_b64_tr_b16 a[130:131], v56 offset:20480
    buffer_load_dwordx4 a[4:7], v22, s[56:59], s68 offen sc1
    v_mfma_f32_16x16x32_bf16 v[224:227], a[160:163], a[28:31], v[224:227]
    s_waitcnt lgkmcnt(14)
    v_mfma_f32_16x16x32_bf16 v[132:135], a[164:167], a[16:19], v[132:135]
    ds_read_b64_tr_b16 a[132:133], v57 offset:16384
    buffer_load_dwordx4 a[8:11], v23, s[56:59], s68 offen sc1
    v_mfma_f32_16x16x32_bf16 v[164:167], a[164:167], a[20:23], v[164:167]
    ds_read_b64_tr_b16 a[134:135], v57 offset:20480
    v_mfma_f32_16x16x32_bf16 v[196:199], a[164:167], a[24:27], v[196:199]
    buffer_load_dwordx4 a[12:15], v24, s[56:59], s68 offen sc1
    v_mfma_f32_16x16x32_bf16 v[228:231], a[164:167], a[28:31], v[228:231]
    ds_read_b64_tr_b16 a[136:137], v58 offset:16384
    s_waitcnt lgkmcnt(15)
    v_mfma_f32_16x16x32_bf16 v[136:139], a[168:171], a[16:19], v[136:139]
    ds_read_b64_tr_b16 a[138:139], v58 offset:20480
    s_add_u32 s68, s68, 16384
    v_mfma_f32_16x16x32_bf16 v[168:171], a[168:171], a[20:23], v[168:171]
    v_mfma_f32_16x16x32_bf16 v[200:203], a[168:171], a[24:27], v[200:203]
    ds_read_b64_tr_b16 a[140:141], v59 offset:16384
    v_mfma_f32_16x16x32_bf16 v[232:235], a[168:171], a[28:31], v[232:235]
    ds_read_b64_tr_b16 a[142:143], v59 offset:20480
    s_mov_b32 s82, 131072
    s_add_u32 m0, s3, 81920
    s_waitcnt lgkmcnt(15)
    v_mfma_f32_16x16x32_bf16 v[140:143], a[172:175], a[16:19], v[140:143]
    buffer_load_dwordx4 v17, s[52:55], s82 offen lds
    v_mfma_f32_16x16x32_bf16 v[172:175], a[172:175], a[20:23], v[172:175]
    ds_read_b64_tr_b16 a[144:145], v60 offset:16384
    v_mfma_f32_16x16x32_bf16 v[204:207], a[172:175], a[24:27], v[204:207]
    ds_read_b64_tr_b16 a[146:147], v60 offset:20480
    v_mfma_f32_16x16x32_bf16 v[236:239], a[172:175], a[28:31], v[236:239]
    s_waitcnt lgkmcnt(15)
    v_mfma_f32_16x16x32_bf16 v[144:147], a[176:179], a[16:19], v[144:147]
    ds_read_b64_tr_b16 a[148:149], v61 offset:16384
    buffer_load_dwordx4 v18, s[52:55], s82 offen offset:1024 lds
    v_mfma_f32_16x16x32_bf16 v[176:179], a[176:179], a[20:23], v[176:179]
    ds_read_b64_tr_b16 a[150:151], v61 offset:20480
    v_mfma_f32_16x16x32_bf16 v[208:211], a[176:179], a[24:27], v[208:211]
    v_mfma_f32_16x16x32_bf16 v[240:243], a[176:179], a[28:31], v[240:243]
    ds_read_b64_tr_b16 a[152:153], v62 offset:16384
    s_waitcnt lgkmcnt(15)
    v_mfma_f32_16x16x32_bf16 v[148:151], a[180:183], a[16:19], v[148:151]
    ds_read_b64_tr_b16 a[154:155], v62 offset:20480
    v_mfma_f32_16x16x32_bf16 v[180:183], a[180:183], a[20:23], v[180:183]
    s_mov_b32 s83, 196608
    s_add_u32 m0, s3, 90112
    v_mfma_f32_16x16x32_bf16 v[212:215], a[180:183], a[24:27], v[212:215]
    ds_read_b64_tr_b16 a[156:157], v63 offset:16384
    buffer_load_dwordx4 v17, s[52:55], s83 offen lds
    v_mfma_f32_16x16x32_bf16 v[244:247], a[180:183], a[28:31], v[244:247]
    ds_read_b64_tr_b16 a[158:159], v63 offset:20480
    v_mfma_f32_16x16x32_bf16 v[152:155], a[184:187], a[16:19], v[152:155]
    v_mfma_f32_16x16x32_bf16 v[184:187], a[184:187], a[20:23], v[184:187]
    v_mfma_f32_16x16x32_bf16 v[216:219], a[184:187], a[24:27], v[216:219]
    buffer_load_dwordx4 v18, s[52:55], s83 offen offset:1024 lds
    v_mfma_f32_16x16x32_bf16 v[248:251], a[184:187], a[28:31], v[248:251]
    s_waitcnt lgkmcnt(15)
    v_mfma_f32_16x16x32_bf16 v[156:159], a[188:191], a[16:19], v[156:159]
    v_mfma_f32_16x16x32_bf16 v[188:191], a[188:191], a[20:23], v[188:191]
    v_mfma_f32_16x16x32_bf16 v[220:223], a[188:191], a[24:27], v[220:223]
    v_mfma_f32_16x16x32_bf16 v[252:255], a[188:191], a[28:31], v[252:255]
    s_waitcnt lgkmcnt(14)
    v_mfma_f32_16x16x32_bf16 v[128:131], a[128:131], a[32:35], v[128:131]
    buffer_load_dwordx4 a[16:19], v21, s[56:59], s68 offen sc1
    v_mfma_f32_16x16x32_bf16 v[160:163], a[128:131], a[36:39], v[160:163]
    ds_read_b64_tr_b16 a[160:161], v56 offset:24576
    v_mfma_f32_16x16x32_bf16 v[192:195], a[128:131], a[40:43], v[192:195]
    ds_read_b64_tr_b16 a[162:163], v56 offset:28672
    buffer_load_dwordx4 a[20:23], v22, s[56:59], s68 offen sc1
    v_mfma_f32_16x16x32_bf16 v[224:227], a[128:131], a[44:47], v[224:227]
    s_waitcnt lgkmcnt(14)
    v_mfma_f32_16x16x32_bf16 v[132:135], a[132:135], a[32:35], v[132:135]
    ds_read_b64_tr_b16 a[164:165], v57 offset:24576
    buffer_load_dwordx4 a[24:27], v23, s[56:59], s68 offen sc1
    v_mfma_f32_16x16x32_bf16 v[164:167], a[132:135], a[36:39], v[164:167]
    ds_read_b64_tr_b16 a[166:167], v57 offset:28672
    v_mfma_f32_16x16x32_bf16 v[196:199], a[132:135], a[40:43], v[196:199]
    buffer_load_dwordx4 a[28:31], v24, s[56:59], s68 offen sc1
    v_mfma_f32_16x16x32_bf16 v[228:231], a[132:135], a[44:47], v[228:231]
    ds_read_b64_tr_b16 a[168:169], v58 offset:24576
    s_waitcnt lgkmcnt(15)
    v_mfma_f32_16x16x32_bf16 v[136:139], a[136:139], a[32:35], v[136:139]
    ds_read_b64_tr_b16 a[170:171], v58 offset:28672
    s_add_u32 s68, s68, 16384
    v_mfma_f32_16x16x32_bf16 v[168:171], a[136:139], a[36:39], v[168:171]
    v_mfma_f32_16x16x32_bf16 v[200:203], a[136:139], a[40:43], v[200:203]
    ds_read_b64_tr_b16 a[172:173], v59 offset:24576
    v_mfma_f32_16x16x32_bf16 v[232:235], a[136:139], a[44:47], v[232:235]
    ds_read_b64_tr_b16 a[174:175], v59 offset:28672
    s_mov_b32 s82, 262144
    s_add_u32 m0, s3, 98304
    s_waitcnt lgkmcnt(15)
    v_mfma_f32_16x16x32_bf16 v[140:143], a[140:143], a[32:35], v[140:143]
    buffer_load_dwordx4 v17, s[52:55], s82 offen lds
    v_mfma_f32_16x16x32_bf16 v[172:175], a[140:143], a[36:39], v[172:175]
    ds_read_b64_tr_b16 a[176:177], v60 offset:24576
    v_mfma_f32_16x16x32_bf16 v[204:207], a[140:143], a[40:43], v[204:207]
    ds_read_b64_tr_b16 a[178:179], v60 offset:28672
    v_mfma_f32_16x16x32_bf16 v[236:239], a[140:143], a[44:47], v[236:239]
    s_waitcnt lgkmcnt(15)
    v_mfma_f32_16x16x32_bf16 v[144:147], a[144:147], a[32:35], v[144:147]
    ds_read_b64_tr_b16 a[180:181], v61 offset:24576
    buffer_load_dwordx4 v18, s[52:55], s82 offen offset:1024 lds
    v_mfma_f32_16x16x32_bf16 v[176:179], a[144:147], a[36:39], v[176:179]
    ds_read_b64_tr_b16 a[182:183], v61 offset:28672
    v_mfma_f32_16x16x32_bf16 v[208:211], a[144:147], a[40:43], v[208:211]
    v_mfma_f32_16x16x32_bf16 v[240:243], a[144:147], a[44:47], v[240:243]
    ds_read_b64_tr_b16 a[184:185], v62 offset:24576
    s_waitcnt lgkmcnt(15)
    v_mfma_f32_16x16x32_bf16 v[148:151], a[148:151], a[32:35], v[148:151]
    ds_read_b64_tr_b16 a[186:187], v62 offset:28672
    v_mfma_f32_16x16x32_bf16 v[180:183], a[148:151], a[36:39], v[180:183]
    s_mov_b32 s83, 327680
    s_add_u32 m0, s3, 106496
    v_mfma_f32_16x16x32_bf16 v[212:215], a[148:151], a[40:43], v[212:215]
    ds_read_b64_tr_b16 a[188:189], v63 offset:24576
    buffer_load_dwordx4 v17, s[52:55], s83 offen lds
    v_mfma_f32_16x16x32_bf16 v[244:247], a[148:151], a[44:47], v[244:247]
    ds_read_b64_tr_b16 a[190:191], v63 offset:28672
    v_mfma_f32_16x16x32_bf16 v[152:155], a[152:155], a[32:35], v[152:155]
    v_mfma_f32_16x16x32_bf16 v[184:187], a[152:155], a[36:39], v[184:187]
    v_mfma_f32_16x16x32_bf16 v[216:219], a[152:155], a[40:43], v[216:219]
    buffer_load_dwordx4 v18, s[52:55], s83 offen offset:1024 lds
    v_mfma_f32_16x16x32_bf16 v[248:251], a[152:155], a[44:47], v[248:251]
    s_waitcnt lgkmcnt(15)
    v_mfma_f32_16x16x32_bf16 v[156:159], a[156:159], a[32:35], v[156:159]
    v_mfma_f32_16x16x32_bf16 v[188:191], a[156:159], a[36:39], v[188:191]
    v_mfma_f32_16x16x32_bf16 v[220:223], a[156:159], a[40:43], v[220:223]
    v_mfma_f32_16x16x32_bf16 v[252:255], a[156:159], a[44:47], v[252:255]
    s_waitcnt vmcnt(40) lgkmcnt(14)
    v_mfma_f32_16x16x32_bf16 v[128:131], a[160:163], a[48:51], v[128:131]
    buffer_load_dwordx4 a[32:35], v21, s[56:59], s68 offen sc1
    s_waitcnt vmcnt(40)
    v_mfma_f32_16x16x32_bf16 v[160:163], a[160:163], a[52:55], v[160:163]
    ds_read_b64_tr_b16 a[128:129], v8 offset:0
    s_waitcnt vmcnt(39)
    v_mfma_f32_16x16x32_bf16 v[192:195], a[160:163], a[56:59], v[192:195]
    ds_read_b64_tr_b16 a[130:131], v8 offset:4096
    buffer_load_dwordx4 a[36:39], v22, s[56:59], s68 offen sc1
    s_waitcnt vmcnt(39)
    v_mfma_f32_16x16x32_bf16 v[224:227], a[160:163], a[60:63], v[224:227]
    s_waitcnt lgkmcnt(14)
    v_mfma_f32_16x16x32_bf16 v[132:135], a[164:167], a[48:51], v[132:135]
    ds_read_b64_tr_b16 a[132:133], v9 offset:0
    buffer_load_dwordx4 a[40:43], v23, s[56:59], s68 offen sc1
    v_mfma_f32_16x16x32_bf16 v[164:167], a[164:167], a[52:55], v[164:167]
    ds_read_b64_tr_b16 a[134:135], v9 offset:4096
    v_mfma_f32_16x16x32_bf16 v[196:199], a[164:167], a[56:59], v[196:199]
    buffer_load_dwordx4 a[44:47], v24, s[56:59], s68 offen sc1
    v_mfma_f32_16x16x32_bf16 v[228:231], a[164:167], a[60:63], v[228:231]
    ds_read_b64_tr_b16 a[136:137], v10 offset:0
    s_waitcnt lgkmcnt(15)
    v_mfma_f32_16x16x32_bf16 v[136:139], a[168:171], a[48:51], v[136:139]
    ds_read_b64_tr_b16 a[138:139], v10 offset:4096
    s_add_u32 s68, s68, 16384
    v_mfma_f32_16x16x32_bf16 v[168:171], a[168:171], a[52:55], v[168:171]
    v_mfma_f32_16x16x32_bf16 v[200:203], a[168:171], a[56:59], v[200:203]
    ds_read_b64_tr_b16 a[140:141], v11 offset:0
    v_mfma_f32_16x16x32_bf16 v[232:235], a[168:171], a[60:63], v[232:235]
    ds_read_b64_tr_b16 a[142:143], v11 offset:4096
    s_mov_b32 s82, 393216
    s_add_u32 m0, s3, 114688
    s_waitcnt lgkmcnt(15)
    v_mfma_f32_16x16x32_bf16 v[140:143], a[172:175], a[48:51], v[140:143]
    buffer_load_dwordx4 v17, s[52:55], s82 offen lds
    v_mfma_f32_16x16x32_bf16 v[172:175], a[172:175], a[52:55], v[172:175]
    ds_read_b64_tr_b16 a[144:145], v12 offset:0
    v_mfma_f32_16x16x32_bf16 v[204:207], a[172:175], a[56:59], v[204:207]
    ds_read_b64_tr_b16 a[146:147], v12 offset:4096
    v_mfma_f32_16x16x32_bf16 v[236:239], a[172:175], a[60:63], v[236:239]
    s_waitcnt lgkmcnt(15)
    v_mfma_f32_16x16x32_bf16 v[144:147], a[176:179], a[48:51], v[144:147]
    ds_read_b64_tr_b16 a[148:149], v13 offset:0
    buffer_load_dwordx4 v18, s[52:55], s82 offen offset:1024 lds
    v_mfma_f32_16x16x32_bf16 v[176:179], a[176:179], a[52:55], v[176:179]
    ds_read_b64_tr_b16 a[150:151], v13 offset:4096
    v_mfma_f32_16x16x32_bf16 v[208:211], a[176:179], a[56:59], v[208:211]
    v_mfma_f32_16x16x32_bf16 v[240:243], a[176:179], a[60:63], v[240:243]
    ds_read_b64_tr_b16 a[152:153], v14 offset:0
    s_waitcnt lgkmcnt(15)
    v_mfma_f32_16x16x32_bf16 v[148:151], a[180:183], a[48:51], v[148:151]
    ds_read_b64_tr_b16 a[154:155], v14 offset:4096
    v_mfma_f32_16x16x32_bf16 v[180:183], a[180:183], a[52:55], v[180:183]
    s_mov_b32 s83, 458752
    s_add_u32 m0, s3, 122880
    v_mfma_f32_16x16x32_bf16 v[212:215], a[180:183], a[56:59], v[212:215]
    ds_read_b64_tr_b16 a[156:157], v15 offset:0
    buffer_load_dwordx4 v17, s[52:55], s83 offen lds
    v_mfma_f32_16x16x32_bf16 v[244:247], a[180:183], a[60:63], v[244:247]
    ds_read_b64_tr_b16 a[158:159], v15 offset:4096
    v_mfma_f32_16x16x32_bf16 v[152:155], a[184:187], a[48:51], v[152:155]
    v_mfma_f32_16x16x32_bf16 v[184:187], a[184:187], a[52:55], v[184:187]
    v_mfma_f32_16x16x32_bf16 v[216:219], a[184:187], a[56:59], v[216:219]
    buffer_load_dwordx4 v18, s[52:55], s83 offen offset:1024 lds
    v_mfma_f32_16x16x32_bf16 v[248:251], a[184:187], a[60:63], v[248:251]
    s_waitcnt lgkmcnt(15)
    v_mfma_f32_16x16x32_bf16 v[156:159], a[188:191], a[48:51], v[156:159]
    v_mfma_f32_16x16x32_bf16 v[188:191], a[188:191], a[52:55], v[188:191]
    v_mfma_f32_16x16x32_bf16 v[220:223], a[188:191], a[56:59], v[220:223]
    v_mfma_f32_16x16x32_bf16 v[252:255], a[188:191], a[60:63], v[252:255]
    s_waitcnt vmcnt(44) lgkmcnt(14)
    v_mfma_f32_16x16x32_bf16 v[128:131], a[128:131], a[64:67], v[128:131]
    buffer_load_dwordx4 a[48:51], v21, s[56:59], s68 offen sc1
    s_waitcnt vmcnt(44)
    v_mfma_f32_16x16x32_bf16 v[160:163], a[128:131], a[68:71], v[160:163]
    ds_read_b64_tr_b16 a[160:161], v8 offset:8192
    s_waitcnt vmcnt(43)
    v_mfma_f32_16x16x32_bf16 v[192:195], a[128:131], a[72:75], v[192:195]
    ds_read_b64_tr_b16 a[162:163], v8 offset:12288
    buffer_load_dwordx4 a[52:55], v22, s[56:59], s68 offen sc1
    s_waitcnt vmcnt(43)
    v_mfma_f32_16x16x32_bf16 v[224:227], a[128:131], a[76:79], v[224:227]
    s_waitcnt lgkmcnt(14)
    v_mfma_f32_16x16x32_bf16 v[132:135], a[132:135], a[64:67], v[132:135]
    ds_read_b64_tr_b16 a[164:165], v9 offset:8192
    buffer_load_dwordx4 a[56:59], v23, s[56:59], s68 offen sc1
    v_mfma_f32_16x16x32_bf16 v[164:167], a[132:135], a[68:71], v[164:167]
    ds_read_b64_tr_b16 a[166:167], v9 offset:12288
    v_mfma_f32_16x16x32_bf16 v[196:199], a[132:135], a[72:75], v[196:199]
    buffer_load_dwordx4 a[60:63], v24, s[56:59], s68 offen sc1
    v_mfma_f32_16x16x32_bf16 v[228:231], a[132:135], a[76:79], v[228:231]
    ds_read_b64_tr_b16 a[168:169], v10 offset:8192
    s_waitcnt lgkmcnt(15)
    v_mfma_f32_16x16x32_bf16 v[136:139], a[136:139], a[64:67], v[136:139]
    ds_read_b64_tr_b16 a[170:171], v10 offset:12288
    s_add_u32 s68, s68, 16384
    v_mfma_f32_16x16x32_bf16 v[168:171], a[136:139], a[68:71], v[168:171]
    v_mfma_f32_16x16x32_bf16 v[200:203], a[136:139], a[72:75], v[200:203]
    ds_read_b64_tr_b16 a[172:173], v11 offset:8192
    v_mfma_f32_16x16x32_bf16 v[232:235], a[136:139], a[76:79], v[232:235]
    ds_read_b64_tr_b16 a[174:175], v11 offset:12288
    s_waitcnt lgkmcnt(15)
    v_mfma_f32_16x16x32_bf16 v[140:143], a[140:143], a[64:67], v[140:143]
    v_mfma_f32_16x16x32_bf16 v[172:175], a[140:143], a[68:71], v[172:175]
    ds_read_b64_tr_b16 a[176:177], v12 offset:8192
    v_mfma_f32_16x16x32_bf16 v[204:207], a[140:143], a[72:75], v[204:207]
    ds_read_b64_tr_b16 a[178:179], v12 offset:12288
    v_mfma_f32_16x16x32_bf16 v[236:239], a[140:143], a[76:79], v[236:239]
    s_waitcnt lgkmcnt(15)
    v_mfma_f32_16x16x32_bf16 v[144:147], a[144:147], a[64:67], v[144:147]
    ds_read_b64_tr_b16 a[180:181], v13 offset:8192
    v_mfma_f32_16x16x32_bf16 v[176:179], a[144:147], a[68:71], v[176:179]
    ds_read_b64_tr_b16 a[182:183], v13 offset:12288
    v_mfma_f32_16x16x32_bf16 v[208:211], a[144:147], a[72:75], v[208:211]
    v_mfma_f32_16x16x32_bf16 v[240:243], a[144:147], a[76:79], v[240:243]
    ds_read_b64_tr_b16 a[184:185], v14 offset:8192
    s_waitcnt lgkmcnt(15)
    v_mfma_f32_16x16x32_bf16 v[148:151], a[148:151], a[64:67], v[148:151]
    ds_read_b64_tr_b16 a[186:187], v14 offset:12288
    v_mfma_f32_16x16x32_bf16 v[180:183], a[148:151], a[68:71], v[180:183]
    v_mfma_f32_16x16x32_bf16 v[212:215], a[148:151], a[72:75], v[212:215]
    ds_read_b64_tr_b16 a[188:189], v15 offset:8192
    v_mfma_f32_16x16x32_bf16 v[244:247], a[148:151], a[76:79], v[244:247]
    ds_read_b64_tr_b16 a[190:191], v15 offset:12288
    v_mfma_f32_16x16x32_bf16 v[152:155], a[152:155], a[64:67], v[152:155]
    v_mfma_f32_16x16x32_bf16 v[184:187], a[152:155], a[68:71], v[184:187]
    v_mfma_f32_16x16x32_bf16 v[216:219], a[152:155], a[72:75], v[216:219]
    v_mfma_f32_16x16x32_bf16 v[248:251], a[152:155], a[76:79], v[248:251]
    s_waitcnt lgkmcnt(15)
    v_mfma_f32_16x16x32_bf16 v[156:159], a[156:159], a[64:67], v[156:159]
    v_mfma_f32_16x16x32_bf16 v[188:191], a[156:159], a[68:71], v[188:191]
    v_mfma_f32_16x16x32_bf16 v[220:223], a[156:159], a[72:75], v[220:223]
    v_mfma_f32_16x16x32_bf16 v[252:255], a[156:159], a[76:79], v[252:255]
    s_waitcnt vmcnt(43) lgkmcnt(14)
    v_mfma_f32_16x16x32_bf16 v[128:131], a[160:163], a[80:83], v[128:131]
    v_readfirstlane_b32 s86, v44
    s_cmp_eq_u32 s86, 64
    s_cbranch_scc0 L_spO
L_okO:
    buffer_load_dwordx4 a[64:67], v16, s[56:59], s69 offen offset:0 sc1
    s_waitcnt vmcnt(43)
    v_mfma_f32_16x16x32_bf16 v[160:163], a[160:163], a[84:87], v[160:163]
    ds_read_b64_tr_b16 a[128:129], v8 offset:16384
    s_waitcnt vmcnt(42)
    v_mfma_f32_16x16x32_bf16 v[192:195], a[160:163], a[88:91], v[192:195]
    ds_read_b64_tr_b16 a[130:131], v8 offset:20480
    buffer_load_dwordx4 a[68:71], v16, s[56:59], s69 offen offset:1024 sc1
    s_waitcnt vmcnt(42)
    v_mfma_f32_16x16x32_bf16 v[224:227], a[160:163], a[92:95], v[224:227]
    s_waitcnt lgkmcnt(14)
    v_mfma_f32_16x16x32_bf16 v[132:135], a[164:167], a[80:83], v[132:135]
    ds_read_b64_tr_b16 a[132:133], v9 offset:16384
    buffer_load_dwordx4 a[72:75], v16, s[56:59], s69 offen offset:2048 sc1
    v_mfma_f32_16x16x32_bf16 v[164:167], a[164:167], a[84:87], v[164:167]
    ds_read_b64_tr_b16 a[134:135], v9 offset:20480
    v_mfma_f32_16x16x32_bf16 v[196:199], a[164:167], a[88:91], v[196:199]
    buffer_load_dwordx4 a[76:79], v16, s[56:59], s69 offen offset:3072 sc1
    v_mfma_f32_16x16x32_bf16 v[228:231], a[164:167], a[92:95], v[228:231]
    ds_read_b64_tr_b16 a[136:137], v10 offset:16384
    s_waitcnt lgkmcnt(15)
    v_mfma_f32_16x16x32_bf16 v[136:139], a[168:171], a[80:83], v[136:139]
    ds_read_b64_tr_b16 a[138:139], v10 offset:20480
    s_add_u32 s69, s69, 4096
    v_mfma_f32_16x16x32_bf16 v[168:171], a[168:171], a[84:87], v[168:171]
    v_mfma_f32_16x16x32_bf16 v[200:203], a[168:171], a[88:91], v[200:203]
    ds_read_b64_tr_b16 a[140:141], v11 offset:16384
    v_mfma_f32_16x16x32_bf16 v[232:235], a[168:171], a[92:95], v[232:235]
    ds_read_b64_tr_b16 a[142:143], v11 offset:20480
    s_waitcnt lgkmcnt(15)
    v_mfma_f32_16x16x32_bf16 v[140:143], a[172:175], a[80:83], v[140:143]
    v_mfma_f32_16x16x32_bf16 v[172:175], a[172:175], a[84:87], v[172:175]
    ds_read_b64_tr_b16 a[144:145], v12 offset:16384
    v_mfma_f32_16x16x32_bf16 v[204:207], a[172:175], a[88:91], v[204:207]
    ds_read_b64_tr_b16 a[146:147], v12 offset:20480
    v_mfma_f32_16x16x32_bf16 v[236:239], a[172:175], a[92:95], v[236:239]
    s_waitcnt lgkmcnt(15)
    v_mfma_f32_16x16x32_bf16 v[144:147], a[176:179], a[80:83], v[144:147]
    ds_read_b64_tr_b16 a[148:149], v13 offset:16384
    v_mfma_f32_16x16x32_bf16 v[176:179], a[176:179], a[84:87], v[176:179]
    ds_read_b64_tr_b16 a[150:151], v13 offset:20480
    v_mfma_f32_16x16x32_bf16 v[208:211], a[176:179], a[88:91], v[208:211]
    v_mfma_f32_16x16x32_bf16 v[240:243], a[176:179], a[92:95], v[240:243]
    ds_read_b64_tr_b16 a[152:153], v14 offset:16384
    s_waitcnt lgkmcnt(15)
    v_mfma_f32_16x16x32_bf16 v[148:151], a[180:183], a[80:83], v[148:151]
    ds_read_b64_tr_b16 a[154:155], v14 offset:20480
    v_mfma_f32_16x16x32_bf16 v[180:183], a[180:183], a[84:87], v[180:183]
    v_mfma_f32_16x16x32_bf16 v[212:215], a[180:183], a[88:91], v[212:215]
    ds_read_b64_tr_b16 a[156:157], v15 offset:16384
    v_mfma_f32_16x16x32_bf16 v[244:247], a[180:183], a[92:95], v[244:247]
    ds_read_b64_tr_b16 a[158:159], v15 offset:20480
    v_mfma_f32_16x16x32_bf16 v[152:155], a[184:187], a[80:83], v[152:155]
    v_mfma_f32_16x16x32_bf16 v[184:187], a[184:187], a[84:87], v[184:187]
    v_mfma_f32_16x16x32_bf16 v[216:219], a[184:187], a[88:91], v[216:219]
    v_mfma_f32_16x16x32_bf16 v[248:251], a[184:187], a[92:95], v[248:251]
    s_waitcnt lgkmcnt(15)
    v_mfma_f32_16x16x32_bf16 v[156:159], a[188:191], a[80:83], v[156:159]
    v_mfma_f32_16x16x32_bf16 v[188:191], a[188:191], a[84:87], v[188:191]
    v_mfma_f32_16x16x32_bf16 v[220:223], a[188:191], a[88:91], v[220:223]
    v_mfma_f32_16x16x32_bf16 v[252:255], a[188:191], a[92:95], v[252:255]
    s_waitcnt vmcnt(43) lgkmcnt(14)
    v_mfma_f32_16x16x32_bf16 v[128:131], a[128:131], a[96:99], v[128:131]
    buffer_load_dwordx4 a[80:83], v16, s[56:59], s69 offen offset:0 sc1
    s_waitcnt vmcnt(43)
    v_mfma_f32_16x16x32_bf16 v[160:163], a[128:131], a[100:103], v[160:163]
    ds_read_b64_tr_b16 a[160:161], v8 offset:24576
    s_waitcnt vmcnt(42)
    v_mfma_f32_16x16x32_bf16 v[192:195], a[128:131], a[104:107], v[192:195]
    ds_read_b64_tr_b16 a[162:163], v8 offset:28672
    buffer_load_dwordx4 a[84:87], v16, s[56:59], s69 offen offset:1024 sc1
    s_waitcnt vmcnt(42)
    v_mfma_f32_16x16x32_bf16 v[224:227], a[128:131], a[108:111], v[224:227]
    s_waitcnt lgkmcnt(14)
    v_mfma_f32_16x16x32_bf16 v[132:135], a[132:135], a[96:99], v[132:135]
    ds_read_b64_tr_b16 a[164:165], v9 offset:24576
    buffer_load_dwordx4 a[88:91], v16, s[56:59], s69 offen offset:2048 sc1
    v_mfma_f32_16x16x32_bf16 v[164:167], a[132:135], a[100:103], v[164:167]
    ds_read_b64_tr_b16 a[166:167], v9 offset:28672
    v_mfma_f32_16x16x32_bf16 v[196:199], a[132:135], a[104:107], v[196:199]
    buffer_load_dwordx4 a[92:95], v16, s[56:59], s69 offen offset:3072 sc1
    v_mfma_f32_16x16x32_bf16 v[228:231], a[132:135], a[108:111], v[228:231]
    ds_read_b64_tr_b16 a[168:169], v10 offset:24576
    s_waitcnt lgkmcnt(15)
    v_mfma_f32_16x16x32_bf16 v[136:139], a[136:139], a[96:99], v[136:139]
    ds_read_b64_tr_b16 a[170:171], v10 offset:28672
    s_add_u32 s69, s69, 4096
    v_mfma_f32_16x16x32_bf16 v[168:171], a[136:139], a[100:103], v[168:171]
    v_mfma_f32_16x16x32_bf16 v[200:203], a[136:139], a[104:107], v[200:203]
    ds_read_b64_tr_b16 a[172:173], v11 offset:24576
    v_mfma_f32_16x16x32_bf16 v[232:235], a[136:139], a[108:111], v[232:235]
    ds_read_b64_tr_b16 a[174:175], v11 offset:28672
    s_waitcnt lgkmcnt(15)
    v_mfma_f32_16x16x32_bf16 v[140:143], a[140:143], a[96:99], v[140:143]
    v_mfma_f32_16x16x32_bf16 v[172:175], a[140:143], a[100:103], v[172:175]
    ds_read_b64_tr_b16 a[176:177], v12 offset:24576
    v_mfma_f32_16x16x32_bf16 v[204:207], a[140:143], a[104:107], v[204:207]
    ds_read_b64_tr_b16 a[178:179], v12 offset:28672
    v_mfma_f32_16x16x32_bf16 v[236:239], a[140:143], a[108:111], v[236:239]
    s_waitcnt lgkmcnt(15)
    v_mfma_f32_16x16x32_bf16 v[144:147], a[144:147], a[96:99], v[144:147]
    ds_read_b64_tr_b16 a[180:181], v13 offset:24576
    v_mfma_f32_16x16x32_bf16 v[176:179], a[144:147], a[100:103], v[176:179]
    ds_read_b64_tr_b16 a[182:183], v13 offset:28672
    v_mfma_f32_16x16x32_bf16 v[208:211], a[144:147], a[104:107], v[208:211]
    v_mfma_f32_16x16x32_bf16 v[240:243], a[144:147], a[108:111], v[240:243]
    ds_read_b64_tr_b16 a[184:185], v14 offset:24576
    s_waitcnt lgkmcnt(15)
    v_mfma_f32_16x16x32_bf16 v[148:151], a[148:151], a[96:99], v[148:151]
    ds_read_b64_tr_b16 a[186:187], v14 offset:28672
    v_mfma_f32_16x16x32_bf16 v[180:183], a[148:151], a[100:103], v[180:183]
    v_mfma_f32_16x16x32_bf16 v[212:215], a[148:151], a[104:107], v[212:215]
    ds_read_b64_tr_b16 a[188:189], v15 offset:24576
    v_mfma_f32_16x16x32_bf16 v[244:247], a[148:151], a[108:111], v[244:247]
    ds_read_b64_tr_b16 a[190:191], v15 offset:28672
    v_mfma_f32_16x16x32_bf16 v[152:155], a[152:155], a[96:99], v[152:155]
    v_mfma_f32_16x16x32_bf16 v[184:187], a[152:155], a[100:103], v[184:187]
    v_mfma_f32_16x16x32_bf16 v[216:219], a[152:155], a[104:107], v[216:219]
    v_mfma_f32_16x16x32_bf16 v[248:251], a[152:155], a[108:111], v[248:251]
    s_waitcnt lgkmcnt(15)
    v_mfma_f32_16x16x32_bf16 v[156:159], a[156:159], a[96:99], v[156:159]
    v_mfma_f32_16x16x32_bf16 v[188:191], a[156:159], a[100:103], v[188:191]
    v_mfma_f32_16x16x32_bf16 v[220:223], a[156:159], a[104:107], v[220:223]
    v_mfma_f32_16x16x32_bf16 v[252:255], a[156:159], a[108:111], v[252:255]
    s_waitcnt vmcnt(43) lgkmcnt(14)
    v_mfma_f32_16x16x32_bf16 v[128:131], a[160:163], a[112:115], v[128:131]
    buffer_load_dwordx4 a[96:99], v16, s[56:59], s69 offen offset:0 sc1
    s_waitcnt vmcnt(43)
    v_mfma_f32_16x16x32_bf16 v[160:163], a[160:163], a[116:119], v[160:163]
    ds_read_b64_tr_b16 a[128:129], v8 offset:32768
    s_waitcnt vmcnt(42)
    v_mfma_f32_16x16x32_bf16 v[192:195], a[160:163], a[120:123], v[192:195]
    ds_read_b64_tr_b16 a[130:131], v8 offset:36864
    buffer_load_dwordx4 a[100:103], v16, s[56:59], s69 offen offset:1024 sc1
    s_waitcnt vmcnt(42)
    v_mfma_f32_16x16x32_bf16 v[224:227], a[160:163], a[124:127], v[224:227]
    s_waitcnt lgkmcnt(14)
    v_mfma_f32_16x16x32_bf16 v[132:135], a[164:167], a[112:115], v[132:135]
    ds_read_b64_tr_b16 a[132:133], v9 offset:32768
    buffer_load_dwordx4 a[104:107], v16, s[56:59], s69 offen offset:2048 sc1
    v_mfma_f32_16x16x32_bf16 v[164:167], a[164:167], a[116:119], v[164:167]
    ds_read_b64_tr_b16 a[134:135], v9 offset:36864
    v_mfma_f32_16x16x32_bf16 v[196:199], a[164:167], a[120:123], v[196:199]
    buffer_load_dwordx4 a[108:111], v16, s[56:59], s69 offen offset:3072 sc1
    v_mfma_f32_16x16x32_bf16 v[228:231], a[164:167], a[124:127], v[228:231]
    ds_read_b64_tr_b16 a[136:137], v10 offset:32768
    s_waitcnt lgkmcnt(15)
    v_mfma_f32_16x16x32_bf16 v[136:139], a[168:171], a[112:115], v[136:139]
    ds_read_b64_tr_b16 a[138:139], v10 offset:36864
    s_add_u32 s69, s69, 4096
    v_mfma_f32_16x16x32_bf16 v[168:171], a[168:171], a[116:119], v[168:171]
    v_mfma_f32_16x16x32_bf16 v[200:203], a[168:171], a[120:123], v[200:203]
    ds_read_b64_tr_b16 a[140:141], v11 offset:32768
    v_mfma_f32_16x16x32_bf16 v[232:235], a[168:171], a[124:127], v[232:235]
    ds_read_b64_tr_b16 a[142:143], v11 offset:36864
    s_waitcnt lgkmcnt(15)
    v_mfma_f32_16x16x32_bf16 v[140:143], a[172:175], a[112:115], v[140:143]
    v_mfma_f32_16x16x32_bf16 v[172:175], a[172:175], a[116:119], v[172:175]
    ds_read_b64_tr_b16 a[144:145], v12 offset:32768
    v_mfma_f32_16x16x32_bf16 v[204:207], a[172:175], a[120:123], v[204:207]
    ds_read_b64_tr_b16 a[146:147], v12 offset:36864
    v_mfma_f32_16x16x32_bf16 v[236:239], a[172:175], a[124:127], v[236:239]
    s_waitcnt lgkmcnt(15)
    v_mfma_f32_16x16x32_bf16 v[144:147], a[176:179], a[112:115], v[144:147]
    ds_read_b64_tr_b16 a[148:149], v13 offset:32768
    v_mfma_f32_16x16x32_bf16 v[176:179], a[176:179], a[116:119], v[176:179]
    ds_read_b64_tr_b16 a[150:151], v13 offset:36864
    v_mfma_f32_16x16x32_bf16 v[208:211], a[176:179], a[120:123], v[208:211]
    v_mfma_f32_16x16x32_bf16 v[240:243], a[176:179], a[124:127], v[240:243]
    ds_read_b64_tr_b16 a[152:153], v14 offset:32768
    s_waitcnt lgkmcnt(15)
    v_mfma_f32_16x16x32_bf16 v[148:151], a[180:183], a[112:115], v[148:151]
    ds_read_b64_tr_b16 a[154:155], v14 offset:36864
    v_mfma_f32_16x16x32_bf16 v[180:183], a[180:183], a[116:119], v[180:183]
    v_mfma_f32_16x16x32_bf16 v[212:215], a[180:183], a[120:123], v[212:215]
    ds_read_b64_tr_b16 a[156:157], v15 offset:32768
    v_mfma_f32_16x16x32_bf16 v[244:247], a[180:183], a[124:127], v[244:247]
    ds_read_b64_tr_b16 a[158:159], v15 offset:36864
    v_mfma_f32_16x16x32_bf16 v[152:155], a[184:187], a[112:115], v[152:155]
    v_mfma_f32_16x16x32_bf16 v[184:187], a[184:187], a[116:119], v[184:187]
    v_mfma_f32_16x16x32_bf16 v[216:219], a[184:187], a[120:123], v[216:219]
    v_mfma_f32_16x16x32_bf16 v[248:251], a[184:187], a[124:127], v[248:251]
    s_waitcnt lgkmcnt(15)
    v_mfma_f32_16x16x32_bf16 v[156:159], a[188:191], a[112:115], v[156:159]
    v_mfma_f32_16x16x32_bf16 v[188:191], a[188:191], a[116:119], v[188:191]
    v_mfma_f32_16x16x32_bf16 v[220:223], a[188:191], a[120:123], v[220:223]
    v_mfma_f32_16x16x32_bf16 v[252:255], a[188:191], a[124:127], v[252:255]
    s_waitcnt vmcnt(16)
    s_barrier
    s_waitcnt lgkmcnt(14)
    v_mfma_f32_16x16x32_bf16 v[128:131], a[128:131], a[0:3], v[128:131]
    buffer_load_dwordx4 a[112:115], v16, s[56:59], s69 offen offset:0 sc1
    v_mfma_f32_16x16x32_bf16 v[160:163], a[128:131], a[4:7], v[160:163]
    ds_read_b64_tr_b16 a[160:161], v8 offset:40960
    v_mfma_f32_16x16x32_bf16 v[192:195], a[128:131], a[8:11], v[192:195]
    ds_read_b64_tr_b16 a[162:163], v8 offset:45056
    buffer_load_dwordx4 a[116:119], v16, s[56:59], s69 offen offset:1024 sc1
    v_mfma_f32_16x16x32_bf16 v[224:227], a[128:131], a[12:15], v[224:227]
    s_waitcnt lgkmcnt(14)
    v_mfma_f32_16x16x32_bf16 v[132:135], a[132:135], a[0:3], v[132:135]
    ds_read_b64_tr_b16 a[164:165], v9 offset:40960
    buffer_load_dwordx4 a[120:123], v16, s[56:59], s69 offen offset:2048 sc1
    v_mfma_f32_16x16x32_bf16 v[164:167], a[132:135], a[4:7], v[164:167]
    ds_read_b64_tr_b16 a[166:167], v9 offset:45056
    v_mfma_f32_16x16x32_bf16 v[196:199], a[132:135], a[8:11], v[196:199]
    buffer_load_dwordx4 a[124:127], v16, s[56:59], s69 offen offset:3072 sc1
    v_mfma_f32_16x16x32_bf16 v[228:231], a[132:135], a[12:15], v[228:231]
    ds_read_b64_tr_b16 a[168:169], v10 offset:40960
    s_waitcnt lgkmcnt(15)
    v_mfma_f32_16x16x32_bf16 v[136:139], a[136:139], a[0:3], v[136:139]
    ds_read_b64_tr_b16 a[170:171], v10 offset:45056
    s_add_u32 s69, s69, 4096
    v_mfma_f32_16x16x32_bf16 v[168:171], a[136:139], a[4:7], v[168:171]
    v_mfma_f32_16x16x32_bf16 v[200:203], a[136:139], a[8:11], v[200:203]
    ds_read_b64_tr_b16 a[172:173], v11 offset:40960
    v_mfma_f32_16x16x32_bf16 v[232:235], a[136:139], a[12:15], v[232:235]
    ds_read_b64_tr_b16 a[174:175], v11 offset:45056
    s_mov_b32 s82, 524288
    s_add_u32 m0, s3, 131072
    s_waitcnt lgkmcnt(15)
    v_mfma_f32_16x16x32_bf16 v[140:143], a[140:143], a[0:3], v[140:143]
    buffer_load_dwordx4 v17, s[52:55], s82 offen lds
    v_mfma_f32_16x16x32_bf16 v[172:175], a[140:143], a[4:7], v[172:175]
    ds_read_b64_tr_b16 a[176:177], v12 offset:40960
    v_mfma_f32_16x16x32_bf16 v[204:207], a[140:143], a[8:11], v[204:207]
    ds_read_b64_tr_b16 a[178:179], v12 offset:45056
    v_mfma_f32_16x16x32_bf16 v[236:239], a[140:143], a[12:15], v[236:239]
    s_waitcnt lgkmcnt(15)
    v_mfma_f32_16x16x32_bf16 v[144:147], a[144:147], a[0:3], v[144:147]
    ds_read_b64_tr_b16 a[180:181], v13 offset:40960
    buffer_load_dwordx4 v18, s[52:55], s82 offen offset:1024 lds
    v_mfma_f32_16x16x32_bf16 v[176:179], a[144:147], a[4:7], v[176:179]
    ds_read_b64_tr_b16 a[182:183], v13 offset:45056
    v_mfma_f32_16x16x32_bf16 v[208:211], a[144:147], a[8:11], v[208:211]
    v_mfma_f32_16x16x32_bf16 v[240:243], a[144:147], a[12:15], v[240:243]
    ds_read_b64_tr_b16 a[184:185], v14 offset:40960
    s_waitcnt lgkmcnt(15)
    v_mfma_f32_16x16x32_bf16 v[148:151], a[148:151], a[0:3], v[148:151]
    ds_read_b64_tr_b16 a[186:187], v14 offset:45056
    v_mfma_f32_16x16x32_bf16 v[180:183], a[148:151], a[4:7], v[180:183]
    s_mov_b32 s83, 589824
    s_add_u32 m0, s3, 139264
    v_mfma_f32_16x16x32_bf16 v[212:215], a[148:151], a[8:11], v[212:215]
    ds_read_b64_tr_b16 a[188:189], v15 offset:40960
    buffer_load_dwordx4 v17, s[52:55], s83 offen lds
    v_mfma_f32_16x16x32_bf16 v[244:247], a[148:151], a[12:15], v[244:247]
    ds_read_b64_tr_b16 a[190:191], v15 offset:45056
    v_mfma_f32_16x16x32_bf16 v[152:155], a[152:155], a[0:3], v[152:155]
    v_mfma_f32_16x16x32_bf16 v[184:187], a[152:155], a[4:7], v[184:187]
    v_mfma_f32_16x16x32_bf16 v[216:219], a[152:155], a[8:11], v[216:219]
    buffer_load_dwordx4 v18, s[52:55], s83 offen offset:1024 lds
    v_mfma_f32_16x16x32_bf16 v[248:251], a[152:155], a[12:15], v[248:251]
    s_waitcnt lgkmcnt(15)
    v_mfma_f32_16x16x32_bf16 v[156:159], a[156:159], a[0:3], v[156:159]
    v_mfma_f32_16x16x32_bf16 v[188:191], a[156:159], a[4:7], v[188:191]
    v_mfma_f32_16x16x32_bf16 v[220:223], a[156:159], a[8:11], v[220:223]
    v_mfma_f32_16x16x32_bf16 v[252:255], a[156:159], a[12:15], v[252:255]
    s_waitcnt lgkmcnt(14)
    v_mfma_f32_16x16x32_bf16 v[128:131], a[160:163], a[16:19], v[128:131]
    buffer_load_dwordx4 a[0:3], v16, s[56:59], s69 offen offset:0 sc1
    v_mfma_f32_16x16x32_bf16 v[160:163], a[160:163], a[20:23], v[160:163]
    ds_read_b64_tr_b16 a[128:129], v8 offset:49152
    v_mfma_f32_16x16x32_bf16 v[192:195], a[160:163], a[24:27], v[192:195]
    ds_read_b64_tr_b16 a[130:131], v8 offset:53248
    buffer_load_dwordx4 a[4:7], v16, s[56:59], s69 offen offset:1024 sc1
    v_mfma_f32_16x16x32_bf16 v[224:227], a[160:163], a[28:31], v[224:227]
    s_waitcnt lgkmcnt(14)
    v_mfma_f32_16x16x32_bf16 v[132:135], a[164:167], a[16:19], v[132:135]
    ds_read_b64_tr_b16 a[132:133], v9 offset:49152
    buffer_load_dwordx4 a[8:11], v16, s[56:59], s69 offen offset:2048 sc1
    v_mfma_f32_16x16x32_bf16 v[164:167], a[164:167], a[20:23], v[164:167]
    ds_read_b64_tr_b16 a[134:135], v9 offset:53248
    v_mfma_f32_16x16x32_bf16 v[196:199], a[164:167], a[24:27], v[196:199]
    buffer_load_dwordx4 a[12:15], v16, s[56:59], s69 offen offset:3072 sc1
    v_mfma_f32_16x16x32_bf16 v[228:231], a[164:167], a[28:31], v[228:231]
    ds_read_b64_tr_b16 a[136:137], v10 offset:49152
    s_waitcnt lgkmcnt(15)
    v_mfma_f32_16x16x32_bf16 v[136:139], a[168:171], a[16:19], v[136:139]
    ds_read_b64_tr_b16 a[138:139], v10 offset:53248
    s_add_u32 s69, s69, 4096
    v_mfma_f32_16x16x32_bf16 v[168:171], a[168:171], a[20:23], v[168:171]
    v_mfma_f32_16x16x32_bf16 v[200:203], a[168:171], a[24:27], v[200:203]
    ds_read_b64_tr_b16 a[140:141], v11 offset:49152
    v_mfma_f32_16x16x32_bf16 v[232:235], a[168:171], a[28:31], v[232:235]
    ds_read_b64_tr_b16 a[142:143], v11 offset:53248
    s_mov_b32 s82, 655360
    s_add_u32 m0, s3, 147456
    s_waitcnt lgkmcnt(15)
    v_mfma_f32_16x16x32_bf16 v[140:143], a[172:175], a[16:19], v[140:143]
    buffer_load_dwordx4 v17, s[52:55], s82 offen lds
    v_mfma_f32_16x16x32_bf16 v[172:175], a[172:175], a[20:23], v[172:175]
    ds_read_b64_tr_b16 a[144:145], v12 offset:49152
    v_mfma_f32_16x16x32_bf16 v[204:207], a[172:175], a[24:27], v[204:207]
    ds_read_b64_tr_b16 a[146:147], v12 offset:53248
    v_mfma_f32_16x16x32_bf16 v[236:239], a[172:175], a[28:31], v[236:239]
    s_waitcnt lgkmcnt(15)
    v_mfma_f32_16x16x32_bf16 v[144:147], a[176:179], a[16:19], v[144:147]
    ds_read_b64_tr_b16 a[148:149], v13 offset:49152
    buffer_load_dwordx4 v18, s[52:55], s82 offen offset:1024 lds
    v_mfma_f32_16x16x32_bf16 v[176:179], a[176:179], a[20:23], v[176:179]
    ds_read_b64_tr_b16 a[150:151], v13 offset:53248
    v_mfma_f32_16x16x32_bf16 v[208:211], a[176:179], a[24:27], v[208:211]
    v_mfma_f32_16x16x32_bf16 v[240:243], a[176:179], a[28:31], v[240:243]
    ds_read_b64_tr_b16 a[152:153], v14 offset:49152
    s_waitcnt lgkmcnt(15)
    v_mfma_f32_16x16x32_bf16 v[148:151], a[180:183], a[16:19], v[148:151]
    ds_read_b64_tr_b16 a[154:155], v14 offset:53248
    v_mfma_f32_16x16x32_bf16 v[180:183], a[180:183], a[20:23], v[180:183]
    s_mov_b32 s83, 720896
    s_add_u32 m0, s3, 155648
    v_mfma_f32_16x16x32_bf16 v[212:215], a[180:183], a[24:27], v[212:215]
    ds_read_b64_tr_b16 a[156:157], v15 offset:49152
    buffer_load_dwordx4 v17, s[52:55], s83 offen lds
    v_mfma_f32_16x16x32_bf16 v[244:247], a[180:183], a[28:31], v[244:247]
    ds_read_b64_tr_b16 a[158:159], v15 offset:53248
    v_mfma_f32_16x16x32_bf16 v[152:155], a[184:187], a[16:19], v[152:155]
    v_mfma_f32_16x16x32_bf16 v[184:187], a[184:187], a[20:23], v[184:187]
    v_mfma_f32_16x16x32_bf16 v[216:219], a[184:187], a[24:27], v[216:219]
    buffer_load_dwordx4 v18, s[52:55], s83 offen offset:1024 lds
    v_mfma_f32_16x16x32_bf16 v[248:251], a[184:187], a[28:31], v[248:251]
    s_waitcnt lgkmcnt(15)
    v_mfma_f32_16x16x32_bf16 v[156:159], a[188:191], a[16:19], v[156:159]
    v_mfma_f32_16x16x32_bf16 v[188:191], a[188:191], a[20:23], v[188:191]
    v_mfma_f32_16x16x32_bf16 v[220:223], a[188:191], a[24:27], v[220:223]
    v_mfma_f32_16x16x32_bf16 v[252:255], a[188:191], a[28:31], v[252:255]
    s_waitcnt lgkmcnt(14)
    v_mfma_f32_16x16x32_bf16 v[128:131], a[128:131], a[32:35], v[128:131]
    buffer_load_dwordx4 a[16:19], v16, s[56:59], s69 offen offset:0 sc1
    v_mfma_f32_16x16x32_bf16 v[160:163], a[128:131], a[36:39], v[160:163]
    ds_read_b64_tr_b16 a[160:161], v8 offset:57344
    v_mfma_f32_16x16x32_bf16 v[192:195], a[128:131], a[40:43], v[192:195]
    ds_read_b64_tr_b16 a[162:163], v8 offset:61440
    buffer_load_dwordx4 a[20:23], v16, s[56:59], s69 offen offset:1024 sc1
    v_mfma_f32_16x16x32_bf16 v[224:227], a[128:131], a[44:47], v[224:227]
    s_waitcnt lgkmcnt(14)
    v_mfma_f32_16x16x32_bf16 v[132:135], a[132:135], a[32:35], v[132:135]
    ds_read_b64_tr_b16 a[164:165], v9 offset:57344
    buffer_load_dwordx4 a[24:27], v16, s[56:59], s69 offen offset:2048 sc1
    v_mfma_f32_16x16x32_bf16 v[164:167], a[132:135], a[36:39], v[164:167]
    ds_read_b64_tr_b16 a[166:167], v9 offset:61440
    v_mfma_f32_16x16x32_bf16 v[196:199], a[132:135], a[40:43], v[196:199]
    buffer_load_dwordx4 a[28:31], v16, s[56:59], s69 offen offset:3072 sc1
    v_mfma_f32_16x16x32_bf16 v[228:231], a[132:135], a[44:47], v[228:231]
    ds_read_b64_tr_b16 a[168:169], v10 offset:57344
    s_waitcnt lgkmcnt(15)
    v_mfma_f32_16x16x32_bf16 v[136:139], a[136:139], a[32:35], v[136:139]
    ds_read_b64_tr_b16 a[170:171], v10 offset:61440
    s_add_u32 s69, s69, 4096
    v_mfma_f32_16x16x32_bf16 v[168:171], a[136:139], a[36:39], v[168:171]
    v_mfma_f32_16x16x32_bf16 v[200:203], a[136:139], a[40:43], v[200:203]
    ds_read_b64_tr_b16 a[172:173], v11 offset:57344
    v_mfma_f32_16x16x32_bf16 v[232:235], a[136:139], a[44:47], v[232:235]
    ds_read_b64_tr_b16 a[174:175], v11 offset:61440
    s_mov_b32 s82, 786432
    s_add_u32 m0, s3, 0
    s_waitcnt lgkmcnt(15)
    v_mfma_f32_16x16x32_bf16 v[140:143], a[140:143], a[32:35], v[140:143]
    buffer_load_dwordx4 v17, s[52:55], s82 offen lds
    v_mfma_f32_16x16x32_bf16 v[172:175], a[140:143], a[36:39], v[172:175]
    ds_read_b64_tr_b16 a[176:177], v12 offset:57344
    v_mfma_f32_16x16x32_bf16 v[204:207], a[140:143], a[40:43], v[204:207]
    ds_read_b64_tr_b16 a[178:179], v12 offset:61440
    v_mfma_f32_16x16x32_bf16 v[236:239], a[140:143], a[44:47], v[236:239]
    s_waitcnt lgkmcnt(15)
    v_mfma_f32_16x16x32_bf16 v[144:147], a[144:147], a[32:35], v[144:147]
    ds_read_b64_tr_b16 a[180:181], v13 offset:57344
    buffer_load_dwordx4 v18, s[52:55], s82 offen offset:1024 lds
    v_mfma_f32_16x16x32_bf16 v[176:179], a[144:147], a[36:39], v[176:179]
    ds_read_b64_tr_b16 a[182:183], v13 offset:61440
    v_mfma_f32_16x16x32_bf16 v[208:211], a[144:147], a[40:43], v[208:211]
    v_mfma_f32_16x16x32_bf16 v[240:243], a[144:147], a[44:47], v[240:243]
    ds_read_b64_tr_b16 a[184:185], v14 offset:57344
    s_waitcnt lgkmcnt(15)
    v_mfma_f32_16x16x32_bf16 v[148:151], a[148:151], a[32:35], v[148:151]
    ds_read_b64_tr_b16 a[186:187], v14 offset:61440
    v_mfma_f32_16x16x32_bf16 v[180:183], a[148:151], a[36:39], v[180:183]
    s_mov_b32 s83, 851968
    s_add_u32 m0, s3, 8192
    v_mfma_f32_16x16x32_bf16 v[212:215], a[148:151], a[40:43], v[212:215]
    ds_read_b64_tr_b16 a[188:189], v15 offset:57344
    buffer_load_dwordx4 v17, s[52:55], s83 offen lds
    v_mfma_f32_16x16x32_bf16 v[244:247], a[148:151], a[44:47], v[244:247]
    ds_read_b64_tr_b16 a[190:191], v15 offset:61440
    v_mfma_f32_16x16x32_bf16 v[152:155], a[152:155], a[32:35], v[152:155]
    v_mfma_f32_16x16x32_bf16 v[184:187], a[152:155], a[36:39], v[184:187]
    v_mfma_f32_16x16x32_bf16 v[216:219], a[152:155], a[40:43], v[216:219]
    buffer_load_dwordx4 v18, s[52:55], s83 offen offset:1024 lds
    v_mfma_f32_16x16x32_bf16 v[248:251], a[152:155], a[44:47], v[248:251]
    s_waitcnt lgkmcnt(15)
    v_mfma_f32_16x16x32_bf16 v[156:159], a[156:159], a[32:35], v[156:159]
    v_mfma_f32_16x16x32_bf16 v[188:191], a[156:159], a[36:39], v[188:191]
    v_mfma_f32_16x16x32_bf16 v[220:223], a[156:159], a[40:43], v[220:223]
    v_mfma_f32_16x16x32_bf16 v[252:255], a[156:159], a[44:47], v[252:255]
    s_waitcnt vmcnt(38) lgkmcnt(14)
    v_mfma_f32_16x16x32_bf16 v[160:163], a[160:163], a[52:55], v[160:163]
    buffer_load_dwordx4 a[32:35], v16, s[56:59], s69 offen offset:0 sc1
    s_waitcnt lgkmcnt(12)
    v_mfma_f32_16x16x32_bf16 v[164:167], a[164:167], a[52:55], v[164:167]
    ds_read_b64_tr_b16 a[128:129], v48 offset:0
    s_waitcnt lgkmcnt(11)
    v_mfma_f32_16x16x32_bf16 v[168:171], a[168:171], a[52:55], v[168:171]
    ds_read_b64_tr_b16 a[130:131], v48 offset:4096
    buffer_load_dwordx4 a[36:39], v16, s[56:59], s69 offen offset:1024 sc1
    s_waitcnt lgkmcnt(10)
    v_mfma_f32_16x16x32_bf16 v[172:175], a[172:175], a[52:55], v[172:175]
    ds_read_b64_tr_b16 a[132:133], v49 offset:0
    s_waitcnt lgkmcnt(9)
    v_mfma_f32_16x16x32_bf16 v[176:179], a[176:179], a[52:55], v[176:179]
    ds_read_b64_tr_b16 a[134:135], v49 offset:4096
    buffer_load_dwordx4 a[40:43], v16, s[56:59], s69 offen offset:2048 sc1
    s_waitcnt lgkmcnt(8)
    v_mfma_f32_16x16x32_bf16 v[180:183], a[180:183], a[52:55], v[180:183]
    ds_read_b64_tr_b16 a[136:137], v50 offset:0
    s_waitcnt lgkmcnt(7)
    v_mfma_f32_16x16x32_bf16 v[184:187], a[184:187], a[52:55], v[184:187]
    ds_read_b64_tr_b16 a[138:139], v50 offset:4096
    buffer_load_dwordx4 a[44:47], v16, s[56:59], s69 offen offset:3072 sc1
    s_waitcnt lgkmcnt(6)
    v_mfma_f32_16x16x32_bf16 v[188:191], a[188:191], a[52:55], v[188:191]
    ds_read_b64_tr_b16 a[140:141], v51 offset:0
    s_waitcnt vmcnt(41)
    v_mfma_f32_16x16x32_bf16 v[192:195], a[160:163], a[56:59], v[192:195]
    ds_read_b64_tr_b16 a[142:143], v51 offset:4096
    s_add_u32 s69, s69, 4096
    v_mfma_f32_16x16x32_bf16 v[196:199], a[164:167], a[56:59], v[196:199]
    ds_read_b64_tr_b16 a[144:145], v52 offset:0
    v_mfma_f32_16x16x32_bf16 v[200:203], a[168:171], a[56:59], v[200:203]
    ds_read_b64_tr_b16 a[146:147], v52 offset:4096
    v_mfma_f32_16x16x32_bf16 v[204:207], a[172:175], a[56:59], v[204:207]
    ds_read_b64_tr_b16 a[148:149], v53 offset:0
    s_mov_b32 s82, 917504
    s_add_u32 m0, s3, 16384
    v_mfma_f32_16x16x32_bf16 v[208:211], a[176:179], a[56:59], v[208:211]
    ds_read_b64_tr_b16 a[150:151], v53 offset:4096
    buffer_load_dwordx4 v17, s[52:55], s82 offen lds
    v_cvt_pk_bf16_f32 v160, v160, v161
    v_cvt_pk_bf16_f32 v161, v162, v163
    v_mfma_f32_16x16x32_bf16 v[212:215], a[180:183], a[56:59], v[212:215]
    ds_read_b64_tr_b16 a[152:153], v54 offset:0
    v_cvt_pk_bf16_f32 v162, v164, v165
    v_cvt_pk_bf16_f32 v163, v166, v167
    v_mfma_f32_16x16x32_bf16 v[216:219], a[184:187], a[56:59], v[216:219]
    ds_read_b64_tr_b16 a[154:155], v54 offset:4096
    buffer_store_dwordx4 v[160:163], v16, s[56:59], s70 offen offset:0 sc1
    v_cvt_pk_bf16_f32 v168, v168, v169
    v_mfma_f32_16x16x32_bf16 v[220:223], a[188:191], a[56:59], v[220:223]
    v_cvt_pk_bf16_f32 v169, v170, v171
    v_cvt_pk_bf16_f32 v170, v172, v173
    s_waitcnt vmcnt(42)
    v_mfma_f32_16x16x32_bf16 v[224:227], a[160:163], a[60:63], v[224:227]
    buffer_load_dwordx4 v18, s[52:55], s82 offen offset:1024 lds
    v_cvt_pk_bf16_f32 v171, v174, v175
    buffer_store_dwordx4 v[168:171], v16, s[56:59], s70 offen offset:1024 sc1
    v_mfma_f32_16x16x32_bf16 v[228:231], a[164:167], a[60:63], v[228:231]
    v_cvt_pk_bf16_f32 v176, v176, v177
    v_cvt_pk_bf16_f32 v177, v178, v179
    v_mfma_f32_16x16x32_bf16 v[232:235], a[168:171], a[60:63], v[232:235]
    v_cvt_pk_bf16_f32 v178, v180, v181
    v_cvt_pk_bf16_f32 v179, v182, v183
    v_mfma_f32_16x16x32_bf16 v[236:239], a[172:175], a[60:63], v[236:239]
    buffer_store_dwordx4 v[176:179], v16, s[56:59], s70 offen offset:2048 sc1
    v_cvt_pk_bf16_f32 v184, v184, v185
    v_mfma_f32_16x16x32_bf16 v[240:243], a[176:179], a[60:63], v[240:243]
    v_cvt_pk_bf16_f32 v185, v186, v187
    v_cvt_pk_bf16_f32 v186, v188, v189
    v_mfma_f32_16x16x32_bf16 v[244:247], a[180:183], a[60:63], v[244:247]
    s_mov_b32 s83, 983040
    s_add_u32 m0, s3, 24576
    v_cvt_pk_bf16_f32 v187, v190, v191
    buffer_store_dwordx4 v[184:187], v16, s[56:59], s70 offen offset:3072 sc1
    v_mfma_f32_16x16x32_bf16 v[248:251], a[184:187], a[60:63], v[248:251]
    buffer_load_dwordx4 v17, s[52:55], s83 offen lds
    v_cvt_pk_bf16_f32 v192, v192, v193
    v_cvt_pk_bf16_f32 v193, v194, v195
    v_mfma_f32_16x16x32_bf16 v[252:255], a[188:191], a[60:63], v[252:255]
    v_cvt_pk_bf16_f32 v194, v196, v197
    v_cvt_pk_bf16_f32 v195, v198, v199
    v_mfma_f32_16x16x32_bf16 v[128:131], a[160:163], a[48:51], v[128:131]
    buffer_store_dwordx4 v[192:195], v16, s[56:59], s71 offen offset:0 sc1
    v_cvt_pk_bf16_f32 v200, v200, v201
    v_mfma_f32_16x16x32_bf16 v[132:135], a[164:167], a[48:51], v[132:135]
    v_cvt_pk_bf16_f32 v201, v202, v203
    v_cvt_pk_bf16_f32 v202, v204, v205
    v_mfma_f32_16x16x32_bf16 v[136:139], a[168:171], a[48:51], v[136:139]
    buffer_load_dwordx4 v18, s[52:55], s83 offen offset:1024 lds
    v_cvt_pk_bf16_f32 v203, v206, v207
    buffer_store_dwordx4 v[200:203], v16, s[56:59], s71 offen offset:1024 sc1
    v_mfma_f32_16x16x32_bf16 v[140:143], a[172:175], a[48:51], v[140:143]
    v_cvt_pk_bf16_f32 v208, v208, v209
    v_cvt_pk_bf16_f32 v209, v210, v211
    v_mfma_f32_16x16x32_bf16 v[144:147], a[176:179], a[48:51], v[144:147]
    v_cvt_pk_bf16_f32 v210, v212, v213
    v_cvt_pk_bf16_f32 v211, v214, v215
    v_mfma_f32_16x16x32_bf16 v[148:151], a[180:183], a[48:51], v[148:151]
    buffer_store_dwordx4 v[208:211], v16, s[56:59], s71 offen offset:2048 sc1
    v_cvt_pk_bf16_f32 v216, v216, v217
    v_mfma_f32_16x16x32_bf16 v[152:155], a[184:187], a[48:51], v[152:155]
    v_cvt_pk_bf16_f32 v217, v218, v219
    v_cvt_pk_bf16_f32 v218, v220, v221
    v_mfma_f32_16x16x32_bf16 v[156:159], a[188:191], a[48:51], v[156:159]
    v_cvt_pk_bf16_f32 v219, v222, v223
    buffer_store_dwordx4 v[216:219], v16, s[56:59], s71 offen offset:3072 sc1
    s_barrier
    buffer_load_dwordx4 a[48:51], v16, s[56:59], s69 offen offset:0 sc1
    buffer_load_dwordx4 a[52:55], v16, s[56:59], s69 offen offset:1024 sc1
    buffer_load_dwordx4 a[56:59], v16, s[56:59], s69 offen offset:2048 sc1
    buffer_load_dwordx4 a[60:63], v16, s[56:59], s69 offen offset:3072 sc1
    s_add_u32 s69, s69, 4096
    s_waitcnt vmcnt(55) lgkmcnt(12)
    v_mfma_f32_16x16x32_bf16 v[96:99], a[128:131], a[64:67], 0
    ds_read_b64_tr_b16 a[156:157], v55 offset:0
    ds_read_b64_tr_b16 a[158:159], v55 offset:4096
    v_cvt_pk_bf16_f32 v224, v224, v225
    v_cvt_pk_bf16_f32 v225, v226, v227
    s_waitcnt lgkmcnt(12)
    v_mfma_f32_16x16x32_bf16 v[100:103], a[132:135], a[64:67], 0
    ds_read_b64_tr_b16 a[160:161], v48 offset:8192
    ds_read_b64_tr_b16 a[162:163], v48 offset:12288
    v_cvt_pk_bf16_f32 v226, v228, v229
    v_cvt_pk_bf16_f32 v227, v230, v231
    s_waitcnt lgkmcnt(12)
    v_mfma_f32_16x16x32_bf16 v[104:107], a[136:139], a[64:67], 0
    ds_read_b64_tr_b16 a[164:165], v49 offset:8192
    ds_read_b64_tr_b16 a[166:167], v49 offset:12288
    buffer_store_dwordx4 v[224:227], v16, s[56:59], s72 offen offset:0 sc1
    v_cvt_pk_bf16_f32 v232, v232, v233
    s_waitcnt lgkmcnt(12)
    v_mfma_f32_16x16x32_bf16 v[108:111], a[140:143], a[64:67], 0
    ds_read_b64_tr_b16 a[168:169], v50 offset:8192
    ds_read_b64_tr_b16 a[170:171], v50 offset:12288
    v_cvt_pk_bf16_f32 v233, v234, v235
    v_cvt_pk_bf16_f32 v234, v236, v237
    s_waitcnt lgkmcnt(12)
    v_mfma_f32_16x16x32_bf16 v[112:115], a[144:147], a[64:67], 0
    ds_read_b64_tr_b16 a[172:173], v51 offset:8192
    ds_read_b64_tr_b16 a[174:175], v51 offset:12288
    v_cvt_pk_bf16_f32 v235, v238, v239
    buffer_store_dwordx4 v[232:235], v16, s[56:59], s72 offen offset:1024 sc1
    s_waitcnt lgkmcnt(12)
    v_mfma_f32_16x16x32_bf16 v[116:119], a[148:151], a[64:67], 0
    ds_read_b64_tr_b16 a[176:177], v52 offset:8192
    ds_read_b64_tr_b16 a[178:179], v52 offset:12288
    v_cvt_pk_bf16_f32 v240, v240, v241
    v_cvt_pk_bf16_f32 v241, v242, v243
    s_waitcnt lgkmcnt(12)
    v_mfma_f32_16x16x32_bf16 v[120:123], a[152:155], a[64:67], 0
    ds_read_b64_tr_b16 a[180:181], v53 offset:8192
    ds_read_b64_tr_b16 a[182:183], v53 offset:12288
    v_cvt_pk_bf16_f32 v242, v244, v245
    v_cvt_pk_bf16_f32 v243, v246, v247
    s_waitcnt lgkmcnt(12)
    v_mfma_f32_16x16x32_bf16 v[124:127], a[156:159], a[64:67], 0
    ds_read_b64_tr_b16 a[184:185], v54 offset:8192
    ds_read_b64_tr_b16 a[186:187], v54 offset:12288
    buffer_store_dwordx4 v[240:243], v16, s[56:59], s72 offen offset:2048 sc1
    v_cvt_pk_bf16_f32 v248, v248, v249
    s_waitcnt vmcnt(57) lgkmcnt(12)
    v_mfma_f32_16x16x32_bf16 v[96:99], a[160:163], a[68:71], v[96:99]
    ds_read_b64_tr_b16 a[188:189], v55 offset:8192
    ds_read_b64_tr_b16 a[190:191], v55 offset:12288
    v_cvt_pk_bf16_f32 v249, v250, v251
    v_cvt_pk_bf16_f32 v250, v252, v253
    s_waitcnt lgkmcnt(12)
    v_mfma_f32_16x16x32_bf16 v[100:103], a[164:167], a[68:71], v[100:103]
    ds_read_b64_tr_b16 a[128:129], v48 offset:16384
    ds_read_b64_tr_b16 a[130:131], v48 offset:20480
    v_cvt_pk_bf16_f32 v251, v254, v255
    buffer_store_dwordx4 v[248:251], v16, s[56:59], s72 offen offset:3072 sc1
    s_waitcnt lgkmcnt(12)
    v_mfma_f32_16x16x32_bf16 v[104:107], a[168:171], a[68:71], v[104:107]
    ds_read_b64_tr_b16 a[132:133], v49 offset:16384
    ds_read_b64_tr_b16 a[134:135], v49 offset:20480
    s_mov_b32 s82, 1048576
    s_add_u32 m0, s3, 32768
    s_nop 0
    buffer_load_dwordx4 v17, s[52:55], s82 offen lds
    s_waitcnt lgkmcnt(12)
    v_mfma_f32_16x16x32_bf16 v[108:111], a[172:175], a[68:71], v[108:111]
    ds_read_b64_tr_b16 a[136:137], v50 offset:16384
    ds_read_b64_tr_b16 a[138:139], v50 offset:20480
    s_waitcnt lgkmcnt(12)
    v_mfma_f32_16x16x32_bf16 v[112:115], a[176:179], a[68:71], v[112:115]
    ds_read_b64_tr_b16 a[140:141], v51 offset:16384
    ds_read_b64_tr_b16 a[142:143], v51 offset:20480
    s_waitcnt lgkmcnt(12)
    v_mfma_f32_16x16x32_bf16 v[116:119], a[180:183], a[68:71], v[116:119]
    ds_read_b64_tr_b16 a[144:145], v52 offset:16384
    ds_read_b64_tr_b16 a[146:147], v52 offset:20480
    buffer_load_dwordx4 v18, s[52:55], s82 offen offset:1024 lds
    s_waitcnt lgkmcnt(12)
    v_mfma_f32_16x16x32_bf16 v[120:123], a[184:187], a[68:71], v[120:123]
    ds_read_b64_tr_b16 a[148:149], v53 offset:16384
    ds_read_b64_tr_b16 a[150:151], v53 offset:20480
    s_waitcnt lgkmcnt(12)
    v_mfma_f32_16x16x32_bf16 v[124:127], a[188:191], a[68:71], v[124:127]
    ds_read_b64_tr_b16 a[152:153], v54 offset:16384
    ds_read_b64_tr_b16 a[154:155], v54 offset:20480
    s_waitcnt vmcnt(59) lgkmcnt(12)
    v_mfma_f32_16x16x32_bf16 v[96:99], a[128:131], a[72:75], v[96:99]
    ds_read_b64_tr_b16 a[156:157], v55 offset:16384
    ds_read_b64_tr_b16 a[158:159], v55 offset:20480
    s_mov_b32 s83, 1114112
    s_add_u32 m0, s3, 40960
    s_nop 0
    buffer_load_dwordx4 v17, s[52:55], s83 offen lds
    s_waitcnt lgkmcnt(12)
    v_mfma_f32_16x16x32_bf16 v[100:103], a[132:135], a[72:75], v[100:103]
    ds_read_b64_tr_b16 a[160:161], v48 offset:24576
    ds_read_b64_tr_b16 a[162:163], v48 offset:28672
    s_waitcnt lgkmcnt(12)
    v_mfma_f32_16x16x32_bf16 v[104:107], a[136:139], a[72:75], v[104:107]
    ds_read_b64_tr_b16 a[164:165], v49 offset:24576
    ds_read_b64_tr_b16 a[166:167], v49 offset:28672
    s_waitcnt lgkmcnt(12)
    v_mfma_f32_16x16x32_bf16 v[108:111], a[140:143], a[72:75], v[108:111]
    ds_read_b64_tr_b16 a[168:169], v50 offset:24576
    ds_read_b64_tr_b16 a[170:171], v50 offset:28672
    buffer_load_dwordx4 v18, s[52:55], s83 offen offset:1024 lds
    s_waitcnt lgkmcnt(12)
    v_mfma_f32_16x16x32_bf16 v[112:115], a[144:147], a[72:75], v[112:115]
    ds_read_b64_tr_b16 a[172:173], v51 offset:24576
    ds_read_b64_tr_b16 a[174:175], v51 offset:28672
    s_waitcnt lgkmcnt(12)
    v_mfma_f32_16x16x32_bf16 v[116:119], a[148:151], a[72:75], v[116:119]
    ds_read_b64_tr_b16 a[176:177], v52 offset:24576
    ds_read_b64_tr_b16 a[178:179], v52 offset:28672
    s_waitcnt lgkmcnt(12)
    v_mfma_f32_16x16x32_bf16 v[120:123], a[152:155], a[72:75], v[120:123]
    ds_read_b64_tr_b16 a[180:181], v53 offset:24576
    ds_read_b64_tr_b16 a[182:183], v53 offset:28672
    s_mov_b32 s82, 1179648
    s_add_u32 m0, s3, 49152
    s_nop 0
    buffer_load_dwordx4 v17, s[52:55], s82 offen lds
    s_waitcnt lgkmcnt(12)
    v_mfma_f32_16x16x32_bf16 v[124:127], a[156:159], a[72:75], v[124:127]
    ds_read_b64_tr_b16 a[184:185], v54 offset:24576
    ds_read_b64_tr_b16 a[186:187], v54 offset:28672
    s_waitcnt vmcnt(61) lgkmcnt(12)
    v_mfma_f32_16x16x32_bf16 v[96:99], a[160:163], a[76:79], v[96:99]
    ds_read_b64_tr_b16 a[188:189], v55 offset:24576
    ds_read_b64_tr_b16 a[190:191], v55 offset:28672
    s_waitcnt lgkmcnt(12)
    v_mfma_f32_16x16x32_bf16 v[100:103], a[164:167], a[76:79], v[100:103]
    ds_read_b64_tr_b16 a[128:129], v48 offset:32768
    ds_read_b64_tr_b16 a[130:131], v48 offset:36864
    buffer_load_dwordx4 v18, s[52:55], s82 offen offset:1024 lds
    s_waitcnt lgkmcnt(12)
    v_mfma_f32_16x16x32_bf16 v[104:107], a[168:171], a[76:79], v[104:107]
    ds_read_b64_tr_b16 a[132:133], v49 offset:32768
    ds_read_b64_tr_b16 a[134:135], v49 offset:36864
    s_waitcnt lgkmcnt(12)
    v_mfma_f32_16x16x32_bf16 v[108:111], a[172:175], a[76:79], v[108:111]
    ds_read_b64_tr_b16 a[136:137], v50 offset:32768
    ds_read_b64_tr_b16 a[138:139], v50 offset:36864
    s_waitcnt lgkmcnt(12)
    v_mfma_f32_16x16x32_bf16 v[112:115], a[176:179], a[76:79], v[112:115]
    ds_read_b64_tr_b16 a[140:141], v51 offset:32768
    ds_read_b64_tr_b16 a[142:143], v51 offset:36864
    s_mov_b32 s83, 1245184
    s_add_u32 m0, s3, 57344
    s_nop 0
    buffer_load_dwordx4 v17, s[52:55], s83 offen lds
    s_waitcnt lgkmcnt(12)
    v_mfma_f32_16x16x32_bf16 v[116:119], a[180:183], a[76:79], v[116:119]
    ds_read_b64_tr_b16 a[144:145], v52 offset:32768
    ds_read_b64_tr_b16 a[146:147], v52 offset:36864
    s_waitcnt lgkmcnt(12)
    v_mfma_f32_16x16x32_bf16 v[120:123], a[184:187], a[76:79], v[120:123]
    ds_read_b64_tr_b16 a[148:149], v53 offset:32768
    ds_read_b64_tr_b16 a[150:151], v53 offset:36864
    s_waitcnt lgkmcnt(12)
    v_mfma_f32_16x16x32_bf16 v[124:127], a[188:191], a[76:79], v[124:127]
    ds_read_b64_tr_b16 a[152:153], v54 offset:32768
    ds_read_b64_tr_b16 a[154:155], v54 offset:36864
    buffer_load_dwordx4 v18, s[52:55], s83 offen offset:1024 lds
    s_waitcnt vmcnt(63) lgkmcnt(12)
    v_mfma_f32_16x16x32_bf16 v[96:99], a[128:131], a[80:83], v[96:99]
    ds_read_b64_tr_b16 a[156:157], v55 offset:32768
    ds_read_b64_tr_b16 a[158:159], v55 offset:36864
    s_waitcnt lgkmcnt(12)
    v_mfma_f32_16x16x32_bf16 v[100:103], a[132:135], a[80:83], v[100:103]
    ds_read_b64_tr_b16 a[160:161], v48 offset:40960
    ds_read_b64_tr_b16 a[162:163], v48 offset:45056
    s_waitcnt lgkmcnt(12)
    v_mfma_f32_16x16x32_bf16 v[104:107], a[136:139], a[80:83], v[104:107]
    ds_read_b64_tr_b16 a[164:165], v49 offset:40960
    ds_read_b64_tr_b16 a[166:167], v49 offset:45056
    s_waitcnt lgkmcnt(12)
    v_mfma_f32_16x16x32_bf16 v[108:111], a[140:143], a[80:83], v[108:111]
    ds_read_b64_tr_b16 a[168:169], v50 offset:40960
    ds_read_b64_tr_b16 a[170:171], v50 offset:45056
    s_waitcnt lgkmcnt(12)
    v_mfma_f32_16x16x32_bf16 v[112:115], a[144:147], a[80:83], v[112:115]
    ds_read_b64_tr_b16 a[172:173], v51 offset:40960
    ds_read_b64_tr_b16 a[174:175], v51 offset:45056
    s_waitcnt lgkmcnt(12)
    v_mfma_f32_16x16x32_bf16 v[116:119], a[148:151], a[80:83], v[116:119]
    ds_read_b64_tr_b16 a[176:177], v52 offset:40960
    ds_read_b64_tr_b16 a[178:179], v52 offset:45056
    s_waitcnt lgkmcnt(12)
    v_mfma_f32_16x16x32_bf16 v[120:123], a[152:155], a[80:83], v[120:123]
    ds_read_b64_tr_b16 a[180:181], v53 offset:40960
    ds_read_b64_tr_b16 a[182:183], v53 offset:45056
    s_waitcnt lgkmcnt(12)
    v_mfma_f32_16x16x32_bf16 v[124:127], a[156:159], a[80:83], v[124:127]
    ds_read_b64_tr_b16 a[184:185], v54 offset:40960
    ds_read_b64_tr_b16 a[186:187], v54 offset:45056
    s_waitcnt vmcnt(62) lgkmcnt(12)
    v_mfma_f32_16x16x32_bf16 v[96:99], a[160:163], a[84:87], v[96:99]
    ds_read_b64_tr_b16 a[188:189], v55 offset:40960
    ds_read_b64_tr_b16 a[190:191], v55 offset:45056
    s_waitcnt lgkmcnt(12)
    v_mfma_f32_16x16x32_bf16 v[100:103], a[164:167], a[84:87], v[100:103]
    ds_read_b64_tr_b16 a[128:129], v48 offset:49152
    ds_read_b64_tr_b16 a[130:131], v48 offset:53248
    s_waitcnt lgkmcnt(12)
    v_mfma_f32_16x16x32_bf16 v[104:107], a[168:171], a[84:87], v[104:107]
    ds_read_b64_tr_b16 a[132:133], v49 offset:49152
    ds_read_b64_tr_b16 a[134:135], v49 offset:53248
    s_waitcnt lgkmcnt(12)
    v_mfma_f32_16x16x32_bf16 v[108:111], a[172:175], a[84:87], v[108:111]
    ds_read_b64_tr_b16 a[136:137], v50 offset:49152
    ds_read_b64_tr_b16 a[138:139], v50 offset:53248
    s_waitcnt lgkmcnt(12)
    v_mfma_f32_16x16x32_bf16 v[112:115], a[176:179], a[84:87], v[112:115]
    ds_read_b64_tr_b16 a[140:141], v51 offset:49152
    ds_read_b64_tr_b16 a[142:143], v51 offset:53248
    s_waitcnt lgkmcnt(12)
    v_mfma_f32_16x16x32_bf16 v[116:119], a[180:183], a[84:87], v[116:119]
    ds_read_b64_tr_b16 a[144:145], v52 offset:49152
    ds_read_b64_tr_b16 a[146:147], v52 offset:53248
    s_waitcnt lgkmcnt(12)
    v_mfma_f32_16x16x32_bf16 v[120:123], a[184:187], a[84:87], v[120:123]
    ds_read_b64_tr_b16 a[148:149], v53 offset:49152
    ds_read_b64_tr_b16 a[150:151], v53 offset:53248
    s_waitcnt lgkmcnt(12)
    v_mfma_f32_16x16x32_bf16 v[124:127], a[188:191], a[84:87], v[124:127]
    ds_read_b64_tr_b16 a[152:153], v54 offset:49152
    ds_read_b64_tr_b16 a[154:155], v54 offset:53248
    s_waitcnt vmcnt(19)
    s_barrier
    s_waitcnt lgkmcnt(12)
    v_mfma_f32_16x16x32_bf16 v[96:99], a[128:131], a[88:91], v[96:99]
    ds_read_b64_tr_b16 a[156:157], v55 offset:49152
    ds_read_b64_tr_b16 a[158:159], v55 offset:53248
    s_mov_b32 s82, 1310720
    s_add_u32 m0, s3, 65536
    s_nop 0
    buffer_load_dwordx4 v17, s[52:55], s82 offen lds
    s_waitcnt lgkmcnt(12)
    v_mfma_f32_16x16x32_bf16 v[100:103], a[132:135], a[88:91], v[100:103]
    ds_read_b64_tr_b16 a[160:161], v48 offset:57344
    ds_read_b64_tr_b16 a[162:163], v48 offset:61440
    s_waitcnt lgkmcnt(12)
    v_mfma_f32_16x16x32_bf16 v[104:107], a[136:139], a[88:91], v[104:107]
    ds_read_b64_tr_b16 a[164:165], v49 offset:57344
    ds_read_b64_tr_b16 a[166:167], v49 offset:61440
    s_waitcnt lgkmcnt(12)
    v_mfma_f32_16x16x32_bf16 v[108:111], a[140:143], a[88:91], v[108:111]
    ds_read_b64_tr_b16 a[168:169], v50 offset:57344
    ds_read_b64_tr_b16 a[170:171], v50 offset:61440
    buffer_load_dwordx4 v18, s[52:55], s82 offen offset:1024 lds
    s_waitcnt lgkmcnt(12)
    v_mfma_f32_16x16x32_bf16 v[112:115], a[144:147], a[88:91], v[112:115]
    ds_read_b64_tr_b16 a[172:173], v51 offset:57344
    ds_read_b64_tr_b16 a[174:175], v51 offset:61440
    s_waitcnt lgkmcnt(12)
    v_mfma_f32_16x16x32_bf16 v[116:119], a[148:151], a[88:91], v[116:119]
    ds_read_b64_tr_b16 a[176:177], v52 offset:57344
    ds_read_b64_tr_b16 a[178:179], v52 offset:61440
    s_waitcnt lgkmcnt(12)
    v_mfma_f32_16x16x32_bf16 v[120:123], a[152:155], a[88:91], v[120:123]
    ds_read_b64_tr_b16 a[180:181], v53 offset:57344
    ds_read_b64_tr_b16 a[182:183], v53 offset:61440
    s_mov_b32 s83, 1376256
    s_add_u32 m0, s3, 73728
    s_nop 0
    buffer_load_dwordx4 v17, s[52:55], s83 offen lds
    s_waitcnt lgkmcnt(12)
    v_mfma_f32_16x16x32_bf16 v[124:127], a[156:159], a[88:91], v[124:127]
    ds_read_b64_tr_b16 a[184:185], v54 offset:57344
    ds_read_b64_tr_b16 a[186:187], v54 offset:61440
    s_waitcnt lgkmcnt(12)
    v_mfma_f32_16x16x32_bf16 v[96:99], a[160:163], a[92:95], v[96:99]
    ds_read_b64_tr_b16 a[188:189], v55 offset:57344
    ds_read_b64_tr_b16 a[190:191], v55 offset:61440
    s_waitcnt vmcnt(11)
    s_mov_b64 exec, 1
    buffer_atomic_add v25, off, s[56:59], s77 sc1
    s_mov_b64 exec, -1
    s_waitcnt lgkmcnt(12)
    v_mfma_f32_16x16x32_bf16 v[100:103], a[164:167], a[92:95], v[100:103]
    ds_read_b64_tr_b16 a[128:129], v56 offset:0
    ds_read_b64_tr_b16 a[130:131], v56 offset:4096
    buffer_load_dwordx4 v18, s[52:55], s83 offen offset:1024 lds
    s_waitcnt lgkmcnt(12)
    v_mfma_f32_16x16x32_bf16 v[104:107], a[168:171], a[92:95], v[104:107]
    ds_read_b64_tr_b16 a[132:133], v57 offset:0
    ds_read_b64_tr_b16 a[134:135], v57 offset:4096
    s_waitcnt lgkmcnt(12)
    v_mfma_f32_16x16x32_bf16 v[108:111], a[172:175], a[92:95], v[108:111]
    ds_read_b64_tr_b16 a[136:137], v58 offset:0
    ds_read_b64_tr_b16 a[138:139], v58 offset:4096
    s_waitcnt lgkmcnt(12)
    v_mfma_f32_16x16x32_bf16 v[112:115], a[176:179], a[92:95], v[112:115]
    ds_read_b64_tr_b16 a[140:141], v59 offset:0
    ds_read_b64_tr_b16 a[142:143], v59 offset:4096
    s_mov_b32 s82, 1441792
    s_add_u32 m0, s3, 81920
    s_nop 0
    buffer_load_dwordx4 v17, s[52:55], s82 offen lds
    s_waitcnt lgkmcnt(12)
    v_mfma_f32_16x16x32_bf16 v[116:119], a[180:183], a[92:95], v[116:119]
    ds_read_b64_tr_b16 a[144:145], v60 offset:0
    ds_read_b64_tr_b16 a[146:147], v60 offset:4096
    s_waitcnt lgkmcnt(12)
    v_mfma_f32_16x16x32_bf16 v[120:123], a[184:187], a[92:95], v[120:123]
    ds_read_b64_tr_b16 a[148:149], v61 offset:0
    ds_read_b64_tr_b16 a[150:151], v61 offset:4096
    s_waitcnt lgkmcnt(12)
    v_mfma_f32_16x16x32_bf16 v[124:127], a[188:191], a[92:95], v[124:127]
    ds_read_b64_tr_b16 a[152:153], v62 offset:0
    ds_read_b64_tr_b16 a[154:155], v62 offset:4096
    buffer_load_dwordx4 v18, s[52:55], s82 offen offset:1024 lds
    s_waitcnt lgkmcnt(12)
    v_mfma_f32_16x16x32_bf16 v[96:99], a[128:131], a[96:99], v[96:99]
    ds_read_b64_tr_b16 a[156:157], v63 offset:0
    ds_read_b64_tr_b16 a[158:159], v63 offset:4096
    s_waitcnt lgkmcnt(12)
    v_mfma_f32_16x16x32_bf16 v[100:103], a[132:135], a[96:99], v[100:103]
    ds_read_b64_tr_b16 a[160:161], v56 offset:8192
    ds_read_b64_tr_b16 a[162:163], v56 offset:12288
    s_waitcnt lgkmcnt(12)
    v_mfma_f32_16x16x32_bf16 v[104:107], a[136:139], a[96:99], v[104:107]
    ds_read_b64_tr_b16 a[164:165], v57 offset:8192
    ds_read_b64_tr_b16 a[166:167], v57 offset:12288
    s_mov_b32 s83, 1507328
    s_add_u32 m0, s3, 90112
    s_nop 0
    buffer_load_dwordx4 v17, s[52:55], s83 offen lds
    s_waitcnt lgkmcnt(12)
    v_mfma_f32_16x16x32_bf16 v[108:111], a[140:143], a[96:99], v[108:111]
    ds_read_b64_tr_b16 a[168:169], v58 offset:8192
    ds_read_b64_tr_b16 a[170:171], v58 offset:12288
    s_waitcnt lgkmcnt(12)
    v_mfma_f32_16x16x32_bf16 v[112:115], a[144:147], a[96:99], v[112:115]
    ds_read_b64_tr_b16 a[172:173], v59 offset:8192
    ds_read_b64_tr_b16 a[174:175], v59 offset:12288
    s_waitcnt lgkmcnt(12)
    v_mfma_f32_16x16x32_bf16 v[116:119], a[148:151], a[96:99], v[116:119]
    ds_read_b64_tr_b16 a[176:177], v60 offset:8192
    ds_read_b64_tr_b16 a[178:179], v60 offset:12288
    buffer_load_dwordx4 v18, s[52:55], s83 offen offset:1024 lds
    s_waitcnt lgkmcnt(12)
    v_mfma_f32_16x16x32_bf16 v[120:123], a[152:155], a[96:99], v[120:123]
    ds_read_b64_tr_b16 a[180:181], v61 offset:8192
    ds_read_b64_tr_b16 a[182:183], v61 offset:12288
    s_waitcnt lgkmcnt(12)
    v_mfma_f32_16x16x32_bf16 v[124:127], a[156:159], a[96:99], v[124:127]
    ds_read_b64_tr_b16 a[184:185], v62 offset:8192
    ds_read_b64_tr_b16 a[186:187], v62 offset:12288
    s_waitcnt lgkmcnt(12)
    v_mfma_f32_16x16x32_bf16 v[96:99], a[160:163], a[100:103], v[96:99]
    ds_read_b64_tr_b16 a[188:189], v63 offset:8192
    ds_read_b64_tr_b16 a[190:191], v63 offset:12288
    s_mov_b32 s82, 1572864
    s_add_u32 m0, s3, 98304
    s_nop 0
    buffer_load_dwordx4 v17, s[52:55], s82 offen lds
    s_waitcnt lgkmcnt(12)
    v_mfma_f32_16x16x32_bf16 v[100:103], a[164:167], a[100:103], v[100:103]
    ds_read_b64_tr_b16 a[128:129], v56 offset:16384
    ds_read_b64_tr_b16 a[130:131], v56 offset:20480
    s_waitcnt lgkmcnt(12)
    v_mfma_f32_16x16x32_bf16 v[104:107], a[168:171], a[100:103], v[104:107]
    ds_read_b64_tr_b16 a[132:133], v57 offset:16384
    ds_read_b64_tr_b16 a[134:135], v57 offset:20480
    s_waitcnt lgkmcnt(12)
    v_mfma_f32_16x16x32_bf16 v[108:111], a[172:175], a[100:103], v[108:111]
    ds_read_b64_tr_b16 a[136:137], v58 offset:16384
    ds_read_b64_tr_b16 a[138:139], v58 offset:20480
    buffer_load_dwordx4 v18, s[52:55], s82 offen offset:1024 lds
    s_waitcnt lgkmcnt(12)
    v_mfma_f32_16x16x32_bf16 v[112:115], a[176:179], a[100:103], v[112:115]
    ds_read_b64_tr_b16 a[140:141], v59 offset:16384
    ds_read_b64_tr_b16 a[142:143], v59 offset:20480
    s_waitcnt lgkmcnt(12)
    v_mfma_f32_16x16x32_bf16 v[116:119], a[180:183], a[100:103], v[116:119]
    ds_read_b64_tr_b16 a[144:145], v60 offset:16384
    ds_read_b64_tr_b16 a[146:147], v60 offset:20480
    s_waitcnt lgkmcnt(12)
    v_mfma_f32_16x16x32_bf16 v[120:123], a[184:187], a[100:103], v[120:123]
    ds_read_b64_tr_b16 a[148:149], v61 offset:16384
    ds_read_b64_tr_b16 a[150:151], v61 offset:20480
    s_mov_b32 s83, 1638400
    s_add_u32 m0, s3, 106496
    s_nop 0
    buffer_load_dwordx4 v17, s[52:55], s83 offen lds
    s_waitcnt lgkmcnt(12)
    v_mfma_f32_16x16x32_bf16 v[124:127], a[188:191], a[100:103], v[124:127]
    ds_read_b64_tr_b16 a[152:153], v62 offset:16384
    ds_read_b64_tr_b16 a[154:155], v62 offset:20480
    s_waitcnt lgkmcnt(12)
    v_mfma_f32_16x16x32_bf16 v[96:99], a[128:131], a[104:107], v[96:99]
    ds_read_b64_tr_b16 a[156:157], v63 offset:16384
    ds_read_b64_tr_b16 a[158:159], v63 offset:20480
    s_waitcnt lgkmcnt(12)
    v_mfma_f32_16x16x32_bf16 v[100:103], a[132:135], a[104:107], v[100:103]
    ds_read_b64_tr_b16 a[160:161], v56 offset:24576
    ds_read_b64_tr_b16 a[162:163], v56 offset:28672
    buffer_load_dwordx4 v18, s[52:55], s83 offen offset:1024 lds
    s_waitcnt lgkmcnt(12)
    v_mfma_f32_16x16x32_bf16 v[104:107], a[136:139], a[104:107], v[104:107]
    ds_read_b64_tr_b16 a[164:165], v57 offset:24576
    ds_read_b64_tr_b16 a[166:167], v57 offset:28672
    s_waitcnt lgkmcnt(12)
    v_mfma_f32_16x16x32_bf16 v[108:111], a[140:143], a[104:107], v[108:111]
    ds_read_b64_tr_b16 a[168:169], v58 offset:24576
    ds_read_b64_tr_b16 a[170:171], v58 offset:28672
    s_waitcnt lgkmcnt(12)
    v_mfma_f32_16x16x32_bf16 v[112:115], a[144:147], a[104:107], v[112:115]
    ds_read_b64_tr_b16 a[172:173], v59 offset:24576
    ds_read_b64_tr_b16 a[174:175], v59 offset:28672
    s_waitcnt lgkmcnt(12)
    v_mfma_f32_16x16x32_bf16 v[116:119], a[148:151], a[104:107], v[116:119]
    ds_read_b64_tr_b16 a[176:177], v60 offset:24576
    ds_read_b64_tr_b16 a[178:179], v60 offset:28672
    s_waitcnt lgkmcnt(12)
    v_mfma_f32_16x16x32_bf16 v[120:123], a[152:155], a[104:107], v[120:123]
    ds_read_b64_tr_b16 a[180:181], v61 offset:24576
    ds_read_b64_tr_b16 a[182:183], v61 offset:28672
    s_waitcnt lgkmcnt(12)
    v_mfma_f32_16x16x32_bf16 v[124:127], a[156:159], a[104:107], v[124:127]
    ds_read_b64_tr_b16 a[184:185], v62 offset:24576
    ds_read_b64_tr_b16 a[186:187], v62 offset:28672
    s_waitcnt lgkmcnt(12)
    v_mfma_f32_16x16x32_bf16 v[96:99], a[160:163], a[108:111], v[96:99]
    ds_read_b64_tr_b16 a[188:189], v63 offset:24576
    ds_read_b64_tr_b16 a[190:191], v63 offset:28672
    s_waitcnt lgkmcnt(12)
    v_mfma_f32_16x16x32_bf16 v[100:103], a[164:167], a[108:111], v[100:103]
    ds_read_b64_tr_b16 a[128:129], v8 offset:0
    ds_read_b64_tr_b16 a[130:131], v8 offset:4096
    s_waitcnt lgkmcnt(12)
    v_mfma_f32_16x16x32_bf16 v[104:107], a[168:171], a[108:111], v[104:107]
    ds_read_b64_tr_b16 a[132:133], v9 offset:0
    ds_read_b64_tr_b16 a[134:135], v9 offset:4096
    s_waitcnt lgkmcnt(12)
    v_mfma_f32_16x16x32_bf16 v[108:111], a[172:175], a[108:111], v[108:111]
    ds_read_b64_tr_b16 a[136:137], v10 offset:0
    ds_read_b64_tr_b16 a[138:139], v10 offset:4096
    s_waitcnt lgkmcnt(12)
    v_mfma_f32_16x16x32_bf16 v[112:115], a[176:179], a[108:111], v[112:115]
    ds_read_b64_tr_b16 a[140:141], v11 offset:0
    ds_read_b64_tr_b16 a[142:143], v11 offset:4096
    s_waitcnt lgkmcnt(12)
    v_mfma_f32_16x16x32_bf16 v[116:119], a[180:183], a[108:111], v[116:119]
    ds_read_b64_tr_b16 a[144:145], v12 offset:0
    ds_read_b64_tr_b16 a[146:147], v12 offset:4096
    s_waitcnt lgkmcnt(12)
    v_mfma_f32_16x16x32_bf16 v[120:123], a[184:187], a[108:111], v[120:123]
    ds_read_b64_tr_b16 a[148:149], v13 offset:0
    ds_read_b64_tr_b16 a[150:151], v13 offset:4096
    s_waitcnt lgkmcnt(12)
    v_mfma_f32_16x16x32_bf16 v[124:127], a[188:191], a[108:111], v[124:127]
    ds_read_b64_tr_b16 a[152:153], v14 offset:0
    ds_read_b64_tr_b16 a[154:155], v14 offset:4096
    s_waitcnt lgkmcnt(12)
    v_mfma_f32_16x16x32_bf16 v[96:99], a[128:131], a[112:115], v[96:99]
    ds_read_b64_tr_b16 a[156:157], v15 offset:0
    ds_read_b64_tr_b16 a[158:159], v15 offset:4096
    s_waitcnt lgkmcnt(12)
    v_mfma_f32_16x16x32_bf16 v[100:103], a[132:135], a[112:115], v[100:103]
    ds_read_b64_tr_b16 a[160:161], v8 offset:8192
    ds_read_b64_tr_b16 a[162:163], v8 offset:12288
    s_waitcnt lgkmcnt(12)
    v_mfma_f32_16x16x32_bf16 v[104:107], a[136:139], a[112:115], v[104:107]
    ds_read_b64_tr_b16 a[164:165], v9 offset:8192
    ds_read_b64_tr_b16 a[166:167], v9 offset:12288
    s_waitcnt lgkmcnt(12)
    v_mfma_f32_16x16x32_bf16 v[108:111], a[140:143], a[112:115], v[108:111]
    ds_read_b64_tr_b16 a[168:169], v10 offset:8192
    ds_read_b64_tr_b16 a[170:171], v10 offset:12288
    s_waitcnt lgkmcnt(12)
    v_mfma_f32_16x16x32_bf16 v[112:115], a[144:147], a[112:115], v[112:115]
    ds_read_b64_tr_b16 a[172:173], v11 offset:8192
    ds_read_b64_tr_b16 a[174:175], v11 offset:12288
    s_waitcnt lgkmcnt(12)
    v_mfma_f32_16x16x32_bf16 v[116:119], a[148:151], a[112:115], v[116:119]
    ds_read_b64_tr_b16 a[176:177], v12 offset:8192
    ds_read_b64_tr_b16 a[178:179], v12 offset:12288
    s_waitcnt lgkmcnt(12)
    v_mfma_f32_16x16x32_bf16 v[120:123], a[152:155], a[112:115], v[120:123]
    ds_read_b64_tr_b16 a[180:181], v13 offset:8192
    ds_read_b64_tr_b16 a[182:183], v13 offset:12288
    s_waitcnt lgkmcnt(12)
    v_mfma_f32_16x16x32_bf16 v[124:127], a[156:159], a[112:115], v[124:127]
    ds_read_b64_tr_b16 a[184:185], v14 offset:8192
    ds_read_b64_tr_b16 a[186:187], v14 offset:12288
    s_waitcnt lgkmcnt(12)
    v_mfma_f32_16x16x32_bf16 v[96:99], a[160:163], a[116:119], v[96:99]
    ds_read_b64_tr_b16 a[188:189], v15 offset:8192
    ds_read_b64_tr_b16 a[190:191], v15 offset:12288
    s_waitcnt lgkmcnt(12)
    v_mfma_f32_16x16x32_bf16 v[100:103], a[164:167], a[116:119], v[100:103]
    ds_read_b64_tr_b16 a[128:129], v8 offset:16384
    ds_read_b64_tr_b16 a[130:131], v8 offset:20480
    s_waitcnt lgkmcnt(12)
    v_mfma_f32_16x16x32_bf16 v[104:107], a[168:171], a[116:119], v[104:107]
    ds_read_b64_tr_b16 a[132:133], v9 offset:16384
    ds_read_b64_tr_b16 a[134:135], v9 offset:20480
    s_waitcnt lgkmcnt(12)
    v_mfma_f32_16x16x32_bf16 v[108:111], a[172:175], a[116:119], v[108:111]
    ds_read_b64_tr_b16 a[136:137], v10 offset:16384
    ds_read_b64_tr_b16 a[138:139], v10 offset:20480
    s_waitcnt lgkmcnt(12)
    v_mfma_f32_16x16x32_bf16 v[112:115], a[176:179], a[116:119], v[112:115]
    ds_read_b64_tr_b16 a[140:141], v11 offset:16384
    ds_read_b64_tr_b16 a[142:143], v11 offset:20480
    s_waitcnt lgkmcnt(12)
    v_mfma_f32_16x16x32_bf16 v[116:119], a[180:183], a[116:119], v[116:119]
    ds_read_b64_tr_b16 a[144:145], v12 offset:16384
    ds_read_b64_tr_b16 a[146:147], v12 offset:20480
    s_waitcnt lgkmcnt(12)
    v_mfma_f32_16x16x32_bf16 v[120:123], a[184:187], a[116:119], v[120:123]
    ds_read_b64_tr_b16 a[148:149], v13 offset:16384
    ds_read_b64_tr_b16 a[150:151], v13 offset:20480
    s_waitcnt lgkmcnt(12)
    v_mfma_f32_16x16x32_bf16 v[124:127], a[188:191], a[116:119], v[124:127]
    ds_read_b64_tr_b16 a[152:153], v14 offset:16384
    ds_read_b64_tr_b16 a[154:155], v14 offset:20480
    s_waitcnt vmcnt(13)
    s_barrier
    s_waitcnt lgkmcnt(12)
    v_mfma_f32_16x16x32_bf16 v[96:99], a[128:131], a[120:123], v[96:99]
    ds_read_b64_tr_b16 a[156:157], v15 offset:16384
    ds_read_b64_tr_b16 a[158:159], v15 offset:20480
    s_mov_b32 s82, 1703936
    s_add_u32 m0, s3, 114688
    s_nop 0
    buffer_load_dwordx4 v17, s[52:55], s82 offen lds
    s_waitcnt lgkmcnt(12)
    v_mfma_f32_16x16x32_bf16 v[100:103], a[132:135], a[120:123], v[100:103]
    ds_read_b64_tr_b16 a[160:161], v8 offset:24576
    ds_read_b64_tr_b16 a[162:163], v8 offset:28672
    s_waitcnt lgkmcnt(12)
    v_mfma_f32_16x16x32_bf16 v[104:107], a[136:139], a[120:123], v[104:107]
    ds_read_b64_tr_b16 a[164:165], v9 offset:24576
    ds_read_b64_tr_b16 a[166:167], v9 offset:28672
    s_waitcnt lgkmcnt(12)
    v_mfma_f32_16x16x32_bf16 v[108:111], a[140:143], a[120:123], v[108:111]
    ds_read_b64_tr_b16 a[168:169], v10 offset:24576
    ds_read_b64_tr_b16 a[170:171], v10 offset:28672
    buffer_load_dwordx4 v18, s[52:55], s82 offen offset:1024 lds
    s_waitcnt lgkmcnt(12)
    v_mfma_f32_16x16x32_bf16 v[112:115], a[144:147], a[120:123], v[112:115]
    ds_read_b64_tr_b16 a[172:173], v11 offset:24576
    ds_read_b64_tr_b16 a[174:175], v11 offset:28672
    s_waitcnt lgkmcnt(12)
    v_mfma_f32_16x16x32_bf16 v[116:119], a[148:151], a[120:123], v[116:119]
    ds_read_b64_tr_b16 a[176:177], v12 offset:24576
    ds_read_b64_tr_b16 a[178:179], v12 offset:28672
    s_waitcnt lgkmcnt(12)
    v_mfma_f32_16x16x32_bf16 v[120:123], a[152:155], a[120:123], v[120:123]
    ds_read_b64_tr_b16 a[180:181], v13 offset:24576
    ds_read_b64_tr_b16 a[182:183], v13 offset:28672
    s_mov_b32 s83, 1769472
    s_add_u32 m0, s3, 122880
    s_nop 0
    buffer_load_dwordx4 v17, s[52:55], s83 offen lds
    s_waitcnt lgkmcnt(12)
    v_mfma_f32_16x16x32_bf16 v[124:127], a[156:159], a[120:123], v[124:127]
    ds_read_b64_tr_b16 a[184:185], v14 offset:24576
    ds_read_b64_tr_b16 a[186:187], v14 offset:28672
    s_waitcnt lgkmcnt(12)
    v_mfma_f32_16x16x32_bf16 v[96:99], a[160:163], a[124:127], v[96:99]
    ds_read_b64_tr_b16 a[188:189], v15 offset:24576
    ds_read_b64_tr_b16 a[190:191], v15 offset:28672
    buffer_load_dword v43, off, s[56:59], s77 sc1
    s_waitcnt lgkmcnt(12)
    v_mfma_f32_16x16x32_bf16 v[100:103], a[164:167], a[124:127], v[100:103]
    ds_read_b64_tr_b16 a[128:129], v8 offset:32768
    ds_read_b64_tr_b16 a[130:131], v8 offset:36864
    buffer_load_dwordx4 v18, s[52:55], s83 offen offset:1024 lds
    s_waitcnt lgkmcnt(12)
    v_mfma_f32_16x16x32_bf16 v[104:107], a[168:171], a[124:127], v[104:107]
    ds_read_b64_tr_b16 a[132:133], v9 offset:32768
    ds_read_b64_tr_b16 a[134:135], v9 offset:36864
    s_waitcnt lgkmcnt(12)
    v_mfma_f32_16x16x32_bf16 v[108:111], a[172:175], a[124:127], v[108:111]
    ds_read_b64_tr_b16 a[136:137], v10 offset:32768
    ds_read_b64_tr_b16 a[138:139], v10 offset:36864
    s_waitcnt lgkmcnt(12)
    v_mfma_f32_16x16x32_bf16 v[112:115], a[176:179], a[124:127], v[112:115]
    ds_read_b64_tr_b16 a[140:141], v11 offset:32768
    ds_read_b64_tr_b16 a[142:143], v11 offset:36864
    s_mov_b32 s82, 1835008
    s_add_u32 m0, s3, 131072
    s_nop 0
    buffer_load_dwordx4 v17, s[52:55], s82 offen lds
    s_waitcnt lgkmcnt(12)
    v_mfma_f32_16x16x32_bf16 v[116:119], a[180:183], a[124:127], v[116:119]
    ds_read_b64_tr_b16 a[144:145], v12 offset:32768
    ds_read_b64_tr_b16 a[146:147], v12 offset:36864
    s_waitcnt lgkmcnt(12)
    v_mfma_f32_16x16x32_bf16 v[120:123], a[184:187], a[124:127], v[120:123]
    ds_read_b64_tr_b16 a[148:149], v13 offset:32768
    ds_read_b64_tr_b16 a[150:151], v13 offset:36864
    s_waitcnt lgkmcnt(12)
    v_mfma_f32_16x16x32_bf16 v[124:127], a[188:191], a[124:127], v[124:127]
    ds_read_b64_tr_b16 a[152:153], v14 offset:32768
    ds_read_b64_tr_b16 a[154:155], v14 offset:36864
    buffer_load_dwordx4 v18, s[52:55], s82 offen offset:1024 lds
    s_waitcnt lgkmcnt(12)
    v_mfma_f32_16x16x32_bf16 v[96:99], a[128:131], a[0:3], v[96:99]
    ds_read_b64_tr_b16 a[156:157], v15 offset:32768
    ds_read_b64_tr_b16 a[158:159], v15 offset:36864
    s_waitcnt lgkmcnt(12)
    v_mfma_f32_16x16x32_bf16 v[100:103], a[132:135], a[0:3], v[100:103]
    ds_read_b64_tr_b16 a[160:161], v8 offset:40960
    ds_read_b64_tr_b16 a[162:163], v8 offset:45056
    s_waitcnt lgkmcnt(12)
    v_mfma_f32_16x16x32_bf16 v[104:107], a[136:139], a[0:3], v[104:107]
    ds_read_b64_tr_b16 a[164:165], v9 offset:40960
    ds_read_b64_tr_b16 a[166:167], v9 offset:45056
    s_mov_b32 s83, 1900544
    s_add_u32 m0, s3, 139264
    s_nop 0
    buffer_load_dwordx4 v17, s[52:55], s83 offen lds
    s_waitcnt lgkmcnt(12)
    v_mfma_f32_16x16x32_bf16 v[108:111], a[140:143], a[0:3], v[108:111]
    ds_read_b64_tr_b16 a[168:169], v10 offset:40960
    ds_read_b64_tr_b16 a[170:171], v10 offset:45056
    s_waitcnt lgkmcnt(12)
    v_mfma_f32_16x16x32_bf16 v[112:115], a[144:147], a[0:3], v[112:115]
    ds_read_b64_tr_b16 a[172:173], v11 offset:40960
    ds_read_b64_tr_b16 a[174:175], v11 offset:45056
    s_waitcnt lgkmcnt(12)
    v_mfma_f32_16x16x32_bf16 v[116:119], a[148:151], a[0:3], v[116:119]
    ds_read_b64_tr_b16 a[176:177], v12 offset:40960
    ds_read_b64_tr_b16 a[178:179], v12 offset:45056
    buffer_load_dwordx4 v18, s[52:55], s83 offen offset:1024 lds
    s_waitcnt lgkmcnt(12)
    v_mfma_f32_16x16x32_bf16 v[120:123], a[152:155], a[0:3], v[120:123]
    ds_read_b64_tr_b16 a[180:181], v13 offset:40960
    ds_read_b64_tr_b16 a[182:183], v13 offset:45056
    s_waitcnt lgkmcnt(12)
    v_mfma_f32_16x16x32_bf16 v[124:127], a[156:159], a[0:3], v[124:127]
    ds_read_b64_tr_b16 a[184:185], v14 offset:40960
    ds_read_b64_tr_b16 a[186:187], v14 offset:45056
    s_waitcnt lgkmcnt(12)
    v_mfma_f32_16x16x32_bf16 v[96:99], a[160:163], a[4:7], v[96:99]
    ds_read_b64_tr_b16 a[188:189], v15 offset:40960
    ds_read_b64_tr_b16 a[190:191], v15 offset:45056
    s_mov_b32 s82, 1966080
    s_add_u32 m0, s3, 147456
    s_nop 0
    buffer_load_dwordx4 v17, s[52:55], s82 offen lds
    s_waitcnt lgkmcnt(12)
    v_mfma_f32_16x16x32_bf16 v[100:103], a[164:167], a[4:7], v[100:103]
    ds_read_b64_tr_b16 a[128:129], v8 offset:49152
    ds_read_b64_tr_b16 a[130:131], v8 offset:53248
    s_waitcnt lgkmcnt(12)
    v_mfma_f32_16x16x32_bf16 v[104:107], a[168:171], a[4:7], v[104:107]
    ds_read_b64_tr_b16 a[132:133], v9 offset:49152
    ds_read_b64_tr_b16 a[134:135], v9 offset:53248
    s_waitcnt lgkmcnt(12)
    v_mfma_f32_16x16x32_bf16 v[108:111], a[172:175], a[4:7], v[108:111]
    ds_read_b64_tr_b16 a[136:137], v10 offset:49152
    ds_read_b64_tr_b16 a[138:139], v10 offset:53248
    buffer_load_dwordx4 v18, s[52:55], s82 offen offset:1024 lds
    s_waitcnt lgkmcnt(12)
    v_mfma_f32_16x16x32_bf16 v[112:115], a[176:179], a[4:7], v[112:115]
    ds_read_b64_tr_b16 a[140:141], v11 offset:49152
    ds_read_b64_tr_b16 a[142:143], v11 offset:53248
    s_waitcnt lgkmcnt(12)
    v_mfma_f32_16x16x32_bf16 v[116:119], a[180:183], a[4:7], v[116:119]
    ds_read_b64_tr_b16 a[144:145], v12 offset:49152
    ds_read_b64_tr_b16 a[146:147], v12 offset:53248
    s_waitcnt lgkmcnt(12)
    v_mfma_f32_16x16x32_bf16 v[120:123], a[184:187], a[4:7], v[120:123]
    ds_read_b64_tr_b16 a[148:149], v13 offset:49152
    ds_read_b64_tr_b16 a[150:151], v13 offset:53248
    s_mov_b32 s83, 2031616
    s_add_u32 m0, s3, 155648
    s_nop 0
    buffer_load_dwordx4 v17, s[52:55], s83 offen lds
    s_waitcnt lgkmcnt(12)
    v_mfma_f32_16x16x32_bf16 v[124:127], a[188:191], a[4:7], v[124:127]
    ds_read_b64_tr_b16 a[152:153], v14 offset:49152
    ds_read_b64_tr_b16 a[154:155], v14 offset:53248
    s_waitcnt vmcnt(12)
    s_barrier
    s_waitcnt lgkmcnt(12)
    v_mfma_f32_16x16x32_bf16 v[96:99], a[128:131], a[8:11], v[96:99]
    ds_read_b64_tr_b16 a[156:157], v15 offset:49152
    ds_read_b64_tr_b16 a[158:159], v15 offset:53248
    s_waitcnt lgkmcnt(12)
    v_mfma_f32_16x16x32_bf16 v[100:103], a[132:135], a[8:11], v[100:103]
    ds_read_b64_tr_b16 a[160:161], v8 offset:57344
    ds_read_b64_tr_b16 a[162:163], v8 offset:61440
    buffer_load_dwordx4 v18, s[52:55], s83 offen offset:1024 lds
    s_waitcnt lgkmcnt(12)
    v_mfma_f32_16x16x32_bf16 v[104:107], a[136:139], a[8:11], v[104:107]
    ds_read_b64_tr_b16 a[164:165], v9 offset:57344
    ds_read_b64_tr_b16 a[166:167], v9 offset:61440
    s_waitcnt lgkmcnt(12)
    v_mfma_f32_16x16x32_bf16 v[108:111], a[140:143], a[8:11], v[108:111]
    ds_read_b64_tr_b16 a[168:169], v10 offset:57344
    ds_read_b64_tr_b16 a[170:171], v10 offset:61440
    s_waitcnt lgkmcnt(12)
    v_mfma_f32_16x16x32_bf16 v[112:115], a[144:147], a[8:11], v[112:115]
    ds_read_b64_tr_b16 a[172:173], v11 offset:57344
    ds_read_b64_tr_b16 a[174:175], v11 offset:61440
    s_waitcnt lgkmcnt(12)
    v_mfma_f32_16x16x32_bf16 v[116:119], a[148:151], a[8:11], v[116:119]
    ds_read_b64_tr_b16 a[176:177], v12 offset:57344
    ds_read_b64_tr_b16 a[178:179], v12 offset:61440
    s_waitcnt lgkmcnt(12)
    v_mfma_f32_16x16x32_bf16 v[120:123], a[152:155], a[8:11], v[120:123]
    ds_read_b64_tr_b16 a[180:181], v13 offset:57344
    ds_read_b64_tr_b16 a[182:183], v13 offset:61440
    s_waitcnt lgkmcnt(12)
    v_mfma_f32_16x16x32_bf16 v[124:127], a[156:159], a[8:11], v[124:127]
    ds_read_b64_tr_b16 a[184:185], v14 offset:57344
    ds_read_b64_tr_b16 a[186:187], v14 offset:61440
    s_waitcnt lgkmcnt(12)
    v_mfma_f32_16x16x32_bf16 v[96:99], a[160:163], a[12:15], v[96:99]
    ds_read_b64_tr_b16 a[188:189], v15 offset:57344
    ds_read_b64_tr_b16 a[190:191], v15 offset:61440
    s_waitcnt lgkmcnt(12)
    v_mfma_f32_16x16x32_bf16 v[100:103], a[164:167], a[12:15], v[100:103]
    ds_read_b64_tr_b16 a[128:129], v48 offset:0
    ds_read_b64_tr_b16 a[130:131], v48 offset:4096
    s_waitcnt lgkmcnt(12)
    v_mfma_f32_16x16x32_bf16 v[104:107], a[168:171], a[12:15], v[104:107]
    ds_read_b64_tr_b16 a[132:133], v49 offset:0
    ds_read_b64_tr_b16 a[134:135], v49 offset:4096
    s_waitcnt lgkmcnt(12)
    v_mfma_f32_16x16x32_bf16 v[108:111], a[172:175], a[12:15], v[108:111]
    ds_read_b64_tr_b16 a[136:137], v50 offset:0
    ds_read_b64_tr_b16 a[138:139], v50 offset:4096
    s_waitcnt lgkmcnt(12)
    v_mfma_f32_16x16x32_bf16 v[112:115], a[176:179], a[12:15], v[112:115]
    ds_read_b64_tr_b16 a[140:141], v51 offset:0
    ds_read_b64_tr_b16 a[142:143], v51 offset:4096
    s_waitcnt lgkmcnt(12)
    v_mfma_f32_16x16x32_bf16 v[116:119], a[180:183], a[12:15], v[116:119]
    ds_read_b64_tr_b16 a[144:145], v52 offset:0
    ds_read_b64_tr_b16 a[146:147], v52 offset:4096
    s_waitcnt lgkmcnt(12)
    v_mfma_f32_16x16x32_bf16 v[120:123], a[184:187], a[12:15], v[120:123]
    ds_read_b64_tr_b16 a[148:149], v53 offset:0
    ds_read_b64_tr_b16 a[150:151], v53 offset:4096
    s_waitcnt lgkmcnt(12)
    v_mfma_f32_16x16x32_bf16 v[124:127], a[188:191], a[12:15], v[124:127]
    ds_read_b64_tr_b16 a[152:153], v54 offset:0
    ds_read_b64_tr_b16 a[154:155], v54 offset:4096
    s_waitcnt lgkmcnt(12)
    v_mfma_f32_16x16x32_bf16 v[96:99], a[128:131], a[16:19], v[96:99]
    ds_read_b64_tr_b16 a[156:157], v55 offset:0
    ds_read_b64_tr_b16 a[158:159], v55 offset:4096
    s_waitcnt vmcnt(9)
    v_readfirstlane_b32 s86, v43
    s_cmp_eq_u32 s86, 4
    s_cbranch_scc0 L_spP
L_okP:
    buffer_load_dwordx4 v[164:167], v16, s[56:59], s73 offen offset:0 sc1
    s_waitcnt lgkmcnt(12)
    v_mfma_f32_16x16x32_bf16 v[100:103], a[132:135], a[16:19], v[100:103]
    ds_read_b64_tr_b16 a[160:161], v48 offset:8192
    ds_read_b64_tr_b16 a[162:163], v48 offset:12288
    buffer_load_dwordx4 v[172:175], v16, s[56:59], s73 offen offset:1024 sc1
    s_waitcnt lgkmcnt(12)
    v_mfma_f32_16x16x32_bf16 v[104:107], a[136:139], a[16:19], v[104:107]
    ds_read_b64_tr_b16 a[164:165], v49 offset:8192
    ds_read_b64_tr_b16 a[166:167], v49 offset:12288
    buffer_load_dwordx4 v[180:183], v16, s[56:59], s73 offen offset:2048 sc1
    s_waitcnt lgkmcnt(12)
    v_mfma_f32_16x16x32_bf16 v[108:111], a[140:143], a[16:19], v[108:111]
    ds_read_b64_tr_b16 a[168:169], v50 offset:8192
    ds_read_b64_tr_b16 a[170:171], v50 offset:12288
    buffer_load_dwordx4 v[188:191], v16, s[56:59], s73 offen offset:3072 sc1
    s_waitcnt lgkmcnt(12)
    v_mfma_f32_16x16x32_bf16 v[112:115], a[144:147], a[16:19], v[112:115]
    ds_read_b64_tr_b16 a[172:173], v51 offset:8192
    ds_read_b64_tr_b16 a[174:175], v51 offset:12288
    buffer_load_dwordx4 v[196:199], v16, s[56:59], s74 offen offset:0 sc1
    s_waitcnt lgkmcnt(12)
    v_mfma_f32_16x16x32_bf16 v[116:119], a[148:151], a[16:19], v[116:119]
    ds_read_b64_tr_b16 a[176:177], v52 offset:8192
    ds_read_b64_tr_b16 a[178:179], v52 offset:12288
    buffer_load_dwordx4 v[204:207], v16, s[56:59], s74 offen offset:1024 sc1
    s_waitcnt lgkmcnt(12)
    v_mfma_f32_16x16x32_bf16 v[120:123], a[152:155], a[16:19], v[120:123]
    ds_read_b64_tr_b16 a[180:181], v53 offset:8192
    ds_read_b64_tr_b16 a[182:183], v53 offset:12288
    buffer_load_dwordx4 v[212:215], v16, s[56:59], s74 offen offset:2048 sc1
    s_waitcnt lgkmcnt(12)
    v_mfma_f32_16x16x32_bf16 v[124:127], a[156:159], a[16:19], v[124:127]
    ds_read_b64_tr_b16 a[184:185], v54 offset:8192
    ds_read_b64_tr_b16 a[186:187], v54 offset:12288
    buffer_load_dwordx4 v[220:223], v16, s[56:59], s74 offen offset:3072 sc1
    s_waitcnt lgkmcnt(12)
    v_mfma_f32_16x16x32_bf16 v[96:99], a[160:163], a[20:23], v[96:99]
    ds_read_b64_tr_b16 a[188:189], v55 offset:8192
    ds_read_b64_tr_b16 a[190:191], v55 offset:12288
    buffer_load_dwordx4 v[228:231], v16, s[56:59], s75 offen offset:0 sc1
    s_waitcnt lgkmcnt(12)
    v_mfma_f32_16x16x32_bf16 v[100:103], a[164:167], a[20:23], v[100:103]
    ds_read_b64_tr_b16 a[128:129], v48 offset:16384
    ds_read_b64_tr_b16 a[130:131], v48 offset:20480
    buffer_load_dwordx4 v[236:239], v16, s[56:59], s75 offen offset:1024 sc1
    s_waitcnt lgkmcnt(12)
    v_mfma_f32_16x16x32_bf16 v[104:107], a[168:171], a[20:23], v[104:107]
    ds_read_b64_tr_b16 a[132:133], v49 offset:16384
    ds_read_b64_tr_b16 a[134:135], v49 offset:20480
    buffer_load_dwordx4 v[244:247], v16, s[56:59], s75 offen offset:2048 sc1
    s_waitcnt lgkmcnt(12)
    v_mfma_f32_16x16x32_bf16 v[108:111], a[172:175], a[20:23], v[108:111]
    ds_read_b64_tr_b16 a[136:137], v50 offset:16384
    ds_read_b64_tr_b16 a[138:139], v50 offset:20480
    buffer_load_dwordx4 v[252:255], v16, s[56:59], s75 offen offset:3072 sc1
    s_waitcnt lgkmcnt(12)
    v_mfma_f32_16x16x32_bf16 v[112:115], a[176:179], a[20:23], v[112:115]
    ds_read_b64_tr_b16 a[140:141], v51 offset:16384
    ds_read_b64_tr_b16 a[142:143], v51 offset:20480
    s_waitcnt lgkmcnt(12)
    v_mfma_f32_16x16x32_bf16 v[116:119], a[180:183], a[20:23], v[116:119]
    ds_read_b64_tr_b16 a[144:145], v52 offset:16384
    ds_read_b64_tr_b16 a[146:147], v52 offset:20480
    s_waitcnt lgkmcnt(12)
    v_mfma_f32_16x16x32_bf16 v[120:123], a[184:187], a[20:23], v[120:123]
    ds_read_b64_tr_b16 a[148:149], v53 offset:16384
    ds_read_b64_tr_b16 a[150:151], v53 offset:20480
    s_waitcnt lgkmcnt(12)
    v_mfma_f32_16x16x32_bf16 v[124:127], a[188:191], a[20:23], v[124:127]
    ds_read_b64_tr_b16 a[152:153], v54 offset:16384
    ds_read_b64_tr_b16 a[154:155], v54 offset:20480
    s_waitcnt lgkmcnt(12)
    v_mfma_f32_16x16x32_bf16 v[96:99], a[128:131], a[24:27], v[96:99]
    ds_read_b64_tr_b16 a[156:157], v55 offset:16384
    ds_read_b64_tr_b16 a[158:159], v55 offset:20480
    s_waitcnt lgkmcnt(12)
    v_mfma_f32_16x16x32_bf16 v[100:103], a[132:135], a[24:27], v[100:103]
    ds_read_b64_tr_b16 a[160:161], v48 offset:24576
    ds_read_b64_tr_b16 a[162:163], v48 offset:28672
    s_waitcnt lgkmcnt(12)
    v_mfma_f32_16x16x32_bf16 v[104:107], a[136:139], a[24:27], v[104:107]
    ds_read_b64_tr_b16 a[164:165], v49 offset:24576
    ds_read_b64_tr_b16 a[166:167], v49 offset:28672
    s_waitcnt lgkmcnt(12)
    v_mfma_f32_16x16x32_bf16 v[108:111], a[140:143], a[24:27], v[108:111]
    ds_read_b64_tr_b16 a[168:169], v50 offset:24576
    ds_read_b64_tr_b16 a[170:171], v50 offset:28672
    s_waitcnt lgkmcnt(12)
    v_mfma_f32_16x16x32_bf16 v[112:115], a[144:147], a[24:27], v[112:115]
    ds_read_b64_tr_b16 a[172:173], v51 offset:24576
    ds_read_b64_tr_b16 a[174:175], v51 offset:28672
    s_waitcnt lgkmcnt(12)
    v_mfma_f32_16x16x32_bf16 v[116:119], a[148:151], a[24:27], v[116:119]
    ds_read_b64_tr_b16 a[176:177], v52 offset:24576
    ds_read_b64_tr_b16 a[178:179], v52 offset:28672
    s_waitcnt lgkmcnt(12)
    v_mfma_f32_16x16x32_bf16 v[120:123], a[152:155], a[24:27], v[120:123]
    ds_read_b64_tr_b16 a[180:181], v53 offset:24576
    ds_read_b64_tr_b16 a[182:183], v53 offset:28672
    s_waitcnt lgkmcnt(12)
    v_mfma_f32_16x16x32_bf16 v[124:127], a[156:159], a[24:27], v[124:127]
    ds_read_b64_tr_b16 a[184:185], v54 offset:24576
    ds_read_b64_tr_b16 a[186:187], v54 offset:28672
    s_waitcnt lgkmcnt(12)
    v_mfma_f32_16x16x32_bf16 v[96:99], a[160:163], a[28:31], v[96:99]
    ds_read_b64_tr_b16 a[188:189], v55 offset:24576
    ds_read_b64_tr_b16 a[190:191], v55 offset:28672
    s_waitcnt lgkmcnt(12)
    v_mfma_f32_16x16x32_bf16 v[100:103], a[164:167], a[28:31], v[100:103]
    ds_read_b64_tr_b16 a[128:129], v48 offset:32768
    ds_read_b64_tr_b16 a[130:131], v48 offset:36864
    s_waitcnt lgkmcnt(12)
    v_mfma_f32_16x16x32_bf16 v[104:107], a[168:171], a[28:31], v[104:107]
    ds_read_b64_tr_b16 a[132:133], v49 offset:32768
    ds_read_b64_tr_b16 a[134:135], v49 offset:36864
    s_waitcnt lgkmcnt(12)
    v_mfma_f32_16x16x32_bf16 v[108:111], a[172:175], a[28:31], v[108:111]
    ds_read_b64_tr_b16 a[136:137], v50 offset:32768
    ds_read_b64_tr_b16 a[138:139], v50 offset:36864
    s_waitcnt lgkmcnt(12)
    v_mfma_f32_16x16x32_bf16 v[112:115], a[176:179], a[28:31], v[112:115]
    ds_read_b64_tr_b16 a[140:141], v51 offset:32768
    ds_read_b64_tr_b16 a[142:143], v51 offset:36864
    s_waitcnt lgkmcnt(12)
    v_mfma_f32_16x16x32_bf16 v[116:119], a[180:183], a[28:31], v[116:119]
    ds_read_b64_tr_b16 a[144:145], v52 offset:32768
    ds_read_b64_tr_b16 a[146:147], v52 offset:36864
    s_waitcnt lgkmcnt(12)
    v_mfma_f32_16x16x32_bf16 v[120:123], a[184:187], a[28:31], v[120:123]
    ds_read_b64_tr_b16 a[148:149], v53 offset:32768
    ds_read_b64_tr_b16 a[150:151], v53 offset:36864
    s_waitcnt lgkmcnt(12)
    v_mfma_f32_16x16x32_bf16 v[124:127], a[188:191], a[28:31], v[124:127]
    ds_read_b64_tr_b16 a[152:153], v54 offset:32768
    ds_read_b64_tr_b16 a[154:155], v54 offset:36864
    s_waitcnt vmcnt(12)
    s_barrier
    s_waitcnt lgkmcnt(12)
    v_mfma_f32_16x16x32_bf16 v[96:99], a[128:131], a[32:35], v[96:99]
    ds_read_b64_tr_b16 a[156:157], v55 offset:32768
    ds_read_b64_tr_b16 a[158:159], v55 offset:36864
    s_waitcnt lgkmcnt(12)
    v_mfma_f32_16x16x32_bf16 v[100:103], a[132:135], a[32:35], v[100:103]
    ds_read_b64_tr_b16 a[160:161], v48 offset:40960
    ds_read_b64_tr_b16 a[162:163], v48 offset:45056
    s_waitcnt lgkmcnt(12)
    v_mfma_f32_16x16x32_bf16 v[104:107], a[136:139], a[32:35], v[104:107]
    ds_read_b64_tr_b16 a[164:165], v49 offset:40960
    ds_read_b64_tr_b16 a[166:167], v49 offset:45056
    s_waitcnt lgkmcnt(12)
    v_mfma_f32_16x16x32_bf16 v[108:111], a[140:143], a[32:35], v[108:111]
    ds_read_b64_tr_b16 a[168:169], v50 offset:40960
    ds_read_b64_tr_b16 a[170:171], v50 offset:45056
    s_waitcnt lgkmcnt(12)
    v_mfma_f32_16x16x32_bf16 v[112:115], a[144:147], a[32:35], v[112:115]
    ds_read_b64_tr_b16 a[172:173], v51 offset:40960
    ds_read_b64_tr_b16 a[174:175], v51 offset:45056
    s_waitcnt lgkmcnt(12)
    v_mfma_f32_16x16x32_bf16 v[116:119], a[148:151], a[32:35], v[116:119]
    ds_read_b64_tr_b16 a[176:177], v52 offset:40960
    ds_read_b64_tr_b16 a[178:179], v52 offset:45056
    s_waitcnt lgkmcnt(12)
    v_mfma_f32_16x16x32_bf16 v[120:123], a[152:155], a[32:35], v[120:123]
    ds_read_b64_tr_b16 a[180:181], v53 offset:40960
    ds_read_b64_tr_b16 a[182:183], v53 offset:45056
    s_waitcnt lgkmcnt(12)
    v_mfma_f32_16x16x32_bf16 v[124:127], a[156:159], a[32:35], v[124:127]
    ds_read_b64_tr_b16 a[184:185], v54 offset:40960
    ds_read_b64_tr_b16 a[186:187], v54 offset:45056
    s_waitcnt lgkmcnt(12)
    v_mfma_f32_16x16x32_bf16 v[96:99], a[160:163], a[36:39], v[96:99]
    ds_read_b64_tr_b16 a[188:189], v55 offset:40960
    ds_read_b64_tr_b16 a[190:191], v55 offset:45056
    s_waitcnt lgkmcnt(12)
    v_mfma_f32_16x16x32_bf16 v[100:103], a[164:167], a[36:39], v[100:103]
    ds_read_b64_tr_b16 a[128:129], v48 offset:49152
    ds_read_b64_tr_b16 a[130:131], v48 offset:53248
    s_waitcnt lgkmcnt(12)
    v_mfma_f32_16x16x32_bf16 v[104:107], a[168:171], a[36:39], v[104:107]
    ds_read_b64_tr_b16 a[132:133], v49 offset:49152
    ds_read_b64_tr_b16 a[134:135], v49 offset:53248
    s_waitcnt lgkmcnt(12)
    v_mfma_f32_16x16x32_bf16 v[108:111], a[172:175], a[36:39], v[108:111]
    ds_read_b64_tr_b16 a[136:137], v50 offset:49152
    ds_read_b64_tr_b16 a[138:139], v50 offset:53248
    s_waitcnt lgkmcnt(12)
    v_mfma_f32_16x16x32_bf16 v[112:115], a[176:179], a[36:39], v[112:115]
    ds_read_b64_tr_b16 a[140:141], v51 offset:49152
    ds_read_b64_tr_b16 a[142:143], v51 offset:53248
    s_waitcnt lgkmcnt(12)
    v_mfma_f32_16x16x32_bf16 v[116:119], a[180:183], a[36:39], v[116:119]
    ds_read_b64_tr_b16 a[144:145], v52 offset:49152
    ds_read_b64_tr_b16 a[146:147], v52 offset:53248
    s_waitcnt lgkmcnt(12)
    v_mfma_f32_16x16x32_bf16 v[120:123], a[184:187], a[36:39], v[120:123]
    ds_read_b64_tr_b16 a[148:149], v53 offset:49152
    ds_read_b64_tr_b16 a[150:151], v53 offset:53248
    s_waitcnt lgkmcnt(12)
    v_mfma_f32_16x16x32_bf16 v[124:127], a[188:191], a[36:39], v[124:127]
    ds_read_b64_tr_b16 a[152:153], v54 offset:49152
    ds_read_b64_tr_b16 a[154:155], v54 offset:53248
    s_waitcnt lgkmcnt(12)
    v_mfma_f32_16x16x32_bf16 v[96:99], a[128:131], a[40:43], v[96:99]
    ds_read_b64_tr_b16 a[156:157], v55 offset:49152
    ds_read_b64_tr_b16 a[158:159], v55 offset:53248
    s_waitcnt lgkmcnt(12)
    v_mfma_f32_16x16x32_bf16 v[100:103], a[132:135], a[40:43], v[100:103]
    ds_read_b64_tr_b16 a[160:161], v48 offset:57344
    ds_read_b64_tr_b16 a[162:163], v48 offset:61440
    s_waitcnt lgkmcnt(12)
    v_mfma_f32_16x16x32_bf16 v[104:107], a[136:139], a[40:43], v[104:107]
    ds_read_b64_tr_b16 a[164:165], v49 offset:57344
    ds_read_b64_tr_b16 a[166:167], v49 offset:61440
    s_waitcnt lgkmcnt(12)
    v_mfma_f32_16x16x32_bf16 v[108:111], a[140:143], a[40:43], v[108:111]
    ds_read_b64_tr_b16 a[168:169], v50 offset:57344
    ds_read_b64_tr_b16 a[170:171], v50 offset:61440
    s_waitcnt lgkmcnt(12)
    v_mfma_f32_16x16x32_bf16 v[112:115], a[144:147], a[40:43], v[112:115]
    ds_read_b64_tr_b16 a[172:173], v51 offset:57344
    ds_read_b64_tr_b16 a[174:175], v51 offset:61440
    s_waitcnt lgkmcnt(12)
    v_mfma_f32_16x16x32_bf16 v[116:119], a[148:151], a[40:43], v[116:119]
    ds_read_b64_tr_b16 a[176:177], v52 offset:57344
    ds_read_b64_tr_b16 a[178:179], v52 offset:61440
    s_waitcnt lgkmcnt(12)
    v_mfma_f32_16x16x32_bf16 v[120:123], a[152:155], a[40:43], v[120:123]
    ds_read_b64_tr_b16 a[180:181], v53 offset:57344
    ds_read_b64_tr_b16 a[182:183], v53 offset:61440
    s_waitcnt lgkmcnt(12)
    v_mfma_f32_16x16x32_bf16 v[124:127], a[156:159], a[40:43], v[124:127]
    ds_read_b64_tr_b16 a[184:185], v54 offset:57344
    ds_read_b64_tr_b16 a[186:187], v54 offset:61440
    s_waitcnt lgkmcnt(12)
    v_mfma_f32_16x16x32_bf16 v[96:99], a[160:163], a[44:47], v[96:99]
    ds_read_b64_tr_b16 a[188:189], v55 offset:57344
    ds_read_b64_tr_b16 a[190:191], v55 offset:61440
    s_waitcnt lgkmcnt(12)
    v_mfma_f32_16x16x32_bf16 v[100:103], a[164:167], a[44:47], v[100:103]
    ds_read_b64_tr_b16 a[128:129], v56 offset:0
    ds_read_b64_tr_b16 a[130:131], v56 offset:4096
    s_waitcnt lgkmcnt(12)
    v_mfma_f32_16x16x32_bf16 v[104:107], a[168:171], a[44:47], v[104:107]
    ds_read_b64_tr_b16 a[132:133], v57 offset:0
    ds_read_b64_tr_b16 a[134:135], v57 offset:4096
    s_waitcnt lgkmcnt(12)
    v_mfma_f32_16x16x32_bf16 v[108:111], a[172:175], a[44:47], v[108:111]
    ds_read_b64_tr_b16 a[136:137], v58 offset:0
    ds_read_b64_tr_b16 a[138:139], v58 offset:4096
    s_waitcnt lgkmcnt(12)
    v_mfma_f32_16x16x32_bf16 v[112:115], a[176:179], a[44:47], v[112:115]
    ds_read_b64_tr_b16 a[140:141], v59 offset:0
    ds_read_b64_tr_b16 a[142:143], v59 offset:4096
    s_waitcnt lgkmcnt(12)
    v_mfma_f32_16x16x32_bf16 v[116:119], a[180:183], a[44:47], v[116:119]
    ds_read_b64_tr_b16 a[144:145], v60 offset:0
    ds_read_b64_tr_b16 a[146:147], v60 offset:4096
    s_waitcnt lgkmcnt(12)
    v_mfma_f32_16x16x32_bf16 v[120:123], a[184:187], a[44:47], v[120:123]
    ds_read_b64_tr_b16 a[148:149], v61 offset:0
    ds_read_b64_tr_b16 a[150:151], v61 offset:4096
    s_waitcnt lgkmcnt(12)
    v_mfma_f32_16x16x32_bf16 v[124:127], a[188:191], a[44:47], v[124:127]
    ds_read_b64_tr_b16 a[152:153], v62 offset:0
    ds_read_b64_tr_b16 a[154:155], v62 offset:4096
    s_waitcnt lgkmcnt(12)
    v_mfma_f32_16x16x32_bf16 v[96:99], a[128:131], a[48:51], v[96:99]
    ds_read_b64_tr_b16 a[156:157], v63 offset:0
    ds_read_b64_tr_b16 a[158:159], v63 offset:4096
    s_waitcnt lgkmcnt(12)
    v_mfma_f32_16x16x32_bf16 v[100:103], a[132:135], a[48:51], v[100:103]
    ds_read_b64_tr_b16 a[160:161], v56 offset:8192
    ds_read_b64_tr_b16 a[162:163], v56 offset:12288
    s_waitcnt lgkmcnt(12)
    v_mfma_f32_16x16x32_bf16 v[104:107], a[136:139], a[48:51], v[104:107]
    ds_read_b64_tr_b16 a[164:165], v57 offset:8192
    ds_read_b64_tr_b16 a[166:167], v57 offset:12288
    s_waitcnt lgkmcnt(12)
    v_mfma_f32_16x16x32_bf16 v[108:111], a[140:143], a[48:51], v[108:111]
    ds_read_b64_tr_b16 a[168:169], v58 offset:8192
    ds_read_b64_tr_b16 a[170:171], v58 offset:12288
    s_waitcnt lgkmcnt(12)
    v_mfma_f32_16x16x32_bf16 v[112:115], a[144:147], a[48:51], v[112:115]
    ds_read_b64_tr_b16 a[172:173], v59 offset:8192
    ds_read_b64_tr_b16 a[174:175], v59 offset:12288
    s_waitcnt lgkmcnt(12)
    v_mfma_f32_16x16x32_bf16 v[116:119], a[148:151], a[48:51], v[116:119]
    ds_read_b64_tr_b16 a[176:177], v60 offset:8192
    ds_read_b64_tr_b16 a[178:179], v60 offset:12288
    s_waitcnt lgkmcnt(12)
    v_mfma_f32_16x16x32_bf16 v[120:123], a[152:155], a[48:51], v[120:123]
    ds_read_b64_tr_b16 a[180:181], v61 offset:8192
    ds_read_b64_tr_b16 a[182:183], v61 offset:12288
    s_waitcnt lgkmcnt(12)
    v_mfma_f32_16x16x32_bf16 v[124:127], a[156:159], a[48:51], v[124:127]
    ds_read_b64_tr_b16 a[184:185], v62 offset:8192
    ds_read_b64_tr_b16 a[186:187], v62 offset:12288
    s_waitcnt lgkmcnt(12)
    v_mfma_f32_16x16x32_bf16 v[96:99], a[160:163], a[52:55], v[96:99]
    ds_read_b64_tr_b16 a[188:189], v63 offset:8192
    ds_read_b64_tr_b16 a[190:191], v63 offset:12288
    s_waitcnt lgkmcnt(12)
    v_mfma_f32_16x16x32_bf16 v[100:103], a[164:167], a[52:55], v[100:103]
    ds_read_b64_tr_b16 a[128:129], v56 offset:16384
    ds_read_b64_tr_b16 a[130:131], v56 offset:20480
    s_waitcnt lgkmcnt(12)
    v_mfma_f32_16x16x32_bf16 v[104:107], a[168:171], a[52:55], v[104:107]
    ds_read_b64_tr_b16 a[132:133], v57 offset:16384
    ds_read_b64_tr_b16 a[134:135], v57 offset:20480
    s_waitcnt lgkmcnt(12)
    v_mfma_f32_16x16x32_bf16 v[108:111], a[172:175], a[52:55], v[108:111]
    ds_read_b64_tr_b16 a[136:137], v58 offset:16384
    ds_read_b64_tr_b16 a[138:139], v58 offset:20480
    s_waitcnt lgkmcnt(12)
    v_mfma_f32_16x16x32_bf16 v[112:115], a[176:179], a[52:55], v[112:115]
    ds_read_b64_tr_b16 a[140:141], v59 offset:16384
    ds_read_b64_tr_b16 a[142:143], v59 offset:20480
    s_waitcnt lgkmcnt(12)
    v_mfma_f32_16x16x32_bf16 v[116:119], a[180:183], a[52:55], v[116:119]
    ds_read_b64_tr_b16 a[144:145], v60 offset:16384
    ds_read_b64_tr_b16 a[146:147], v60 offset:20480
    s_waitcnt lgkmcnt(12)
    v_mfma_f32_16x16x32_bf16 v[120:123], a[184:187], a[52:55], v[120:123]
    ds_read_b64_tr_b16 a[148:149], v61 offset:16384
    ds_read_b64_tr_b16 a[150:151], v61 offset:20480
    s_waitcnt lgkmcnt(12)
    v_mfma_f32_16x16x32_bf16 v[124:127], a[188:191], a[52:55], v[124:127]
    ds_read_b64_tr_b16 a[152:153], v62 offset:16384
    ds_read_b64_tr_b16 a[154:155], v62 offset:20480
    s_waitcnt lgkmcnt(12)
    v_mfma_f32_16x16x32_bf16 v[96:99], a[128:131], a[56:59], v[96:99]
    ds_read_b64_tr_b16 a[156:157], v63 offset:16384
    ds_read_b64_tr_b16 a[158:159], v63 offset:20480
    s_waitcnt lgkmcnt(12)
    v_mfma_f32_16x16x32_bf16 v[100:103], a[132:135], a[56:59], v[100:103]
    ds_read_b64_tr_b16 a[160:161], v56 offset:24576
    ds_read_b64_tr_b16 a[162:163], v56 offset:28672
    s_waitcnt lgkmcnt(12)
    v_mfma_f32_16x16x32_bf16 v[104:107], a[136:139], a[56:59], v[104:107]
    ds_read_b64_tr_b16 a[164:165], v57 offset:24576
    ds_read_b64_tr_b16 a[166:167], v57 offset:28672
    s_waitcnt lgkmcnt(12)
    v_mfma_f32_16x16x32_bf16 v[108:111], a[140:143], a[56:59], v[108:111]
    ds_read_b64_tr_b16 a[168:169], v58 offset:24576
    ds_read_b64_tr_b16 a[170:171], v58 offset:28672
    s_waitcnt lgkmcnt(12)
    v_mfma_f32_16x16x32_bf16 v[112:115], a[144:147], a[56:59], v[112:115]
    ds_read_b64_tr_b16 a[172:173], v59 offset:24576
    ds_read_b64_tr_b16 a[174:175], v59 offset:28672
    s_waitcnt lgkmcnt(12)
    v_mfma_f32_16x16x32_bf16 v[116:119], a[148:151], a[56:59], v[116:119]
    ds_read_b64_tr_b16 a[176:177], v60 offset:24576
    ds_read_b64_tr_b16 a[178:179], v60 offset:28672
    s_waitcnt lgkmcnt(12)
    v_mfma_f32_16x16x32_bf16 v[120:123], a[152:155], a[56:59], v[120:123]
    ds_read_b64_tr_b16 a[180:181], v61 offset:24576
    ds_read_b64_tr_b16 a[182:183], v61 offset:28672
    s_waitcnt lgkmcnt(12)
    v_mfma_f32_16x16x32_bf16 v[124:127], a[156:159], a[56:59], v[124:127]
    ds_read_b64_tr_b16 a[184:185], v62 offset:24576
    ds_read_b64_tr_b16 a[186:187], v62 offset:28672
    s_waitcnt lgkmcnt(12)
    v_mfma_f32_16x16x32_bf16 v[96:99], a[160:163], a[60:63], v[96:99]
    ds_read_b64_tr_b16 a[188:189], v63 offset:24576
    ds_read_b64_tr_b16 a[190:191], v63 offset:28672
    s_waitcnt lgkmcnt(12)
    v_mfma_f32_16x16x32_bf16 v[100:103], a[164:167], a[60:63], v[100:103]
    s_waitcnt lgkmcnt(10)
    v_mfma_f32_16x16x32_bf16 v[104:107], a[168:171], a[60:63], v[104:107]
    s_waitcnt lgkmcnt(8)
    v_mfma_f32_16x16x32_bf16 v[108:111], a[172:175], a[60:63], v[108:111]
    s_waitcnt lgkmcnt(6)
    v_mfma_f32_16x16x32_bf16 v[112:115], a[176:179], a[60:63], v[112:115]
    s_waitcnt lgkmcnt(4)
    v_mfma_f32_16x16x32_bf16 v[116:119], a[180:183], a[60:63], v[116:119]
    s_waitcnt lgkmcnt(2)
    v_mfma_f32_16x16x32_bf16 v[120:123], a[184:187], a[60:63], v[120:123]
    s_waitcnt lgkmcnt(0)
    v_mfma_f32_16x16x32_bf16 v[124:127], a[188:191], a[60:63], v[124:127]
    s_waitcnt vmcnt(11)
    v_mfma_f32_16x16x32_bf16 v[128:131], v[28:31], v[164:167], v[128:131]
    v_mfma_f32_16x16x32_bf16 v[132:135], v[26:29], v[164:167], v[132:135]
    s_waitcnt vmcnt(10)
    v_mfma_f32_16x16x32_bf16 v[136:139], v[28:31], v[172:175], v[136:139]
    v_mfma_f32_16x16x32_bf16 v[140:143], v[26:29], v[172:175], v[140:143]
    s_waitcnt vmcnt(9)
    v_mfma_f32_16x16x32_bf16 v[144:147], v[28:31], v[180:183], v[144:147]
    v_mfma_f32_16x16x32_bf16 v[148:151], v[26:29], v[180:183], v[148:151]
    s_waitcnt vmcnt(8)
    v_mfma_f32_16x16x32_bf16 v[152:155], v[28:31], v[188:191], v[152:155]
    v_mfma_f32_16x16x32_bf16 v[156:159], v[26:29], v[188:191], v[156:159]
    s_waitcnt vmcnt(7)
    v_mfma_f32_16x16x32_bf16 v[128:131], v[28:31], v[196:199], v[128:131]
    v_mfma_f32_16x16x32_bf16 v[132:135], v[26:29], v[196:199], v[132:135]
    s_waitcnt vmcnt(6)
    v_mfma_f32_16x16x32_bf16 v[136:139], v[28:31], v[204:207], v[136:139]
    v_mfma_f32_16x16x32_bf16 v[140:143], v[26:29], v[204:207], v[140:143]
    s_waitcnt vmcnt(5)
    v_mfma_f32_16x16x32_bf16 v[144:147], v[28:31], v[212:215], v[144:147]
    v_mfma_f32_16x16x32_bf16 v[148:151], v[26:29], v[212:215], v[148:151]
    s_waitcnt vmcnt(4)
    v_mfma_f32_16x16x32_bf16 v[152:155], v[28:31], v[220:223], v[152:155]
    v_mfma_f32_16x16x32_bf16 v[156:159], v[26:29], v[220:223], v[156:159]
    s_waitcnt vmcnt(3)
    v_mfma_f32_16x16x32_bf16 v[128:131], v[28:31], v[228:231], v[128:131]
    v_mfma_f32_16x16x32_bf16 v[132:135], v[26:29], v[228:231], v[132:135]
    s_waitcnt vmcnt(2)
    v_mfma_f32_16x16x32_bf16 v[136:139], v[28:31], v[236:239], v[136:139]
    v_mfma_f32_16x16x32_bf16 v[140:143], v[26:29], v[236:239], v[140:143]
    s_waitcnt vmcnt(1)
    v_mfma_f32_16x16x32_bf16 v[144:147], v[28:31], v[244:247], v[144:147]
    v_mfma_f32_16x16x32_bf16 v[148:151], v[26:29], v[244:247], v[148:151]
    s_waitcnt vmcnt(0)
    v_mfma_f32_16x16x32_bf16 v[152:155], v[28:31], v[252:255], v[152:155]
    v_mfma_f32_16x16x32_bf16 v[156:159], v[26:29], v[252:255], v[156:159]
    v_pk_mul_f32 v[34:35], v[128:129], s[14:15]
    v_pk_mul_f32 v[36:37], v[130:131], s[14:15]
    v_pk_mul_f32 v[38:39], v[132:133], s[14:15]
    v_pk_mul_f32 v[40:41], v[134:135], s[14:15]
    v_exp_f32 v34, v34
    v_exp_f32 v35, v35
    v_exp_f32 v36, v36
    v_exp_f32 v37, v37
    v_exp_f32 v38, v38
    v_exp_f32 v39, v39
    v_exp_f32 v40, v40
    v_exp_f32 v41, v41
    v_pk_mul_f32 v[96:97], v[96:97], v[128:129]
    v_pk_mul_f32 v[98:99], v[98:99], v[130:131]
    v_pk_mul_f32 v[100:101], v[100:101], v[132:133]
    v_pk_mul_f32 v[102:103], v[102:103], v[134:135]
    v_pk_add_f32 v[34:35], v[34:35], 1.0 op_sel_hi:[1,0]
    v_pk_add_f32 v[36:37], v[36:37], 1.0 op_sel_hi:[1,0]
    v_pk_add_f32 v[38:39], v[38:39], 1.0 op_sel_hi:[1,0]
    v_pk_add_f32 v[40:41], v[40:41], 1.0 op_sel_hi:[1,0]
    v_rcp_f32 v34, v34
    v_rcp_f32 v35, v35
    v_rcp_f32 v36, v36
    v_rcp_f32 v37, v37
    v_rcp_f32 v38, v38
    v_rcp_f32 v39, v39
    v_rcp_f32 v40, v40
    v_rcp_f32 v41, v41
    v_pk_fma_f32 v[96:97], v[96:97], v[34:35], v[64:65]
    v_pk_fma_f32 v[98:99], v[98:99], v[36:37], v[66:67]
    v_pk_fma_f32 v[100:101], v[100:101], v[38:39], v[68:69]
    v_pk_fma_f32 v[102:103], v[102:103], v[40:41], v[70:71]
    v_cvt_pk_bf16_f32 v96, v96, v97
    v_cvt_pk_bf16_f32 v97, v98, v99
    v_cvt_pk_bf16_f32 v98, v100, v101
    v_cvt_pk_bf16_f32 v99, v102, v103
    s_nop 0
    v_permlane16_swap_b32 v96, v98
    v_permlane16_swap_b32 v97, v99
    global_store_dwordx4 v2, v[96:99], s[22:23] offset:0 sc1
    v_pk_mul_f32 v[34:35], v[136:137], s[14:15]
    v_pk_mul_f32 v[36:37], v[138:139], s[14:15]
    v_pk_mul_f32 v[38:39], v[140:141], s[14:15]
    v_pk_mul_f32 v[40:41], v[142:143], s[14:15]
    v_exp_f32 v34, v34
    v_exp_f32 v35, v35
    v_exp_f32 v36, v36
    v_exp_f32 v37, v37
    v_exp_f32 v38, v38
    v_exp_f32 v39, v39
    v_exp_f32 v40, v40
    v_exp_f32 v41, v41
    v_pk_mul_f32 v[104:105], v[104:105], v[136:137]
    v_pk_mul_f32 v[106:107], v[106:107], v[138:139]
    v_pk_mul_f32 v[108:109], v[108:109], v[140:141]
    v_pk_mul_f32 v[110:111], v[110:111], v[142:143]
    v_pk_add_f32 v[34:35], v[34:35], 1.0 op_sel_hi:[1,0]
    v_pk_add_f32 v[36:37], v[36:37], 1.0 op_sel_hi:[1,0]
    v_pk_add_f32 v[38:39], v[38:39], 1.0 op_sel_hi:[1,0]
    v_pk_add_f32 v[40:41], v[40:41], 1.0 op_sel_hi:[1,0]
    v_rcp_f32 v34, v34
    v_rcp_f32 v35, v35
    v_rcp_f32 v36, v36
    v_rcp_f32 v37, v37
    v_rcp_f32 v38, v38
    v_rcp_f32 v39, v39
    v_rcp_f32 v40, v40
    v_rcp_f32 v41, v41
    v_pk_fma_f32 v[104:105], v[104:105], v[34:35], v[72:73]
    v_pk_fma_f32 v[106:107], v[106:107], v[36:37], v[74:75]
    v_pk_fma_f32 v[108:109], v[108:109], v[38:39], v[76:77]
    v_pk_fma_f32 v[110:111], v[110:111], v[40:41], v[78:79]
    v_cvt_pk_bf16_f32 v104, v104, v105
    v_cvt_pk_bf16_f32 v105, v106, v107
    v_cvt_pk_bf16_f32 v106, v108, v109
    v_cvt_pk_bf16_f32 v107, v110, v111
    s_nop 0
    v_permlane16_swap_b32 v104, v106
    v_permlane16_swap_b32 v105, v107
    global_store_dwordx4 v2, v[104:107], s[22:23] offset:64 sc1
    v_pk_mul_f32 v[34:35], v[144:145], s[14:15]
    v_pk_mul_f32 v[36:37], v[146:147], s[14:15]
    v_pk_mul_f32 v[38:39], v[148:149], s[14:15]
    v_pk_mul_f32 v[40:41], v[150:151], s[14:15]
    v_exp_f32 v34, v34
    v_exp_f32 v35, v35
    v_exp_f32 v36, v36
    v_exp_f32 v37, v37
    v_exp_f32 v38, v38
    v_exp_f32 v39, v39
    v_exp_f32 v40, v40
    v_exp_f32 v41, v41
    v_pk_mul_f32 v[112:113], v[112:113], v[144:145]
    v_pk_mul_f32 v[114:115], v[114:115], v[146:147]
    v_pk_mul_f32 v[116:117], v[116:117], v[148:149]
    v_pk_mul_f32 v[118:119], v[118:119], v[150:151]
    v_pk_add_f32 v[34:35], v[34:35], 1.0 op_sel_hi:[1,0]
    v_pk_add_f32 v[36:37], v[36:37], 1.0 op_sel_hi:[1,0]
    v_pk_add_f32 v[38:39], v[38:39], 1.0 op_sel_hi:[1,0]
    v_pk_add_f32 v[40:41], v[40:41], 1.0 op_sel_hi:[1,0]
    v_rcp_f32 v34, v34
    v_rcp_f32 v35, v35
    v_rcp_f32 v36, v36
    v_rcp_f32 v37, v37
    v_rcp_f32 v38, v38
    v_rcp_f32 v39, v39
    v_rcp_f32 v40, v40
    v_rcp_f32 v41, v41
    v_pk_fma_f32 v[112:113], v[112:113], v[34:35], v[80:81]
    v_pk_fma_f32 v[114:115], v[114:115], v[36:37], v[82:83]
    v_pk_fma_f32 v[116:117], v[116:117], v[38:39], v[84:85]
    v_pk_fma_f32 v[118:119], v[118:119], v[40:41], v[86:87]
    v_cvt_pk_bf16_f32 v112, v112, v113
    v_cvt_pk_bf16_f32 v113, v114, v115
    v_cvt_pk_bf16_f32 v114, v116, v117
    v_cvt_pk_bf16_f32 v115, v118, v119
    s_nop 0
    v_permlane16_swap_b32 v112, v114
    v_permlane16_swap_b32 v113, v115
    global_store_dwordx4 v2, v[112:115], s[22:23] offset:128 sc1
    v_pk_mul_f32 v[34:35], v[152:153], s[14:15]
    v_pk_mul_f32 v[36:37], v[154:155], s[14:15]
    v_pk_mul_f32 v[38:39], v[156:157], s[14:15]
    v_pk_mul_f32 v[40:41], v[158:159], s[14:15]
    v_exp_f32 v34, v34
    v_exp_f32 v35, v35
    v_exp_f32 v36, v36
    v_exp_f32 v37, v37
    v_exp_f32 v38, v38
    v_exp_f32 v39, v39
    v_exp_f32 v40, v40
    v_exp_f32 v41, v41
    v_pk_mul_f32 v[120:121], v[120:121], v[152:153]
    v_pk_mul_f32 v[122:123], v[122:123], v[154:155]
    v_pk_mul_f32 v[124:125], v[124:125], v[156:157]
    v_pk_mul_f32 v[126:127], v[126:127], v[158:159]
    v_pk_add_f32 v[34:35], v[34:35], 1.0 op_sel_hi:[1,0]
    v_pk_add_f32 v[36:37], v[36:37], 1.0 op_sel_hi:[1,0]
    v_pk_add_f32 v[38:39], v[38:39], 1.0 op_sel_hi:[1,0]
    v_pk_add_f32 v[40:41], v[40:41], 1.0 op_sel_hi:[1,0]
    v_rcp_f32 v34, v34
    v_rcp_f32 v35, v35
    v_rcp_f32 v36, v36
    v_rcp_f32 v37, v37
    v_rcp_f32 v38, v38
    v_rcp_f32 v39, v39
    v_rcp_f32 v40, v40
    v_rcp_f32 v41, v41
    v_pk_fma_f32 v[120:121], v[120:121], v[34:35], v[88:89]
    v_pk_fma_f32 v[122:123], v[122:123], v[36:37], v[90:91]
    v_pk_fma_f32 v[124:125], v[124:125], v[38:39], v[92:93]
    v_pk_fma_f32 v[126:127], v[126:127], v[40:41], v[94:95]
    v_cvt_pk_bf16_f32 v120, v120, v121
    v_cvt_pk_bf16_f32 v121, v122, v123
    v_cvt_pk_bf16_f32 v122, v124, v125
    v_cvt_pk_bf16_f32 v123, v126, v127
    s_nop 0
    v_permlane16_swap_b32 v120, v122
    v_permlane16_swap_b32 v121, v123
    global_store_dwordx4 v2, v[120:123], s[22:23] offset:192 sc1
L_end:
    s_endpgm
L_spB:
    buffer_load_dword v43, off, s[56:59], s92 sc1
    s_waitcnt vmcnt(0)
    v_readfirstlane_b32 s86, v43
    s_bfe_u32 s86, s86, 0x80008
    s_cmp_eq_u32 s86, 16
    s_cbranch_scc1 L_okB
    s_add_u32 s67, s67, 1
    s_cmp_lt_u32 s67, 0x40000
    s_cbranch_scc1 L_spB
    s_branch L_okB
L_spC:
    buffer_load_dword v43, off, s[56:59], s92 sc1
    s_waitcnt vmcnt(0)
    v_readfirstlane_b32 s86, v43
    s_bfe_u32 s86, s86, 0x80010
    s_cmp_eq_u32 s86, 16
    s_cbranch_scc1 L_okC
    s_add_u32 s67, s67, 1
    s_cmp_lt_u32 s67, 0x40000
    s_cbranch_scc1 L_spC
    s_branch L_okC
L_spO:
    buffer_load_dword v43, off, s[56:59], s76 sc1
    s_waitcnt vmcnt(0)
    v_readfirstlane_b32 s86, v43
    s_cmp_eq_u32 s86, 64
    s_cbranch_scc1 L_okO
    s_add_u32 s67, s67, 1
    s_cmp_lt_u32 s67, 0x40000
    s_cbranch_scc1 L_spO
    s_branch L_okO
L_spP:
    buffer_load_dword v43, off, s[56:59], s77 sc1
    s_waitcnt vmcnt(0)
    v_readfirstlane_b32 s86, v43
    s_cmp_eq_u32 s86, 4
    s_cbranch_scc1 L_okP
    s_add_u32 s67, s67, 1
    s_cmp_lt_u32 s67, 0x40000
    s_cbranch_scc1 L_spP
    s_branch L_okP
L_code_end:
.section .rodata,"a"
.p2align 6
.amdhsa_kernel recurrent_scan__sliding_local_dilated__glu_gated_geglu__prompt_kernel
  .amdhsa_next_free_vgpr 512
  .amdhsa_next_free_sgpr 102
  .amdhsa_accum_offset 256
  .amdhsa_group_segment_fixed_size 0
  .amdhsa_kernarg_size 80
  .amdhsa_user_sgpr_count 2
  .amdhsa_user_sgpr_kernarg_segment_ptr 1
  .amdhsa_system_sgpr_workgroup_id_x 1
.end_amdhsa_kernel
```

```asm
; @launch grid=(256,1,1) block=(256,1,1) lds=163840
.amdgcn_target "amdgcn-amd-amdhsa--gfx950"
.text
.p2align 8
.globl recurrent_scan__sliding_local_dilated__glu_gated_geglu__prompt_kernel
.type recurrent_scan__sliding_local_dilated__glu_gated_geglu__prompt_kernel,@function
recurrent_scan__sliding_local_dilated__glu_gated_geglu__prompt_kernel:
    s_cmp_ge_u32 s2, 256
    s_cbranch_scc1 L_end
    s_load_dwordx16 s[8:23], s[0:1], 0
    s_load_dwordx4 s[24:27], s[0:1], 64
    v_lshrrev_b32 v1, 6, v0
    v_and_b32 v0, 63, v0
    v_readfirstlane_b32 s60, v1
    s_getpc_b64 s[86:87]
L_pc:
    s_lshr_b32 s82, s2, 3
    s_lshl_b32 s82, s82, 2
    s_add_u32 s82, s82, s60
    s_lshl_b32 s82, s82, 10
    v_lshl_add_u32 v2, v0, 4, s82
    v_min_u32 v2, L_code_end-L_pc-4, v2
    global_load_dword v7, v2, s[86:87]
    s_and_b32 s82, s2, 7
    s_lshr_b32 s83, s2, 3
    s_lshr_b32 s65, s82, 1
    s_and_b32 s63, s82, 1
    s_lshl_b32 s63, s63, 2
    s_and_b32 s84, s83, 3
    s_add_u32 s63, s63, s84
    s_lshr_b32 s66, s83, 2
    s_lshl_b32 s64, s65, 3
    s_add_u32 s64, s64, s66
    s_lshr_b32 s61, s60, 1
    s_and_b32 s62, s60, 1
    v_lshlrev_b32 v16, 4, v0
    s_lshl_b32 s84, s64, 2
    s_add_u32 s84, s84, s60
    s_lshl_b32 s85, s63, 7
    s_add_u32 s84, s84, s85
    s_lshl_b32 s85, s84, 12
    v_add_u32 v36, s85, v16
    s_lshl_b32 s84, s84, 2
    s_add_u32 s84, s84, 39845888
    v_mov_b32 v37, s84
    s_waitcnt lgkmcnt(0)
    global_load_dwordx4 v[48:51], v36, s[8:9] offset:0
    global_load_dwordx4 v[52:55], v36, s[8:9] offset:1024
    global_load_dwordx4 v[56:59], v36, s[8:9] offset:2048
    global_load_dwordx4 v[60:63], v36, s[8:9] offset:3072
    s_lshl_b32 s84, s63, 9
    s_lshl_b32 s85, s61, 8
    s_add_u32 s85, s85, s84
    s_sub_u32 s84, s84, 32
    s_max_i32 s84, s84, 0
    s_cmp_eq_u32 s62, 0
    s_cselect_b32 s85, s85, s84
    s_cselect_b32 s84, 63, 7
    s_add_u32 s85, s85, 39845888
    v_and_b32 v38, s84, v0
    v_lshlrev_b32 v38, 2, v38
    v_add_u32 v38, s85, v38
    global_load_dword v39, v38, s[26:27] sc1
    global_load_dword v40, v37, s[26:27] sc1
    v_lshlrev_b32 v2, 6, v0
    v_sub_u32 v2, v2, v16
    v_add_u32 v2, v2, v36
    global_load_dword v7, v2, s[26:27] sc1
    s_sub_u32 s84, s63, s62
    s_max_i32 s84, s84, 0
    s_lshl_b32 s84, s84, 5
    v_mov_b32 v41, s84
    s_mov_b32 s56, s26
    s_and_b32 s57, s27, 0xffff
    s_mov_b32 s58, 0x10000000
    s_mov_b32 s59, 0x20000
    s_lshl_b32 s84, s63, 2
    s_add_u32 s84, s84, s65
    s_lshl_b32 s92, s84, 8
    s_add_u32 s92, s92, 39849984
    s_mul_i32 s88, s84, 458752
    s_add_u32 s88, s88, 8388608
    s_lshl_b32 s93, s63, 8
    s_add_u32 s93, s93, 39858176
    s_cmp_lg_u32 s60, 3
    s_cbranch_scc1 L_nozero
    s_lshl_b32 s84, s63, 3
    s_add_u32 s84, s84, s66
    s_lshl_b32 s84, s84, 2
    s_add_u32 s84, s84, s65
    s_lshl_b32 s84, s84, 8
    s_add_u32 s84, s84, 39862272
    v_mov_b32 v2, s84
    v_writelane_b32 v2, s92, 1
    v_writelane_b32 v2, s93, 2
    s_cmp_eq_u32 s66, 0
    s_cselect_b32 s84, 3, 1
    s_cmp_eq_u32 s64, 0
    s_cselect_b32 s84, 7, s84
    v_mov_b32 v3, 0
    s_mov_b32 exec_hi, 0
    s_mov_b32 exec_lo, s84
    global_store_dword v2, v3, s[26:27] sc1
    s_mov_b64 exec, -1
L_nozero:
    v_lshrrev_b32 v20, 2, v0
    v_and_b32 v21, 3, v0
    v_lshrrev_b32 v22, 4, v0
    v_and_b32 v23, 15, v0
    v_lshrrev_b32 v24, 3, v20
    v_lshlrev_b32 v24, 1, v24
    v_xor_b32 v24, v21, v24
    v_mul_u32_u24 v2, 6144, v20
    v_lshl_add_u32 v2, v24, 4, v2
    v_mul_u32_u24 v25, 7168, v20
    v_lshl_add_u32 v3, v24, 4, v25
    s_mul_i32 s84, s61, 98304
    s_lshl_b32 s85, s64, 6
    s_add_u32 s84, s84, s85
    s_add_u32 s32, s10, s84
    s_addc_u32 s33, s11, 0
    s_sub_u32 s32, s32, 4096
    s_subb_u32 s33, s33, 0
    s_and_b32 s33, s33, 0xffff
    s_sub_u32 s34, 6295552, s84
    s_mov_b32 s35, 0x20000
    s_mul_i32 s84, s61, 114688
    s_mul_i32 s85, s64, 224
    s_add_u32 s84, s84, s85
    s_add_u32 s36, s16, s84
    s_addc_u32 s37, s17, 0
    s_sub_u32 s36, s36, 4096
    s_subb_u32 s37, s37, 0
    s_and_b32 s37, s37, 0xffff
    s_sub_u32 s38, 7344128, s84
    s_mov_b32 s39, 0x20000
    s_add_u32 s40, s18, s84
    s_addc_u32 s41, s19, 0
    s_sub_u32 s40, s40, 4096
    s_subb_u32 s41, s41, 0
    s_and_b32 s41, s41, 0xffff
    s_sub_u32 s42, 7344128, s84
    s_mov_b32 s43, 0x20000
    v_cmp_lt_u32 vcc, 1, v24
    v_and_b32 v24, 1, v24
    v_lshl_add_u32 v24, v24, 4, v25
    v_add_u32 v24, 3264, v24
    v_mov_b32 v25, 0
    s_add_u32 s82, s16, s84
    s_addc_u32 s83, s17, 0
    s_sub_u32 s82, s82, 4096
    s_subb_u32 s83, s83, 0
    v_lshl_add_u64 v[4:5], v[24:25], 0, s[82:83]
    s_add_u32 s82, s18, s84
    s_addc_u32 s83, s19, 0
    s_sub_u32 s82, s82, 4096
    s_subb_u32 s83, s83, 0
    v_lshl_add_u64 v[24:25], v[24:25], 0, s[82:83]
    v_cndmask_b32 v4, v4, v24, vcc
    v_cndmask_b32 v5, v5, v25, vcc
    s_mov_b32 s80, 229376
    s_mov_b32 s81, 0
    s_cmp_eq_u32 s62, 1
    s_cbranch_scc1 L_init1
    s_lshl_b32 s78, s61, 13
    s_mov_b32 s68, 4096
    s_mov_b32 s69, 35840
    s_mov_b32 s70, 67584
    s_mov_b32 s71, 99328
    s_mov_b32 s72, 135168
    s_mov_b32 s73, 166912
    s_mov_b32 s74, 198656
    s_mov_b32 s75, 230400
    s_lshl_b32 s84, s63, 1
    s_add_u32 s84, s84, s61
    s_lshl_b32 s84, s84, 18
    s_branch L_init2
L_init1:
    s_mul_i32 s78, s61, 11264
    s_add_u32 s78, s78, 16384
    s_mov_b32 s68, 6144
    s_mov_b32 s69, 7168
    s_mov_b32 s70, 2048
    s_mov_b32 s71, 1024
    s_mov_b32 s72, 4096
    s_mov_b32 s73, 3136
    s_mov_b32 s74, 2112
    s_mov_b32 s75, 1152
    s_mov_b32 s76, 4224
    s_mov_b32 s77, 2048
    s_lshl_b32 s84, s63, 19
    s_sub_u32 s84, s84, 32768
    s_max_i32 s84, s84, 0
L_init2:
    s_add_u32 s28, s26, s84
    s_addc_u32 s29, s27, 0
    s_sub_u32 s28, s28, 4096
    s_subb_u32 s29, s29, 0
    s_and_b32 s29, s29, 0xffff
    s_sub_u32 s30, 4198400, s84
    s_mov_b32 s31, 0x20000
    v_mov_b32 v25, 0x78
    v_lshlrev_b32 v24, 1, v22
    v_lshrrev_b32 v24, v24, v25
    v_and_b32 v24, 3, v24
    v_xor_b32 v24, v24, v21
    v_lshlrev_b32 v24, 4, v24
    v_lshl_add_u32 v1, v20, 11, v24
    s_cmp_eq_u32 s63, 0
    s_cselect_b32 s84, 1, 3
    s_and_b32 s85, s60, s84
    s_cmp_eq_u32 s85, s84
    s_cselect_b32 s85, 0x40000000, 0
    s_cselect_b32 s87, 1, 0
    v_add_u32 v1, s85, v1
    s_lshr_b32 s83, s2, 3
    v_lshrrev_b32 v24, 3, v0
    v_and_b32 v25, 7, v0
    s_lshr_b32 s84, s63, 2
    s_lshl_b32 s84, s84, 4
    s_lshr_b32 s85, s83, 1
    s_add_u32 s84, s84, s85
    s_and_b32 s83, s83, 1
    s_cmp_eq_u32 s60, 0
    s_cbranch_scc1 L_pf0
    s_cmp_eq_u32 s60, 1
    s_cselect_b32 s44, s16, s18
    s_cselect_b32 s45, s17, s19
    s_cmp_eq_u32 s60, 3
    s_cselect_b32 s46, 0, 7340032
    s_mov_b32 s79, 229376
    s_mul_i32 s84, s84, 7168
    s_lshl_b32 s85, s65, 1
    s_add_u32 s85, s85, s83
    s_mul_i32 s85, s85, 896
    s_add_u32 s84, s84, s85
    v_cmp_gt_u32 vcc, 7, v25
    v_lshlrev_b32 v25, 7, v25
    s_branch L_pfd
L_pf0:
    s_mov_b32 s44, s10
    s_mov_b32 s45, s11
    s_mov_b32 s46, 6291456
    s_mov_b32 s79, 196608
    s_mul_i32 s84, s84, 6144
    s_lshl_b32 s85, s65, 1
    s_add_u32 s85, s85, s83
    s_lshl_b32 s85, s85, 8
    s_add_u32 s84, s84, s85
    v_cmp_gt_u32 vcc, 6, v25
    v_and_b32 v6, 1, v25
    v_lshrrev_b32 v25, 1, v25
    v_lshlrev_b32 v25, 11, v25
    v_lshl_add_u32 v25, v6, 7, v25
L_pfd:
    v_add_u32 v25, s84, v25
    v_mov_b32 v6, 0x40000000
    v_cndmask_b32 v25, v6, v25, vcc
    v_mul_lo_u32 v42, v24, s79
    v_add_u32 v42, v42, v25
    v_cmp_gt_u32 vcc, 2, v24
    s_nop 1
    v_cndmask_b32 v6, v6, v42, vcc
    s_mul_i32 s84, s79, 8
    v_add_u32 v6, s84, v6
    s_lshl_b32 s86, s79, 3
    s_mul_i32 s79, s79, 2
    s_lshr_b32 s84, s2, 3
    s_and_b32 s84, s84, 1
    s_cmp_eq_u32 s84, 0
    s_cselect_b32 s4, 0, 0x40000000
    s_cmp_eq_u32 s84, 1
    s_cselect_b32 s5, 0, 0x40000000
    s_cmp_lg_u32 s60, 3
    s_cbranch_scc1 L_pf3d
    s_and_b32 s84, s2, 7
    s_lshl_b32 s84, s84, 5
    s_lshr_b32 s85, s2, 3
    s_add_u32 s84, s84, s85
    s_mul_i32 s84, s84, 28672
    s_add_u32 s44, s20, s84
    s_addc_u32 s45, s21, 0
    s_mov_b32 s46, 28672
    s_mov_b32 s79, 0
    v_lshlrev_b32 v6, 7, v0
    v_subrev_u32 v6, 0, v6
    v_mov_b32 v42, 0x40000000
    v_cmp_gt_u32 vcc, 0, v0
    s_nop 1
    v_cndmask_b32 v6, v42, v6, vcc
L_pf3d:
    s_and_b32 s45, s45, 0xffff
    s_mov_b32 s47, 0x20000
    v_mov_b32 v25, 0x78
    v_lshrrev_b32 v24, 2, v23
    v_lshlrev_b32 v24, 1, v24
    v_lshrrev_b32 v24, v24, v25
    v_and_b32 v24, 3, v24
    v_xor_b32 v24, v24, v22
    v_lshlrev_b32 v24, 4, v24
    v_lshl_add_u32 v24, v23, 6, v24
    s_lshl_b32 s84, s61, 13
    v_add_u32 v8, s84, v24
    v_add_u32 v9, 77824, v8
    s_mul_i32 s84, s61, -19456
    s_add_u32 s84, s84, 26624
    v_add_u32 v10, s84, v24
    v_add_u32 v11, 77824, v10
    v_lshrrev_b32 v24, 5, v0
    v_mul_u32_u24 v24, 11264, v24
    v_and_b32 v26, 1, v22
    v_bfe_u32 v25, v0, 2, 2
    v_lshl_add_u32 v25, v26, 3, v25
    v_lshl_add_u32 v24, v25, 6, v24
    v_and_b32 v25, 1, v0
    v_lshl_add_u32 v24, v25, 3, v24
    v_bfe_u32 v27, v0, 1, 1
    v_lshlrev_b32 v26, 1, v26
    s_mul_i32 s84, s62, 5120
    s_add_u32 s84, s84, 16384
    v_add_u32 v24, s84, v24
    v_add_u32 v25, 0, v27
    v_xor_b32 v25, v25, v26
    v_lshl_add_u32 v12, v25, 4, v24
    v_add_u32 v13, 77824, v12
    v_add_u32 v25, 2, v27
    v_xor_b32 v25, v25, v26
    v_lshl_add_u32 v14, v25, 4, v24
    v_add_u32 v15, 77824, v14
    v_mov_b32 v28, 0
    v_mov_b32 v29, 0
    v_mov_b32 v30, 0
    v_mov_b32 v31, 0
    s_cmp_eq_u32 s62, 1
    s_cbranch_scc1 L_early1
    v_mfma_f32_32x32x16_bf16 a[128:143], v[28:31], v[28:31], 0
    v_mfma_f32_32x32x16_bf16 a[144:159], v[28:31], v[28:31], 0
    v_mfma_f32_32x32x16_bf16 a[160:175], v[28:31], v[28:31], 0
    v_mfma_f32_32x32x16_bf16 a[176:191], v[28:31], v[28:31], 0
    v_mfma_f32_32x32x16_bf16 a[192:207], v[28:31], v[28:31], 0
    v_mfma_f32_32x32x16_bf16 a[208:223], v[28:31], v[28:31], 0
    v_mfma_f32_32x32x16_bf16 a[224:239], v[28:31], v[28:31], 0
    v_mfma_f32_32x32x16_bf16 a[240:255], v[28:31], v[28:31], 0
    v_mfma_f32_32x32x16_bf16 v[128:143], v[28:31], v[28:31], 0
    v_mfma_f32_32x32x16_bf16 v[144:159], v[28:31], v[28:31], 0
    v_mfma_f32_32x32x16_bf16 v[160:175], v[28:31], v[28:31], 0
    v_mfma_f32_32x32x16_bf16 v[176:191], v[28:31], v[28:31], 0
    v_mfma_f32_32x32x16_bf16 v[192:207], v[28:31], v[28:31], 0
    v_mfma_f32_32x32x16_bf16 v[208:223], v[28:31], v[28:31], 0
    v_mfma_f32_32x32x16_bf16 v[224:239], v[28:31], v[28:31], 0
    v_mfma_f32_32x32x16_bf16 v[240:255], v[28:31], v[28:31], 0
    s_waitcnt vmcnt(3)
    s_branch L_ln
L_early1:
    v_mfma_f32_32x32x16_bf16 a[128:143], v[28:31], v[28:31], 0
    v_mfma_f32_32x32x16_bf16 a[144:159], v[28:31], v[28:31], 0
    v_mfma_f32_32x32x16_bf16 a[160:175], v[28:31], v[28:31], 0
    v_mfma_f32_32x32x16_bf16 a[176:191], v[28:31], v[28:31], 0
    v_mfma_f32_32x32x16_bf16 a[192:207], v[28:31], v[28:31], 0
    v_mfma_f32_32x32x16_bf16 a[208:223], v[28:31], v[28:31], 0
    v_mfma_f32_32x32x16_bf16 a[224:239], v[28:31], v[28:31], 0
    v_mfma_f32_32x32x16_bf16 a[240:255], v[28:31], v[28:31], 0
    v_mfma_f32_32x32x16_bf16 v[128:143], v[28:31], v[28:31], 0
    v_mfma_f32_32x32x16_bf16 v[144:159], v[28:31], v[28:31], 0
    v_mfma_f32_32x32x16_bf16 v[160:175], v[28:31], v[28:31], 0
    v_mfma_f32_32x32x16_bf16 v[176:191], v[28:31], v[28:31], 0
    v_mfma_f32_32x32x16_bf16 v[192:207], v[28:31], v[28:31], 0
    v_mfma_f32_32x32x16_bf16 v[208:223], v[28:31], v[28:31], 0
    v_mfma_f32_32x32x16_bf16 v[224:239], v[28:31], v[28:31], 0
    v_mfma_f32_32x32x16_bf16 v[240:255], v[28:31], v[28:31], 0
    s_waitcnt vmcnt(3)
L_ln:
    v_lshlrev_b32 v64, 16, v48
    v_and_b32 v65, 0xffff0000, v48
    v_lshlrev_b32 v66, 16, v49
    v_and_b32 v67, 0xffff0000, v49
    v_lshlrev_b32 v68, 16, v50
    v_and_b32 v69, 0xffff0000, v50
    v_lshlrev_b32 v70, 16, v51
    v_and_b32 v71, 0xffff0000, v51
    v_lshlrev_b32 v72, 16, v52
    v_and_b32 v73, 0xffff0000, v52
    v_lshlrev_b32 v74, 16, v53
    v_and_b32 v75, 0xffff0000, v53
    v_lshlrev_b32 v76, 16, v54
    v_and_b32 v77, 0xffff0000, v54
    v_lshlrev_b32 v78, 16, v55
    v_and_b32 v79, 0xffff0000, v55
    v_lshlrev_b32 v80, 16, v56
    v_and_b32 v81, 0xffff0000, v56
    v_lshlrev_b32 v82, 16, v57
    v_and_b32 v83, 0xffff0000, v57
    v_lshlrev_b32 v84, 16, v58
    v_and_b32 v85, 0xffff0000, v58
    v_lshlrev_b32 v86, 16, v59
    v_and_b32 v87, 0xffff0000, v59
    v_lshlrev_b32 v88, 16, v60
    v_and_b32 v89, 0xffff0000, v60
    v_lshlrev_b32 v90, 16, v61
    v_and_b32 v91, 0xffff0000, v61
    v_lshlrev_b32 v92, 16, v62
    v_and_b32 v93, 0xffff0000, v62
    v_lshlrev_b32 v94, 16, v63
    v_and_b32 v95, 0xffff0000, v63
    v_pk_add_f32 v[96:97], v[64:65], v[66:67]
    v_pk_add_f32 v[98:99], v[80:81], v[82:83]
    v_pk_add_f32 v[96:97], v[96:97], v[68:69]
    v_pk_add_f32 v[98:99], v[98:99], v[84:85]
    v_pk_add_f32 v[96:97], v[96:97], v[70:71]
    v_pk_add_f32 v[98:99], v[98:99], v[86:87]
    v_pk_add_f32 v[96:97], v[96:97], v[72:73]
    v_pk_add_f32 v[98:99], v[98:99], v[88:89]
    v_pk_add_f32 v[96:97], v[96:97], v[74:75]
    v_pk_add_f32 v[98:99], v[98:99], v[90:91]
    v_pk_add_f32 v[96:97], v[96:97], v[76:77]
    v_pk_add_f32 v[98:99], v[98:99], v[92:93]
    v_pk_add_f32 v[96:97], v[96:97], v[78:79]
    v_pk_add_f32 v[98:99], v[98:99], v[94:95]
    v_add_f32 v102, v96, v97
    v_add_f32 v103, v98, v99
    s_nop 1
    v_permlane32_swap_b32 v102, v103
    v_add_f32 v102, v102, v103
    v_mov_b32 v100, v102
    s_nop 1
    v_permlane16_swap_b32 v102, v100
    v_add_f32 v102, v102, v100
    s_nop 1
    v_add_f32_dpp v102, v102, v102 quad_perm:[1,0,3,2] row_mask:0xf bank_mask:0xf
    s_nop 1
    v_add_f32_dpp v102, v102, v102 quad_perm:[2,3,0,1] row_mask:0xf bank_mask:0xf
    s_nop 1
    v_add_f32_dpp v102, v102, v102 row_half_mirror row_mask:0xf bank_mask:0xf
    s_nop 1
    v_add_f32_dpp v102, v102, v102 row_mirror row_mask:0xf bank_mask:0xf
    v_mul_f32 v102, 0xba800000, v102
    v_cvt_pk_bf16_f32 v106, v102, v102
    v_lshlrev_b32 v106, 16, v106
    v_mov_b32 v103, v102
    s_nop 1
    v_permlane32_swap_b32 v102, v103
    v_mov_b32 v107, v106
    s_nop 1
    v_permlane32_swap_b32 v106, v107
    v_pk_add_f32 v[108:109], v[64:65], v[102:103] op_sel_hi:[1,0]
    v_pk_add_f32 v[110:111], v[80:81], v[102:103] op_sel:[0,1] op_sel_hi:[1,1]
    v_pk_mul_f32 v[96:97], v[108:109], v[108:109]
    v_pk_mul_f32 v[98:99], v[110:111], v[110:111]
    v_pk_add_f32 v[108:109], v[66:67], v[102:103] op_sel_hi:[1,0]
    v_pk_add_f32 v[110:111], v[82:83], v[102:103] op_sel:[0,1] op_sel_hi:[1,1]
    v_pk_fma_f32 v[96:97], v[108:109], v[108:109], v[96:97]
    v_pk_fma_f32 v[98:99], v[110:111], v[110:111], v[98:99]
    v_pk_add_f32 v[108:109], v[68:69], v[102:103] op_sel_hi:[1,0]
    v_pk_add_f32 v[110:111], v[84:85], v[102:103] op_sel:[0,1] op_sel_hi:[1,1]
    v_pk_fma_f32 v[96:97], v[108:109], v[108:109], v[96:97]
    v_pk_fma_f32 v[98:99], v[110:111], v[110:111], v[98:99]
    v_pk_add_f32 v[108:109], v[70:71], v[102:103] op_sel_hi:[1,0]
    v_pk_add_f32 v[110:111], v[86:87], v[102:103] op_sel:[0,1] op_sel_hi:[1,1]
    v_pk_fma_f32 v[96:97], v[108:109], v[108:109], v[96:97]
    v_pk_fma_f32 v[98:99], v[110:111], v[110:111], v[98:99]
    v_pk_add_f32 v[108:109], v[72:73], v[102:103] op_sel_hi:[1,0]
    v_pk_add_f32 v[110:111], v[88:89], v[102:103] op_sel:[0,1] op_sel_hi:[1,1]
    v_pk_fma_f32 v[96:97], v[108:109], v[108:109], v[96:97]
    v_pk_fma_f32 v[98:99], v[110:111], v[110:111], v[98:99]
    v_pk_add_f32 v[108:109], v[74:75], v[102:103] op_sel_hi:[1,0]
    v_pk_add_f32 v[110:111], v[90:91], v[102:103] op_sel:[0,1] op_sel_hi:[1,1]
    v_pk_fma_f32 v[96:97], v[108:109], v[108:109], v[96:97]
    v_pk_fma_f32 v[98:99], v[110:111], v[110:111], v[98:99]
    v_pk_add_f32 v[108:109], v[76:77], v[102:103] op_sel_hi:[1,0]
    v_pk_add_f32 v[110:111], v[92:93], v[102:103] op_sel:[0,1] op_sel_hi:[1,1]
    v_pk_fma_f32 v[96:97], v[108:109], v[108:109], v[96:97]
    v_pk_fma_f32 v[98:99], v[110:111], v[110:111], v[98:99]
    v_pk_add_f32 v[108:109], v[78:79], v[102:103] op_sel_hi:[1,0]
    v_pk_add_f32 v[110:111], v[94:95], v[102:103] op_sel:[0,1] op_sel_hi:[1,1]
    v_pk_fma_f32 v[96:97], v[108:109], v[108:109], v[96:97]
    v_pk_fma_f32 v[98:99], v[110:111], v[110:111], v[98:99]
    v_add_f32 v104, v96, v97
    v_add_f32 v105, v98, v99
    s_nop 1
    v_permlane32_swap_b32 v104, v105
    v_add_f32 v104, v104, v105
    v_mov_b32 v100, v104
    s_nop 1
    v_permlane16_swap_b32 v104, v100
    v_add_f32 v104, v104, v100
    s_nop 1
    v_add_f32_dpp v104, v104, v104 quad_perm:[1,0,3,2] row_mask:0xf bank_mask:0xf
    s_nop 1
    v_add_f32_dpp v104, v104, v104 quad_perm:[2,3,0,1] row_mask:0xf bank_mask:0xf
    s_nop 1
    v_add_f32_dpp v104, v104, v104 row_half_mirror row_mask:0xf bank_mask:0xf
    s_nop 1
    v_add_f32_dpp v104, v104, v104 row_mirror row_mask:0xf bank_mask:0xf
    v_mul_f32 v104, 0x3a800000, v104
    v_cvt_pk_bf16_f32 v104, v104, v104
    v_lshlrev_b32 v104, 16, v104
    v_add_f32 v104, 0x3727c5ac, v104
    v_cvt_pk_bf16_f32 v104, v104, v104
    v_lshlrev_b32 v104, 16, v104
    v_sqrt_f32 v104, v104
    s_nop 0
    v_cvt_pk_bf16_f32 v104, v104, v104
    v_lshlrev_b32 v104, 16, v104
    v_rcp_f32 v100, v104
    s_nop 0
    v_fma_f32 v104, -v104, v100, 1.0
    v_fma_f32 v104, v104, v100, v100
    v_mov_b32 v105, v104
    s_nop 1
    v_permlane32_swap_b32 v104, v105
    v_pk_add_f32 v[64:65], v[64:65], v[106:107] op_sel_hi:[1,0]
    v_pk_add_f32 v[66:67], v[66:67], v[106:107] op_sel_hi:[1,0]
    v_pk_add_f32 v[68:69], v[68:69], v[106:107] op_sel_hi:[1,0]
    v_pk_add_f32 v[70:71], v[70:71], v[106:107] op_sel_hi:[1,0]
    v_cvt_pk_bf16_f32 v65, v64, v65
    v_cvt_pk_bf16_f32 v67, v66, v67
    v_cvt_pk_bf16_f32 v69, v68, v69
    v_cvt_pk_bf16_f32 v71, v70, v71
    v_lshlrev_b32 v64, 16, v65
    v_and_b32 v65, 0xffff0000, v65
    v_lshlrev_b32 v66, 16, v67
    v_and_b32 v67, 0xffff0000, v67
    v_lshlrev_b32 v68, 16, v69
    v_and_b32 v69, 0xffff0000, v69
    v_lshlrev_b32 v70, 16, v71
    v_and_b32 v71, 0xffff0000, v71
    v_pk_mul_f32 v[64:65], v[64:65], v[104:105] op_sel_hi:[1,0]
    v_pk_mul_f32 v[66:67], v[66:67], v[104:105] op_sel_hi:[1,0]
    v_pk_mul_f32 v[68:69], v[68:69], v[104:105] op_sel_hi:[1,0]
    v_pk_mul_f32 v[70:71], v[70:71], v[104:105] op_sel_hi:[1,0]
    s_waitcnt vmcnt(0)
    v_cvt_pk_bf16_f32 v48, v64, v65
    v_cvt_pk_bf16_f32 v49, v66, v67
    v_cvt_pk_bf16_f32 v50, v68, v69
    v_cvt_pk_bf16_f32 v51, v70, v71
    global_store_dwordx4 v36, v[48:51], s[26:27] offset:0 sc1
    v_pk_add_f32 v[72:73], v[72:73], v[106:107] op_sel_hi:[1,0]
    v_pk_add_f32 v[74:75], v[74:75], v[106:107] op_sel_hi:[1,0]
    v_pk_add_f32 v[76:77], v[76:77], v[106:107] op_sel_hi:[1,0]
    v_pk_add_f32 v[78:79], v[78:79], v[106:107] op_sel_hi:[1,0]
    v_cvt_pk_bf16_f32 v73, v72, v73
    v_cvt_pk_bf16_f32 v75, v74, v75
    v_cvt_pk_bf16_f32 v77, v76, v77
    v_cvt_pk_bf16_f32 v79, v78, v79
    v_lshlrev_b32 v72, 16, v73
    v_and_b32 v73, 0xffff0000, v73
    v_lshlrev_b32 v74, 16, v75
    v_and_b32 v75, 0xffff0000, v75
    v_lshlrev_b32 v76, 16, v77
    v_and_b32 v77, 0xffff0000, v77
    v_lshlrev_b32 v78, 16, v79
    v_and_b32 v79, 0xffff0000, v79
    v_pk_mul_f32 v[72:73], v[72:73], v[104:105] op_sel_hi:[1,0]
    v_pk_mul_f32 v[74:75], v[74:75], v[104:105] op_sel_hi:[1,0]
    v_pk_mul_f32 v[76:77], v[76:77], v[104:105] op_sel_hi:[1,0]
    v_pk_mul_f32 v[78:79], v[78:79], v[104:105] op_sel_hi:[1,0]
    v_cvt_pk_bf16_f32 v52, v72, v73
    v_cvt_pk_bf16_f32 v53, v74, v75
    v_cvt_pk_bf16_f32 v54, v76, v77
    v_cvt_pk_bf16_f32 v55, v78, v79
    global_store_dwordx4 v36, v[52:55], s[26:27] offset:1024 sc1
    v_pk_add_f32 v[80:81], v[80:81], v[106:107] op_sel:[0,1] op_sel_hi:[1,1]
    v_pk_add_f32 v[82:83], v[82:83], v[106:107] op_sel:[0,1] op_sel_hi:[1,1]
    v_pk_add_f32 v[84:85], v[84:85], v[106:107] op_sel:[0,1] op_sel_hi:[1,1]
    v_pk_add_f32 v[86:87], v[86:87], v[106:107] op_sel:[0,1] op_sel_hi:[1,1]
    v_cvt_pk_bf16_f32 v81, v80, v81
    v_cvt_pk_bf16_f32 v83, v82, v83
    v_cvt_pk_bf16_f32 v85, v84, v85
    v_cvt_pk_bf16_f32 v87, v86, v87
    v_lshlrev_b32 v80, 16, v81
    v_and_b32 v81, 0xffff0000, v81
    v_lshlrev_b32 v82, 16, v83
    v_and_b32 v83, 0xffff0000, v83
    v_lshlrev_b32 v84, 16, v85
    v_and_b32 v85, 0xffff0000, v85
    v_lshlrev_b32 v86, 16, v87
    v_and_b32 v87, 0xffff0000, v87
    v_pk_mul_f32 v[80:81], v[80:81], v[104:105] op_sel:[0,1] op_sel_hi:[1,1]
    v_pk_mul_f32 v[82:83], v[82:83], v[104:105] op_sel:[0,1] op_sel_hi:[1,1]
    v_pk_mul_f32 v[84:85], v[84:85], v[104:105] op_sel:[0,1] op_sel_hi:[1,1]
    v_pk_mul_f32 v[86:87], v[86:87], v[104:105] op_sel:[0,1] op_sel_hi:[1,1]
    v_cvt_pk_bf16_f32 v56, v80, v81
    v_cvt_pk_bf16_f32 v57, v82, v83
    v_cvt_pk_bf16_f32 v58, v84, v85
    v_cvt_pk_bf16_f32 v59, v86, v87
    global_store_dwordx4 v36, v[56:59], s[26:27] offset:2048 sc1
    v_pk_add_f32 v[88:89], v[88:89], v[106:107] op_sel:[0,1] op_sel_hi:[1,1]
    v_pk_add_f32 v[90:91], v[90:91], v[106:107] op_sel:[0,1] op_sel_hi:[1,1]
    v_pk_add_f32 v[92:93], v[92:93], v[106:107] op_sel:[0,1] op_sel_hi:[1,1]
    v_pk_add_f32 v[94:95], v[94:95], v[106:107] op_sel:[0,1] op_sel_hi:[1,1]
    v_cvt_pk_bf16_f32 v89, v88, v89
    v_cvt_pk_bf16_f32 v91, v90, v91
    v_cvt_pk_bf16_f32 v93, v92, v93
    v_cvt_pk_bf16_f32 v95, v94, v95
    v_lshlrev_b32 v88, 16, v89
    v_and_b32 v89, 0xffff0000, v89
    v_lshlrev_b32 v90, 16, v91
    v_and_b32 v91, 0xffff0000, v91
    v_lshlrev_b32 v92, 16, v93
    v_and_b32 v93, 0xffff0000, v93
    v_lshlrev_b32 v94, 16, v95
    v_and_b32 v95, 0xffff0000, v95
    v_pk_mul_f32 v[88:89], v[88:89], v[104:105] op_sel:[0,1] op_sel_hi:[1,1]
    v_pk_mul_f32 v[90:91], v[90:91], v[104:105] op_sel:[0,1] op_sel_hi:[1,1]
    v_pk_mul_f32 v[92:93], v[92:93], v[104:105] op_sel:[0,1] op_sel_hi:[1,1]
    v_pk_mul_f32 v[94:95], v[94:95], v[104:105] op_sel:[0,1] op_sel_hi:[1,1]
    v_cvt_pk_bf16_f32 v60, v88, v89
    v_cvt_pk_bf16_f32 v61, v90, v91
    v_cvt_pk_bf16_f32 v62, v92, v93
    v_cvt_pk_bf16_f32 v63, v94, v95
    global_store_dwordx4 v36, v[60:63], s[26:27] offset:3072 sc1
    v_add_u32 v40, 1, v40
    s_waitcnt vmcnt(0)
    s_mov_b64 exec, 1
    global_store_dword v37, v40, s[26:27] sc1
    s_mov_b64 exec, -1
    buffer_load_dword v7, v42, s[44:47], 0 offen
    v_add_u32_e64 v42, s86, v42
    s_barrier
    v_mfma_f32_32x32x16_bf16 v[48:63], v[28:31], v[28:31], 0
    v_mfma_f32_32x32x16_bf16 v[64:79], v[28:31], v[28:31], 0
    v_mfma_f32_32x32x16_bf16 v[80:95], v[28:31], v[28:31], 0
    v_mfma_f32_32x32x16_bf16 v[96:111], v[28:31], v[28:31], 0
    v_mfma_f32_32x32x16_bf16 v[112:127], v[28:31], v[28:31], 0
    s_mov_b32 s67, 0
    s_cmp_lg_u32 s60, 3
    s_cbranch_scc1 L_noarr
    s_lshl_b32 s84, s63, 5
    v_mov_b32 v20, s84
    v_mov_b32 v21, 1
    s_mov_b64 exec, 1
    global_atomic_add v20, v21, s[24:25] sc1
    s_mov_b64 exec, -1
L_noarr:
    s_cmp_eq_u32 s62, 0
    s_cbranch_scc1 L_now
    s_add_u32 m0, s78, 0
    s_nop 0
    buffer_load_dwordx4 v2, s[32:35], s68 offen offset:0 lds
    buffer_load_dwordx4 v2, s[32:35], s69 offen offset:1024 lds
    buffer_load_dwordx4 v2, s[32:35], s70 offen offset:2048 lds
    v_add_u32 v2, 196608, v2
    buffer_load_dwordx4 v3, s[36:39], s71 offen offset:3072 lds
    s_add_u32 m0, s78, 4096
    s_nop 0
    buffer_load_dwordx4 v3, s[40:43], s72 offen offset:0 lds
    buffer_load_dwordx4 v3, s[36:39], s73 offen offset:1024 lds
    buffer_load_dwordx4 v3, s[40:43], s74 offen offset:2048 lds
    buffer_load_dwordx4 v3, s[36:39], s75 offen offset:3072 lds
    s_add_u32 m0, s78, 8192
    s_nop 0
    buffer_load_dwordx4 v3, s[40:43], s76 offen offset:0 lds
    v_add_u32 v3, 229376, v3
    global_load_lds_dwordx4 v[4:5], off offset:1024
    v_lshl_add_u64 v[4:5], v[4:5], 0, s[80:81]
    s_add_u32 m0, s78, 38912
    s_nop 0
    buffer_load_dwordx4 v2, s[32:35], s68 offen offset:0 lds
    buffer_load_dwordx4 v2, s[32:35], s69 offen offset:1024 lds
    buffer_load_dwordx4 v2, s[32:35], s70 offen offset:2048 lds
    v_add_u32 v2, 196608, v2
    buffer_load_dwordx4 v3, s[36:39], s71 offen offset:3072 lds
    s_add_u32 m0, s78, 43008
    s_nop 0
    buffer_load_dwordx4 v3, s[40:43], s72 offen offset:0 lds
    buffer_load_dwordx4 v3, s[36:39], s73 offen offset:1024 lds
    buffer_load_dwordx4 v3, s[40:43], s74 offen offset:2048 lds
    buffer_load_dwordx4 v3, s[36:39], s75 offen offset:3072 lds
    s_add_u32 m0, s78, 47104
    s_nop 0
    buffer_load_dwordx4 v3, s[40:43], s76 offen offset:0 lds
    v_add_u32 v3, 229376, v3
    global_load_lds_dwordx4 v[4:5], off offset:1024
    v_lshl_add_u64 v[4:5], v[4:5], 0, s[80:81]
    s_add_u32 m0, s78, 77824
    s_nop 0
    buffer_load_dwordx4 v2, s[32:35], s68 offen offset:0 lds
    buffer_load_dwordx4 v2, s[32:35], s69 offen offset:1024 lds
    buffer_load_dwordx4 v2, s[32:35], s70 offen offset:2048 lds
    v_add_u32 v2, 196608, v2
    buffer_load_dwordx4 v3, s[36:39], s71 offen offset:3072 lds
    s_add_u32 m0, s78, 81920
    s_nop 0
    buffer_load_dwordx4 v3, s[40:43], s72 offen offset:0 lds
    buffer_load_dwordx4 v3, s[36:39], s73 offen offset:1024 lds
    buffer_load_dwordx4 v3, s[40:43], s74 offen offset:2048 lds
    buffer_load_dwordx4 v3, s[36:39], s75 offen offset:3072 lds
    s_add_u32 m0, s78, 86016
    s_nop 0
    buffer_load_dwordx4 v3, s[40:43], s76 offen offset:0 lds
    v_add_u32 v3, 229376, v3
    global_load_lds_dwordx4 v[4:5], off offset:1024
    v_lshl_add_u64 v[4:5], v[4:5], 0, s[80:81]
    s_add_u32 m0, s78, 116736
    s_nop 0
    buffer_load_dwordx4 v2, s[32:35], s68 offen offset:0 lds
    buffer_load_dwordx4 v2, s[32:35], s69 offen offset:1024 lds
    buffer_load_dwordx4 v2, s[32:35], s70 offen offset:2048 lds
    v_add_u32 v2, 196608, v2
    buffer_load_dwordx4 v3, s[36:39], s71 offen offset:3072 lds
    s_add_u32 m0, s78, 120832
    s_nop 0
    buffer_load_dwordx4 v3, s[40:43], s72 offen offset:0 lds
    buffer_load_dwordx4 v3, s[36:39], s73 offen offset:1024 lds
    buffer_load_dwordx4 v3, s[40:43], s74 offen offset:2048 lds
    buffer_load_dwordx4 v3, s[36:39], s75 offen offset:3072 lds
    s_add_u32 m0, s78, 124928
    s_nop 0
    buffer_load_dwordx4 v3, s[40:43], s76 offen offset:0 lds
    v_add_u32 v3, 229376, v3
    global_load_lds_dwordx4 v[4:5], off offset:1024
    v_lshl_add_u64 v[4:5], v[4:5], 0, s[80:81]
L_now:
    s_cmp_eq_u32 s87, 1
    s_cbranch_scc1 L_lnok
L_lnpoll:
    global_load_dword v20, v38, s[26:27] sc1
    s_waitcnt vmcnt(0)
    v_cmp_ne_u32 vcc, v20, v39
    s_cmp_eq_u64 vcc, -1
    s_cbranch_scc1 L_lnok
    s_add_u32 s67, s67, 1
    s_and_b32 s84, s67, 3
    s_cbranch_scc1 L_lnpoll
    global_load_dword v20, v41, s[24:25] sc1
    s_waitcnt vmcnt(0)
    v_readfirstlane_b32 s84, v20
    s_cmp_ge_u32 s84, 32
    s_cbranch_scc1 L_lnok
    s_cmp_lt_u32 s67, 0x40000
    s_cbranch_scc1 L_lnpoll
L_lnok:
    s_cmp_eq_u32 s62, 1
    s_cbranch_scc1 L_g1_1
    v_mov_b32 v20, 0x7ff00000
    s_add_u32 m0, s78, 0
    s_nop 0
    buffer_load_dwordx4 v1, s[28:31], s68 offen offset:0 sc1 lds
    buffer_load_dwordx4 v1, s[28:31], s69 offen offset:1024 sc1 lds
    buffer_load_dwordx4 v1, s[28:31], s70 offen offset:2048 sc1 lds
    buffer_load_dwordx4 v1, s[28:31], s71 offen offset:3072 sc1 lds
    s_add_u32 m0, s78, 4096
    s_nop 0
    buffer_load_dwordx4 v1, s[28:31], s72 offen offset:0 sc1 lds
    buffer_load_dwordx4 v1, s[28:31], s73 offen offset:1024 sc1 lds
    buffer_load_dwordx4 v1, s[28:31], s74 offen offset:2048 sc1 lds
    buffer_load_dwordx4 v1, s[28:31], s75 offen offset:3072 sc1 lds
    v_add_u32_e64 v1, 64, v1
    buffer_load_dword v7, v20, s[44:47], 0 offen
    s_add_u32 m0, s78, 38912
    s_nop 0
    buffer_load_dwordx4 v1, s[28:31], s68 offen offset:0 sc1 lds
    buffer_load_dwordx4 v1, s[28:31], s69 offen offset:1024 sc1 lds
    buffer_load_dwordx4 v1, s[28:31], s70 offen offset:2048 sc1 lds
    buffer_load_dwordx4 v1, s[28:31], s71 offen offset:3072 sc1 lds
    s_add_u32 m0, s78, 43008
    s_nop 0
    buffer_load_dwordx4 v1, s[28:31], s72 offen offset:0 sc1 lds
    buffer_load_dwordx4 v1, s[28:31], s73 offen offset:1024 sc1 lds
    buffer_load_dwordx4 v1, s[28:31], s74 offen offset:2048 sc1 lds
    buffer_load_dwordx4 v1, s[28:31], s75 offen offset:3072 sc1 lds
    v_add_u32_e64 v1, 64, v1
    buffer_load_dword v7, v20, s[44:47], 0 offen
    s_add_u32 m0, s78, 77824
    s_nop 0
    buffer_load_dwordx4 v1, s[28:31], s68 offen offset:0 sc1 lds
    buffer_load_dwordx4 v1, s[28:31], s69 offen offset:1024 sc1 lds
    buffer_load_dwordx4 v1, s[28:31], s70 offen offset:2048 sc1 lds
    buffer_load_dwordx4 v1, s[28:31], s71 offen offset:3072 sc1 lds
    s_add_u32 m0, s78, 81920
    s_nop 0
    buffer_load_dwordx4 v1, s[28:31], s72 offen offset:0 sc1 lds
    buffer_load_dwordx4 v1, s[28:31], s73 offen offset:1024 sc1 lds
    buffer_load_dwordx4 v1, s[28:31], s74 offen offset:2048 sc1 lds
    buffer_load_dwordx4 v1, s[28:31], s75 offen offset:3072 sc1 lds
    v_add_u32_e64 v1, 64, v1
    buffer_load_dword v7, v20, s[44:47], 0 offen
    s_add_u32 m0, s78, 116736
    s_nop 0
    buffer_load_dwordx4 v1, s[28:31], s68 offen offset:0 sc1 lds
    buffer_load_dwordx4 v1, s[28:31], s69 offen offset:1024 sc1 lds
    buffer_load_dwordx4 v1, s[28:31], s70 offen offset:2048 sc1 lds
    buffer_load_dwordx4 v1, s[28:31], s71 offen offset:3072 sc1 lds
    s_add_u32 m0, s78, 120832
    s_nop 0
    buffer_load_dwordx4 v1, s[28:31], s72 offen offset:0 sc1 lds
    buffer_load_dwordx4 v1, s[28:31], s73 offen offset:1024 sc1 lds
    buffer_load_dwordx4 v1, s[28:31], s74 offen offset:2048 sc1 lds
    buffer_load_dwordx4 v1, s[28:31], s75 offen offset:3072 sc1 lds
    v_add_u32_e64 v1, 64, v1
    buffer_load_dword v7, v20, s[44:47], 0 offen
    s_waitcnt vmcnt(28)
    s_barrier
    ds_read_b64_tr_b16 a[64:65], v12 offset:0
    ds_read_b64_tr_b16 a[66:67], v12 offset:256
    ds_read_b64_tr_b16 a[68:69], v14 offset:0
    ds_read_b64_tr_b16 a[70:71], v14 offset:256
    ds_read_b64_tr_b16 a[72:73], v12 offset:1024
    ds_read_b64_tr_b16 a[74:75], v12 offset:1280
    ds_read_b64_tr_b16 a[76:77], v14 offset:1024
    ds_read_b64_tr_b16 a[78:79], v14 offset:1280
    ds_read_b64_tr_b16 a[80:81], v12 offset:2048
    ds_read_b64_tr_b16 a[82:83], v12 offset:2304
    ds_read_b64_tr_b16 a[84:85], v14 offset:2048
    ds_read_b64_tr_b16 a[86:87], v14 offset:2304
    ds_read_b64_tr_b16 a[88:89], v12 offset:3072
    ds_read_b64_tr_b16 a[90:91], v12 offset:3328
    ds_read_b64_tr_b16 a[92:93], v14 offset:3072
    ds_read_b64_tr_b16 a[94:95], v14 offset:3328
    ds_read_b64_tr_b16 a[96:97], v12 offset:4096
    ds_read_b64_tr_b16 a[98:99], v12 offset:4352
    ds_read_b64_tr_b16 a[100:101], v14 offset:4096
    ds_read_b64_tr_b16 a[102:103], v14 offset:4352
    ds_read_b128 a[0:3], v8 offset:0
    ds_read_b128 a[4:7], v8 offset:1024
    ds_read_b128 a[8:11], v8 offset:2048
    ds_read_b128 a[12:15], v8 offset:3072
    ds_read_b128 a[16:19], v8 offset:4096
    ds_read_b128 a[20:23], v8 offset:5120
    ds_read_b128 a[24:27], v8 offset:6144
    ds_read_b128 a[28:31], v8 offset:7168
    ds_read_b128 a[112:115], v10 offset:0
    s_mov_b32 s67, 7
    v_mov_b32 v20, 0x7ff00000
.p2align 3
L_loop0:
    s_waitcnt vmcnt(19) lgkmcnt(0)
    s_barrier
    v_mfma_f32_16x16x32_bf16 a[128:131], a[64:67], a[0:3], a[128:131]
    s_add_u32 m0, s78, 0
    v_mfma_f32_16x16x32_bf16 a[136:139], a[64:67], a[4:7], a[136:139]
    buffer_load_dwordx4 v1, s[28:31], s68 offen offset:0 sc1 lds
    v_mfma_f32_16x16x32_bf16 a[144:147], a[64:67], a[8:11], a[144:147]
    ds_read_b128 a[32:35], v8 offset:38912
    v_mfma_f32_16x16x32_bf16 a[152:155], a[64:67], a[12:15], a[152:155]
    v_mfma_f32_16x16x32_bf16 a[160:163], a[64:67], a[16:19], a[160:163]
    v_mfma_f32_16x16x32_bf16 a[168:171], a[64:67], a[20:23], a[168:171]
    v_mfma_f32_16x16x32_bf16 a[176:179], a[64:67], a[24:27], a[176:179]
    ds_read_b128 a[36:39], v8 offset:39936
    v_mfma_f32_16x16x32_bf16 a[184:187], a[64:67], a[28:31], a[184:187]
    v_mfma_f32_16x16x32_bf16 v[120:123], a[64:67], a[112:115], v[120:123]
    ds_read_b64_tr_b16 a[64:65], v12 offset:38912
    v_mfma_f32_16x16x32_bf16 a[132:135], a[68:71], a[0:3], a[132:135]
    ds_read_b64_tr_b16 a[66:67], v12 offset:39168
    buffer_load_dwordx4 v1, s[28:31], s69 offen offset:1024 sc1 lds
    v_mfma_f32_16x16x32_bf16 a[140:143], a[68:71], a[4:7], a[140:143]
    ds_read_b128 a[40:43], v8 offset:40960
    v_mfma_f32_16x16x32_bf16 a[148:151], a[68:71], a[8:11], a[148:151]
    v_mfma_f32_16x16x32_bf16 a[156:159], a[68:71], a[12:15], a[156:159]
    v_mfma_f32_16x16x32_bf16 a[164:167], a[68:71], a[16:19], a[164:167]
    v_mfma_f32_16x16x32_bf16 a[172:175], a[68:71], a[20:23], a[172:175]
    ds_read_b128 a[44:47], v8 offset:41984
    v_mfma_f32_16x16x32_bf16 a[180:183], a[68:71], a[24:27], a[180:183]
    v_mfma_f32_16x16x32_bf16 a[188:191], a[68:71], a[28:31], a[188:191]
    v_mfma_f32_16x16x32_bf16 v[124:127], a[68:71], a[112:115], v[124:127]
    ds_read_b64_tr_b16 a[68:69], v14 offset:38912
    buffer_load_dwordx4 v1, s[28:31], s70 offen offset:2048 sc1 lds
    v_mfma_f32_16x16x32_bf16 v[52:55], a[0:3], a[72:75], v[52:55]
    ds_read_b64_tr_b16 a[70:71], v14 offset:39168
    v_mfma_f32_16x16x32_bf16 v[56:59], a[4:7], a[72:75], v[56:59]
    v_mfma_f32_16x16x32_bf16 v[60:63], a[8:11], a[72:75], v[60:63]
    ds_read_b128 a[48:51], v8 offset:43008
    v_mfma_f32_16x16x32_bf16 v[64:67], a[12:15], a[72:75], v[64:67]
    v_mfma_f32_16x16x32_bf16 v[68:71], a[16:19], a[72:75], v[68:71]
    ds_read_b128 a[52:55], v8 offset:44032
    v_mfma_f32_16x16x32_bf16 v[72:75], a[20:23], a[72:75], v[72:75]
    v_mfma_f32_16x16x32_bf16 v[76:79], a[24:27], a[72:75], v[76:79]
    v_mfma_f32_16x16x32_bf16 v[80:83], a[28:31], a[72:75], v[80:83]
    buffer_load_dwordx4 v1, s[28:31], s71 offen offset:3072 sc1 lds
    v_mfma_f32_16x16x32_bf16 v[48:51], a[112:115], a[72:75], v[48:51]
    ds_read_b64_tr_b16 a[72:73], v12 offset:39936
    v_mfma_f32_16x16x32_bf16 v[88:91], a[0:3], a[76:79], v[88:91]
    ds_read_b64_tr_b16 a[74:75], v12 offset:40192
    v_mfma_f32_16x16x32_bf16 v[92:95], a[4:7], a[76:79], v[92:95]
    ds_read_b128 a[56:59], v8 offset:45056
    v_mfma_f32_16x16x32_bf16 v[96:99], a[8:11], a[76:79], v[96:99]
    v_mfma_f32_16x16x32_bf16 v[100:103], a[12:15], a[76:79], v[100:103]
    ds_read_b128 a[60:63], v8 offset:46080
    v_mfma_f32_16x16x32_bf16 v[104:107], a[16:19], a[76:79], v[104:107]
    v_mfma_f32_16x16x32_bf16 v[108:111], a[20:23], a[76:79], v[108:111]
    s_add_u32 m0, s78, 4096
    v_mfma_f32_16x16x32_bf16 v[112:115], a[24:27], a[76:79], v[112:115]
    buffer_load_dwordx4 v1, s[28:31], s72 offen offset:0 sc1 lds
    v_mfma_f32_16x16x32_bf16 v[116:119], a[28:31], a[76:79], v[116:119]
    ds_read_b128 a[116:119], v10 offset:38912
    v_mfma_f32_16x16x32_bf16 v[84:87], a[112:115], a[76:79], v[84:87]
    ds_read_b64_tr_b16 a[76:77], v14 offset:39936
    v_mfma_f32_16x16x32_bf16 a[192:195], a[80:83], a[0:3], a[192:195]
    ds_read_b64_tr_b16 a[78:79], v14 offset:40192
    v_mfma_f32_16x16x32_bf16 a[200:203], a[80:83], a[4:7], a[200:203]
    v_mfma_f32_16x16x32_bf16 a[208:211], a[80:83], a[8:11], a[208:211]
    ds_read_b64_tr_b16 a[104:105], v12 offset:43008
    v_mfma_f32_16x16x32_bf16 a[216:219], a[80:83], a[12:15], a[216:219]
    v_mfma_f32_16x16x32_bf16 a[224:227], a[80:83], a[16:19], a[224:227]
    v_mfma_f32_16x16x32_bf16 a[232:235], a[80:83], a[20:23], a[232:235]
    buffer_load_dwordx4 v1, s[28:31], s73 offen offset:1024 sc1 lds
    v_mfma_f32_16x16x32_bf16 a[240:243], a[80:83], a[24:27], a[240:243]
    ds_read_b64_tr_b16 a[106:107], v12 offset:43264
    v_mfma_f32_16x16x32_bf16 a[248:251], a[80:83], a[28:31], a[248:251]
    ds_read_b64_tr_b16 a[80:81], v12 offset:40960
    v_mfma_f32_16x16x32_bf16 a[196:199], a[84:87], a[0:3], a[196:199]
    ds_read_b64_tr_b16 a[82:83], v12 offset:41216
    v_mfma_f32_16x16x32_bf16 a[204:207], a[84:87], a[4:7], a[204:207]
    v_mfma_f32_16x16x32_bf16 a[212:215], a[84:87], a[8:11], a[212:215]
    ds_read_b64_tr_b16 a[108:109], v14 offset:43008
    v_mfma_f32_16x16x32_bf16 a[220:223], a[84:87], a[12:15], a[220:223]
    v_mfma_f32_16x16x32_bf16 a[228:231], a[84:87], a[16:19], a[228:231]
    v_mfma_f32_16x16x32_bf16 a[236:239], a[84:87], a[20:23], a[236:239]
    buffer_load_dwordx4 v1, s[28:31], s74 offen offset:2048 sc1 lds
    v_mfma_f32_16x16x32_bf16 a[244:247], a[84:87], a[24:27], a[244:247]
    ds_read_b64_tr_b16 a[110:111], v14 offset:43264
    v_mfma_f32_16x16x32_bf16 a[252:255], a[84:87], a[28:31], a[252:255]
    ds_read_b64_tr_b16 a[84:85], v14 offset:40960
    v_mfma_f32_16x16x32_bf16 v[128:131], a[88:91], a[0:3], v[128:131]
    ds_read_b64_tr_b16 a[86:87], v14 offset:41216
    v_mfma_f32_16x16x32_bf16 v[144:147], a[88:91], a[4:7], v[144:147]
    v_mfma_f32_16x16x32_bf16 v[160:163], a[88:91], a[8:11], v[160:163]
    v_mfma_f32_16x16x32_bf16 v[176:179], a[88:91], a[12:15], v[176:179]
    v_mfma_f32_16x16x32_bf16 v[192:195], a[88:91], a[16:19], v[192:195]
    v_mfma_f32_16x16x32_bf16 v[208:211], a[88:91], a[20:23], v[208:211]
    buffer_load_dwordx4 v1, s[28:31], s75 offen offset:3072 sc1 lds
    v_add_u32_e64 v1, 64, v1
    v_mfma_f32_16x16x32_bf16 v[224:227], a[88:91], a[24:27], v[224:227]
    v_mfma_f32_16x16x32_bf16 v[240:243], a[88:91], a[28:31], v[240:243]
    ds_read_b64_tr_b16 a[88:89], v12 offset:41984
    v_mfma_f32_16x16x32_bf16 v[132:135], a[92:95], a[0:3], v[132:135]
    ds_read_b64_tr_b16 a[90:91], v12 offset:42240
    v_mfma_f32_16x16x32_bf16 v[148:151], a[92:95], a[4:7], v[148:151]
    v_mfma_f32_16x16x32_bf16 v[164:167], a[92:95], a[8:11], v[164:167]
    v_mfma_f32_16x16x32_bf16 v[180:183], a[92:95], a[12:15], v[180:183]
    buffer_load_dword v7, v6, s[44:47], s4 offen
    v_mfma_f32_16x16x32_bf16 v[196:199], a[92:95], a[16:19], v[196:199]
    v_mfma_f32_16x16x32_bf16 v[212:215], a[92:95], a[20:23], v[212:215]
    v_mfma_f32_16x16x32_bf16 v[228:231], a[92:95], a[24:27], v[228:231]
    v_mfma_f32_16x16x32_bf16 v[244:247], a[92:95], a[28:31], v[244:247]
    ds_read_b64_tr_b16 a[92:93], v14 offset:41984
    v_mfma_f32_16x16x32_bf16 v[136:139], a[96:99], a[0:3], v[136:139]
    ds_read_b64_tr_b16 a[94:95], v14 offset:42240
    v_mfma_f32_16x16x32_bf16 v[152:155], a[96:99], a[4:7], v[152:155]
    v_mfma_f32_16x16x32_bf16 v[168:171], a[96:99], a[8:11], v[168:171]
    v_mfma_f32_16x16x32_bf16 v[184:187], a[96:99], a[12:15], v[184:187]
    v_mfma_f32_16x16x32_bf16 v[200:203], a[96:99], a[16:19], v[200:203]
    v_mfma_f32_16x16x32_bf16 v[216:219], a[96:99], a[20:23], v[216:219]
    v_mfma_f32_16x16x32_bf16 v[232:235], a[96:99], a[24:27], v[232:235]
    v_mfma_f32_16x16x32_bf16 v[248:251], a[96:99], a[28:31], v[248:251]
    v_mfma_f32_16x16x32_bf16 v[140:143], a[100:103], a[0:3], v[140:143]
    v_mfma_f32_16x16x32_bf16 v[156:159], a[100:103], a[4:7], v[156:159]
    v_mfma_f32_16x16x32_bf16 v[172:175], a[100:103], a[8:11], v[172:175]
    v_mfma_f32_16x16x32_bf16 v[188:191], a[100:103], a[12:15], v[188:191]
    v_mfma_f32_16x16x32_bf16 v[204:207], a[100:103], a[16:19], v[204:207]
    v_mfma_f32_16x16x32_bf16 v[220:223], a[100:103], a[20:23], v[220:223]
    v_mfma_f32_16x16x32_bf16 v[236:239], a[100:103], a[24:27], v[236:239]
    v_mfma_f32_16x16x32_bf16 v[252:255], a[100:103], a[28:31], v[252:255]
    s_waitcnt vmcnt(19) lgkmcnt(0)
    s_barrier
    v_mfma_f32_16x16x32_bf16 a[128:131], a[64:67], a[32:35], a[128:131]
    s_add_u32 m0, s78, 38912
    v_mfma_f32_16x16x32_bf16 a[136:139], a[64:67], a[36:39], a[136:139]
    buffer_load_dwordx4 v1, s[28:31], s68 offen offset:0 sc1 lds
    v_mfma_f32_16x16x32_bf16 a[144:147], a[64:67], a[40:43], a[144:147]
    ds_read_b128 a[0:3], v9 offset:0
    v_mfma_f32_16x16x32_bf16 a[152:155], a[64:67], a[44:47], a[152:155]
    v_mfma_f32_16x16x32_bf16 a[160:163], a[64:67], a[48:51], a[160:163]
    v_mfma_f32_16x16x32_bf16 a[168:171], a[64:67], a[52:55], a[168:171]
    v_mfma_f32_16x16x32_bf16 a[176:179], a[64:67], a[56:59], a[176:179]
    ds_read_b128 a[4:7], v9 offset:1024
    v_mfma_f32_16x16x32_bf16 a[184:187], a[64:67], a[60:63], a[184:187]
    v_mfma_f32_16x16x32_bf16 v[120:123], a[64:67], a[116:119], v[120:123]
    ds_read_b64_tr_b16 a[64:65], v13 offset:0
    v_mfma_f32_16x16x32_bf16 a[132:135], a[68:71], a[32:35], a[132:135]
    ds_read_b64_tr_b16 a[66:67], v13 offset:256
    buffer_load_dwordx4 v1, s[28:31], s69 offen offset:1024 sc1 lds
    v_mfma_f32_16x16x32_bf16 a[140:143], a[68:71], a[36:39], a[140:143]
    ds_read_b128 a[8:11], v9 offset:2048
    v_mfma_f32_16x16x32_bf16 a[148:151], a[68:71], a[40:43], a[148:151]
    v_mfma_f32_16x16x32_bf16 a[156:159], a[68:71], a[44:47], a[156:159]
    v_mfma_f32_16x16x32_bf16 a[164:167], a[68:71], a[48:51], a[164:167]
    v_mfma_f32_16x16x32_bf16 a[172:175], a[68:71], a[52:55], a[172:175]
    ds_read_b128 a[12:15], v9 offset:3072
    v_mfma_f32_16x16x32_bf16 a[180:183], a[68:71], a[56:59], a[180:183]
    v_mfma_f32_16x16x32_bf16 a[188:191], a[68:71], a[60:63], a[188:191]
    v_mfma_f32_16x16x32_bf16 v[124:127], a[68:71], a[116:119], v[124:127]
    ds_read_b64_tr_b16 a[68:69], v15 offset:0
    buffer_load_dwordx4 v1, s[28:31], s70 offen offset:2048 sc1 lds
    v_mfma_f32_16x16x32_bf16 v[52:55], a[32:35], a[72:75], v[52:55]
    ds_read_b64_tr_b16 a[70:71], v15 offset:256
    v_mfma_f32_16x16x32_bf16 v[56:59], a[36:39], a[72:75], v[56:59]
    v_mfma_f32_16x16x32_bf16 v[60:63], a[40:43], a[72:75], v[60:63]
    ds_read_b128 a[16:19], v9 offset:4096
    v_mfma_f32_16x16x32_bf16 v[64:67], a[44:47], a[72:75], v[64:67]
    v_mfma_f32_16x16x32_bf16 v[68:71], a[48:51], a[72:75], v[68:71]
    ds_read_b128 a[20:23], v9 offset:5120
    v_mfma_f32_16x16x32_bf16 v[72:75], a[52:55], a[72:75], v[72:75]
    v_mfma_f32_16x16x32_bf16 v[76:79], a[56:59], a[72:75], v[76:79]
    v_mfma_f32_16x16x32_bf16 v[80:83], a[60:63], a[72:75], v[80:83]
    buffer_load_dwordx4 v1, s[28:31], s71 offen offset:3072 sc1 lds
    v_mfma_f32_16x16x32_bf16 v[48:51], a[116:119], a[72:75], v[48:51]
    ds_read_b64_tr_b16 a[72:73], v13 offset:1024
    v_mfma_f32_16x16x32_bf16 v[88:91], a[32:35], a[76:79], v[88:91]
    ds_read_b64_tr_b16 a[74:75], v13 offset:1280
    v_mfma_f32_16x16x32_bf16 v[92:95], a[36:39], a[76:79], v[92:95]
    ds_read_b128 a[24:27], v9 offset:6144
    v_mfma_f32_16x16x32_bf16 v[96:99], a[40:43], a[76:79], v[96:99]
    v_mfma_f32_16x16x32_bf16 v[100:103], a[44:47], a[76:79], v[100:103]
    ds_read_b128 a[28:31], v9 offset:7168
    v_mfma_f32_16x16x32_bf16 v[104:107], a[48:51], a[76:79], v[104:107]
    v_mfma_f32_16x16x32_bf16 v[108:111], a[52:55], a[76:79], v[108:111]
    s_add_u32 m0, s78, 43008
    v_mfma_f32_16x16x32_bf16 v[112:115], a[56:59], a[76:79], v[112:115]
    buffer_load_dwordx4 v1, s[28:31], s72 offen offset:0 sc1 lds
    v_mfma_f32_16x16x32_bf16 v[116:119], a[60:63], a[76:79], v[116:119]
    ds_read_b128 a[112:115], v11 offset:0
    v_mfma_f32_16x16x32_bf16 v[84:87], a[116:119], a[76:79], v[84:87]
    ds_read_b64_tr_b16 a[76:77], v15 offset:1024
    v_mfma_f32_16x16x32_bf16 a[192:195], a[80:83], a[32:35], a[192:195]
    ds_read_b64_tr_b16 a[78:79], v15 offset:1280
    v_mfma_f32_16x16x32_bf16 a[200:203], a[80:83], a[36:39], a[200:203]
    v_mfma_f32_16x16x32_bf16 a[208:211], a[80:83], a[40:43], a[208:211]
    ds_read_b64_tr_b16 a[96:97], v13 offset:4096
    v_mfma_f32_16x16x32_bf16 a[216:219], a[80:83], a[44:47], a[216:219]
    v_mfma_f32_16x16x32_bf16 a[224:227], a[80:83], a[48:51], a[224:227]
    v_mfma_f32_16x16x32_bf16 a[232:235], a[80:83], a[52:55], a[232:235]
    buffer_load_dwordx4 v1, s[28:31], s73 offen offset:1024 sc1 lds
    v_mfma_f32_16x16x32_bf16 a[240:243], a[80:83], a[56:59], a[240:243]
    ds_read_b64_tr_b16 a[98:99], v13 offset:4352
    v_mfma_f32_16x16x32_bf16 a[248:251], a[80:83], a[60:63], a[248:251]
    ds_read_b64_tr_b16 a[80:81], v13 offset:2048
    v_mfma_f32_16x16x32_bf16 a[196:199], a[84:87], a[32:35], a[196:199]
    ds_read_b64_tr_b16 a[82:83], v13 offset:2304
    v_mfma_f32_16x16x32_bf16 a[204:207], a[84:87], a[36:39], a[204:207]
    v_mfma_f32_16x16x32_bf16 a[212:215], a[84:87], a[40:43], a[212:215]
    ds_read_b64_tr_b16 a[100:101], v15 offset:4096
    v_mfma_f32_16x16x32_bf16 a[220:223], a[84:87], a[44:47], a[220:223]
    v_mfma_f32_16x16x32_bf16 a[228:231], a[84:87], a[48:51], a[228:231]
    v_mfma_f32_16x16x32_bf16 a[236:239], a[84:87], a[52:55], a[236:239]
    buffer_load_dwordx4 v1, s[28:31], s74 offen offset:2048 sc1 lds
    v_mfma_f32_16x16x32_bf16 a[244:247], a[84:87], a[56:59], a[244:247]
    ds_read_b64_tr_b16 a[102:103], v15 offset:4352
    v_mfma_f32_16x16x32_bf16 a[252:255], a[84:87], a[60:63], a[252:255]
    ds_read_b64_tr_b16 a[84:85], v15 offset:2048
    v_mfma_f32_16x16x32_bf16 v[128:131], a[88:91], a[32:35], v[128:131]
    ds_read_b64_tr_b16 a[86:87], v15 offset:2304
    v_mfma_f32_16x16x32_bf16 v[144:147], a[88:91], a[36:39], v[144:147]
    v_mfma_f32_16x16x32_bf16 v[160:163], a[88:91], a[40:43], v[160:163]
    v_mfma_f32_16x16x32_bf16 v[176:179], a[88:91], a[44:47], v[176:179]
    v_mfma_f32_16x16x32_bf16 v[192:195], a[88:91], a[48:51], v[192:195]
    v_mfma_f32_16x16x32_bf16 v[208:211], a[88:91], a[52:55], v[208:211]
    buffer_load_dwordx4 v1, s[28:31], s75 offen offset:3072 sc1 lds
    v_add_u32_e64 v1, 64, v1
    v_mfma_f32_16x16x32_bf16 v[224:227], a[88:91], a[56:59], v[224:227]
    v_mfma_f32_16x16x32_bf16 v[240:243], a[88:91], a[60:63], v[240:243]
    ds_read_b64_tr_b16 a[88:89], v13 offset:3072
    v_mfma_f32_16x16x32_bf16 v[132:135], a[92:95], a[32:35], v[132:135]
    ds_read_b64_tr_b16 a[90:91], v13 offset:3328
    v_mfma_f32_16x16x32_bf16 v[148:151], a[92:95], a[36:39], v[148:151]
    v_mfma_f32_16x16x32_bf16 v[164:167], a[92:95], a[40:43], v[164:167]
    v_mfma_f32_16x16x32_bf16 v[180:183], a[92:95], a[44:47], v[180:183]
    buffer_load_dword v7, v6, s[44:47], s5 offen
    v_add_u32_e64 v6, s79, v6
    v_mfma_f32_16x16x32_bf16 v[196:199], a[92:95], a[48:51], v[196:199]
    v_mfma_f32_16x16x32_bf16 v[212:215], a[92:95], a[52:55], v[212:215]
    v_mfma_f32_16x16x32_bf16 v[228:231], a[92:95], a[56:59], v[228:231]
    v_mfma_f32_16x16x32_bf16 v[244:247], a[92:95], a[60:63], v[244:247]
    ds_read_b64_tr_b16 a[92:93], v15 offset:3072
    v_mfma_f32_16x16x32_bf16 v[136:139], a[104:107], a[32:35], v[136:139]
    ds_read_b64_tr_b16 a[94:95], v15 offset:3328
    v_mfma_f32_16x16x32_bf16 v[152:155], a[104:107], a[36:39], v[152:155]
    v_mfma_f32_16x16x32_bf16 v[168:171], a[104:107], a[40:43], v[168:171]
    v_mfma_f32_16x16x32_bf16 v[184:187], a[104:107], a[44:47], v[184:187]
    v_mfma_f32_16x16x32_bf16 v[200:203], a[104:107], a[48:51], v[200:203]
    v_mfma_f32_16x16x32_bf16 v[216:219], a[104:107], a[52:55], v[216:219]
    v_mfma_f32_16x16x32_bf16 v[232:235], a[104:107], a[56:59], v[232:235]
    v_mfma_f32_16x16x32_bf16 v[248:251], a[104:107], a[60:63], v[248:251]
    v_mfma_f32_16x16x32_bf16 v[140:143], a[108:111], a[32:35], v[140:143]
    v_mfma_f32_16x16x32_bf16 v[156:159], a[108:111], a[36:39], v[156:159]
    v_mfma_f32_16x16x32_bf16 v[172:175], a[108:111], a[40:43], v[172:175]
    v_mfma_f32_16x16x32_bf16 v[188:191], a[108:111], a[44:47], v[188:191]
    v_mfma_f32_16x16x32_bf16 v[204:207], a[108:111], a[48:51], v[204:207]
    v_mfma_f32_16x16x32_bf16 v[220:223], a[108:111], a[52:55], v[220:223]
    v_mfma_f32_16x16x32_bf16 v[236:239], a[108:111], a[56:59], v[236:239]
    v_mfma_f32_16x16x32_bf16 v[252:255], a[108:111], a[60:63], v[252:255]
    s_waitcnt vmcnt(19) lgkmcnt(0)
    s_barrier
    v_mfma_f32_16x16x32_bf16 a[128:131], a[64:67], a[0:3], a[128:131]
    s_add_u32 m0, s78, 77824
    v_mfma_f32_16x16x32_bf16 a[136:139], a[64:67], a[4:7], a[136:139]
    buffer_load_dwordx4 v1, s[28:31], s68 offen offset:0 sc1 lds
    v_mfma_f32_16x16x32_bf16 a[144:147], a[64:67], a[8:11], a[144:147]
    ds_read_b128 a[32:35], v9 offset:38912
    v_mfma_f32_16x16x32_bf16 a[152:155], a[64:67], a[12:15], a[152:155]
    v_mfma_f32_16x16x32_bf16 a[160:163], a[64:67], a[16:19], a[160:163]
    v_mfma_f32_16x16x32_bf16 a[168:171], a[64:67], a[20:23], a[168:171]
    v_mfma_f32_16x16x32_bf16 a[176:179], a[64:67], a[24:27], a[176:179]
    ds_read_b128 a[36:39], v9 offset:39936
    v_mfma_f32_16x16x32_bf16 a[184:187], a[64:67], a[28:31], a[184:187]
    v_mfma_f32_16x16x32_bf16 v[120:123], a[64:67], a[112:115], v[120:123]
    ds_read_b64_tr_b16 a[64:65], v13 offset:38912
    v_mfma_f32_16x16x32_bf16 a[132:135], a[68:71], a[0:3], a[132:135]
    ds_read_b64_tr_b16 a[66:67], v13 offset:39168
    buffer_load_dwordx4 v1, s[28:31], s69 offen offset:1024 sc1 lds
    v_mfma_f32_16x16x32_bf16 a[140:143], a[68:71], a[4:7], a[140:143]
    ds_read_b128 a[40:43], v9 offset:40960
    v_mfma_f32_16x16x32_bf16 a[148:151], a[68:71], a[8:11], a[148:151]
    v_mfma_f32_16x16x32_bf16 a[156:159], a[68:71], a[12:15], a[156:159]
    v_mfma_f32_16x16x32_bf16 a[164:167], a[68:71], a[16:19], a[164:167]
    v_mfma_f32_16x16x32_bf16 a[172:175], a[68:71], a[20:23], a[172:175]
    ds_read_b128 a[44:47], v9 offset:41984
    v_mfma_f32_16x16x32_bf16 a[180:183], a[68:71], a[24:27], a[180:183]
    v_mfma_f32_16x16x32_bf16 a[188:191], a[68:71], a[28:31], a[188:191]
    v_mfma_f32_16x16x32_bf16 v[124:127], a[68:71], a[112:115], v[124:127]
    ds_read_b64_tr_b16 a[68:69], v15 offset:38912
    buffer_load_dwordx4 v1, s[28:31], s70 offen offset:2048 sc1 lds
    v_mfma_f32_16x16x32_bf16 v[52:55], a[0:3], a[72:75], v[52:55]
    ds_read_b64_tr_b16 a[70:71], v15 offset:39168
    v_mfma_f32_16x16x32_bf16 v[56:59], a[4:7], a[72:75], v[56:59]
    v_mfma_f32_16x16x32_bf16 v[60:63], a[8:11], a[72:75], v[60:63]
    ds_read_b128 a[48:51], v9 offset:43008
    v_mfma_f32_16x16x32_bf16 v[64:67], a[12:15], a[72:75], v[64:67]
    v_mfma_f32_16x16x32_bf16 v[68:71], a[16:19], a[72:75], v[68:71]
    ds_read_b128 a[52:55], v9 offset:44032
    v_mfma_f32_16x16x32_bf16 v[72:75], a[20:23], a[72:75], v[72:75]
    v_mfma_f32_16x16x32_bf16 v[76:79], a[24:27], a[72:75], v[76:79]
    v_mfma_f32_16x16x32_bf16 v[80:83], a[28:31], a[72:75], v[80:83]
    buffer_load_dwordx4 v1, s[28:31], s71 offen offset:3072 sc1 lds
    v_mfma_f32_16x16x32_bf16 v[48:51], a[112:115], a[72:75], v[48:51]
    ds_read_b64_tr_b16 a[72:73], v13 offset:39936
    v_mfma_f32_16x16x32_bf16 v[88:91], a[0:3], a[76:79], v[88:91]
    ds_read_b64_tr_b16 a[74:75], v13 offset:40192
    v_mfma_f32_16x16x32_bf16 v[92:95], a[4:7], a[76:79], v[92:95]
    ds_read_b128 a[56:59], v9 offset:45056
    v_mfma_f32_16x16x32_bf16 v[96:99], a[8:11], a[76:79], v[96:99]
    v_mfma_f32_16x16x32_bf16 v[100:103], a[12:15], a[76:79], v[100:103]
    ds_read_b128 a[60:63], v9 offset:46080
    v_mfma_f32_16x16x32_bf16 v[104:107], a[16:19], a[76:79], v[104:107]
    v_mfma_f32_16x16x32_bf16 v[108:111], a[20:23], a[76:79], v[108:111]
    s_add_u32 m0, s78, 81920
    v_mfma_f32_16x16x32_bf16 v[112:115], a[24:27], a[76:79], v[112:115]
    buffer_load_dwordx4 v1, s[28:31], s72 offen offset:0 sc1 lds
    v_mfma_f32_16x16x32_bf16 v[116:119], a[28:31], a[76:79], v[116:119]
    ds_read_b128 a[116:119], v11 offset:38912
    v_mfma_f32_16x16x32_bf16 v[84:87], a[112:115], a[76:79], v[84:87]
    ds_read_b64_tr_b16 a[76:77], v15 offset:39936
    v_mfma_f32_16x16x32_bf16 a[192:195], a[80:83], a[0:3], a[192:195]
    ds_read_b64_tr_b16 a[78:79], v15 offset:40192
    v_mfma_f32_16x16x32_bf16 a[200:203], a[80:83], a[4:7], a[200:203]
    v_mfma_f32_16x16x32_bf16 a[208:211], a[80:83], a[8:11], a[208:211]
    ds_read_b64_tr_b16 a[104:105], v13 offset:43008
    v_mfma_f32_16x16x32_bf16 a[216:219], a[80:83], a[12:15], a[216:219]
    v_mfma_f32_16x16x32_bf16 a[224:227], a[80:83], a[16:19], a[224:227]
    v_mfma_f32_16x16x32_bf16 a[232:235], a[80:83], a[20:23], a[232:235]
    buffer_load_dwordx4 v1, s[28:31], s73 offen offset:1024 sc1 lds
    v_mfma_f32_16x16x32_bf16 a[240:243], a[80:83], a[24:27], a[240:243]
    ds_read_b64_tr_b16 a[106:107], v13 offset:43264
    v_mfma_f32_16x16x32_bf16 a[248:251], a[80:83], a[28:31], a[248:251]
    ds_read_b64_tr_b16 a[80:81], v13 offset:40960
    v_mfma_f32_16x16x32_bf16 a[196:199], a[84:87], a[0:3], a[196:199]
    ds_read_b64_tr_b16 a[82:83], v13 offset:41216
    v_mfma_f32_16x16x32_bf16 a[204:207], a[84:87], a[4:7], a[204:207]
    v_mfma_f32_16x16x32_bf16 a[212:215], a[84:87], a[8:11], a[212:215]
    ds_read_b64_tr_b16 a[108:109], v15 offset:43008
    v_mfma_f32_16x16x32_bf16 a[220:223], a[84:87], a[12:15], a[220:223]
    v_mfma_f32_16x16x32_bf16 a[228:231], a[84:87], a[16:19], a[228:231]
    v_mfma_f32_16x16x32_bf16 a[236:239], a[84:87], a[20:23], a[236:239]
    buffer_load_dwordx4 v1, s[28:31], s74 offen offset:2048 sc1 lds
    v_mfma_f32_16x16x32_bf16 a[244:247], a[84:87], a[24:27], a[244:247]
    ds_read_b64_tr_b16 a[110:111], v15 offset:43264
    v_mfma_f32_16x16x32_bf16 a[252:255], a[84:87], a[28:31], a[252:255]
    ds_read_b64_tr_b16 a[84:85], v15 offset:40960
    v_mfma_f32_16x16x32_bf16 v[128:131], a[88:91], a[0:3], v[128:131]
    ds_read_b64_tr_b16 a[86:87], v15 offset:41216
    v_mfma_f32_16x16x32_bf16 v[144:147], a[88:91], a[4:7], v[144:147]
    v_mfma_f32_16x16x32_bf16 v[160:163], a[88:91], a[8:11], v[160:163]
    v_mfma_f32_16x16x32_bf16 v[176:179], a[88:91], a[12:15], v[176:179]
    v_mfma_f32_16x16x32_bf16 v[192:195], a[88:91], a[16:19], v[192:195]
    v_mfma_f32_16x16x32_bf16 v[208:211], a[88:91], a[20:23], v[208:211]
    buffer_load_dwordx4 v1, s[28:31], s75 offen offset:3072 sc1 lds
    v_add_u32_e64 v1, 64, v1
    v_mfma_f32_16x16x32_bf16 v[224:227], a[88:91], a[24:27], v[224:227]
    v_mfma_f32_16x16x32_bf16 v[240:243], a[88:91], a[28:31], v[240:243]
    ds_read_b64_tr_b16 a[88:89], v13 offset:41984
    v_mfma_f32_16x16x32_bf16 v[132:135], a[92:95], a[0:3], v[132:135]
    ds_read_b64_tr_b16 a[90:91], v13 offset:42240
    v_mfma_f32_16x16x32_bf16 v[148:151], a[92:95], a[4:7], v[148:151]
    v_mfma_f32_16x16x32_bf16 v[164:167], a[92:95], a[8:11], v[164:167]
    v_mfma_f32_16x16x32_bf16 v[180:183], a[92:95], a[12:15], v[180:183]
    buffer_load_dword v7, v6, s[44:47], s4 offen
    v_mfma_f32_16x16x32_bf16 v[196:199], a[92:95], a[16:19], v[196:199]
    v_mfma_f32_16x16x32_bf16 v[212:215], a[92:95], a[20:23], v[212:215]
    v_mfma_f32_16x16x32_bf16 v[228:231], a[92:95], a[24:27], v[228:231]
    v_mfma_f32_16x16x32_bf16 v[244:247], a[92:95], a[28:31], v[244:247]
    ds_read_b64_tr_b16 a[92:93], v15 offset:41984
    v_mfma_f32_16x16x32_bf16 v[136:139], a[96:99], a[0:3], v[136:139]
    ds_read_b64_tr_b16 a[94:95], v15 offset:42240
    v_mfma_f32_16x16x32_bf16 v[152:155], a[96:99], a[4:7], v[152:155]
    v_mfma_f32_16x16x32_bf16 v[168:171], a[96:99], a[8:11], v[168:171]
    v_mfma_f32_16x16x32_bf16 v[184:187], a[96:99], a[12:15], v[184:187]
    v_mfma_f32_16x16x32_bf16 v[200:203], a[96:99], a[16:19], v[200:203]
    v_mfma_f32_16x16x32_bf16 v[216:219], a[96:99], a[20:23], v[216:219]
    v_mfma_f32_16x16x32_bf16 v[232:235], a[96:99], a[24:27], v[232:235]
    v_mfma_f32_16x16x32_bf16 v[248:251], a[96:99], a[28:31], v[248:251]
    v_mfma_f32_16x16x32_bf16 v[140:143], a[100:103], a[0:3], v[140:143]
    v_mfma_f32_16x16x32_bf16 v[156:159], a[100:103], a[4:7], v[156:159]
    v_mfma_f32_16x16x32_bf16 v[172:175], a[100:103], a[8:11], v[172:175]
    v_mfma_f32_16x16x32_bf16 v[188:191], a[100:103], a[12:15], v[188:191]
    v_mfma_f32_16x16x32_bf16 v[204:207], a[100:103], a[16:19], v[204:207]
    v_mfma_f32_16x16x32_bf16 v[220:223], a[100:103], a[20:23], v[220:223]
    v_mfma_f32_16x16x32_bf16 v[236:239], a[100:103], a[24:27], v[236:239]
    v_mfma_f32_16x16x32_bf16 v[252:255], a[100:103], a[28:31], v[252:255]
    s_waitcnt vmcnt(19) lgkmcnt(0)
    s_barrier
    v_mfma_f32_16x16x32_bf16 a[128:131], a[64:67], a[32:35], a[128:131]
    s_add_u32 m0, s78, 116736
    v_mfma_f32_16x16x32_bf16 a[136:139], a[64:67], a[36:39], a[136:139]
    buffer_load_dwordx4 v1, s[28:31], s68 offen offset:0 sc1 lds
    v_mfma_f32_16x16x32_bf16 a[144:147], a[64:67], a[40:43], a[144:147]
    ds_read_b128 a[0:3], v8 offset:0
    v_mfma_f32_16x16x32_bf16 a[152:155], a[64:67], a[44:47], a[152:155]
    v_mfma_f32_16x16x32_bf16 a[160:163], a[64:67], a[48:51], a[160:163]
    v_mfma_f32_16x16x32_bf16 a[168:171], a[64:67], a[52:55], a[168:171]
    v_mfma_f32_16x16x32_bf16 a[176:179], a[64:67], a[56:59], a[176:179]
    ds_read_b128 a[4:7], v8 offset:1024
    v_mfma_f32_16x16x32_bf16 a[184:187], a[64:67], a[60:63], a[184:187]
    v_mfma_f32_16x16x32_bf16 v[120:123], a[64:67], a[116:119], v[120:123]
    ds_read_b64_tr_b16 a[64:65], v12 offset:0
    v_mfma_f32_16x16x32_bf16 a[132:135], a[68:71], a[32:35], a[132:135]
    ds_read_b64_tr_b16 a[66:67], v12 offset:256
    buffer_load_dwordx4 v1, s[28:31], s69 offen offset:1024 sc1 lds
    v_mfma_f32_16x16x32_bf16 a[140:143], a[68:71], a[36:39], a[140:143]
    ds_read_b128 a[8:11], v8 offset:2048
    v_mfma_f32_16x16x32_bf16 a[148:151], a[68:71], a[40:43], a[148:151]
    v_mfma_f32_16x16x32_bf16 a[156:159], a[68:71], a[44:47], a[156:159]
    v_mfma_f32_16x16x32_bf16 a[164:167], a[68:71], a[48:51], a[164:167]
    v_mfma_f32_16x16x32_bf16 a[172:175], a[68:71], a[52:55], a[172:175]
    ds_read_b128 a[12:15], v8 offset:3072
    v_mfma_f32_16x16x32_bf16 a[180:183], a[68:71], a[56:59], a[180:183]
    v_mfma_f32_16x16x32_bf16 a[188:191], a[68:71], a[60:63], a[188:191]
    v_mfma_f32_16x16x32_bf16 v[124:127], a[68:71], a[116:119], v[124:127]
    ds_read_b64_tr_b16 a[68:69], v14 offset:0
    buffer_load_dwordx4 v1, s[28:31], s70 offen offset:2048 sc1 lds
    v_mfma_f32_16x16x32_bf16 v[52:55], a[32:35], a[72:75], v[52:55]
    ds_read_b64_tr_b16 a[70:71], v14 offset:256
    v_mfma_f32_16x16x32_bf16 v[56:59], a[36:39], a[72:75], v[56:59]
    v_mfma_f32_16x16x32_bf16 v[60:63], a[40:43], a[72:75], v[60:63]
    ds_read_b128 a[16:19], v8 offset:4096
    v_mfma_f32_16x16x32_bf16 v[64:67], a[44:47], a[72:75], v[64:67]
    v_mfma_f32_16x16x32_bf16 v[68:71], a[48:51], a[72:75], v[68:71]
    ds_read_b128 a[20:23], v8 offset:5120
    v_mfma_f32_16x16x32_bf16 v[72:75], a[52:55], a[72:75], v[72:75]
    v_mfma_f32_16x16x32_bf16 v[76:79], a[56:59], a[72:75], v[76:79]
    v_mfma_f32_16x16x32_bf16 v[80:83], a[60:63], a[72:75], v[80:83]
    buffer_load_dwordx4 v1, s[28:31], s71 offen offset:3072 sc1 lds
    v_mfma_f32_16x16x32_bf16 v[48:51], a[116:119], a[72:75], v[48:51]
    ds_read_b64_tr_b16 a[72:73], v12 offset:1024
    v_mfma_f32_16x16x32_bf16 v[88:91], a[32:35], a[76:79], v[88:91]
    ds_read_b64_tr_b16 a[74:75], v12 offset:1280
    v_mfma_f32_16x16x32_bf16 v[92:95], a[36:39], a[76:79], v[92:95]
    ds_read_b128 a[24:27], v8 offset:6144
    v_mfma_f32_16x16x32_bf16 v[96:99], a[40:43], a[76:79], v[96:99]
    v_mfma_f32_16x16x32_bf16 v[100:103], a[44:47], a[76:79], v[100:103]
    ds_read_b128 a[28:31], v8 offset:7168
    v_mfma_f32_16x16x32_bf16 v[104:107], a[48:51], a[76:79], v[104:107]
    v_mfma_f32_16x16x32_bf16 v[108:111], a[52:55], a[76:79], v[108:111]
    s_add_u32 m0, s78, 120832
    v_mfma_f32_16x16x32_bf16 v[112:115], a[56:59], a[76:79], v[112:115]
    buffer_load_dwordx4 v1, s[28:31], s72 offen offset:0 sc1 lds
    v_mfma_f32_16x16x32_bf16 v[116:119], a[60:63], a[76:79], v[116:119]
    ds_read_b128 a[112:115], v10 offset:0
    v_mfma_f32_16x16x32_bf16 v[84:87], a[116:119], a[76:79], v[84:87]
    ds_read_b64_tr_b16 a[76:77], v14 offset:1024
    v_mfma_f32_16x16x32_bf16 a[192:195], a[80:83], a[32:35], a[192:195]
    ds_read_b64_tr_b16 a[78:79], v14 offset:1280
    v_mfma_f32_16x16x32_bf16 a[200:203], a[80:83], a[36:39], a[200:203]
    v_mfma_f32_16x16x32_bf16 a[208:211], a[80:83], a[40:43], a[208:211]
    ds_read_b64_tr_b16 a[96:97], v12 offset:4096
    v_mfma_f32_16x16x32_bf16 a[216:219], a[80:83], a[44:47], a[216:219]
    v_mfma_f32_16x16x32_bf16 a[224:227], a[80:83], a[48:51], a[224:227]
    v_mfma_f32_16x16x32_bf16 a[232:235], a[80:83], a[52:55], a[232:235]
    buffer_load_dwordx4 v1, s[28:31], s73 offen offset:1024 sc1 lds
    v_mfma_f32_16x16x32_bf16 a[240:243], a[80:83], a[56:59], a[240:243]
    ds_read_b64_tr_b16 a[98:99], v12 offset:4352
    v_mfma_f32_16x16x32_bf16 a[248:251], a[80:83], a[60:63], a[248:251]
    ds_read_b64_tr_b16 a[80:81], v12 offset:2048
    v_mfma_f32_16x16x32_bf16 a[196:199], a[84:87], a[32:35], a[196:199]
    ds_read_b64_tr_b16 a[82:83], v12 offset:2304
    v_mfma_f32_16x16x32_bf16 a[204:207], a[84:87], a[36:39], a[204:207]
    v_mfma_f32_16x16x32_bf16 a[212:215], a[84:87], a[40:43], a[212:215]
    ds_read_b64_tr_b16 a[100:101], v14 offset:4096
    v_mfma_f32_16x16x32_bf16 a[220:223], a[84:87], a[44:47], a[220:223]
    v_mfma_f32_16x16x32_bf16 a[228:231], a[84:87], a[48:51], a[228:231]
    v_mfma_f32_16x16x32_bf16 a[236:239], a[84:87], a[52:55], a[236:239]
    buffer_load_dwordx4 v1, s[28:31], s74 offen offset:2048 sc1 lds
    v_mfma_f32_16x16x32_bf16 a[244:247], a[84:87], a[56:59], a[244:247]
    ds_read_b64_tr_b16 a[102:103], v14 offset:4352
    v_mfma_f32_16x16x32_bf16 a[252:255], a[84:87], a[60:63], a[252:255]
    ds_read_b64_tr_b16 a[84:85], v14 offset:2048
    v_mfma_f32_16x16x32_bf16 v[128:131], a[88:91], a[32:35], v[128:131]
    ds_read_b64_tr_b16 a[86:87], v14 offset:2304
    v_mfma_f32_16x16x32_bf16 v[144:147], a[88:91], a[36:39], v[144:147]
    v_mfma_f32_16x16x32_bf16 v[160:163], a[88:91], a[40:43], v[160:163]
    v_mfma_f32_16x16x32_bf16 v[176:179], a[88:91], a[44:47], v[176:179]
    v_mfma_f32_16x16x32_bf16 v[192:195], a[88:91], a[48:51], v[192:195]
    v_mfma_f32_16x16x32_bf16 v[208:211], a[88:91], a[52:55], v[208:211]
    buffer_load_dwordx4 v1, s[28:31], s75 offen offset:3072 sc1 lds
    v_add_u32_e64 v1, 64, v1
    v_mfma_f32_16x16x32_bf16 v[224:227], a[88:91], a[56:59], v[224:227]
    v_mfma_f32_16x16x32_bf16 v[240:243], a[88:91], a[60:63], v[240:243]
    ds_read_b64_tr_b16 a[88:89], v12 offset:3072
    v_mfma_f32_16x16x32_bf16 v[132:135], a[92:95], a[32:35], v[132:135]
    ds_read_b64_tr_b16 a[90:91], v12 offset:3328
    v_mfma_f32_16x16x32_bf16 v[148:151], a[92:95], a[36:39], v[148:151]
    v_mfma_f32_16x16x32_bf16 v[164:167], a[92:95], a[40:43], v[164:167]
    v_mfma_f32_16x16x32_bf16 v[180:183], a[92:95], a[44:47], v[180:183]
    buffer_load_dword v7, v6, s[44:47], s5 offen
    v_add_u32_e64 v6, s79, v6
    v_mfma_f32_16x16x32_bf16 v[196:199], a[92:95], a[48:51], v[196:199]
    v_mfma_f32_16x16x32_bf16 v[212:215], a[92:95], a[52:55], v[212:215]
    v_mfma_f32_16x16x32_bf16 v[228:231], a[92:95], a[56:59], v[228:231]
    v_mfma_f32_16x16x32_bf16 v[244:247], a[92:95], a[60:63], v[244:247]
    ds_read_b64_tr_b16 a[92:93], v14 offset:3072
    v_mfma_f32_16x16x32_bf16 v[136:139], a[104:107], a[32:35], v[136:139]
    ds_read_b64_tr_b16 a[94:95], v14 offset:3328
    v_mfma_f32_16x16x32_bf16 v[152:155], a[104:107], a[36:39], v[152:155]
    v_mfma_f32_16x16x32_bf16 v[168:171], a[104:107], a[40:43], v[168:171]
    v_mfma_f32_16x16x32_bf16 v[184:187], a[104:107], a[44:47], v[184:187]
    v_mfma_f32_16x16x32_bf16 v[200:203], a[104:107], a[48:51], v[200:203]
    v_mfma_f32_16x16x32_bf16 v[216:219], a[104:107], a[52:55], v[216:219]
    v_mfma_f32_16x16x32_bf16 v[232:235], a[104:107], a[56:59], v[232:235]
    v_mfma_f32_16x16x32_bf16 v[248:251], a[104:107], a[60:63], v[248:251]
    v_mfma_f32_16x16x32_bf16 v[140:143], a[108:111], a[32:35], v[140:143]
    v_mfma_f32_16x16x32_bf16 v[156:159], a[108:111], a[36:39], v[156:159]
    v_mfma_f32_16x16x32_bf16 v[172:175], a[108:111], a[40:43], v[172:175]
    v_mfma_f32_16x16x32_bf16 v[188:191], a[108:111], a[44:47], v[188:191]
    v_mfma_f32_16x16x32_bf16 v[204:207], a[108:111], a[48:51], v[204:207]
    v_mfma_f32_16x16x32_bf16 v[220:223], a[108:111], a[52:55], v[220:223]
    v_mfma_f32_16x16x32_bf16 v[236:239], a[108:111], a[56:59], v[236:239]
    v_mfma_f32_16x16x32_bf16 v[252:255], a[108:111], a[60:63], v[252:255]
    s_sub_u32 s67, s67, 1
    s_cmp_lg_u32 s67, 0
    s_cbranch_scc1 L_loop0
L_tail0:
    s_waitcnt vmcnt(19) lgkmcnt(0)
    s_barrier
    v_mfma_f32_16x16x32_bf16 a[128:131], a[64:67], a[0:3], a[128:131]
    s_getpc_b64 s[86:87]
L_pc0:
    s_sub_u32 s86, s86, L_pc0-L_tail0
    s_subb_u32 s87, s87, 0
    s_lshr_b32 s82, s2, 3
    s_lshl_b32 s82, s82, 2
    s_add_u32 s82, s82, s60
    s_lshl_b32 s82, s82, 10
    v_add_u32 v34, s82, v16
    v_min_u32 v34, L_code_end-L_tail0-4, v34
    global_load_dword v7, v34, s[86:87]
    v_mfma_f32_16x16x32_bf16 a[136:139], a[64:67], a[4:7], a[136:139]
    v_mfma_f32_16x16x32_bf16 a[144:147], a[64:67], a[8:11], a[144:147]
    ds_read_b128 a[32:35], v8 offset:38912
    s_and_b32 s82, s2, 7
    s_lshl_b32 s82, s82, 5
    s_lshr_b32 s83, s2, 3
    s_add_u32 s82, s82, s83
    s_lshl_b32 s82, s82, 2
    s_add_u32 s82, s82, s60
    s_mul_i32 s82, s82, 7168
    v_min_u32 v34, 55, v0
    v_lshlrev_b32 v34, 7, v34
    v_add_u32 v34, s82, v34
    global_load_dword v7, v34, s[20:21]
    v_mfma_f32_16x16x32_bf16 a[152:155], a[64:67], a[12:15], a[152:155]
    v_mfma_f32_16x16x32_bf16 a[160:163], a[64:67], a[16:19], a[160:163]
    v_mfma_f32_16x16x32_bf16 a[168:171], a[64:67], a[20:23], a[168:171]
    v_mfma_f32_16x16x32_bf16 a[176:179], a[64:67], a[24:27], a[176:179]
    ds_read_b128 a[36:39], v8 offset:39936
    v_mfma_f32_16x16x32_bf16 a[184:187], a[64:67], a[28:31], a[184:187]
    v_mfma_f32_16x16x32_bf16 v[120:123], a[64:67], a[112:115], v[120:123]
    ds_read_b64_tr_b16 a[64:65], v12 offset:38912
    v_mfma_f32_16x16x32_bf16 a[132:135], a[68:71], a[0:3], a[132:135]
    ds_read_b64_tr_b16 a[66:67], v12 offset:39168
    v_mfma_f32_16x16x32_bf16 a[140:143], a[68:71], a[4:7], a[140:143]
    ds_read_b128 a[40:43], v8 offset:40960
    v_mfma_f32_16x16x32_bf16 a[148:151], a[68:71], a[8:11], a[148:151]
    v_mfma_f32_16x16x32_bf16 a[156:159], a[68:71], a[12:15], a[156:159]
    v_mfma_f32_16x16x32_bf16 a[164:167], a[68:71], a[16:19], a[164:167]
    v_mfma_f32_16x16x32_bf16 a[172:175], a[68:71], a[20:23], a[172:175]
    ds_read_b128 a[44:47], v8 offset:41984
    v_mfma_f32_16x16x32_bf16 a[180:183], a[68:71], a[24:27], a[180:183]
    v_mfma_f32_16x16x32_bf16 a[188:191], a[68:71], a[28:31], a[188:191]
    v_mfma_f32_16x16x32_bf16 v[124:127], a[68:71], a[112:115], v[124:127]
    ds_read_b64_tr_b16 a[68:69], v14 offset:38912
    v_mfma_f32_16x16x32_bf16 v[52:55], a[0:3], a[72:75], v[52:55]
    ds_read_b64_tr_b16 a[70:71], v14 offset:39168
    v_mfma_f32_16x16x32_bf16 v[56:59], a[4:7], a[72:75], v[56:59]
    v_mfma_f32_16x16x32_bf16 v[60:63], a[8:11], a[72:75], v[60:63]
    ds_read_b128 a[48:51], v8 offset:43008
    s_lshl_b32 s82, s2, 2
    s_add_u32 s82, s82, s60
    s_lshl_b32 s82, s82, 11
    v_and_b32 v35, 31, v0
    v_lshlrev_b32 v35, 6, v35
    v_add_u32 v35, s82, v35
    global_load_dword v7, v35, s[12:13]
    v_mfma_f32_16x16x32_bf16 v[64:67], a[12:15], a[72:75], v[64:67]
    v_mfma_f32_16x16x32_bf16 v[68:71], a[16:19], a[72:75], v[68:71]
    ds_read_b128 a[52:55], v8 offset:44032
    v_mfma_f32_16x16x32_bf16 v[72:75], a[20:23], a[72:75], v[72:75]
    v_mfma_f32_16x16x32_bf16 v[76:79], a[24:27], a[72:75], v[76:79]
    v_mfma_f32_16x16x32_bf16 v[80:83], a[28:31], a[72:75], v[80:83]
    v_mfma_f32_16x16x32_bf16 v[48:51], a[112:115], a[72:75], v[48:51]
    ds_read_b64_tr_b16 a[72:73], v12 offset:39936
    v_mfma_f32_16x16x32_bf16 v[88:91], a[0:3], a[76:79], v[88:91]
    ds_read_b64_tr_b16 a[74:75], v12 offset:40192
    v_mfma_f32_16x16x32_bf16 v[92:95], a[4:7], a[76:79], v[92:95]
    ds_read_b128 a[56:59], v8 offset:45056
    v_mfma_f32_16x16x32_bf16 v[96:99], a[8:11], a[76:79], v[96:99]
    v_mfma_f32_16x16x32_bf16 v[100:103], a[12:15], a[76:79], v[100:103]
    ds_read_b128 a[60:63], v8 offset:46080
    v_mfma_f32_16x16x32_bf16 v[104:107], a[16:19], a[76:79], v[104:107]
    v_mfma_f32_16x16x32_bf16 v[108:111], a[20:23], a[76:79], v[108:111]
    v_mfma_f32_16x16x32_bf16 v[112:115], a[24:27], a[76:79], v[112:115]
    v_mfma_f32_16x16x32_bf16 v[116:119], a[28:31], a[76:79], v[116:119]
    ds_read_b128 a[116:119], v10 offset:38912
    v_mfma_f32_16x16x32_bf16 v[84:87], a[112:115], a[76:79], v[84:87]
    ds_read_b64_tr_b16 a[76:77], v14 offset:39936
    v_mfma_f32_16x16x32_bf16 a[192:195], a[80:83], a[0:3], a[192:195]
    ds_read_b64_tr_b16 a[78:79], v14 offset:40192
    v_mfma_f32_16x16x32_bf16 a[200:203], a[80:83], a[4:7], a[200:203]
    v_mfma_f32_16x16x32_bf16 a[208:211], a[80:83], a[8:11], a[208:211]
    ds_read_b64_tr_b16 a[104:105], v12 offset:43008
    v_mfma_f32_16x16x32_bf16 a[216:219], a[80:83], a[12:15], a[216:219]
    v_mfma_f32_16x16x32_bf16 a[224:227], a[80:83], a[16:19], a[224:227]
    v_mfma_f32_16x16x32_bf16 a[232:235], a[80:83], a[20:23], a[232:235]
    v_mfma_f32_16x16x32_bf16 a[240:243], a[80:83], a[24:27], a[240:243]
    ds_read_b64_tr_b16 a[106:107], v12 offset:43264
    v_mfma_f32_16x16x32_bf16 a[248:251], a[80:83], a[28:31], a[248:251]
    ds_read_b64_tr_b16 a[80:81], v12 offset:40960
    v_mfma_f32_16x16x32_bf16 a[196:199], a[84:87], a[0:3], a[196:199]
    ds_read_b64_tr_b16 a[82:83], v12 offset:41216
    v_mfma_f32_16x16x32_bf16 a[204:207], a[84:87], a[4:7], a[204:207]
    v_mfma_f32_16x16x32_bf16 a[212:215], a[84:87], a[8:11], a[212:215]
    ds_read_b64_tr_b16 a[108:109], v14 offset:43008
    v_mfma_f32_16x16x32_bf16 a[220:223], a[84:87], a[12:15], a[220:223]
    v_mfma_f32_16x16x32_bf16 a[228:231], a[84:87], a[16:19], a[228:231]
    v_mfma_f32_16x16x32_bf16 a[236:239], a[84:87], a[20:23], a[236:239]
    v_mfma_f32_16x16x32_bf16 a[244:247], a[84:87], a[24:27], a[244:247]
    ds_read_b64_tr_b16 a[110:111], v14 offset:43264
    v_mfma_f32_16x16x32_bf16 a[252:255], a[84:87], a[28:31], a[252:255]
    ds_read_b64_tr_b16 a[84:85], v14 offset:40960
    v_mfma_f32_16x16x32_bf16 v[128:131], a[88:91], a[0:3], v[128:131]
    ds_read_b64_tr_b16 a[86:87], v14 offset:41216
    v_mfma_f32_16x16x32_bf16 v[144:147], a[88:91], a[4:7], v[144:147]
    v_mfma_f32_16x16x32_bf16 v[160:163], a[88:91], a[8:11], v[160:163]
    v_mfma_f32_16x16x32_bf16 v[176:179], a[88:91], a[12:15], v[176:179]
    v_mfma_f32_16x16x32_bf16 v[192:195], a[88:91], a[16:19], v[192:195]
    v_mfma_f32_16x16x32_bf16 v[208:211], a[88:91], a[20:23], v[208:211]
    v_mfma_f32_16x16x32_bf16 v[224:227], a[88:91], a[24:27], v[224:227]
    v_mfma_f32_16x16x32_bf16 v[240:243], a[88:91], a[28:31], v[240:243]
    ds_read_b64_tr_b16 a[88:89], v12 offset:41984
    v_mfma_f32_16x16x32_bf16 v[132:135], a[92:95], a[0:3], v[132:135]
    ds_read_b64_tr_b16 a[90:91], v12 offset:42240
    v_mfma_f32_16x16x32_bf16 v[148:151], a[92:95], a[4:7], v[148:151]
    v_mfma_f32_16x16x32_bf16 v[164:167], a[92:95], a[8:11], v[164:167]
    v_mfma_f32_16x16x32_bf16 v[180:183], a[92:95], a[12:15], v[180:183]
    v_mfma_f32_16x16x32_bf16 v[196:199], a[92:95], a[16:19], v[196:199]
    v_mfma_f32_16x16x32_bf16 v[212:215], a[92:95], a[20:23], v[212:215]
    v_mfma_f32_16x16x32_bf16 v[228:231], a[92:95], a[24:27], v[228:231]
    v_mfma_f32_16x16x32_bf16 v[244:247], a[92:95], a[28:31], v[244:247]
    ds_read_b64_tr_b16 a[92:93], v14 offset:41984
    v_mfma_f32_16x16x32_bf16 v[136:139], a[96:99], a[0:3], v[136:139]
    ds_read_b64_tr_b16 a[94:95], v14 offset:42240
    v_mfma_f32_16x16x32_bf16 v[152:155], a[96:99], a[4:7], v[152:155]
    v_mfma_f32_16x16x32_bf16 v[168:171], a[96:99], a[8:11], v[168:171]
    v_mfma_f32_16x16x32_bf16 v[184:187], a[96:99], a[12:15], v[184:187]
    v_mfma_f32_16x16x32_bf16 v[200:203], a[96:99], a[16:19], v[200:203]
    v_mfma_f32_16x16x32_bf16 v[216:219], a[96:99], a[20:23], v[216:219]
    v_mfma_f32_16x16x32_bf16 v[232:235], a[96:99], a[24:27], v[232:235]
    v_mfma_f32_16x16x32_bf16 v[248:251], a[96:99], a[28:31], v[248:251]
    v_mfma_f32_16x16x32_bf16 v[140:143], a[100:103], a[0:3], v[140:143]
    v_mfma_f32_16x16x32_bf16 v[156:159], a[100:103], a[4:7], v[156:159]
    v_mfma_f32_16x16x32_bf16 v[172:175], a[100:103], a[8:11], v[172:175]
    v_mfma_f32_16x16x32_bf16 v[188:191], a[100:103], a[12:15], v[188:191]
    v_mfma_f32_16x16x32_bf16 v[204:207], a[100:103], a[16:19], v[204:207]
    v_mfma_f32_16x16x32_bf16 v[220:223], a[100:103], a[20:23], v[220:223]
    v_mfma_f32_16x16x32_bf16 v[236:239], a[100:103], a[24:27], v[236:239]
    v_mfma_f32_16x16x32_bf16 v[252:255], a[100:103], a[28:31], v[252:255]
    s_waitcnt vmcnt(13) lgkmcnt(0)
    s_barrier
    v_mfma_f32_16x16x32_bf16 a[128:131], a[64:67], a[32:35], a[128:131]
    v_mfma_f32_16x16x32_bf16 a[136:139], a[64:67], a[36:39], a[136:139]
    v_mfma_f32_16x16x32_bf16 a[144:147], a[64:67], a[40:43], a[144:147]
    ds_read_b128 a[0:3], v9 offset:0
    v_mfma_f32_16x16x32_bf16 a[152:155], a[64:67], a[44:47], a[152:155]
    v_mfma_f32_16x16x32_bf16 a[160:163], a[64:67], a[48:51], a[160:163]
    s_mul_i32 s82, s65, 1835008
    s_lshl_b32 s83, s66, 8
    v_mfma_f32_16x16x32_bf16 a[168:171], a[64:67], a[52:55], a[168:171]
    s_add_u32 s82, s82, s83
    s_add_u32 s48, s20, s82
    v_mfma_f32_16x16x32_bf16 a[176:179], a[64:67], a[56:59], a[176:179]
    ds_read_b128 a[4:7], v9 offset:1024
    s_addc_u32 s49, s21, 0
    s_and_b32 s49, s49, 0xffff
    v_mfma_f32_16x16x32_bf16 a[184:187], a[64:67], a[60:63], a[184:187]
    s_sub_u32 s50, 7340032, s82
    s_mov_b32 s51, 0x20000
    v_mfma_f32_16x16x32_bf16 v[120:123], a[64:67], a[116:119], v[120:123]
    ds_read_b64_tr_b16 a[64:65], v13 offset:0
    s_add_u32 s52, s12, s83
    s_addc_u32 s53, s13, 0
    v_mfma_f32_16x16x32_bf16 a[132:135], a[68:71], a[32:35], a[132:135]
    ds_read_b64_tr_b16 a[66:67], v13 offset:256
    s_and_b32 s53, s53, 0xffff
    s_sub_u32 s54, 2097152, s83
    v_mfma_f32_16x16x32_bf16 a[140:143], a[68:71], a[36:39], a[140:143]
    ds_read_b128 a[8:11], v9 offset:2048
    s_mov_b32 s55, 0x20000
    s_lshl_b32 s3, s60, 11
    v_mfma_f32_16x16x32_bf16 a[148:151], a[68:71], a[40:43], a[148:151]
    v_lshrrev_b32 v34, 4, v0
    v_and_b32 v35, 15, v0
    v_mfma_f32_16x16x32_bf16 a[156:159], a[68:71], a[44:47], a[156:159]
    v_lshlrev_b32 v36, 1, v34
    v_add_u32 v36, 0, v36
    v_mfma_f32_16x16x32_bf16 a[164:167], a[68:71], a[48:51], a[164:167]
    v_xor_b32 v36, v36, v35
    v_lshlrev_b32 v36, 4, v36
    v_mfma_f32_16x16x32_bf16 a[172:175], a[68:71], a[52:55], a[172:175]
    ds_read_b128 a[12:15], v9 offset:3072
    v_lshl_add_u32 v36, v34, 11, v36
    s_lshl_b32 s82, s60, 14
    v_mfma_f32_16x16x32_bf16 a[180:183], a[68:71], a[56:59], a[180:183]
    s_add_u32 s82, s82, 0
    v_add_u32 v17, s82, v36
    v_mfma_f32_16x16x32_bf16 a[188:191], a[68:71], a[60:63], a[188:191]
    s_lshl_b32 s82, s62, 1
    s_add_u32 s82, s82, 0
    v_mfma_f32_16x16x32_bf16 v[124:127], a[68:71], a[116:119], v[124:127]
    ds_read_b64_tr_b16 a[68:69], v15 offset:0
    s_lshl_b32 s82, s82, 3
    s_lshl_b32 s83, s61, 2
    v_mfma_f32_16x16x32_bf16 v[52:55], a[32:35], a[72:75], v[52:55]
    ds_read_b64_tr_b16 a[70:71], v15 offset:256
    s_add_u32 s82, s82, s83
    s_mul_i32 s83, s62, 96
    v_mfma_f32_16x16x32_bf16 v[56:59], a[36:39], a[72:75], v[56:59]
    s_add_u32 s82, s82, s83
    s_lshl_b32 s82, s82, 11
    v_mfma_f32_16x16x32_bf16 v[60:63], a[40:43], a[72:75], v[60:63]
    ds_read_b128 a[16:19], v9 offset:4096
    s_sub_u32 s82, s82, 0
    v_add_u32 v19, s82, v36
    v_mfma_f32_16x16x32_bf16 v[64:67], a[44:47], a[72:75], v[64:67]
    v_lshlrev_b32 v36, 1, v34
    v_add_u32 v36, 8, v36
    v_mfma_f32_16x16x32_bf16 v[68:71], a[48:51], a[72:75], v[68:71]
    ds_read_b128 a[20:23], v9 offset:5120
    v_xor_b32 v36, v36, v35
    v_lshlrev_b32 v36, 4, v36
    v_mfma_f32_16x16x32_bf16 v[72:75], a[52:55], a[72:75], v[72:75]
    v_lshl_add_u32 v36, v34, 11, v36
    s_lshl_b32 s82, s60, 14
    v_mfma_f32_16x16x32_bf16 v[76:79], a[56:59], a[72:75], v[76:79]
    s_add_u32 s82, s82, 7168
    v_add_u32 v18, s82, v36
    v_mfma_f32_16x16x32_bf16 v[80:83], a[60:63], a[72:75], v[80:83]
    s_lshl_b32 s82, s62, 1
    s_add_u32 s82, s82, 1
    v_mfma_f32_16x16x32_bf16 v[48:51], a[116:119], a[72:75], v[48:51]
    ds_read_b64_tr_b16 a[72:73], v13 offset:1024
    s_lshl_b32 s82, s82, 3
    s_lshl_b32 s83, s61, 2
    v_mfma_f32_16x16x32_bf16 v[88:91], a[32:35], a[76:79], v[88:91]
    ds_read_b64_tr_b16 a[74:75], v13 offset:1280
    s_add_u32 s82, s82, s83
    s_mul_i32 s83, s62, 96
    v_mfma_f32_16x16x32_bf16 v[92:95], a[36:39], a[76:79], v[92:95]
    ds_read_b128 a[24:27], v9 offset:6144
    s_add_u32 s82, s82, s83
    s_lshl_b32 s82, s82, 11
    v_mfma_f32_16x16x32_bf16 v[96:99], a[40:43], a[76:79], v[96:99]
    s_sub_u32 s82, s82, 1024
    v_add_u32 v20, s82, v36
    v_mfma_f32_16x16x32_bf16 v[100:103], a[44:47], a[76:79], v[100:103]
    ds_read_b128 a[28:31], v9 offset:7168
    s_xor_b32 s82, s65, 0
    s_lshl_b32 s82, s82, 10
    v_mfma_f32_16x16x32_bf16 v[104:107], a[48:51], a[76:79], v[104:107]
    v_add_u32 v21, s82, v16
    s_xor_b32 s82, s65, 1
    v_mfma_f32_16x16x32_bf16 v[108:111], a[52:55], a[76:79], v[108:111]
    s_lshl_b32 s82, s82, 10
    v_add_u32 v22, s82, v16
    v_mfma_f32_16x16x32_bf16 v[112:115], a[56:59], a[76:79], v[112:115]
    s_xor_b32 s82, s65, 2
    s_lshl_b32 s82, s82, 10
    v_mfma_f32_16x16x32_bf16 v[116:119], a[60:63], a[76:79], v[116:119]
    ds_read_b128 a[112:115], v11 offset:0
    v_add_u32 v23, s82, v16
    s_xor_b32 s82, s65, 3
    v_mfma_f32_16x16x32_bf16 v[84:87], a[116:119], a[76:79], v[84:87]
    ds_read_b64_tr_b16 a[76:77], v15 offset:1024
    s_lshl_b32 s82, s82, 10
    v_add_u32 v24, s82, v16
    v_mfma_f32_16x16x32_bf16 a[192:195], a[80:83], a[32:35], a[192:195]
    ds_read_b64_tr_b16 a[78:79], v15 offset:1280
    s_mov_b32 s94, 0xbdd2d3e8
    s_mov_b32 s95, 0xbdd2d3e8
    v_mfma_f32_16x16x32_bf16 a[200:203], a[80:83], a[36:39], a[200:203]
    v_mov_b32 v26, 0xc0135761
    v_mov_b32 v27, 0xc0135761
    v_mfma_f32_16x16x32_bf16 a[208:211], a[80:83], a[40:43], a[208:211]
    ds_read_b64_tr_b16 a[96:97], v13 offset:4096
    v_mov_b32 v25, 1
    s_lshl_b32 s82, s60, 12
    v_mfma_f32_16x16x32_bf16 a[216:219], a[80:83], a[44:47], a[216:219]
    s_add_u32 s68, s88, s82
    s_lshl_b32 s82, s61, 13
    v_mfma_f32_16x16x32_bf16 a[224:227], a[80:83], a[48:51], a[224:227]
    s_add_u32 s88, s88, s82
    s_lshr_b32 s82, s66, 1
    v_mfma_f32_16x16x32_bf16 a[232:235], a[80:83], a[52:55], a[232:235]
    s_add_u32 s82, s82, 24
    s_lshl_b32 s82, s82, 14
    v_mfma_f32_16x16x32_bf16 a[240:243], a[80:83], a[56:59], a[240:243]
    ds_read_b64_tr_b16 a[98:99], v13 offset:4352
    s_add_u32 s90, s88, s82
    s_lshl_b32 s82, s66, 14
    v_mfma_f32_16x16x32_bf16 a[248:251], a[80:83], a[60:63], a[248:251]
    ds_read_b64_tr_b16 a[80:81], v13 offset:2048
    v_mfma_f32_16x16x32_bf16 a[196:199], a[84:87], a[32:35], a[196:199]
    ds_read_b64_tr_b16 a[82:83], v13 offset:2304
    v_mfma_f32_16x16x32_bf16 a[204:207], a[84:87], a[36:39], a[204:207]
    v_mfma_f32_16x16x32_bf16 a[212:215], a[84:87], a[40:43], a[212:215]
    ds_read_b64_tr_b16 a[100:101], v15 offset:4096
    v_mfma_f32_16x16x32_bf16 a[220:223], a[84:87], a[44:47], a[220:223]
    v_mfma_f32_16x16x32_bf16 a[228:231], a[84:87], a[48:51], a[228:231]
    v_mfma_f32_16x16x32_bf16 a[236:239], a[84:87], a[52:55], a[236:239]
    v_mfma_f32_16x16x32_bf16 a[244:247], a[84:87], a[56:59], a[244:247]
    ds_read_b64_tr_b16 a[102:103], v15 offset:4352
    v_mfma_f32_16x16x32_bf16 a[252:255], a[84:87], a[60:63], a[252:255]
    ds_read_b64_tr_b16 a[84:85], v15 offset:2048
    v_mfma_f32_16x16x32_bf16 v[128:131], a[88:91], a[32:35], v[128:131]
    ds_read_b64_tr_b16 a[86:87], v15 offset:2304
    v_mfma_f32_16x16x32_bf16 v[144:147], a[88:91], a[36:39], v[144:147]
    v_mfma_f32_16x16x32_bf16 v[160:163], a[88:91], a[40:43], v[160:163]
    v_mfma_f32_16x16x32_bf16 v[176:179], a[88:91], a[44:47], v[176:179]
    v_mfma_f32_16x16x32_bf16 v[192:195], a[88:91], a[48:51], v[192:195]
    v_mfma_f32_16x16x32_bf16 v[208:211], a[88:91], a[52:55], v[208:211]
    v_mfma_f32_16x16x32_bf16 v[224:227], a[88:91], a[56:59], v[224:227]
    v_mfma_f32_16x16x32_bf16 v[240:243], a[88:91], a[60:63], v[240:243]
    ds_read_b64_tr_b16 a[88:89], v13 offset:3072
    v_mfma_f32_16x16x32_bf16 v[132:135], a[92:95], a[32:35], v[132:135]
    ds_read_b64_tr_b16 a[90:91], v13 offset:3328
    v_mfma_f32_16x16x32_bf16 v[148:151], a[92:95], a[36:39], v[148:151]
    v_mfma_f32_16x16x32_bf16 v[164:167], a[92:95], a[40:43], v[164:167]
    v_mfma_f32_16x16x32_bf16 v[180:183], a[92:95], a[44:47], v[180:183]
    v_mfma_f32_16x16x32_bf16 v[196:199], a[92:95], a[48:51], v[196:199]
    v_mfma_f32_16x16x32_bf16 v[212:215], a[92:95], a[52:55], v[212:215]
    v_mfma_f32_16x16x32_bf16 v[228:231], a[92:95], a[56:59], v[228:231]
    v_mfma_f32_16x16x32_bf16 v[244:247], a[92:95], a[60:63], v[244:247]
    ds_read_b64_tr_b16 a[92:93], v15 offset:3072
    v_mfma_f32_16x16x32_bf16 v[136:139], a[104:107], a[32:35], v[136:139]
    ds_read_b64_tr_b16 a[94:95], v15 offset:3328
    v_mfma_f32_16x16x32_bf16 v[152:155], a[104:107], a[36:39], v[152:155]
    v_mfma_f32_16x16x32_bf16 v[168:171], a[104:107], a[40:43], v[168:171]
    v_mfma_f32_16x16x32_bf16 v[184:187], a[104:107], a[44:47], v[184:187]
    v_mfma_f32_16x16x32_bf16 v[200:203], a[104:107], a[48:51], v[200:203]
    v_mfma_f32_16x16x32_bf16 v[216:219], a[104:107], a[52:55], v[216:219]
    v_mfma_f32_16x16x32_bf16 v[232:235], a[104:107], a[56:59], v[232:235]
    v_mfma_f32_16x16x32_bf16 v[248:251], a[104:107], a[60:63], v[248:251]
    v_mfma_f32_16x16x32_bf16 v[140:143], a[108:111], a[32:35], v[140:143]
    v_mfma_f32_16x16x32_bf16 v[156:159], a[108:111], a[36:39], v[156:159]
    v_mfma_f32_16x16x32_bf16 v[172:175], a[108:111], a[40:43], v[172:175]
    v_mfma_f32_16x16x32_bf16 v[188:191], a[108:111], a[44:47], v[188:191]
    v_mfma_f32_16x16x32_bf16 v[204:207], a[108:111], a[48:51], v[204:207]
    v_mfma_f32_16x16x32_bf16 v[220:223], a[108:111], a[52:55], v[220:223]
    v_mfma_f32_16x16x32_bf16 v[236:239], a[108:111], a[56:59], v[236:239]
    v_mfma_f32_16x16x32_bf16 v[252:255], a[108:111], a[60:63], v[252:255]
    s_waitcnt vmcnt(4) lgkmcnt(0)
    s_barrier
    v_mfma_f32_16x16x32_bf16 a[128:131], a[64:67], a[0:3], a[128:131]
    v_mfma_f32_16x16x32_bf16 a[136:139], a[64:67], a[4:7], a[136:139]
    v_mfma_f32_16x16x32_bf16 a[144:147], a[64:67], a[8:11], a[144:147]
    ds_read_b128 a[32:35], v9 offset:38912
    v_mfma_f32_16x16x32_bf16 a[152:155], a[64:67], a[12:15], a[152:155]
    v_mfma_f32_16x16x32_bf16 a[160:163], a[64:67], a[16:19], a[160:163]
    s_add_u32 s88, s88, s82
    s_add_u32 s89, s88, 262144
    v_mfma_f32_16x16x32_bf16 a[168:171], a[64:67], a[20:23], a[168:171]
    s_mov_b32 s76, s93
    s_lshl_b32 s82, s63, 4
    v_mfma_f32_16x16x32_bf16 a[176:179], a[64:67], a[24:27], a[176:179]
    ds_read_b128 a[36:39], v9 offset:39936
    s_lshl_b32 s83, s60, 2
    s_add_u32 s83, s83, s82
    v_mfma_f32_16x16x32_bf16 a[184:187], a[64:67], a[28:31], a[184:187]
    s_add_u32 s83, s83, s65
    s_lshl_b32 s83, s83, 15
    v_mfma_f32_16x16x32_bf16 v[120:123], a[64:67], a[112:115], v[120:123]
    ds_read_b64_tr_b16 a[64:65], v13 offset:38912
    s_add_u32 s69, s83, 4194304
    s_lshl_b32 s84, s63, 3
    v_mfma_f32_16x16x32_bf16 a[132:135], a[68:71], a[0:3], a[132:135]
    ds_read_b64_tr_b16 a[66:67], v13 offset:39168
    s_add_u32 s84, s84, s66
    s_lshl_b32 s85, s84, 2
    v_mfma_f32_16x16x32_bf16 a[140:143], a[68:71], a[4:7], a[140:143]
    ds_read_b128 a[40:43], v9 offset:40960
    s_add_u32 s85, s85, s60
    s_lshl_b32 s85, s85, 8
    v_mfma_f32_16x16x32_bf16 a[148:151], a[68:71], a[8:11], a[148:151]
    s_add_u32 s77, s85, 39862272
    s_lshl_b32 s84, s84, 18
    v_mfma_f32_16x16x32_bf16 a[156:159], a[68:71], a[12:15], a[156:159]
    s_lshl_b32 s85, s60, 12
    s_add_u32 s84, s84, s85
    v_mfma_f32_16x16x32_bf16 a[164:167], a[68:71], a[16:19], a[164:167]
    s_add_u32 s84, s84, 23068672
    s_xor_b32 s85, s65, 1
    v_mfma_f32_16x16x32_bf16 a[172:175], a[68:71], a[20:23], a[172:175]
    ds_read_b128 a[44:47], v9 offset:41984
    s_lshl_b32 s85, s85, 16
    s_add_u32 s70, s84, s85
    v_mfma_f32_16x16x32_bf16 a[180:183], a[68:71], a[24:27], a[180:183]
    s_add_u32 s70, s70, 16384
    s_lshl_b32 s85, s65, 16
    v_mfma_f32_16x16x32_bf16 a[188:191], a[68:71], a[28:31], a[188:191]
    s_add_u32 s73, s84, s85
    s_add_u32 s73, s73, 16384
    v_mfma_f32_16x16x32_bf16 v[124:127], a[68:71], a[112:115], v[124:127]
    ds_read_b64_tr_b16 a[68:69], v15 offset:38912
    s_xor_b32 s85, s65, 2
    s_lshl_b32 s85, s85, 16
    v_mfma_f32_16x16x32_bf16 v[52:55], a[0:3], a[72:75], v[52:55]
    ds_read_b64_tr_b16 a[70:71], v15 offset:39168
    s_add_u32 s71, s84, s85
    s_add_u32 s71, s71, 32768
    v_mfma_f32_16x16x32_bf16 v[56:59], a[4:7], a[72:75], v[56:59]
    s_lshl_b32 s85, s65, 16
    s_add_u32 s74, s84, s85
    v_mfma_f32_16x16x32_bf16 v[60:63], a[8:11], a[72:75], v[60:63]
    ds_read_b128 a[48:51], v9 offset:43008
    s_add_u32 s74, s74, 32768
    s_xor_b32 s85, s65, 3
    v_mfma_f32_16x16x32_bf16 v[64:67], a[12:15], a[72:75], v[64:67]
    s_lshl_b32 s85, s85, 16
    s_add_u32 s72, s84, s85
    v_mfma_f32_16x16x32_bf16 v[68:71], a[16:19], a[72:75], v[68:71]
    ds_read_b128 a[52:55], v9 offset:44032
    s_add_u32 s72, s72, 49152
    s_lshl_b32 s85, s65, 16
    v_mfma_f32_16x16x32_bf16 v[72:75], a[20:23], a[72:75], v[72:75]
    s_add_u32 s75, s84, s85
    s_add_u32 s75, s75, 49152
    v_mfma_f32_16x16x32_bf16 v[76:79], a[24:27], a[72:75], v[76:79]
    s_lshl_b32 s83, s61, 3
    s_add_u32 s82, s82, s83
    v_mfma_f32_16x16x32_bf16 v[80:83], a[28:31], a[72:75], v[80:83]
    s_lshl_b32 s82, s82, 5
    s_add_u32 s82, s82, s64
    v_mfma_f32_16x16x32_bf16 v[48:51], a[112:115], a[72:75], v[48:51]
    ds_read_b64_tr_b16 a[72:73], v13 offset:39936
    s_lshl_b32 s82, s82, 10
    s_add_u32 s91, s82, 4194304
    v_mfma_f32_16x16x32_bf16 v[88:91], a[0:3], a[76:79], v[88:91]
    ds_read_b64_tr_b16 a[74:75], v13 offset:40192
    v_mov_b32 v42, 1
    v_and_b32 v37, 1, v35
    v_mfma_f32_16x16x32_bf16 v[92:95], a[4:7], a[76:79], v[92:95]
    ds_read_b128 a[56:59], v9 offset:45056
    v_lshl_add_u32 v36, v34, 2, v37
    v_cmp_le_u32 s[4:5], v36, v35
    v_mfma_f32_16x16x32_bf16 v[96:99], a[8:11], a[76:79], v[96:99]
    v_add_u32 v36, 2, v36
    v_cmp_le_u32 s[6:7], v36, v35
    v_mfma_f32_16x16x32_bf16 v[100:103], a[12:15], a[76:79], v[100:103]
    ds_read_b128 a[60:63], v9 offset:46080
    v_mul_u32_u24 v36, 0x0202, v37
    v_lshlrev_b32 v36, 16, v36
    v_mfma_f32_16x16x32_bf16 v[104:107], a[16:19], a[76:79], v[104:107]
    v_add_u32 v36, 0x01000c0c, v36
    v_add_u32 v38, 0x04040000, v36
    v_mfma_f32_16x16x32_bf16 v[108:111], a[20:23], a[76:79], v[108:111]
    v_cndmask_b32 v28, v36, v38, s[4:5]
    v_cndmask_b32 v29, v36, v38, s[6:7]
    v_mfma_f32_16x16x32_bf16 v[112:115], a[24:27], a[76:79], v[112:115]
    v_cmp_eq_u32 vcc, 1, v37
    v_mov_b32 v36, 0x0c0c0100
    v_mfma_f32_16x16x32_bf16 v[116:119], a[28:31], a[76:79], v[116:119]
    ds_read_b128 a[116:119], v11 offset:38912
    v_mov_b32 v38, 0x01000c0c
    v_cndmask_b32 v36, v36, v38, vcc
    v_mfma_f32_16x16x32_bf16 v[84:87], a[112:115], a[76:79], v[84:87]
    ds_read_b64_tr_b16 a[76:77], v15 offset:39936
    v_mov_b32 v38, 0x0c0c0302
    v_mov_b32 v39, 0x03020c0c
    v_mfma_f32_16x16x32_bf16 a[192:195], a[80:83], a[0:3], a[192:195]
    ds_read_b64_tr_b16 a[78:79], v15 offset:40192
    v_cndmask_b32 v38, v38, v39, vcc
    v_mov_b32 v39, 0x0c0c0c0c
    v_mfma_f32_16x16x32_bf16 a[200:203], a[80:83], a[4:7], a[200:203]
    v_cndmask_b32 v30, v36, v39, s[4:5]
    v_cndmask_b32 v31, v38, v39, s[6:7]
    v_mfma_f32_16x16x32_bf16 a[208:211], a[80:83], a[8:11], a[208:211]
    ds_read_b64_tr_b16 a[104:105], v13 offset:43008
    v_cndmask_b32 v32, v39, v36, s[4:5]
    v_cndmask_b32 v33, v39, v38, s[6:7]
    v_mfma_f32_16x16x32_bf16 a[216:219], a[80:83], a[12:15], a[216:219]
    s_or_b32 s82, s63, s61
    s_cmp_eq_u32 s82, 0
    v_mfma_f32_16x16x32_bf16 a[224:227], a[80:83], a[16:19], a[224:227]
    s_cselect_b64 s[4:5], s[4:5], -1
    s_cselect_b64 s[6:7], s[6:7], -1
    v_mfma_f32_16x16x32_bf16 a[232:235], a[80:83], a[20:23], a[232:235]
    s_mov_b32 s14, 0x3e3504f3
    s_mov_b32 s15, 0x3e3504f3
    v_mfma_f32_16x16x32_bf16 a[240:243], a[80:83], a[24:27], a[240:243]
    ds_read_b64_tr_b16 a[106:107], v13 offset:43264
    s_mov_b32 s98, 0x3fb8aa3b
    s_mov_b32 s99, 0x3fb8aa3b
    v_mfma_f32_16x16x32_bf16 a[248:251], a[80:83], a[28:31], a[248:251]
    ds_read_b64_tr_b16 a[80:81], v13 offset:40960
    v_mfma_f32_16x16x32_bf16 a[196:199], a[84:87], a[0:3], a[196:199]
    ds_read_b64_tr_b16 a[82:83], v13 offset:41216
    v_mfma_f32_16x16x32_bf16 a[204:207], a[84:87], a[4:7], a[204:207]
    v_mfma_f32_16x16x32_bf16 a[212:215], a[84:87], a[8:11], a[212:215]
    ds_read_b64_tr_b16 a[108:109], v15 offset:43008
    v_mfma_f32_16x16x32_bf16 a[220:223], a[84:87], a[12:15], a[220:223]
    v_mfma_f32_16x16x32_bf16 a[228:231], a[84:87], a[16:19], a[228:231]
    v_mfma_f32_16x16x32_bf16 a[236:239], a[84:87], a[20:23], a[236:239]
    v_mfma_f32_16x16x32_bf16 a[244:247], a[84:87], a[24:27], a[244:247]
    ds_read_b64_tr_b16 a[110:111], v15 offset:43264
    v_mfma_f32_16x16x32_bf16 a[252:255], a[84:87], a[28:31], a[252:255]
    ds_read_b64_tr_b16 a[84:85], v15 offset:40960
    v_mfma_f32_16x16x32_bf16 v[128:131], a[88:91], a[0:3], v[128:131]
    ds_read_b64_tr_b16 a[86:87], v15 offset:41216
    v_mfma_f32_16x16x32_bf16 v[144:147], a[88:91], a[4:7], v[144:147]
    v_mfma_f32_16x16x32_bf16 v[160:163], a[88:91], a[8:11], v[160:163]
    v_mfma_f32_16x16x32_bf16 v[176:179], a[88:91], a[12:15], v[176:179]
    v_mfma_f32_16x16x32_bf16 v[192:195], a[88:91], a[16:19], v[192:195]
    v_mfma_f32_16x16x32_bf16 v[208:211], a[88:91], a[20:23], v[208:211]
    v_mfma_f32_16x16x32_bf16 v[224:227], a[88:91], a[24:27], v[224:227]
    v_mfma_f32_16x16x32_bf16 v[240:243], a[88:91], a[28:31], v[240:243]
    ds_read_b64_tr_b16 a[88:89], v13 offset:41984
    v_mfma_f32_16x16x32_bf16 v[132:135], a[92:95], a[0:3], v[132:135]
    ds_read_b64_tr_b16 a[90:91], v13 offset:42240
    v_mfma_f32_16x16x32_bf16 v[148:151], a[92:95], a[4:7], v[148:151]
    v_mfma_f32_16x16x32_bf16 v[164:167], a[92:95], a[8:11], v[164:167]
    v_mfma_f32_16x16x32_bf16 v[180:183], a[92:95], a[12:15], v[180:183]
    v_mfma_f32_16x16x32_bf16 v[196:199], a[92:95], a[16:19], v[196:199]
    v_mfma_f32_16x16x32_bf16 v[212:215], a[92:95], a[20:23], v[212:215]
    v_mfma_f32_16x16x32_bf16 v[228:231], a[92:95], a[24:27], v[228:231]
    v_mfma_f32_16x16x32_bf16 v[244:247], a[92:95], a[28:31], v[244:247]
    ds_read_b64_tr_b16 a[92:93], v15 offset:41984
    v_mfma_f32_16x16x32_bf16 v[136:139], a[96:99], a[0:3], v[136:139]
    ds_read_b64_tr_b16 a[94:95], v15 offset:42240
    v_mfma_f32_16x16x32_bf16 v[152:155], a[96:99], a[4:7], v[152:155]
    v_mfma_f32_16x16x32_bf16 v[168:171], a[96:99], a[8:11], v[168:171]
    v_mfma_f32_16x16x32_bf16 v[184:187], a[96:99], a[12:15], v[184:187]
    v_mfma_f32_16x16x32_bf16 v[200:203], a[96:99], a[16:19], v[200:203]
    v_mfma_f32_16x16x32_bf16 v[216:219], a[96:99], a[20:23], v[216:219]
    v_mfma_f32_16x16x32_bf16 v[232:235], a[96:99], a[24:27], v[232:235]
    v_mfma_f32_16x16x32_bf16 v[248:251], a[96:99], a[28:31], v[248:251]
    v_mfma_f32_16x16x32_bf16 v[140:143], a[100:103], a[0:3], v[140:143]
    v_mfma_f32_16x16x32_bf16 v[156:159], a[100:103], a[4:7], v[156:159]
    v_mfma_f32_16x16x32_bf16 v[172:175], a[100:103], a[8:11], v[172:175]
    v_mfma_f32_16x16x32_bf16 v[188:191], a[100:103], a[12:15], v[188:191]
    v_mfma_f32_16x16x32_bf16 v[204:207], a[100:103], a[16:19], v[204:207]
    v_mfma_f32_16x16x32_bf16 v[220:223], a[100:103], a[20:23], v[220:223]
    v_mfma_f32_16x16x32_bf16 v[236:239], a[100:103], a[24:27], v[236:239]
    v_mfma_f32_16x16x32_bf16 v[252:255], a[100:103], a[28:31], v[252:255]
    s_waitcnt lgkmcnt(0)
    s_barrier
    v_mfma_f32_16x16x32_bf16 a[128:131], a[64:67], a[32:35], a[128:131]
    v_mfma_f32_16x16x32_bf16 a[136:139], a[64:67], a[36:39], a[136:139]
    v_mfma_f32_16x16x32_bf16 a[144:147], a[64:67], a[40:43], a[144:147]
    s_mov_b32 s82, 0
    s_add_u32 m0, s3, 0
    v_mfma_f32_16x16x32_bf16 a[152:155], a[64:67], a[44:47], a[152:155]
    buffer_load_dwordx4 v17, s[48:51], s82 offen lds
    v_mfma_f32_16x16x32_bf16 a[160:163], a[64:67], a[48:51], a[160:163]
    v_mfma_f32_16x16x32_bf16 a[168:171], a[64:67], a[52:55], a[168:171]
    v_mfma_f32_16x16x32_bf16 a[176:179], a[64:67], a[56:59], a[176:179]
    v_mfma_f32_16x16x32_bf16 a[184:187], a[64:67], a[60:63], a[184:187]
    buffer_load_dwordx4 v18, s[48:51], s82 offen offset:1024 lds
    v_mfma_f32_16x16x32_bf16 v[120:123], a[64:67], a[116:119], v[120:123]
    v_mfma_f32_16x16x32_bf16 a[132:135], a[68:71], a[32:35], a[132:135]
    v_mfma_f32_16x16x32_bf16 a[140:143], a[68:71], a[36:39], a[140:143]
    v_mfma_f32_16x16x32_bf16 a[148:151], a[68:71], a[40:43], a[148:151]
    s_mov_b32 s83, 229376
    s_add_u32 m0, s3, 8192
    v_mfma_f32_16x16x32_bf16 a[156:159], a[68:71], a[44:47], a[156:159]
    buffer_load_dwordx4 v17, s[48:51], s83 offen lds
    v_mfma_f32_16x16x32_bf16 a[164:167], a[68:71], a[48:51], a[164:167]
    v_mfma_f32_16x16x32_bf16 a[172:175], a[68:71], a[52:55], a[172:175]
    v_mfma_f32_16x16x32_bf16 a[180:183], a[68:71], a[56:59], a[180:183]
    v_mfma_f32_16x16x32_bf16 a[188:191], a[68:71], a[60:63], a[188:191]
    buffer_load_dwordx4 v18, s[48:51], s83 offen offset:1024 lds
    v_mfma_f32_16x16x32_bf16 v[124:127], a[68:71], a[116:119], v[124:127]
    v_mfma_f32_16x16x32_bf16 v[52:55], a[32:35], a[72:75], v[52:55]
    v_mfma_f32_16x16x32_bf16 v[56:59], a[36:39], a[72:75], v[56:59]
    v_mfma_f32_16x16x32_bf16 v[60:63], a[40:43], a[72:75], v[60:63]
    s_mov_b32 s82, 458752
    s_add_u32 m0, s3, 16384
    v_mfma_f32_16x16x32_bf16 v[64:67], a[44:47], a[72:75], v[64:67]
    buffer_load_dwordx4 v17, s[48:51], s82 offen lds
    v_mfma_f32_16x16x32_bf16 v[68:71], a[48:51], a[72:75], v[68:71]
    v_mfma_f32_16x16x32_bf16 v[72:75], a[52:55], a[72:75], v[72:75]
    v_mfma_f32_16x16x32_bf16 v[76:79], a[56:59], a[72:75], v[76:79]
    v_mfma_f32_16x16x32_bf16 v[80:83], a[60:63], a[72:75], v[80:83]
    buffer_load_dwordx4 v18, s[48:51], s82 offen offset:1024 lds
    v_mfma_f32_16x16x32_bf16 v[48:51], a[116:119], a[72:75], v[48:51]
    v_mfma_f32_16x16x32_bf16 v[88:91], a[32:35], a[76:79], v[88:91]
    v_mfma_f32_16x16x32_bf16 v[92:95], a[36:39], a[76:79], v[92:95]
    v_mfma_f32_16x16x32_bf16 v[96:99], a[40:43], a[76:79], v[96:99]
    s_mov_b32 s83, 688128
    s_add_u32 m0, s3, 24576
    v_mfma_f32_16x16x32_bf16 v[100:103], a[44:47], a[76:79], v[100:103]
    buffer_load_dwordx4 v17, s[48:51], s83 offen lds
    v_mfma_f32_16x16x32_bf16 v[104:107], a[48:51], a[76:79], v[104:107]
    v_mfma_f32_16x16x32_bf16 v[108:111], a[52:55], a[76:79], v[108:111]
    v_mfma_f32_16x16x32_bf16 v[112:115], a[56:59], a[76:79], v[112:115]
    v_mfma_f32_16x16x32_bf16 v[116:119], a[60:63], a[76:79], v[116:119]
    buffer_load_dwordx4 v18, s[48:51], s83 offen offset:1024 lds
    v_mfma_f32_16x16x32_bf16 v[84:87], a[116:119], a[76:79], v[84:87]
    v_mfma_f32_16x16x32_bf16 a[192:195], a[80:83], a[32:35], a[192:195]
    v_mfma_f32_16x16x32_bf16 a[200:203], a[80:83], a[36:39], a[200:203]
    v_mfma_f32_16x16x32_bf16 a[208:211], a[80:83], a[40:43], a[208:211]
    s_mov_b32 s82, 917504
    s_add_u32 m0, s3, 32768
    v_mfma_f32_16x16x32_bf16 a[216:219], a[80:83], a[44:47], a[216:219]
    buffer_load_dwordx4 v17, s[48:51], s82 offen lds
    v_mfma_f32_16x16x32_bf16 a[224:227], a[80:83], a[48:51], a[224:227]
    v_mfma_f32_16x16x32_bf16 a[232:235], a[80:83], a[52:55], a[232:235]
    v_mfma_f32_16x16x32_bf16 a[240:243], a[80:83], a[56:59], a[240:243]
    v_mfma_f32_16x16x32_bf16 a[248:251], a[80:83], a[60:63], a[248:251]
    buffer_load_dwordx4 v18, s[48:51], s82 offen offset:1024 lds
    v_mfma_f32_16x16x32_bf16 a[196:199], a[84:87], a[32:35], a[196:199]
    v_mfma_f32_16x16x32_bf16 a[204:207], a[84:87], a[36:39], a[204:207]
    v_mfma_f32_16x16x32_bf16 a[212:215], a[84:87], a[40:43], a[212:215]
    v_mfma_f32_16x16x32_bf16 a[220:223], a[84:87], a[44:47], a[220:223]
    s_mov_b32 s83, 1146880
    s_add_u32 m0, s3, 40960
    v_mfma_f32_16x16x32_bf16 a[228:231], a[84:87], a[48:51], a[228:231]
    buffer_load_dwordx4 v17, s[48:51], s83 offen lds
    v_mfma_f32_16x16x32_bf16 a[236:239], a[84:87], a[52:55], a[236:239]
    v_mfma_f32_16x16x32_bf16 a[244:247], a[84:87], a[56:59], a[244:247]
    v_mfma_f32_16x16x32_bf16 a[252:255], a[84:87], a[60:63], a[252:255]
    v_mfma_f32_16x16x32_bf16 v[128:131], a[88:91], a[32:35], v[128:131]
    buffer_load_dwordx4 v18, s[48:51], s83 offen offset:1024 lds
    v_mfma_f32_16x16x32_bf16 v[144:147], a[88:91], a[36:39], v[144:147]
    v_mfma_f32_16x16x32_bf16 v[160:163], a[88:91], a[40:43], v[160:163]
    v_mfma_f32_16x16x32_bf16 v[176:179], a[88:91], a[44:47], v[176:179]
    v_mfma_f32_16x16x32_bf16 v[192:195], a[88:91], a[48:51], v[192:195]
    s_mov_b32 s82, 1376256
    s_add_u32 m0, s3, 49152
    v_mfma_f32_16x16x32_bf16 v[208:211], a[88:91], a[52:55], v[208:211]
    buffer_load_dwordx4 v17, s[48:51], s82 offen lds
    v_mfma_f32_16x16x32_bf16 v[224:227], a[88:91], a[56:59], v[224:227]
    v_mfma_f32_16x16x32_bf16 v[240:243], a[88:91], a[60:63], v[240:243]
    v_mfma_f32_16x16x32_bf16 v[132:135], a[92:95], a[32:35], v[132:135]
    v_mfma_f32_16x16x32_bf16 v[148:151], a[92:95], a[36:39], v[148:151]
    buffer_load_dwordx4 v18, s[48:51], s82 offen offset:1024 lds
    v_mfma_f32_16x16x32_bf16 v[164:167], a[92:95], a[40:43], v[164:167]
    v_mfma_f32_16x16x32_bf16 v[180:183], a[92:95], a[44:47], v[180:183]
    v_mfma_f32_16x16x32_bf16 v[196:199], a[92:95], a[48:51], v[196:199]
    v_mfma_f32_16x16x32_bf16 v[212:215], a[92:95], a[52:55], v[212:215]
    s_mov_b32 s83, 1605632
    s_add_u32 m0, s3, 57344
    v_mfma_f32_16x16x32_bf16 v[228:231], a[92:95], a[56:59], v[228:231]
    buffer_load_dwordx4 v17, s[48:51], s83 offen lds
    v_mfma_f32_16x16x32_bf16 v[244:247], a[92:95], a[60:63], v[244:247]
    v_mfma_f32_16x16x32_bf16 v[136:139], a[104:107], a[32:35], v[136:139]
    v_mfma_f32_16x16x32_bf16 v[152:155], a[104:107], a[36:39], v[152:155]
    v_mfma_f32_16x16x32_bf16 v[168:171], a[104:107], a[40:43], v[168:171]
    buffer_load_dwordx4 v18, s[48:51], s83 offen offset:1024 lds
    v_mfma_f32_16x16x32_bf16 v[184:187], a[104:107], a[44:47], v[184:187]
    v_mfma_f32_16x16x32_bf16 v[200:203], a[104:107], a[48:51], v[200:203]
    v_mfma_f32_16x16x32_bf16 v[216:219], a[104:107], a[52:55], v[216:219]
    v_mfma_f32_16x16x32_bf16 v[232:235], a[104:107], a[56:59], v[232:235]
    v_mfma_f32_16x16x32_bf16 v[248:251], a[104:107], a[60:63], v[248:251]
    v_mfma_f32_16x16x32_bf16 v[140:143], a[108:111], a[32:35], v[140:143]
    v_mfma_f32_16x16x32_bf16 v[156:159], a[108:111], a[36:39], v[156:159]
    v_mfma_f32_16x16x32_bf16 v[172:175], a[108:111], a[40:43], v[172:175]
    v_mfma_f32_16x16x32_bf16 v[188:191], a[108:111], a[44:47], v[188:191]
    v_mfma_f32_16x16x32_bf16 v[204:207], a[108:111], a[48:51], v[204:207]
    v_mfma_f32_16x16x32_bf16 v[220:223], a[108:111], a[52:55], v[220:223]
    v_mfma_f32_16x16x32_bf16 v[236:239], a[108:111], a[56:59], v[236:239]
    v_mfma_f32_16x16x32_bf16 v[252:255], a[108:111], a[60:63], v[252:255]
    s_branch L_epi
L_g1_1:
    s_add_u32 m0, s78, 8192
    s_nop 0
    buffer_load_dwordx4 v1, s[28:31], s77 offen offset:2048 sc1 lds
    v_add_u32_e64 v1, 64, v1
    s_add_u32 m0, s78, 47104
    s_nop 0
    buffer_load_dwordx4 v1, s[28:31], s77 offen offset:2048 sc1 lds
    v_add_u32_e64 v1, 64, v1
    s_add_u32 m0, s78, 86016
    s_nop 0
    buffer_load_dwordx4 v1, s[28:31], s77 offen offset:2048 sc1 lds
    v_add_u32_e64 v1, 64, v1
    s_add_u32 m0, s78, 124928
    s_nop 0
    buffer_load_dwordx4 v1, s[28:31], s77 offen offset:2048 sc1 lds
    v_add_u32_e64 v1, 64, v1
    s_waitcnt vmcnt(0)
    s_barrier
    ds_read_b64_tr_b16 a[64:65], v12 offset:0
    ds_read_b64_tr_b16 a[66:67], v12 offset:256
    ds_read_b64_tr_b16 a[68:69], v14 offset:0
    ds_read_b64_tr_b16 a[70:71], v14 offset:256
    ds_read_b64_tr_b16 a[72:73], v12 offset:1024
    ds_read_b64_tr_b16 a[74:75], v12 offset:1280
    ds_read_b64_tr_b16 a[76:77], v14 offset:1024
    ds_read_b64_tr_b16 a[78:79], v14 offset:1280
    ds_read_b64_tr_b16 a[80:81], v12 offset:2048
    ds_read_b64_tr_b16 a[82:83], v12 offset:2304
    ds_read_b64_tr_b16 a[84:85], v14 offset:2048
    ds_read_b64_tr_b16 a[86:87], v14 offset:2304
    ds_read_b64_tr_b16 a[88:89], v12 offset:3072
    ds_read_b64_tr_b16 a[90:91], v12 offset:3328
    ds_read_b64_tr_b16 a[92:93], v14 offset:3072
    ds_read_b64_tr_b16 a[94:95], v14 offset:3328
    ds_read_b64_tr_b16 a[96:97], v12 offset:4096
    ds_read_b64_tr_b16 a[98:99], v12 offset:4352
    ds_read_b64_tr_b16 a[100:101], v14 offset:4096
    ds_read_b64_tr_b16 a[102:103], v14 offset:4352
    ds_read_b128 a[0:3], v8 offset:0
    ds_read_b128 a[4:7], v8 offset:1024
    ds_read_b128 a[8:11], v8 offset:2048
    ds_read_b128 a[12:15], v8 offset:3072
    ds_read_b128 a[16:19], v8 offset:4096
    ds_read_b128 a[20:23], v8 offset:5120
    ds_read_b128 a[24:27], v8 offset:6144
    ds_read_b128 a[28:31], v8 offset:7168
    s_mov_b32 s67, 7
    v_mov_b32 v20, 0x7ff00000
.p2align 3
L_loop1:
    s_waitcnt vmcnt(25) lgkmcnt(0)
    s_barrier
    v_mfma_f32_16x16x32_bf16 v[128:131], a[64:67], a[0:3], v[128:131]
    s_add_u32 m0, s78, 0
    v_mfma_f32_16x16x32_bf16 v[144:147], a[64:67], a[4:7], v[144:147]
    buffer_load_dwordx4 v2, s[32:35], s68 offen offset:0 lds
    v_mfma_f32_16x16x32_bf16 v[160:163], a[64:67], a[8:11], v[160:163]
    ds_read_b128 a[32:35], v8 offset:38912
    v_mfma_f32_16x16x32_bf16 v[176:179], a[64:67], a[12:15], v[176:179]
    v_mfma_f32_16x16x32_bf16 v[192:195], a[64:67], a[16:19], v[192:195]
    v_mfma_f32_16x16x32_bf16 v[208:211], a[64:67], a[20:23], v[208:211]
    v_mfma_f32_16x16x32_bf16 v[224:227], a[64:67], a[24:27], v[224:227]
    ds_read_b128 a[36:39], v8 offset:39936
    v_mfma_f32_16x16x32_bf16 v[240:243], a[64:67], a[28:31], v[240:243]
    ds_read_b64_tr_b16 a[64:65], v12 offset:38912
    buffer_load_dwordx4 v2, s[32:35], s69 offen offset:1024 lds
    v_mfma_f32_16x16x32_bf16 v[132:135], a[68:71], a[0:3], v[132:135]
    ds_read_b64_tr_b16 a[66:67], v12 offset:39168
    v_mfma_f32_16x16x32_bf16 v[148:151], a[68:71], a[4:7], v[148:151]
    v_mfma_f32_16x16x32_bf16 v[164:167], a[68:71], a[8:11], v[164:167]
    ds_read_b128 a[40:43], v8 offset:40960
    v_mfma_f32_16x16x32_bf16 v[180:183], a[68:71], a[12:15], v[180:183]
    v_mfma_f32_16x16x32_bf16 v[196:199], a[68:71], a[16:19], v[196:199]
    v_mfma_f32_16x16x32_bf16 v[212:215], a[68:71], a[20:23], v[212:215]
    buffer_load_dwordx4 v2, s[32:35], s70 offen offset:2048 lds
    v_add_u32 v2, 196608, v2
    v_mfma_f32_16x16x32_bf16 v[228:231], a[68:71], a[24:27], v[228:231]
    ds_read_b128 a[44:47], v8 offset:41984
    v_mfma_f32_16x16x32_bf16 v[244:247], a[68:71], a[28:31], v[244:247]
    ds_read_b64_tr_b16 a[68:69], v14 offset:38912
    v_mfma_f32_16x16x32_bf16 v[136:139], a[72:75], a[0:3], v[136:139]
    ds_read_b64_tr_b16 a[70:71], v14 offset:39168
    v_mfma_f32_16x16x32_bf16 v[152:155], a[72:75], a[4:7], v[152:155]
    v_mfma_f32_16x16x32_bf16 v[168:171], a[72:75], a[8:11], v[168:171]
    ds_read_b128 a[48:51], v8 offset:43008
    v_mfma_f32_16x16x32_bf16 v[184:187], a[72:75], a[12:15], v[184:187]
    buffer_load_dwordx4 v3, s[36:39], s71 offen offset:3072 lds
    v_mfma_f32_16x16x32_bf16 v[200:203], a[72:75], a[16:19], v[200:203]
    v_mfma_f32_16x16x32_bf16 v[216:219], a[72:75], a[20:23], v[216:219]
    v_mfma_f32_16x16x32_bf16 v[232:235], a[72:75], a[24:27], v[232:235]
    ds_read_b128 a[52:55], v8 offset:44032
    v_mfma_f32_16x16x32_bf16 v[248:251], a[72:75], a[28:31], v[248:251]
    ds_read_b64_tr_b16 a[72:73], v12 offset:39936
    v_mfma_f32_16x16x32_bf16 v[140:143], a[76:79], a[0:3], v[140:143]
    ds_read_b64_tr_b16 a[74:75], v12 offset:40192
    s_add_u32 m0, s78, 4096
    v_mfma_f32_16x16x32_bf16 v[156:159], a[76:79], a[4:7], v[156:159]
    buffer_load_dwordx4 v3, s[40:43], s72 offen offset:0 lds
    v_mfma_f32_16x16x32_bf16 v[172:175], a[76:79], a[8:11], v[172:175]
    ds_read_b128 a[56:59], v8 offset:45056
    v_mfma_f32_16x16x32_bf16 v[188:191], a[76:79], a[12:15], v[188:191]
    v_mfma_f32_16x16x32_bf16 v[204:207], a[76:79], a[16:19], v[204:207]
    v_mfma_f32_16x16x32_bf16 v[220:223], a[76:79], a[20:23], v[220:223]
    v_mfma_f32_16x16x32_bf16 v[236:239], a[76:79], a[24:27], v[236:239]
    ds_read_b128 a[60:63], v8 offset:46080
    v_mfma_f32_16x16x32_bf16 v[252:255], a[76:79], a[28:31], v[252:255]
    ds_read_b64_tr_b16 a[76:77], v14 offset:39936
    buffer_load_dwordx4 v3, s[36:39], s73 offen offset:1024 lds
    v_mfma_f32_16x16x32_bf16 a[128:131], a[80:83], a[0:3], a[128:131]
    ds_read_b64_tr_b16 a[78:79], v14 offset:40192
    v_mfma_f32_16x16x32_bf16 a[144:147], a[80:83], a[4:7], a[144:147]
    v_mfma_f32_16x16x32_bf16 a[160:163], a[80:83], a[8:11], a[160:163]
    ds_read_b64_tr_b16 a[104:105], v12 offset:43008
    v_mfma_f32_16x16x32_bf16 a[176:179], a[80:83], a[12:15], a[176:179]
    v_mfma_f32_16x16x32_bf16 a[192:195], a[80:83], a[16:19], a[192:195]
    v_mfma_f32_16x16x32_bf16 a[208:211], a[80:83], a[20:23], a[208:211]
    buffer_load_dwordx4 v3, s[40:43], s74 offen offset:2048 lds
    v_mfma_f32_16x16x32_bf16 a[224:227], a[80:83], a[24:27], a[224:227]
    ds_read_b64_tr_b16 a[106:107], v12 offset:43264
    v_mfma_f32_16x16x32_bf16 a[240:243], a[80:83], a[28:31], a[240:243]
    ds_read_b64_tr_b16 a[80:81], v12 offset:40960
    v_mfma_f32_16x16x32_bf16 a[132:135], a[84:87], a[0:3], a[132:135]
    ds_read_b64_tr_b16 a[82:83], v12 offset:41216
    v_mfma_f32_16x16x32_bf16 a[148:151], a[84:87], a[4:7], a[148:151]
    v_mfma_f32_16x16x32_bf16 a[164:167], a[84:87], a[8:11], a[164:167]
    ds_read_b64_tr_b16 a[108:109], v14 offset:43008
    v_mfma_f32_16x16x32_bf16 a[180:183], a[84:87], a[12:15], a[180:183]
    buffer_load_dwordx4 v3, s[36:39], s75 offen offset:3072 lds
    v_mfma_f32_16x16x32_bf16 a[196:199], a[84:87], a[16:19], a[196:199]
    v_mfma_f32_16x16x32_bf16 a[212:215], a[84:87], a[20:23], a[212:215]
    v_mfma_f32_16x16x32_bf16 a[228:231], a[84:87], a[24:27], a[228:231]
    ds_read_b64_tr_b16 a[110:111], v14 offset:43264
    v_mfma_f32_16x16x32_bf16 a[244:247], a[84:87], a[28:31], a[244:247]
    ds_read_b64_tr_b16 a[84:85], v14 offset:40960
    v_mfma_f32_16x16x32_bf16 a[136:139], a[88:91], a[0:3], a[136:139]
    ds_read_b64_tr_b16 a[86:87], v14 offset:41216
    s_add_u32 m0, s78, 8192
    v_mfma_f32_16x16x32_bf16 a[152:155], a[88:91], a[4:7], a[152:155]
    buffer_load_dwordx4 v3, s[40:43], s76 offen offset:0 lds
    v_add_u32 v3, 229376, v3
    v_mfma_f32_16x16x32_bf16 a[168:171], a[88:91], a[8:11], a[168:171]
    v_mfma_f32_16x16x32_bf16 a[184:187], a[88:91], a[12:15], a[184:187]
    v_mfma_f32_16x16x32_bf16 a[200:203], a[88:91], a[16:19], a[200:203]
    v_mfma_f32_16x16x32_bf16 a[216:219], a[88:91], a[20:23], a[216:219]
    v_mfma_f32_16x16x32_bf16 a[232:235], a[88:91], a[24:27], a[232:235]
    v_mfma_f32_16x16x32_bf16 a[248:251], a[88:91], a[28:31], a[248:251]
    ds_read_b64_tr_b16 a[88:89], v12 offset:41984
    global_load_lds_dwordx4 v[4:5], off offset:1024
    v_lshl_add_u64 v[4:5], v[4:5], 0, s[80:81]
    v_mfma_f32_16x16x32_bf16 a[140:143], a[92:95], a[0:3], a[140:143]
    ds_read_b64_tr_b16 a[90:91], v12 offset:42240
    v_mfma_f32_16x16x32_bf16 a[156:159], a[92:95], a[4:7], a[156:159]
    v_mfma_f32_16x16x32_bf16 a[172:175], a[92:95], a[8:11], a[172:175]
    v_mfma_f32_16x16x32_bf16 a[188:191], a[92:95], a[12:15], a[188:191]
    v_mfma_f32_16x16x32_bf16 a[204:207], a[92:95], a[16:19], a[204:207]
    v_mfma_f32_16x16x32_bf16 a[220:223], a[92:95], a[20:23], a[220:223]
    buffer_load_dwordx4 v1, s[28:31], s77 offen offset:2048 sc1 lds
    v_add_u32_e64 v1, 64, v1
    v_mfma_f32_16x16x32_bf16 a[236:239], a[92:95], a[24:27], a[236:239]
    v_mfma_f32_16x16x32_bf16 a[252:255], a[92:95], a[28:31], a[252:255]
    ds_read_b64_tr_b16 a[92:93], v14 offset:41984
    buffer_load_dword v7, v6, s[44:47], s4 offen
    v_mfma_f32_16x16x32_bf16 v[48:51], a[96:99], a[0:3], v[48:51]
    ds_read_b64_tr_b16 a[94:95], v14 offset:42240
    v_mfma_f32_16x16x32_bf16 v[52:55], a[96:99], a[4:7], v[52:55]
    v_mfma_f32_16x16x32_bf16 v[64:67], a[96:99], a[8:11], v[64:67]
    v_mfma_f32_16x16x32_bf16 v[68:71], a[96:99], a[12:15], v[68:71]
    v_mfma_f32_16x16x32_bf16 v[80:83], a[96:99], a[16:19], v[80:83]
    v_mfma_f32_16x16x32_bf16 v[84:87], a[96:99], a[20:23], v[84:87]
    v_mfma_f32_16x16x32_bf16 v[96:99], a[96:99], a[24:27], v[96:99]
    v_mfma_f32_16x16x32_bf16 v[100:103], a[96:99], a[28:31], v[100:103]
    v_mfma_f32_16x16x32_bf16 v[56:59], a[100:103], a[0:3], v[56:59]
    v_mfma_f32_16x16x32_bf16 v[60:63], a[100:103], a[4:7], v[60:63]
    v_mfma_f32_16x16x32_bf16 v[72:75], a[100:103], a[8:11], v[72:75]
    v_mfma_f32_16x16x32_bf16 v[76:79], a[100:103], a[12:15], v[76:79]
    v_mfma_f32_16x16x32_bf16 v[88:91], a[100:103], a[16:19], v[88:91]
    v_mfma_f32_16x16x32_bf16 v[92:95], a[100:103], a[20:23], v[92:95]
    v_mfma_f32_16x16x32_bf16 v[104:107], a[100:103], a[24:27], v[104:107]
    v_mfma_f32_16x16x32_bf16 v[108:111], a[100:103], a[28:31], v[108:111]
    s_waitcnt vmcnt(25) lgkmcnt(0)
    s_barrier
    v_mfma_f32_16x16x32_bf16 v[128:131], a[64:67], a[32:35], v[128:131]
    s_add_u32 m0, s78, 38912
    v_mfma_f32_16x16x32_bf16 v[144:147], a[64:67], a[36:39], v[144:147]
    buffer_load_dwordx4 v2, s[32:35], s68 offen offset:0 lds
    v_mfma_f32_16x16x32_bf16 v[160:163], a[64:67], a[40:43], v[160:163]
    ds_read_b128 a[0:3], v9 offset:0
    v_mfma_f32_16x16x32_bf16 v[176:179], a[64:67], a[44:47], v[176:179]
    v_mfma_f32_16x16x32_bf16 v[192:195], a[64:67], a[48:51], v[192:195]
    v_mfma_f32_16x16x32_bf16 v[208:211], a[64:67], a[52:55], v[208:211]
    v_mfma_f32_16x16x32_bf16 v[224:227], a[64:67], a[56:59], v[224:227]
    ds_read_b128 a[4:7], v9 offset:1024
    v_mfma_f32_16x16x32_bf16 v[240:243], a[64:67], a[60:63], v[240:243]
    ds_read_b64_tr_b16 a[64:65], v13 offset:0
    buffer_load_dwordx4 v2, s[32:35], s69 offen offset:1024 lds
    v_mfma_f32_16x16x32_bf16 v[132:135], a[68:71], a[32:35], v[132:135]
    ds_read_b64_tr_b16 a[66:67], v13 offset:256
    v_mfma_f32_16x16x32_bf16 v[148:151], a[68:71], a[36:39], v[148:151]
    v_mfma_f32_16x16x32_bf16 v[164:167], a[68:71], a[40:43], v[164:167]
    ds_read_b128 a[8:11], v9 offset:2048
    v_mfma_f32_16x16x32_bf16 v[180:183], a[68:71], a[44:47], v[180:183]
    v_mfma_f32_16x16x32_bf16 v[196:199], a[68:71], a[48:51], v[196:199]
    v_mfma_f32_16x16x32_bf16 v[212:215], a[68:71], a[52:55], v[212:215]
    buffer_load_dwordx4 v2, s[32:35], s70 offen offset:2048 lds
    v_add_u32 v2, 196608, v2
    v_mfma_f32_16x16x32_bf16 v[228:231], a[68:71], a[56:59], v[228:231]
    ds_read_b128 a[12:15], v9 offset:3072
    v_mfma_f32_16x16x32_bf16 v[244:247], a[68:71], a[60:63], v[244:247]
    ds_read_b64_tr_b16 a[68:69], v15 offset:0
    v_mfma_f32_16x16x32_bf16 v[136:139], a[72:75], a[32:35], v[136:139]
    ds_read_b64_tr_b16 a[70:71], v15 offset:256
    v_mfma_f32_16x16x32_bf16 v[152:155], a[72:75], a[36:39], v[152:155]
    v_mfma_f32_16x16x32_bf16 v[168:171], a[72:75], a[40:43], v[168:171]
    ds_read_b128 a[16:19], v9 offset:4096
    v_mfma_f32_16x16x32_bf16 v[184:187], a[72:75], a[44:47], v[184:187]
    buffer_load_dwordx4 v3, s[36:39], s71 offen offset:3072 lds
    v_mfma_f32_16x16x32_bf16 v[200:203], a[72:75], a[48:51], v[200:203]
    v_mfma_f32_16x16x32_bf16 v[216:219], a[72:75], a[52:55], v[216:219]
    v_mfma_f32_16x16x32_bf16 v[232:235], a[72:75], a[56:59], v[232:235]
    ds_read_b128 a[20:23], v9 offset:5120
    v_mfma_f32_16x16x32_bf16 v[248:251], a[72:75], a[60:63], v[248:251]
    ds_read_b64_tr_b16 a[72:73], v13 offset:1024
    v_mfma_f32_16x16x32_bf16 v[140:143], a[76:79], a[32:35], v[140:143]
    ds_read_b64_tr_b16 a[74:75], v13 offset:1280
    s_add_u32 m0, s78, 43008
    v_mfma_f32_16x16x32_bf16 v[156:159], a[76:79], a[36:39], v[156:159]
    buffer_load_dwordx4 v3, s[40:43], s72 offen offset:0 lds
    v_mfma_f32_16x16x32_bf16 v[172:175], a[76:79], a[40:43], v[172:175]
    ds_read_b128 a[24:27], v9 offset:6144
    v_mfma_f32_16x16x32_bf16 v[188:191], a[76:79], a[44:47], v[188:191]
    v_mfma_f32_16x16x32_bf16 v[204:207], a[76:79], a[48:51], v[204:207]
    v_mfma_f32_16x16x32_bf16 v[220:223], a[76:79], a[52:55], v[220:223]
    v_mfma_f32_16x16x32_bf16 v[236:239], a[76:79], a[56:59], v[236:239]
    ds_read_b128 a[28:31], v9 offset:7168
    v_mfma_f32_16x16x32_bf16 v[252:255], a[76:79], a[60:63], v[252:255]
    ds_read_b64_tr_b16 a[76:77], v15 offset:1024
    buffer_load_dwordx4 v3, s[36:39], s73 offen offset:1024 lds
    v_mfma_f32_16x16x32_bf16 a[128:131], a[80:83], a[32:35], a[128:131]
    ds_read_b64_tr_b16 a[78:79], v15 offset:1280
    v_mfma_f32_16x16x32_bf16 a[144:147], a[80:83], a[36:39], a[144:147]
    v_mfma_f32_16x16x32_bf16 a[160:163], a[80:83], a[40:43], a[160:163]
    ds_read_b64_tr_b16 a[96:97], v13 offset:4096
    v_mfma_f32_16x16x32_bf16 a[176:179], a[80:83], a[44:47], a[176:179]
    v_mfma_f32_16x16x32_bf16 a[192:195], a[80:83], a[48:51], a[192:195]
    v_mfma_f32_16x16x32_bf16 a[208:211], a[80:83], a[52:55], a[208:211]
    buffer_load_dwordx4 v3, s[40:43], s74 offen offset:2048 lds
    v_mfma_f32_16x16x32_bf16 a[224:227], a[80:83], a[56:59], a[224:227]
    ds_read_b64_tr_b16 a[98:99], v13 offset:4352
    v_mfma_f32_16x16x32_bf16 a[240:243], a[80:83], a[60:63], a[240:243]
    ds_read_b64_tr_b16 a[80:81], v13 offset:2048
    v_mfma_f32_16x16x32_bf16 a[132:135], a[84:87], a[32:35], a[132:135]
    ds_read_b64_tr_b16 a[82:83], v13 offset:2304
    v_mfma_f32_16x16x32_bf16 a[148:151], a[84:87], a[36:39], a[148:151]
    v_mfma_f32_16x16x32_bf16 a[164:167], a[84:87], a[40:43], a[164:167]
    ds_read_b64_tr_b16 a[100:101], v15 offset:4096
    v_mfma_f32_16x16x32_bf16 a[180:183], a[84:87], a[44:47], a[180:183]
    buffer_load_dwordx4 v3, s[36:39], s75 offen offset:3072 lds
    v_mfma_f32_16x16x32_bf16 a[196:199], a[84:87], a[48:51], a[196:199]
    v_mfma_f32_16x16x32_bf16 a[212:215], a[84:87], a[52:55], a[212:215]
    v_mfma_f32_16x16x32_bf16 a[228:231], a[84:87], a[56:59], a[228:231]
    ds_read_b64_tr_b16 a[102:103], v15 offset:4352
    v_mfma_f32_16x16x32_bf16 a[244:247], a[84:87], a[60:63], a[244:247]
    ds_read_b64_tr_b16 a[84:85], v15 offset:2048
    v_mfma_f32_16x16x32_bf16 a[136:139], a[88:91], a[32:35], a[136:139]
    ds_read_b64_tr_b16 a[86:87], v15 offset:2304
    s_add_u32 m0, s78, 47104
    v_mfma_f32_16x16x32_bf16 a[152:155], a[88:91], a[36:39], a[152:155]
    buffer_load_dwordx4 v3, s[40:43], s76 offen offset:0 lds
    v_add_u32 v3, 229376, v3
    v_mfma_f32_16x16x32_bf16 a[168:171], a[88:91], a[40:43], a[168:171]
    v_mfma_f32_16x16x32_bf16 a[184:187], a[88:91], a[44:47], a[184:187]
    v_mfma_f32_16x16x32_bf16 a[200:203], a[88:91], a[48:51], a[200:203]
    v_mfma_f32_16x16x32_bf16 a[216:219], a[88:91], a[52:55], a[216:219]
    v_mfma_f32_16x16x32_bf16 a[232:235], a[88:91], a[56:59], a[232:235]
    v_mfma_f32_16x16x32_bf16 a[248:251], a[88:91], a[60:63], a[248:251]
    ds_read_b64_tr_b16 a[88:89], v13 offset:3072
    global_load_lds_dwordx4 v[4:5], off offset:1024
    v_lshl_add_u64 v[4:5], v[4:5], 0, s[80:81]
    v_mfma_f32_16x16x32_bf16 a[140:143], a[92:95], a[32:35], a[140:143]
    ds_read_b64_tr_b16 a[90:91], v13 offset:3328
    v_mfma_f32_16x16x32_bf16 a[156:159], a[92:95], a[36:39], a[156:159]
    v_mfma_f32_16x16x32_bf16 a[172:175], a[92:95], a[40:43], a[172:175]
    v_mfma_f32_16x16x32_bf16 a[188:191], a[92:95], a[44:47], a[188:191]
    v_mfma_f32_16x16x32_bf16 a[204:207], a[92:95], a[48:51], a[204:207]
    v_mfma_f32_16x16x32_bf16 a[220:223], a[92:95], a[52:55], a[220:223]
    buffer_load_dwordx4 v1, s[28:31], s77 offen offset:2048 sc1 lds
    v_add_u32_e64 v1, 64, v1
    v_mfma_f32_16x16x32_bf16 a[236:239], a[92:95], a[56:59], a[236:239]
    v_mfma_f32_16x16x32_bf16 a[252:255], a[92:95], a[60:63], a[252:255]
    ds_read_b64_tr_b16 a[92:93], v15 offset:3072
    buffer_load_dword v7, v6, s[44:47], s5 offen
    v_add_u32_e64 v6, s79, v6
    v_mfma_f32_16x16x32_bf16 v[48:51], a[104:107], a[32:35], v[48:51]
    ds_read_b64_tr_b16 a[94:95], v15 offset:3328
    v_mfma_f32_16x16x32_bf16 v[52:55], a[104:107], a[36:39], v[52:55]
    v_mfma_f32_16x16x32_bf16 v[64:67], a[104:107], a[40:43], v[64:67]
    v_mfma_f32_16x16x32_bf16 v[68:71], a[104:107], a[44:47], v[68:71]
    v_mfma_f32_16x16x32_bf16 v[80:83], a[104:107], a[48:51], v[80:83]
    v_mfma_f32_16x16x32_bf16 v[84:87], a[104:107], a[52:55], v[84:87]
    v_mfma_f32_16x16x32_bf16 v[96:99], a[104:107], a[56:59], v[96:99]
    v_mfma_f32_16x16x32_bf16 v[100:103], a[104:107], a[60:63], v[100:103]
    v_mfma_f32_16x16x32_bf16 v[56:59], a[108:111], a[32:35], v[56:59]
    v_mfma_f32_16x16x32_bf16 v[60:63], a[108:111], a[36:39], v[60:63]
    v_mfma_f32_16x16x32_bf16 v[72:75], a[108:111], a[40:43], v[72:75]
    v_mfma_f32_16x16x32_bf16 v[76:79], a[108:111], a[44:47], v[76:79]
    v_mfma_f32_16x16x32_bf16 v[88:91], a[108:111], a[48:51], v[88:91]
    v_mfma_f32_16x16x32_bf16 v[92:95], a[108:111], a[52:55], v[92:95]
    v_mfma_f32_16x16x32_bf16 v[104:107], a[108:111], a[56:59], v[104:107]
    v_mfma_f32_16x16x32_bf16 v[108:111], a[108:111], a[60:63], v[108:111]
    s_waitcnt vmcnt(25) lgkmcnt(0)
    s_barrier
    v_mfma_f32_16x16x32_bf16 v[128:131], a[64:67], a[0:3], v[128:131]
    s_add_u32 m0, s78, 77824
    v_mfma_f32_16x16x32_bf16 v[144:147], a[64:67], a[4:7], v[144:147]
    buffer_load_dwordx4 v2, s[32:35], s68 offen offset:0 lds
    v_mfma_f32_16x16x32_bf16 v[160:163], a[64:67], a[8:11], v[160:163]
    ds_read_b128 a[32:35], v9 offset:38912
    v_mfma_f32_16x16x32_bf16 v[176:179], a[64:67], a[12:15], v[176:179]
    v_mfma_f32_16x16x32_bf16 v[192:195], a[64:67], a[16:19], v[192:195]
    v_mfma_f32_16x16x32_bf16 v[208:211], a[64:67], a[20:23], v[208:211]
    v_mfma_f32_16x16x32_bf16 v[224:227], a[64:67], a[24:27], v[224:227]
    ds_read_b128 a[36:39], v9 offset:39936
    v_mfma_f32_16x16x32_bf16 v[240:243], a[64:67], a[28:31], v[240:243]
    ds_read_b64_tr_b16 a[64:65], v13 offset:38912
    buffer_load_dwordx4 v2, s[32:35], s69 offen offset:1024 lds
    v_mfma_f32_16x16x32_bf16 v[132:135], a[68:71], a[0:3], v[132:135]
    ds_read_b64_tr_b16 a[66:67], v13 offset:39168
    v_mfma_f32_16x16x32_bf16 v[148:151], a[68:71], a[4:7], v[148:151]
    v_mfma_f32_16x16x32_bf16 v[164:167], a[68:71], a[8:11], v[164:167]
    ds_read_b128 a[40:43], v9 offset:40960
    v_mfma_f32_16x16x32_bf16 v[180:183], a[68:71], a[12:15], v[180:183]
    v_mfma_f32_16x16x32_bf16 v[196:199], a[68:71], a[16:19], v[196:199]
    v_mfma_f32_16x16x32_bf16 v[212:215], a[68:71], a[20:23], v[212:215]
    buffer_load_dwordx4 v2, s[32:35], s70 offen offset:2048 lds
    v_add_u32 v2, 196608, v2
    v_mfma_f32_16x16x32_bf16 v[228:231], a[68:71], a[24:27], v[228:231]
    ds_read_b128 a[44:47], v9 offset:41984
    v_mfma_f32_16x16x32_bf16 v[244:247], a[68:71], a[28:31], v[244:247]
    ds_read_b64_tr_b16 a[68:69], v15 offset:38912
    v_mfma_f32_16x16x32_bf16 v[136:139], a[72:75], a[0:3], v[136:139]
    ds_read_b64_tr_b16 a[70:71], v15 offset:39168
    v_mfma_f32_16x16x32_bf16 v[152:155], a[72:75], a[4:7], v[152:155]
    v_mfma_f32_16x16x32_bf16 v[168:171], a[72:75], a[8:11], v[168:171]
    ds_read_b128 a[48:51], v9 offset:43008
    v_mfma_f32_16x16x32_bf16 v[184:187], a[72:75], a[12:15], v[184:187]
    buffer_load_dwordx4 v3, s[36:39], s71 offen offset:3072 lds
    v_mfma_f32_16x16x32_bf16 v[200:203], a[72:75], a[16:19], v[200:203]
    v_mfma_f32_16x16x32_bf16 v[216:219], a[72:75], a[20:23], v[216:219]
    v_mfma_f32_16x16x32_bf16 v[232:235], a[72:75], a[24:27], v[232:235]
    ds_read_b128 a[52:55], v9 offset:44032
    v_mfma_f32_16x16x32_bf16 v[248:251], a[72:75], a[28:31], v[248:251]
    ds_read_b64_tr_b16 a[72:73], v13 offset:39936
    v_mfma_f32_16x16x32_bf16 v[140:143], a[76:79], a[0:3], v[140:143]
    ds_read_b64_tr_b16 a[74:75], v13 offset:40192
    s_add_u32 m0, s78, 81920
    v_mfma_f32_16x16x32_bf16 v[156:159], a[76:79], a[4:7], v[156:159]
    buffer_load_dwordx4 v3, s[40:43], s72 offen offset:0 lds
    v_mfma_f32_16x16x32_bf16 v[172:175], a[76:79], a[8:11], v[172:175]
    ds_read_b128 a[56:59], v9 offset:45056
    v_mfma_f32_16x16x32_bf16 v[188:191], a[76:79], a[12:15], v[188:191]
    v_mfma_f32_16x16x32_bf16 v[204:207], a[76:79], a[16:19], v[204:207]
    v_mfma_f32_16x16x32_bf16 v[220:223], a[76:79], a[20:23], v[220:223]
    v_mfma_f32_16x16x32_bf16 v[236:239], a[76:79], a[24:27], v[236:239]
    ds_read_b128 a[60:63], v9 offset:46080
    v_mfma_f32_16x16x32_bf16 v[252:255], a[76:79], a[28:31], v[252:255]
    ds_read_b64_tr_b16 a[76:77], v15 offset:39936
    buffer_load_dwordx4 v3, s[36:39], s73 offen offset:1024 lds
    v_mfma_f32_16x16x32_bf16 a[128:131], a[80:83], a[0:3], a[128:131]
    ds_read_b64_tr_b16 a[78:79], v15 offset:40192
    v_mfma_f32_16x16x32_bf16 a[144:147], a[80:83], a[4:7], a[144:147]
    v_mfma_f32_16x16x32_bf16 a[160:163], a[80:83], a[8:11], a[160:163]
    ds_read_b64_tr_b16 a[104:105], v13 offset:43008
    v_mfma_f32_16x16x32_bf16 a[176:179], a[80:83], a[12:15], a[176:179]
    v_mfma_f32_16x16x32_bf16 a[192:195], a[80:83], a[16:19], a[192:195]
    v_mfma_f32_16x16x32_bf16 a[208:211], a[80:83], a[20:23], a[208:211]
    buffer_load_dwordx4 v3, s[40:43], s74 offen offset:2048 lds
    v_mfma_f32_16x16x32_bf16 a[224:227], a[80:83], a[24:27], a[224:227]
    ds_read_b64_tr_b16 a[106:107], v13 offset:43264
    v_mfma_f32_16x16x32_bf16 a[240:243], a[80:83], a[28:31], a[240:243]
    ds_read_b64_tr_b16 a[80:81], v13 offset:40960
    v_mfma_f32_16x16x32_bf16 a[132:135], a[84:87], a[0:3], a[132:135]
    ds_read_b64_tr_b16 a[82:83], v13 offset:41216
    v_mfma_f32_16x16x32_bf16 a[148:151], a[84:87], a[4:7], a[148:151]
    v_mfma_f32_16x16x32_bf16 a[164:167], a[84:87], a[8:11], a[164:167]
    ds_read_b64_tr_b16 a[108:109], v15 offset:43008
    v_mfma_f32_16x16x32_bf16 a[180:183], a[84:87], a[12:15], a[180:183]
    buffer_load_dwordx4 v3, s[36:39], s75 offen offset:3072 lds
    v_mfma_f32_16x16x32_bf16 a[196:199], a[84:87], a[16:19], a[196:199]
    v_mfma_f32_16x16x32_bf16 a[212:215], a[84:87], a[20:23], a[212:215]
    v_mfma_f32_16x16x32_bf16 a[228:231], a[84:87], a[24:27], a[228:231]
    ds_read_b64_tr_b16 a[110:111], v15 offset:43264
    v_mfma_f32_16x16x32_bf16 a[244:247], a[84:87], a[28:31], a[244:247]
    ds_read_b64_tr_b16 a[84:85], v15 offset:40960
    v_mfma_f32_16x16x32_bf16 a[136:139], a[88:91], a[0:3], a[136:139]
    ds_read_b64_tr_b16 a[86:87], v15 offset:41216
    s_add_u32 m0, s78, 86016
    v_mfma_f32_16x16x32_bf16 a[152:155], a[88:91], a[4:7], a[152:155]
    buffer_load_dwordx4 v3, s[40:43], s76 offen offset:0 lds
    v_add_u32 v3, 229376, v3
    v_mfma_f32_16x16x32_bf16 a[168:171], a[88:91], a[8:11], a[168:171]
    v_mfma_f32_16x16x32_bf16 a[184:187], a[88:91], a[12:15], a[184:187]
    v_mfma_f32_16x16x32_bf16 a[200:203], a[88:91], a[16:19], a[200:203]
    v_mfma_f32_16x16x32_bf16 a[216:219], a[88:91], a[20:23], a[216:219]
    v_mfma_f32_16x16x32_bf16 a[232:235], a[88:91], a[24:27], a[232:235]
    v_mfma_f32_16x16x32_bf16 a[248:251], a[88:91], a[28:31], a[248:251]
    ds_read_b64_tr_b16 a[88:89], v13 offset:41984
    global_load_lds_dwordx4 v[4:5], off offset:1024
    v_lshl_add_u64 v[4:5], v[4:5], 0, s[80:81]
    v_mfma_f32_16x16x32_bf16 a[140:143], a[92:95], a[0:3], a[140:143]
    ds_read_b64_tr_b16 a[90:91], v13 offset:42240
    v_mfma_f32_16x16x32_bf16 a[156:159], a[92:95], a[4:7], a[156:159]
    v_mfma_f32_16x16x32_bf16 a[172:175], a[92:95], a[8:11], a[172:175]
    v_mfma_f32_16x16x32_bf16 a[188:191], a[92:95], a[12:15], a[188:191]
    v_mfma_f32_16x16x32_bf16 a[204:207], a[92:95], a[16:19], a[204:207]
    v_mfma_f32_16x16x32_bf16 a[220:223], a[92:95], a[20:23], a[220:223]
    buffer_load_dwordx4 v1, s[28:31], s77 offen offset:2048 sc1 lds
    v_add_u32_e64 v1, 64, v1
    v_mfma_f32_16x16x32_bf16 a[236:239], a[92:95], a[24:27], a[236:239]
    v_mfma_f32_16x16x32_bf16 a[252:255], a[92:95], a[28:31], a[252:255]
    ds_read_b64_tr_b16 a[92:93], v15 offset:41984
    buffer_load_dword v7, v6, s[44:47], s4 offen
    v_mfma_f32_16x16x32_bf16 v[48:51], a[96:99], a[0:3], v[48:51]
    ds_read_b64_tr_b16 a[94:95], v15 offset:42240
    v_mfma_f32_16x16x32_bf16 v[52:55], a[96:99], a[4:7], v[52:55]
    v_mfma_f32_16x16x32_bf16 v[64:67], a[96:99], a[8:11], v[64:67]
    v_mfma_f32_16x16x32_bf16 v[68:71], a[96:99], a[12:15], v[68:71]
    v_mfma_f32_16x16x32_bf16 v[80:83], a[96:99], a[16:19], v[80:83]
    v_mfma_f32_16x16x32_bf16 v[84:87], a[96:99], a[20:23], v[84:87]
    v_mfma_f32_16x16x32_bf16 v[96:99], a[96:99], a[24:27], v[96:99]
    v_mfma_f32_16x16x32_bf16 v[100:103], a[96:99], a[28:31], v[100:103]
    v_mfma_f32_16x16x32_bf16 v[56:59], a[100:103], a[0:3], v[56:59]
    v_mfma_f32_16x16x32_bf16 v[60:63], a[100:103], a[4:7], v[60:63]
    v_mfma_f32_16x16x32_bf16 v[72:75], a[100:103], a[8:11], v[72:75]
    v_mfma_f32_16x16x32_bf16 v[76:79], a[100:103], a[12:15], v[76:79]
    v_mfma_f32_16x16x32_bf16 v[88:91], a[100:103], a[16:19], v[88:91]
    v_mfma_f32_16x16x32_bf16 v[92:95], a[100:103], a[20:23], v[92:95]
    v_mfma_f32_16x16x32_bf16 v[104:107], a[100:103], a[24:27], v[104:107]
    v_mfma_f32_16x16x32_bf16 v[108:111], a[100:103], a[28:31], v[108:111]
    s_waitcnt vmcnt(25) lgkmcnt(0)
    s_barrier
    v_mfma_f32_16x16x32_bf16 v[128:131], a[64:67], a[32:35], v[128:131]
    s_add_u32 m0, s78, 116736
    v_mfma_f32_16x16x32_bf16 v[144:147], a[64:67], a[36:39], v[144:147]
    buffer_load_dwordx4 v2, s[32:35], s68 offen offset:0 lds
    v_mfma_f32_16x16x32_bf16 v[160:163], a[64:67], a[40:43], v[160:163]
    ds_read_b128 a[0:3], v8 offset:0
    v_mfma_f32_16x16x32_bf16 v[176:179], a[64:67], a[44:47], v[176:179]
    v_mfma_f32_16x16x32_bf16 v[192:195], a[64:67], a[48:51], v[192:195]
    v_mfma_f32_16x16x32_bf16 v[208:211], a[64:67], a[52:55], v[208:211]
    v_mfma_f32_16x16x32_bf16 v[224:227], a[64:67], a[56:59], v[224:227]
    ds_read_b128 a[4:7], v8 offset:1024
    v_mfma_f32_16x16x32_bf16 v[240:243], a[64:67], a[60:63], v[240:243]
    ds_read_b64_tr_b16 a[64:65], v12 offset:0
    buffer_load_dwordx4 v2, s[32:35], s69 offen offset:1024 lds
    v_mfma_f32_16x16x32_bf16 v[132:135], a[68:71], a[32:35], v[132:135]
    ds_read_b64_tr_b16 a[66:67], v12 offset:256
    v_mfma_f32_16x16x32_bf16 v[148:151], a[68:71], a[36:39], v[148:151]
    v_mfma_f32_16x16x32_bf16 v[164:167], a[68:71], a[40:43], v[164:167]
    ds_read_b128 a[8:11], v8 offset:2048
    v_mfma_f32_16x16x32_bf16 v[180:183], a[68:71], a[44:47], v[180:183]
    v_mfma_f32_16x16x32_bf16 v[196:199], a[68:71], a[48:51], v[196:199]
    v_mfma_f32_16x16x32_bf16 v[212:215], a[68:71], a[52:55], v[212:215]
    buffer_load_dwordx4 v2, s[32:35], s70 offen offset:2048 lds
    v_add_u32 v2, 196608, v2
    v_mfma_f32_16x16x32_bf16 v[228:231], a[68:71], a[56:59], v[228:231]
    ds_read_b128 a[12:15], v8 offset:3072
    v_mfma_f32_16x16x32_bf16 v[244:247], a[68:71], a[60:63], v[244:247]
    ds_read_b64_tr_b16 a[68:69], v14 offset:0
    v_mfma_f32_16x16x32_bf16 v[136:139], a[72:75], a[32:35], v[136:139]
    ds_read_b64_tr_b16 a[70:71], v14 offset:256
    v_mfma_f32_16x16x32_bf16 v[152:155], a[72:75], a[36:39], v[152:155]
    v_mfma_f32_16x16x32_bf16 v[168:171], a[72:75], a[40:43], v[168:171]
    ds_read_b128 a[16:19], v8 offset:4096
    v_mfma_f32_16x16x32_bf16 v[184:187], a[72:75], a[44:47], v[184:187]
    buffer_load_dwordx4 v3, s[36:39], s71 offen offset:3072 lds
    v_mfma_f32_16x16x32_bf16 v[200:203], a[72:75], a[48:51], v[200:203]
    v_mfma_f32_16x16x32_bf16 v[216:219], a[72:75], a[52:55], v[216:219]
    v_mfma_f32_16x16x32_bf16 v[232:235], a[72:75], a[56:59], v[232:235]
    ds_read_b128 a[20:23], v8 offset:5120
    v_mfma_f32_16x16x32_bf16 v[248:251], a[72:75], a[60:63], v[248:251]
    ds_read_b64_tr_b16 a[72:73], v12 offset:1024
    v_mfma_f32_16x16x32_bf16 v[140:143], a[76:79], a[32:35], v[140:143]
    ds_read_b64_tr_b16 a[74:75], v12 offset:1280
    s_add_u32 m0, s78, 120832
    v_mfma_f32_16x16x32_bf16 v[156:159], a[76:79], a[36:39], v[156:159]
    buffer_load_dwordx4 v3, s[40:43], s72 offen offset:0 lds
    v_mfma_f32_16x16x32_bf16 v[172:175], a[76:79], a[40:43], v[172:175]
    ds_read_b128 a[24:27], v8 offset:6144
    v_mfma_f32_16x16x32_bf16 v[188:191], a[76:79], a[44:47], v[188:191]
    v_mfma_f32_16x16x32_bf16 v[204:207], a[76:79], a[48:51], v[204:207]
    v_mfma_f32_16x16x32_bf16 v[220:223], a[76:79], a[52:55], v[220:223]
    v_mfma_f32_16x16x32_bf16 v[236:239], a[76:79], a[56:59], v[236:239]
    ds_read_b128 a[28:31], v8 offset:7168
    v_mfma_f32_16x16x32_bf16 v[252:255], a[76:79], a[60:63], v[252:255]
    ds_read_b64_tr_b16 a[76:77], v14 offset:1024
    buffer_load_dwordx4 v3, s[36:39], s73 offen offset:1024 lds
    v_mfma_f32_16x16x32_bf16 a[128:131], a[80:83], a[32:35], a[128:131]
    ds_read_b64_tr_b16 a[78:79], v14 offset:1280
    v_mfma_f32_16x16x32_bf16 a[144:147], a[80:83], a[36:39], a[144:147]
    v_mfma_f32_16x16x32_bf16 a[160:163], a[80:83], a[40:43], a[160:163]
    ds_read_b64_tr_b16 a[96:97], v12 offset:4096
    v_mfma_f32_16x16x32_bf16 a[176:179], a[80:83], a[44:47], a[176:179]
    v_mfma_f32_16x16x32_bf16 a[192:195], a[80:83], a[48:51], a[192:195]
    v_mfma_f32_16x16x32_bf16 a[208:211], a[80:83], a[52:55], a[208:211]
    buffer_load_dwordx4 v3, s[40:43], s74 offen offset:2048 lds
    v_mfma_f32_16x16x32_bf16 a[224:227], a[80:83], a[56:59], a[224:227]
    ds_read_b64_tr_b16 a[98:99], v12 offset:4352
    v_mfma_f32_16x16x32_bf16 a[240:243], a[80:83], a[60:63], a[240:243]
    ds_read_b64_tr_b16 a[80:81], v12 offset:2048
    v_mfma_f32_16x16x32_bf16 a[132:135], a[84:87], a[32:35], a[132:135]
    ds_read_b64_tr_b16 a[82:83], v12 offset:2304
    v_mfma_f32_16x16x32_bf16 a[148:151], a[84:87], a[36:39], a[148:151]
    v_mfma_f32_16x16x32_bf16 a[164:167], a[84:87], a[40:43], a[164:167]
    ds_read_b64_tr_b16 a[100:101], v14 offset:4096
    v_mfma_f32_16x16x32_bf16 a[180:183], a[84:87], a[44:47], a[180:183]
    buffer_load_dwordx4 v3, s[36:39], s75 offen offset:3072 lds
    v_mfma_f32_16x16x32_bf16 a[196:199], a[84:87], a[48:51], a[196:199]
    v_mfma_f32_16x16x32_bf16 a[212:215], a[84:87], a[52:55], a[212:215]
    v_mfma_f32_16x16x32_bf16 a[228:231], a[84:87], a[56:59], a[228:231]
    ds_read_b64_tr_b16 a[102:103], v14 offset:4352
    v_mfma_f32_16x16x32_bf16 a[244:247], a[84:87], a[60:63], a[244:247]
    ds_read_b64_tr_b16 a[84:85], v14 offset:2048
    v_mfma_f32_16x16x32_bf16 a[136:139], a[88:91], a[32:35], a[136:139]
    ds_read_b64_tr_b16 a[86:87], v14 offset:2304
    s_add_u32 m0, s78, 124928
    v_mfma_f32_16x16x32_bf16 a[152:155], a[88:91], a[36:39], a[152:155]
    buffer_load_dwordx4 v3, s[40:43], s76 offen offset:0 lds
    v_add_u32 v3, 229376, v3
    v_mfma_f32_16x16x32_bf16 a[168:171], a[88:91], a[40:43], a[168:171]
    v_mfma_f32_16x16x32_bf16 a[184:187], a[88:91], a[44:47], a[184:187]
    v_mfma_f32_16x16x32_bf16 a[200:203], a[88:91], a[48:51], a[200:203]
    v_mfma_f32_16x16x32_bf16 a[216:219], a[88:91], a[52:55], a[216:219]
    v_mfma_f32_16x16x32_bf16 a[232:235], a[88:91], a[56:59], a[232:235]
    v_mfma_f32_16x16x32_bf16 a[248:251], a[88:91], a[60:63], a[248:251]
    ds_read_b64_tr_b16 a[88:89], v12 offset:3072
    global_load_lds_dwordx4 v[4:5], off offset:1024
    v_lshl_add_u64 v[4:5], v[4:5], 0, s[80:81]
    v_mfma_f32_16x16x32_bf16 a[140:143], a[92:95], a[32:35], a[140:143]
    ds_read_b64_tr_b16 a[90:91], v12 offset:3328
    v_mfma_f32_16x16x32_bf16 a[156:159], a[92:95], a[36:39], a[156:159]
    v_mfma_f32_16x16x32_bf16 a[172:175], a[92:95], a[40:43], a[172:175]
    v_mfma_f32_16x16x32_bf16 a[188:191], a[92:95], a[44:47], a[188:191]
    v_mfma_f32_16x16x32_bf16 a[204:207], a[92:95], a[48:51], a[204:207]
    v_mfma_f32_16x16x32_bf16 a[220:223], a[92:95], a[52:55], a[220:223]
    buffer_load_dwordx4 v1, s[28:31], s77 offen offset:2048 sc1 lds
    v_add_u32_e64 v1, 64, v1
    v_mfma_f32_16x16x32_bf16 a[236:239], a[92:95], a[56:59], a[236:239]
    v_mfma_f32_16x16x32_bf16 a[252:255], a[92:95], a[60:63], a[252:255]
    ds_read_b64_tr_b16 a[92:93], v14 offset:3072
    buffer_load_dword v7, v6, s[44:47], s5 offen
    v_add_u32_e64 v6, s79, v6
    v_mfma_f32_16x16x32_bf16 v[48:51], a[104:107], a[32:35], v[48:51]
    ds_read_b64_tr_b16 a[94:95], v14 offset:3328
    v_mfma_f32_16x16x32_bf16 v[52:55], a[104:107], a[36:39], v[52:55]
    v_mfma_f32_16x16x32_bf16 v[64:67], a[104:107], a[40:43], v[64:67]
    v_mfma_f32_16x16x32_bf16 v[68:71], a[104:107], a[44:47], v[68:71]
    v_mfma_f32_16x16x32_bf16 v[80:83], a[104:107], a[48:51], v[80:83]
    v_mfma_f32_16x16x32_bf16 v[84:87], a[104:107], a[52:55], v[84:87]
    v_mfma_f32_16x16x32_bf16 v[96:99], a[104:107], a[56:59], v[96:99]
    v_mfma_f32_16x16x32_bf16 v[100:103], a[104:107], a[60:63], v[100:103]
    v_mfma_f32_16x16x32_bf16 v[56:59], a[108:111], a[32:35], v[56:59]
    v_mfma_f32_16x16x32_bf16 v[60:63], a[108:111], a[36:39], v[60:63]
    v_mfma_f32_16x16x32_bf16 v[72:75], a[108:111], a[40:43], v[72:75]
    v_mfma_f32_16x16x32_bf16 v[76:79], a[108:111], a[44:47], v[76:79]
    v_mfma_f32_16x16x32_bf16 v[88:91], a[108:111], a[48:51], v[88:91]
    v_mfma_f32_16x16x32_bf16 v[92:95], a[108:111], a[52:55], v[92:95]
    v_mfma_f32_16x16x32_bf16 v[104:107], a[108:111], a[56:59], v[104:107]
    v_mfma_f32_16x16x32_bf16 v[108:111], a[108:111], a[60:63], v[108:111]
    s_sub_u32 s67, s67, 1
    s_cmp_lg_u32 s67, 0
    s_cbranch_scc1 L_loop1
L_tail1:
    s_waitcnt vmcnt(25) lgkmcnt(0)
    s_barrier
    v_mfma_f32_16x16x32_bf16 v[128:131], a[64:67], a[0:3], v[128:131]
    s_getpc_b64 s[86:87]
L_pc1:
    s_sub_u32 s86, s86, L_pc1-L_tail0
    s_subb_u32 s87, s87, 0
    s_lshr_b32 s82, s2, 3
    s_lshl_b32 s82, s82, 2
    s_add_u32 s82, s82, s60
    s_lshl_b32 s82, s82, 10
    v_add_u32 v34, s82, v16
    v_min_u32 v34, L_code_end-L_tail0-4, v34
    global_load_dword v7, v34, s[86:87]
    v_mfma_f32_16x16x32_bf16 v[144:147], a[64:67], a[4:7], v[144:147]
    v_mfma_f32_16x16x32_bf16 v[160:163], a[64:67], a[8:11], v[160:163]
    ds_read_b128 a[32:35], v8 offset:38912
    s_and_b32 s82, s2, 7
    s_lshl_b32 s82, s82, 5
    s_lshr_b32 s83, s2, 3
    s_add_u32 s82, s82, s83
    s_lshl_b32 s82, s82, 2
    s_add_u32 s82, s82, s60
    s_mul_i32 s82, s82, 7168
    v_min_u32 v34, 55, v0
    v_lshlrev_b32 v34, 7, v34
    v_add_u32 v34, s82, v34
    global_load_dword v7, v34, s[20:21]
    v_mfma_f32_16x16x32_bf16 v[176:179], a[64:67], a[12:15], v[176:179]
    v_mfma_f32_16x16x32_bf16 v[192:195], a[64:67], a[16:19], v[192:195]
    v_mfma_f32_16x16x32_bf16 v[208:211], a[64:67], a[20:23], v[208:211]
    v_mfma_f32_16x16x32_bf16 v[224:227], a[64:67], a[24:27], v[224:227]
    ds_read_b128 a[36:39], v8 offset:39936
    v_mfma_f32_16x16x32_bf16 v[240:243], a[64:67], a[28:31], v[240:243]
    ds_read_b64_tr_b16 a[64:65], v12 offset:38912
    v_mfma_f32_16x16x32_bf16 v[132:135], a[68:71], a[0:3], v[132:135]
    ds_read_b64_tr_b16 a[66:67], v12 offset:39168
    v_mfma_f32_16x16x32_bf16 v[148:151], a[68:71], a[4:7], v[148:151]
    v_mfma_f32_16x16x32_bf16 v[164:167], a[68:71], a[8:11], v[164:167]
    ds_read_b128 a[40:43], v8 offset:40960
    v_mfma_f32_16x16x32_bf16 v[180:183], a[68:71], a[12:15], v[180:183]
    v_mfma_f32_16x16x32_bf16 v[196:199], a[68:71], a[16:19], v[196:199]
    v_mfma_f32_16x16x32_bf16 v[212:215], a[68:71], a[20:23], v[212:215]
    v_mfma_f32_16x16x32_bf16 v[228:231], a[68:71], a[24:27], v[228:231]
    ds_read_b128 a[44:47], v8 offset:41984
    v_mfma_f32_16x16x32_bf16 v[244:247], a[68:71], a[28:31], v[244:247]
    ds_read_b64_tr_b16 a[68:69], v14 offset:38912
    v_mfma_f32_16x16x32_bf16 v[136:139], a[72:75], a[0:3], v[136:139]
    ds_read_b64_tr_b16 a[70:71], v14 offset:39168
    v_mfma_f32_16x16x32_bf16 v[152:155], a[72:75], a[4:7], v[152:155]
    v_mfma_f32_16x16x32_bf16 v[168:171], a[72:75], a[8:11], v[168:171]
    ds_read_b128 a[48:51], v8 offset:43008
    v_mfma_f32_16x16x32_bf16 v[184:187], a[72:75], a[12:15], v[184:187]
    v_mfma_f32_16x16x32_bf16 v[200:203], a[72:75], a[16:19], v[200:203]
    s_lshl_b32 s82, s2, 2
    s_add_u32 s82, s82, s60
    s_lshl_b32 s82, s82, 11
    v_and_b32 v35, 31, v0
    v_lshlrev_b32 v35, 6, v35
    v_add_u32 v35, s82, v35
    global_load_dword v7, v35, s[12:13]
    v_mfma_f32_16x16x32_bf16 v[216:219], a[72:75], a[20:23], v[216:219]
    v_mfma_f32_16x16x32_bf16 v[232:235], a[72:75], a[24:27], v[232:235]
    ds_read_b128 a[52:55], v8 offset:44032
    v_mfma_f32_16x16x32_bf16 v[248:251], a[72:75], a[28:31], v[248:251]
    ds_read_b64_tr_b16 a[72:73], v12 offset:39936
    v_mfma_f32_16x16x32_bf16 v[140:143], a[76:79], a[0:3], v[140:143]
    ds_read_b64_tr_b16 a[74:75], v12 offset:40192
    v_mfma_f32_16x16x32_bf16 v[156:159], a[76:79], a[4:7], v[156:159]
    v_mfma_f32_16x16x32_bf16 v[172:175], a[76:79], a[8:11], v[172:175]
    ds_read_b128 a[56:59], v8 offset:45056
    v_mfma_f32_16x16x32_bf16 v[188:191], a[76:79], a[12:15], v[188:191]
    v_mfma_f32_16x16x32_bf16 v[204:207], a[76:79], a[16:19], v[204:207]
    v_mfma_f32_16x16x32_bf16 v[220:223], a[76:79], a[20:23], v[220:223]
    v_mfma_f32_16x16x32_bf16 v[236:239], a[76:79], a[24:27], v[236:239]
    ds_read_b128 a[60:63], v8 offset:46080
    v_mfma_f32_16x16x32_bf16 v[252:255], a[76:79], a[28:31], v[252:255]
    ds_read_b64_tr_b16 a[76:77], v14 offset:39936
    v_mfma_f32_16x16x32_bf16 a[128:131], a[80:83], a[0:3], a[128:131]
    ds_read_b64_tr_b16 a[78:79], v14 offset:40192
    v_mfma_f32_16x16x32_bf16 a[144:147], a[80:83], a[4:7], a[144:147]
    v_mfma_f32_16x16x32_bf16 a[160:163], a[80:83], a[8:11], a[160:163]
    ds_read_b64_tr_b16 a[104:105], v12 offset:43008
    v_mfma_f32_16x16x32_bf16 a[176:179], a[80:83], a[12:15], a[176:179]
    v_mfma_f32_16x16x32_bf16 a[192:195], a[80:83], a[16:19], a[192:195]
    v_mfma_f32_16x16x32_bf16 a[208:211], a[80:83], a[20:23], a[208:211]
    v_mfma_f32_16x16x32_bf16 a[224:227], a[80:83], a[24:27], a[224:227]
    ds_read_b64_tr_b16 a[106:107], v12 offset:43264
    v_mfma_f32_16x16x32_bf16 a[240:243], a[80:83], a[28:31], a[240:243]
    ds_read_b64_tr_b16 a[80:81], v12 offset:40960
    v_mfma_f32_16x16x32_bf16 a[132:135], a[84:87], a[0:3], a[132:135]
    ds_read_b64_tr_b16 a[82:83], v12 offset:41216
    v_mfma_f32_16x16x32_bf16 a[148:151], a[84:87], a[4:7], a[148:151]
    v_mfma_f32_16x16x32_bf16 a[164:167], a[84:87], a[8:11], a[164:167]
    ds_read_b64_tr_b16 a[108:109], v14 offset:43008
    v_mfma_f32_16x16x32_bf16 a[180:183], a[84:87], a[12:15], a[180:183]
    v_mfma_f32_16x16x32_bf16 a[196:199], a[84:87], a[16:19], a[196:199]
    v_mfma_f32_16x16x32_bf16 a[212:215], a[84:87], a[20:23], a[212:215]
    v_mfma_f32_16x16x32_bf16 a[228:231], a[84:87], a[24:27], a[228:231]
    ds_read_b64_tr_b16 a[110:111], v14 offset:43264
    v_mfma_f32_16x16x32_bf16 a[244:247], a[84:87], a[28:31], a[244:247]
    ds_read_b64_tr_b16 a[84:85], v14 offset:40960
    v_mfma_f32_16x16x32_bf16 a[136:139], a[88:91], a[0:3], a[136:139]
    ds_read_b64_tr_b16 a[86:87], v14 offset:41216
    v_mfma_f32_16x16x32_bf16 a[152:155], a[88:91], a[4:7], a[152:155]
    v_mfma_f32_16x16x32_bf16 a[168:171], a[88:91], a[8:11], a[168:171]
    v_mfma_f32_16x16x32_bf16 a[184:187], a[88:91], a[12:15], a[184:187]
    v_mfma_f32_16x16x32_bf16 a[200:203], a[88:91], a[16:19], a[200:203]
    v_mfma_f32_16x16x32_bf16 a[216:219], a[88:91], a[20:23], a[216:219]
    v_mfma_f32_16x16x32_bf16 a[232:235], a[88:91], a[24:27], a[232:235]
    v_mfma_f32_16x16x32_bf16 a[248:251], a[88:91], a[28:31], a[248:251]
    ds_read_b64_tr_b16 a[88:89], v12 offset:41984
    v_mfma_f32_16x16x32_bf16 a[140:143], a[92:95], a[0:3], a[140:143]
    ds_read_b64_tr_b16 a[90:91], v12 offset:42240
    v_mfma_f32_16x16x32_bf16 a[156:159], a[92:95], a[4:7], a[156:159]
    v_mfma_f32_16x16x32_bf16 a[172:175], a[92:95], a[8:11], a[172:175]
    v_mfma_f32_16x16x32_bf16 a[188:191], a[92:95], a[12:15], a[188:191]
    v_mfma_f32_16x16x32_bf16 a[204:207], a[92:95], a[16:19], a[204:207]
    v_mfma_f32_16x16x32_bf16 a[220:223], a[92:95], a[20:23], a[220:223]
    v_mfma_f32_16x16x32_bf16 a[236:239], a[92:95], a[24:27], a[236:239]
    v_mfma_f32_16x16x32_bf16 a[252:255], a[92:95], a[28:31], a[252:255]
    ds_read_b64_tr_b16 a[92:93], v14 offset:41984
    v_mfma_f32_16x16x32_bf16 v[48:51], a[96:99], a[0:3], v[48:51]
    ds_read_b64_tr_b16 a[94:95], v14 offset:42240
    v_mfma_f32_16x16x32_bf16 v[52:55], a[96:99], a[4:7], v[52:55]
    v_mfma_f32_16x16x32_bf16 v[64:67], a[96:99], a[8:11], v[64:67]
    v_mfma_f32_16x16x32_bf16 v[68:71], a[96:99], a[12:15], v[68:71]
    v_mfma_f32_16x16x32_bf16 v[80:83], a[96:99], a[16:19], v[80:83]
    v_mfma_f32_16x16x32_bf16 v[84:87], a[96:99], a[20:23], v[84:87]
    v_mfma_f32_16x16x32_bf16 v[96:99], a[96:99], a[24:27], v[96:99]
    v_mfma_f32_16x16x32_bf16 v[100:103], a[96:99], a[28:31], v[100:103]
    v_mfma_f32_16x16x32_bf16 v[56:59], a[100:103], a[0:3], v[56:59]
    v_mfma_f32_16x16x32_bf16 v[60:63], a[100:103], a[4:7], v[60:63]
    v_mfma_f32_16x16x32_bf16 v[72:75], a[100:103], a[8:11], v[72:75]
    v_mfma_f32_16x16x32_bf16 v[76:79], a[100:103], a[12:15], v[76:79]
    v_mfma_f32_16x16x32_bf16 v[88:91], a[100:103], a[16:19], v[88:91]
    v_mfma_f32_16x16x32_bf16 v[92:95], a[100:103], a[20:23], v[92:95]
    v_mfma_f32_16x16x32_bf16 v[104:107], a[100:103], a[24:27], v[104:107]
    v_mfma_f32_16x16x32_bf16 v[108:111], a[100:103], a[28:31], v[108:111]
    s_waitcnt vmcnt(16) lgkmcnt(0)
    s_barrier
    v_mfma_f32_16x16x32_bf16 v[128:131], a[64:67], a[32:35], v[128:131]
    v_mfma_f32_16x16x32_bf16 v[144:147], a[64:67], a[36:39], v[144:147]
    v_mfma_f32_16x16x32_bf16 v[160:163], a[64:67], a[40:43], v[160:163]
    ds_read_b128 a[0:3], v9 offset:0
    v_mfma_f32_16x16x32_bf16 v[176:179], a[64:67], a[44:47], v[176:179]
    v_mfma_f32_16x16x32_bf16 v[192:195], a[64:67], a[48:51], v[192:195]
    s_mul_i32 s82, s65, 1835008
    v_mfma_f32_16x16x32_bf16 v[208:211], a[64:67], a[52:55], v[208:211]
    s_lshl_b32 s83, s66, 8
    v_mfma_f32_16x16x32_bf16 v[224:227], a[64:67], a[56:59], v[224:227]
    ds_read_b128 a[4:7], v9 offset:1024
    s_add_u32 s82, s82, s83
    v_mfma_f32_16x16x32_bf16 v[240:243], a[64:67], a[60:63], v[240:243]
    ds_read_b64_tr_b16 a[64:65], v13 offset:0
    s_add_u32 s48, s20, s82
    v_mfma_f32_16x16x32_bf16 v[132:135], a[68:71], a[32:35], v[132:135]
    ds_read_b64_tr_b16 a[66:67], v13 offset:256
    s_addc_u32 s49, s21, 0
    v_mfma_f32_16x16x32_bf16 v[148:151], a[68:71], a[36:39], v[148:151]
    s_and_b32 s49, s49, 0xffff
    v_mfma_f32_16x16x32_bf16 v[164:167], a[68:71], a[40:43], v[164:167]
    ds_read_b128 a[8:11], v9 offset:2048
    s_sub_u32 s50, 7340032, s82
    v_mfma_f32_16x16x32_bf16 v[180:183], a[68:71], a[44:47], v[180:183]
    s_mov_b32 s51, 0x20000
    v_mfma_f32_16x16x32_bf16 v[196:199], a[68:71], a[48:51], v[196:199]
    s_add_u32 s52, s12, s83
    v_mfma_f32_16x16x32_bf16 v[212:215], a[68:71], a[52:55], v[212:215]
    s_addc_u32 s53, s13, 0
    v_mfma_f32_16x16x32_bf16 v[228:231], a[68:71], a[56:59], v[228:231]
    ds_read_b128 a[12:15], v9 offset:3072
    s_and_b32 s53, s53, 0xffff
    v_mfma_f32_16x16x32_bf16 v[244:247], a[68:71], a[60:63], v[244:247]
    ds_read_b64_tr_b16 a[68:69], v15 offset:0
    s_sub_u32 s54, 2097152, s83
    v_mfma_f32_16x16x32_bf16 v[136:139], a[72:75], a[32:35], v[136:139]
    ds_read_b64_tr_b16 a[70:71], v15 offset:256
    s_mov_b32 s55, 0x20000
    v_mfma_f32_16x16x32_bf16 v[152:155], a[72:75], a[36:39], v[152:155]
    s_lshl_b32 s3, s60, 11
    v_mfma_f32_16x16x32_bf16 v[168:171], a[72:75], a[40:43], v[168:171]
    ds_read_b128 a[16:19], v9 offset:4096
    v_lshrrev_b32 v34, 4, v0
    v_mfma_f32_16x16x32_bf16 v[184:187], a[72:75], a[44:47], v[184:187]
    v_and_b32 v35, 15, v0
    v_mfma_f32_16x16x32_bf16 v[200:203], a[72:75], a[48:51], v[200:203]
    v_lshlrev_b32 v36, 1, v34
    v_mfma_f32_16x16x32_bf16 v[216:219], a[72:75], a[52:55], v[216:219]
    v_add_u32 v36, 0, v36
    v_mfma_f32_16x16x32_bf16 v[232:235], a[72:75], a[56:59], v[232:235]
    ds_read_b128 a[20:23], v9 offset:5120
    v_xor_b32 v36, v36, v35
    v_mfma_f32_16x16x32_bf16 v[248:251], a[72:75], a[60:63], v[248:251]
    ds_read_b64_tr_b16 a[72:73], v13 offset:1024
    v_lshlrev_b32 v36, 4, v36
    v_mfma_f32_16x16x32_bf16 v[140:143], a[76:79], a[32:35], v[140:143]
    ds_read_b64_tr_b16 a[74:75], v13 offset:1280
    v_lshl_add_u32 v36, v34, 11, v36
    v_mfma_f32_16x16x32_bf16 v[156:159], a[76:79], a[36:39], v[156:159]
    s_lshl_b32 s82, s60, 14
    v_mfma_f32_16x16x32_bf16 v[172:175], a[76:79], a[40:43], v[172:175]
    ds_read_b128 a[24:27], v9 offset:6144
    s_add_u32 s82, s82, 0
    v_mfma_f32_16x16x32_bf16 v[188:191], a[76:79], a[44:47], v[188:191]
    v_add_u32 v17, s82, v36
    v_mfma_f32_16x16x32_bf16 v[204:207], a[76:79], a[48:51], v[204:207]
    s_lshl_b32 s82, s62, 1
    v_mfma_f32_16x16x32_bf16 v[220:223], a[76:79], a[52:55], v[220:223]
    s_add_u32 s82, s82, 0
    v_mfma_f32_16x16x32_bf16 v[236:239], a[76:79], a[56:59], v[236:239]
    ds_read_b128 a[28:31], v9 offset:7168
    s_lshl_b32 s82, s82, 3
    v_mfma_f32_16x16x32_bf16 v[252:255], a[76:79], a[60:63], v[252:255]
    ds_read_b64_tr_b16 a[76:77], v15 offset:1024
    s_lshl_b32 s83, s61, 2
    v_mfma_f32_16x16x32_bf16 a[128:131], a[80:83], a[32:35], a[128:131]
    ds_read_b64_tr_b16 a[78:79], v15 offset:1280
    s_add_u32 s82, s82, s83
    v_mfma_f32_16x16x32_bf16 a[144:147], a[80:83], a[36:39], a[144:147]
    s_mul_i32 s83, s62, 96
    v_mfma_f32_16x16x32_bf16 a[160:163], a[80:83], a[40:43], a[160:163]
    ds_read_b64_tr_b16 a[96:97], v13 offset:4096
    s_add_u32 s82, s82, s83
    v_mfma_f32_16x16x32_bf16 a[176:179], a[80:83], a[44:47], a[176:179]
    s_lshl_b32 s82, s82, 11
    v_mfma_f32_16x16x32_bf16 a[192:195], a[80:83], a[48:51], a[192:195]
    s_sub_u32 s82, s82, 0
    v_mfma_f32_16x16x32_bf16 a[208:211], a[80:83], a[52:55], a[208:211]
    v_add_u32 v19, s82, v36
    v_mfma_f32_16x16x32_bf16 a[224:227], a[80:83], a[56:59], a[224:227]
    ds_read_b64_tr_b16 a[98:99], v13 offset:4352
    v_lshlrev_b32 v36, 1, v34
    v_mfma_f32_16x16x32_bf16 a[240:243], a[80:83], a[60:63], a[240:243]
    ds_read_b64_tr_b16 a[80:81], v13 offset:2048
    v_add_u32 v36, 8, v36
    v_mfma_f32_16x16x32_bf16 a[132:135], a[84:87], a[32:35], a[132:135]
    ds_read_b64_tr_b16 a[82:83], v13 offset:2304
    v_xor_b32 v36, v36, v35
    v_mfma_f32_16x16x32_bf16 a[148:151], a[84:87], a[36:39], a[148:151]
    v_lshlrev_b32 v36, 4, v36
    v_mfma_f32_16x16x32_bf16 a[164:167], a[84:87], a[40:43], a[164:167]
    ds_read_b64_tr_b16 a[100:101], v15 offset:4096
    v_lshl_add_u32 v36, v34, 11, v36
    v_mfma_f32_16x16x32_bf16 a[180:183], a[84:87], a[44:47], a[180:183]
    s_lshl_b32 s82, s60, 14
    v_mfma_f32_16x16x32_bf16 a[196:199], a[84:87], a[48:51], a[196:199]
    s_add_u32 s82, s82, 7168
    v_mfma_f32_16x16x32_bf16 a[212:215], a[84:87], a[52:55], a[212:215]
    v_add_u32 v18, s82, v36
    v_mfma_f32_16x16x32_bf16 a[228:231], a[84:87], a[56:59], a[228:231]
    ds_read_b64_tr_b16 a[102:103], v15 offset:4352
    s_lshl_b32 s82, s62, 1
    v_mfma_f32_16x16x32_bf16 a[244:247], a[84:87], a[60:63], a[244:247]
    ds_read_b64_tr_b16 a[84:85], v15 offset:2048
    s_add_u32 s82, s82, 1
    v_mfma_f32_16x16x32_bf16 a[136:139], a[88:91], a[32:35], a[136:139]
    ds_read_b64_tr_b16 a[86:87], v15 offset:2304
    s_lshl_b32 s82, s82, 3
    v_mfma_f32_16x16x32_bf16 a[152:155], a[88:91], a[36:39], a[152:155]
    s_lshl_b32 s83, s61, 2
    v_mfma_f32_16x16x32_bf16 a[168:171], a[88:91], a[40:43], a[168:171]
    s_add_u32 s82, s82, s83
    v_mfma_f32_16x16x32_bf16 a[184:187], a[88:91], a[44:47], a[184:187]
    s_mul_i32 s83, s62, 96
    v_mfma_f32_16x16x32_bf16 a[200:203], a[88:91], a[48:51], a[200:203]
    s_add_u32 s82, s82, s83
    v_mfma_f32_16x16x32_bf16 a[216:219], a[88:91], a[52:55], a[216:219]
    s_lshl_b32 s82, s82, 11
    v_mfma_f32_16x16x32_bf16 a[232:235], a[88:91], a[56:59], a[232:235]
    s_sub_u32 s82, s82, 1024
    v_mfma_f32_16x16x32_bf16 a[248:251], a[88:91], a[60:63], a[248:251]
    ds_read_b64_tr_b16 a[88:89], v13 offset:3072
    v_add_u32 v20, s82, v36
    v_mfma_f32_16x16x32_bf16 a[140:143], a[92:95], a[32:35], a[140:143]
    ds_read_b64_tr_b16 a[90:91], v13 offset:3328
    s_xor_b32 s82, s65, 0
    v_mfma_f32_16x16x32_bf16 a[156:159], a[92:95], a[36:39], a[156:159]
    s_lshl_b32 s82, s82, 10
    v_mfma_f32_16x16x32_bf16 a[172:175], a[92:95], a[40:43], a[172:175]
    v_add_u32 v21, s82, v16
    v_mfma_f32_16x16x32_bf16 a[188:191], a[92:95], a[44:47], a[188:191]
    s_xor_b32 s82, s65, 1
    v_mfma_f32_16x16x32_bf16 a[204:207], a[92:95], a[48:51], a[204:207]
    s_lshl_b32 s82, s82, 10
    v_mfma_f32_16x16x32_bf16 a[220:223], a[92:95], a[52:55], a[220:223]
    v_add_u32 v22, s82, v16
    v_mfma_f32_16x16x32_bf16 a[236:239], a[92:95], a[56:59], a[236:239]
    s_xor_b32 s82, s65, 2
    v_mfma_f32_16x16x32_bf16 a[252:255], a[92:95], a[60:63], a[252:255]
    ds_read_b64_tr_b16 a[92:93], v15 offset:3072
    s_lshl_b32 s82, s82, 10
    v_mfma_f32_16x16x32_bf16 v[48:51], a[104:107], a[32:35], v[48:51]
    ds_read_b64_tr_b16 a[94:95], v15 offset:3328
    v_add_u32 v23, s82, v16
    v_mfma_f32_16x16x32_bf16 v[52:55], a[104:107], a[36:39], v[52:55]
    s_xor_b32 s82, s65, 3
    v_mfma_f32_16x16x32_bf16 v[64:67], a[104:107], a[40:43], v[64:67]
    s_lshl_b32 s82, s82, 10
    v_mfma_f32_16x16x32_bf16 v[68:71], a[104:107], a[44:47], v[68:71]
    v_add_u32 v24, s82, v16
    v_mfma_f32_16x16x32_bf16 v[80:83], a[104:107], a[48:51], v[80:83]
    s_mov_b32 s94, 0xbdd2d3e8
    v_mfma_f32_16x16x32_bf16 v[84:87], a[104:107], a[52:55], v[84:87]
    v_mfma_f32_16x16x32_bf16 v[96:99], a[104:107], a[56:59], v[96:99]
    v_mfma_f32_16x16x32_bf16 v[100:103], a[104:107], a[60:63], v[100:103]
    v_mfma_f32_16x16x32_bf16 v[56:59], a[108:111], a[32:35], v[56:59]
    v_mfma_f32_16x16x32_bf16 v[60:63], a[108:111], a[36:39], v[60:63]
    v_mfma_f32_16x16x32_bf16 v[72:75], a[108:111], a[40:43], v[72:75]
    v_mfma_f32_16x16x32_bf16 v[76:79], a[108:111], a[44:47], v[76:79]
    v_mfma_f32_16x16x32_bf16 v[88:91], a[108:111], a[48:51], v[88:91]
    v_mfma_f32_16x16x32_bf16 v[92:95], a[108:111], a[52:55], v[92:95]
    v_mfma_f32_16x16x32_bf16 v[104:107], a[108:111], a[56:59], v[104:107]
    v_mfma_f32_16x16x32_bf16 v[108:111], a[108:111], a[60:63], v[108:111]
    s_waitcnt vmcnt(4) lgkmcnt(0)
    s_barrier
    v_mfma_f32_16x16x32_bf16 v[128:131], a[64:67], a[0:3], v[128:131]
    v_mfma_f32_16x16x32_bf16 v[144:147], a[64:67], a[4:7], v[144:147]
    v_mfma_f32_16x16x32_bf16 v[160:163], a[64:67], a[8:11], v[160:163]
    ds_read_b128 a[32:35], v9 offset:38912
    v_mfma_f32_16x16x32_bf16 v[176:179], a[64:67], a[12:15], v[176:179]
    v_mfma_f32_16x16x32_bf16 v[192:195], a[64:67], a[16:19], v[192:195]
    s_mov_b32 s95, 0xbdd2d3e8
    v_mfma_f32_16x16x32_bf16 v[208:211], a[64:67], a[20:23], v[208:211]
    v_mov_b32 v26, 0xc0135761
    v_mfma_f32_16x16x32_bf16 v[224:227], a[64:67], a[24:27], v[224:227]
    ds_read_b128 a[36:39], v9 offset:39936
    v_mov_b32 v27, 0xc0135761
    v_mfma_f32_16x16x32_bf16 v[240:243], a[64:67], a[28:31], v[240:243]
    ds_read_b64_tr_b16 a[64:65], v13 offset:38912
    v_mov_b32 v25, 1
    v_mfma_f32_16x16x32_bf16 v[132:135], a[68:71], a[0:3], v[132:135]
    ds_read_b64_tr_b16 a[66:67], v13 offset:39168
    s_lshl_b32 s82, s60, 12
    v_mfma_f32_16x16x32_bf16 v[148:151], a[68:71], a[4:7], v[148:151]
    s_add_u32 s68, s88, s82
    v_mfma_f32_16x16x32_bf16 v[164:167], a[68:71], a[8:11], v[164:167]
    ds_read_b128 a[40:43], v9 offset:40960
    s_lshl_b32 s82, s61, 13
    v_mfma_f32_16x16x32_bf16 v[180:183], a[68:71], a[12:15], v[180:183]
    s_add_u32 s88, s88, s82
    v_mfma_f32_16x16x32_bf16 v[196:199], a[68:71], a[16:19], v[196:199]
    s_lshr_b32 s82, s66, 1
    v_mfma_f32_16x16x32_bf16 v[212:215], a[68:71], a[20:23], v[212:215]
    s_add_u32 s82, s82, 24
    v_mfma_f32_16x16x32_bf16 v[228:231], a[68:71], a[24:27], v[228:231]
    ds_read_b128 a[44:47], v9 offset:41984
    s_lshl_b32 s82, s82, 14
    v_mfma_f32_16x16x32_bf16 v[244:247], a[68:71], a[28:31], v[244:247]
    ds_read_b64_tr_b16 a[68:69], v15 offset:38912
    s_add_u32 s90, s88, s82
    v_mfma_f32_16x16x32_bf16 v[136:139], a[72:75], a[0:3], v[136:139]
    ds_read_b64_tr_b16 a[70:71], v15 offset:39168
    s_lshl_b32 s82, s66, 14
    v_mfma_f32_16x16x32_bf16 v[152:155], a[72:75], a[4:7], v[152:155]
    s_add_u32 s88, s88, s82
    v_mfma_f32_16x16x32_bf16 v[168:171], a[72:75], a[8:11], v[168:171]
    ds_read_b128 a[48:51], v9 offset:43008
    s_add_u32 s89, s88, 262144
    v_mfma_f32_16x16x32_bf16 v[184:187], a[72:75], a[12:15], v[184:187]
    s_add_u32 s88, s88, 131072
    v_mfma_f32_16x16x32_bf16 v[200:203], a[72:75], a[16:19], v[200:203]
    s_mov_b32 s76, s93
    v_mfma_f32_16x16x32_bf16 v[216:219], a[72:75], a[20:23], v[216:219]
    s_lshl_b32 s82, s63, 4
    v_mfma_f32_16x16x32_bf16 v[232:235], a[72:75], a[24:27], v[232:235]
    ds_read_b128 a[52:55], v9 offset:44032
    s_lshl_b32 s83, s60, 2
    v_mfma_f32_16x16x32_bf16 v[248:251], a[72:75], a[28:31], v[248:251]
    ds_read_b64_tr_b16 a[72:73], v13 offset:39936
    s_add_u32 s83, s83, s82
    v_mfma_f32_16x16x32_bf16 v[140:143], a[76:79], a[0:3], v[140:143]
    ds_read_b64_tr_b16 a[74:75], v13 offset:40192
    s_add_u32 s83, s83, s65
    v_mfma_f32_16x16x32_bf16 v[156:159], a[76:79], a[4:7], v[156:159]
    s_lshl_b32 s83, s83, 15
    v_mfma_f32_16x16x32_bf16 v[172:175], a[76:79], a[8:11], v[172:175]
    ds_read_b128 a[56:59], v9 offset:45056
    s_add_u32 s69, s83, 4194304
    v_mfma_f32_16x16x32_bf16 v[188:191], a[76:79], a[12:15], v[188:191]
    s_lshl_b32 s84, s63, 3
    v_mfma_f32_16x16x32_bf16 v[204:207], a[76:79], a[16:19], v[204:207]
    s_add_u32 s84, s84, s66
    v_mfma_f32_16x16x32_bf16 v[220:223], a[76:79], a[20:23], v[220:223]
    s_lshl_b32 s85, s84, 2
    v_mfma_f32_16x16x32_bf16 v[236:239], a[76:79], a[24:27], v[236:239]
    ds_read_b128 a[60:63], v9 offset:46080
    s_add_u32 s85, s85, s60
    v_mfma_f32_16x16x32_bf16 v[252:255], a[76:79], a[28:31], v[252:255]
    ds_read_b64_tr_b16 a[76:77], v15 offset:39936
    s_lshl_b32 s85, s85, 8
    v_mfma_f32_16x16x32_bf16 a[128:131], a[80:83], a[0:3], a[128:131]
    ds_read_b64_tr_b16 a[78:79], v15 offset:40192
    s_add_u32 s77, s85, 39862272
    v_mfma_f32_16x16x32_bf16 a[144:147], a[80:83], a[4:7], a[144:147]
    s_lshl_b32 s84, s84, 18
    v_mfma_f32_16x16x32_bf16 a[160:163], a[80:83], a[8:11], a[160:163]
    ds_read_b64_tr_b16 a[104:105], v13 offset:43008
    s_lshl_b32 s85, s60, 12
    v_mfma_f32_16x16x32_bf16 a[176:179], a[80:83], a[12:15], a[176:179]
    s_add_u32 s84, s84, s85
    v_mfma_f32_16x16x32_bf16 a[192:195], a[80:83], a[16:19], a[192:195]
    s_add_u32 s84, s84, 23068672
    v_mfma_f32_16x16x32_bf16 a[208:211], a[80:83], a[20:23], a[208:211]
    s_xor_b32 s85, s65, 1
    v_mfma_f32_16x16x32_bf16 a[224:227], a[80:83], a[24:27], a[224:227]
    ds_read_b64_tr_b16 a[106:107], v13 offset:43264
    s_lshl_b32 s85, s85, 16
    v_mfma_f32_16x16x32_bf16 a[240:243], a[80:83], a[28:31], a[240:243]
    ds_read_b64_tr_b16 a[80:81], v13 offset:40960
    s_add_u32 s70, s84, s85
    v_mfma_f32_16x16x32_bf16 a[132:135], a[84:87], a[0:3], a[132:135]
    ds_read_b64_tr_b16 a[82:83], v13 offset:41216
    s_add_u32 s70, s70, 16384
    v_mfma_f32_16x16x32_bf16 a[148:151], a[84:87], a[4:7], a[148:151]
    s_lshl_b32 s85, s65, 16
    v_mfma_f32_16x16x32_bf16 a[164:167], a[84:87], a[8:11], a[164:167]
    ds_read_b64_tr_b16 a[108:109], v15 offset:43008
    s_add_u32 s73, s84, s85
    v_mfma_f32_16x16x32_bf16 a[180:183], a[84:87], a[12:15], a[180:183]
    s_add_u32 s73, s73, 16384
    v_mfma_f32_16x16x32_bf16 a[196:199], a[84:87], a[16:19], a[196:199]
    s_xor_b32 s85, s65, 2
    v_mfma_f32_16x16x32_bf16 a[212:215], a[84:87], a[20:23], a[212:215]
    s_lshl_b32 s85, s85, 16
    v_mfma_f32_16x16x32_bf16 a[228:231], a[84:87], a[24:27], a[228:231]
    ds_read_b64_tr_b16 a[110:111], v15 offset:43264
    s_add_u32 s71, s84, s85
    v_mfma_f32_16x16x32_bf16 a[244:247], a[84:87], a[28:31], a[244:247]
    ds_read_b64_tr_b16 a[84:85], v15 offset:40960
    s_add_u32 s71, s71, 32768
    v_mfma_f32_16x16x32_bf16 a[136:139], a[88:91], a[0:3], a[136:139]
    ds_read_b64_tr_b16 a[86:87], v15 offset:41216
    s_lshl_b32 s85, s65, 16
    v_mfma_f32_16x16x32_bf16 a[152:155], a[88:91], a[4:7], a[152:155]
    s_add_u32 s74, s84, s85
    v_mfma_f32_16x16x32_bf16 a[168:171], a[88:91], a[8:11], a[168:171]
    s_add_u32 s74, s74, 32768
    v_mfma_f32_16x16x32_bf16 a[184:187], a[88:91], a[12:15], a[184:187]
    s_xor_b32 s85, s65, 3
    v_mfma_f32_16x16x32_bf16 a[200:203], a[88:91], a[16:19], a[200:203]
    s_lshl_b32 s85, s85, 16
    v_mfma_f32_16x16x32_bf16 a[216:219], a[88:91], a[20:23], a[216:219]
    s_add_u32 s72, s84, s85
    v_mfma_f32_16x16x32_bf16 a[232:235], a[88:91], a[24:27], a[232:235]
    s_add_u32 s72, s72, 49152
    v_mfma_f32_16x16x32_bf16 a[248:251], a[88:91], a[28:31], a[248:251]
    ds_read_b64_tr_b16 a[88:89], v13 offset:41984
    s_lshl_b32 s85, s65, 16
    v_mfma_f32_16x16x32_bf16 a[140:143], a[92:95], a[0:3], a[140:143]
    ds_read_b64_tr_b16 a[90:91], v13 offset:42240
    s_add_u32 s75, s84, s85
    v_mfma_f32_16x16x32_bf16 a[156:159], a[92:95], a[4:7], a[156:159]
    s_add_u32 s75, s75, 49152
    v_mfma_f32_16x16x32_bf16 a[172:175], a[92:95], a[8:11], a[172:175]
    v_and_b32 v36, 1, v34
    v_mfma_f32_16x16x32_bf16 a[188:191], a[92:95], a[12:15], a[188:191]
    v_lshlrev_b32 v36, 10, v36
    v_mfma_f32_16x16x32_bf16 a[204:207], a[92:95], a[16:19], a[204:207]
    v_lshrrev_b32 v34, 1, v34
    v_mfma_f32_16x16x32_bf16 a[220:223], a[92:95], a[20:23], a[220:223]
    v_lshl_add_u32 v36, v34, 8, v36
    v_mfma_f32_16x16x32_bf16 a[236:239], a[92:95], a[24:27], a[236:239]
    v_lshl_add_u32 v36, v35, 4, v36
    v_mfma_f32_16x16x32_bf16 a[252:255], a[92:95], a[28:31], a[252:255]
    ds_read_b64_tr_b16 a[92:93], v15 offset:41984
    s_and_b32 s82, s66, 1
    v_mfma_f32_16x16x32_bf16 v[48:51], a[96:99], a[0:3], v[48:51]
    ds_read_b64_tr_b16 a[94:95], v15 offset:42240
    s_lshl_b32 s82, s82, 9
    v_mfma_f32_16x16x32_bf16 v[52:55], a[96:99], a[4:7], v[52:55]
    v_add_u32 v28, s82, v36
    v_mfma_f32_16x16x32_bf16 v[64:67], a[96:99], a[8:11], v[64:67]
    v_mov_b32 v29, 0x100
    v_mfma_f32_16x16x32_bf16 v[68:71], a[96:99], a[12:15], v[68:71]
    v_mov_b32 v42, 0x10000
    v_mfma_f32_16x16x32_bf16 v[80:83], a[96:99], a[16:19], v[80:83]
    s_mov_b32 s93, s92
    v_mfma_f32_16x16x32_bf16 v[84:87], a[96:99], a[20:23], v[84:87]
    v_mfma_f32_16x16x32_bf16 v[96:99], a[96:99], a[24:27], v[96:99]
    v_mfma_f32_16x16x32_bf16 v[100:103], a[96:99], a[28:31], v[100:103]
    v_mfma_f32_16x16x32_bf16 v[56:59], a[100:103], a[0:3], v[56:59]
    v_mfma_f32_16x16x32_bf16 v[60:63], a[100:103], a[4:7], v[60:63]
    v_mfma_f32_16x16x32_bf16 v[72:75], a[100:103], a[8:11], v[72:75]
    v_mfma_f32_16x16x32_bf16 v[76:79], a[100:103], a[12:15], v[76:79]
    v_mfma_f32_16x16x32_bf16 v[88:91], a[100:103], a[16:19], v[88:91]
    v_mfma_f32_16x16x32_bf16 v[92:95], a[100:103], a[20:23], v[92:95]
    v_mfma_f32_16x16x32_bf16 v[104:107], a[100:103], a[24:27], v[104:107]
    v_mfma_f32_16x16x32_bf16 v[108:111], a[100:103], a[28:31], v[108:111]
    s_waitcnt lgkmcnt(0)
    s_barrier
    v_mfma_f32_16x16x32_bf16 v[128:131], a[64:67], a[32:35], v[128:131]
    v_mfma_f32_16x16x32_bf16 v[144:147], a[64:67], a[36:39], v[144:147]
    v_mfma_f32_16x16x32_bf16 v[160:163], a[64:67], a[40:43], v[160:163]
    s_mov_b32 s82, 0
    s_add_u32 m0, s3, 0
    v_mfma_f32_16x16x32_bf16 v[176:179], a[64:67], a[44:47], v[176:179]
    buffer_load_dwordx4 v17, s[48:51], s82 offen lds
    v_mfma_f32_16x16x32_bf16 v[192:195], a[64:67], a[48:51], v[192:195]
    v_mfma_f32_16x16x32_bf16 v[208:211], a[64:67], a[52:55], v[208:211]
    v_mfma_f32_16x16x32_bf16 v[224:227], a[64:67], a[56:59], v[224:227]
    v_mfma_f32_16x16x32_bf16 v[240:243], a[64:67], a[60:63], v[240:243]
    buffer_load_dwordx4 v18, s[48:51], s82 offen offset:1024 lds
    v_mfma_f32_16x16x32_bf16 v[132:135], a[68:71], a[32:35], v[132:135]
    v_mfma_f32_16x16x32_bf16 v[148:151], a[68:71], a[36:39], v[148:151]
    v_mfma_f32_16x16x32_bf16 v[164:167], a[68:71], a[40:43], v[164:167]
    v_mfma_f32_16x16x32_bf16 v[180:183], a[68:71], a[44:47], v[180:183]
    s_mov_b32 s83, 229376
    s_add_u32 m0, s3, 8192
    v_mfma_f32_16x16x32_bf16 v[196:199], a[68:71], a[48:51], v[196:199]
    buffer_load_dwordx4 v17, s[48:51], s83 offen lds
    v_mfma_f32_16x16x32_bf16 v[212:215], a[68:71], a[52:55], v[212:215]
    v_mfma_f32_16x16x32_bf16 v[228:231], a[68:71], a[56:59], v[228:231]
    v_mfma_f32_16x16x32_bf16 v[244:247], a[68:71], a[60:63], v[244:247]
    v_mfma_f32_16x16x32_bf16 v[136:139], a[72:75], a[32:35], v[136:139]
    buffer_load_dwordx4 v18, s[48:51], s83 offen offset:1024 lds
    v_mfma_f32_16x16x32_bf16 v[152:155], a[72:75], a[36:39], v[152:155]
    v_mfma_f32_16x16x32_bf16 v[168:171], a[72:75], a[40:43], v[168:171]
    v_mfma_f32_16x16x32_bf16 v[184:187], a[72:75], a[44:47], v[184:187]
    v_mfma_f32_16x16x32_bf16 v[200:203], a[72:75], a[48:51], v[200:203]
    s_mov_b32 s82, 458752
    s_add_u32 m0, s3, 16384
    v_mfma_f32_16x16x32_bf16 v[216:219], a[72:75], a[52:55], v[216:219]
    buffer_load_dwordx4 v17, s[48:51], s82 offen lds
    v_mfma_f32_16x16x32_bf16 v[232:235], a[72:75], a[56:59], v[232:235]
    v_mfma_f32_16x16x32_bf16 v[248:251], a[72:75], a[60:63], v[248:251]
    v_mfma_f32_16x16x32_bf16 v[140:143], a[76:79], a[32:35], v[140:143]
    v_mfma_f32_16x16x32_bf16 v[156:159], a[76:79], a[36:39], v[156:159]
    buffer_load_dwordx4 v18, s[48:51], s82 offen offset:1024 lds
    v_mfma_f32_16x16x32_bf16 v[172:175], a[76:79], a[40:43], v[172:175]
    v_mfma_f32_16x16x32_bf16 v[188:191], a[76:79], a[44:47], v[188:191]
    v_mfma_f32_16x16x32_bf16 v[204:207], a[76:79], a[48:51], v[204:207]
    v_mfma_f32_16x16x32_bf16 v[220:223], a[76:79], a[52:55], v[220:223]
    s_mov_b32 s83, 688128
    s_add_u32 m0, s3, 24576
    v_mfma_f32_16x16x32_bf16 v[236:239], a[76:79], a[56:59], v[236:239]
    buffer_load_dwordx4 v17, s[48:51], s83 offen lds
    v_mfma_f32_16x16x32_bf16 v[252:255], a[76:79], a[60:63], v[252:255]
    v_mfma_f32_16x16x32_bf16 a[128:131], a[80:83], a[32:35], a[128:131]
    v_mfma_f32_16x16x32_bf16 a[144:147], a[80:83], a[36:39], a[144:147]
    v_mfma_f32_16x16x32_bf16 a[160:163], a[80:83], a[40:43], a[160:163]
    buffer_load_dwordx4 v18, s[48:51], s83 offen offset:1024 lds
    v_mfma_f32_16x16x32_bf16 a[176:179], a[80:83], a[44:47], a[176:179]
    v_mfma_f32_16x16x32_bf16 a[192:195], a[80:83], a[48:51], a[192:195]
    v_mfma_f32_16x16x32_bf16 a[208:211], a[80:83], a[52:55], a[208:211]
    v_mfma_f32_16x16x32_bf16 a[224:227], a[80:83], a[56:59], a[224:227]
    s_mov_b32 s82, 917504
    s_add_u32 m0, s3, 32768
    v_mfma_f32_16x16x32_bf16 a[240:243], a[80:83], a[60:63], a[240:243]
    buffer_load_dwordx4 v17, s[48:51], s82 offen lds
    v_mfma_f32_16x16x32_bf16 a[132:135], a[84:87], a[32:35], a[132:135]
    v_mfma_f32_16x16x32_bf16 a[148:151], a[84:87], a[36:39], a[148:151]
    v_mfma_f32_16x16x32_bf16 a[164:167], a[84:87], a[40:43], a[164:167]
    v_mfma_f32_16x16x32_bf16 a[180:183], a[84:87], a[44:47], a[180:183]
    buffer_load_dwordx4 v18, s[48:51], s82 offen offset:1024 lds
    v_mfma_f32_16x16x32_bf16 a[196:199], a[84:87], a[48:51], a[196:199]
    v_mfma_f32_16x16x32_bf16 a[212:215], a[84:87], a[52:55], a[212:215]
    v_mfma_f32_16x16x32_bf16 a[228:231], a[84:87], a[56:59], a[228:231]
    v_mfma_f32_16x16x32_bf16 a[244:247], a[84:87], a[60:63], a[244:247]
    s_mov_b32 s83, 1146880
    s_add_u32 m0, s3, 40960
    v_mfma_f32_16x16x32_bf16 a[136:139], a[88:91], a[32:35], a[136:139]
    buffer_load_dwordx4 v17, s[48:51], s83 offen lds
    v_mfma_f32_16x16x32_bf16 a[152:155], a[88:91], a[36:39], a[152:155]
    v_mfma_f32_16x16x32_bf16 a[168:171], a[88:91], a[40:43], a[168:171]
    v_mfma_f32_16x16x32_bf16 a[184:187], a[88:91], a[44:47], a[184:187]
    v_mfma_f32_16x16x32_bf16 a[200:203], a[88:91], a[48:51], a[200:203]
    buffer_load_dwordx4 v18, s[48:51], s83 offen offset:1024 lds
    v_mfma_f32_16x16x32_bf16 a[216:219], a[88:91], a[52:55], a[216:219]
    v_mfma_f32_16x16x32_bf16 a[232:235], a[88:91], a[56:59], a[232:235]
    v_mfma_f32_16x16x32_bf16 a[248:251], a[88:91], a[60:63], a[248:251]
    v_mfma_f32_16x16x32_bf16 a[140:143], a[92:95], a[32:35], a[140:143]
    s_mov_b32 s82, 1376256
    s_add_u32 m0, s3, 49152
    v_mfma_f32_16x16x32_bf16 a[156:159], a[92:95], a[36:39], a[156:159]
    buffer_load_dwordx4 v17, s[48:51], s82 offen lds
    v_mfma_f32_16x16x32_bf16 a[172:175], a[92:95], a[40:43], a[172:175]
    v_mfma_f32_16x16x32_bf16 a[188:191], a[92:95], a[44:47], a[188:191]
    v_mfma_f32_16x16x32_bf16 a[204:207], a[92:95], a[48:51], a[204:207]
    v_mfma_f32_16x16x32_bf16 a[220:223], a[92:95], a[52:55], a[220:223]
    buffer_load_dwordx4 v18, s[48:51], s82 offen offset:1024 lds
    v_mfma_f32_16x16x32_bf16 a[236:239], a[92:95], a[56:59], a[236:239]
    v_mfma_f32_16x16x32_bf16 a[252:255], a[92:95], a[60:63], a[252:255]
    v_mfma_f32_16x16x32_bf16 v[48:51], a[104:107], a[32:35], v[48:51]
    v_mfma_f32_16x16x32_bf16 v[52:55], a[104:107], a[36:39], v[52:55]
    s_mov_b32 s83, 1605632
    s_add_u32 m0, s3, 57344
    v_mfma_f32_16x16x32_bf16 v[64:67], a[104:107], a[40:43], v[64:67]
    buffer_load_dwordx4 v17, s[48:51], s83 offen lds
    v_mfma_f32_16x16x32_bf16 v[68:71], a[104:107], a[44:47], v[68:71]
    v_mfma_f32_16x16x32_bf16 v[80:83], a[104:107], a[48:51], v[80:83]
    v_mfma_f32_16x16x32_bf16 v[84:87], a[104:107], a[52:55], v[84:87]
    v_mfma_f32_16x16x32_bf16 v[96:99], a[104:107], a[56:59], v[96:99]
    buffer_load_dwordx4 v18, s[48:51], s83 offen offset:1024 lds
    v_mfma_f32_16x16x32_bf16 v[100:103], a[104:107], a[60:63], v[100:103]
    v_mfma_f32_16x16x32_bf16 v[56:59], a[108:111], a[32:35], v[56:59]
    v_mfma_f32_16x16x32_bf16 v[60:63], a[108:111], a[36:39], v[60:63]
    v_mfma_f32_16x16x32_bf16 v[72:75], a[108:111], a[40:43], v[72:75]
    v_mfma_f32_16x16x32_bf16 v[76:79], a[108:111], a[44:47], v[76:79]
    v_mfma_f32_16x16x32_bf16 v[88:91], a[108:111], a[48:51], v[88:91]
    v_mfma_f32_16x16x32_bf16 v[92:95], a[108:111], a[52:55], v[92:95]
    v_mfma_f32_16x16x32_bf16 v[104:107], a[108:111], a[56:59], v[104:107]
    v_mfma_f32_16x16x32_bf16 v[108:111], a[108:111], a[60:63], v[108:111]
L_epi:
    v_pk_mul_f32 v[34:35], v[128:129], v[128:129]
    v_pk_mul_f32 v[36:37], v[130:131], v[130:131]
    v_pk_mul_f32 v[38:39], v[132:133], v[132:133]
    v_pk_mul_f32 v[40:41], v[134:135], v[134:135]
    v_pk_fma_f32 v[34:35], v[34:35], s[94:95], v[26:27]
    v_pk_fma_f32 v[36:37], v[36:37], s[94:95], v[26:27]
    v_pk_fma_f32 v[38:39], v[38:39], s[94:95], v[26:27]
    v_pk_fma_f32 v[40:41], v[40:41], s[94:95], v[26:27]
    v_pk_mul_f32 v[34:35], v[34:35], v[128:129]
    v_pk_mul_f32 v[36:37], v[36:37], v[130:131]
    v_pk_mul_f32 v[38:39], v[38:39], v[132:133]
    v_pk_mul_f32 v[40:41], v[40:41], v[134:135]
    v_exp_f32 v34, v34
    v_exp_f32 v35, v35
    v_exp_f32 v36, v36
    v_exp_f32 v37, v37
    v_exp_f32 v38, v38
    v_exp_f32 v39, v39
    v_exp_f32 v40, v40
    v_exp_f32 v41, v41
    v_pk_mul_f32 v[136:137], v[136:137], v[128:129]
    v_pk_mul_f32 v[138:139], v[138:139], v[130:131]
    v_pk_mul_f32 v[140:141], v[140:141], v[132:133]
    v_pk_mul_f32 v[142:143], v[142:143], v[134:135]
    v_pk_add_f32 v[34:35], v[34:35], 1.0 op_sel_hi:[1,0]
    v_pk_add_f32 v[36:37], v[36:37], 1.0 op_sel_hi:[1,0]
    v_pk_add_f32 v[38:39], v[38:39], 1.0 op_sel_hi:[1,0]
    v_pk_add_f32 v[40:41], v[40:41], 1.0 op_sel_hi:[1,0]
    v_rcp_f32 v34, v34
    v_rcp_f32 v35, v35
    v_rcp_f32 v36, v36
    v_rcp_f32 v37, v37
    v_rcp_f32 v38, v38
    v_rcp_f32 v39, v39
    v_rcp_f32 v40, v40
    v_rcp_f32 v41, v41
    v_pk_mul_f32 v[136:137], v[136:137], v[34:35]
    v_pk_mul_f32 v[138:139], v[138:139], v[36:37]
    v_pk_mul_f32 v[140:141], v[140:141], v[38:39]
    v_pk_mul_f32 v[142:143], v[142:143], v[40:41]
    v_cvt_pk_bf16_f32 v128, v136, v137
    v_cvt_pk_bf16_f32 v129, v138, v139
    v_cvt_pk_bf16_f32 v130, v140, v141
    v_cvt_pk_bf16_f32 v131, v142, v143
    buffer_store_dwordx4 v[128:131], v16, s[56:59], s88 offen offset:0 sc1
    v_pk_mul_f32 v[34:35], v[144:145], v[144:145]
    v_pk_mul_f32 v[36:37], v[146:147], v[146:147]
    v_pk_mul_f32 v[38:39], v[148:149], v[148:149]
    v_pk_mul_f32 v[40:41], v[150:151], v[150:151]
    v_pk_fma_f32 v[34:35], v[34:35], s[94:95], v[26:27]
    v_pk_fma_f32 v[36:37], v[36:37], s[94:95], v[26:27]
    v_pk_fma_f32 v[38:39], v[38:39], s[94:95], v[26:27]
    v_pk_fma_f32 v[40:41], v[40:41], s[94:95], v[26:27]
    v_pk_mul_f32 v[34:35], v[34:35], v[144:145]
    v_pk_mul_f32 v[36:37], v[36:37], v[146:147]
    v_pk_mul_f32 v[38:39], v[38:39], v[148:149]
    v_pk_mul_f32 v[40:41], v[40:41], v[150:151]
    v_exp_f32 v34, v34
    v_exp_f32 v35, v35
    v_exp_f32 v36, v36
    v_exp_f32 v37, v37
    v_exp_f32 v38, v38
    v_exp_f32 v39, v39
    v_exp_f32 v40, v40
    v_exp_f32 v41, v41
    v_pk_mul_f32 v[152:153], v[152:153], v[144:145]
    v_pk_mul_f32 v[154:155], v[154:155], v[146:147]
    v_pk_mul_f32 v[156:157], v[156:157], v[148:149]
    v_pk_mul_f32 v[158:159], v[158:159], v[150:151]
    v_pk_add_f32 v[34:35], v[34:35], 1.0 op_sel_hi:[1,0]
    v_pk_add_f32 v[36:37], v[36:37], 1.0 op_sel_hi:[1,0]
    v_pk_add_f32 v[38:39], v[38:39], 1.0 op_sel_hi:[1,0]
    v_pk_add_f32 v[40:41], v[40:41], 1.0 op_sel_hi:[1,0]
    v_rcp_f32 v34, v34
    v_rcp_f32 v35, v35
    v_rcp_f32 v36, v36
    v_rcp_f32 v37, v37
    v_rcp_f32 v38, v38
    v_rcp_f32 v39, v39
    v_rcp_f32 v40, v40
    v_rcp_f32 v41, v41
    v_pk_mul_f32 v[152:153], v[152:153], v[34:35]
    v_pk_mul_f32 v[154:155], v[154:155], v[36:37]
    v_pk_mul_f32 v[156:157], v[156:157], v[38:39]
    v_pk_mul_f32 v[158:159], v[158:159], v[40:41]
    v_cvt_pk_bf16_f32 v144, v152, v153
    v_cvt_pk_bf16_f32 v145, v154, v155
    v_cvt_pk_bf16_f32 v146, v156, v157
    v_cvt_pk_bf16_f32 v147, v158, v159
    buffer_store_dwordx4 v[144:147], v16, s[56:59], s88 offen offset:1024 sc1
    v_pk_mul_f32 v[34:35], v[160:161], v[160:161]
    v_pk_mul_f32 v[36:37], v[162:163], v[162:163]
    v_pk_mul_f32 v[38:39], v[164:165], v[164:165]
    v_pk_mul_f32 v[40:41], v[166:167], v[166:167]
    v_pk_fma_f32 v[34:35], v[34:35], s[94:95], v[26:27]
    v_pk_fma_f32 v[36:37], v[36:37], s[94:95], v[26:27]
    v_pk_fma_f32 v[38:39], v[38:39], s[94:95], v[26:27]
    v_pk_fma_f32 v[40:41], v[40:41], s[94:95], v[26:27]
    v_pk_mul_f32 v[34:35], v[34:35], v[160:161]
    v_pk_mul_f32 v[36:37], v[36:37], v[162:163]
    v_pk_mul_f32 v[38:39], v[38:39], v[164:165]
    v_pk_mul_f32 v[40:41], v[40:41], v[166:167]
    v_exp_f32 v34, v34
    v_exp_f32 v35, v35
    v_exp_f32 v36, v36
    v_exp_f32 v37, v37
    v_exp_f32 v38, v38
    v_exp_f32 v39, v39
    v_exp_f32 v40, v40
    v_exp_f32 v41, v41
    v_pk_mul_f32 v[168:169], v[168:169], v[160:161]
    v_pk_mul_f32 v[170:171], v[170:171], v[162:163]
    v_pk_mul_f32 v[172:173], v[172:173], v[164:165]
    v_pk_mul_f32 v[174:175], v[174:175], v[166:167]
    v_pk_add_f32 v[34:35], v[34:35], 1.0 op_sel_hi:[1,0]
    v_pk_add_f32 v[36:37], v[36:37], 1.0 op_sel_hi:[1,0]
    v_pk_add_f32 v[38:39], v[38:39], 1.0 op_sel_hi:[1,0]
    v_pk_add_f32 v[40:41], v[40:41], 1.0 op_sel_hi:[1,0]
    v_rcp_f32 v34, v34
    v_rcp_f32 v35, v35
    v_rcp_f32 v36, v36
    v_rcp_f32 v37, v37
    v_rcp_f32 v38, v38
    v_rcp_f32 v39, v39
    v_rcp_f32 v40, v40
    v_rcp_f32 v41, v41
    v_pk_mul_f32 v[168:169], v[168:169], v[34:35]
    v_pk_mul_f32 v[170:171], v[170:171], v[36:37]
    v_pk_mul_f32 v[172:173], v[172:173], v[38:39]
    v_pk_mul_f32 v[174:175], v[174:175], v[40:41]
    v_cvt_pk_bf16_f32 v160, v168, v169
    v_cvt_pk_bf16_f32 v161, v170, v171
    v_cvt_pk_bf16_f32 v162, v172, v173
    v_cvt_pk_bf16_f32 v163, v174, v175
    buffer_store_dwordx4 v[160:163], v16, s[56:59], s88 offen offset:2048 sc1
    v_pk_mul_f32 v[34:35], v[176:177], v[176:177]
    v_pk_mul_f32 v[36:37], v[178:179], v[178:179]
    v_pk_mul_f32 v[38:39], v[180:181], v[180:181]
    v_pk_mul_f32 v[40:41], v[182:183], v[182:183]
    v_pk_fma_f32 v[34:35], v[34:35], s[94:95], v[26:27]
    v_pk_fma_f32 v[36:37], v[36:37], s[94:95], v[26:27]
    v_pk_fma_f32 v[38:39], v[38:39], s[94:95], v[26:27]
    v_pk_fma_f32 v[40:41], v[40:41], s[94:95], v[26:27]
    v_pk_mul_f32 v[34:35], v[34:35], v[176:177]
    v_pk_mul_f32 v[36:37], v[36:37], v[178:179]
    v_pk_mul_f32 v[38:39], v[38:39], v[180:181]
    v_pk_mul_f32 v[40:41], v[40:41], v[182:183]
    v_exp_f32 v34, v34
    v_exp_f32 v35, v35
    v_exp_f32 v36, v36
    v_exp_f32 v37, v37
    v_exp_f32 v38, v38
    v_exp_f32 v39, v39
    v_exp_f32 v40, v40
    v_exp_f32 v41, v41
    v_pk_mul_f32 v[184:185], v[184:185], v[176:177]
    v_pk_mul_f32 v[186:187], v[186:187], v[178:179]
    v_pk_mul_f32 v[188:189], v[188:189], v[180:181]
    v_pk_mul_f32 v[190:191], v[190:191], v[182:183]
    v_pk_add_f32 v[34:35], v[34:35], 1.0 op_sel_hi:[1,0]
    v_pk_add_f32 v[36:37], v[36:37], 1.0 op_sel_hi:[1,0]
    v_pk_add_f32 v[38:39], v[38:39], 1.0 op_sel_hi:[1,0]
    v_pk_add_f32 v[40:41], v[40:41], 1.0 op_sel_hi:[1,0]
    v_rcp_f32 v34, v34
    v_rcp_f32 v35, v35
    v_rcp_f32 v36, v36
    v_rcp_f32 v37, v37
    v_rcp_f32 v38, v38
    v_rcp_f32 v39, v39
    v_rcp_f32 v40, v40
    v_rcp_f32 v41, v41
    v_pk_mul_f32 v[184:185], v[184:185], v[34:35]
    v_pk_mul_f32 v[186:187], v[186:187], v[36:37]
    v_pk_mul_f32 v[188:189], v[188:189], v[38:39]
    v_pk_mul_f32 v[190:191], v[190:191], v[40:41]
    v_cvt_pk_bf16_f32 v176, v184, v185
    v_cvt_pk_bf16_f32 v177, v186, v187
    v_cvt_pk_bf16_f32 v178, v188, v189
    v_cvt_pk_bf16_f32 v179, v190, v191
    buffer_store_dwordx4 v[176:179], v16, s[56:59], s88 offen offset:3072 sc1
    v_pk_mul_f32 v[34:35], v[192:193], v[192:193]
    v_pk_mul_f32 v[36:37], v[194:195], v[194:195]
    v_pk_mul_f32 v[38:39], v[196:197], v[196:197]
    v_pk_mul_f32 v[40:41], v[198:199], v[198:199]
    v_pk_fma_f32 v[34:35], v[34:35], s[94:95], v[26:27]
    v_pk_fma_f32 v[36:37], v[36:37], s[94:95], v[26:27]
    v_pk_fma_f32 v[38:39], v[38:39], s[94:95], v[26:27]
    v_pk_fma_f32 v[40:41], v[40:41], s[94:95], v[26:27]
    v_pk_mul_f32 v[34:35], v[34:35], v[192:193]
    v_pk_mul_f32 v[36:37], v[36:37], v[194:195]
    v_pk_mul_f32 v[38:39], v[38:39], v[196:197]
    v_pk_mul_f32 v[40:41], v[40:41], v[198:199]
    v_exp_f32 v34, v34
    v_exp_f32 v35, v35
    v_exp_f32 v36, v36
    v_exp_f32 v37, v37
    v_exp_f32 v38, v38
    v_exp_f32 v39, v39
    v_exp_f32 v40, v40
    v_exp_f32 v41, v41
    v_pk_mul_f32 v[200:201], v[200:201], v[192:193]
    v_pk_mul_f32 v[202:203], v[202:203], v[194:195]
    v_pk_mul_f32 v[204:205], v[204:205], v[196:197]
    v_pk_mul_f32 v[206:207], v[206:207], v[198:199]
    v_pk_add_f32 v[34:35], v[34:35], 1.0 op_sel_hi:[1,0]
    v_pk_add_f32 v[36:37], v[36:37], 1.0 op_sel_hi:[1,0]
    v_pk_add_f32 v[38:39], v[38:39], 1.0 op_sel_hi:[1,0]
    v_pk_add_f32 v[40:41], v[40:41], 1.0 op_sel_hi:[1,0]
    v_rcp_f32 v34, v34
    v_rcp_f32 v35, v35
    v_rcp_f32 v36, v36
    v_rcp_f32 v37, v37
    v_rcp_f32 v38, v38
    v_rcp_f32 v39, v39
    v_rcp_f32 v40, v40
    v_rcp_f32 v41, v41
    v_pk_mul_f32 v[200:201], v[200:201], v[34:35]
    v_pk_mul_f32 v[202:203], v[202:203], v[36:37]
    v_pk_mul_f32 v[204:205], v[204:205], v[38:39]
    v_pk_mul_f32 v[206:207], v[206:207], v[40:41]
    v_cvt_pk_bf16_f32 v192, v200, v201
    v_cvt_pk_bf16_f32 v193, v202, v203
    v_cvt_pk_bf16_f32 v194, v204, v205
    v_cvt_pk_bf16_f32 v195, v206, v207
    s_add_u32 s88, s88, 4096
    buffer_store_dwordx4 v[192:195], v16, s[56:59], s88 offen offset:0 sc1
    v_pk_mul_f32 v[34:35], v[208:209], v[208:209]
    v_pk_mul_f32 v[36:37], v[210:211], v[210:211]
    v_pk_mul_f32 v[38:39], v[212:213], v[212:213]
    v_pk_mul_f32 v[40:41], v[214:215], v[214:215]
    v_pk_fma_f32 v[34:35], v[34:35], s[94:95], v[26:27]
    v_pk_fma_f32 v[36:37], v[36:37], s[94:95], v[26:27]
    v_pk_fma_f32 v[38:39], v[38:39], s[94:95], v[26:27]
    v_pk_fma_f32 v[40:41], v[40:41], s[94:95], v[26:27]
    v_pk_mul_f32 v[34:35], v[34:35], v[208:209]
    v_pk_mul_f32 v[36:37], v[36:37], v[210:211]
    v_pk_mul_f32 v[38:39], v[38:39], v[212:213]
    v_pk_mul_f32 v[40:41], v[40:41], v[214:215]
    v_exp_f32 v34, v34
    v_exp_f32 v35, v35
    v_exp_f32 v36, v36
    v_exp_f32 v37, v37
    v_exp_f32 v38, v38
    v_exp_f32 v39, v39
    v_exp_f32 v40, v40
    v_exp_f32 v41, v41
    v_pk_mul_f32 v[216:217], v[216:217], v[208:209]
    v_pk_mul_f32 v[218:219], v[218:219], v[210:211]
    v_pk_mul_f32 v[220:221], v[220:221], v[212:213]
    v_pk_mul_f32 v[222:223], v[222:223], v[214:215]
    v_pk_add_f32 v[34:35], v[34:35], 1.0 op_sel_hi:[1,0]
    v_pk_add_f32 v[36:37], v[36:37], 1.0 op_sel_hi:[1,0]
    v_pk_add_f32 v[38:39], v[38:39], 1.0 op_sel_hi:[1,0]
    v_pk_add_f32 v[40:41], v[40:41], 1.0 op_sel_hi:[1,0]
    v_rcp_f32 v34, v34
    v_rcp_f32 v35, v35
    v_rcp_f32 v36, v36
    v_rcp_f32 v37, v37
    v_rcp_f32 v38, v38
    v_rcp_f32 v39, v39
    v_rcp_f32 v40, v40
    v_rcp_f32 v41, v41
    v_pk_mul_f32 v[216:217], v[216:217], v[34:35]
    v_pk_mul_f32 v[218:219], v[218:219], v[36:37]
    v_pk_mul_f32 v[220:221], v[220:221], v[38:39]
    v_pk_mul_f32 v[222:223], v[222:223], v[40:41]
    v_cvt_pk_bf16_f32 v208, v216, v217
    v_cvt_pk_bf16_f32 v209, v218, v219
    v_cvt_pk_bf16_f32 v210, v220, v221
    v_cvt_pk_bf16_f32 v211, v222, v223
    buffer_store_dwordx4 v[208:211], v16, s[56:59], s88 offen offset:1024 sc1
    v_pk_mul_f32 v[34:35], v[224:225], v[224:225]
    v_pk_mul_f32 v[36:37], v[226:227], v[226:227]
    v_pk_mul_f32 v[38:39], v[228:229], v[228:229]
    v_pk_mul_f32 v[40:41], v[230:231], v[230:231]
    v_pk_fma_f32 v[34:35], v[34:35], s[94:95], v[26:27]
    v_pk_fma_f32 v[36:37], v[36:37], s[94:95], v[26:27]
    v_pk_fma_f32 v[38:39], v[38:39], s[94:95], v[26:27]
    v_pk_fma_f32 v[40:41], v[40:41], s[94:95], v[26:27]
    v_pk_mul_f32 v[34:35], v[34:35], v[224:225]
    v_pk_mul_f32 v[36:37], v[36:37], v[226:227]
    v_pk_mul_f32 v[38:39], v[38:39], v[228:229]
    v_pk_mul_f32 v[40:41], v[40:41], v[230:231]
    v_exp_f32 v34, v34
    v_exp_f32 v35, v35
    v_exp_f32 v36, v36
    v_exp_f32 v37, v37
    v_exp_f32 v38, v38
    v_exp_f32 v39, v39
    v_exp_f32 v40, v40
    v_exp_f32 v41, v41
    v_pk_mul_f32 v[232:233], v[232:233], v[224:225]
    v_pk_mul_f32 v[234:235], v[234:235], v[226:227]
    v_pk_mul_f32 v[236:237], v[236:237], v[228:229]
    v_pk_mul_f32 v[238:239], v[238:239], v[230:231]
    v_pk_add_f32 v[34:35], v[34:35], 1.0 op_sel_hi:[1,0]
    v_pk_add_f32 v[36:37], v[36:37], 1.0 op_sel_hi:[1,0]
    v_pk_add_f32 v[38:39], v[38:39], 1.0 op_sel_hi:[1,0]
    v_pk_add_f32 v[40:41], v[40:41], 1.0 op_sel_hi:[1,0]
    v_rcp_f32 v34, v34
    v_rcp_f32 v35, v35
    v_rcp_f32 v36, v36
    v_rcp_f32 v37, v37
    v_rcp_f32 v38, v38
    v_rcp_f32 v39, v39
    v_rcp_f32 v40, v40
    v_rcp_f32 v41, v41
    v_pk_mul_f32 v[232:233], v[232:233], v[34:35]
    v_pk_mul_f32 v[234:235], v[234:235], v[36:37]
    v_pk_mul_f32 v[236:237], v[236:237], v[38:39]
    v_pk_mul_f32 v[238:239], v[238:239], v[40:41]
    v_cvt_pk_bf16_f32 v224, v232, v233
    v_cvt_pk_bf16_f32 v225, v234, v235
    v_cvt_pk_bf16_f32 v226, v236, v237
    v_cvt_pk_bf16_f32 v227, v238, v239
    buffer_store_dwordx4 v[224:227], v16, s[56:59], s88 offen offset:2048 sc1
    v_pk_mul_f32 v[34:35], v[240:241], v[240:241]
    v_pk_mul_f32 v[36:37], v[242:243], v[242:243]
    v_pk_mul_f32 v[38:39], v[244:245], v[244:245]
    v_pk_mul_f32 v[40:41], v[246:247], v[246:247]
    v_pk_fma_f32 v[34:35], v[34:35], s[94:95], v[26:27]
    v_pk_fma_f32 v[36:37], v[36:37], s[94:95], v[26:27]
    v_pk_fma_f32 v[38:39], v[38:39], s[94:95], v[26:27]
    v_pk_fma_f32 v[40:41], v[40:41], s[94:95], v[26:27]
    v_pk_mul_f32 v[34:35], v[34:35], v[240:241]
    v_pk_mul_f32 v[36:37], v[36:37], v[242:243]
    v_pk_mul_f32 v[38:39], v[38:39], v[244:245]
    v_pk_mul_f32 v[40:41], v[40:41], v[246:247]
    v_exp_f32 v34, v34
    v_exp_f32 v35, v35
    v_exp_f32 v36, v36
    v_exp_f32 v37, v37
    v_exp_f32 v38, v38
    v_exp_f32 v39, v39
    v_exp_f32 v40, v40
    v_exp_f32 v41, v41
    v_pk_mul_f32 v[248:249], v[248:249], v[240:241]
    v_pk_mul_f32 v[250:251], v[250:251], v[242:243]
    v_pk_mul_f32 v[252:253], v[252:253], v[244:245]
    v_pk_mul_f32 v[254:255], v[254:255], v[246:247]
    v_pk_add_f32 v[34:35], v[34:35], 1.0 op_sel_hi:[1,0]
    v_pk_add_f32 v[36:37], v[36:37], 1.0 op_sel_hi:[1,0]
    v_pk_add_f32 v[38:39], v[38:39], 1.0 op_sel_hi:[1,0]
    v_pk_add_f32 v[40:41], v[40:41], 1.0 op_sel_hi:[1,0]
    v_rcp_f32 v34, v34
    v_rcp_f32 v35, v35
    v_rcp_f32 v36, v36
    v_rcp_f32 v37, v37
    v_rcp_f32 v38, v38
    v_rcp_f32 v39, v39
    v_rcp_f32 v40, v40
    v_rcp_f32 v41, v41
    v_pk_mul_f32 v[248:249], v[248:249], v[34:35]
    v_pk_mul_f32 v[250:251], v[250:251], v[36:37]
    v_pk_mul_f32 v[252:253], v[252:253], v[38:39]
    v_pk_mul_f32 v[254:255], v[254:255], v[40:41]
    v_cvt_pk_bf16_f32 v240, v248, v249
    v_cvt_pk_bf16_f32 v241, v250, v251
    v_cvt_pk_bf16_f32 v242, v252, v253
    v_cvt_pk_bf16_f32 v243, v254, v255
    buffer_store_dwordx4 v[240:243], v16, s[56:59], s88 offen offset:3072 sc1
    s_cmp_eq_u32 s62, 1
    s_cbranch_scc1 L_epi1
    v_mov_b32 v244, 0xce6e6b28
    v_cvt_pk_bf16_f32 v128, v120, v121
    v_cvt_pk_bf16_f32 v129, v122, v123
    v_cvt_pk_bf16_f32 v130, v124, v125
    v_cvt_pk_bf16_f32 v131, v126, v127
    v_accvgpr_read_b32 v34, a128
    v_accvgpr_read_b32 v35, a129
    v_accvgpr_read_b32 v36, a130
    v_accvgpr_read_b32 v37, a131
    v_accvgpr_read_b32 v38, a132
    v_accvgpr_read_b32 v39, a133
    v_accvgpr_read_b32 v40, a134
    v_accvgpr_read_b32 v41, a135
    v_cvt_pk_bf16_f32 v132, v34, v35
    s_mov_b32 s82, 65536
    s_add_u32 m0, s3, 65536
    s_nop 0
    buffer_load_dwordx4 v17, s[48:51], s82 offen lds
    buffer_load_dwordx4 v18, s[48:51], s82 offen offset:1024 lds
    v_cvt_pk_bf16_f32 v133, v36, v37
    v_cvt_pk_bf16_f32 v134, v38, v39
    v_cvt_pk_bf16_f32 v135, v40, v41
    v_accvgpr_read_b32 v246, a192
    v_accvgpr_read_b32 v247, a193
    v_accvgpr_read_b32 v248, a194
    v_accvgpr_read_b32 v249, a195
    v_accvgpr_read_b32 v250, a196
    v_accvgpr_read_b32 v251, a197
    v_accvgpr_read_b32 v252, a198
    v_accvgpr_read_b32 v253, a199
    v_cvt_pk_bf16_f32 v164, v246, v247
    v_cvt_pk_bf16_f32 v165, v248, v249
    v_cvt_pk_bf16_f32 v166, v250, v251
    v_cvt_pk_bf16_f32 v167, v252, v253
    v_accvgpr_read_b32 v34, a136
    v_accvgpr_read_b32 v35, a137
    v_accvgpr_read_b32 v36, a138
    v_accvgpr_read_b32 v37, a139
    v_accvgpr_read_b32 v38, a140
    v_accvgpr_read_b32 v39, a141
    v_accvgpr_read_b32 v40, a142
    s_mov_b32 s83, 294912
    s_add_u32 m0, s3, 73728
    s_nop 0
    buffer_load_dwordx4 v17, s[48:51], s83 offen lds
    buffer_load_dwordx4 v18, s[48:51], s83 offen offset:1024 lds
    v_accvgpr_read_b32 v41, a143
    v_cvt_pk_bf16_f32 v136, v34, v35
    v_cvt_pk_bf16_f32 v137, v36, v37
    v_cvt_pk_bf16_f32 v138, v38, v39
    v_cvt_pk_bf16_f32 v139, v40, v41
    v_accvgpr_read_b32 v246, a200
    v_accvgpr_read_b32 v247, a201
    v_accvgpr_read_b32 v248, a202
    v_accvgpr_read_b32 v249, a203
    v_accvgpr_read_b32 v250, a204
    v_accvgpr_read_b32 v251, a205
    v_accvgpr_read_b32 v252, a206
    v_accvgpr_read_b32 v253, a207
    v_cvt_pk_bf16_f32 v168, v246, v247
    v_cvt_pk_bf16_f32 v169, v248, v249
    v_cvt_pk_bf16_f32 v170, v250, v251
    v_cvt_pk_bf16_f32 v171, v252, v253
    v_accvgpr_read_b32 v34, a144
    v_accvgpr_read_b32 v35, a145
    v_accvgpr_read_b32 v36, a146
    v_accvgpr_read_b32 v37, a147
    v_accvgpr_read_b32 v38, a148
    s_mov_b32 s82, 524288
    s_add_u32 m0, s3, 81920
    s_nop 0
    buffer_load_dwordx4 v17, s[48:51], s82 offen lds
    buffer_load_dwordx4 v18, s[48:51], s82 offen offset:1024 lds
    v_accvgpr_read_b32 v39, a149
    v_accvgpr_read_b32 v40, a150
    v_accvgpr_read_b32 v41, a151
    v_cvt_pk_bf16_f32 v140, v34, v35
    v_cvt_pk_bf16_f32 v141, v36, v37
    v_cvt_pk_bf16_f32 v142, v38, v39
    v_cvt_pk_bf16_f32 v143, v40, v41
    v_accvgpr_read_b32 v246, a208
    v_accvgpr_read_b32 v247, a209
    v_accvgpr_read_b32 v248, a210
    v_accvgpr_read_b32 v249, a211
    v_accvgpr_read_b32 v250, a212
    v_accvgpr_read_b32 v251, a213
    v_accvgpr_read_b32 v252, a214
    v_accvgpr_read_b32 v253, a215
    v_cvt_pk_bf16_f32 v172, v246, v247
    v_cvt_pk_bf16_f32 v173, v248, v249
    v_cvt_pk_bf16_f32 v174, v250, v251
    v_cvt_pk_bf16_f32 v175, v252, v253
    v_accvgpr_read_b32 v34, a152
    v_accvgpr_read_b32 v35, a153
    v_accvgpr_read_b32 v36, a154
    s_mov_b32 s83, 753664
    s_add_u32 m0, s3, 90112
    s_nop 0
    buffer_load_dwordx4 v17, s[48:51], s83 offen lds
    buffer_load_dwordx4 v18, s[48:51], s83 offen offset:1024 lds
    v_accvgpr_read_b32 v37, a155
    v_accvgpr_read_b32 v38, a156
    v_accvgpr_read_b32 v39, a157
    v_accvgpr_read_b32 v40, a158
    v_accvgpr_read_b32 v41, a159
    v_cvt_pk_bf16_f32 v144, v34, v35
    v_cvt_pk_bf16_f32 v145, v36, v37
    v_cvt_pk_bf16_f32 v146, v38, v39
    v_cvt_pk_bf16_f32 v147, v40, v41
    v_accvgpr_read_b32 v246, a216
    v_accvgpr_read_b32 v247, a217
    v_accvgpr_read_b32 v248, a218
    v_accvgpr_read_b32 v249, a219
    v_accvgpr_read_b32 v250, a220
    v_accvgpr_read_b32 v251, a221
    v_accvgpr_read_b32 v252, a222
    v_accvgpr_read_b32 v253, a223
    v_cvt_pk_bf16_f32 v176, v246, v247
    v_cvt_pk_bf16_f32 v177, v248, v249
    v_cvt_pk_bf16_f32 v178, v250, v251
    v_cvt_pk_bf16_f32 v179, v252, v253
    v_mfma_f32_16x16x32_bf16 v[196:199], v[128:131], v[164:167], 0
    v_mfma_f32_16x16x32_bf16 v[200:203], v[132:135], v[164:167], 0
    v_mfma_f32_16x16x32_bf16 v[204:207], v[132:135], v[168:171], 0
    v_mfma_f32_16x16x32_bf16 v[208:211], v[136:139], v[168:171], 0
    v_mfma_f32_16x16x32_bf16 v[212:215], v[136:139], v[172:175], 0
    v_mfma_f32_16x16x32_bf16 v[216:219], v[140:143], v[172:175], 0
    v_mfma_f32_16x16x32_bf16 v[220:223], v[140:143], v[176:179], 0
    v_mfma_f32_16x16x32_bf16 v[224:227], v[144:147], v[176:179], 0
    s_waitcnt vmcnt(8)
    s_mov_b64 exec, 1
    buffer_atomic_add v25, off, s[56:59], s92 sc1
    s_mov_b64 exec, -1
    v_cvt_pk_bf16_f32 v48, v48, v49
    v_cvt_pk_bf16_f32 v49, v50, v51
    v_cvt_pk_bf16_f32 v84, v84, v85
    v_cvt_pk_bf16_f32 v85, v86, v87
    v_cvt_pk_bf16_f32 v50, v52, v53
    v_cvt_pk_bf16_f32 v51, v54, v55
    v_cvt_pk_bf16_f32 v86, v88, v89
    v_cvt_pk_bf16_f32 v87, v90, v91
    v_cvt_pk_bf16_f32 v52, v56, v57
    v_cvt_pk_bf16_f32 v53, v58, v59
    v_cvt_pk_bf16_f32 v88, v92, v93
    v_cvt_pk_bf16_f32 v89, v94, v95
    v_cvt_pk_bf16_f32 v54, v60, v61
    v_cvt_pk_bf16_f32 v55, v62, v63
    v_cvt_pk_bf16_f32 v90, v96, v97
    v_cvt_pk_bf16_f32 v91, v98, v99
    v_cvt_pk_bf16_f32 v56, v64, v65
    v_cvt_pk_bf16_f32 v57, v66, v67
    v_cvt_pk_bf16_f32 v92, v100, v101
    v_cvt_pk_bf16_f32 v93, v102, v103
    v_cvt_pk_bf16_f32 v58, v68, v69
    v_cvt_pk_bf16_f32 v59, v70, v71
    v_cvt_pk_bf16_f32 v94, v104, v105
    v_cvt_pk_bf16_f32 v95, v106, v107
    v_cvt_pk_bf16_f32 v60, v72, v73
    v_cvt_pk_bf16_f32 v61, v74, v75
    v_cvt_pk_bf16_f32 v96, v108, v109
    v_cvt_pk_bf16_f32 v97, v110, v111
    v_cvt_pk_bf16_f32 v62, v76, v77
    v_cvt_pk_bf16_f32 v63, v78, v79
    v_cvt_pk_bf16_f32 v98, v112, v113
    v_cvt_pk_bf16_f32 v99, v114, v115
    v_cvt_pk_bf16_f32 v64, v80, v81
    v_cvt_pk_bf16_f32 v65, v82, v83
    v_cvt_pk_bf16_f32 v100, v116, v117
    v_cvt_pk_bf16_f32 v101, v118, v119
    v_cvt_pk_bf16_f32 v196, v196, v197
    s_mov_b32 s82, 983040
    s_add_u32 m0, s3, 98304
    s_nop 0
    buffer_load_dwordx4 v17, s[48:51], s82 offen lds
    buffer_load_dwordx4 v18, s[48:51], s82 offen offset:1024 lds
    v_cvt_pk_bf16_f32 v198, v198, v199
    v_cvt_pk_bf16_f32 v200, v200, v201
    v_cvt_pk_bf16_f32 v202, v202, v203
    v_cvt_pk_bf16_f32 v204, v204, v205
    v_cvt_pk_bf16_f32 v206, v206, v207
    v_cvt_pk_bf16_f32 v208, v208, v209
    v_cvt_pk_bf16_f32 v210, v210, v211
    v_cvt_pk_bf16_f32 v212, v212, v213
    v_cvt_pk_bf16_f32 v214, v214, v215
    v_cvt_pk_bf16_f32 v216, v216, v217
    v_cvt_pk_bf16_f32 v218, v218, v219
    v_cvt_pk_bf16_f32 v220, v220, v221
    v_cvt_pk_bf16_f32 v222, v222, v223
    v_cvt_pk_bf16_f32 v224, v224, v225
    v_cvt_pk_bf16_f32 v226, v226, v227
    v_perm_b32 v228, v200, v196, v28
    v_perm_b32 v229, v202, v198, v29
    v_perm_b32 v230, v208, v204, v28
    v_perm_b32 v231, v210, v206, v29
    v_perm_b32 v232, v216, v212, v28
    v_perm_b32 v233, v218, v214, v29
    v_perm_b32 v234, v224, v220, v28
    v_perm_b32 v235, v226, v222, v29
    v_pk_mul_f32 v[228:229], v[228:229], s[14:15]
    v_pk_mul_f32 v[230:231], v[230:231], s[14:15]
    v_pk_mul_f32 v[232:233], v[232:233], s[14:15]
    v_pk_mul_f32 v[234:235], v[234:235], s[14:15]
    v_cvt_pk_bf16_f32 v229, v228, v229
    s_mov_b32 s83, 1212416
    s_add_u32 m0, s3, 106496
    s_nop 0
    buffer_load_dwordx4 v17, s[48:51], s83 offen lds
    buffer_load_dwordx4 v18, s[48:51], s83 offen offset:1024 lds
    v_cvt_pk_bf16_f32 v231, v230, v231
    v_cvt_pk_bf16_f32 v233, v232, v233
    v_cvt_pk_bf16_f32 v235, v234, v235
    v_lshlrev_b32 v228, 16, v229
    v_and_b32 v229, 0xffff0000, v229
    v_lshlrev_b32 v230, 16, v231
    v_and_b32 v231, 0xffff0000, v231
    v_lshlrev_b32 v232, 16, v233
    v_and_b32 v233, 0xffff0000, v233
    v_lshlrev_b32 v234, 16, v235
    v_and_b32 v235, 0xffff0000, v235
    v_cndmask_b32 v228, v244, v228, s[4:5]
    v_cndmask_b32 v229, v244, v229, s[6:7]
    v_max_f32 v236, v228, v229
    v_max_f32 v238, v230, v231
    v_max_f32 v240, v232, v233
    v_max_f32 v242, v234, v235
    v_permlane16_swap_b32 v236, v238
    s_nop 0
    v_permlane16_swap_b32 v240, v242
    v_max_f32 v236, v236, v238
    v_max_f32 v240, v240, v242
    s_nop 1
    v_permlane32_swap_b32 v236, v240
    v_max_f32 v236, v236, v240
    v_mul_f32 v236, 0xbfb8aa3b, v236
    v_mov_b32 v240, v236
    s_nop 1
    v_permlane32_swap_b32 v236, v240
    v_mov_b32 v238, v236
    v_mov_b32 v242, v240
    s_mov_b32 s82, 1441792
    s_add_u32 m0, s3, 114688
    s_nop 0
    buffer_load_dwordx4 v17, s[48:51], s82 offen lds
    buffer_load_dwordx4 v18, s[48:51], s82 offen offset:1024 lds
    v_permlane16_swap_b32 v236, v238
    v_permlane16_swap_b32 v240, v242
    v_pk_fma_f32 v[228:229], v[228:229], s[98:99], v[236:237] op_sel_hi:[1,1,0]
    v_pk_fma_f32 v[230:231], v[230:231], s[98:99], v[238:239] op_sel_hi:[1,1,0]
    v_pk_fma_f32 v[232:233], v[232:233], s[98:99], v[240:241] op_sel_hi:[1,1,0]
    v_pk_fma_f32 v[234:235], v[234:235], s[98:99], v[242:243] op_sel_hi:[1,1,0]
    v_exp_f32 v228, v228
    v_exp_f32 v229, v229
    v_exp_f32 v230, v230
    v_exp_f32 v231, v231
    v_exp_f32 v232, v232
    v_exp_f32 v233, v233
    v_exp_f32 v234, v234
    v_exp_f32 v235, v235
    v_add_f32 v236, v228, v229
    v_add_f32 v238, v230, v231
    v_add_f32 v240, v232, v233
    v_add_f32 v242, v234, v235
    v_permlane16_swap_b32 v236, v238
    s_nop 0
    v_permlane16_swap_b32 v240, v242
    v_add_f32 v236, v236, v238
    v_add_f32 v240, v240, v242
    s_nop 1
    v_permlane32_swap_b32 v236, v240
    v_add_f32 v236, v236, v240
    v_rcp_f32 v236, v236
    s_nop 0
    v_mov_b32 v240, v236
    s_nop 1
    v_permlane32_swap_b32 v236, v240
    v_mov_b32 v238, v236
    s_mov_b32 s83, 1671168
    s_add_u32 m0, s3, 122880
    s_nop 0
    buffer_load_dwordx4 v17, s[48:51], s83 offen lds
    buffer_load_dwordx4 v18, s[48:51], s83 offen offset:1024 lds
    v_mov_b32 v242, v240
    v_permlane16_swap_b32 v236, v238
    s_nop 0
    v_permlane16_swap_b32 v240, v242
    v_pk_mul_f32 v[228:229], v[228:229], v[236:237] op_sel_hi:[1,0]
    v_pk_mul_f32 v[230:231], v[230:231], v[238:239] op_sel_hi:[1,0]
    v_pk_mul_f32 v[232:233], v[232:233], v[240:241] op_sel_hi:[1,0]
    v_pk_mul_f32 v[234:235], v[234:235], v[242:243] op_sel_hi:[1,0]
    v_cvt_pk_bf16_f32 v228, v228, v229
    v_cvt_pk_bf16_f32 v230, v230, v231
    v_cvt_pk_bf16_f32 v232, v232, v233
    v_cvt_pk_bf16_f32 v234, v234, v235
    v_perm_b32 v164, v228, v228, v30
    v_perm_b32 v165, v228, v228, v31
    v_perm_b32 v166, v228, v228, v32
    v_perm_b32 v167, v228, v228, v33
    v_perm_b32 v168, v230, v230, v30
    v_perm_b32 v169, v230, v230, v31
    v_perm_b32 v170, v230, v230, v32
    v_perm_b32 v171, v230, v230, v33
    v_perm_b32 v172, v232, v232, v30
    v_perm_b32 v173, v232, v232, v31
    v_perm_b32 v174, v232, v232, v32
    v_perm_b32 v175, v232, v232, v33
    v_perm_b32 v176, v234, v234, v30
    v_perm_b32 v177, v234, v234, v31
    v_perm_b32 v178, v234, v234, v32
    v_perm_b32 v179, v234, v234, v33
    v_mfma_f32_16x16x32_bf16 v[196:199], v[48:51], v[164:167], 0
    v_mfma_f32_16x16x32_bf16 v[200:203], v[84:87], v[164:167], 0
    v_mfma_f32_16x16x32_bf16 v[204:207], v[50:53], v[168:171], 0
    v_mfma_f32_16x16x32_bf16 v[208:211], v[86:89], v[168:171], 0
    v_mfma_f32_16x16x32_bf16 v[212:215], v[52:55], v[172:175], 0
    v_mfma_f32_16x16x32_bf16 v[216:219], v[88:91], v[172:175], 0
    v_mfma_f32_16x16x32_bf16 v[220:223], v[54:57], v[176:179], 0
    v_mfma_f32_16x16x32_bf16 v[224:227], v[90:93], v[176:179], 0
    v_accvgpr_read_b32 v34, a160
    s_mov_b32 s82, 131072
    s_add_u32 m0, s3, 131072
    s_nop 0
    buffer_load_dwordx4 v17, s[48:51], s82 offen lds
    buffer_load_dwordx4 v18, s[48:51], s82 offen offset:1024 lds
    v_accvgpr_read_b32 v35, a161
    v_accvgpr_read_b32 v36, a162
    v_accvgpr_read_b32 v37, a163
    v_accvgpr_read_b32 v38, a164
    v_accvgpr_read_b32 v39, a165
    v_accvgpr_read_b32 v40, a166
    v_accvgpr_read_b32 v41, a167
    v_cvt_pk_bf16_f32 v148, v34, v35
    v_cvt_pk_bf16_f32 v149, v36, v37
    v_cvt_pk_bf16_f32 v150, v38, v39
    v_cvt_pk_bf16_f32 v151, v40, v41
    v_accvgpr_read_b32 v246, a224
    v_accvgpr_read_b32 v247, a225
    v_accvgpr_read_b32 v248, a226
    v_accvgpr_read_b32 v249, a227
    v_accvgpr_read_b32 v250, a228
    v_accvgpr_read_b32 v251, a229
    v_accvgpr_read_b32 v252, a230
    v_accvgpr_read_b32 v253, a231
    v_cvt_pk_bf16_f32 v180, v246, v247
    v_cvt_pk_bf16_f32 v181, v248, v249
    v_cvt_pk_bf16_f32 v182, v250, v251
    v_cvt_pk_bf16_f32 v183, v252, v253
    v_accvgpr_read_b32 v34, a168
    s_mov_b32 s83, 360448
    s_add_u32 m0, s3, 139264
    s_nop 0
    buffer_load_dwordx4 v17, s[48:51], s83 offen lds
    buffer_load_dwordx4 v18, s[48:51], s83 offen offset:1024 lds
    v_accvgpr_read_b32 v35, a169
    v_accvgpr_read_b32 v36, a170
    v_accvgpr_read_b32 v37, a171
    v_accvgpr_read_b32 v38, a172
    v_accvgpr_read_b32 v39, a173
    v_accvgpr_read_b32 v40, a174
    v_accvgpr_read_b32 v41, a175
    v_cvt_pk_bf16_f32 v152, v34, v35
    v_cvt_pk_bf16_f32 v153, v36, v37
    v_cvt_pk_bf16_f32 v154, v38, v39
    v_cvt_pk_bf16_f32 v155, v40, v41
    v_accvgpr_read_b32 v246, a232
    v_accvgpr_read_b32 v247, a233
    v_accvgpr_read_b32 v248, a234
    v_accvgpr_read_b32 v249, a235
    v_accvgpr_read_b32 v250, a236
    v_accvgpr_read_b32 v251, a237
    v_accvgpr_read_b32 v252, a238
    v_accvgpr_read_b32 v253, a239
    v_cvt_pk_bf16_f32 v184, v246, v247
    v_cvt_pk_bf16_f32 v185, v248, v249
    v_cvt_pk_bf16_f32 v186, v250, v251
    v_cvt_pk_bf16_f32 v187, v252, v253
    v_accvgpr_read_b32 v34, a176
    s_mov_b32 s82, 589824
    s_add_u32 m0, s3, 147456
    s_nop 0
    buffer_load_dwordx4 v17, s[48:51], s82 offen lds
    buffer_load_dwordx4 v18, s[48:51], s82 offen offset:1024 lds
    v_accvgpr_read_b32 v35, a177
    v_accvgpr_read_b32 v36, a178
    v_accvgpr_read_b32 v37, a179
    v_accvgpr_read_b32 v38, a180
    v_accvgpr_read_b32 v39, a181
    v_accvgpr_read_b32 v40, a182
    v_accvgpr_read_b32 v41, a183
    v_cvt_pk_bf16_f32 v156, v34, v35
    v_cvt_pk_bf16_f32 v157, v36, v37
    v_cvt_pk_bf16_f32 v158, v38, v39
    v_cvt_pk_bf16_f32 v159, v40, v41
    v_accvgpr_read_b32 v246, a240
    v_accvgpr_read_b32 v247, a241
    v_accvgpr_read_b32 v248, a242
    v_accvgpr_read_b32 v249, a243
    v_accvgpr_read_b32 v250, a244
    v_accvgpr_read_b32 v251, a245
    v_accvgpr_read_b32 v252, a246
    v_accvgpr_read_b32 v253, a247
    v_cvt_pk_bf16_f32 v188, v246, v247
    v_cvt_pk_bf16_f32 v189, v248, v249
    v_cvt_pk_bf16_f32 v190, v250, v251
    v_cvt_pk_bf16_f32 v191, v252, v253
    v_accvgpr_read_b32 v34, a184
    s_mov_b32 s83, 819200
    s_add_u32 m0, s3, 155648
    s_nop 0
    buffer_load_dwordx4 v17, s[48:51], s83 offen lds
    buffer_load_dwordx4 v18, s[48:51], s83 offen offset:1024 lds
    v_accvgpr_read_b32 v35, a185
    v_accvgpr_read_b32 v36, a186
    v_accvgpr_read_b32 v37, a187
    v_accvgpr_read_b32 v38, a188
    v_accvgpr_read_b32 v39, a189
    v_accvgpr_read_b32 v40, a190
    v_accvgpr_read_b32 v41, a191
    v_cvt_pk_bf16_f32 v160, v34, v35
    v_cvt_pk_bf16_f32 v161, v36, v37
    v_cvt_pk_bf16_f32 v162, v38, v39
    v_cvt_pk_bf16_f32 v163, v40, v41
    v_accvgpr_read_b32 v246, a248
    v_accvgpr_read_b32 v247, a249
    v_accvgpr_read_b32 v248, a250
    v_accvgpr_read_b32 v249, a251
    v_accvgpr_read_b32 v250, a252
    v_accvgpr_read_b32 v251, a253
    v_accvgpr_read_b32 v252, a254
    v_accvgpr_read_b32 v253, a255
    v_cvt_pk_bf16_f32 v192, v246, v247
    v_cvt_pk_bf16_f32 v193, v248, v249
    v_cvt_pk_bf16_f32 v194, v250, v251
    v_cvt_pk_bf16_f32 v195, v252, v253
    v_cvt_pk_bf16_f32 v196, v196, v197
    v_cvt_pk_bf16_f32 v197, v198, v199
    v_cvt_pk_bf16_f32 v198, v200, v201
    v_cvt_pk_bf16_f32 v199, v202, v203
    buffer_store_dwordx4 v[196:199], v16, s[56:59], s91 offen offset:0 sc1
    s_add_u32 s91, s91, 32768
    v_cvt_pk_bf16_f32 v204, v204, v205
    v_cvt_pk_bf16_f32 v205, v206, v207
    v_cvt_pk_bf16_f32 v206, v208, v209
    v_cvt_pk_bf16_f32 v207, v210, v211
    buffer_store_dwordx4 v[204:207], v16, s[56:59], s91 offen offset:0 sc1
    s_add_u32 s91, s91, 32768
    v_cvt_pk_bf16_f32 v212, v212, v213
    v_cvt_pk_bf16_f32 v213, v214, v215
    v_cvt_pk_bf16_f32 v214, v216, v217
    v_cvt_pk_bf16_f32 v215, v218, v219
    buffer_store_dwordx4 v[212:215], v16, s[56:59], s91 offen offset:0 sc1
    s_add_u32 s91, s91, 32768
    v_cvt_pk_bf16_f32 v220, v220, v221
    v_cvt_pk_bf16_f32 v221, v222, v223
    v_cvt_pk_bf16_f32 v222, v224, v225
    v_cvt_pk_bf16_f32 v223, v226, v227
    buffer_store_dwordx4 v[220:223], v16, s[56:59], s91 offen offset:0 sc1
    s_add_u32 s91, s91, 32768
    v_mfma_f32_16x16x32_bf16 v[196:199], v[144:147], v[180:183], 0
    v_mfma_f32_16x16x32_bf16 v[200:203], v[148:151], v[180:183], 0
    v_mfma_f32_16x16x32_bf16 v[204:207], v[148:151], v[184:187], 0
    v_mfma_f32_16x16x32_bf16 v[208:211], v[152:155], v[184:187], 0
    v_mfma_f32_16x16x32_bf16 v[212:215], v[152:155], v[188:191], 0
    v_mfma_f32_16x16x32_bf16 v[216:219], v[156:159], v[188:191], 0
    v_mfma_f32_16x16x32_bf16 v[220:223], v[156:159], v[192:195], 0
    v_mfma_f32_16x16x32_bf16 v[224:227], v[160:163], v[192:195], 0
    s_nop 0
    v_cvt_pk_bf16_f32 v196, v196, v197
    v_cvt_pk_bf16_f32 v198, v198, v199
    v_cvt_pk_bf16_f32 v200, v200, v201
    v_cvt_pk_bf16_f32 v202, v202, v203
    v_cvt_pk_bf16_f32 v204, v204, v205
    v_cvt_pk_bf16_f32 v206, v206, v207
    v_cvt_pk_bf16_f32 v208, v208, v209
    v_cvt_pk_bf16_f32 v210, v210, v211
    v_cvt_pk_bf16_f32 v212, v212, v213
    v_cvt_pk_bf16_f32 v214, v214, v215
    v_cvt_pk_bf16_f32 v216, v216, v217
    v_cvt_pk_bf16_f32 v218, v218, v219
    v_cvt_pk_bf16_f32 v220, v220, v221
    v_cvt_pk_bf16_f32 v222, v222, v223
    v_cvt_pk_bf16_f32 v224, v224, v225
    v_cvt_pk_bf16_f32 v226, v226, v227
    v_perm_b32 v228, v200, v196, v28
    v_perm_b32 v229, v202, v198, v29
    v_perm_b32 v230, v208, v204, v28
    v_perm_b32 v231, v210, v206, v29
    v_perm_b32 v232, v216, v212, v28
    v_perm_b32 v233, v218, v214, v29
    v_perm_b32 v234, v224, v220, v28
    v_perm_b32 v235, v226, v222, v29
    v_pk_mul_f32 v[228:229], v[228:229], s[14:15]
    v_pk_mul_f32 v[230:231], v[230:231], s[14:15]
    v_pk_mul_f32 v[232:233], v[232:233], s[14:15]
    v_pk_mul_f32 v[234:235], v[234:235], s[14:15]
    v_cvt_pk_bf16_f32 v229, v228, v229
    v_cvt_pk_bf16_f32 v231, v230, v231
    v_cvt_pk_bf16_f32 v233, v232, v233
    v_cvt_pk_bf16_f32 v235, v234, v235
    v_lshlrev_b32 v228, 16, v229
    v_and_b32 v229, 0xffff0000, v229
    v_lshlrev_b32 v230, 16, v231
    v_and_b32 v231, 0xffff0000, v231
    v_lshlrev_b32 v232, 16, v233
    v_and_b32 v233, 0xffff0000, v233
    v_lshlrev_b32 v234, 16, v235
    v_and_b32 v235, 0xffff0000, v235
    v_max_f32 v236, v228, v229
    v_max_f32 v238, v230, v231
    v_max_f32 v240, v232, v233
    v_max_f32 v242, v234, v235
    v_permlane16_swap_b32 v236, v238
    s_nop 0
    v_permlane16_swap_b32 v240, v242
    v_max_f32 v236, v236, v238
    v_max_f32 v240, v240, v242
    s_nop 1
    v_permlane32_swap_b32 v236, v240
    v_max_f32 v236, v236, v240
    v_mul_f32 v236, 0xbfb8aa3b, v236
    v_mov_b32 v240, v236
    s_nop 1
    v_permlane32_swap_b32 v236, v240
    v_mov_b32 v238, v236
    v_mov_b32 v242, v240
    s_nop 0
    v_permlane16_swap_b32 v236, v238
    v_permlane16_swap_b32 v240, v242
    v_pk_fma_f32 v[228:229], v[228:229], s[98:99], v[236:237] op_sel_hi:[1,1,0]
    v_pk_fma_f32 v[230:231], v[230:231], s[98:99], v[238:239] op_sel_hi:[1,1,0]
    v_pk_fma_f32 v[232:233], v[232:233], s[98:99], v[240:241] op_sel_hi:[1,1,0]
    v_pk_fma_f32 v[234:235], v[234:235], s[98:99], v[242:243] op_sel_hi:[1,1,0]
    v_exp_f32 v228, v228
    v_exp_f32 v229, v229
    v_exp_f32 v230, v230
    v_exp_f32 v231, v231
    v_exp_f32 v232, v232
    v_exp_f32 v233, v233
    v_exp_f32 v234, v234
    v_exp_f32 v235, v235
    v_add_f32 v236, v228, v229
    v_add_f32 v238, v230, v231
    v_add_f32 v240, v232, v233
    v_add_f32 v242, v234, v235
    v_permlane16_swap_b32 v236, v238
    s_nop 0
    v_permlane16_swap_b32 v240, v242
    v_add_f32 v236, v236, v238
    v_add_f32 v240, v240, v242
    s_nop 1
    v_permlane32_swap_b32 v236, v240
    v_add_f32 v236, v236, v240
    v_rcp_f32 v236, v236
    s_nop 0
    v_mov_b32 v240, v236
    s_nop 1
    v_permlane32_swap_b32 v236, v240
    v_mov_b32 v238, v236
    v_mov_b32 v242, v240
    s_nop 0
    v_permlane16_swap_b32 v236, v238
    v_permlane16_swap_b32 v240, v242
    v_pk_mul_f32 v[228:229], v[228:229], v[236:237] op_sel_hi:[1,0]
    v_pk_mul_f32 v[230:231], v[230:231], v[238:239] op_sel_hi:[1,0]
    v_pk_mul_f32 v[232:233], v[232:233], v[240:241] op_sel_hi:[1,0]
    v_pk_mul_f32 v[234:235], v[234:235], v[242:243] op_sel_hi:[1,0]
    v_cvt_pk_bf16_f32 v228, v228, v229
    v_cvt_pk_bf16_f32 v230, v230, v231
    v_cvt_pk_bf16_f32 v232, v232, v233
    v_cvt_pk_bf16_f32 v234, v234, v235
    v_perm_b32 v180, v228, v228, v30
    v_perm_b32 v181, v228, v228, v31
    v_perm_b32 v182, v228, v228, v32
    v_perm_b32 v183, v228, v228, v33
    v_perm_b32 v184, v230, v230, v30
    v_perm_b32 v185, v230, v230, v31
    v_perm_b32 v186, v230, v230, v32
    v_perm_b32 v187, v230, v230, v33
    v_perm_b32 v188, v232, v232, v30
    v_perm_b32 v189, v232, v232, v31
    v_perm_b32 v190, v232, v232, v32
    v_perm_b32 v191, v232, v232, v33
    v_perm_b32 v192, v234, v234, v30
    v_perm_b32 v193, v234, v234, v31
    v_perm_b32 v194, v234, v234, v32
    v_perm_b32 v195, v234, v234, v33
    v_mfma_f32_16x16x32_bf16 v[196:199], v[56:59], v[180:183], 0
    v_mfma_f32_16x16x32_bf16 v[200:203], v[92:95], v[180:183], 0
    v_mfma_f32_16x16x32_bf16 v[204:207], v[58:61], v[184:187], 0
    v_mfma_f32_16x16x32_bf16 v[208:211], v[94:97], v[184:187], 0
    v_mfma_f32_16x16x32_bf16 v[212:215], v[60:63], v[188:191], 0
    v_mfma_f32_16x16x32_bf16 v[216:219], v[96:99], v[188:191], 0
    v_mfma_f32_16x16x32_bf16 v[220:223], v[62:65], v[192:195], 0
    v_mfma_f32_16x16x32_bf16 v[224:227], v[98:101], v[192:195], 0
    s_nop 0
    v_cvt_pk_bf16_f32 v196, v196, v197
    v_cvt_pk_bf16_f32 v197, v198, v199
    v_cvt_pk_bf16_f32 v198, v200, v201
    v_cvt_pk_bf16_f32 v199, v202, v203
    buffer_store_dwordx4 v[196:199], v16, s[56:59], s91 offen offset:0 sc1
    s_add_u32 s91, s91, 32768
    v_cvt_pk_bf16_f32 v204, v204, v205
    v_cvt_pk_bf16_f32 v205, v206, v207
    v_cvt_pk_bf16_f32 v206, v208, v209
    v_cvt_pk_bf16_f32 v207, v210, v211
    buffer_store_dwordx4 v[204:207], v16, s[56:59], s91 offen offset:0 sc1
    s_add_u32 s91, s91, 32768
    v_cvt_pk_bf16_f32 v212, v212, v213
    v_cvt_pk_bf16_f32 v213, v214, v215
    v_cvt_pk_bf16_f32 v214, v216, v217
    v_cvt_pk_bf16_f32 v215, v218, v219
    buffer_store_dwordx4 v[212:215], v16, s[56:59], s91 offen offset:0 sc1
    s_add_u32 s91, s91, 32768
    v_cvt_pk_bf16_f32 v220, v220, v221
    v_cvt_pk_bf16_f32 v221, v222, v223
    v_cvt_pk_bf16_f32 v222, v224, v225
    v_cvt_pk_bf16_f32 v223, v226, v227
    buffer_store_dwordx4 v[220:223], v16, s[56:59], s91 offen offset:0 sc1
    s_add_u32 s91, s91, 32768
    s_mov_b32 s67, 0
L_spA:
    buffer_load_dword v43, off, s[56:59], s92 sc1
    s_waitcnt vmcnt(0)
    v_readfirstlane_b32 s86, v43
    s_bfe_u32 s86, s86, 0x80000
    s_cmp_eq_u32 s86, 32
    s_cbranch_scc1 L_okA
    s_add_u32 s67, s67, 1
    s_cmp_lt_u32 s67, 0x40000
    s_cbranch_scc1 L_spA
L_okA:
    buffer_load_dwordx4 a[0:3], v21, s[56:59], s68 offen sc1
    buffer_load_dwordx4 a[4:7], v22, s[56:59], s68 offen sc1
    buffer_load_dwordx4 a[8:11], v23, s[56:59], s68 offen sc1
    buffer_load_dwordx4 a[12:15], v24, s[56:59], s68 offen sc1
    s_add_u32 s68, s68, 16384
    buffer_load_dwordx4 a[16:19], v21, s[56:59], s68 offen sc1
    buffer_load_dwordx4 a[20:23], v22, s[56:59], s68 offen sc1
    buffer_load_dwordx4 a[24:27], v23, s[56:59], s68 offen sc1
    buffer_load_dwordx4 a[28:31], v24, s[56:59], s68 offen sc1
    s_add_u32 s68, s68, 16384
    buffer_load_dwordx4 a[32:35], v21, s[56:59], s68 offen sc1
    buffer_load_dwordx4 a[36:39], v22, s[56:59], s68 offen sc1
    buffer_load_dwordx4 a[40:43], v23, s[56:59], s68 offen sc1
    buffer_load_dwordx4 a[44:47], v24, s[56:59], s68 offen sc1
    s_add_u32 s68, s68, 16384
    buffer_load_dwordx4 a[48:51], v21, s[56:59], s68 offen sc1
    buffer_load_dwordx4 a[52:55], v22, s[56:59], s68 offen sc1
    buffer_load_dwordx4 a[56:59], v23, s[56:59], s68 offen sc1
    buffer_load_dwordx4 a[60:63], v24, s[56:59], s68 offen sc1
    s_add_u32 s68, s68, 16384
    buffer_load_dwordx4 a[64:67], v21, s[56:59], s68 offen sc1
    buffer_load_dwordx4 a[68:71], v22, s[56:59], s68 offen sc1
    buffer_load_dwordx4 a[72:75], v23, s[56:59], s68 offen sc1
    buffer_load_dwordx4 a[76:79], v24, s[56:59], s68 offen sc1
    s_add_u32 s68, s68, 16384
    buffer_load_dwordx4 a[80:83], v21, s[56:59], s68 offen sc1
    buffer_load_dwordx4 a[84:87], v22, s[56:59], s68 offen sc1
    buffer_load_dwordx4 a[88:91], v23, s[56:59], s68 offen sc1
    buffer_load_dwordx4 a[92:95], v24, s[56:59], s68 offen sc1
    s_add_u32 s68, s68, 16384
    buffer_load_dwordx4 a[96:99], v21, s[56:59], s68 offen sc1
    buffer_load_dwordx4 a[100:103], v22, s[56:59], s68 offen sc1
    buffer_load_dwordx4 a[104:107], v23, s[56:59], s68 offen sc1
    buffer_load_dwordx4 a[108:111], v24, s[56:59], s68 offen sc1
    s_add_u32 s68, s68, 16384
    buffer_load_dwordx4 a[112:115], v21, s[56:59], s68 offen sc1
    buffer_load_dwordx4 a[116:119], v22, s[56:59], s68 offen sc1
    buffer_load_dwordx4 a[120:123], v23, s[56:59], s68 offen sc1
    buffer_load_dwordx4 a[124:127], v24, s[56:59], s68 offen sc1
    s_add_u32 s68, s68, 16384
    s_barrier
    s_branch L_D
L_epi1:
    v_accvgpr_read_b32 v128, a128
    v_accvgpr_read_b32 v129, a129
    v_accvgpr_read_b32 v130, a130
    v_accvgpr_read_b32 v131, a131
    v_accvgpr_read_b32 v132, a132
    s_mov_b32 s82, 65536
    s_add_u32 m0, s3, 65536
    s_nop 0
    buffer_load_dwordx4 v17, s[48:51], s82 offen lds
    buffer_load_dwordx4 v18, s[48:51], s82 offen offset:1024 lds
    v_accvgpr_read_b32 v133, a133
    v_accvgpr_read_b32 v134, a134
    v_accvgpr_read_b32 v135, a135
    v_accvgpr_read_b32 v136, a136
    v_accvgpr_read_b32 v137, a137
    v_accvgpr_read_b32 v138, a138
    v_accvgpr_read_b32 v139, a139
    v_accvgpr_read_b32 v140, a140
    v_accvgpr_read_b32 v141, a141
    v_accvgpr_read_b32 v142, a142
    v_accvgpr_read_b32 v143, a143
    v_pk_mul_f32 v[34:35], v[128:129], v[128:129]
    v_pk_mul_f32 v[36:37], v[130:131], v[130:131]
    v_pk_mul_f32 v[38:39], v[132:133], v[132:133]
    v_pk_mul_f32 v[40:41], v[134:135], v[134:135]
    v_pk_fma_f32 v[34:35], v[34:35], s[94:95], v[26:27]
    v_pk_fma_f32 v[36:37], v[36:37], s[94:95], v[26:27]
    v_pk_fma_f32 v[38:39], v[38:39], s[94:95], v[26:27]
    v_pk_fma_f32 v[40:41], v[40:41], s[94:95], v[26:27]
    v_pk_mul_f32 v[34:35], v[34:35], v[128:129]
    v_pk_mul_f32 v[36:37], v[36:37], v[130:131]
    v_pk_mul_f32 v[38:39], v[38:39], v[132:133]
    v_pk_mul_f32 v[40:41], v[40:41], v[134:135]
    v_exp_f32 v34, v34
    v_exp_f32 v35, v35
    v_exp_f32 v36, v36
    v_exp_f32 v37, v37
    v_exp_f32 v38, v38
    s_mov_b32 s83, 294912
    s_add_u32 m0, s3, 73728
    s_nop 0
    buffer_load_dwordx4 v17, s[48:51], s83 offen lds
    buffer_load_dwordx4 v18, s[48:51], s83 offen offset:1024 lds
    v_exp_f32 v39, v39
    v_exp_f32 v40, v40
    v_exp_f32 v41, v41
    v_pk_mul_f32 v[136:137], v[136:137], v[128:129]
    v_pk_mul_f32 v[138:139], v[138:139], v[130:131]
    v_pk_mul_f32 v[140:141], v[140:141], v[132:133]
    v_pk_mul_f32 v[142:143], v[142:143], v[134:135]
    v_pk_add_f32 v[34:35], v[34:35], 1.0 op_sel_hi:[1,0]
    v_pk_add_f32 v[36:37], v[36:37], 1.0 op_sel_hi:[1,0]
    v_pk_add_f32 v[38:39], v[38:39], 1.0 op_sel_hi:[1,0]
    v_pk_add_f32 v[40:41], v[40:41], 1.0 op_sel_hi:[1,0]
    v_rcp_f32 v34, v34
    v_rcp_f32 v35, v35
    v_rcp_f32 v36, v36
    v_rcp_f32 v37, v37
    v_rcp_f32 v38, v38
    v_rcp_f32 v39, v39
    v_rcp_f32 v40, v40
    v_rcp_f32 v41, v41
    v_pk_mul_f32 v[136:137], v[136:137], v[34:35]
    v_pk_mul_f32 v[138:139], v[138:139], v[36:37]
    v_pk_mul_f32 v[140:141], v[140:141], v[38:39]
    v_pk_mul_f32 v[142:143], v[142:143], v[40:41]
    v_cvt_pk_bf16_f32 v128, v136, v137
    v_cvt_pk_bf16_f32 v129, v138, v139
    v_cvt_pk_bf16_f32 v130, v140, v141
    v_cvt_pk_bf16_f32 v131, v142, v143
    buffer_store_dwordx4 v[128:131], v16, s[56:59], s89 offen offset:0 sc1
    s_waitcnt vmcnt(5)
    s_mov_b64 exec, 1
    buffer_atomic_add v25, off, s[56:59], s92 sc1
    s_mov_b64 exec, -1
    v_accvgpr_read_b32 v144, a144
    v_accvgpr_read_b32 v145, a145
    v_accvgpr_read_b32 v146, a146
    v_accvgpr_read_b32 v147, a147
    v_accvgpr_read_b32 v148, a148
    s_mov_b32 s82, 524288
    s_add_u32 m0, s3, 81920
    s_nop 0
    buffer_load_dwordx4 v17, s[48:51], s82 offen lds
    buffer_load_dwordx4 v18, s[48:51], s82 offen offset:1024 lds
    v_accvgpr_read_b32 v149, a149
    v_accvgpr_read_b32 v150, a150
    v_accvgpr_read_b32 v151, a151
    v_accvgpr_read_b32 v152, a152
    v_accvgpr_read_b32 v153, a153
    v_accvgpr_read_b32 v154, a154
    v_accvgpr_read_b32 v155, a155
    v_accvgpr_read_b32 v156, a156
    v_accvgpr_read_b32 v157, a157
    v_accvgpr_read_b32 v158, a158
    v_accvgpr_read_b32 v159, a159
    v_pk_mul_f32 v[34:35], v[144:145], v[144:145]
    v_pk_mul_f32 v[36:37], v[146:147], v[146:147]
    v_pk_mul_f32 v[38:39], v[148:149], v[148:149]
    v_pk_mul_f32 v[40:41], v[150:151], v[150:151]
    v_pk_fma_f32 v[34:35], v[34:35], s[94:95], v[26:27]
    v_pk_fma_f32 v[36:37], v[36:37], s[94:95], v[26:27]
    v_pk_fma_f32 v[38:39], v[38:39], s[94:95], v[26:27]
    v_pk_fma_f32 v[40:41], v[40:41], s[94:95], v[26:27]
    v_pk_mul_f32 v[34:35], v[34:35], v[144:145]
    v_pk_mul_f32 v[36:37], v[36:37], v[146:147]
    v_pk_mul_f32 v[38:39], v[38:39], v[148:149]
    v_pk_mul_f32 v[40:41], v[40:41], v[150:151]
    v_exp_f32 v34, v34
    v_exp_f32 v35, v35
    v_exp_f32 v36, v36
    v_exp_f32 v37, v37
    v_exp_f32 v38, v38
    s_mov_b32 s83, 753664
    s_add_u32 m0, s3, 90112
    s_nop 0
    buffer_load_dwordx4 v17, s[48:51], s83 offen lds
    buffer_load_dwordx4 v18, s[48:51], s83 offen offset:1024 lds
    v_exp_f32 v39, v39
    v_exp_f32 v40, v40
    v_exp_f32 v41, v41
    v_pk_mul_f32 v[152:153], v[152:153], v[144:145]
    v_pk_mul_f32 v[154:155], v[154:155], v[146:147]
    v_pk_mul_f32 v[156:157], v[156:157], v[148:149]
    v_pk_mul_f32 v[158:159], v[158:159], v[150:151]
    v_pk_add_f32 v[34:35], v[34:35], 1.0 op_sel_hi:[1,0]
    v_pk_add_f32 v[36:37], v[36:37], 1.0 op_sel_hi:[1,0]
    v_pk_add_f32 v[38:39], v[38:39], 1.0 op_sel_hi:[1,0]
    v_pk_add_f32 v[40:41], v[40:41], 1.0 op_sel_hi:[1,0]
    v_rcp_f32 v34, v34
    v_rcp_f32 v35, v35
    v_rcp_f32 v36, v36
    v_rcp_f32 v37, v37
    v_rcp_f32 v38, v38
    v_rcp_f32 v39, v39
    v_rcp_f32 v40, v40
    v_rcp_f32 v41, v41
    v_pk_mul_f32 v[152:153], v[152:153], v[34:35]
    v_pk_mul_f32 v[154:155], v[154:155], v[36:37]
    v_pk_mul_f32 v[156:157], v[156:157], v[38:39]
    v_pk_mul_f32 v[158:159], v[158:159], v[40:41]
    v_cvt_pk_bf16_f32 v144, v152, v153
    v_cvt_pk_bf16_f32 v145, v154, v155
    v_cvt_pk_bf16_f32 v146, v156, v157
    v_cvt_pk_bf16_f32 v147, v158, v159
    buffer_store_dwordx4 v[144:147], v16, s[56:59], s89 offen offset:1024 sc1
    v_accvgpr_read_b32 v160, a160
    v_accvgpr_read_b32 v161, a161
    v_accvgpr_read_b32 v162, a162
    v_accvgpr_read_b32 v163, a163
    v_accvgpr_read_b32 v164, a164
    s_mov_b32 s82, 983040
    s_add_u32 m0, s3, 98304
    s_nop 0
    buffer_load_dwordx4 v17, s[48:51], s82 offen lds
    buffer_load_dwordx4 v18, s[48:51], s82 offen offset:1024 lds
    v_accvgpr_read_b32 v165, a165
    v_accvgpr_read_b32 v166, a166
    v_accvgpr_read_b32 v167, a167
    v_accvgpr_read_b32 v168, a168
    v_accvgpr_read_b32 v169, a169
    v_accvgpr_read_b32 v170, a170
    v_accvgpr_read_b32 v171, a171
    v_accvgpr_read_b32 v172, a172
    v_accvgpr_read_b32 v173, a173
    v_accvgpr_read_b32 v174, a174
    v_accvgpr_read_b32 v175, a175
    v_pk_mul_f32 v[34:35], v[160:161], v[160:161]
    v_pk_mul_f32 v[36:37], v[162:163], v[162:163]
    v_pk_mul_f32 v[38:39], v[164:165], v[164:165]
    v_pk_mul_f32 v[40:41], v[166:167], v[166:167]
    v_pk_fma_f32 v[34:35], v[34:35], s[94:95], v[26:27]
    v_pk_fma_f32 v[36:37], v[36:37], s[94:95], v[26:27]
    v_pk_fma_f32 v[38:39], v[38:39], s[94:95], v[26:27]
    v_pk_fma_f32 v[40:41], v[40:41], s[94:95], v[26:27]
    v_pk_mul_f32 v[34:35], v[34:35], v[160:161]
    v_pk_mul_f32 v[36:37], v[36:37], v[162:163]
    v_pk_mul_f32 v[38:39], v[38:39], v[164:165]
    v_pk_mul_f32 v[40:41], v[40:41], v[166:167]
    v_exp_f32 v34, v34
    v_exp_f32 v35, v35
    v_exp_f32 v36, v36
    v_exp_f32 v37, v37
    v_exp_f32 v38, v38
    s_mov_b32 s83, 1212416
    s_add_u32 m0, s3, 106496
    s_nop 0
    buffer_load_dwordx4 v17, s[48:51], s83 offen lds
    buffer_load_dwordx4 v18, s[48:51], s83 offen offset:1024 lds
    v_exp_f32 v39, v39
    v_exp_f32 v40, v40
    v_exp_f32 v41, v41
    v_pk_mul_f32 v[168:169], v[168:169], v[160:161]
    v_pk_mul_f32 v[170:171], v[170:171], v[162:163]
    v_pk_mul_f32 v[172:173], v[172:173], v[164:165]
    v_pk_mul_f32 v[174:175], v[174:175], v[166:167]
    v_pk_add_f32 v[34:35], v[34:35], 1.0 op_sel_hi:[1,0]
    v_pk_add_f32 v[36:37], v[36:37], 1.0 op_sel_hi:[1,0]
    v_pk_add_f32 v[38:39], v[38:39], 1.0 op_sel_hi:[1,0]
    v_pk_add_f32 v[40:41], v[40:41], 1.0 op_sel_hi:[1,0]
    v_rcp_f32 v34, v34
    v_rcp_f32 v35, v35
    v_rcp_f32 v36, v36
    v_rcp_f32 v37, v37
    v_rcp_f32 v38, v38
    v_rcp_f32 v39, v39
    v_rcp_f32 v40, v40
    v_rcp_f32 v41, v41
    v_pk_mul_f32 v[168:169], v[168:169], v[34:35]
    v_pk_mul_f32 v[170:171], v[170:171], v[36:37]
    v_pk_mul_f32 v[172:173], v[172:173], v[38:39]
    v_pk_mul_f32 v[174:175], v[174:175], v[40:41]
    v_cvt_pk_bf16_f32 v160, v168, v169
    v_cvt_pk_bf16_f32 v161, v170, v171
    v_cvt_pk_bf16_f32 v162, v172, v173
    v_cvt_pk_bf16_f32 v163, v174, v175
    buffer_store_dwordx4 v[160:163], v16, s[56:59], s89 offen offset:2048 sc1
    v_accvgpr_read_b32 v176, a176
    v_accvgpr_read_b32 v177, a177
    v_accvgpr_read_b32 v178, a178
    v_accvgpr_read_b32 v179, a179
    v_accvgpr_read_b32 v180, a180
    s_mov_b32 s82, 1441792
    s_add_u32 m0, s3, 114688
    s_nop 0
    buffer_load_dwordx4 v17, s[48:51], s82 offen lds
    buffer_load_dwordx4 v18, s[48:51], s82 offen offset:1024 lds
    v_accvgpr_read_b32 v181, a181
    v_accvgpr_read_b32 v182, a182
    v_accvgpr_read_b32 v183, a183
    v_accvgpr_read_b32 v184, a184
    v_accvgpr_read_b32 v185, a185
    v_accvgpr_read_b32 v186, a186
    v_accvgpr_read_b32 v187, a187
    v_accvgpr_read_b32 v188, a188
    v_accvgpr_read_b32 v189, a189
    v_accvgpr_read_b32 v190, a190
    v_accvgpr_read_b32 v191, a191
    v_pk_mul_f32 v[34:35], v[176:177], v[176:177]
    v_pk_mul_f32 v[36:37], v[178:179], v[178:179]
    v_pk_mul_f32 v[38:39], v[180:181], v[180:181]
    v_pk_mul_f32 v[40:41], v[182:183], v[182:183]
    v_pk_fma_f32 v[34:35], v[34:35], s[94:95], v[26:27]
    v_pk_fma_f32 v[36:37], v[36:37], s[94:95], v[26:27]
    v_pk_fma_f32 v[38:39], v[38:39], s[94:95], v[26:27]
    v_pk_fma_f32 v[40:41], v[40:41], s[94:95], v[26:27]
    v_pk_mul_f32 v[34:35], v[34:35], v[176:177]
    v_pk_mul_f32 v[36:37], v[36:37], v[178:179]
    v_pk_mul_f32 v[38:39], v[38:39], v[180:181]
    v_pk_mul_f32 v[40:41], v[40:41], v[182:183]
    v_exp_f32 v34, v34
    v_exp_f32 v35, v35
    v_exp_f32 v36, v36
    v_exp_f32 v37, v37
    v_exp_f32 v38, v38
    s_mov_b32 s83, 1671168
    s_add_u32 m0, s3, 122880
    s_nop 0
    buffer_load_dwordx4 v17, s[48:51], s83 offen lds
    buffer_load_dwordx4 v18, s[48:51], s83 offen offset:1024 lds
    v_exp_f32 v39, v39
    v_exp_f32 v40, v40
    v_exp_f32 v41, v41
    v_pk_mul_f32 v[184:185], v[184:185], v[176:177]
    v_pk_mul_f32 v[186:187], v[186:187], v[178:179]
    v_pk_mul_f32 v[188:189], v[188:189], v[180:181]
    v_pk_mul_f32 v[190:191], v[190:191], v[182:183]
    v_pk_add_f32 v[34:35], v[34:35], 1.0 op_sel_hi:[1,0]
    v_pk_add_f32 v[36:37], v[36:37], 1.0 op_sel_hi:[1,0]
    v_pk_add_f32 v[38:39], v[38:39], 1.0 op_sel_hi:[1,0]
    v_pk_add_f32 v[40:41], v[40:41], 1.0 op_sel_hi:[1,0]
    v_rcp_f32 v34, v34
    v_rcp_f32 v35, v35
    v_rcp_f32 v36, v36
    v_rcp_f32 v37, v37
    v_rcp_f32 v38, v38
    v_rcp_f32 v39, v39
    v_rcp_f32 v40, v40
    v_rcp_f32 v41, v41
    v_pk_mul_f32 v[184:185], v[184:185], v[34:35]
    v_pk_mul_f32 v[186:187], v[186:187], v[36:37]
    v_pk_mul_f32 v[188:189], v[188:189], v[38:39]
    v_pk_mul_f32 v[190:191], v[190:191], v[40:41]
    v_cvt_pk_bf16_f32 v176, v184, v185
    v_cvt_pk_bf16_f32 v177, v186, v187
    v_cvt_pk_bf16_f32 v178, v188, v189
    v_cvt_pk_bf16_f32 v179, v190, v191
    buffer_store_dwordx4 v[176:179], v16, s[56:59], s89 offen offset:3072 sc1
    v_accvgpr_read_b32 v128, a192
    v_accvgpr_read_b32 v129, a193
    v_accvgpr_read_b32 v130, a194
    v_accvgpr_read_b32 v131, a195
    v_accvgpr_read_b32 v132, a196
    s_mov_b32 s82, 131072
    s_add_u32 m0, s3, 131072
    s_nop 0
    buffer_load_dwordx4 v17, s[48:51], s82 offen lds
    buffer_load_dwordx4 v18, s[48:51], s82 offen offset:1024 lds
    v_accvgpr_read_b32 v133, a197
    v_accvgpr_read_b32 v134, a198
    v_accvgpr_read_b32 v135, a199
    v_accvgpr_read_b32 v136, a200
    v_accvgpr_read_b32 v137, a201
    v_accvgpr_read_b32 v138, a202
    v_accvgpr_read_b32 v139, a203
    v_accvgpr_read_b32 v140, a204
    v_accvgpr_read_b32 v141, a205
    v_accvgpr_read_b32 v142, a206
    v_accvgpr_read_b32 v143, a207
    v_pk_mul_f32 v[34:35], v[128:129], v[128:129]
    v_pk_mul_f32 v[36:37], v[130:131], v[130:131]
    v_pk_mul_f32 v[38:39], v[132:133], v[132:133]
    v_pk_mul_f32 v[40:41], v[134:135], v[134:135]
    v_pk_fma_f32 v[34:35], v[34:35], s[94:95], v[26:27]
    v_pk_fma_f32 v[36:37], v[36:37], s[94:95], v[26:27]
    v_pk_fma_f32 v[38:39], v[38:39], s[94:95], v[26:27]
    v_pk_fma_f32 v[40:41], v[40:41], s[94:95], v[26:27]
    v_pk_mul_f32 v[34:35], v[34:35], v[128:129]
    v_pk_mul_f32 v[36:37], v[36:37], v[130:131]
    v_pk_mul_f32 v[38:39], v[38:39], v[132:133]
    v_pk_mul_f32 v[40:41], v[40:41], v[134:135]
    v_exp_f32 v34, v34
    v_exp_f32 v35, v35
    v_exp_f32 v36, v36
    v_exp_f32 v37, v37
    v_exp_f32 v38, v38
    s_mov_b32 s83, 360448
    s_add_u32 m0, s3, 139264
    s_nop 0
    buffer_load_dwordx4 v17, s[48:51], s83 offen lds
    buffer_load_dwordx4 v18, s[48:51], s83 offen offset:1024 lds
    v_exp_f32 v39, v39
    v_exp_f32 v40, v40
    v_exp_f32 v41, v41
    v_pk_mul_f32 v[136:137], v[136:137], v[128:129]
    v_pk_mul_f32 v[138:139], v[138:139], v[130:131]
    v_pk_mul_f32 v[140:141], v[140:141], v[132:133]
    v_pk_mul_f32 v[142:143], v[142:143], v[134:135]
    v_pk_add_f32 v[34:35], v[34:35], 1.0 op_sel_hi:[1,0]
    v_pk_add_f32 v[36:37], v[36:37], 1.0 op_sel_hi:[1,0]
    v_pk_add_f32 v[38:39], v[38:39], 1.0 op_sel_hi:[1,0]
    v_pk_add_f32 v[40:41], v[40:41], 1.0 op_sel_hi:[1,0]
    v_rcp_f32 v34, v34
    v_rcp_f32 v35, v35
    v_rcp_f32 v36, v36
    v_rcp_f32 v37, v37
    v_rcp_f32 v38, v38
    v_rcp_f32 v39, v39
    v_rcp_f32 v40, v40
    v_rcp_f32 v41, v41
    v_pk_mul_f32 v[136:137], v[136:137], v[34:35]
    v_pk_mul_f32 v[138:139], v[138:139], v[36:37]
    v_pk_mul_f32 v[140:141], v[140:141], v[38:39]
    v_pk_mul_f32 v[142:143], v[142:143], v[40:41]
    v_cvt_pk_bf16_f32 v128, v136, v137
    v_cvt_pk_bf16_f32 v129, v138, v139
    v_cvt_pk_bf16_f32 v130, v140, v141
    v_cvt_pk_bf16_f32 v131, v142, v143
    s_add_u32 s89, s89, 4096
    buffer_store_dwordx4 v[128:131], v16, s[56:59], s89 offen offset:0 sc1
    v_accvgpr_read_b32 v144, a208
    v_accvgpr_read_b32 v145, a209
    v_accvgpr_read_b32 v146, a210
    v_accvgpr_read_b32 v147, a211
    v_accvgpr_read_b32 v148, a212
    s_mov_b32 s82, 589824
    s_add_u32 m0, s3, 147456
    s_nop 0
    buffer_load_dwordx4 v17, s[48:51], s82 offen lds
    buffer_load_dwordx4 v18, s[48:51], s82 offen offset:1024 lds
    v_accvgpr_read_b32 v149, a213
    v_accvgpr_read_b32 v150, a214
    v_accvgpr_read_b32 v151, a215
    v_accvgpr_read_b32 v152, a216
    v_accvgpr_read_b32 v153, a217
    v_accvgpr_read_b32 v154, a218
    v_accvgpr_read_b32 v155, a219
    v_accvgpr_read_b32 v156, a220
    v_accvgpr_read_b32 v157, a221
    v_accvgpr_read_b32 v158, a222
    v_accvgpr_read_b32 v159, a223
    v_pk_mul_f32 v[34:35], v[144:145], v[144:145]
    v_pk_mul_f32 v[36:37], v[146:147], v[146:147]
    v_pk_mul_f32 v[38:39], v[148:149], v[148:149]
    v_pk_mul_f32 v[40:41], v[150:151], v[150:151]
    v_pk_fma_f32 v[34:35], v[34:35], s[94:95], v[26:27]
    v_pk_fma_f32 v[36:37], v[36:37], s[94:95], v[26:27]
    v_pk_fma_f32 v[38:39], v[38:39], s[94:95], v[26:27]
    v_pk_fma_f32 v[40:41], v[40:41], s[94:95], v[26:27]
    v_pk_mul_f32 v[34:35], v[34:35], v[144:145]
    v_pk_mul_f32 v[36:37], v[36:37], v[146:147]
    v_pk_mul_f32 v[38:39], v[38:39], v[148:149]
    v_pk_mul_f32 v[40:41], v[40:41], v[150:151]
    v_exp_f32 v34, v34
    v_exp_f32 v35, v35
    v_exp_f32 v36, v36
    v_exp_f32 v37, v37
    v_exp_f32 v38, v38
    s_mov_b32 s83, 819200
    s_add_u32 m0, s3, 155648
    s_nop 0
    buffer_load_dwordx4 v17, s[48:51], s83 offen lds
    buffer_load_dwordx4 v18, s[48:51], s83 offen offset:1024 lds
    v_exp_f32 v39, v39
    v_exp_f32 v40, v40
    v_exp_f32 v41, v41
    v_pk_mul_f32 v[152:153], v[152:153], v[144:145]
    v_pk_mul_f32 v[154:155], v[154:155], v[146:147]
    v_pk_mul_f32 v[156:157], v[156:157], v[148:149]
    v_pk_mul_f32 v[158:159], v[158:159], v[150:151]
    v_pk_add_f32 v[34:35], v[34:35], 1.0 op_sel_hi:[1,0]
    v_pk_add_f32 v[36:37], v[36:37], 1.0 op_sel_hi:[1,0]
    v_pk_add_f32 v[38:39], v[38:39], 1.0 op_sel_hi:[1,0]
    v_pk_add_f32 v[40:41], v[40:41], 1.0 op_sel_hi:[1,0]
    v_rcp_f32 v34, v34
    v_rcp_f32 v35, v35
    v_rcp_f32 v36, v36
    v_rcp_f32 v37, v37
    v_rcp_f32 v38, v38
    v_rcp_f32 v39, v39
    v_rcp_f32 v40, v40
    v_rcp_f32 v41, v41
    v_pk_mul_f32 v[152:153], v[152:153], v[34:35]
    v_pk_mul_f32 v[154:155], v[154:155], v[36:37]
    v_pk_mul_f32 v[156:157], v[156:157], v[38:39]
    v_pk_mul_f32 v[158:159], v[158:159], v[40:41]
    v_cvt_pk_bf16_f32 v144, v152, v153
    v_cvt_pk_bf16_f32 v145, v154, v155
    v_cvt_pk_bf16_f32 v146, v156, v157
    v_cvt_pk_bf16_f32 v147, v158, v159
    buffer_store_dwordx4 v[144:147], v16, s[56:59], s89 offen offset:1024 sc1
    v_accvgpr_read_b32 v160, a224
    v_accvgpr_read_b32 v161, a225
    v_accvgpr_read_b32 v162, a226
    v_accvgpr_read_b32 v163, a227
    v_accvgpr_read_b32 v164, a228
    v_accvgpr_read_b32 v165, a229
    v_accvgpr_read_b32 v166, a230
    v_accvgpr_read_b32 v167, a231
    v_accvgpr_read_b32 v168, a232
    v_accvgpr_read_b32 v169, a233
    v_accvgpr_read_b32 v170, a234
    v_accvgpr_read_b32 v171, a235
    v_accvgpr_read_b32 v172, a236
    v_accvgpr_read_b32 v173, a237
    v_accvgpr_read_b32 v174, a238
    v_accvgpr_read_b32 v175, a239
    v_pk_mul_f32 v[34:35], v[160:161], v[160:161]
    v_pk_mul_f32 v[36:37], v[162:163], v[162:163]
    v_pk_mul_f32 v[38:39], v[164:165], v[164:165]
    v_pk_mul_f32 v[40:41], v[166:167], v[166:167]
    v_pk_fma_f32 v[34:35], v[34:35], s[94:95], v[26:27]
    v_pk_fma_f32 v[36:37], v[36:37], s[94:95], v[26:27]
    v_pk_fma_f32 v[38:39], v[38:39], s[94:95], v[26:27]
    v_pk_fma_f32 v[40:41], v[40:41], s[94:95], v[26:27]
    v_pk_mul_f32 v[34:35], v[34:35], v[160:161]
    v_pk_mul_f32 v[36:37], v[36:37], v[162:163]
    v_pk_mul_f32 v[38:39], v[38:39], v[164:165]
    v_pk_mul_f32 v[40:41], v[40:41], v[166:167]
    v_exp_f32 v34, v34
    v_exp_f32 v35, v35
    v_exp_f32 v36, v36
    v_exp_f32 v37, v37
    v_exp_f32 v38, v38
    v_exp_f32 v39, v39
    v_exp_f32 v40, v40
    v_exp_f32 v41, v41
    v_pk_mul_f32 v[168:169], v[168:169], v[160:161]
    v_pk_mul_f32 v[170:171], v[170:171], v[162:163]
    v_pk_mul_f32 v[172:173], v[172:173], v[164:165]
    v_pk_mul_f32 v[174:175], v[174:175], v[166:167]
    v_pk_add_f32 v[34:35], v[34:35], 1.0 op_sel_hi:[1,0]
    v_pk_add_f32 v[36:37], v[36:37], 1.0 op_sel_hi:[1,0]
    v_pk_add_f32 v[38:39], v[38:39], 1.0 op_sel_hi:[1,0]
    v_pk_add_f32 v[40:41], v[40:41], 1.0 op_sel_hi:[1,0]
    v_rcp_f32 v34, v34
    v_rcp_f32 v35, v35
    v_rcp_f32 v36, v36
    v_rcp_f32 v37, v37
    v_rcp_f32 v38, v38
    v_rcp_f32 v39, v39
    v_rcp_f32 v40, v40
    v_rcp_f32 v41, v41
    v_pk_mul_f32 v[168:169], v[168:169], v[34:35]
    v_pk_mul_f32 v[170:171], v[170:171], v[36:37]
    v_pk_mul_f32 v[172:173], v[172:173], v[38:39]
    v_pk_mul_f32 v[174:175], v[174:175], v[40:41]
    v_cvt_pk_bf16_f32 v160, v168, v169
    v_cvt_pk_bf16_f32 v161, v170, v171
    v_cvt_pk_bf16_f32 v162, v172, v173
    v_cvt_pk_bf16_f32 v163, v174, v175
    buffer_store_dwordx4 v[160:163], v16, s[56:59], s89 offen offset:2048 sc1
    v_accvgpr_read_b32 v176, a240
    v_accvgpr_read_b32 v177, a241
    v_accvgpr_read_b32 v178, a242
    v_accvgpr_read_b32 v179, a243
    v_accvgpr_read_b32 v180, a244
    v_accvgpr_read_b32 v181, a245
    v_accvgpr_read_b32 v182, a246
    v_accvgpr_read_b32 v183, a247
    v_accvgpr_read_b32 v184, a248
    v_accvgpr_read_b32 v185, a249
    v_accvgpr_read_b32 v186, a250
    v_accvgpr_read_b32 v187, a251
    v_accvgpr_read_b32 v188, a252
    v_accvgpr_read_b32 v189, a253
    v_accvgpr_read_b32 v190, a254
    v_accvgpr_read_b32 v191, a255
    v_pk_mul_f32 v[34:35], v[176:177], v[176:177]
    v_pk_mul_f32 v[36:37], v[178:179], v[178:179]
    v_pk_mul_f32 v[38:39], v[180:181], v[180:181]
    v_pk_mul_f32 v[40:41], v[182:183], v[182:183]
    v_pk_fma_f32 v[34:35], v[34:35], s[94:95], v[26:27]
    v_pk_fma_f32 v[36:37], v[36:37], s[94:95], v[26:27]
    v_pk_fma_f32 v[38:39], v[38:39], s[94:95], v[26:27]
    v_pk_fma_f32 v[40:41], v[40:41], s[94:95], v[26:27]
    v_pk_mul_f32 v[34:35], v[34:35], v[176:177]
    v_pk_mul_f32 v[36:37], v[36:37], v[178:179]
    v_pk_mul_f32 v[38:39], v[38:39], v[180:181]
    v_pk_mul_f32 v[40:41], v[40:41], v[182:183]
    v_exp_f32 v34, v34
    v_exp_f32 v35, v35
    v_exp_f32 v36, v36
    v_exp_f32 v37, v37
    v_exp_f32 v38, v38
    v_exp_f32 v39, v39
    v_exp_f32 v40, v40
    v_exp_f32 v41, v41
    v_pk_mul_f32 v[184:185], v[184:185], v[176:177]
    v_pk_mul_f32 v[186:187], v[186:187], v[178:179]
    v_pk_mul_f32 v[188:189], v[188:189], v[180:181]
    v_pk_mul_f32 v[190:191], v[190:191], v[182:183]
    v_pk_add_f32 v[34:35], v[34:35], 1.0 op_sel_hi:[1,0]
    v_pk_add_f32 v[36:37], v[36:37], 1.0 op_sel_hi:[1,0]
    v_pk_add_f32 v[38:39], v[38:39], 1.0 op_sel_hi:[1,0]
    v_pk_add_f32 v[40:41], v[40:41], 1.0 op_sel_hi:[1,0]
    v_rcp_f32 v34, v34
    v_rcp_f32 v35, v35
    v_rcp_f32 v36, v36
    v_rcp_f32 v37, v37
    v_rcp_f32 v38, v38
    v_rcp_f32 v39, v39
    v_rcp_f32 v40, v40
    v_rcp_f32 v41, v41
    v_pk_mul_f32 v[184:185], v[184:185], v[34:35]
    v_pk_mul_f32 v[186:187], v[186:187], v[36:37]
    v_pk_mul_f32 v[188:189], v[188:189], v[38:39]
    v_pk_mul_f32 v[190:191], v[190:191], v[40:41]
    v_cvt_pk_bf16_f32 v176, v184, v185
    v_cvt_pk_bf16_f32 v177, v186, v187
    v_cvt_pk_bf16_f32 v178, v188, v189
    v_cvt_pk_bf16_f32 v179, v190, v191
    buffer_store_dwordx4 v[176:179], v16, s[56:59], s89 offen offset:3072 sc1
    v_pk_mul_f32 v[34:35], v[48:49], v[48:49]
    v_pk_mul_f32 v[36:37], v[50:51], v[50:51]
    v_pk_mul_f32 v[38:39], v[52:53], v[52:53]
    v_pk_mul_f32 v[40:41], v[54:55], v[54:55]
    v_pk_fma_f32 v[34:35], v[34:35], s[94:95], v[26:27]
    v_pk_fma_f32 v[36:37], v[36:37], s[94:95], v[26:27]
    v_pk_fma_f32 v[38:39], v[38:39], s[94:95], v[26:27]
    v_pk_fma_f32 v[40:41], v[40:41], s[94:95], v[26:27]
    v_pk_mul_f32 v[34:35], v[34:35], v[48:49]
    v_pk_mul_f32 v[36:37], v[36:37], v[50:51]
    v_pk_mul_f32 v[38:39], v[38:39], v[52:53]
    v_pk_mul_f32 v[40:41], v[40:41], v[54:55]
    v_exp_f32 v34, v34
    v_exp_f32 v35, v35
    v_exp_f32 v36, v36
    v_exp_f32 v37, v37
    v_exp_f32 v38, v38
    v_exp_f32 v39, v39
    v_exp_f32 v40, v40
    v_exp_f32 v41, v41
    v_pk_mul_f32 v[56:57], v[56:57], v[48:49]
    v_pk_mul_f32 v[58:59], v[58:59], v[50:51]
    v_pk_mul_f32 v[60:61], v[60:61], v[52:53]
    v_pk_mul_f32 v[62:63], v[62:63], v[54:55]
    v_pk_add_f32 v[34:35], v[34:35], 1.0 op_sel_hi:[1,0]
    v_pk_add_f32 v[36:37], v[36:37], 1.0 op_sel_hi:[1,0]
    v_pk_add_f32 v[38:39], v[38:39], 1.0 op_sel_hi:[1,0]
    v_pk_add_f32 v[40:41], v[40:41], 1.0 op_sel_hi:[1,0]
    v_rcp_f32 v34, v34
    v_rcp_f32 v35, v35
    v_rcp_f32 v36, v36
    v_rcp_f32 v37, v37
    v_rcp_f32 v38, v38
    v_rcp_f32 v39, v39
    v_rcp_f32 v40, v40
    v_rcp_f32 v41, v41
    v_pk_mul_f32 v[56:57], v[56:57], v[34:35]
    v_pk_mul_f32 v[58:59], v[58:59], v[36:37]
    v_pk_mul_f32 v[60:61], v[60:61], v[38:39]
    v_pk_mul_f32 v[62:63], v[62:63], v[40:41]
    v_cvt_pk_bf16_f32 v48, v56, v57
    v_cvt_pk_bf16_f32 v49, v58, v59
    v_cvt_pk_bf16_f32 v50, v60, v61
    v_cvt_pk_bf16_f32 v51, v62, v63
    s_nop 0
    v_permlane16_swap_b32 v48, v50
    v_permlane16_swap_b32 v49, v51
    buffer_store_dwordx4 v[48:51], v28, s[56:59], s90 offen offset:0 sc1
    v_pk_mul_f32 v[34:35], v[64:65], v[64:65]
    v_pk_mul_f32 v[36:37], v[66:67], v[66:67]
    v_pk_mul_f32 v[38:39], v[68:69], v[68:69]
    v_pk_mul_f32 v[40:41], v[70:71], v[70:71]
    v_pk_fma_f32 v[34:35], v[34:35], s[94:95], v[26:27]
    v_pk_fma_f32 v[36:37], v[36:37], s[94:95], v[26:27]
    v_pk_fma_f32 v[38:39], v[38:39], s[94:95], v[26:27]
    v_pk_fma_f32 v[40:41], v[40:41], s[94:95], v[26:27]
    v_pk_mul_f32 v[34:35], v[34:35], v[64:65]
    v_pk_mul_f32 v[36:37], v[36:37], v[66:67]
    v_pk_mul_f32 v[38:39], v[38:39], v[68:69]
    v_pk_mul_f32 v[40:41], v[40:41], v[70:71]
    v_exp_f32 v34, v34
    v_exp_f32 v35, v35
    v_exp_f32 v36, v36
    v_exp_f32 v37, v37
    v_exp_f32 v38, v38
    v_exp_f32 v39, v39
    v_exp_f32 v40, v40
    v_exp_f32 v41, v41
    v_pk_mul_f32 v[72:73], v[72:73], v[64:65]
    v_pk_mul_f32 v[74:75], v[74:75], v[66:67]
    v_pk_mul_f32 v[76:77], v[76:77], v[68:69]
    v_pk_mul_f32 v[78:79], v[78:79], v[70:71]
    v_pk_add_f32 v[34:35], v[34:35], 1.0 op_sel_hi:[1,0]
    v_pk_add_f32 v[36:37], v[36:37], 1.0 op_sel_hi:[1,0]
    v_pk_add_f32 v[38:39], v[38:39], 1.0 op_sel_hi:[1,0]
    v_pk_add_f32 v[40:41], v[40:41], 1.0 op_sel_hi:[1,0]
    v_rcp_f32 v34, v34
    v_rcp_f32 v35, v35
    v_rcp_f32 v36, v36
    v_rcp_f32 v37, v37
    v_rcp_f32 v38, v38
    v_rcp_f32 v39, v39
    v_rcp_f32 v40, v40
    v_rcp_f32 v41, v41
    v_pk_mul_f32 v[72:73], v[72:73], v[34:35]
    v_pk_mul_f32 v[74:75], v[74:75], v[36:37]
    v_pk_mul_f32 v[76:77], v[76:77], v[38:39]
    v_pk_mul_f32 v[78:79], v[78:79], v[40:41]
    v_cvt_pk_bf16_f32 v64, v72, v73
    v_cvt_pk_bf16_f32 v65, v74, v75
    v_cvt_pk_bf16_f32 v66, v76, v77
    v_cvt_pk_bf16_f32 v67, v78, v79
    s_nop 0
    v_permlane16_swap_b32 v64, v66
    v_permlane16_swap_b32 v65, v67
    buffer_store_dwordx4 v[64:67], v28, s[56:59], s90 offen offset:2048 sc1
    s_waitcnt vmcnt(2)
    s_mov_b64 exec, 1
    buffer_atomic_add v29, off, s[56:59], s92 sc1
    s_mov_b64 exec, -1
    v_pk_mul_f32 v[34:35], v[80:81], v[80:81]
    v_pk_mul_f32 v[36:37], v[82:83], v[82:83]
    v_pk_mul_f32 v[38:39], v[84:85], v[84:85]
    v_pk_mul_f32 v[40:41], v[86:87], v[86:87]
    v_pk_fma_f32 v[34:35], v[34:35], s[94:95], v[26:27]
    v_pk_fma_f32 v[36:37], v[36:37], s[94:95], v[26:27]
    v_pk_fma_f32 v[38:39], v[38:39], s[94:95], v[26:27]
    v_pk_fma_f32 v[40:41], v[40:41], s[94:95], v[26:27]
    v_pk_mul_f32 v[34:35], v[34:35], v[80:81]
    v_pk_mul_f32 v[36:37], v[36:37], v[82:83]
    v_pk_mul_f32 v[38:39], v[38:39], v[84:85]
    v_pk_mul_f32 v[40:41], v[40:41], v[86:87]
    v_exp_f32 v34, v34
    v_exp_f32 v35, v35
    v_exp_f32 v36, v36
    v_exp_f32 v37, v37
    v_exp_f32 v38, v38
    v_exp_f32 v39, v39
    v_exp_f32 v40, v40
    v_exp_f32 v41, v41
    v_pk_mul_f32 v[88:89], v[88:89], v[80:81]
    v_pk_mul_f32 v[90:91], v[90:91], v[82:83]
    v_pk_mul_f32 v[92:93], v[92:93], v[84:85]
    v_pk_mul_f32 v[94:95], v[94:95], v[86:87]
    v_pk_add_f32 v[34:35], v[34:35], 1.0 op_sel_hi:[1,0]
    v_pk_add_f32 v[36:37], v[36:37], 1.0 op_sel_hi:[1,0]
    v_pk_add_f32 v[38:39], v[38:39], 1.0 op_sel_hi:[1,0]
    v_pk_add_f32 v[40:41], v[40:41], 1.0 op_sel_hi:[1,0]
    v_rcp_f32 v34, v34
    v_rcp_f32 v35, v35
    v_rcp_f32 v36, v36
    v_rcp_f32 v37, v37
    v_rcp_f32 v38, v38
    v_rcp_f32 v39, v39
    v_rcp_f32 v40, v40
    v_rcp_f32 v41, v41
    v_pk_mul_f32 v[88:89], v[88:89], v[34:35]
    v_pk_mul_f32 v[90:91], v[90:91], v[36:37]
    v_pk_mul_f32 v[92:93], v[92:93], v[38:39]
    v_pk_mul_f32 v[94:95], v[94:95], v[40:41]
    v_cvt_pk_bf16_f32 v80, v88, v89
    v_cvt_pk_bf16_f32 v81, v90, v91
    v_cvt_pk_bf16_f32 v82, v92, v93
    v_cvt_pk_bf16_f32 v83, v94, v95
    s_nop 0
    v_permlane16_swap_b32 v80, v82
    v_permlane16_swap_b32 v81, v83
    s_add_u32 s90, s90, 4096
    buffer_store_dwordx4 v[80:83], v28, s[56:59], s90 offen offset:0 sc1
    v_pk_mul_f32 v[34:35], v[96:97], v[96:97]
    v_pk_mul_f32 v[36:37], v[98:99], v[98:99]
    v_pk_mul_f32 v[38:39], v[100:101], v[100:101]
    v_pk_mul_f32 v[40:41], v[102:103], v[102:103]
    v_pk_fma_f32 v[34:35], v[34:35], s[94:95], v[26:27]
    v_pk_fma_f32 v[36:37], v[36:37], s[94:95], v[26:27]
    v_pk_fma_f32 v[38:39], v[38:39], s[94:95], v[26:27]
    v_pk_fma_f32 v[40:41], v[40:41], s[94:95], v[26:27]
    v_pk_mul_f32 v[34:35], v[34:35], v[96:97]
    v_pk_mul_f32 v[36:37], v[36:37], v[98:99]
    v_pk_mul_f32 v[38:39], v[38:39], v[100:101]
    v_pk_mul_f32 v[40:41], v[40:41], v[102:103]
    v_exp_f32 v34, v34
    v_exp_f32 v35, v35
    v_exp_f32 v36, v36
    v_exp_f32 v37, v37
    v_exp_f32 v38, v38
    v_exp_f32 v39, v39
    v_exp_f32 v40, v40
    v_exp_f32 v41, v41
    v_pk_mul_f32 v[104:105], v[104:105], v[96:97]
    v_pk_mul_f32 v[106:107], v[106:107], v[98:99]
    v_pk_mul_f32 v[108:109], v[108:109], v[100:101]
    v_pk_mul_f32 v[110:111], v[110:111], v[102:103]
    v_pk_add_f32 v[34:35], v[34:35], 1.0 op_sel_hi:[1,0]
    v_pk_add_f32 v[36:37], v[36:37], 1.0 op_sel_hi:[1,0]
    v_pk_add_f32 v[38:39], v[38:39], 1.0 op_sel_hi:[1,0]
    v_pk_add_f32 v[40:41], v[40:41], 1.0 op_sel_hi:[1,0]
    v_rcp_f32 v34, v34
    v_rcp_f32 v35, v35
    v_rcp_f32 v36, v36
    v_rcp_f32 v37, v37
    v_rcp_f32 v38, v38
    v_rcp_f32 v39, v39
    v_rcp_f32 v40, v40
    v_rcp_f32 v41, v41
    v_pk_mul_f32 v[104:105], v[104:105], v[34:35]
    v_pk_mul_f32 v[106:107], v[106:107], v[36:37]
    v_pk_mul_f32 v[108:109], v[108:109], v[38:39]
    v_pk_mul_f32 v[110:111], v[110:111], v[40:41]
    v_cvt_pk_bf16_f32 v96, v104, v105
    v_cvt_pk_bf16_f32 v97, v106, v107
    v_cvt_pk_bf16_f32 v98, v108, v109
    v_cvt_pk_bf16_f32 v99, v110, v111
    s_nop 0
    v_permlane16_swap_b32 v96, v98
    v_permlane16_swap_b32 v97, v99
    buffer_store_dwordx4 v[96:99], v28, s[56:59], s90 offen offset:2048 sc1
    s_mov_b32 s67, 0
    s_barrier
    buffer_load_dwordx4 a[0:3], v21, s[56:59], s68 offen sc1
    buffer_load_dwordx4 a[4:7], v22, s[56:59], s68 offen sc1
    buffer_load_dwordx4 a[8:11], v23, s[56:59], s68 offen sc1
    buffer_load_dwordx4 a[12:15], v24, s[56:59], s68 offen sc1
    s_add_u32 s68, s68, 16384
    buffer_load_dwordx4 a[16:19], v21, s[56:59], s68 offen sc1
    buffer_load_dwordx4 a[20:23], v22, s[56:59], s68 offen sc1
    buffer_load_dwordx4 a[24:27], v23, s[56:59], s68 offen sc1
    buffer_load_dwordx4 a[28:31], v24, s[56:59], s68 offen sc1
    s_add_u32 s68, s68, 16384
    buffer_load_dwordx4 a[32:35], v21, s[56:59], s68 offen sc1
    buffer_load_dwordx4 a[36:39], v22, s[56:59], s68 offen sc1
    buffer_load_dwordx4 a[40:43], v23, s[56:59], s68 offen sc1
    buffer_load_dwordx4 a[44:47], v24, s[56:59], s68 offen sc1
    s_add_u32 s68, s68, 16384
    buffer_load_dwordx4 a[48:51], v21, s[56:59], s68 offen sc1
    buffer_load_dwordx4 a[52:55], v22, s[56:59], s68 offen sc1
    buffer_load_dwordx4 a[56:59], v23, s[56:59], s68 offen sc1
    buffer_load_dwordx4 a[60:63], v24, s[56:59], s68 offen sc1
    s_add_u32 s68, s68, 16384
    buffer_load_dwordx4 a[64:67], v21, s[56:59], s68 offen sc1
    buffer_load_dwordx4 a[68:71], v22, s[56:59], s68 offen sc1
    buffer_load_dwordx4 a[72:75], v23, s[56:59], s68 offen sc1
    buffer_load_dwordx4 a[76:79], v24, s[56:59], s68 offen sc1
    s_add_u32 s68, s68, 16384
    buffer_load_dwordx4 a[80:83], v21, s[56:59], s68 offen sc1
    buffer_load_dwordx4 a[84:87], v22, s[56:59], s68 offen sc1
    buffer_load_dwordx4 a[88:91], v23, s[56:59], s68 offen sc1
    buffer_load_dwordx4 a[92:95], v24, s[56:59], s68 offen sc1
    s_add_u32 s68, s68, 16384
    buffer_load_dwordx4 a[96:99], v21, s[56:59], s68 offen sc1
    buffer_load_dwordx4 a[100:103], v22, s[56:59], s68 offen sc1
    buffer_load_dwordx4 a[104:107], v23, s[56:59], s68 offen sc1
    buffer_load_dwordx4 a[108:111], v24, s[56:59], s68 offen sc1
    s_add_u32 s68, s68, 16384
    buffer_load_dwordx4 a[112:115], v21, s[56:59], s68 offen sc1
    buffer_load_dwordx4 a[116:119], v22, s[56:59], s68 offen sc1
    buffer_load_dwordx4 a[120:123], v23, s[56:59], s68 offen sc1
    buffer_load_dwordx4 a[124:127], v24, s[56:59], s68 offen sc1
    s_add_u32 s68, s68, 16384
L_D:
    v_lshrrev_b32 v34, 2, v0
    v_and_b32 v35, 3, v0
    v_lshlrev_b32 v35, 3, v35
    v_lshl_add_u32 v35, v34, 8, v35
    v_and_b32 v34, 7, v34
    v_xor_b32 v36, 0, v34
    v_lshl_add_u32 v8, v36, 5, v35
    v_xor_b32 v36, 1, v34
    v_lshl_add_u32 v9, v36, 5, v35
    v_xor_b32 v36, 2, v34
    v_lshl_add_u32 v10, v36, 5, v35
    v_xor_b32 v36, 3, v34
    v_lshl_add_u32 v11, v36, 5, v35
    v_xor_b32 v36, 4, v34
    v_lshl_add_u32 v12, v36, 5, v35
    v_xor_b32 v36, 5, v34
    v_lshl_add_u32 v13, v36, 5, v35
    v_xor_b32 v36, 6, v34
    v_lshl_add_u32 v14, v36, 5, v35
    v_xor_b32 v36, 7, v34
    v_lshl_add_u32 v15, v36, 5, v35
    ds_read_b64_tr_b16 a[128:129], v8 offset:0
    ds_read_b64_tr_b16 a[130:131], v8 offset:4096
    ds_read_b64_tr_b16 a[132:133], v9 offset:0
    ds_read_b64_tr_b16 a[134:135], v9 offset:4096
    ds_read_b64_tr_b16 a[136:137], v10 offset:0
    ds_read_b64_tr_b16 a[138:139], v10 offset:4096
    ds_read_b64_tr_b16 a[140:141], v11 offset:0
    ds_read_b64_tr_b16 a[142:143], v11 offset:4096
    ds_read_b64_tr_b16 a[144:145], v12 offset:0
    ds_read_b64_tr_b16 a[146:147], v12 offset:4096
    ds_read_b64_tr_b16 a[148:149], v13 offset:0
    ds_read_b64_tr_b16 a[150:151], v13 offset:4096
    ds_read_b64_tr_b16 a[152:153], v14 offset:0
    ds_read_b64_tr_b16 a[154:155], v14 offset:4096
    ds_read_b64_tr_b16 a[156:157], v15 offset:0
    ds_read_b64_tr_b16 a[158:159], v15 offset:4096
    v_add_u32 v48, 0x10000, v8
    v_add_u32 v56, 0x20000, v8
    v_add_u32 v49, 0x10000, v9
    v_add_u32 v57, 0x20000, v9
    v_add_u32 v50, 0x10000, v10
    v_add_u32 v58, 0x20000, v10
    v_add_u32 v51, 0x10000, v11
    v_add_u32 v59, 0x20000, v11
    v_add_u32 v52, 0x10000, v12
    v_add_u32 v60, 0x20000, v12
    v_add_u32 v53, 0x10000, v13
    v_add_u32 v61, 0x20000, v13
    v_add_u32 v54, 0x10000, v14
    v_add_u32 v62, 0x20000, v14
    v_add_u32 v55, 0x10000, v15
    v_add_u32 v63, 0x20000, v15
    s_lshl_b32 s84, s63, 2
    s_add_u32 s84, s84, s60
    s_lshl_b32 s84, s84, 2
    s_add_u32 s84, s84, s65
    s_lshl_b32 s84, s84, 15
    s_lshl_b32 s85, s66, 8
    s_add_u32 s84, s84, s85
    v_and_b32 v34, 15, v0
    v_lshrrev_b32 v35, 4, v0
    v_lshlrev_b32 v36, 11, v34
    v_add_u32 v36, s84, v36
    v_lshl_add_u32 v1, v35, 3, v36
    v_and_b32 v2, 1, v35
    v_lshl_add_u32 v36, v2, 5, v36
    v_lshrrev_b32 v2, 1, v35
    v_lshl_add_u32 v2, v2, 4, v36
    v_lshlrev_b32 v35, 2, v35
    v_sub_u32 v34, v34, v35
    v_mov_b32 v26, 0
    v_mov_b32 v27, 0
    v_mov_b32 v30, 0
    v_mov_b32 v31, 0
    v_mov_b32 v35, 0x3f80
    v_mov_b32 v36, 0x3f800000
    v_cmp_eq_u32 vcc, 0, v34
    s_nop 1
    v_cndmask_b32 v28, v26, v35, vcc
    v_cmp_eq_u32 vcc, 1, v34
    s_nop 1
    v_cndmask_b32 v28, v28, v36, vcc
    v_cmp_eq_u32 vcc, 2, v34
    s_nop 1
    v_cndmask_b32 v29, v26, v35, vcc
    v_cmp_eq_u32 vcc, 3, v34
    s_nop 1
    v_cndmask_b32 v29, v29, v36, vcc
    s_mov_b32 s14, 0xbfb8aa3b
    s_mov_b32 s15, 0xbfb8aa3b
    s_waitcnt vmcnt(31) lgkmcnt(14)
    v_mfma_f32_16x16x32_bf16 v[128:131], a[128:131], a[0:3], 0
    s_waitcnt vmcnt(30)
    v_mfma_f32_16x16x32_bf16 v[160:163], a[128:131], a[4:7], 0
    ds_read_b64_tr_b16 a[160:161], v8 offset:8192
    s_waitcnt vmcnt(29)
    v_mfma_f32_16x16x32_bf16 v[192:195], a[128:131], a[8:11], 0
    ds_read_b64_tr_b16 a[162:163], v8 offset:12288
    s_waitcnt vmcnt(28)
    v_mfma_f32_16x16x32_bf16 v[224:227], a[128:131], a[12:15], 0
    s_waitcnt lgkmcnt(14)
    v_mfma_f32_16x16x32_bf16 v[132:135], a[132:135], a[0:3], 0
    ds_read_b64_tr_b16 a[164:165], v9 offset:8192
    v_mfma_f32_16x16x32_bf16 v[164:167], a[132:135], a[4:7], 0
    ds_read_b64_tr_b16 a[166:167], v9 offset:12288
    v_mfma_f32_16x16x32_bf16 v[196:199], a[132:135], a[8:11], 0
    v_mfma_f32_16x16x32_bf16 v[228:231], a[132:135], a[12:15], 0
    ds_read_b64_tr_b16 a[168:169], v10 offset:8192
    s_waitcnt lgkmcnt(15)
    v_mfma_f32_16x16x32_bf16 v[136:139], a[136:139], a[0:3], 0
    ds_read_b64_tr_b16 a[170:171], v10 offset:12288
    v_mfma_f32_16x16x32_bf16 v[168:171], a[136:139], a[4:7], 0
    v_mfma_f32_16x16x32_bf16 v[200:203], a[136:139], a[8:11], 0
    ds_read_b64_tr_b16 a[172:173], v11 offset:8192
    v_mfma_f32_16x16x32_bf16 v[232:235], a[136:139], a[12:15], 0
    ds_read_b64_tr_b16 a[174:175], v11 offset:12288
    s_waitcnt lgkmcnt(15)
    v_mfma_f32_16x16x32_bf16 v[140:143], a[140:143], a[0:3], 0
    v_mfma_f32_16x16x32_bf16 v[172:175], a[140:143], a[4:7], 0
    ds_read_b64_tr_b16 a[176:177], v12 offset:8192
    v_mfma_f32_16x16x32_bf16 v[204:207], a[140:143], a[8:11], 0
    ds_read_b64_tr_b16 a[178:179], v12 offset:12288
    v_mfma_f32_16x16x32_bf16 v[236:239], a[140:143], a[12:15], 0
    s_waitcnt lgkmcnt(15)
    v_mfma_f32_16x16x32_bf16 v[144:147], a[144:147], a[0:3], 0
    ds_read_b64_tr_b16 a[180:181], v13 offset:8192
    v_mfma_f32_16x16x32_bf16 v[176:179], a[144:147], a[4:7], 0
    ds_read_b64_tr_b16 a[182:183], v13 offset:12288
    v_mfma_f32_16x16x32_bf16 v[208:211], a[144:147], a[8:11], 0
    v_mfma_f32_16x16x32_bf16 v[240:243], a[144:147], a[12:15], 0
    ds_read_b64_tr_b16 a[184:185], v14 offset:8192
    s_waitcnt lgkmcnt(15)
    v_mfma_f32_16x16x32_bf16 v[148:151], a[148:151], a[0:3], 0
    ds_read_b64_tr_b16 a[186:187], v14 offset:12288
    s_mov_b64 exec, 1
    buffer_atomic_add v42, off, s[56:59], s93 sc1
    s_mov_b64 exec, -1
    v_mfma_f32_16x16x32_bf16 v[180:183], a[148:151], a[4:7], 0
    v_mfma_f32_16x16x32_bf16 v[212:215], a[148:151], a[8:11], 0
    ds_read_b64_tr_b16 a[188:189], v15 offset:8192
    v_mfma_f32_16x16x32_bf16 v[244:247], a[148:151], a[12:15], 0
    ds_read_b64_tr_b16 a[190:191], v15 offset:12288
    v_mfma_f32_16x16x32_bf16 v[152:155], a[152:155], a[0:3], 0
    v_mfma_f32_16x16x32_bf16 v[184:187], a[152:155], a[4:7], 0
    v_mfma_f32_16x16x32_bf16 v[216:219], a[152:155], a[8:11], 0
    v_mfma_f32_16x16x32_bf16 v[248:251], a[152:155], a[12:15], 0
    s_waitcnt lgkmcnt(15)
    v_mfma_f32_16x16x32_bf16 v[156:159], a[156:159], a[0:3], 0
    v_mfma_f32_16x16x32_bf16 v[188:191], a[156:159], a[4:7], 0
    v_mfma_f32_16x16x32_bf16 v[220:223], a[156:159], a[8:11], 0
    v_mfma_f32_16x16x32_bf16 v[252:255], a[156:159], a[12:15], 0
    s_waitcnt vmcnt(28) lgkmcnt(14)
    v_mfma_f32_16x16x32_bf16 v[128:131], a[160:163], a[16:19], v[128:131]
    buffer_load_dwordx4 a[0:3], v21, s[56:59], s68 offen sc1
    s_waitcnt vmcnt(28)
    v_mfma_f32_16x16x32_bf16 v[160:163], a[160:163], a[20:23], v[160:163]
    ds_read_b64_tr_b16 a[128:129], v8 offset:16384
    s_waitcnt vmcnt(27)
    v_mfma_f32_16x16x32_bf16 v[192:195], a[160:163], a[24:27], v[192:195]
    ds_read_b64_tr_b16 a[130:131], v8 offset:20480
    buffer_load_dwordx4 a[4:7], v22, s[56:59], s68 offen sc1
    s_waitcnt vmcnt(27)
    v_mfma_f32_16x16x32_bf16 v[224:227], a[160:163], a[28:31], v[224:227]
    s_waitcnt lgkmcnt(14)
    v_mfma_f32_16x16x32_bf16 v[132:135], a[164:167], a[16:19], v[132:135]
    ds_read_b64_tr_b16 a[132:133], v9 offset:16384
    buffer_load_dwordx4 a[8:11], v23, s[56:59], s68 offen sc1
    v_mfma_f32_16x16x32_bf16 v[164:167], a[164:167], a[20:23], v[164:167]
    ds_read_b64_tr_b16 a[134:135], v9 offset:20480
    v_mfma_f32_16x16x32_bf16 v[196:199], a[164:167], a[24:27], v[196:199]
    buffer_load_dwordx4 a[12:15], v24, s[56:59], s68 offen sc1
    v_mfma_f32_16x16x32_bf16 v[228:231], a[164:167], a[28:31], v[228:231]
    ds_read_b64_tr_b16 a[136:137], v10 offset:16384
    s_waitcnt lgkmcnt(15)
    v_mfma_f32_16x16x32_bf16 v[136:139], a[168:171], a[16:19], v[136:139]
    ds_read_b64_tr_b16 a[138:139], v10 offset:20480
    s_add_u32 s68, s68, 16384
    v_mfma_f32_16x16x32_bf16 v[168:171], a[168:171], a[20:23], v[168:171]
    v_mfma_f32_16x16x32_bf16 v[200:203], a[168:171], a[24:27], v[200:203]
    ds_read_b64_tr_b16 a[140:141], v11 offset:16384
    v_mfma_f32_16x16x32_bf16 v[232:235], a[168:171], a[28:31], v[232:235]
    ds_read_b64_tr_b16 a[142:143], v11 offset:20480
    s_waitcnt lgkmcnt(15)
    v_mfma_f32_16x16x32_bf16 v[140:143], a[172:175], a[16:19], v[140:143]
    v_mfma_f32_16x16x32_bf16 v[172:175], a[172:175], a[20:23], v[172:175]
    ds_read_b64_tr_b16 a[144:145], v12 offset:16384
    v_mfma_f32_16x16x32_bf16 v[204:207], a[172:175], a[24:27], v[204:207]
    ds_read_b64_tr_b16 a[146:147], v12 offset:20480
    v_mfma_f32_16x16x32_bf16 v[236:239], a[172:175], a[28:31], v[236:239]
    s_waitcnt lgkmcnt(15)
    v_mfma_f32_16x16x32_bf16 v[144:147], a[176:179], a[16:19], v[144:147]
    ds_read_b64_tr_b16 a[148:149], v13 offset:16384
    v_mfma_f32_16x16x32_bf16 v[176:179], a[176:179], a[20:23], v[176:179]
    ds_read_b64_tr_b16 a[150:151], v13 offset:20480
    v_mfma_f32_16x16x32_bf16 v[208:211], a[176:179], a[24:27], v[208:211]
    v_mfma_f32_16x16x32_bf16 v[240:243], a[176:179], a[28:31], v[240:243]
    ds_read_b64_tr_b16 a[152:153], v14 offset:16384
    s_waitcnt lgkmcnt(15)
    v_mfma_f32_16x16x32_bf16 v[148:151], a[180:183], a[16:19], v[148:151]
    ds_read_b64_tr_b16 a[154:155], v14 offset:20480
    v_mfma_f32_16x16x32_bf16 v[180:183], a[180:183], a[20:23], v[180:183]
    v_mfma_f32_16x16x32_bf16 v[212:215], a[180:183], a[24:27], v[212:215]
    ds_read_b64_tr_b16 a[156:157], v15 offset:16384
    v_mfma_f32_16x16x32_bf16 v[244:247], a[180:183], a[28:31], v[244:247]
    ds_read_b64_tr_b16 a[158:159], v15 offset:20480
    v_mfma_f32_16x16x32_bf16 v[152:155], a[184:187], a[16:19], v[152:155]
    v_mfma_f32_16x16x32_bf16 v[184:187], a[184:187], a[20:23], v[184:187]
    v_mfma_f32_16x16x32_bf16 v[216:219], a[184:187], a[24:27], v[216:219]
    v_mfma_f32_16x16x32_bf16 v[248:251], a[184:187], a[28:31], v[248:251]
    s_waitcnt lgkmcnt(15)
    v_mfma_f32_16x16x32_bf16 v[156:159], a[188:191], a[16:19], v[156:159]
    v_mfma_f32_16x16x32_bf16 v[188:191], a[188:191], a[20:23], v[188:191]
    v_mfma_f32_16x16x32_bf16 v[220:223], a[188:191], a[24:27], v[220:223]
    v_mfma_f32_16x16x32_bf16 v[252:255], a[188:191], a[28:31], v[252:255]
    s_waitcnt vmcnt(28) lgkmcnt(14)
    v_mfma_f32_16x16x32_bf16 v[128:131], a[128:131], a[32:35], v[128:131]
    buffer_load_dwordx4 a[16:19], v21, s[56:59], s68 offen sc1
    s_waitcnt vmcnt(28)
    v_mfma_f32_16x16x32_bf16 v[160:163], a[128:131], a[36:39], v[160:163]
    ds_read_b64_tr_b16 a[160:161], v8 offset:24576
    s_waitcnt vmcnt(27)
    v_mfma_f32_16x16x32_bf16 v[192:195], a[128:131], a[40:43], v[192:195]
    ds_read_b64_tr_b16 a[162:163], v8 offset:28672
    buffer_load_dwordx4 a[20:23], v22, s[56:59], s68 offen sc1
    s_waitcnt vmcnt(27)
    v_mfma_f32_16x16x32_bf16 v[224:227], a[128:131], a[44:47], v[224:227]
    s_waitcnt lgkmcnt(14)
    v_mfma_f32_16x16x32_bf16 v[132:135], a[132:135], a[32:35], v[132:135]
    ds_read_b64_tr_b16 a[164:165], v9 offset:24576
    buffer_load_dwordx4 a[24:27], v23, s[56:59], s68 offen sc1
    v_mfma_f32_16x16x32_bf16 v[164:167], a[132:135], a[36:39], v[164:167]
    ds_read_b64_tr_b16 a[166:167], v9 offset:28672
    v_mfma_f32_16x16x32_bf16 v[196:199], a[132:135], a[40:43], v[196:199]
    buffer_load_dwordx4 a[28:31], v24, s[56:59], s68 offen sc1
    v_mfma_f32_16x16x32_bf16 v[228:231], a[132:135], a[44:47], v[228:231]
    ds_read_b64_tr_b16 a[168:169], v10 offset:24576
    s_waitcnt lgkmcnt(15)
    v_mfma_f32_16x16x32_bf16 v[136:139], a[136:139], a[32:35], v[136:139]
    ds_read_b64_tr_b16 a[170:171], v10 offset:28672
    s_add_u32 s68, s68, 16384
    v_mfma_f32_16x16x32_bf16 v[168:171], a[136:139], a[36:39], v[168:171]
    v_mfma_f32_16x16x32_bf16 v[200:203], a[136:139], a[40:43], v[200:203]
    ds_read_b64_tr_b16 a[172:173], v11 offset:24576
    global_load_dwordx2 v[66:67], v1, s[8:9] offset:0
    v_mfma_f32_16x16x32_bf16 v[232:235], a[136:139], a[44:47], v[232:235]
    ds_read_b64_tr_b16 a[174:175], v11 offset:28672
    s_waitcnt lgkmcnt(15)
    v_mfma_f32_16x16x32_bf16 v[140:143], a[140:143], a[32:35], v[140:143]
    global_load_dwordx2 v[70:71], v1, s[8:9] offset:32
    v_mfma_f32_16x16x32_bf16 v[172:175], a[140:143], a[36:39], v[172:175]
    ds_read_b64_tr_b16 a[176:177], v12 offset:24576
    v_mfma_f32_16x16x32_bf16 v[204:207], a[140:143], a[40:43], v[204:207]
    ds_read_b64_tr_b16 a[178:179], v12 offset:28672
    global_load_dwordx2 v[74:75], v1, s[8:9] offset:64
    v_mfma_f32_16x16x32_bf16 v[236:239], a[140:143], a[44:47], v[236:239]
    s_waitcnt lgkmcnt(15)
    v_mfma_f32_16x16x32_bf16 v[144:147], a[144:147], a[32:35], v[144:147]
    ds_read_b64_tr_b16 a[180:181], v13 offset:24576
    global_load_dwordx2 v[78:79], v1, s[8:9] offset:96
    v_mfma_f32_16x16x32_bf16 v[176:179], a[144:147], a[36:39], v[176:179]
    ds_read_b64_tr_b16 a[182:183], v13 offset:28672
    v_mfma_f32_16x16x32_bf16 v[208:211], a[144:147], a[40:43], v[208:211]
    global_load_dwordx2 v[82:83], v1, s[8:9] offset:128
    v_mfma_f32_16x16x32_bf16 v[240:243], a[144:147], a[44:47], v[240:243]
    ds_read_b64_tr_b16 a[184:185], v14 offset:24576
    s_waitcnt lgkmcnt(15)
    v_mfma_f32_16x16x32_bf16 v[148:151], a[148:151], a[32:35], v[148:151]
    ds_read_b64_tr_b16 a[186:187], v14 offset:28672
    global_load_dwordx2 v[86:87], v1, s[8:9] offset:160
    v_mfma_f32_16x16x32_bf16 v[180:183], a[148:151], a[36:39], v[180:183]
    v_mfma_f32_16x16x32_bf16 v[212:215], a[148:151], a[40:43], v[212:215]
    ds_read_b64_tr_b16 a[188:189], v15 offset:24576
    global_load_dwordx2 v[90:91], v1, s[8:9] offset:192
    v_mfma_f32_16x16x32_bf16 v[244:247], a[148:151], a[44:47], v[244:247]
    ds_read_b64_tr_b16 a[190:191], v15 offset:28672
    v_mfma_f32_16x16x32_bf16 v[152:155], a[152:155], a[32:35], v[152:155]
    global_load_dwordx2 v[94:95], v1, s[8:9] offset:224
    v_mfma_f32_16x16x32_bf16 v[184:187], a[152:155], a[36:39], v[184:187]
    v_mfma_f32_16x16x32_bf16 v[216:219], a[152:155], a[40:43], v[216:219]
    v_mfma_f32_16x16x32_bf16 v[248:251], a[152:155], a[44:47], v[248:251]
    s_waitcnt lgkmcnt(15)
    v_mfma_f32_16x16x32_bf16 v[156:159], a[156:159], a[32:35], v[156:159]
    v_mfma_f32_16x16x32_bf16 v[188:191], a[156:159], a[36:39], v[188:191]
    v_mfma_f32_16x16x32_bf16 v[220:223], a[156:159], a[40:43], v[220:223]
    v_mfma_f32_16x16x32_bf16 v[252:255], a[156:159], a[44:47], v[252:255]
    s_waitcnt vmcnt(36) lgkmcnt(14)
    v_mfma_f32_16x16x32_bf16 v[128:131], a[160:163], a[48:51], v[128:131]
    buffer_load_dwordx4 a[32:35], v21, s[56:59], s68 offen sc1
    s_waitcnt vmcnt(36)
    v_mfma_f32_16x16x32_bf16 v[160:163], a[160:163], a[52:55], v[160:163]
    ds_read_b64_tr_b16 a[128:129], v8 offset:32768
    s_waitcnt vmcnt(35)
    v_mfma_f32_16x16x32_bf16 v[192:195], a[160:163], a[56:59], v[192:195]
    ds_read_b64_tr_b16 a[130:131], v8 offset:36864
    buffer_load_dwordx4 a[36:39], v22, s[56:59], s68 offen sc1
    s_waitcnt vmcnt(35)
    v_mfma_f32_16x16x32_bf16 v[224:227], a[160:163], a[60:63], v[224:227]
    s_waitcnt lgkmcnt(14)
    v_mfma_f32_16x16x32_bf16 v[132:135], a[164:167], a[48:51], v[132:135]
    ds_read_b64_tr_b16 a[132:133], v9 offset:32768
    buffer_load_dwordx4 a[40:43], v23, s[56:59], s68 offen sc1
    v_mfma_f32_16x16x32_bf16 v[164:167], a[164:167], a[52:55], v[164:167]
    ds_read_b64_tr_b16 a[134:135], v9 offset:36864
    v_mfma_f32_16x16x32_bf16 v[196:199], a[164:167], a[56:59], v[196:199]
    buffer_load_dwordx4 a[44:47], v24, s[56:59], s68 offen sc1
    v_mfma_f32_16x16x32_bf16 v[228:231], a[164:167], a[60:63], v[228:231]
    ds_read_b64_tr_b16 a[136:137], v10 offset:32768
    s_waitcnt lgkmcnt(15)
    v_mfma_f32_16x16x32_bf16 v[136:139], a[168:171], a[48:51], v[136:139]
    ds_read_b64_tr_b16 a[138:139], v10 offset:36864
    s_add_u32 s68, s68, 16384
    v_mfma_f32_16x16x32_bf16 v[168:171], a[168:171], a[52:55], v[168:171]
    v_mfma_f32_16x16x32_bf16 v[200:203], a[168:171], a[56:59], v[200:203]
    ds_read_b64_tr_b16 a[140:141], v11 offset:32768
    v_mfma_f32_16x16x32_bf16 v[232:235], a[168:171], a[60:63], v[232:235]
    ds_read_b64_tr_b16 a[142:143], v11 offset:36864
    s_waitcnt lgkmcnt(15)
    v_mfma_f32_16x16x32_bf16 v[140:143], a[172:175], a[48:51], v[140:143]
    v_mfma_f32_16x16x32_bf16 v[172:175], a[172:175], a[52:55], v[172:175]
    ds_read_b64_tr_b16 a[144:145], v12 offset:32768
    v_mfma_f32_16x16x32_bf16 v[204:207], a[172:175], a[56:59], v[204:207]
    ds_read_b64_tr_b16 a[146:147], v12 offset:36864
    v_mfma_f32_16x16x32_bf16 v[236:239], a[172:175], a[60:63], v[236:239]
    s_waitcnt lgkmcnt(15)
    v_mfma_f32_16x16x32_bf16 v[144:147], a[176:179], a[48:51], v[144:147]
    ds_read_b64_tr_b16 a[148:149], v13 offset:32768
    v_mfma_f32_16x16x32_bf16 v[176:179], a[176:179], a[52:55], v[176:179]
    ds_read_b64_tr_b16 a[150:151], v13 offset:36864
    v_mfma_f32_16x16x32_bf16 v[208:211], a[176:179], a[56:59], v[208:211]
    v_mfma_f32_16x16x32_bf16 v[240:243], a[176:179], a[60:63], v[240:243]
    ds_read_b64_tr_b16 a[152:153], v14 offset:32768
    s_waitcnt lgkmcnt(15)
    v_mfma_f32_16x16x32_bf16 v[148:151], a[180:183], a[48:51], v[148:151]
    ds_read_b64_tr_b16 a[154:155], v14 offset:36864
    v_mfma_f32_16x16x32_bf16 v[180:183], a[180:183], a[52:55], v[180:183]
    v_mfma_f32_16x16x32_bf16 v[212:215], a[180:183], a[56:59], v[212:215]
    ds_read_b64_tr_b16 a[156:157], v15 offset:32768
    v_mfma_f32_16x16x32_bf16 v[244:247], a[180:183], a[60:63], v[244:247]
    ds_read_b64_tr_b16 a[158:159], v15 offset:36864
    v_mfma_f32_16x16x32_bf16 v[152:155], a[184:187], a[48:51], v[152:155]
    v_mfma_f32_16x16x32_bf16 v[184:187], a[184:187], a[52:55], v[184:187]
    v_mfma_f32_16x16x32_bf16 v[216:219], a[184:187], a[56:59], v[216:219]
    v_mfma_f32_16x16x32_bf16 v[248:251], a[184:187], a[60:63], v[248:251]
    s_waitcnt lgkmcnt(15)
    v_mfma_f32_16x16x32_bf16 v[156:159], a[188:191], a[48:51], v[156:159]
    buffer_load_dword v43, off, s[56:59], s92 sc1
    v_mfma_f32_16x16x32_bf16 v[188:191], a[188:191], a[52:55], v[188:191]
    v_mfma_f32_16x16x32_bf16 v[220:223], a[188:191], a[56:59], v[220:223]
    v_mfma_f32_16x16x32_bf16 v[252:255], a[188:191], a[60:63], v[252:255]
    s_waitcnt vmcnt(37) lgkmcnt(14)
    v_mfma_f32_16x16x32_bf16 v[128:131], a[128:131], a[64:67], v[128:131]
    buffer_load_dwordx4 a[48:51], v21, s[56:59], s68 offen sc1
    s_waitcnt vmcnt(37)
    v_mfma_f32_16x16x32_bf16 v[160:163], a[128:131], a[68:71], v[160:163]
    ds_read_b64_tr_b16 a[160:161], v8 offset:40960
    s_waitcnt vmcnt(36)
    v_mfma_f32_16x16x32_bf16 v[192:195], a[128:131], a[72:75], v[192:195]
    ds_read_b64_tr_b16 a[162:163], v8 offset:45056
    buffer_load_dwordx4 a[52:55], v22, s[56:59], s68 offen sc1
    s_waitcnt vmcnt(36)
    v_mfma_f32_16x16x32_bf16 v[224:227], a[128:131], a[76:79], v[224:227]
    s_waitcnt lgkmcnt(14)
    v_mfma_f32_16x16x32_bf16 v[132:135], a[132:135], a[64:67], v[132:135]
    ds_read_b64_tr_b16 a[164:165], v9 offset:40960
    buffer_load_dwordx4 a[56:59], v23, s[56:59], s68 offen sc1
    v_mfma_f32_16x16x32_bf16 v[164:167], a[132:135], a[68:71], v[164:167]
    ds_read_b64_tr_b16 a[166:167], v9 offset:45056
    v_mfma_f32_16x16x32_bf16 v[196:199], a[132:135], a[72:75], v[196:199]
    buffer_load_dwordx4 a[60:63], v24, s[56:59], s68 offen sc1
    v_mfma_f32_16x16x32_bf16 v[228:231], a[132:135], a[76:79], v[228:231]
    ds_read_b64_tr_b16 a[168:169], v10 offset:40960
    s_waitcnt lgkmcnt(15)
    v_mfma_f32_16x16x32_bf16 v[136:139], a[136:139], a[64:67], v[136:139]
    ds_read_b64_tr_b16 a[170:171], v10 offset:45056
    s_add_u32 s68, s68, 16384
    v_mfma_f32_16x16x32_bf16 v[168:171], a[136:139], a[68:71], v[168:171]
    v_mfma_f32_16x16x32_bf16 v[200:203], a[136:139], a[72:75], v[200:203]
    ds_read_b64_tr_b16 a[172:173], v11 offset:40960
    v_mfma_f32_16x16x32_bf16 v[232:235], a[136:139], a[76:79], v[232:235]
    ds_read_b64_tr_b16 a[174:175], v11 offset:45056
    s_waitcnt lgkmcnt(15)
    v_mfma_f32_16x16x32_bf16 v[140:143], a[140:143], a[64:67], v[140:143]
    v_mfma_f32_16x16x32_bf16 v[172:175], a[140:143], a[68:71], v[172:175]
    ds_read_b64_tr_b16 a[176:177], v12 offset:40960
    v_mfma_f32_16x16x32_bf16 v[204:207], a[140:143], a[72:75], v[204:207]
    ds_read_b64_tr_b16 a[178:179], v12 offset:45056
    v_mfma_f32_16x16x32_bf16 v[236:239], a[140:143], a[76:79], v[236:239]
    s_waitcnt lgkmcnt(15)
    v_mfma_f32_16x16x32_bf16 v[144:147], a[144:147], a[64:67], v[144:147]
    ds_read_b64_tr_b16 a[180:181], v13 offset:40960
    v_mfma_f32_16x16x32_bf16 v[176:179], a[144:147], a[68:71], v[176:179]
    ds_read_b64_tr_b16 a[182:183], v13 offset:45056
    v_mfma_f32_16x16x32_bf16 v[208:211], a[144:147], a[72:75], v[208:211]
    v_mfma_f32_16x16x32_bf16 v[240:243], a[144:147], a[76:79], v[240:243]
    ds_read_b64_tr_b16 a[184:185], v14 offset:40960
    s_waitcnt lgkmcnt(15)
    v_mfma_f32_16x16x32_bf16 v[148:151], a[148:151], a[64:67], v[148:151]
    ds_read_b64_tr_b16 a[186:187], v14 offset:45056
    v_mfma_f32_16x16x32_bf16 v[180:183], a[148:151], a[68:71], v[180:183]
    v_mfma_f32_16x16x32_bf16 v[212:215], a[148:151], a[72:75], v[212:215]
    ds_read_b64_tr_b16 a[188:189], v15 offset:40960
    v_mfma_f32_16x16x32_bf16 v[244:247], a[148:151], a[76:79], v[244:247]
    ds_read_b64_tr_b16 a[190:191], v15 offset:45056
    v_mfma_f32_16x16x32_bf16 v[152:155], a[152:155], a[64:67], v[152:155]
    v_mfma_f32_16x16x32_bf16 v[184:187], a[152:155], a[68:71], v[184:187]
    v_mfma_f32_16x16x32_bf16 v[216:219], a[152:155], a[72:75], v[216:219]
    v_mfma_f32_16x16x32_bf16 v[248:251], a[152:155], a[76:79], v[248:251]
    s_waitcnt lgkmcnt(15)
    v_mfma_f32_16x16x32_bf16 v[156:159], a[156:159], a[64:67], v[156:159]
    v_mfma_f32_16x16x32_bf16 v[188:191], a[156:159], a[68:71], v[188:191]
    v_mfma_f32_16x16x32_bf16 v[220:223], a[156:159], a[72:75], v[220:223]
    v_mfma_f32_16x16x32_bf16 v[252:255], a[156:159], a[76:79], v[252:255]
    s_waitcnt vmcnt(37) lgkmcnt(14)
    v_mfma_f32_16x16x32_bf16 v[128:131], a[160:163], a[80:83], v[128:131]
    buffer_load_dwordx4 a[64:67], v21, s[56:59], s68 offen sc1
    s_waitcnt vmcnt(37)
    v_mfma_f32_16x16x32_bf16 v[160:163], a[160:163], a[84:87], v[160:163]
    ds_read_b64_tr_b16 a[128:129], v8 offset:49152
    s_waitcnt vmcnt(36)
    v_mfma_f32_16x16x32_bf16 v[192:195], a[160:163], a[88:91], v[192:195]
    ds_read_b64_tr_b16 a[130:131], v8 offset:53248
    buffer_load_dwordx4 a[68:71], v22, s[56:59], s68 offen sc1
    s_waitcnt vmcnt(36)
    v_mfma_f32_16x16x32_bf16 v[224:227], a[160:163], a[92:95], v[224:227]
    s_waitcnt lgkmcnt(14)
    v_mfma_f32_16x16x32_bf16 v[132:135], a[164:167], a[80:83], v[132:135]
    ds_read_b64_tr_b16 a[132:133], v9 offset:49152
    buffer_load_dwordx4 a[72:75], v23, s[56:59], s68 offen sc1
    v_mfma_f32_16x16x32_bf16 v[164:167], a[164:167], a[84:87], v[164:167]
    ds_read_b64_tr_b16 a[134:135], v9 offset:53248
    v_mfma_f32_16x16x32_bf16 v[196:199], a[164:167], a[88:91], v[196:199]
    buffer_load_dwordx4 a[76:79], v24, s[56:59], s68 offen sc1
    v_mfma_f32_16x16x32_bf16 v[228:231], a[164:167], a[92:95], v[228:231]
    ds_read_b64_tr_b16 a[136:137], v10 offset:49152
    s_waitcnt lgkmcnt(15)
    v_mfma_f32_16x16x32_bf16 v[136:139], a[168:171], a[80:83], v[136:139]
    ds_read_b64_tr_b16 a[138:139], v10 offset:53248
    s_add_u32 s68, s68, 16384
    v_mfma_f32_16x16x32_bf16 v[168:171], a[168:171], a[84:87], v[168:171]
    v_mfma_f32_16x16x32_bf16 v[200:203], a[168:171], a[88:91], v[200:203]
    ds_read_b64_tr_b16 a[140:141], v11 offset:49152
    v_mfma_f32_16x16x32_bf16 v[232:235], a[168:171], a[92:95], v[232:235]
    ds_read_b64_tr_b16 a[142:143], v11 offset:53248
    s_waitcnt lgkmcnt(15)
    v_mfma_f32_16x16x32_bf16 v[140:143], a[172:175], a[80:83], v[140:143]
    v_mfma_f32_16x16x32_bf16 v[172:175], a[172:175], a[84:87], v[172:175]
    ds_read_b64_tr_b16 a[144:145], v12 offset:49152
    v_mfma_f32_16x16x32_bf16 v[204:207], a[172:175], a[88:91], v[204:207]
    ds_read_b64_tr_b16 a[146:147], v12 offset:53248
    v_mfma_f32_16x16x32_bf16 v[236:239], a[172:175], a[92:95], v[236:239]
    s_waitcnt lgkmcnt(15)
    v_mfma_f32_16x16x32_bf16 v[144:147], a[176:179], a[80:83], v[144:147]
    ds_read_b64_tr_b16 a[148:149], v13 offset:49152
    v_mfma_f32_16x16x32_bf16 v[176:179], a[176:179], a[84:87], v[176:179]
    ds_read_b64_tr_b16 a[150:151], v13 offset:53248
    v_mfma_f32_16x16x32_bf16 v[208:211], a[176:179], a[88:91], v[208:211]
    v_mfma_f32_16x16x32_bf16 v[240:243], a[176:179], a[92:95], v[240:243]
    ds_read_b64_tr_b16 a[152:153], v14 offset:49152
    s_waitcnt lgkmcnt(15)
    v_mfma_f32_16x16x32_bf16 v[148:151], a[180:183], a[80:83], v[148:151]
    ds_read_b64_tr_b16 a[154:155], v14 offset:53248
    v_mfma_f32_16x16x32_bf16 v[180:183], a[180:183], a[84:87], v[180:183]
    v_mfma_f32_16x16x32_bf16 v[212:215], a[180:183], a[88:91], v[212:215]
    ds_read_b64_tr_b16 a[156:157], v15 offset:49152
    v_mfma_f32_16x16x32_bf16 v[244:247], a[180:183], a[92:95], v[244:247]
    ds_read_b64_tr_b16 a[158:159], v15 offset:53248
    v_mfma_f32_16x16x32_bf16 v[152:155], a[184:187], a[80:83], v[152:155]
    v_mfma_f32_16x16x32_bf16 v[184:187], a[184:187], a[84:87], v[184:187]
    v_mfma_f32_16x16x32_bf16 v[216:219], a[184:187], a[88:91], v[216:219]
    v_mfma_f32_16x16x32_bf16 v[248:251], a[184:187], a[92:95], v[248:251]
    s_waitcnt lgkmcnt(15)
    v_mfma_f32_16x16x32_bf16 v[156:159], a[188:191], a[80:83], v[156:159]
    v_mfma_f32_16x16x32_bf16 v[188:191], a[188:191], a[84:87], v[188:191]
    v_mfma_f32_16x16x32_bf16 v[220:223], a[188:191], a[88:91], v[220:223]
    v_mfma_f32_16x16x32_bf16 v[252:255], a[188:191], a[92:95], v[252:255]
    s_waitcnt vmcnt(37) lgkmcnt(14)
    v_mfma_f32_16x16x32_bf16 v[128:131], a[128:131], a[96:99], v[128:131]
    buffer_load_dwordx4 a[80:83], v21, s[56:59], s68 offen sc1
    s_waitcnt vmcnt(37)
    v_mfma_f32_16x16x32_bf16 v[160:163], a[128:131], a[100:103], v[160:163]
    ds_read_b64_tr_b16 a[160:161], v8 offset:57344
    s_waitcnt vmcnt(36)
    v_mfma_f32_16x16x32_bf16 v[192:195], a[128:131], a[104:107], v[192:195]
    ds_read_b64_tr_b16 a[162:163], v8 offset:61440
    buffer_load_dwordx4 a[84:87], v22, s[56:59], s68 offen sc1
    s_waitcnt vmcnt(36)
    v_mfma_f32_16x16x32_bf16 v[224:227], a[128:131], a[108:111], v[224:227]
    s_waitcnt lgkmcnt(14)
    v_mfma_f32_16x16x32_bf16 v[132:135], a[132:135], a[96:99], v[132:135]
    ds_read_b64_tr_b16 a[164:165], v9 offset:57344
    buffer_load_dwordx4 a[88:91], v23, s[56:59], s68 offen sc1
    v_mfma_f32_16x16x32_bf16 v[164:167], a[132:135], a[100:103], v[164:167]
    ds_read_b64_tr_b16 a[166:167], v9 offset:61440
    v_mfma_f32_16x16x32_bf16 v[196:199], a[132:135], a[104:107], v[196:199]
    buffer_load_dwordx4 a[92:95], v24, s[56:59], s68 offen sc1
    v_mfma_f32_16x16x32_bf16 v[228:231], a[132:135], a[108:111], v[228:231]
    ds_read_b64_tr_b16 a[168:169], v10 offset:57344
    s_waitcnt lgkmcnt(15)
    v_mfma_f32_16x16x32_bf16 v[136:139], a[136:139], a[96:99], v[136:139]
    ds_read_b64_tr_b16 a[170:171], v10 offset:61440
    s_add_u32 s68, s68, 16384
    v_mfma_f32_16x16x32_bf16 v[168:171], a[136:139], a[100:103], v[168:171]
    v_mfma_f32_16x16x32_bf16 v[200:203], a[136:139], a[104:107], v[200:203]
    ds_read_b64_tr_b16 a[172:173], v11 offset:57344
    v_mfma_f32_16x16x32_bf16 v[232:235], a[136:139], a[108:111], v[232:235]
    ds_read_b64_tr_b16 a[174:175], v11 offset:61440
    s_waitcnt lgkmcnt(15)
    v_mfma_f32_16x16x32_bf16 v[140:143], a[140:143], a[96:99], v[140:143]
    v_mfma_f32_16x16x32_bf16 v[172:175], a[140:143], a[100:103], v[172:175]
    ds_read_b64_tr_b16 a[176:177], v12 offset:57344
    v_mfma_f32_16x16x32_bf16 v[204:207], a[140:143], a[104:107], v[204:207]
    ds_read_b64_tr_b16 a[178:179], v12 offset:61440
    v_mfma_f32_16x16x32_bf16 v[236:239], a[140:143], a[108:111], v[236:239]
    s_waitcnt lgkmcnt(15)
    v_mfma_f32_16x16x32_bf16 v[144:147], a[144:147], a[96:99], v[144:147]
    ds_read_b64_tr_b16 a[180:181], v13 offset:57344
    v_mfma_f32_16x16x32_bf16 v[176:179], a[144:147], a[100:103], v[176:179]
    ds_read_b64_tr_b16 a[182:183], v13 offset:61440
    v_mfma_f32_16x16x32_bf16 v[208:211], a[144:147], a[104:107], v[208:211]
    v_mfma_f32_16x16x32_bf16 v[240:243], a[144:147], a[108:111], v[240:243]
    ds_read_b64_tr_b16 a[184:185], v14 offset:57344
    s_waitcnt lgkmcnt(15)
    v_mfma_f32_16x16x32_bf16 v[148:151], a[148:151], a[96:99], v[148:151]
    ds_read_b64_tr_b16 a[186:187], v14 offset:61440
    v_mfma_f32_16x16x32_bf16 v[180:183], a[148:151], a[100:103], v[180:183]
    v_mfma_f32_16x16x32_bf16 v[212:215], a[148:151], a[104:107], v[212:215]
    ds_read_b64_tr_b16 a[188:189], v15 offset:57344
    v_mfma_f32_16x16x32_bf16 v[244:247], a[148:151], a[108:111], v[244:247]
    ds_read_b64_tr_b16 a[190:191], v15 offset:61440
    v_mfma_f32_16x16x32_bf16 v[152:155], a[152:155], a[96:99], v[152:155]
    v_mfma_f32_16x16x32_bf16 v[184:187], a[152:155], a[100:103], v[184:187]
    v_mfma_f32_16x16x32_bf16 v[216:219], a[152:155], a[104:107], v[216:219]
    v_mfma_f32_16x16x32_bf16 v[248:251], a[152:155], a[108:111], v[248:251]
    s_waitcnt lgkmcnt(15)
    v_mfma_f32_16x16x32_bf16 v[156:159], a[156:159], a[96:99], v[156:159]
    v_mfma_f32_16x16x32_bf16 v[188:191], a[156:159], a[100:103], v[188:191]
    v_mfma_f32_16x16x32_bf16 v[220:223], a[156:159], a[104:107], v[220:223]
    v_mfma_f32_16x16x32_bf16 v[252:255], a[156:159], a[108:111], v[252:255]
    s_waitcnt vmcnt(37) lgkmcnt(14)
    v_mfma_f32_16x16x32_bf16 v[128:131], a[160:163], a[112:115], v[128:131]
    buffer_load_dwordx4 a[96:99], v21, s[56:59], s68 offen sc1
    s_waitcnt vmcnt(37)
    v_mfma_f32_16x16x32_bf16 v[160:163], a[160:163], a[116:119], v[160:163]
    ds_read_b64_tr_b16 a[128:129], v48 offset:0
    s_waitcnt vmcnt(36)
    v_mfma_f32_16x16x32_bf16 v[192:195], a[160:163], a[120:123], v[192:195]
    ds_read_b64_tr_b16 a[130:131], v48 offset:4096
    buffer_load_dwordx4 a[100:103], v22, s[56:59], s68 offen sc1
    s_waitcnt vmcnt(36)
    v_mfma_f32_16x16x32_bf16 v[224:227], a[160:163], a[124:127], v[224:227]
    s_waitcnt lgkmcnt(14)
    v_mfma_f32_16x16x32_bf16 v[132:135], a[164:167], a[112:115], v[132:135]
    ds_read_b64_tr_b16 a[132:133], v49 offset:0
    buffer_load_dwordx4 a[104:107], v23, s[56:59], s68 offen sc1
    v_mfma_f32_16x16x32_bf16 v[164:167], a[164:167], a[116:119], v[164:167]
    ds_read_b64_tr_b16 a[134:135], v49 offset:4096
    v_mfma_f32_16x16x32_bf16 v[196:199], a[164:167], a[120:123], v[196:199]
    buffer_load_dwordx4 a[108:111], v24, s[56:59], s68 offen sc1
    v_mfma_f32_16x16x32_bf16 v[228:231], a[164:167], a[124:127], v[228:231]
    ds_read_b64_tr_b16 a[136:137], v50 offset:0
    s_waitcnt lgkmcnt(15)
    v_mfma_f32_16x16x32_bf16 v[136:139], a[168:171], a[112:115], v[136:139]
    ds_read_b64_tr_b16 a[138:139], v50 offset:4096
    s_add_u32 s68, s68, 16384
    v_mfma_f32_16x16x32_bf16 v[168:171], a[168:171], a[116:119], v[168:171]
    v_mfma_f32_16x16x32_bf16 v[200:203], a[168:171], a[120:123], v[200:203]
    ds_read_b64_tr_b16 a[140:141], v51 offset:0
    v_mfma_f32_16x16x32_bf16 v[232:235], a[168:171], a[124:127], v[232:235]
    ds_read_b64_tr_b16 a[142:143], v51 offset:4096
    s_waitcnt lgkmcnt(15)
    v_mfma_f32_16x16x32_bf16 v[140:143], a[172:175], a[112:115], v[140:143]
    v_mfma_f32_16x16x32_bf16 v[172:175], a[172:175], a[116:119], v[172:175]
    ds_read_b64_tr_b16 a[144:145], v52 offset:0
    v_mfma_f32_16x16x32_bf16 v[204:207], a[172:175], a[120:123], v[204:207]
    ds_read_b64_tr_b16 a[146:147], v52 offset:4096
    v_mfma_f32_16x16x32_bf16 v[236:239], a[172:175], a[124:127], v[236:239]
    s_waitcnt lgkmcnt(15)
    v_mfma_f32_16x16x32_bf16 v[144:147], a[176:179], a[112:115], v[144:147]
    ds_read_b64_tr_b16 a[148:149], v53 offset:0
    v_mfma_f32_16x16x32_bf16 v[176:179], a[176:179], a[116:119], v[176:179]
    ds_read_b64_tr_b16 a[150:151], v53 offset:4096
    v_mfma_f32_16x16x32_bf16 v[208:211], a[176:179], a[120:123], v[208:211]
    v_mfma_f32_16x16x32_bf16 v[240:243], a[176:179], a[124:127], v[240:243]
    ds_read_b64_tr_b16 a[152:153], v54 offset:0
    s_waitcnt lgkmcnt(15)
    v_mfma_f32_16x16x32_bf16 v[148:151], a[180:183], a[112:115], v[148:151]
    ds_read_b64_tr_b16 a[154:155], v54 offset:4096
    v_mfma_f32_16x16x32_bf16 v[180:183], a[180:183], a[116:119], v[180:183]
    v_mfma_f32_16x16x32_bf16 v[212:215], a[180:183], a[120:123], v[212:215]
    ds_read_b64_tr_b16 a[156:157], v55 offset:0
    v_mfma_f32_16x16x32_bf16 v[244:247], a[180:183], a[124:127], v[244:247]
    ds_read_b64_tr_b16 a[158:159], v55 offset:4096
    v_mfma_f32_16x16x32_bf16 v[152:155], a[184:187], a[112:115], v[152:155]
    v_mfma_f32_16x16x32_bf16 v[184:187], a[184:187], a[116:119], v[184:187]
    v_mfma_f32_16x16x32_bf16 v[216:219], a[184:187], a[120:123], v[216:219]
    v_mfma_f32_16x16x32_bf16 v[248:251], a[184:187], a[124:127], v[248:251]
    s_waitcnt lgkmcnt(15)
    v_mfma_f32_16x16x32_bf16 v[156:159], a[188:191], a[112:115], v[156:159]
    v_mfma_f32_16x16x32_bf16 v[188:191], a[188:191], a[116:119], v[188:191]
    v_mfma_f32_16x16x32_bf16 v[220:223], a[188:191], a[120:123], v[220:223]
    v_mfma_f32_16x16x32_bf16 v[252:255], a[188:191], a[124:127], v[252:255]
    s_barrier
    s_waitcnt vmcnt(36) lgkmcnt(14)
    v_mfma_f32_16x16x32_bf16 v[128:131], a[128:131], a[0:3], v[128:131]
    buffer_load_dwordx4 a[112:115], v21, s[56:59], s68 offen sc1
    s_waitcnt vmcnt(36)
    v_mfma_f32_16x16x32_bf16 v[160:163], a[128:131], a[4:7], v[160:163]
    ds_read_b64_tr_b16 a[160:161], v48 offset:8192
    s_waitcnt vmcnt(35)
    v_mfma_f32_16x16x32_bf16 v[192:195], a[128:131], a[8:11], v[192:195]
    ds_read_b64_tr_b16 a[162:163], v48 offset:12288
    buffer_load_dwordx4 a[116:119], v22, s[56:59], s68 offen sc1
    s_waitcnt vmcnt(35)
    v_mfma_f32_16x16x32_bf16 v[224:227], a[128:131], a[12:15], v[224:227]
    s_waitcnt lgkmcnt(14)
    v_mfma_f32_16x16x32_bf16 v[132:135], a[132:135], a[0:3], v[132:135]
    ds_read_b64_tr_b16 a[164:165], v49 offset:8192
    buffer_load_dwordx4 a[120:123], v23, s[56:59], s68 offen sc1
    v_mfma_f32_16x16x32_bf16 v[164:167], a[132:135], a[4:7], v[164:167]
    ds_read_b64_tr_b16 a[166:167], v49 offset:12288
    v_mfma_f32_16x16x32_bf16 v[196:199], a[132:135], a[8:11], v[196:199]
    buffer_load_dwordx4 a[124:127], v24, s[56:59], s68 offen sc1
    v_mfma_f32_16x16x32_bf16 v[228:231], a[132:135], a[12:15], v[228:231]
    ds_read_b64_tr_b16 a[168:169], v50 offset:8192
    s_waitcnt lgkmcnt(15)
    v_mfma_f32_16x16x32_bf16 v[136:139], a[136:139], a[0:3], v[136:139]
    ds_read_b64_tr_b16 a[170:171], v50 offset:12288
    s_add_u32 s68, s68, 16384
    v_mfma_f32_16x16x32_bf16 v[168:171], a[136:139], a[4:7], v[168:171]
    v_mfma_f32_16x16x32_bf16 v[200:203], a[136:139], a[8:11], v[200:203]
    ds_read_b64_tr_b16 a[172:173], v51 offset:8192
    v_mfma_f32_16x16x32_bf16 v[232:235], a[136:139], a[12:15], v[232:235]
    ds_read_b64_tr_b16 a[174:175], v51 offset:12288
    s_mov_b32 s82, 1048576
    s_add_u32 m0, s3, 0
    s_waitcnt lgkmcnt(15)
    v_mfma_f32_16x16x32_bf16 v[140:143], a[140:143], a[0:3], v[140:143]
    buffer_load_dwordx4 v17, s[48:51], s82 offen lds
    v_mfma_f32_16x16x32_bf16 v[172:175], a[140:143], a[4:7], v[172:175]
    ds_read_b64_tr_b16 a[176:177], v52 offset:8192
    v_mfma_f32_16x16x32_bf16 v[204:207], a[140:143], a[8:11], v[204:207]
    ds_read_b64_tr_b16 a[178:179], v52 offset:12288
    v_mfma_f32_16x16x32_bf16 v[236:239], a[140:143], a[12:15], v[236:239]
    s_waitcnt lgkmcnt(15)
    v_mfma_f32_16x16x32_bf16 v[144:147], a[144:147], a[0:3], v[144:147]
    ds_read_b64_tr_b16 a[180:181], v53 offset:8192
    buffer_load_dwordx4 v18, s[48:51], s82 offen offset:1024 lds
    v_mfma_f32_16x16x32_bf16 v[176:179], a[144:147], a[4:7], v[176:179]
    ds_read_b64_tr_b16 a[182:183], v53 offset:12288
    v_mfma_f32_16x16x32_bf16 v[208:211], a[144:147], a[8:11], v[208:211]
    v_mfma_f32_16x16x32_bf16 v[240:243], a[144:147], a[12:15], v[240:243]
    ds_read_b64_tr_b16 a[184:185], v54 offset:8192
    s_waitcnt lgkmcnt(15)
    v_mfma_f32_16x16x32_bf16 v[148:151], a[148:151], a[0:3], v[148:151]
    ds_read_b64_tr_b16 a[186:187], v54 offset:12288
    v_mfma_f32_16x16x32_bf16 v[180:183], a[148:151], a[4:7], v[180:183]
    s_mov_b32 s83, 1277952
    s_add_u32 m0, s3, 8192
    v_mfma_f32_16x16x32_bf16 v[212:215], a[148:151], a[8:11], v[212:215]
    ds_read_b64_tr_b16 a[188:189], v55 offset:8192
    buffer_load_dwordx4 v17, s[48:51], s83 offen lds
    v_mfma_f32_16x16x32_bf16 v[244:247], a[148:151], a[12:15], v[244:247]
    ds_read_b64_tr_b16 a[190:191], v55 offset:12288
    v_mfma_f32_16x16x32_bf16 v[152:155], a[152:155], a[0:3], v[152:155]
    v_mfma_f32_16x16x32_bf16 v[184:187], a[152:155], a[4:7], v[184:187]
    v_mfma_f32_16x16x32_bf16 v[216:219], a[152:155], a[8:11], v[216:219]
    buffer_load_dwordx4 v18, s[48:51], s83 offen offset:1024 lds
    v_mfma_f32_16x16x32_bf16 v[248:251], a[152:155], a[12:15], v[248:251]
    s_waitcnt lgkmcnt(15)
    v_mfma_f32_16x16x32_bf16 v[156:159], a[156:159], a[0:3], v[156:159]
    v_mfma_f32_16x16x32_bf16 v[188:191], a[156:159], a[4:7], v[188:191]
    v_mfma_f32_16x16x32_bf16 v[220:223], a[156:159], a[8:11], v[220:223]
    v_mfma_f32_16x16x32_bf16 v[252:255], a[156:159], a[12:15], v[252:255]
    s_waitcnt vmcnt(40) lgkmcnt(14)
    v_mfma_f32_16x16x32_bf16 v[128:131], a[160:163], a[16:19], v[128:131]
    s_waitcnt vmcnt(24)
    v_readfirstlane_b32 s86, v43
    s_bfe_u32 s86, s86, 0x80008
    s_cmp_eq_u32 s86, 16
    s_cbranch_scc0 L_spB
L_okB:
    buffer_load_dwordx4 a[0:3], v21, s[56:59], s68 offen sc1
    v_mfma_f32_16x16x32_bf16 v[160:163], a[160:163], a[20:23], v[160:163]
    ds_read_b64_tr_b16 a[128:129], v48 offset:16384
    v_mfma_f32_16x16x32_bf16 v[192:195], a[160:163], a[24:27], v[192:195]
    ds_read_b64_tr_b16 a[130:131], v48 offset:20480
    buffer_load_dwordx4 a[4:7], v22, s[56:59], s68 offen sc1
    v_mfma_f32_16x16x32_bf16 v[224:227], a[160:163], a[28:31], v[224:227]
    s_waitcnt lgkmcnt(14)
    v_mfma_f32_16x16x32_bf16 v[132:135], a[164:167], a[16:19], v[132:135]
    ds_read_b64_tr_b16 a[132:133], v49 offset:16384
    buffer_load_dwordx4 a[8:11], v23, s[56:59], s68 offen sc1
    v_mfma_f32_16x16x32_bf16 v[164:167], a[164:167], a[20:23], v[164:167]
    ds_read_b64_tr_b16 a[134:135], v49 offset:20480
    v_mfma_f32_16x16x32_bf16 v[196:199], a[164:167], a[24:27], v[196:199]
    buffer_load_dwordx4 a[12:15], v24, s[56:59], s68 offen sc1
    v_mfma_f32_16x16x32_bf16 v[228:231], a[164:167], a[28:31], v[228:231]
    ds_read_b64_tr_b16 a[136:137], v50 offset:16384
    s_waitcnt lgkmcnt(15)
    v_mfma_f32_16x16x32_bf16 v[136:139], a[168:171], a[16:19], v[136:139]
    ds_read_b64_tr_b16 a[138:139], v50 offset:20480
    s_add_u32 s68, s68, 16384
    v_mfma_f32_16x16x32_bf16 v[168:171], a[168:171], a[20:23], v[168:171]
    v_mfma_f32_16x16x32_bf16 v[200:203], a[168:171], a[24:27], v[200:203]
    ds_read_b64_tr_b16 a[140:141], v51 offset:16384
    v_mfma_f32_16x16x32_bf16 v[232:235], a[168:171], a[28:31], v[232:235]
    ds_read_b64_tr_b16 a[142:143], v51 offset:20480
    s_mov_b32 s82, 1507328
    s_add_u32 m0, s3, 16384
    s_waitcnt lgkmcnt(15)
    v_mfma_f32_16x16x32_bf16 v[140:143], a[172:175], a[16:19], v[140:143]
    buffer_load_dwordx4 v17, s[48:51], s82 offen lds
    v_mfma_f32_16x16x32_bf16 v[172:175], a[172:175], a[20:23], v[172:175]
    ds_read_b64_tr_b16 a[144:145], v52 offset:16384
    v_mfma_f32_16x16x32_bf16 v[204:207], a[172:175], a[24:27], v[204:207]
    ds_read_b64_tr_b16 a[146:147], v52 offset:20480
    v_mfma_f32_16x16x32_bf16 v[236:239], a[172:175], a[28:31], v[236:239]
    s_waitcnt lgkmcnt(15)
    v_mfma_f32_16x16x32_bf16 v[144:147], a[176:179], a[16:19], v[144:147]
    ds_read_b64_tr_b16 a[148:149], v53 offset:16384
    buffer_load_dwordx4 v18, s[48:51], s82 offen offset:1024 lds
    v_mfma_f32_16x16x32_bf16 v[176:179], a[176:179], a[20:23], v[176:179]
    ds_read_b64_tr_b16 a[150:151], v53 offset:20480
    v_mfma_f32_16x16x32_bf16 v[208:211], a[176:179], a[24:27], v[208:211]
    v_mfma_f32_16x16x32_bf16 v[240:243], a[176:179], a[28:31], v[240:243]
    ds_read_b64_tr_b16 a[152:153], v54 offset:16384
    s_waitcnt lgkmcnt(15)
    v_mfma_f32_16x16x32_bf16 v[148:151], a[180:183], a[16:19], v[148:151]
    ds_read_b64_tr_b16 a[154:155], v54 offset:20480
    v_mfma_f32_16x16x32_bf16 v[180:183], a[180:183], a[20:23], v[180:183]
    s_mov_b32 s83, 1736704
    s_add_u32 m0, s3, 24576
    v_mfma_f32_16x16x32_bf16 v[212:215], a[180:183], a[24:27], v[212:215]
    ds_read_b64_tr_b16 a[156:157], v55 offset:16384
    buffer_load_dwordx4 v17, s[48:51], s83 offen lds
    v_mfma_f32_16x16x32_bf16 v[244:247], a[180:183], a[28:31], v[244:247]
    ds_read_b64_tr_b16 a[158:159], v55 offset:20480
    v_mfma_f32_16x16x32_bf16 v[152:155], a[184:187], a[16:19], v[152:155]
    v_mfma_f32_16x16x32_bf16 v[184:187], a[184:187], a[20:23], v[184:187]
    v_mfma_f32_16x16x32_bf16 v[216:219], a[184:187], a[24:27], v[216:219]
    buffer_load_dwordx4 v18, s[48:51], s83 offen offset:1024 lds
    v_mfma_f32_16x16x32_bf16 v[248:251], a[184:187], a[28:31], v[248:251]
    s_waitcnt lgkmcnt(15)
    v_mfma_f32_16x16x32_bf16 v[156:159], a[188:191], a[16:19], v[156:159]
    v_mfma_f32_16x16x32_bf16 v[188:191], a[188:191], a[20:23], v[188:191]
    v_mfma_f32_16x16x32_bf16 v[220:223], a[188:191], a[24:27], v[220:223]
    v_mfma_f32_16x16x32_bf16 v[252:255], a[188:191], a[28:31], v[252:255]
    s_waitcnt lgkmcnt(14)
    v_mfma_f32_16x16x32_bf16 v[128:131], a[128:131], a[32:35], v[128:131]
    buffer_load_dwordx4 a[16:19], v21, s[56:59], s68 offen sc1
    v_mfma_f32_16x16x32_bf16 v[160:163], a[128:131], a[36:39], v[160:163]
    ds_read_b64_tr_b16 a[160:161], v48 offset:24576
    v_mfma_f32_16x16x32_bf16 v[192:195], a[128:131], a[40:43], v[192:195]
    ds_read_b64_tr_b16 a[162:163], v48 offset:28672
    buffer_load_dwordx4 a[20:23], v22, s[56:59], s68 offen sc1
    v_mfma_f32_16x16x32_bf16 v[224:227], a[128:131], a[44:47], v[224:227]
    s_waitcnt lgkmcnt(14)
    v_mfma_f32_16x16x32_bf16 v[132:135], a[132:135], a[32:35], v[132:135]
    ds_read_b64_tr_b16 a[164:165], v49 offset:24576
    buffer_load_dwordx4 a[24:27], v23, s[56:59], s68 offen sc1
    v_mfma_f32_16x16x32_bf16 v[164:167], a[132:135], a[36:39], v[164:167]
    ds_read_b64_tr_b16 a[166:167], v49 offset:28672
    v_mfma_f32_16x16x32_bf16 v[196:199], a[132:135], a[40:43], v[196:199]
    buffer_load_dwordx4 a[28:31], v24, s[56:59], s68 offen sc1
    v_mfma_f32_16x16x32_bf16 v[228:231], a[132:135], a[44:47], v[228:231]
    ds_read_b64_tr_b16 a[168:169], v50 offset:24576
    s_waitcnt lgkmcnt(15)
    v_mfma_f32_16x16x32_bf16 v[136:139], a[136:139], a[32:35], v[136:139]
    ds_read_b64_tr_b16 a[170:171], v50 offset:28672
    s_add_u32 s68, s68, 16384
    v_mfma_f32_16x16x32_bf16 v[168:171], a[136:139], a[36:39], v[168:171]
    v_mfma_f32_16x16x32_bf16 v[200:203], a[136:139], a[40:43], v[200:203]
    ds_read_b64_tr_b16 a[172:173], v51 offset:24576
    v_mfma_f32_16x16x32_bf16 v[232:235], a[136:139], a[44:47], v[232:235]
    ds_read_b64_tr_b16 a[174:175], v51 offset:28672
    s_mov_b32 s82, 196608
    s_add_u32 m0, s3, 32768
    s_waitcnt lgkmcnt(15)
    v_mfma_f32_16x16x32_bf16 v[140:143], a[140:143], a[32:35], v[140:143]
    buffer_load_dwordx4 v19, s[48:51], s82 offen lds
    v_mfma_f32_16x16x32_bf16 v[172:175], a[140:143], a[36:39], v[172:175]
    ds_read_b64_tr_b16 a[176:177], v52 offset:24576
    v_mfma_f32_16x16x32_bf16 v[204:207], a[140:143], a[40:43], v[204:207]
    ds_read_b64_tr_b16 a[178:179], v52 offset:28672
    v_mfma_f32_16x16x32_bf16 v[236:239], a[140:143], a[44:47], v[236:239]
    s_waitcnt lgkmcnt(15)
    v_mfma_f32_16x16x32_bf16 v[144:147], a[144:147], a[32:35], v[144:147]
    ds_read_b64_tr_b16 a[180:181], v53 offset:24576
    buffer_load_dwordx4 v20, s[48:51], s82 offen offset:1024 lds
    v_mfma_f32_16x16x32_bf16 v[176:179], a[144:147], a[36:39], v[176:179]
    ds_read_b64_tr_b16 a[182:183], v53 offset:28672
    v_mfma_f32_16x16x32_bf16 v[208:211], a[144:147], a[40:43], v[208:211]
    v_mfma_f32_16x16x32_bf16 v[240:243], a[144:147], a[44:47], v[240:243]
    ds_read_b64_tr_b16 a[184:185], v54 offset:24576
    s_waitcnt lgkmcnt(15)
    v_mfma_f32_16x16x32_bf16 v[148:151], a[148:151], a[32:35], v[148:151]
    ds_read_b64_tr_b16 a[186:187], v54 offset:28672
    v_mfma_f32_16x16x32_bf16 v[180:183], a[148:151], a[36:39], v[180:183]
    s_mov_b32 s83, 655360
    s_add_u32 m0, s3, 40960
    v_mfma_f32_16x16x32_bf16 v[212:215], a[148:151], a[40:43], v[212:215]
    ds_read_b64_tr_b16 a[188:189], v55 offset:24576
    buffer_load_dwordx4 v19, s[48:51], s83 offen lds
    v_mfma_f32_16x16x32_bf16 v[244:247], a[148:151], a[44:47], v[244:247]
    ds_read_b64_tr_b16 a[190:191], v55 offset:28672
    v_mfma_f32_16x16x32_bf16 v[152:155], a[152:155], a[32:35], v[152:155]
    v_mfma_f32_16x16x32_bf16 v[184:187], a[152:155], a[36:39], v[184:187]
    v_mfma_f32_16x16x32_bf16 v[216:219], a[152:155], a[40:43], v[216:219]
    buffer_load_dwordx4 v20, s[48:51], s83 offen offset:1024 lds
    v_mfma_f32_16x16x32_bf16 v[248:251], a[152:155], a[44:47], v[248:251]
    s_waitcnt lgkmcnt(15)
    v_mfma_f32_16x16x32_bf16 v[156:159], a[156:159], a[32:35], v[156:159]
    buffer_load_dword v43, off, s[56:59], s92 sc1
    v_mfma_f32_16x16x32_bf16 v[188:191], a[156:159], a[36:39], v[188:191]
    v_mfma_f32_16x16x32_bf16 v[220:223], a[156:159], a[40:43], v[220:223]
    v_mfma_f32_16x16x32_bf16 v[252:255], a[156:159], a[44:47], v[252:255]
    s_waitcnt vmcnt(40) lgkmcnt(14)
    v_mfma_f32_16x16x32_bf16 v[128:131], a[160:163], a[48:51], v[128:131]
    buffer_load_dwordx4 a[32:35], v21, s[56:59], s68 offen sc1
    s_waitcnt vmcnt(40)
    v_mfma_f32_16x16x32_bf16 v[160:163], a[160:163], a[52:55], v[160:163]
    ds_read_b64_tr_b16 a[128:129], v48 offset:32768
    s_waitcnt vmcnt(39)
    v_mfma_f32_16x16x32_bf16 v[192:195], a[160:163], a[56:59], v[192:195]
    ds_read_b64_tr_b16 a[130:131], v48 offset:36864
    buffer_load_dwordx4 a[36:39], v22, s[56:59], s68 offen sc1
    s_waitcnt vmcnt(39)
    v_mfma_f32_16x16x32_bf16 v[224:227], a[160:163], a[60:63], v[224:227]
    s_waitcnt lgkmcnt(14)
    v_mfma_f32_16x16x32_bf16 v[132:135], a[164:167], a[48:51], v[132:135]
    ds_read_b64_tr_b16 a[132:133], v49 offset:32768
    buffer_load_dwordx4 a[40:43], v23, s[56:59], s68 offen sc1
    v_mfma_f32_16x16x32_bf16 v[164:167], a[164:167], a[52:55], v[164:167]
    ds_read_b64_tr_b16 a[134:135], v49 offset:36864
    v_mfma_f32_16x16x32_bf16 v[196:199], a[164:167], a[56:59], v[196:199]
    buffer_load_dwordx4 a[44:47], v24, s[56:59], s68 offen sc1
    v_mfma_f32_16x16x32_bf16 v[228:231], a[164:167], a[60:63], v[228:231]
    ds_read_b64_tr_b16 a[136:137], v50 offset:32768
    s_waitcnt lgkmcnt(15)
    v_mfma_f32_16x16x32_bf16 v[136:139], a[168:171], a[48:51], v[136:139]
    ds_read_b64_tr_b16 a[138:139], v50 offset:36864
    s_add_u32 s68, s68, 16384
    v_mfma_f32_16x16x32_bf16 v[168:171], a[168:171], a[52:55], v[168:171]
    v_mfma_f32_16x16x32_bf16 v[200:203], a[168:171], a[56:59], v[200:203]
    ds_read_b64_tr_b16 a[140:141], v51 offset:32768
    v_mfma_f32_16x16x32_bf16 v[232:235], a[168:171], a[60:63], v[232:235]
    ds_read_b64_tr_b16 a[142:143], v51 offset:36864
    s_mov_b32 s82, 1114112
    s_add_u32 m0, s3, 49152
    s_waitcnt lgkmcnt(15)
    v_mfma_f32_16x16x32_bf16 v[140:143], a[172:175], a[48:51], v[140:143]
    buffer_load_dwordx4 v19, s[48:51], s82 offen lds
    v_mfma_f32_16x16x32_bf16 v[172:175], a[172:175], a[52:55], v[172:175]
    ds_read_b64_tr_b16 a[144:145], v52 offset:32768
    v_mfma_f32_16x16x32_bf16 v[204:207], a[172:175], a[56:59], v[204:207]
    ds_read_b64_tr_b16 a[146:147], v52 offset:36864
    v_mfma_f32_16x16x32_bf16 v[236:239], a[172:175], a[60:63], v[236:239]
    s_waitcnt lgkmcnt(15)
    v_mfma_f32_16x16x32_bf16 v[144:147], a[176:179], a[48:51], v[144:147]
    ds_read_b64_tr_b16 a[148:149], v53 offset:32768
    buffer_load_dwordx4 v20, s[48:51], s82 offen offset:1024 lds
    v_mfma_f32_16x16x32_bf16 v[176:179], a[176:179], a[52:55], v[176:179]
    ds_read_b64_tr_b16 a[150:151], v53 offset:36864
    v_mfma_f32_16x16x32_bf16 v[208:211], a[176:179], a[56:59], v[208:211]
    v_mfma_f32_16x16x32_bf16 v[240:243], a[176:179], a[60:63], v[240:243]
    ds_read_b64_tr_b16 a[152:153], v54 offset:32768
    s_waitcnt lgkmcnt(15)
    v_mfma_f32_16x16x32_bf16 v[148:151], a[180:183], a[48:51], v[148:151]
    ds_read_b64_tr_b16 a[154:155], v54 offset:36864
    v_mfma_f32_16x16x32_bf16 v[180:183], a[180:183], a[52:55], v[180:183]
    s_mov_b32 s83, 1572864
    s_add_u32 m0, s3, 57344
    v_mfma_f32_16x16x32_bf16 v[212:215], a[180:183], a[56:59], v[212:215]
    ds_read_b64_tr_b16 a[156:157], v55 offset:32768
    buffer_load_dwordx4 v19, s[48:51], s83 offen lds
    v_mfma_f32_16x16x32_bf16 v[244:247], a[180:183], a[60:63], v[244:247]
    ds_read_b64_tr_b16 a[158:159], v55 offset:36864
    v_mfma_f32_16x16x32_bf16 v[152:155], a[184:187], a[48:51], v[152:155]
    v_mfma_f32_16x16x32_bf16 v[184:187], a[184:187], a[52:55], v[184:187]
    v_mfma_f32_16x16x32_bf16 v[216:219], a[184:187], a[56:59], v[216:219]
    buffer_load_dwordx4 v20, s[48:51], s83 offen offset:1024 lds
    v_mfma_f32_16x16x32_bf16 v[248:251], a[184:187], a[60:63], v[248:251]
    s_waitcnt lgkmcnt(15)
    v_mfma_f32_16x16x32_bf16 v[156:159], a[188:191], a[48:51], v[156:159]
    v_mfma_f32_16x16x32_bf16 v[188:191], a[188:191], a[52:55], v[188:191]
    v_mfma_f32_16x16x32_bf16 v[220:223], a[188:191], a[56:59], v[220:223]
    v_mfma_f32_16x16x32_bf16 v[252:255], a[188:191], a[60:63], v[252:255]
    s_waitcnt vmcnt(44) lgkmcnt(14)
    v_mfma_f32_16x16x32_bf16 v[128:131], a[128:131], a[64:67], v[128:131]
    buffer_load_dwordx4 a[48:51], v21, s[56:59], s68 offen sc1
    s_waitcnt vmcnt(44)
    v_mfma_f32_16x16x32_bf16 v[160:163], a[128:131], a[68:71], v[160:163]
    ds_read_b64_tr_b16 a[160:161], v48 offset:40960
    s_waitcnt vmcnt(43)
    v_mfma_f32_16x16x32_bf16 v[192:195], a[128:131], a[72:75], v[192:195]
    ds_read_b64_tr_b16 a[162:163], v48 offset:45056
    buffer_load_dwordx4 a[52:55], v22, s[56:59], s68 offen sc1
    s_waitcnt vmcnt(43)
    v_mfma_f32_16x16x32_bf16 v[224:227], a[128:131], a[76:79], v[224:227]
    s_waitcnt lgkmcnt(14)
    v_mfma_f32_16x16x32_bf16 v[132:135], a[132:135], a[64:67], v[132:135]
    ds_read_b64_tr_b16 a[164:165], v49 offset:40960
    buffer_load_dwordx4 a[56:59], v23, s[56:59], s68 offen sc1
    v_mfma_f32_16x16x32_bf16 v[164:167], a[132:135], a[68:71], v[164:167]
    ds_read_b64_tr_b16 a[166:167], v49 offset:45056
    v_mfma_f32_16x16x32_bf16 v[196:199], a[132:135], a[72:75], v[196:199]
    buffer_load_dwordx4 a[60:63], v24, s[56:59], s68 offen sc1
    v_mfma_f32_16x16x32_bf16 v[228:231], a[132:135], a[76:79], v[228:231]
    ds_read_b64_tr_b16 a[168:169], v50 offset:40960
    s_waitcnt lgkmcnt(15)
    v_mfma_f32_16x16x32_bf16 v[136:139], a[136:139], a[64:67], v[136:139]
    ds_read_b64_tr_b16 a[170:171], v50 offset:45056
    s_add_u32 s68, s68, 16384
    v_mfma_f32_16x16x32_bf16 v[168:171], a[136:139], a[68:71], v[168:171]
    v_mfma_f32_16x16x32_bf16 v[200:203], a[136:139], a[72:75], v[200:203]
    ds_read_b64_tr_b16 a[172:173], v51 offset:40960
    v_lshlrev_b32 v64, 16, v66
    v_mfma_f32_16x16x32_bf16 v[232:235], a[136:139], a[76:79], v[232:235]
    ds_read_b64_tr_b16 a[174:175], v51 offset:45056
    v_and_b32 v65, 0xffff0000, v66
    s_waitcnt lgkmcnt(15)
    v_mfma_f32_16x16x32_bf16 v[140:143], a[140:143], a[64:67], v[140:143]
    v_lshlrev_b32 v66, 16, v67
    v_mfma_f32_16x16x32_bf16 v[172:175], a[140:143], a[68:71], v[172:175]
    ds_read_b64_tr_b16 a[176:177], v52 offset:40960
    v_and_b32 v67, 0xffff0000, v67
    v_mfma_f32_16x16x32_bf16 v[204:207], a[140:143], a[72:75], v[204:207]
    ds_read_b64_tr_b16 a[178:179], v52 offset:45056
    v_lshlrev_b32 v68, 16, v70
    v_mfma_f32_16x16x32_bf16 v[236:239], a[140:143], a[76:79], v[236:239]
    v_and_b32 v69, 0xffff0000, v70
    s_waitcnt lgkmcnt(15)
    v_mfma_f32_16x16x32_bf16 v[144:147], a[144:147], a[64:67], v[144:147]
    ds_read_b64_tr_b16 a[180:181], v53 offset:40960
    v_lshlrev_b32 v70, 16, v71
    v_mfma_f32_16x16x32_bf16 v[176:179], a[144:147], a[68:71], v[176:179]
    ds_read_b64_tr_b16 a[182:183], v53 offset:45056
    v_and_b32 v71, 0xffff0000, v71
    v_mfma_f32_16x16x32_bf16 v[208:211], a[144:147], a[72:75], v[208:211]
    v_lshlrev_b32 v72, 16, v74
    v_mfma_f32_16x16x32_bf16 v[240:243], a[144:147], a[76:79], v[240:243]
    ds_read_b64_tr_b16 a[184:185], v54 offset:40960
    v_and_b32 v73, 0xffff0000, v74
    s_waitcnt lgkmcnt(15)
    v_mfma_f32_16x16x32_bf16 v[148:151], a[148:151], a[64:67], v[148:151]
    ds_read_b64_tr_b16 a[186:187], v54 offset:45056
    v_lshlrev_b32 v74, 16, v75
    v_mfma_f32_16x16x32_bf16 v[180:183], a[148:151], a[68:71], v[180:183]
    v_and_b32 v75, 0xffff0000, v75
    v_mfma_f32_16x16x32_bf16 v[212:215], a[148:151], a[72:75], v[212:215]
    ds_read_b64_tr_b16 a[188:189], v55 offset:40960
    v_lshlrev_b32 v76, 16, v78
    v_mfma_f32_16x16x32_bf16 v[244:247], a[148:151], a[76:79], v[244:247]
    ds_read_b64_tr_b16 a[190:191], v55 offset:45056
    v_and_b32 v77, 0xffff0000, v78
    v_mfma_f32_16x16x32_bf16 v[152:155], a[152:155], a[64:67], v[152:155]
    v_lshlrev_b32 v78, 16, v79
    v_mfma_f32_16x16x32_bf16 v[184:187], a[152:155], a[68:71], v[184:187]
    v_and_b32 v79, 0xffff0000, v79
    v_mfma_f32_16x16x32_bf16 v[216:219], a[152:155], a[72:75], v[216:219]
    v_mfma_f32_16x16x32_bf16 v[248:251], a[152:155], a[76:79], v[248:251]
    s_waitcnt lgkmcnt(15)
    v_mfma_f32_16x16x32_bf16 v[156:159], a[156:159], a[64:67], v[156:159]
    v_mfma_f32_16x16x32_bf16 v[188:191], a[156:159], a[68:71], v[188:191]
    v_mfma_f32_16x16x32_bf16 v[220:223], a[156:159], a[72:75], v[220:223]
    v_mfma_f32_16x16x32_bf16 v[252:255], a[156:159], a[76:79], v[252:255]
    s_waitcnt vmcnt(44) lgkmcnt(14)
    v_mfma_f32_16x16x32_bf16 v[128:131], a[160:163], a[80:83], v[128:131]
    buffer_load_dwordx4 a[64:67], v21, s[56:59], s68 offen sc1
    s_waitcnt vmcnt(44)
    v_mfma_f32_16x16x32_bf16 v[160:163], a[160:163], a[84:87], v[160:163]
    ds_read_b64_tr_b16 a[128:129], v48 offset:49152
    s_waitcnt vmcnt(43)
    v_mfma_f32_16x16x32_bf16 v[192:195], a[160:163], a[88:91], v[192:195]
    ds_read_b64_tr_b16 a[130:131], v48 offset:53248
    buffer_load_dwordx4 a[68:71], v22, s[56:59], s68 offen sc1
    s_waitcnt vmcnt(43)
    v_mfma_f32_16x16x32_bf16 v[224:227], a[160:163], a[92:95], v[224:227]
    s_waitcnt lgkmcnt(14)
    v_mfma_f32_16x16x32_bf16 v[132:135], a[164:167], a[80:83], v[132:135]
    ds_read_b64_tr_b16 a[132:133], v49 offset:49152
    buffer_load_dwordx4 a[72:75], v23, s[56:59], s68 offen sc1
    v_mfma_f32_16x16x32_bf16 v[164:167], a[164:167], a[84:87], v[164:167]
    ds_read_b64_tr_b16 a[134:135], v49 offset:53248
    v_mfma_f32_16x16x32_bf16 v[196:199], a[164:167], a[88:91], v[196:199]
    buffer_load_dwordx4 a[76:79], v24, s[56:59], s68 offen sc1
    v_mfma_f32_16x16x32_bf16 v[228:231], a[164:167], a[92:95], v[228:231]
    ds_read_b64_tr_b16 a[136:137], v50 offset:49152
    s_waitcnt lgkmcnt(15)
    v_mfma_f32_16x16x32_bf16 v[136:139], a[168:171], a[80:83], v[136:139]
    ds_read_b64_tr_b16 a[138:139], v50 offset:53248
    s_add_u32 s68, s68, 16384
    v_mfma_f32_16x16x32_bf16 v[168:171], a[168:171], a[84:87], v[168:171]
    v_mfma_f32_16x16x32_bf16 v[200:203], a[168:171], a[88:91], v[200:203]
    ds_read_b64_tr_b16 a[140:141], v51 offset:49152
    v_lshlrev_b32 v80, 16, v82
    v_mfma_f32_16x16x32_bf16 v[232:235], a[168:171], a[92:95], v[232:235]
    ds_read_b64_tr_b16 a[142:143], v51 offset:53248
    v_and_b32 v81, 0xffff0000, v82
    s_waitcnt lgkmcnt(15)
    v_mfma_f32_16x16x32_bf16 v[140:143], a[172:175], a[80:83], v[140:143]
    v_lshlrev_b32 v82, 16, v83
    v_mfma_f32_16x16x32_bf16 v[172:175], a[172:175], a[84:87], v[172:175]
    ds_read_b64_tr_b16 a[144:145], v52 offset:49152
    v_and_b32 v83, 0xffff0000, v83
    v_mfma_f32_16x16x32_bf16 v[204:207], a[172:175], a[88:91], v[204:207]
    ds_read_b64_tr_b16 a[146:147], v52 offset:53248
    v_lshlrev_b32 v84, 16, v86
    v_mfma_f32_16x16x32_bf16 v[236:239], a[172:175], a[92:95], v[236:239]
    v_and_b32 v85, 0xffff0000, v86
    s_waitcnt lgkmcnt(15)
    v_mfma_f32_16x16x32_bf16 v[144:147], a[176:179], a[80:83], v[144:147]
    ds_read_b64_tr_b16 a[148:149], v53 offset:49152
    v_lshlrev_b32 v86, 16, v87
    v_mfma_f32_16x16x32_bf16 v[176:179], a[176:179], a[84:87], v[176:179]
    ds_read_b64_tr_b16 a[150:151], v53 offset:53248
    v_and_b32 v87, 0xffff0000, v87
    v_mfma_f32_16x16x32_bf16 v[208:211], a[176:179], a[88:91], v[208:211]
    v_lshlrev_b32 v88, 16, v90
    v_mfma_f32_16x16x32_bf16 v[240:243], a[176:179], a[92:95], v[240:243]
    ds_read_b64_tr_b16 a[152:153], v54 offset:49152
    v_and_b32 v89, 0xffff0000, v90
    s_waitcnt lgkmcnt(15)
    v_mfma_f32_16x16x32_bf16 v[148:151], a[180:183], a[80:83], v[148:151]
    ds_read_b64_tr_b16 a[154:155], v54 offset:53248
    v_lshlrev_b32 v90, 16, v91
    v_mfma_f32_16x16x32_bf16 v[180:183], a[180:183], a[84:87], v[180:183]
    v_and_b32 v91, 0xffff0000, v91
    v_mfma_f32_16x16x32_bf16 v[212:215], a[180:183], a[88:91], v[212:215]
    ds_read_b64_tr_b16 a[156:157], v55 offset:49152
    v_lshlrev_b32 v92, 16, v94
    v_mfma_f32_16x16x32_bf16 v[244:247], a[180:183], a[92:95], v[244:247]
    ds_read_b64_tr_b16 a[158:159], v55 offset:53248
    v_and_b32 v93, 0xffff0000, v94
    v_mfma_f32_16x16x32_bf16 v[152:155], a[184:187], a[80:83], v[152:155]
    v_lshlrev_b32 v94, 16, v95
    v_mfma_f32_16x16x32_bf16 v[184:187], a[184:187], a[84:87], v[184:187]
    v_and_b32 v95, 0xffff0000, v95
    v_mfma_f32_16x16x32_bf16 v[216:219], a[184:187], a[88:91], v[216:219]
    v_mfma_f32_16x16x32_bf16 v[248:251], a[184:187], a[92:95], v[248:251]
    s_waitcnt lgkmcnt(15)
    v_mfma_f32_16x16x32_bf16 v[156:159], a[188:191], a[80:83], v[156:159]
    buffer_load_dword v44, off, s[56:59], s76 sc1
    v_mfma_f32_16x16x32_bf16 v[188:191], a[188:191], a[84:87], v[188:191]
    v_mfma_f32_16x16x32_bf16 v[220:223], a[188:191], a[88:91], v[220:223]
    v_mfma_f32_16x16x32_bf16 v[252:255], a[188:191], a[92:95], v[252:255]
    s_waitcnt vmcnt(45) lgkmcnt(14)
    v_mfma_f32_16x16x32_bf16 v[128:131], a[128:131], a[96:99], v[128:131]
    buffer_load_dwordx4 a[80:83], v21, s[56:59], s68 offen sc1
    s_waitcnt vmcnt(45)
    v_mfma_f32_16x16x32_bf16 v[160:163], a[128:131], a[100:103], v[160:163]
    ds_read_b64_tr_b16 a[160:161], v48 offset:57344
    s_waitcnt vmcnt(44)
    v_mfma_f32_16x16x32_bf16 v[192:195], a[128:131], a[104:107], v[192:195]
    ds_read_b64_tr_b16 a[162:163], v48 offset:61440
    buffer_load_dwordx4 a[84:87], v22, s[56:59], s68 offen sc1
    s_waitcnt vmcnt(44)
    v_mfma_f32_16x16x32_bf16 v[224:227], a[128:131], a[108:111], v[224:227]
    s_waitcnt lgkmcnt(14)
    v_mfma_f32_16x16x32_bf16 v[132:135], a[132:135], a[96:99], v[132:135]
    ds_read_b64_tr_b16 a[164:165], v49 offset:57344
    buffer_load_dwordx4 a[88:91], v23, s[56:59], s68 offen sc1
    v_mfma_f32_16x16x32_bf16 v[164:167], a[132:135], a[100:103], v[164:167]
    ds_read_b64_tr_b16 a[166:167], v49 offset:61440
    v_mfma_f32_16x16x32_bf16 v[196:199], a[132:135], a[104:107], v[196:199]
    buffer_load_dwordx4 a[92:95], v24, s[56:59], s68 offen sc1
    v_mfma_f32_16x16x32_bf16 v[228:231], a[132:135], a[108:111], v[228:231]
    ds_read_b64_tr_b16 a[168:169], v50 offset:57344
    s_waitcnt lgkmcnt(15)
    v_mfma_f32_16x16x32_bf16 v[136:139], a[136:139], a[96:99], v[136:139]
    ds_read_b64_tr_b16 a[170:171], v50 offset:61440
    s_add_u32 s68, s68, 16384
    v_mfma_f32_16x16x32_bf16 v[168:171], a[136:139], a[100:103], v[168:171]
    v_mfma_f32_16x16x32_bf16 v[200:203], a[136:139], a[104:107], v[200:203]
    ds_read_b64_tr_b16 a[172:173], v51 offset:57344
    v_mfma_f32_16x16x32_bf16 v[232:235], a[136:139], a[108:111], v[232:235]
    ds_read_b64_tr_b16 a[174:175], v51 offset:61440
    s_waitcnt lgkmcnt(15)
    v_mfma_f32_16x16x32_bf16 v[140:143], a[140:143], a[96:99], v[140:143]
    v_mfma_f32_16x16x32_bf16 v[172:175], a[140:143], a[100:103], v[172:175]
    ds_read_b64_tr_b16 a[176:177], v52 offset:57344
    v_mfma_f32_16x16x32_bf16 v[204:207], a[140:143], a[104:107], v[204:207]
    ds_read_b64_tr_b16 a[178:179], v52 offset:61440
    v_mfma_f32_16x16x32_bf16 v[236:239], a[140:143], a[108:111], v[236:239]
    s_waitcnt lgkmcnt(15)
    v_mfma_f32_16x16x32_bf16 v[144:147], a[144:147], a[96:99], v[144:147]
    ds_read_b64_tr_b16 a[180:181], v53 offset:57344
    v_mfma_f32_16x16x32_bf16 v[176:179], a[144:147], a[100:103], v[176:179]
    ds_read_b64_tr_b16 a[182:183], v53 offset:61440
    v_mfma_f32_16x16x32_bf16 v[208:211], a[144:147], a[104:107], v[208:211]
    v_mfma_f32_16x16x32_bf16 v[240:243], a[144:147], a[108:111], v[240:243]
    ds_read_b64_tr_b16 a[184:185], v54 offset:57344
    s_waitcnt lgkmcnt(15)
    v_mfma_f32_16x16x32_bf16 v[148:151], a[148:151], a[96:99], v[148:151]
    ds_read_b64_tr_b16 a[186:187], v54 offset:61440
    v_mfma_f32_16x16x32_bf16 v[180:183], a[148:151], a[100:103], v[180:183]
    v_mfma_f32_16x16x32_bf16 v[212:215], a[148:151], a[104:107], v[212:215]
    ds_read_b64_tr_b16 a[188:189], v55 offset:57344
    v_mfma_f32_16x16x32_bf16 v[244:247], a[148:151], a[108:111], v[244:247]
    ds_read_b64_tr_b16 a[190:191], v55 offset:61440
    v_mfma_f32_16x16x32_bf16 v[152:155], a[152:155], a[96:99], v[152:155]
    v_mfma_f32_16x16x32_bf16 v[184:187], a[152:155], a[100:103], v[184:187]
    v_mfma_f32_16x16x32_bf16 v[216:219], a[152:155], a[104:107], v[216:219]
    v_mfma_f32_16x16x32_bf16 v[248:251], a[152:155], a[108:111], v[248:251]
    s_waitcnt lgkmcnt(15)
    v_mfma_f32_16x16x32_bf16 v[156:159], a[156:159], a[96:99], v[156:159]
    v_mfma_f32_16x16x32_bf16 v[188:191], a[156:159], a[100:103], v[188:191]
    v_mfma_f32_16x16x32_bf16 v[220:223], a[156:159], a[104:107], v[220:223]
    v_mfma_f32_16x16x32_bf16 v[252:255], a[156:159], a[108:111], v[252:255]
    s_waitcnt vmcnt(45) lgkmcnt(14)
    v_mfma_f32_16x16x32_bf16 v[128:131], a[160:163], a[112:115], v[128:131]
    buffer_load_dwordx4 a[96:99], v21, s[56:59], s68 offen sc1
    s_waitcnt vmcnt(45)
    v_mfma_f32_16x16x32_bf16 v[160:163], a[160:163], a[116:119], v[160:163]
    ds_read_b64_tr_b16 a[128:129], v56 offset:0
    s_waitcnt vmcnt(44)
    v_mfma_f32_16x16x32_bf16 v[192:195], a[160:163], a[120:123], v[192:195]
    ds_read_b64_tr_b16 a[130:131], v56 offset:4096
    buffer_load_dwordx4 a[100:103], v22, s[56:59], s68 offen sc1
    s_waitcnt vmcnt(44)
    v_mfma_f32_16x16x32_bf16 v[224:227], a[160:163], a[124:127], v[224:227]
    s_waitcnt lgkmcnt(14)
    v_mfma_f32_16x16x32_bf16 v[132:135], a[164:167], a[112:115], v[132:135]
    ds_read_b64_tr_b16 a[132:133], v57 offset:0
    buffer_load_dwordx4 a[104:107], v23, s[56:59], s68 offen sc1
    v_mfma_f32_16x16x32_bf16 v[164:167], a[164:167], a[116:119], v[164:167]
    ds_read_b64_tr_b16 a[134:135], v57 offset:4096
    v_mfma_f32_16x16x32_bf16 v[196:199], a[164:167], a[120:123], v[196:199]
    buffer_load_dwordx4 a[108:111], v24, s[56:59], s68 offen sc1
    v_mfma_f32_16x16x32_bf16 v[228:231], a[164:167], a[124:127], v[228:231]
    ds_read_b64_tr_b16 a[136:137], v58 offset:0
    s_waitcnt lgkmcnt(15)
    v_mfma_f32_16x16x32_bf16 v[136:139], a[168:171], a[112:115], v[136:139]
    ds_read_b64_tr_b16 a[138:139], v58 offset:4096
    s_add_u32 s68, s68, 16384
    v_mfma_f32_16x16x32_bf16 v[168:171], a[168:171], a[116:119], v[168:171]
    v_mfma_f32_16x16x32_bf16 v[200:203], a[168:171], a[120:123], v[200:203]
    ds_read_b64_tr_b16 a[140:141], v59 offset:0
    v_mfma_f32_16x16x32_bf16 v[232:235], a[168:171], a[124:127], v[232:235]
    ds_read_b64_tr_b16 a[142:143], v59 offset:4096
    s_waitcnt lgkmcnt(15)
    v_mfma_f32_16x16x32_bf16 v[140:143], a[172:175], a[112:115], v[140:143]
    v_mfma_f32_16x16x32_bf16 v[172:175], a[172:175], a[116:119], v[172:175]
    ds_read_b64_tr_b16 a[144:145], v60 offset:0
    v_mfma_f32_16x16x32_bf16 v[204:207], a[172:175], a[120:123], v[204:207]
    ds_read_b64_tr_b16 a[146:147], v60 offset:4096
    v_mfma_f32_16x16x32_bf16 v[236:239], a[172:175], a[124:127], v[236:239]
    s_waitcnt lgkmcnt(15)
    v_mfma_f32_16x16x32_bf16 v[144:147], a[176:179], a[112:115], v[144:147]
    ds_read_b64_tr_b16 a[148:149], v61 offset:0
    v_mfma_f32_16x16x32_bf16 v[176:179], a[176:179], a[116:119], v[176:179]
    ds_read_b64_tr_b16 a[150:151], v61 offset:4096
    v_mfma_f32_16x16x32_bf16 v[208:211], a[176:179], a[120:123], v[208:211]
    v_mfma_f32_16x16x32_bf16 v[240:243], a[176:179], a[124:127], v[240:243]
    ds_read_b64_tr_b16 a[152:153], v62 offset:0
    s_waitcnt lgkmcnt(15)
    v_mfma_f32_16x16x32_bf16 v[148:151], a[180:183], a[112:115], v[148:151]
    ds_read_b64_tr_b16 a[154:155], v62 offset:4096
    v_mfma_f32_16x16x32_bf16 v[180:183], a[180:183], a[116:119], v[180:183]
    v_mfma_f32_16x16x32_bf16 v[212:215], a[180:183], a[120:123], v[212:215]
    ds_read_b64_tr_b16 a[156:157], v63 offset:0
    v_mfma_f32_16x16x32_bf16 v[244:247], a[180:183], a[124:127], v[244:247]
    ds_read_b64_tr_b16 a[158:159], v63 offset:4096
    v_mfma_f32_16x16x32_bf16 v[152:155], a[184:187], a[112:115], v[152:155]
    v_mfma_f32_16x16x32_bf16 v[184:187], a[184:187], a[116:119], v[184:187]
    v_mfma_f32_16x16x32_bf16 v[216:219], a[184:187], a[120:123], v[216:219]
    v_mfma_f32_16x16x32_bf16 v[248:251], a[184:187], a[124:127], v[248:251]
    s_waitcnt lgkmcnt(15)
    v_mfma_f32_16x16x32_bf16 v[156:159], a[188:191], a[112:115], v[156:159]
    v_mfma_f32_16x16x32_bf16 v[188:191], a[188:191], a[116:119], v[188:191]
    v_mfma_f32_16x16x32_bf16 v[220:223], a[188:191], a[120:123], v[220:223]
    v_mfma_f32_16x16x32_bf16 v[252:255], a[188:191], a[124:127], v[252:255]
    s_waitcnt vmcnt(17)
    s_barrier
    s_waitcnt lgkmcnt(14)
    v_mfma_f32_16x16x32_bf16 v[128:131], a[128:131], a[0:3], v[128:131]
    buffer_load_dwordx4 a[112:115], v21, s[56:59], s68 offen sc1
    v_mfma_f32_16x16x32_bf16 v[160:163], a[128:131], a[4:7], v[160:163]
    ds_read_b64_tr_b16 a[160:161], v56 offset:8192
    v_mfma_f32_16x16x32_bf16 v[192:195], a[128:131], a[8:11], v[192:195]
    ds_read_b64_tr_b16 a[162:163], v56 offset:12288
    buffer_load_dwordx4 a[116:119], v22, s[56:59], s68 offen sc1
    v_mfma_f32_16x16x32_bf16 v[224:227], a[128:131], a[12:15], v[224:227]
    s_waitcnt lgkmcnt(14)
    v_mfma_f32_16x16x32_bf16 v[132:135], a[132:135], a[0:3], v[132:135]
    ds_read_b64_tr_b16 a[164:165], v57 offset:8192
    buffer_load_dwordx4 a[120:123], v23, s[56:59], s68 offen sc1
    v_mfma_f32_16x16x32_bf16 v[164:167], a[132:135], a[4:7], v[164:167]
    ds_read_b64_tr_b16 a[166:167], v57 offset:12288
    v_mfma_f32_16x16x32_bf16 v[196:199], a[132:135], a[8:11], v[196:199]
    buffer_load_dwordx4 a[124:127], v24, s[56:59], s68 offen sc1
    v_mfma_f32_16x16x32_bf16 v[228:231], a[132:135], a[12:15], v[228:231]
    ds_read_b64_tr_b16 a[168:169], v58 offset:8192
    s_waitcnt lgkmcnt(15)
    v_mfma_f32_16x16x32_bf16 v[136:139], a[136:139], a[0:3], v[136:139]
    ds_read_b64_tr_b16 a[170:171], v58 offset:12288
    s_add_u32 s68, s68, 16384
    v_mfma_f32_16x16x32_bf16 v[168:171], a[136:139], a[4:7], v[168:171]
    v_mfma_f32_16x16x32_bf16 v[200:203], a[136:139], a[8:11], v[200:203]
    ds_read_b64_tr_b16 a[172:173], v59 offset:8192
    v_mfma_f32_16x16x32_bf16 v[232:235], a[136:139], a[12:15], v[232:235]
    ds_read_b64_tr_b16 a[174:175], v59 offset:12288
    s_mov_b32 s82, 0
    s_add_u32 m0, s3, 65536
    s_waitcnt lgkmcnt(15)
    v_mfma_f32_16x16x32_bf16 v[140:143], a[140:143], a[0:3], v[140:143]
    buffer_load_dwordx4 v17, s[52:55], s82 offen lds
    v_mfma_f32_16x16x32_bf16 v[172:175], a[140:143], a[4:7], v[172:175]
    ds_read_b64_tr_b16 a[176:177], v60 offset:8192
    v_mfma_f32_16x16x32_bf16 v[204:207], a[140:143], a[8:11], v[204:207]
    ds_read_b64_tr_b16 a[178:179], v60 offset:12288
    v_mfma_f32_16x16x32_bf16 v[236:239], a[140:143], a[12:15], v[236:239]
    s_waitcnt lgkmcnt(15)
    v_mfma_f32_16x16x32_bf16 v[144:147], a[144:147], a[0:3], v[144:147]
    ds_read_b64_tr_b16 a[180:181], v61 offset:8192
    buffer_load_dwordx4 v18, s[52:55], s82 offen offset:1024 lds
    v_mfma_f32_16x16x32_bf16 v[176:179], a[144:147], a[4:7], v[176:179]
    ds_read_b64_tr_b16 a[182:183], v61 offset:12288
    v_mfma_f32_16x16x32_bf16 v[208:211], a[144:147], a[8:11], v[208:211]
    v_mfma_f32_16x16x32_bf16 v[240:243], a[144:147], a[12:15], v[240:243]
    ds_read_b64_tr_b16 a[184:185], v62 offset:8192
    s_waitcnt lgkmcnt(15)
    v_mfma_f32_16x16x32_bf16 v[148:151], a[148:151], a[0:3], v[148:151]
    ds_read_b64_tr_b16 a[186:187], v62 offset:12288
    v_mfma_f32_16x16x32_bf16 v[180:183], a[148:151], a[4:7], v[180:183]
    s_mov_b32 s83, 65536
    s_add_u32 m0, s3, 73728
    v_mfma_f32_16x16x32_bf16 v[212:215], a[148:151], a[8:11], v[212:215]
    ds_read_b64_tr_b16 a[188:189], v63 offset:8192
    buffer_load_dwordx4 v17, s[52:55], s83 offen lds
    v_mfma_f32_16x16x32_bf16 v[244:247], a[148:151], a[12:15], v[244:247]
    ds_read_b64_tr_b16 a[190:191], v63 offset:12288
    v_mfma_f32_16x16x32_bf16 v[152:155], a[152:155], a[0:3], v[152:155]
    v_mfma_f32_16x16x32_bf16 v[184:187], a[152:155], a[4:7], v[184:187]
    v_mfma_f32_16x16x32_bf16 v[216:219], a[152:155], a[8:11], v[216:219]
    buffer_load_dwordx4 v18, s[52:55], s83 offen offset:1024 lds
    v_mfma_f32_16x16x32_bf16 v[248:251], a[152:155], a[12:15], v[248:251]
    s_waitcnt lgkmcnt(15)
    v_mfma_f32_16x16x32_bf16 v[156:159], a[156:159], a[0:3], v[156:159]
    v_mfma_f32_16x16x32_bf16 v[188:191], a[156:159], a[4:7], v[188:191]
    v_mfma_f32_16x16x32_bf16 v[220:223], a[156:159], a[8:11], v[220:223]
    v_mfma_f32_16x16x32_bf16 v[252:255], a[156:159], a[12:15], v[252:255]
    s_waitcnt lgkmcnt(14)
    v_mfma_f32_16x16x32_bf16 v[128:131], a[160:163], a[16:19], v[128:131]
    v_readfirstlane_b32 s86, v43
    s_bfe_u32 s86, s86, 0x80010
    s_cmp_eq_u32 s86, 16
    s_cbranch_scc0 L_spC
L_okC:
    buffer_load_dwordx4 a[0:3], v21, s[56:59], s68 offen sc1
    v_mfma_f32_16x16x32_bf16 v[160:163], a[160:163], a[20:23], v[160:163]
    ds_read_b64_tr_b16 a[128:129], v56 offset:16384
    v_mfma_f32_16x16x32_bf16 v[192:195], a[160:163], a[24:27], v[192:195]
    ds_read_b64_tr_b16 a[130:131], v56 offset:20480
    buffer_load_dwordx4 a[4:7], v22, s[56:59], s68 offen sc1
    v_mfma_f32_16x16x32_bf16 v[224:227], a[160:163], a[28:31], v[224:227]
    s_waitcnt lgkmcnt(14)
    v_mfma_f32_16x16x32_bf16 v[132:135], a[164:167], a[16:19], v[132:135]
    ds_read_b64_tr_b16 a[132:133], v57 offset:16384
    buffer_load_dwordx4 a[8:11], v23, s[56:59], s68 offen sc1
    v_mfma_f32_16x16x32_bf16 v[164:167], a[164:167], a[20:23], v[164:167]
    ds_read_b64_tr_b16 a[134:135], v57 offset:20480
    v_mfma_f32_16x16x32_bf16 v[196:199], a[164:167], a[24:27], v[196:199]
    buffer_load_dwordx4 a[12:15], v24, s[56:59], s68 offen sc1
    v_mfma_f32_16x16x32_bf16 v[228:231], a[164:167], a[28:31], v[228:231]
    ds_read_b64_tr_b16 a[136:137], v58 offset:16384
    s_waitcnt lgkmcnt(15)
    v_mfma_f32_16x16x32_bf16 v[136:139], a[168:171], a[16:19], v[136:139]
    ds_read_b64_tr_b16 a[138:139], v58 offset:20480
    s_add_u32 s68, s68, 16384
    v_mfma_f32_16x16x32_bf16 v[168:171], a[168:171], a[20:23], v[168:171]
    v_mfma_f32_16x16x32_bf16 v[200:203], a[168:171], a[24:27], v[200:203]
    ds_read_b64_tr_b16 a[140:141], v59 offset:16384
    v_mfma_f32_16x16x32_bf16 v[232:235], a[168:171], a[28:31], v[232:235]
    ds_read_b64_tr_b16 a[142:143], v59 offset:20480
    s_mov_b32 s82, 131072
    s_add_u32 m0, s3, 81920
    s_waitcnt lgkmcnt(15)
    v_mfma_f32_16x16x32_bf16 v[140:143], a[172:175], a[16:19], v[140:143]
    buffer_load_dwordx4 v17, s[52:55], s82 offen lds
    v_mfma_f32_16x16x32_bf16 v[172:175], a[172:175], a[20:23], v[172:175]
    ds_read_b64_tr_b16 a[144:145], v60 offset:16384
    v_mfma_f32_16x16x32_bf16 v[204:207], a[172:175], a[24:27], v[204:207]
    ds_read_b64_tr_b16 a[146:147], v60 offset:20480
    v_mfma_f32_16x16x32_bf16 v[236:239], a[172:175], a[28:31], v[236:239]
    s_waitcnt lgkmcnt(15)
    v_mfma_f32_16x16x32_bf16 v[144:147], a[176:179], a[16:19], v[144:147]
    ds_read_b64_tr_b16 a[148:149], v61 offset:16384
    buffer_load_dwordx4 v18, s[52:55], s82 offen offset:1024 lds
    v_mfma_f32_16x16x32_bf16 v[176:179], a[176:179], a[20:23], v[176:179]
    ds_read_b64_tr_b16 a[150:151], v61 offset:20480
    v_mfma_f32_16x16x32_bf16 v[208:211], a[176:179], a[24:27], v[208:211]
    v_mfma_f32_16x16x32_bf16 v[240:243], a[176:179], a[28:31], v[240:243]
    ds_read_b64_tr_b16 a[152:153], v62 offset:16384
    s_waitcnt lgkmcnt(15)
    v_mfma_f32_16x16x32_bf16 v[148:151], a[180:183], a[16:19], v[148:151]
    ds_read_b64_tr_b16 a[154:155], v62 offset:20480
    v_mfma_f32_16x16x32_bf16 v[180:183], a[180:183], a[20:23], v[180:183]
    s_mov_b32 s83, 196608
    s_add_u32 m0, s3, 90112
    v_mfma_f32_16x16x32_bf16 v[212:215], a[180:183], a[24:27], v[212:215]
    ds_read_b64_tr_b16 a[156:157], v63 offset:16384
    buffer_load_dwordx4 v17, s[52:55], s83 offen lds
    v_mfma_f32_16x16x32_bf16 v[244:247], a[180:183], a[28:31], v[244:247]
    ds_read_b64_tr_b16 a[158:159], v63 offset:20480
    v_mfma_f32_16x16x32_bf16 v[152:155], a[184:187], a[16:19], v[152:155]
    v_mfma_f32_16x16x32_bf16 v[184:187], a[184:187], a[20:23], v[184:187]
    v_mfma_f32_16x16x32_bf16 v[216:219], a[184:187], a[24:27], v[216:219]
    buffer_load_dwordx4 v18, s[52:55], s83 offen offset:1024 lds
    v_mfma_f32_16x16x32_bf16 v[248:251], a[184:187], a[28:31], v[248:251]
    s_waitcnt lgkmcnt(15)
    v_mfma_f32_16x16x32_bf16 v[156:159], a[188:191], a[16:19], v[156:159]
    v_mfma_f32_16x16x32_bf16 v[188:191], a[188:191], a[20:23], v[188:191]
    v_mfma_f32_16x16x32_bf16 v[220:223], a[188:191], a[24:27], v[220:223]
    v_mfma_f32_16x16x32_bf16 v[252:255], a[188:191], a[28:31], v[252:255]
    s_waitcnt lgkmcnt(14)
    v_mfma_f32_16x16x32_bf16 v[128:131], a[128:131], a[32:35], v[128:131]
    buffer_load_dwordx4 a[16:19], v21, s[56:59], s68 offen sc1
    v_mfma_f32_16x16x32_bf16 v[160:163], a[128:131], a[36:39], v[160:163]
    ds_read_b64_tr_b16 a[160:161], v56 offset:24576
    v_mfma_f32_16x16x32_bf16 v[192:195], a[128:131], a[40:43], v[192:195]
    ds_read_b64_tr_b16 a[162:163], v56 offset:28672
    buffer_load_dwordx4 a[20:23], v22, s[56:59], s68 offen sc1
    v_mfma_f32_16x16x32_bf16 v[224:227], a[128:131], a[44:47], v[224:227]
    s_waitcnt lgkmcnt(14)
    v_mfma_f32_16x16x32_bf16 v[132:135], a[132:135], a[32:35], v[132:135]
    ds_read_b64_tr_b16 a[164:165], v57 offset:24576
    buffer_load_dwordx4 a[24:27], v23, s[56:59], s68 offen sc1
    v_mfma_f32_16x16x32_bf16 v[164:167], a[132:135], a[36:39], v[164:167]
    ds_read_b64_tr_b16 a[166:167], v57 offset:28672
    v_mfma_f32_16x16x32_bf16 v[196:199], a[132:135], a[40:43], v[196:199]
    buffer_load_dwordx4 a[28:31], v24, s[56:59], s68 offen sc1
    v_mfma_f32_16x16x32_bf16 v[228:231], a[132:135], a[44:47], v[228:231]
    ds_read_b64_tr_b16 a[168:169], v58 offset:24576
    s_waitcnt lgkmcnt(15)
    v_mfma_f32_16x16x32_bf16 v[136:139], a[136:139], a[32:35], v[136:139]
    ds_read_b64_tr_b16 a[170:171], v58 offset:28672
    s_add_u32 s68, s68, 16384
    v_mfma_f32_16x16x32_bf16 v[168:171], a[136:139], a[36:39], v[168:171]
    v_mfma_f32_16x16x32_bf16 v[200:203], a[136:139], a[40:43], v[200:203]
    ds_read_b64_tr_b16 a[172:173], v59 offset:24576
    v_mfma_f32_16x16x32_bf16 v[232:235], a[136:139], a[44:47], v[232:235]
    ds_read_b64_tr_b16 a[174:175], v59 offset:28672
    s_mov_b32 s82, 262144
    s_add_u32 m0, s3, 98304
    s_waitcnt lgkmcnt(15)
    v_mfma_f32_16x16x32_bf16 v[140:143], a[140:143], a[32:35], v[140:143]
    buffer_load_dwordx4 v17, s[52:55], s82 offen lds
    v_mfma_f32_16x16x32_bf16 v[172:175], a[140:143], a[36:39], v[172:175]
    ds_read_b64_tr_b16 a[176:177], v60 offset:24576
    v_mfma_f32_16x16x32_bf16 v[204:207], a[140:143], a[40:43], v[204:207]
    ds_read_b64_tr_b16 a[178:179], v60 offset:28672
    v_mfma_f32_16x16x32_bf16 v[236:239], a[140:143], a[44:47], v[236:239]
    s_waitcnt lgkmcnt(15)
    v_mfma_f32_16x16x32_bf16 v[144:147], a[144:147], a[32:35], v[144:147]
    ds_read_b64_tr_b16 a[180:181], v61 offset:24576
    buffer_load_dwordx4 v18, s[52:55], s82 offen offset:1024 lds
    v_mfma_f32_16x16x32_bf16 v[176:179], a[144:147], a[36:39], v[176:179]
    ds_read_b64_tr_b16 a[182:183], v61 offset:28672
    v_mfma_f32_16x16x32_bf16 v[208:211], a[144:147], a[40:43], v[208:211]
    v_mfma_f32_16x16x32_bf16 v[240:243], a[144:147], a[44:47], v[240:243]
    ds_read_b64_tr_b16 a[184:185], v62 offset:24576
    s_waitcnt lgkmcnt(15)
    v_mfma_f32_16x16x32_bf16 v[148:151], a[148:151], a[32:35], v[148:151]
    ds_read_b64_tr_b16 a[186:187], v62 offset:28672
    v_mfma_f32_16x16x32_bf16 v[180:183], a[148:151], a[36:39], v[180:183]
    s_mov_b32 s83, 327680
    s_add_u32 m0, s3, 106496
    v_mfma_f32_16x16x32_bf16 v[212:215], a[148:151], a[40:43], v[212:215]
    ds_read_b64_tr_b16 a[188:189], v63 offset:24576
    buffer_load_dwordx4 v17, s[52:55], s83 offen lds
    v_mfma_f32_16x16x32_bf16 v[244:247], a[148:151], a[44:47], v[244:247]
    ds_read_b64_tr_b16 a[190:191], v63 offset:28672
    v_mfma_f32_16x16x32_bf16 v[152:155], a[152:155], a[32:35], v[152:155]
    v_mfma_f32_16x16x32_bf16 v[184:187], a[152:155], a[36:39], v[184:187]
    v_mfma_f32_16x16x32_bf16 v[216:219], a[152:155], a[40:43], v[216:219]
    buffer_load_dwordx4 v18, s[52:55], s83 offen offset:1024 lds
    v_mfma_f32_16x16x32_bf16 v[248:251], a[152:155], a[44:47], v[248:251]
    s_waitcnt lgkmcnt(15)
    v_mfma_f32_16x16x32_bf16 v[156:159], a[156:159], a[32:35], v[156:159]
    v_mfma_f32_16x16x32_bf16 v[188:191], a[156:159], a[36:39], v[188:191]
    v_mfma_f32_16x16x32_bf16 v[220:223], a[156:159], a[40:43], v[220:223]
    v_mfma_f32_16x16x32_bf16 v[252:255], a[156:159], a[44:47], v[252:255]
    s_waitcnt vmcnt(40) lgkmcnt(14)
    v_mfma_f32_16x16x32_bf16 v[128:131], a[160:163], a[48:51], v[128:131]
    buffer_load_dwordx4 a[32:35], v21, s[56:59], s68 offen sc1
    s_waitcnt vmcnt(40)
    v_mfma_f32_16x16x32_bf16 v[160:163], a[160:163], a[52:55], v[160:163]
    ds_read_b64_tr_b16 a[128:129], v8 offset:0
    s_waitcnt vmcnt(39)
    v_mfma_f32_16x16x32_bf16 v[192:195], a[160:163], a[56:59], v[192:195]
    ds_read_b64_tr_b16 a[130:131], v8 offset:4096
    buffer_load_dwordx4 a[36:39], v22, s[56:59], s68 offen sc1
    s_waitcnt vmcnt(39)
    v_mfma_f32_16x16x32_bf16 v[224:227], a[160:163], a[60:63], v[224:227]
    s_waitcnt lgkmcnt(14)
    v_mfma_f32_16x16x32_bf16 v[132:135], a[164:167], a[48:51], v[132:135]
    ds_read_b64_tr_b16 a[132:133], v9 offset:0
    buffer_load_dwordx4 a[40:43], v23, s[56:59], s68 offen sc1
    v_mfma_f32_16x16x32_bf16 v[164:167], a[164:167], a[52:55], v[164:167]
    ds_read_b64_tr_b16 a[134:135], v9 offset:4096
    v_mfma_f32_16x16x32_bf16 v[196:199], a[164:167], a[56:59], v[196:199]
    buffer_load_dwordx4 a[44:47], v24, s[56:59], s68 offen sc1
    v_mfma_f32_16x16x32_bf16 v[228:231], a[164:167], a[60:63], v[228:231]
    ds_read_b64_tr_b16 a[136:137], v10 offset:0
    s_waitcnt lgkmcnt(15)
    v_mfma_f32_16x16x32_bf16 v[136:139], a[168:171], a[48:51], v[136:139]
    ds_read_b64_tr_b16 a[138:139], v10 offset:4096
    s_add_u32 s68, s68, 16384
    v_mfma_f32_16x16x32_bf16 v[168:171], a[168:171], a[52:55], v[168:171]
    v_mfma_f32_16x16x32_bf16 v[200:203], a[168:171], a[56:59], v[200:203]
    ds_read_b64_tr_b16 a[140:141], v11 offset:0
    v_mfma_f32_16x16x32_bf16 v[232:235], a[168:171], a[60:63], v[232:235]
    ds_read_b64_tr_b16 a[142:143], v11 offset:4096
    s_mov_b32 s82, 393216
    s_add_u32 m0, s3, 114688
    s_waitcnt lgkmcnt(15)
    v_mfma_f32_16x16x32_bf16 v[140:143], a[172:175], a[48:51], v[140:143]
    buffer_load_dwordx4 v17, s[52:55], s82 offen lds
    v_mfma_f32_16x16x32_bf16 v[172:175], a[172:175], a[52:55], v[172:175]
    ds_read_b64_tr_b16 a[144:145], v12 offset:0
    v_mfma_f32_16x16x32_bf16 v[204:207], a[172:175], a[56:59], v[204:207]
    ds_read_b64_tr_b16 a[146:147], v12 offset:4096
    v_mfma_f32_16x16x32_bf16 v[236:239], a[172:175], a[60:63], v[236:239]
    s_waitcnt lgkmcnt(15)
    v_mfma_f32_16x16x32_bf16 v[144:147], a[176:179], a[48:51], v[144:147]
    ds_read_b64_tr_b16 a[148:149], v13 offset:0
    buffer_load_dwordx4 v18, s[52:55], s82 offen offset:1024 lds
    v_mfma_f32_16x16x32_bf16 v[176:179], a[176:179], a[52:55], v[176:179]
    ds_read_b64_tr_b16 a[150:151], v13 offset:4096
    v_mfma_f32_16x16x32_bf16 v[208:211], a[176:179], a[56:59], v[208:211]
    v_mfma_f32_16x16x32_bf16 v[240:243], a[176:179], a[60:63], v[240:243]
    ds_read_b64_tr_b16 a[152:153], v14 offset:0
    s_waitcnt lgkmcnt(15)
    v_mfma_f32_16x16x32_bf16 v[148:151], a[180:183], a[48:51], v[148:151]
    ds_read_b64_tr_b16 a[154:155], v14 offset:4096
    v_mfma_f32_16x16x32_bf16 v[180:183], a[180:183], a[52:55], v[180:183]
    s_mov_b32 s83, 458752
    s_add_u32 m0, s3, 122880
    v_mfma_f32_16x16x32_bf16 v[212:215], a[180:183], a[56:59], v[212:215]
    ds_read_b64_tr_b16 a[156:157], v15 offset:0
    buffer_load_dwordx4 v17, s[52:55], s83 offen lds
    v_mfma_f32_16x16x32_bf16 v[244:247], a[180:183], a[60:63], v[244:247]
    ds_read_b64_tr_b16 a[158:159], v15 offset:4096
    v_mfma_f32_16x16x32_bf16 v[152:155], a[184:187], a[48:51], v[152:155]
    v_mfma_f32_16x16x32_bf16 v[184:187], a[184:187], a[52:55], v[184:187]
    v_mfma_f32_16x16x32_bf16 v[216:219], a[184:187], a[56:59], v[216:219]
    buffer_load_dwordx4 v18, s[52:55], s83 offen offset:1024 lds
    v_mfma_f32_16x16x32_bf16 v[248:251], a[184:187], a[60:63], v[248:251]
    s_waitcnt lgkmcnt(15)
    v_mfma_f32_16x16x32_bf16 v[156:159], a[188:191], a[48:51], v[156:159]
    v_mfma_f32_16x16x32_bf16 v[188:191], a[188:191], a[52:55], v[188:191]
    v_mfma_f32_16x16x32_bf16 v[220:223], a[188:191], a[56:59], v[220:223]
    v_mfma_f32_16x16x32_bf16 v[252:255], a[188:191], a[60:63], v[252:255]
    s_waitcnt vmcnt(44) lgkmcnt(14)
    v_mfma_f32_16x16x32_bf16 v[128:131], a[128:131], a[64:67], v[128:131]
    buffer_load_dwordx4 a[48:51], v21, s[56:59], s68 offen sc1
    s_waitcnt vmcnt(44)
    v_mfma_f32_16x16x32_bf16 v[160:163], a[128:131], a[68:71], v[160:163]
    ds_read_b64_tr_b16 a[160:161], v8 offset:8192
    s_waitcnt vmcnt(43)
    v_mfma_f32_16x16x32_bf16 v[192:195], a[128:131], a[72:75], v[192:195]
    ds_read_b64_tr_b16 a[162:163], v8 offset:12288
    buffer_load_dwordx4 a[52:55], v22, s[56:59], s68 offen sc1
    s_waitcnt vmcnt(43)
    v_mfma_f32_16x16x32_bf16 v[224:227], a[128:131], a[76:79], v[224:227]
    s_waitcnt lgkmcnt(14)
    v_mfma_f32_16x16x32_bf16 v[132:135], a[132:135], a[64:67], v[132:135]
    ds_read_b64_tr_b16 a[164:165], v9 offset:8192
    buffer_load_dwordx4 a[56:59], v23, s[56:59], s68 offen sc1
    v_mfma_f32_16x16x32_bf16 v[164:167], a[132:135], a[68:71], v[164:167]
    ds_read_b64_tr_b16 a[166:167], v9 offset:12288
    v_mfma_f32_16x16x32_bf16 v[196:199], a[132:135], a[72:75], v[196:199]
    buffer_load_dwordx4 a[60:63], v24, s[56:59], s68 offen sc1
    v_mfma_f32_16x16x32_bf16 v[228:231], a[132:135], a[76:79], v[228:231]
    ds_read_b64_tr_b16 a[168:169], v10 offset:8192
    s_waitcnt lgkmcnt(15)
    v_mfma_f32_16x16x32_bf16 v[136:139], a[136:139], a[64:67], v[136:139]
    ds_read_b64_tr_b16 a[170:171], v10 offset:12288
    s_add_u32 s68, s68, 16384
    v_mfma_f32_16x16x32_bf16 v[168:171], a[136:139], a[68:71], v[168:171]
    v_mfma_f32_16x16x32_bf16 v[200:203], a[136:139], a[72:75], v[200:203]
    ds_read_b64_tr_b16 a[172:173], v11 offset:8192
    v_mfma_f32_16x16x32_bf16 v[232:235], a[136:139], a[76:79], v[232:235]
    ds_read_b64_tr_b16 a[174:175], v11 offset:12288
    s_waitcnt lgkmcnt(15)
    v_mfma_f32_16x16x32_bf16 v[140:143], a[140:143], a[64:67], v[140:143]
    v_mfma_f32_16x16x32_bf16 v[172:175], a[140:143], a[68:71], v[172:175]
    ds_read_b64_tr_b16 a[176:177], v12 offset:8192
    v_mfma_f32_16x16x32_bf16 v[204:207], a[140:143], a[72:75], v[204:207]
    ds_read_b64_tr_b16 a[178:179], v12 offset:12288
    v_mfma_f32_16x16x32_bf16 v[236:239], a[140:143], a[76:79], v[236:239]
    s_waitcnt lgkmcnt(15)
    v_mfma_f32_16x16x32_bf16 v[144:147], a[144:147], a[64:67], v[144:147]
    ds_read_b64_tr_b16 a[180:181], v13 offset:8192
    v_mfma_f32_16x16x32_bf16 v[176:179], a[144:147], a[68:71], v[176:179]
    ds_read_b64_tr_b16 a[182:183], v13 offset:12288
    v_mfma_f32_16x16x32_bf16 v[208:211], a[144:147], a[72:75], v[208:211]
    v_mfma_f32_16x16x32_bf16 v[240:243], a[144:147], a[76:79], v[240:243]
    ds_read_b64_tr_b16 a[184:185], v14 offset:8192
    s_waitcnt lgkmcnt(15)
    v_mfma_f32_16x16x32_bf16 v[148:151], a[148:151], a[64:67], v[148:151]
    ds_read_b64_tr_b16 a[186:187], v14 offset:12288
    v_mfma_f32_16x16x32_bf16 v[180:183], a[148:151], a[68:71], v[180:183]
    v_mfma_f32_16x16x32_bf16 v[212:215], a[148:151], a[72:75], v[212:215]
    ds_read_b64_tr_b16 a[188:189], v15 offset:8192
    v_mfma_f32_16x16x32_bf16 v[244:247], a[148:151], a[76:79], v[244:247]
    ds_read_b64_tr_b16 a[190:191], v15 offset:12288
    v_mfma_f32_16x16x32_bf16 v[152:155], a[152:155], a[64:67], v[152:155]
    v_mfma_f32_16x16x32_bf16 v[184:187], a[152:155], a[68:71], v[184:187]
    v_mfma_f32_16x16x32_bf16 v[216:219], a[152:155], a[72:75], v[216:219]
    v_mfma_f32_16x16x32_bf16 v[248:251], a[152:155], a[76:79], v[248:251]
    s_waitcnt lgkmcnt(15)
    v_mfma_f32_16x16x32_bf16 v[156:159], a[156:159], a[64:67], v[156:159]
    v_mfma_f32_16x16x32_bf16 v[188:191], a[156:159], a[68:71], v[188:191]
    v_mfma_f32_16x16x32_bf16 v[220:223], a[156:159], a[72:75], v[220:223]
    v_mfma_f32_16x16x32_bf16 v[252:255], a[156:159], a[76:79], v[252:255]
    s_waitcnt vmcnt(43) lgkmcnt(14)
    v_mfma_f32_16x16x32_bf16 v[128:131], a[160:163], a[80:83], v[128:131]
    v_readfirstlane_b32 s86, v44
    s_cmp_eq_u32 s86, 64
    s_cbranch_scc0 L_spO
L_okO:
    buffer_load_dwordx4 a[64:67], v16, s[56:59], s69 offen offset:0 sc1
    s_waitcnt vmcnt(43)
    v_mfma_f32_16x16x32_bf16 v[160:163], a[160:163], a[84:87], v[160:163]
    ds_read_b64_tr_b16 a[128:129], v8 offset:16384
    s_waitcnt vmcnt(42)
    v_mfma_f32_16x16x32_bf16 v[192:195], a[160:163], a[88:91], v[192:195]
    ds_read_b64_tr_b16 a[130:131], v8 offset:20480
    buffer_load_dwordx4 a[68:71], v16, s[56:59], s69 offen offset:1024 sc1
    s_waitcnt vmcnt(42)
    v_mfma_f32_16x16x32_bf16 v[224:227], a[160:163], a[92:95], v[224:227]
    s_waitcnt lgkmcnt(14)
    v_mfma_f32_16x16x32_bf16 v[132:135], a[164:167], a[80:83], v[132:135]
    ds_read_b64_tr_b16 a[132:133], v9 offset:16384
    buffer_load_dwordx4 a[72:75], v16, s[56:59], s69 offen offset:2048 sc1
    v_mfma_f32_16x16x32_bf16 v[164:167], a[164:167], a[84:87], v[164:167]
    ds_read_b64_tr_b16 a[134:135], v9 offset:20480
    v_mfma_f32_16x16x32_bf16 v[196:199], a[164:167], a[88:91], v[196:199]
    buffer_load_dwordx4 a[76:79], v16, s[56:59], s69 offen offset:3072 sc1
    v_mfma_f32_16x16x32_bf16 v[228:231], a[164:167], a[92:95], v[228:231]
    ds_read_b64_tr_b16 a[136:137], v10 offset:16384
    s_waitcnt lgkmcnt(15)
    v_mfma_f32_16x16x32_bf16 v[136:139], a[168:171], a[80:83], v[136:139]
    ds_read_b64_tr_b16 a[138:139], v10 offset:20480
    s_add_u32 s69, s69, 4096
    v_mfma_f32_16x16x32_bf16 v[168:171], a[168:171], a[84:87], v[168:171]
    v_mfma_f32_16x16x32_bf16 v[200:203], a[168:171], a[88:91], v[200:203]
    ds_read_b64_tr_b16 a[140:141], v11 offset:16384
    v_mfma_f32_16x16x32_bf16 v[232:235], a[168:171], a[92:95], v[232:235]
    ds_read_b64_tr_b16 a[142:143], v11 offset:20480
    s_waitcnt lgkmcnt(15)
    v_mfma_f32_16x16x32_bf16 v[140:143], a[172:175], a[80:83], v[140:143]
    v_mfma_f32_16x16x32_bf16 v[172:175], a[172:175], a[84:87], v[172:175]
    ds_read_b64_tr_b16 a[144:145], v12 offset:16384
    v_mfma_f32_16x16x32_bf16 v[204:207], a[172:175], a[88:91], v[204:207]
    ds_read_b64_tr_b16 a[146:147], v12 offset:20480
    v_mfma_f32_16x16x32_bf16 v[236:239], a[172:175], a[92:95], v[236:239]
    s_waitcnt lgkmcnt(15)
    v_mfma_f32_16x16x32_bf16 v[144:147], a[176:179], a[80:83], v[144:147]
    ds_read_b64_tr_b16 a[148:149], v13 offset:16384
    v_mfma_f32_16x16x32_bf16 v[176:179], a[176:179], a[84:87], v[176:179]
    ds_read_b64_tr_b16 a[150:151], v13 offset:20480
    v_mfma_f32_16x16x32_bf16 v[208:211], a[176:179], a[88:91], v[208:211]
    v_mfma_f32_16x16x32_bf16 v[240:243], a[176:179], a[92:95], v[240:243]
    ds_read_b64_tr_b16 a[152:153], v14 offset:16384
    s_waitcnt lgkmcnt(15)
    v_mfma_f32_16x16x32_bf16 v[148:151], a[180:183], a[80:83], v[148:151]
    ds_read_b64_tr_b16 a[154:155], v14 offset:20480
    v_mfma_f32_16x16x32_bf16 v[180:183], a[180:183], a[84:87], v[180:183]
    v_mfma_f32_16x16x32_bf16 v[212:215], a[180:183], a[88:91], v[212:215]
    ds_read_b64_tr_b16 a[156:157], v15 offset:16384
    v_mfma_f32_16x16x32_bf16 v[244:247], a[180:183], a[92:95], v[244:247]
    ds_read_b64_tr_b16 a[158:159], v15 offset:20480
    v_mfma_f32_16x16x32_bf16 v[152:155], a[184:187], a[80:83], v[152:155]
    v_mfma_f32_16x16x32_bf16 v[184:187], a[184:187], a[84:87], v[184:187]
    v_mfma_f32_16x16x32_bf16 v[216:219], a[184:187], a[88:91], v[216:219]
    v_mfma_f32_16x16x32_bf16 v[248:251], a[184:187], a[92:95], v[248:251]
    s_waitcnt lgkmcnt(15)
    v_mfma_f32_16x16x32_bf16 v[156:159], a[188:191], a[80:83], v[156:159]
    v_mfma_f32_16x16x32_bf16 v[188:191], a[188:191], a[84:87], v[188:191]
    v_mfma_f32_16x16x32_bf16 v[220:223], a[188:191], a[88:91], v[220:223]
    v_mfma_f32_16x16x32_bf16 v[252:255], a[188:191], a[92:95], v[252:255]
    s_waitcnt vmcnt(43) lgkmcnt(14)
    v_mfma_f32_16x16x32_bf16 v[128:131], a[128:131], a[96:99], v[128:131]
    buffer_load_dwordx4 a[80:83], v16, s[56:59], s69 offen offset:0 sc1
    s_waitcnt vmcnt(43)
    v_mfma_f32_16x16x32_bf16 v[160:163], a[128:131], a[100:103], v[160:163]
    ds_read_b64_tr_b16 a[160:161], v8 offset:24576
    s_waitcnt vmcnt(42)
    v_mfma_f32_16x16x32_bf16 v[192:195], a[128:131], a[104:107], v[192:195]
    ds_read_b64_tr_b16 a[162:163], v8 offset:28672
    buffer_load_dwordx4 a[84:87], v16, s[56:59], s69 offen offset:1024 sc1
    s_waitcnt vmcnt(42)
    v_mfma_f32_16x16x32_bf16 v[224:227], a[128:131], a[108:111], v[224:227]
    s_waitcnt lgkmcnt(14)
    v_mfma_f32_16x16x32_bf16 v[132:135], a[132:135], a[96:99], v[132:135]
    ds_read_b64_tr_b16 a[164:165], v9 offset:24576
    buffer_load_dwordx4 a[88:91], v16, s[56:59], s69 offen offset:2048 sc1
    v_mfma_f32_16x16x32_bf16 v[164:167], a[132:135], a[100:103], v[164:167]
    ds_read_b64_tr_b16 a[166:167], v9 offset:28672
    v_mfma_f32_16x16x32_bf16 v[196:199], a[132:135], a[104:107], v[196:199]
    buffer_load_dwordx4 a[92:95], v16, s[56:59], s69 offen offset:3072 sc1
    v_mfma_f32_16x16x32_bf16 v[228:231], a[132:135], a[108:111], v[228:231]
    ds_read_b64_tr_b16 a[168:169], v10 offset:24576
    s_waitcnt lgkmcnt(15)
    v_mfma_f32_16x16x32_bf16 v[136:139], a[136:139], a[96:99], v[136:139]
    ds_read_b64_tr_b16 a[170:171], v10 offset:28672
    s_add_u32 s69, s69, 4096
    v_mfma_f32_16x16x32_bf16 v[168:171], a[136:139], a[100:103], v[168:171]
    v_mfma_f32_16x16x32_bf16 v[200:203], a[136:139], a[104:107], v[200:203]
    ds_read_b64_tr_b16 a[172:173], v11 offset:24576
    v_mfma_f32_16x16x32_bf16 v[232:235], a[136:139], a[108:111], v[232:235]
    ds_read_b64_tr_b16 a[174:175], v11 offset:28672
    s_waitcnt lgkmcnt(15)
    v_mfma_f32_16x16x32_bf16 v[140:143], a[140:143], a[96:99], v[140:143]
    v_mfma_f32_16x16x32_bf16 v[172:175], a[140:143], a[100:103], v[172:175]
    ds_read_b64_tr_b16 a[176:177], v12 offset:24576
    v_mfma_f32_16x16x32_bf16 v[204:207], a[140:143], a[104:107], v[204:207]
    ds_read_b64_tr_b16 a[178:179], v12 offset:28672
    v_mfma_f32_16x16x32_bf16 v[236:239], a[140:143], a[108:111], v[236:239]
    s_waitcnt lgkmcnt(15)
    v_mfma_f32_16x16x32_bf16 v[144:147], a[144:147], a[96:99], v[144:147]
    ds_read_b64_tr_b16 a[180:181], v13 offset:24576
    v_mfma_f32_16x16x32_bf16 v[176:179], a[144:147], a[100:103], v[176:179]
    ds_read_b64_tr_b16 a[182:183], v13 offset:28672
    v_mfma_f32_16x16x32_bf16 v[208:211], a[144:147], a[104:107], v[208:211]
    v_mfma_f32_16x16x32_bf16 v[240:243], a[144:147], a[108:111], v[240:243]
    ds_read_b64_tr_b16 a[184:185], v14 offset:24576
    s_waitcnt lgkmcnt(15)
    v_mfma_f32_16x16x32_bf16 v[148:151], a[148:151], a[96:99], v[148:151]
    ds_read_b64_tr_b16 a[186:187], v14 offset:28672
    v_mfma_f32_16x16x32_bf16 v[180:183], a[148:151], a[100:103], v[180:183]
    v_mfma_f32_16x16x32_bf16 v[212:215], a[148:151], a[104:107], v[212:215]
    ds_read_b64_tr_b16 a[188:189], v15 offset:24576
    v_mfma_f32_16x16x32_bf16 v[244:247], a[148:151], a[108:111], v[244:247]
    ds_read_b64_tr_b16 a[190:191], v15 offset:28672
    v_mfma_f32_16x16x32_bf16 v[152:155], a[152:155], a[96:99], v[152:155]
    v_mfma_f32_16x16x32_bf16 v[184:187], a[152:155], a[100:103], v[184:187]
    v_mfma_f32_16x16x32_bf16 v[216:219], a[152:155], a[104:107], v[216:219]
    v_mfma_f32_16x16x32_bf16 v[248:251], a[152:155], a[108:111], v[248:251]
    s_waitcnt lgkmcnt(15)
    v_mfma_f32_16x16x32_bf16 v[156:159], a[156:159], a[96:99], v[156:159]
    v_mfma_f32_16x16x32_bf16 v[188:191], a[156:159], a[100:103], v[188:191]
    v_mfma_f32_16x16x32_bf16 v[220:223], a[156:159], a[104:107], v[220:223]
    v_mfma_f32_16x16x32_bf16 v[252:255], a[156:159], a[108:111], v[252:255]
    s_waitcnt vmcnt(43) lgkmcnt(14)
    v_mfma_f32_16x16x32_bf16 v[128:131], a[160:163], a[112:115], v[128:131]
    buffer_load_dwordx4 a[96:99], v16, s[56:59], s69 offen offset:0 sc1
    s_waitcnt vmcnt(43)
    v_mfma_f32_16x16x32_bf16 v[160:163], a[160:163], a[116:119], v[160:163]
    ds_read_b64_tr_b16 a[128:129], v8 offset:32768
    s_waitcnt vmcnt(42)
    v_mfma_f32_16x16x32_bf16 v[192:195], a[160:163], a[120:123], v[192:195]
    ds_read_b64_tr_b16 a[130:131], v8 offset:36864
    buffer_load_dwordx4 a[100:103], v16, s[56:59], s69 offen offset:1024 sc1
    s_waitcnt vmcnt(42)
    v_mfma_f32_16x16x32_bf16 v[224:227], a[160:163], a[124:127], v[224:227]
    s_waitcnt lgkmcnt(14)
    v_mfma_f32_16x16x32_bf16 v[132:135], a[164:167], a[112:115], v[132:135]
    ds_read_b64_tr_b16 a[132:133], v9 offset:32768
    buffer_load_dwordx4 a[104:107], v16, s[56:59], s69 offen offset:2048 sc1
    v_mfma_f32_16x16x32_bf16 v[164:167], a[164:167], a[116:119], v[164:167]
    ds_read_b64_tr_b16 a[134:135], v9 offset:36864
    v_mfma_f32_16x16x32_bf16 v[196:199], a[164:167], a[120:123], v[196:199]
    buffer_load_dwordx4 a[108:111], v16, s[56:59], s69 offen offset:3072 sc1
    v_mfma_f32_16x16x32_bf16 v[228:231], a[164:167], a[124:127], v[228:231]
    ds_read_b64_tr_b16 a[136:137], v10 offset:32768
    s_waitcnt lgkmcnt(15)
    v_mfma_f32_16x16x32_bf16 v[136:139], a[168:171], a[112:115], v[136:139]
    ds_read_b64_tr_b16 a[138:139], v10 offset:36864
    s_add_u32 s69, s69, 4096
    v_mfma_f32_16x16x32_bf16 v[168:171], a[168:171], a[116:119], v[168:171]
    v_mfma_f32_16x16x32_bf16 v[200:203], a[168:171], a[120:123], v[200:203]
    ds_read_b64_tr_b16 a[140:141], v11 offset:32768
    v_mfma_f32_16x16x32_bf16 v[232:235], a[168:171], a[124:127], v[232:235]
    ds_read_b64_tr_b16 a[142:143], v11 offset:36864
    s_waitcnt lgkmcnt(15)
    v_mfma_f32_16x16x32_bf16 v[140:143], a[172:175], a[112:115], v[140:143]
    v_mfma_f32_16x16x32_bf16 v[172:175], a[172:175], a[116:119], v[172:175]
    ds_read_b64_tr_b16 a[144:145], v12 offset:32768
    v_mfma_f32_16x16x32_bf16 v[204:207], a[172:175], a[120:123], v[204:207]
    ds_read_b64_tr_b16 a[146:147], v12 offset:36864
    v_mfma_f32_16x16x32_bf16 v[236:239], a[172:175], a[124:127], v[236:239]
    s_waitcnt lgkmcnt(15)
    v_mfma_f32_16x16x32_bf16 v[144:147], a[176:179], a[112:115], v[144:147]
    ds_read_b64_tr_b16 a[148:149], v13 offset:32768
    v_mfma_f32_16x16x32_bf16 v[176:179], a[176:179], a[116:119], v[176:179]
    ds_read_b64_tr_b16 a[150:151], v13 offset:36864
    v_mfma_f32_16x16x32_bf16 v[208:211], a[176:179], a[120:123], v[208:211]
    v_mfma_f32_16x16x32_bf16 v[240:243], a[176:179], a[124:127], v[240:243]
    ds_read_b64_tr_b16 a[152:153], v14 offset:32768
    s_waitcnt lgkmcnt(15)
    v_mfma_f32_16x16x32_bf16 v[148:151], a[180:183], a[112:115], v[148:151]
    ds_read_b64_tr_b16 a[154:155], v14 offset:36864
    v_mfma_f32_16x16x32_bf16 v[180:183], a[180:183], a[116:119], v[180:183]
    v_mfma_f32_16x16x32_bf16 v[212:215], a[180:183], a[120:123], v[212:215]
    ds_read_b64_tr_b16 a[156:157], v15 offset:32768
    v_mfma_f32_16x16x32_bf16 v[244:247], a[180:183], a[124:127], v[244:247]
    ds_read_b64_tr_b16 a[158:159], v15 offset:36864
    v_mfma_f32_16x16x32_bf16 v[152:155], a[184:187], a[112:115], v[152:155]
    v_mfma_f32_16x16x32_bf16 v[184:187], a[184:187], a[116:119], v[184:187]
    v_mfma_f32_16x16x32_bf16 v[216:219], a[184:187], a[120:123], v[216:219]
    v_mfma_f32_16x16x32_bf16 v[248:251], a[184:187], a[124:127], v[248:251]
    s_waitcnt lgkmcnt(15)
    v_mfma_f32_16x16x32_bf16 v[156:159], a[188:191], a[112:115], v[156:159]
    v_mfma_f32_16x16x32_bf16 v[188:191], a[188:191], a[116:119], v[188:191]
    v_mfma_f32_16x16x32_bf16 v[220:223], a[188:191], a[120:123], v[220:223]
    v_mfma_f32_16x16x32_bf16 v[252:255], a[188:191], a[124:127], v[252:255]
    s_waitcnt vmcnt(16)
    s_barrier
    s_waitcnt lgkmcnt(14)
    v_mfma_f32_16x16x32_bf16 v[128:131], a[128:131], a[0:3], v[128:131]
    buffer_load_dwordx4 a[112:115], v16, s[56:59], s69 offen offset:0 sc1
    v_mfma_f32_16x16x32_bf16 v[160:163], a[128:131], a[4:7], v[160:163]
    ds_read_b64_tr_b16 a[160:161], v8 offset:40960
    v_mfma_f32_16x16x32_bf16 v[192:195], a[128:131], a[8:11], v[192:195]
    ds_read_b64_tr_b16 a[162:163], v8 offset:45056
    buffer_load_dwordx4 a[116:119], v16, s[56:59], s69 offen offset:1024 sc1
    v_mfma_f32_16x16x32_bf16 v[224:227], a[128:131], a[12:15], v[224:227]
    s_waitcnt lgkmcnt(14)
    v_mfma_f32_16x16x32_bf16 v[132:135], a[132:135], a[0:3], v[132:135]
    ds_read_b64_tr_b16 a[164:165], v9 offset:40960
    buffer_load_dwordx4 a[120:123], v16, s[56:59], s69 offen offset:2048 sc1
    v_mfma_f32_16x16x32_bf16 v[164:167], a[132:135], a[4:7], v[164:167]
    ds_read_b64_tr_b16 a[166:167], v9 offset:45056
    v_mfma_f32_16x16x32_bf16 v[196:199], a[132:135], a[8:11], v[196:199]
    buffer_load_dwordx4 a[124:127], v16, s[56:59], s69 offen offset:3072 sc1
    v_mfma_f32_16x16x32_bf16 v[228:231], a[132:135], a[12:15], v[228:231]
    ds_read_b64_tr_b16 a[168:169], v10 offset:40960
    s_waitcnt lgkmcnt(15)
    v_mfma_f32_16x16x32_bf16 v[136:139], a[136:139], a[0:3], v[136:139]
    ds_read_b64_tr_b16 a[170:171], v10 offset:45056
    s_add_u32 s69, s69, 4096
    v_mfma_f32_16x16x32_bf16 v[168:171], a[136:139], a[4:7], v[168:171]
    v_mfma_f32_16x16x32_bf16 v[200:203], a[136:139], a[8:11], v[200:203]
    ds_read_b64_tr_b16 a[172:173], v11 offset:40960
    v_mfma_f32_16x16x32_bf16 v[232:235], a[136:139], a[12:15], v[232:235]
    ds_read_b64_tr_b16 a[174:175], v11 offset:45056
    s_mov_b32 s82, 524288
    s_add_u32 m0, s3, 131072
    s_waitcnt lgkmcnt(15)
    v_mfma_f32_16x16x32_bf16 v[140:143], a[140:143], a[0:3], v[140:143]
    buffer_load_dwordx4 v17, s[52:55], s82 offen lds
    v_mfma_f32_16x16x32_bf16 v[172:175], a[140:143], a[4:7], v[172:175]
    ds_read_b64_tr_b16 a[176:177], v12 offset:40960
    v_mfma_f32_16x16x32_bf16 v[204:207], a[140:143], a[8:11], v[204:207]
    ds_read_b64_tr_b16 a[178:179], v12 offset:45056
    v_mfma_f32_16x16x32_bf16 v[236:239], a[140:143], a[12:15], v[236:239]
    s_waitcnt lgkmcnt(15)
    v_mfma_f32_16x16x32_bf16 v[144:147], a[144:147], a[0:3], v[144:147]
    ds_read_b64_tr_b16 a[180:181], v13 offset:40960
    buffer_load_dwordx4 v18, s[52:55], s82 offen offset:1024 lds
    v_mfma_f32_16x16x32_bf16 v[176:179], a[144:147], a[4:7], v[176:179]
    ds_read_b64_tr_b16 a[182:183], v13 offset:45056
    v_mfma_f32_16x16x32_bf16 v[208:211], a[144:147], a[8:11], v[208:211]
    v_mfma_f32_16x16x32_bf16 v[240:243], a[144:147], a[12:15], v[240:243]
    ds_read_b64_tr_b16 a[184:185], v14 offset:40960
    s_waitcnt lgkmcnt(15)
    v_mfma_f32_16x16x32_bf16 v[148:151], a[148:151], a[0:3], v[148:151]
    ds_read_b64_tr_b16 a[186:187], v14 offset:45056
    v_mfma_f32_16x16x32_bf16 v[180:183], a[148:151], a[4:7], v[180:183]
    s_mov_b32 s83, 589824
    s_add_u32 m0, s3, 139264
    v_mfma_f32_16x16x32_bf16 v[212:215], a[148:151], a[8:11], v[212:215]
    ds_read_b64_tr_b16 a[188:189], v15 offset:40960
    buffer_load_dwordx4 v17, s[52:55], s83 offen lds
    v_mfma_f32_16x16x32_bf16 v[244:247], a[148:151], a[12:15], v[244:247]
    ds_read_b64_tr_b16 a[190:191], v15 offset:45056
    v_mfma_f32_16x16x32_bf16 v[152:155], a[152:155], a[0:3], v[152:155]
    v_mfma_f32_16x16x32_bf16 v[184:187], a[152:155], a[4:7], v[184:187]
    v_mfma_f32_16x16x32_bf16 v[216:219], a[152:155], a[8:11], v[216:219]
    buffer_load_dwordx4 v18, s[52:55], s83 offen offset:1024 lds
    v_mfma_f32_16x16x32_bf16 v[248:251], a[152:155], a[12:15], v[248:251]
    s_waitcnt lgkmcnt(15)
    v_mfma_f32_16x16x32_bf16 v[156:159], a[156:159], a[0:3], v[156:159]
    v_mfma_f32_16x16x32_bf16 v[188:191], a[156:159], a[4:7], v[188:191]
    v_mfma_f32_16x16x32_bf16 v[220:223], a[156:159], a[8:11], v[220:223]
    v_mfma_f32_16x16x32_bf16 v[252:255], a[156:159], a[12:15], v[252:255]
    s_waitcnt lgkmcnt(14)
    v_mfma_f32_16x16x32_bf16 v[128:131], a[160:163], a[16:19], v[128:131]
    buffer_load_dwordx4 a[0:3], v16, s[56:59], s69 offen offset:0 sc1
    v_mfma_f32_16x16x32_bf16 v[160:163], a[160:163], a[20:23], v[160:163]
    ds_read_b64_tr_b16 a[128:129], v8 offset:49152
    v_mfma_f32_16x16x32_bf16 v[192:195], a[160:163], a[24:27], v[192:195]
    ds_read_b64_tr_b16 a[130:131], v8 offset:53248
    buffer_load_dwordx4 a[4:7], v16, s[56:59], s69 offen offset:1024 sc1
    v_mfma_f32_16x16x32_bf16 v[224:227], a[160:163], a[28:31], v[224:227]
    s_waitcnt lgkmcnt(14)
    v_mfma_f32_16x16x32_bf16 v[132:135], a[164:167], a[16:19], v[132:135]
    ds_read_b64_tr_b16 a[132:133], v9 offset:49152
    buffer_load_dwordx4 a[8:11], v16, s[56:59], s69 offen offset:2048 sc1
    v_mfma_f32_16x16x32_bf16 v[164:167], a[164:167], a[20:23], v[164:167]
    ds_read_b64_tr_b16 a[134:135], v9 offset:53248
    v_mfma_f32_16x16x32_bf16 v[196:199], a[164:167], a[24:27], v[196:199]
    buffer_load_dwordx4 a[12:15], v16, s[56:59], s69 offen offset:3072 sc1
    v_mfma_f32_16x16x32_bf16 v[228:231], a[164:167], a[28:31], v[228:231]
    ds_read_b64_tr_b16 a[136:137], v10 offset:49152
    s_waitcnt lgkmcnt(15)
    v_mfma_f32_16x16x32_bf16 v[136:139], a[168:171], a[16:19], v[136:139]
    ds_read_b64_tr_b16 a[138:139], v10 offset:53248
    s_add_u32 s69, s69, 4096
    v_mfma_f32_16x16x32_bf16 v[168:171], a[168:171], a[20:23], v[168:171]
    v_mfma_f32_16x16x32_bf16 v[200:203], a[168:171], a[24:27], v[200:203]
    ds_read_b64_tr_b16 a[140:141], v11 offset:49152
    v_mfma_f32_16x16x32_bf16 v[232:235], a[168:171], a[28:31], v[232:235]
    ds_read_b64_tr_b16 a[142:143], v11 offset:53248
    s_mov_b32 s82, 655360
    s_add_u32 m0, s3, 147456
    s_waitcnt lgkmcnt(15)
    v_mfma_f32_16x16x32_bf16 v[140:143], a[172:175], a[16:19], v[140:143]
    buffer_load_dwordx4 v17, s[52:55], s82 offen lds
    v_mfma_f32_16x16x32_bf16 v[172:175], a[172:175], a[20:23], v[172:175]
    ds_read_b64_tr_b16 a[144:145], v12 offset:49152
    v_mfma_f32_16x16x32_bf16 v[204:207], a[172:175], a[24:27], v[204:207]
    ds_read_b64_tr_b16 a[146:147], v12 offset:53248
    v_mfma_f32_16x16x32_bf16 v[236:239], a[172:175], a[28:31], v[236:239]
    s_waitcnt lgkmcnt(15)
    v_mfma_f32_16x16x32_bf16 v[144:147], a[176:179], a[16:19], v[144:147]
    ds_read_b64_tr_b16 a[148:149], v13 offset:49152
    buffer_load_dwordx4 v18, s[52:55], s82 offen offset:1024 lds
    v_mfma_f32_16x16x32_bf16 v[176:179], a[176:179], a[20:23], v[176:179]
    ds_read_b64_tr_b16 a[150:151], v13 offset:53248
    v_mfma_f32_16x16x32_bf16 v[208:211], a[176:179], a[24:27], v[208:211]
    v_mfma_f32_16x16x32_bf16 v[240:243], a[176:179], a[28:31], v[240:243]
    ds_read_b64_tr_b16 a[152:153], v14 offset:49152
    s_waitcnt lgkmcnt(15)
    v_mfma_f32_16x16x32_bf16 v[148:151], a[180:183], a[16:19], v[148:151]
    ds_read_b64_tr_b16 a[154:155], v14 offset:53248
    v_mfma_f32_16x16x32_bf16 v[180:183], a[180:183], a[20:23], v[180:183]
    s_mov_b32 s83, 720896
    s_add_u32 m0, s3, 155648
    v_mfma_f32_16x16x32_bf16 v[212:215], a[180:183], a[24:27], v[212:215]
    ds_read_b64_tr_b16 a[156:157], v15 offset:49152
    buffer_load_dwordx4 v17, s[52:55], s83 offen lds
    v_mfma_f32_16x16x32_bf16 v[244:247], a[180:183], a[28:31], v[244:247]
    ds_read_b64_tr_b16 a[158:159], v15 offset:53248
    v_mfma_f32_16x16x32_bf16 v[152:155], a[184:187], a[16:19], v[152:155]
    v_mfma_f32_16x16x32_bf16 v[184:187], a[184:187], a[20:23], v[184:187]
    v_mfma_f32_16x16x32_bf16 v[216:219], a[184:187], a[24:27], v[216:219]
    buffer_load_dwordx4 v18, s[52:55], s83 offen offset:1024 lds
    v_mfma_f32_16x16x32_bf16 v[248:251], a[184:187], a[28:31], v[248:251]
    s_waitcnt lgkmcnt(15)
    v_mfma_f32_16x16x32_bf16 v[156:159], a[188:191], a[16:19], v[156:159]
    v_mfma_f32_16x16x32_bf16 v[188:191], a[188:191], a[20:23], v[188:191]
    v_mfma_f32_16x16x32_bf16 v[220:223], a[188:191], a[24:27], v[220:223]
    v_mfma_f32_16x16x32_bf16 v[252:255], a[188:191], a[28:31], v[252:255]
    s_waitcnt lgkmcnt(14)
    v_mfma_f32_16x16x32_bf16 v[128:131], a[128:131], a[32:35], v[128:131]
    buffer_load_dwordx4 a[16:19], v16, s[56:59], s69 offen offset:0 sc1
    v_mfma_f32_16x16x32_bf16 v[160:163], a[128:131], a[36:39], v[160:163]
    ds_read_b64_tr_b16 a[160:161], v8 offset:57344
    v_mfma_f32_16x16x32_bf16 v[192:195], a[128:131], a[40:43], v[192:195]
    ds_read_b64_tr_b16 a[162:163], v8 offset:61440
    buffer_load_dwordx4 a[20:23], v16, s[56:59], s69 offen offset:1024 sc1
    v_mfma_f32_16x16x32_bf16 v[224:227], a[128:131], a[44:47], v[224:227]
    s_waitcnt lgkmcnt(14)
    v_mfma_f32_16x16x32_bf16 v[132:135], a[132:135], a[32:35], v[132:135]
    ds_read_b64_tr_b16 a[164:165], v9 offset:57344
    buffer_load_dwordx4 a[24:27], v16, s[56:59], s69 offen offset:2048 sc1
    v_mfma_f32_16x16x32_bf16 v[164:167], a[132:135], a[36:39], v[164:167]
    ds_read_b64_tr_b16 a[166:167], v9 offset:61440
    v_mfma_f32_16x16x32_bf16 v[196:199], a[132:135], a[40:43], v[196:199]
    buffer_load_dwordx4 a[28:31], v16, s[56:59], s69 offen offset:3072 sc1
    v_mfma_f32_16x16x32_bf16 v[228:231], a[132:135], a[44:47], v[228:231]
    ds_read_b64_tr_b16 a[168:169], v10 offset:57344
    s_waitcnt lgkmcnt(15)
    v_mfma_f32_16x16x32_bf16 v[136:139], a[136:139], a[32:35], v[136:139]
    ds_read_b64_tr_b16 a[170:171], v10 offset:61440
    s_add_u32 s69, s69, 4096
    v_mfma_f32_16x16x32_bf16 v[168:171], a[136:139], a[36:39], v[168:171]
    v_mfma_f32_16x16x32_bf16 v[200:203], a[136:139], a[40:43], v[200:203]
    ds_read_b64_tr_b16 a[172:173], v11 offset:57344
    v_mfma_f32_16x16x32_bf16 v[232:235], a[136:139], a[44:47], v[232:235]
    ds_read_b64_tr_b16 a[174:175], v11 offset:61440
    s_mov_b32 s82, 786432
    s_add_u32 m0, s3, 0
    s_waitcnt lgkmcnt(15)
    v_mfma_f32_16x16x32_bf16 v[140:143], a[140:143], a[32:35], v[140:143]
    buffer_load_dwordx4 v17, s[52:55], s82 offen lds
    v_mfma_f32_16x16x32_bf16 v[172:175], a[140:143], a[36:39], v[172:175]
    ds_read_b64_tr_b16 a[176:177], v12 offset:57344
    v_mfma_f32_16x16x32_bf16 v[204:207], a[140:143], a[40:43], v[204:207]
    ds_read_b64_tr_b16 a[178:179], v12 offset:61440
    v_mfma_f32_16x16x32_bf16 v[236:239], a[140:143], a[44:47], v[236:239]
    s_waitcnt lgkmcnt(15)
    v_mfma_f32_16x16x32_bf16 v[144:147], a[144:147], a[32:35], v[144:147]
    ds_read_b64_tr_b16 a[180:181], v13 offset:57344
    buffer_load_dwordx4 v18, s[52:55], s82 offen offset:1024 lds
    v_mfma_f32_16x16x32_bf16 v[176:179], a[144:147], a[36:39], v[176:179]
    ds_read_b64_tr_b16 a[182:183], v13 offset:61440
    v_mfma_f32_16x16x32_bf16 v[208:211], a[144:147], a[40:43], v[208:211]
    v_mfma_f32_16x16x32_bf16 v[240:243], a[144:147], a[44:47], v[240:243]
    ds_read_b64_tr_b16 a[184:185], v14 offset:57344
    s_waitcnt lgkmcnt(15)
    v_mfma_f32_16x16x32_bf16 v[148:151], a[148:151], a[32:35], v[148:151]
    ds_read_b64_tr_b16 a[186:187], v14 offset:61440
    v_mfma_f32_16x16x32_bf16 v[180:183], a[148:151], a[36:39], v[180:183]
    s_mov_b32 s83, 851968
    s_add_u32 m0, s3, 8192
    v_mfma_f32_16x16x32_bf16 v[212:215], a[148:151], a[40:43], v[212:215]
    ds_read_b64_tr_b16 a[188:189], v15 offset:57344
    buffer_load_dwordx4 v17, s[52:55], s83 offen lds
    v_mfma_f32_16x16x32_bf16 v[244:247], a[148:151], a[44:47], v[244:247]
    ds_read_b64_tr_b16 a[190:191], v15 offset:61440
    v_mfma_f32_16x16x32_bf16 v[152:155], a[152:155], a[32:35], v[152:155]
    v_mfma_f32_16x16x32_bf16 v[184:187], a[152:155], a[36:39], v[184:187]
    v_mfma_f32_16x16x32_bf16 v[216:219], a[152:155], a[40:43], v[216:219]
    buffer_load_dwordx4 v18, s[52:55], s83 offen offset:1024 lds
    v_mfma_f32_16x16x32_bf16 v[248:251], a[152:155], a[44:47], v[248:251]
    s_waitcnt lgkmcnt(15)
    v_mfma_f32_16x16x32_bf16 v[156:159], a[156:159], a[32:35], v[156:159]
    v_mfma_f32_16x16x32_bf16 v[188:191], a[156:159], a[36:39], v[188:191]
    v_mfma_f32_16x16x32_bf16 v[220:223], a[156:159], a[40:43], v[220:223]
    v_mfma_f32_16x16x32_bf16 v[252:255], a[156:159], a[44:47], v[252:255]
    s_waitcnt vmcnt(38) lgkmcnt(14)
    v_mfma_f32_16x16x32_bf16 v[160:163], a[160:163], a[52:55], v[160:163]
    buffer_load_dwordx4 a[32:35], v16, s[56:59], s69 offen offset:0 sc1
    s_waitcnt lgkmcnt(12)
    v_mfma_f32_16x16x32_bf16 v[164:167], a[164:167], a[52:55], v[164:167]
    ds_read_b64_tr_b16 a[128:129], v48 offset:0
    s_waitcnt lgkmcnt(11)
    v_mfma_f32_16x16x32_bf16 v[168:171], a[168:171], a[52:55], v[168:171]
    ds_read_b64_tr_b16 a[130:131], v48 offset:4096
    buffer_load_dwordx4 a[36:39], v16, s[56:59], s69 offen offset:1024 sc1
    s_waitcnt lgkmcnt(10)
    v_mfma_f32_16x16x32_bf16 v[172:175], a[172:175], a[52:55], v[172:175]
    ds_read_b64_tr_b16 a[132:133], v49 offset:0
    s_waitcnt lgkmcnt(9)
    v_mfma_f32_16x16x32_bf16 v[176:179], a[176:179], a[52:55], v[176:179]
    ds_read_b64_tr_b16 a[134:135], v49 offset:4096
    buffer_load_dwordx4 a[40:43], v16, s[56:59], s69 offen offset:2048 sc1
    s_waitcnt lgkmcnt(8)
    v_mfma_f32_16x16x32_bf16 v[180:183], a[180:183], a[52:55], v[180:183]
    ds_read_b64_tr_b16 a[136:137], v50 offset:0
    s_waitcnt lgkmcnt(7)
    v_mfma_f32_16x16x32_bf16 v[184:187], a[184:187], a[52:55], v[184:187]
    ds_read_b64_tr_b16 a[138:139], v50 offset:4096
    buffer_load_dwordx4 a[44:47], v16, s[56:59], s69 offen offset:3072 sc1
    s_waitcnt lgkmcnt(6)
    v_mfma_f32_16x16x32_bf16 v[188:191], a[188:191], a[52:55], v[188:191]
    ds_read_b64_tr_b16 a[140:141], v51 offset:0
    s_waitcnt vmcnt(41)
    v_mfma_f32_16x16x32_bf16 v[192:195], a[160:163], a[56:59], v[192:195]
    ds_read_b64_tr_b16 a[142:143], v51 offset:4096
    s_add_u32 s69, s69, 4096
    v_mfma_f32_16x16x32_bf16 v[196:199], a[164:167], a[56:59], v[196:199]
    ds_read_b64_tr_b16 a[144:145], v52 offset:0
    v_mfma_f32_16x16x32_bf16 v[200:203], a[168:171], a[56:59], v[200:203]
    ds_read_b64_tr_b16 a[146:147], v52 offset:4096
    v_mfma_f32_16x16x32_bf16 v[204:207], a[172:175], a[56:59], v[204:207]
    ds_read_b64_tr_b16 a[148:149], v53 offset:0
    s_mov_b32 s82, 917504
    s_add_u32 m0, s3, 16384
    v_mfma_f32_16x16x32_bf16 v[208:211], a[176:179], a[56:59], v[208:211]
    ds_read_b64_tr_b16 a[150:151], v53 offset:4096
    buffer_load_dwordx4 v17, s[52:55], s82 offen lds
    v_cvt_pk_bf16_f32 v160, v160, v161
    v_cvt_pk_bf16_f32 v161, v162, v163
    v_mfma_f32_16x16x32_bf16 v[212:215], a[180:183], a[56:59], v[212:215]
    ds_read_b64_tr_b16 a[152:153], v54 offset:0
    v_cvt_pk_bf16_f32 v162, v164, v165
    v_cvt_pk_bf16_f32 v163, v166, v167
    v_mfma_f32_16x16x32_bf16 v[216:219], a[184:187], a[56:59], v[216:219]
    ds_read_b64_tr_b16 a[154:155], v54 offset:4096
    buffer_store_dwordx4 v[160:163], v16, s[56:59], s70 offen offset:0 sc1
    v_cvt_pk_bf16_f32 v168, v168, v169
    v_mfma_f32_16x16x32_bf16 v[220:223], a[188:191], a[56:59], v[220:223]
    v_cvt_pk_bf16_f32 v169, v170, v171
    v_cvt_pk_bf16_f32 v170, v172, v173
    s_waitcnt vmcnt(42)
    v_mfma_f32_16x16x32_bf16 v[224:227], a[160:163], a[60:63], v[224:227]
    buffer_load_dwordx4 v18, s[52:55], s82 offen offset:1024 lds
    v_cvt_pk_bf16_f32 v171, v174, v175
    buffer_store_dwordx4 v[168:171], v16, s[56:59], s70 offen offset:1024 sc1
    v_mfma_f32_16x16x32_bf16 v[228:231], a[164:167], a[60:63], v[228:231]
    v_cvt_pk_bf16_f32 v176, v176, v177
    v_cvt_pk_bf16_f32 v177, v178, v179
    v_mfma_f32_16x16x32_bf16 v[232:235], a[168:171], a[60:63], v[232:235]
    v_cvt_pk_bf16_f32 v178, v180, v181
    v_cvt_pk_bf16_f32 v179, v182, v183
    v_mfma_f32_16x16x32_bf16 v[236:239], a[172:175], a[60:63], v[236:239]
    buffer_store_dwordx4 v[176:179], v16, s[56:59], s70 offen offset:2048 sc1
    v_cvt_pk_bf16_f32 v184, v184, v185
    v_mfma_f32_16x16x32_bf16 v[240:243], a[176:179], a[60:63], v[240:243]
    v_cvt_pk_bf16_f32 v185, v186, v187
    v_cvt_pk_bf16_f32 v186, v188, v189
    v_mfma_f32_16x16x32_bf16 v[244:247], a[180:183], a[60:63], v[244:247]
    s_mov_b32 s83, 983040
    s_add_u32 m0, s3, 24576
    v_cvt_pk_bf16_f32 v187, v190, v191
    buffer_store_dwordx4 v[184:187], v16, s[56:59], s70 offen offset:3072 sc1
    v_mfma_f32_16x16x32_bf16 v[248:251], a[184:187], a[60:63], v[248:251]
    buffer_load_dwordx4 v17, s[52:55], s83 offen lds
    v_cvt_pk_bf16_f32 v192, v192, v193
    v_cvt_pk_bf16_f32 v193, v194, v195
    v_mfma_f32_16x16x32_bf16 v[252:255], a[188:191], a[60:63], v[252:255]
    v_cvt_pk_bf16_f32 v194, v196, v197
    v_cvt_pk_bf16_f32 v195, v198, v199
    v_mfma_f32_16x16x32_bf16 v[128:131], a[160:163], a[48:51], v[128:131]
    buffer_store_dwordx4 v[192:195], v16, s[56:59], s71 offen offset:0 sc1
    v_cvt_pk_bf16_f32 v200, v200, v201
    v_mfma_f32_16x16x32_bf16 v[132:135], a[164:167], a[48:51], v[132:135]
    v_cvt_pk_bf16_f32 v201, v202, v203
    v_cvt_pk_bf16_f32 v202, v204, v205
    v_mfma_f32_16x16x32_bf16 v[136:139], a[168:171], a[48:51], v[136:139]
    buffer_load_dwordx4 v18, s[52:55], s83 offen offset:1024 lds
    v_cvt_pk_bf16_f32 v203, v206, v207
    buffer_store_dwordx4 v[200:203], v16, s[56:59], s71 offen offset:1024 sc1
    v_mfma_f32_16x16x32_bf16 v[140:143], a[172:175], a[48:51], v[140:143]
    v_cvt_pk_bf16_f32 v208, v208, v209
    v_cvt_pk_bf16_f32 v209, v210, v211
    v_mfma_f32_16x16x32_bf16 v[144:147], a[176:179], a[48:51], v[144:147]
    v_cvt_pk_bf16_f32 v210, v212, v213
    v_cvt_pk_bf16_f32 v211, v214, v215
    v_mfma_f32_16x16x32_bf16 v[148:151], a[180:183], a[48:51], v[148:151]
    buffer_store_dwordx4 v[208:211], v16, s[56:59], s71 offen offset:2048 sc1
    v_cvt_pk_bf16_f32 v216, v216, v217
    v_mfma_f32_16x16x32_bf16 v[152:155], a[184:187], a[48:51], v[152:155]
    v_cvt_pk_bf16_f32 v217, v218, v219
    v_cvt_pk_bf16_f32 v218, v220, v221
    v_mfma_f32_16x16x32_bf16 v[156:159], a[188:191], a[48:51], v[156:159]
    v_cvt_pk_bf16_f32 v219, v222, v223
    buffer_store_dwordx4 v[216:219], v16, s[56:59], s71 offen offset:3072 sc1
    s_barrier
    buffer_load_dwordx4 a[48:51], v16, s[56:59], s69 offen offset:0 sc1
    buffer_load_dwordx4 a[52:55], v16, s[56:59], s69 offen offset:1024 sc1
    buffer_load_dwordx4 a[56:59], v16, s[56:59], s69 offen offset:2048 sc1
    buffer_load_dwordx4 a[60:63], v16, s[56:59], s69 offen offset:3072 sc1
    s_add_u32 s69, s69, 4096
    s_waitcnt vmcnt(55) lgkmcnt(12)
    v_mfma_f32_16x16x32_bf16 v[96:99], a[128:131], a[64:67], 0
    ds_read_b64_tr_b16 a[156:157], v55 offset:0
    ds_read_b64_tr_b16 a[158:159], v55 offset:4096
    v_cvt_pk_bf16_f32 v224, v224, v225
    v_cvt_pk_bf16_f32 v225, v226, v227
    s_waitcnt lgkmcnt(12)
    v_mfma_f32_16x16x32_bf16 v[100:103], a[132:135], a[64:67], 0
    ds_read_b64_tr_b16 a[160:161], v48 offset:8192
    ds_read_b64_tr_b16 a[162:163], v48 offset:12288
    v_cvt_pk_bf16_f32 v226, v228, v229
    v_cvt_pk_bf16_f32 v227, v230, v231
    s_waitcnt lgkmcnt(12)
    v_mfma_f32_16x16x32_bf16 v[104:107], a[136:139], a[64:67], 0
    ds_read_b64_tr_b16 a[164:165], v49 offset:8192
    ds_read_b64_tr_b16 a[166:167], v49 offset:12288
    buffer_store_dwordx4 v[224:227], v16, s[56:59], s72 offen offset:0 sc1
    v_cvt_pk_bf16_f32 v232, v232, v233
    s_waitcnt lgkmcnt(12)
    v_mfma_f32_16x16x32_bf16 v[108:111], a[140:143], a[64:67], 0
    ds_read_b64_tr_b16 a[168:169], v50 offset:8192
    ds_read_b64_tr_b16 a[170:171], v50 offset:12288
    v_cvt_pk_bf16_f32 v233, v234, v235
    v_cvt_pk_bf16_f32 v234, v236, v237
    s_waitcnt lgkmcnt(12)
    v_mfma_f32_16x16x32_bf16 v[112:115], a[144:147], a[64:67], 0
    ds_read_b64_tr_b16 a[172:173], v51 offset:8192
    ds_read_b64_tr_b16 a[174:175], v51 offset:12288
    v_cvt_pk_bf16_f32 v235, v238, v239
    buffer_store_dwordx4 v[232:235], v16, s[56:59], s72 offen offset:1024 sc1
    s_waitcnt lgkmcnt(12)
    v_mfma_f32_16x16x32_bf16 v[116:119], a[148:151], a[64:67], 0
    ds_read_b64_tr_b16 a[176:177], v52 offset:8192
    ds_read_b64_tr_b16 a[178:179], v52 offset:12288
    v_cvt_pk_bf16_f32 v240, v240, v241
    v_cvt_pk_bf16_f32 v241, v242, v243
    s_waitcnt lgkmcnt(12)
    v_mfma_f32_16x16x32_bf16 v[120:123], a[152:155], a[64:67], 0
    ds_read_b64_tr_b16 a[180:181], v53 offset:8192
    ds_read_b64_tr_b16 a[182:183], v53 offset:12288
    v_cvt_pk_bf16_f32 v242, v244, v245
    v_cvt_pk_bf16_f32 v243, v246, v247
    s_waitcnt lgkmcnt(12)
    v_mfma_f32_16x16x32_bf16 v[124:127], a[156:159], a[64:67], 0
    ds_read_b64_tr_b16 a[184:185], v54 offset:8192
    ds_read_b64_tr_b16 a[186:187], v54 offset:12288
    buffer_store_dwordx4 v[240:243], v16, s[56:59], s72 offen offset:2048 sc1
    v_cvt_pk_bf16_f32 v248, v248, v249
    s_waitcnt vmcnt(57) lgkmcnt(12)
    v_mfma_f32_16x16x32_bf16 v[96:99], a[160:163], a[68:71], v[96:99]
    ds_read_b64_tr_b16 a[188:189], v55 offset:8192
    ds_read_b64_tr_b16 a[190:191], v55 offset:12288
    v_cvt_pk_bf16_f32 v249, v250, v251
    v_cvt_pk_bf16_f32 v250, v252, v253
    s_waitcnt lgkmcnt(12)
    v_mfma_f32_16x16x32_bf16 v[100:103], a[164:167], a[68:71], v[100:103]
    ds_read_b64_tr_b16 a[128:129], v48 offset:16384
    ds_read_b64_tr_b16 a[130:131], v48 offset:20480
    v_cvt_pk_bf16_f32 v251, v254, v255
    buffer_store_dwordx4 v[248:251], v16, s[56:59], s72 offen offset:3072 sc1
    s_waitcnt lgkmcnt(12)
    v_mfma_f32_16x16x32_bf16 v[104:107], a[168:171], a[68:71], v[104:107]
    ds_read_b64_tr_b16 a[132:133], v49 offset:16384
    ds_read_b64_tr_b16 a[134:135], v49 offset:20480
    s_mov_b32 s82, 1048576
    s_add_u32 m0, s3, 32768
    s_nop 0
    buffer_load_dwordx4 v17, s[52:55], s82 offen lds
    s_waitcnt lgkmcnt(12)
    v_mfma_f32_16x16x32_bf16 v[108:111], a[172:175], a[68:71], v[108:111]
    ds_read_b64_tr_b16 a[136:137], v50 offset:16384
    ds_read_b64_tr_b16 a[138:139], v50 offset:20480
    s_waitcnt lgkmcnt(12)
    v_mfma_f32_16x16x32_bf16 v[112:115], a[176:179], a[68:71], v[112:115]
    ds_read_b64_tr_b16 a[140:141], v51 offset:16384
    ds_read_b64_tr_b16 a[142:143], v51 offset:20480
    s_waitcnt lgkmcnt(12)
    v_mfma_f32_16x16x32_bf16 v[116:119], a[180:183], a[68:71], v[116:119]
    ds_read_b64_tr_b16 a[144:145], v52 offset:16384
    ds_read_b64_tr_b16 a[146:147], v52 offset:20480
    buffer_load_dwordx4 v18, s[52:55], s82 offen offset:1024 lds
    s_waitcnt lgkmcnt(12)
    v_mfma_f32_16x16x32_bf16 v[120:123], a[184:187], a[68:71], v[120:123]
    ds_read_b64_tr_b16 a[148:149], v53 offset:16384
    ds_read_b64_tr_b16 a[150:151], v53 offset:20480
    s_waitcnt lgkmcnt(12)
    v_mfma_f32_16x16x32_bf16 v[124:127], a[188:191], a[68:71], v[124:127]
    ds_read_b64_tr_b16 a[152:153], v54 offset:16384
    ds_read_b64_tr_b16 a[154:155], v54 offset:20480
    s_waitcnt vmcnt(59) lgkmcnt(12)
    v_mfma_f32_16x16x32_bf16 v[96:99], a[128:131], a[72:75], v[96:99]
    ds_read_b64_tr_b16 a[156:157], v55 offset:16384
    ds_read_b64_tr_b16 a[158:159], v55 offset:20480
    s_mov_b32 s83, 1114112
    s_add_u32 m0, s3, 40960
    s_nop 0
    buffer_load_dwordx4 v17, s[52:55], s83 offen lds
    s_waitcnt lgkmcnt(12)
    v_mfma_f32_16x16x32_bf16 v[100:103], a[132:135], a[72:75], v[100:103]
    ds_read_b64_tr_b16 a[160:161], v48 offset:24576
    ds_read_b64_tr_b16 a[162:163], v48 offset:28672
    s_waitcnt lgkmcnt(12)
    v_mfma_f32_16x16x32_bf16 v[104:107], a[136:139], a[72:75], v[104:107]
    ds_read_b64_tr_b16 a[164:165], v49 offset:24576
    ds_read_b64_tr_b16 a[166:167], v49 offset:28672
    s_waitcnt lgkmcnt(12)
    v_mfma_f32_16x16x32_bf16 v[108:111], a[140:143], a[72:75], v[108:111]
    ds_read_b64_tr_b16 a[168:169], v50 offset:24576
    ds_read_b64_tr_b16 a[170:171], v50 offset:28672
    buffer_load_dwordx4 v18, s[52:55], s83 offen offset:1024 lds
    s_waitcnt lgkmcnt(12)
    v_mfma_f32_16x16x32_bf16 v[112:115], a[144:147], a[72:75], v[112:115]
    ds_read_b64_tr_b16 a[172:173], v51 offset:24576
    ds_read_b64_tr_b16 a[174:175], v51 offset:28672
    s_waitcnt lgkmcnt(12)
    v_mfma_f32_16x16x32_bf16 v[116:119], a[148:151], a[72:75], v[116:119]
    ds_read_b64_tr_b16 a[176:177], v52 offset:24576
    ds_read_b64_tr_b16 a[178:179], v52 offset:28672
    s_waitcnt lgkmcnt(12)
    v_mfma_f32_16x16x32_bf16 v[120:123], a[152:155], a[72:75], v[120:123]
    ds_read_b64_tr_b16 a[180:181], v53 offset:24576
    ds_read_b64_tr_b16 a[182:183], v53 offset:28672
    s_mov_b32 s82, 1179648
    s_add_u32 m0, s3, 49152
    s_nop 0
    buffer_load_dwordx4 v17, s[52:55], s82 offen lds
    s_waitcnt lgkmcnt(12)
    v_mfma_f32_16x16x32_bf16 v[124:127], a[156:159], a[72:75], v[124:127]
    ds_read_b64_tr_b16 a[184:185], v54 offset:24576
    ds_read_b64_tr_b16 a[186:187], v54 offset:28672
    s_waitcnt vmcnt(61) lgkmcnt(12)
    v_mfma_f32_16x16x32_bf16 v[96:99], a[160:163], a[76:79], v[96:99]
    ds_read_b64_tr_b16 a[188:189], v55 offset:24576
    ds_read_b64_tr_b16 a[190:191], v55 offset:28672
    s_waitcnt lgkmcnt(12)
    v_mfma_f32_16x16x32_bf16 v[100:103], a[164:167], a[76:79], v[100:103]
    ds_read_b64_tr_b16 a[128:129], v48 offset:32768
    ds_read_b64_tr_b16 a[130:131], v48 offset:36864
    buffer_load_dwordx4 v18, s[52:55], s82 offen offset:1024 lds
    s_waitcnt lgkmcnt(12)
    v_mfma_f32_16x16x32_bf16 v[104:107], a[168:171], a[76:79], v[104:107]
    ds_read_b64_tr_b16 a[132:133], v49 offset:32768
    ds_read_b64_tr_b16 a[134:135], v49 offset:36864
    s_waitcnt lgkmcnt(12)
    v_mfma_f32_16x16x32_bf16 v[108:111], a[172:175], a[76:79], v[108:111]
    ds_read_b64_tr_b16 a[136:137], v50 offset:32768
    ds_read_b64_tr_b16 a[138:139], v50 offset:36864
    s_waitcnt lgkmcnt(12)
    v_mfma_f32_16x16x32_bf16 v[112:115], a[176:179], a[76:79], v[112:115]
    ds_read_b64_tr_b16 a[140:141], v51 offset:32768
    ds_read_b64_tr_b16 a[142:143], v51 offset:36864
    s_mov_b32 s83, 1245184
    s_add_u32 m0, s3, 57344
    s_nop 0
    buffer_load_dwordx4 v17, s[52:55], s83 offen lds
    s_waitcnt lgkmcnt(12)
    v_mfma_f32_16x16x32_bf16 v[116:119], a[180:183], a[76:79], v[116:119]
    ds_read_b64_tr_b16 a[144:145], v52 offset:32768
    ds_read_b64_tr_b16 a[146:147], v52 offset:36864
    s_waitcnt lgkmcnt(12)
    v_mfma_f32_16x16x32_bf16 v[120:123], a[184:187], a[76:79], v[120:123]
    ds_read_b64_tr_b16 a[148:149], v53 offset:32768
    ds_read_b64_tr_b16 a[150:151], v53 offset:36864
    s_waitcnt lgkmcnt(12)
    v_mfma_f32_16x16x32_bf16 v[124:127], a[188:191], a[76:79], v[124:127]
    ds_read_b64_tr_b16 a[152:153], v54 offset:32768
    ds_read_b64_tr_b16 a[154:155], v54 offset:36864
    buffer_load_dwordx4 v18, s[52:55], s83 offen offset:1024 lds
    s_waitcnt vmcnt(63) lgkmcnt(12)
    v_mfma_f32_16x16x32_bf16 v[96:99], a[128:131], a[80:83], v[96:99]
    ds_read_b64_tr_b16 a[156:157], v55 offset:32768
    ds_read_b64_tr_b16 a[158:159], v55 offset:36864
    s_waitcnt lgkmcnt(12)
    v_mfma_f32_16x16x32_bf16 v[100:103], a[132:135], a[80:83], v[100:103]
    ds_read_b64_tr_b16 a[160:161], v48 offset:40960
    ds_read_b64_tr_b16 a[162:163], v48 offset:45056
    s_waitcnt lgkmcnt(12)
    v_mfma_f32_16x16x32_bf16 v[104:107], a[136:139], a[80:83], v[104:107]
    ds_read_b64_tr_b16 a[164:165], v49 offset:40960
    ds_read_b64_tr_b16 a[166:167], v49 offset:45056
    s_waitcnt lgkmcnt(12)
    v_mfma_f32_16x16x32_bf16 v[108:111], a[140:143], a[80:83], v[108:111]
    ds_read_b64_tr_b16 a[168:169], v50 offset:40960
    ds_read_b64_tr_b16 a[170:171], v50 offset:45056
    s_waitcnt lgkmcnt(12)
    v_mfma_f32_16x16x32_bf16 v[112:115], a[144:147], a[80:83], v[112:115]
    ds_read_b64_tr_b16 a[172:173], v51 offset:40960
    ds_read_b64_tr_b16 a[174:175], v51 offset:45056
    s_waitcnt lgkmcnt(12)
    v_mfma_f32_16x16x32_bf16 v[116:119], a[148:151], a[80:83], v[116:119]
    ds_read_b64_tr_b16 a[176:177], v52 offset:40960
    ds_read_b64_tr_b16 a[178:179], v52 offset:45056
    s_waitcnt lgkmcnt(12)
    v_mfma_f32_16x16x32_bf16 v[120:123], a[152:155], a[80:83], v[120:123]
    ds_read_b64_tr_b16 a[180:181], v53 offset:40960
    ds_read_b64_tr_b16 a[182:183], v53 offset:45056
    s_waitcnt lgkmcnt(12)
    v_mfma_f32_16x16x32_bf16 v[124:127], a[156:159], a[80:83], v[124:127]
    ds_read_b64_tr_b16 a[184:185], v54 offset:40960
    ds_read_b64_tr_b16 a[186:187], v54 offset:45056
    s_waitcnt vmcnt(62) lgkmcnt(12)
    v_mfma_f32_16x16x32_bf16 v[96:99], a[160:163], a[84:87], v[96:99]
    ds_read_b64_tr_b16 a[188:189], v55 offset:40960
    ds_read_b64_tr_b16 a[190:191], v55 offset:45056
    s_waitcnt lgkmcnt(12)
    v_mfma_f32_16x16x32_bf16 v[100:103], a[164:167], a[84:87], v[100:103]
    ds_read_b64_tr_b16 a[128:129], v48 offset:49152
    ds_read_b64_tr_b16 a[130:131], v48 offset:53248
    s_waitcnt lgkmcnt(12)
    v_mfma_f32_16x16x32_bf16 v[104:107], a[168:171], a[84:87], v[104:107]
    ds_read_b64_tr_b16 a[132:133], v49 offset:49152
    ds_read_b64_tr_b16 a[134:135], v49 offset:53248
    s_waitcnt lgkmcnt(12)
    v_mfma_f32_16x16x32_bf16 v[108:111], a[172:175], a[84:87], v[108:111]
    ds_read_b64_tr_b16 a[136:137], v50 offset:49152
    ds_read_b64_tr_b16 a[138:139], v50 offset:53248
    s_waitcnt lgkmcnt(12)
    v_mfma_f32_16x16x32_bf16 v[112:115], a[176:179], a[84:87], v[112:115]
    ds_read_b64_tr_b16 a[140:141], v51 offset:49152
    ds_read_b64_tr_b16 a[142:143], v51 offset:53248
    s_waitcnt lgkmcnt(12)
    v_mfma_f32_16x16x32_bf16 v[116:119], a[180:183], a[84:87], v[116:119]
    ds_read_b64_tr_b16 a[144:145], v52 offset:49152
    ds_read_b64_tr_b16 a[146:147], v52 offset:53248
    s_waitcnt lgkmcnt(12)
    v_mfma_f32_16x16x32_bf16 v[120:123], a[184:187], a[84:87], v[120:123]
    ds_read_b64_tr_b16 a[148:149], v53 offset:49152
    ds_read_b64_tr_b16 a[150:151], v53 offset:53248
    s_waitcnt lgkmcnt(12)
    v_mfma_f32_16x16x32_bf16 v[124:127], a[188:191], a[84:87], v[124:127]
    ds_read_b64_tr_b16 a[152:153], v54 offset:49152
    ds_read_b64_tr_b16 a[154:155], v54 offset:53248
    s_waitcnt vmcnt(19)
    s_barrier
    s_waitcnt lgkmcnt(12)
    v_mfma_f32_16x16x32_bf16 v[96:99], a[128:131], a[88:91], v[96:99]
    ds_read_b64_tr_b16 a[156:157], v55 offset:49152
    ds_read_b64_tr_b16 a[158:159], v55 offset:53248
    s_mov_b32 s82, 1310720
    s_add_u32 m0, s3, 65536
    s_nop 0
    buffer_load_dwordx4 v17, s[52:55], s82 offen lds
    s_waitcnt lgkmcnt(12)
    v_mfma_f32_16x16x32_bf16 v[100:103], a[132:135], a[88:91], v[100:103]
    ds_read_b64_tr_b16 a[160:161], v48 offset:57344
    ds_read_b64_tr_b16 a[162:163], v48 offset:61440
    s_waitcnt lgkmcnt(12)
    v_mfma_f32_16x16x32_bf16 v[104:107], a[136:139], a[88:91], v[104:107]
    ds_read_b64_tr_b16 a[164:165], v49 offset:57344
    ds_read_b64_tr_b16 a[166:167], v49 offset:61440
    s_waitcnt lgkmcnt(12)
    v_mfma_f32_16x16x32_bf16 v[108:111], a[140:143], a[88:91], v[108:111]
    ds_read_b64_tr_b16 a[168:169], v50 offset:57344
    ds_read_b64_tr_b16 a[170:171], v50 offset:61440
    buffer_load_dwordx4 v18, s[52:55], s82 offen offset:1024 lds
    s_waitcnt lgkmcnt(12)
    v_mfma_f32_16x16x32_bf16 v[112:115], a[144:147], a[88:91], v[112:115]
    ds_read_b64_tr_b16 a[172:173], v51 offset:57344
    ds_read_b64_tr_b16 a[174:175], v51 offset:61440
    s_waitcnt lgkmcnt(12)
    v_mfma_f32_16x16x32_bf16 v[116:119], a[148:151], a[88:91], v[116:119]
    ds_read_b64_tr_b16 a[176:177], v52 offset:57344
    ds_read_b64_tr_b16 a[178:179], v52 offset:61440
    s_waitcnt lgkmcnt(12)
    v_mfma_f32_16x16x32_bf16 v[120:123], a[152:155], a[88:91], v[120:123]
    ds_read_b64_tr_b16 a[180:181], v53 offset:57344
    ds_read_b64_tr_b16 a[182:183], v53 offset:61440
    s_mov_b32 s83, 1376256
    s_add_u32 m0, s3, 73728
    s_nop 0
    buffer_load_dwordx4 v17, s[52:55], s83 offen lds
    s_waitcnt lgkmcnt(12)
    v_mfma_f32_16x16x32_bf16 v[124:127], a[156:159], a[88:91], v[124:127]
    ds_read_b64_tr_b16 a[184:185], v54 offset:57344
    ds_read_b64_tr_b16 a[186:187], v54 offset:61440
    s_waitcnt lgkmcnt(12)
    v_mfma_f32_16x16x32_bf16 v[96:99], a[160:163], a[92:95], v[96:99]
    ds_read_b64_tr_b16 a[188:189], v55 offset:57344
    ds_read_b64_tr_b16 a[190:191], v55 offset:61440
    s_waitcnt vmcnt(11)
    s_mov_b64 exec, 1
    buffer_atomic_add v25, off, s[56:59], s77 sc1
    s_mov_b64 exec, -1
    s_waitcnt lgkmcnt(12)
    v_mfma_f32_16x16x32_bf16 v[100:103], a[164:167], a[92:95], v[100:103]
    ds_read_b64_tr_b16 a[128:129], v56 offset:0
    ds_read_b64_tr_b16 a[130:131], v56 offset:4096
    buffer_load_dwordx4 v18, s[52:55], s83 offen offset:1024 lds
    s_waitcnt lgkmcnt(12)
    v_mfma_f32_16x16x32_bf16 v[104:107], a[168:171], a[92:95], v[104:107]
    ds_read_b64_tr_b16 a[132:133], v57 offset:0
    ds_read_b64_tr_b16 a[134:135], v57 offset:4096
    s_waitcnt lgkmcnt(12)
    v_mfma_f32_16x16x32_bf16 v[108:111], a[172:175], a[92:95], v[108:111]
    ds_read_b64_tr_b16 a[136:137], v58 offset:0
    ds_read_b64_tr_b16 a[138:139], v58 offset:4096
    s_waitcnt lgkmcnt(12)
    v_mfma_f32_16x16x32_bf16 v[112:115], a[176:179], a[92:95], v[112:115]
    ds_read_b64_tr_b16 a[140:141], v59 offset:0
    ds_read_b64_tr_b16 a[142:143], v59 offset:4096
    s_mov_b32 s82, 1441792
    s_add_u32 m0, s3, 81920
    s_nop 0
    buffer_load_dwordx4 v17, s[52:55], s82 offen lds
    s_waitcnt lgkmcnt(12)
    v_mfma_f32_16x16x32_bf16 v[116:119], a[180:183], a[92:95], v[116:119]
    ds_read_b64_tr_b16 a[144:145], v60 offset:0
    ds_read_b64_tr_b16 a[146:147], v60 offset:4096
    s_waitcnt lgkmcnt(12)
    v_mfma_f32_16x16x32_bf16 v[120:123], a[184:187], a[92:95], v[120:123]
    ds_read_b64_tr_b16 a[148:149], v61 offset:0
    ds_read_b64_tr_b16 a[150:151], v61 offset:4096
    s_waitcnt lgkmcnt(12)
    v_mfma_f32_16x16x32_bf16 v[124:127], a[188:191], a[92:95], v[124:127]
    ds_read_b64_tr_b16 a[152:153], v62 offset:0
    ds_read_b64_tr_b16 a[154:155], v62 offset:4096
    buffer_load_dwordx4 v18, s[52:55], s82 offen offset:1024 lds
    s_waitcnt lgkmcnt(12)
    v_mfma_f32_16x16x32_bf16 v[96:99], a[128:131], a[96:99], v[96:99]
    ds_read_b64_tr_b16 a[156:157], v63 offset:0
    ds_read_b64_tr_b16 a[158:159], v63 offset:4096
    s_waitcnt lgkmcnt(12)
    v_mfma_f32_16x16x32_bf16 v[100:103], a[132:135], a[96:99], v[100:103]
    ds_read_b64_tr_b16 a[160:161], v56 offset:8192
    ds_read_b64_tr_b16 a[162:163], v56 offset:12288
    s_waitcnt lgkmcnt(12)
    v_mfma_f32_16x16x32_bf16 v[104:107], a[136:139], a[96:99], v[104:107]
    ds_read_b64_tr_b16 a[164:165], v57 offset:8192
    ds_read_b64_tr_b16 a[166:167], v57 offset:12288
    s_mov_b32 s83, 1507328
    s_add_u32 m0, s3, 90112
    s_nop 0
    buffer_load_dwordx4 v17, s[52:55], s83 offen lds
    s_waitcnt lgkmcnt(12)
    v_mfma_f32_16x16x32_bf16 v[108:111], a[140:143], a[96:99], v[108:111]
    ds_read_b64_tr_b16 a[168:169], v58 offset:8192
    ds_read_b64_tr_b16 a[170:171], v58 offset:12288
    s_waitcnt lgkmcnt(12)
    v_mfma_f32_16x16x32_bf16 v[112:115], a[144:147], a[96:99], v[112:115]
    ds_read_b64_tr_b16 a[172:173], v59 offset:8192
    ds_read_b64_tr_b16 a[174:175], v59 offset:12288
    s_waitcnt lgkmcnt(12)
    v_mfma_f32_16x16x32_bf16 v[116:119], a[148:151], a[96:99], v[116:119]
    ds_read_b64_tr_b16 a[176:177], v60 offset:8192
    ds_read_b64_tr_b16 a[178:179], v60 offset:12288
    buffer_load_dwordx4 v18, s[52:55], s83 offen offset:1024 lds
    s_waitcnt lgkmcnt(12)
    v_mfma_f32_16x16x32_bf16 v[120:123], a[152:155], a[96:99], v[120:123]
    ds_read_b64_tr_b16 a[180:181], v61 offset:8192
    ds_read_b64_tr_b16 a[182:183], v61 offset:12288
    s_waitcnt lgkmcnt(12)
    v_mfma_f32_16x16x32_bf16 v[124:127], a[156:159], a[96:99], v[124:127]
    ds_read_b64_tr_b16 a[184:185], v62 offset:8192
    ds_read_b64_tr_b16 a[186:187], v62 offset:12288
    s_waitcnt lgkmcnt(12)
    v_mfma_f32_16x16x32_bf16 v[96:99], a[160:163], a[100:103], v[96:99]
    ds_read_b64_tr_b16 a[188:189], v63 offset:8192
    ds_read_b64_tr_b16 a[190:191], v63 offset:12288
    s_mov_b32 s82, 1572864
    s_add_u32 m0, s3, 98304
    s_nop 0
    buffer_load_dwordx4 v17, s[52:55], s82 offen lds
    s_waitcnt lgkmcnt(12)
    v_mfma_f32_16x16x32_bf16 v[100:103], a[164:167], a[100:103], v[100:103]
    ds_read_b64_tr_b16 a[128:129], v56 offset:16384
    ds_read_b64_tr_b16 a[130:131], v56 offset:20480
    s_waitcnt lgkmcnt(12)
    v_mfma_f32_16x16x32_bf16 v[104:107], a[168:171], a[100:103], v[104:107]
    ds_read_b64_tr_b16 a[132:133], v57 offset:16384
    ds_read_b64_tr_b16 a[134:135], v57 offset:20480
    s_waitcnt lgkmcnt(12)
    v_mfma_f32_16x16x32_bf16 v[108:111], a[172:175], a[100:103], v[108:111]
    ds_read_b64_tr_b16 a[136:137], v58 offset:16384
    ds_read_b64_tr_b16 a[138:139], v58 offset:20480
    buffer_load_dwordx4 v18, s[52:55], s82 offen offset:1024 lds
    s_waitcnt lgkmcnt(12)
    v_mfma_f32_16x16x32_bf16 v[112:115], a[176:179], a[100:103], v[112:115]
    ds_read_b64_tr_b16 a[140:141], v59 offset:16384
    ds_read_b64_tr_b16 a[142:143], v59 offset:20480
    s_waitcnt lgkmcnt(12)
    v_mfma_f32_16x16x32_bf16 v[116:119], a[180:183], a[100:103], v[116:119]
    ds_read_b64_tr_b16 a[144:145], v60 offset:16384
    ds_read_b64_tr_b16 a[146:147], v60 offset:20480
    s_waitcnt lgkmcnt(12)
    v_mfma_f32_16x16x32_bf16 v[120:123], a[184:187], a[100:103], v[120:123]
    ds_read_b64_tr_b16 a[148:149], v61 offset:16384
    ds_read_b64_tr_b16 a[150:151], v61 offset:20480
    s_mov_b32 s83, 1638400
    s_add_u32 m0, s3, 106496
    s_nop 0
    buffer_load_dwordx4 v17, s[52:55], s83 offen lds
    s_waitcnt lgkmcnt(12)
    v_mfma_f32_16x16x32_bf16 v[124:127], a[188:191], a[100:103], v[124:127]
    ds_read_b64_tr_b16 a[152:153], v62 offset:16384
    ds_read_b64_tr_b16 a[154:155], v62 offset:20480
    s_waitcnt lgkmcnt(12)
    v_mfma_f32_16x16x32_bf16 v[96:99], a[128:131], a[104:107], v[96:99]
    ds_read_b64_tr_b16 a[156:157], v63 offset:16384
    ds_read_b64_tr_b16 a[158:159], v63 offset:20480
    s_waitcnt lgkmcnt(12)
    v_mfma_f32_16x16x32_bf16 v[100:103], a[132:135], a[104:107], v[100:103]
    ds_read_b64_tr_b16 a[160:161], v56 offset:24576
    ds_read_b64_tr_b16 a[162:163], v56 offset:28672
    buffer_load_dwordx4 v18, s[52:55], s83 offen offset:1024 lds
    s_waitcnt lgkmcnt(12)
    v_mfma_f32_16x16x32_bf16 v[104:107], a[136:139], a[104:107], v[104:107]
    ds_read_b64_tr_b16 a[164:165], v57 offset:24576
    ds_read_b64_tr_b16 a[166:167], v57 offset:28672
    s_waitcnt lgkmcnt(12)
    v_mfma_f32_16x16x32_bf16 v[108:111], a[140:143], a[104:107], v[108:111]
    ds_read_b64_tr_b16 a[168:169], v58 offset:24576
    ds_read_b64_tr_b16 a[170:171], v58 offset:28672
    s_waitcnt lgkmcnt(12)
    v_mfma_f32_16x16x32_bf16 v[112:115], a[144:147], a[104:107], v[112:115]
    ds_read_b64_tr_b16 a[172:173], v59 offset:24576
    ds_read_b64_tr_b16 a[174:175], v59 offset:28672
    s_waitcnt lgkmcnt(12)
    v_mfma_f32_16x16x32_bf16 v[116:119], a[148:151], a[104:107], v[116:119]
    ds_read_b64_tr_b16 a[176:177], v60 offset:24576
    ds_read_b64_tr_b16 a[178:179], v60 offset:28672
    s_waitcnt lgkmcnt(12)
    v_mfma_f32_16x16x32_bf16 v[120:123], a[152:155], a[104:107], v[120:123]
    ds_read_b64_tr_b16 a[180:181], v61 offset:24576
    ds_read_b64_tr_b16 a[182:183], v61 offset:28672
    s_waitcnt lgkmcnt(12)
    v_mfma_f32_16x16x32_bf16 v[124:127], a[156:159], a[104:107], v[124:127]
    ds_read_b64_tr_b16 a[184:185], v62 offset:24576
    ds_read_b64_tr_b16 a[186:187], v62 offset:28672
    s_waitcnt lgkmcnt(12)
    v_mfma_f32_16x16x32_bf16 v[96:99], a[160:163], a[108:111], v[96:99]
    ds_read_b64_tr_b16 a[188:189], v63 offset:24576
    ds_read_b64_tr_b16 a[190:191], v63 offset:28672
    s_waitcnt lgkmcnt(12)
    v_mfma_f32_16x16x32_bf16 v[100:103], a[164:167], a[108:111], v[100:103]
    ds_read_b64_tr_b16 a[128:129], v8 offset:0
    ds_read_b64_tr_b16 a[130:131], v8 offset:4096
    s_waitcnt lgkmcnt(12)
    v_mfma_f32_16x16x32_bf16 v[104:107], a[168:171], a[108:111], v[104:107]
    ds_read_b64_tr_b16 a[132:133], v9 offset:0
    ds_read_b64_tr_b16 a[134:135], v9 offset:4096
    s_waitcnt lgkmcnt(12)
    v_mfma_f32_16x16x32_bf16 v[108:111], a[172:175], a[108:111], v[108:111]
    ds_read_b64_tr_b16 a[136:137], v10 offset:0
    ds_read_b64_tr_b16 a[138:139], v10 offset:4096
    s_waitcnt lgkmcnt(12)
    v_mfma_f32_16x16x32_bf16 v[112:115], a[176:179], a[108:111], v[112:115]
    ds_read_b64_tr_b16 a[140:141], v11 offset:0
    ds_read_b64_tr_b16 a[142:143], v11 offset:4096
    s_waitcnt lgkmcnt(12)
    v_mfma_f32_16x16x32_bf16 v[116:119], a[180:183], a[108:111], v[116:119]
    ds_read_b64_tr_b16 a[144:145], v12 offset:0
    ds_read_b64_tr_b16 a[146:147], v12 offset:4096
    s_waitcnt lgkmcnt(12)
    v_mfma_f32_16x16x32_bf16 v[120:123], a[184:187], a[108:111], v[120:123]
    ds_read_b64_tr_b16 a[148:149], v13 offset:0
    ds_read_b64_tr_b16 a[150:151], v13 offset:4096
    s_waitcnt lgkmcnt(12)
    v_mfma_f32_16x16x32_bf16 v[124:127], a[188:191], a[108:111], v[124:127]
    ds_read_b64_tr_b16 a[152:153], v14 offset:0
    ds_read_b64_tr_b16 a[154:155], v14 offset:4096
    s_waitcnt lgkmcnt(12)
    v_mfma_f32_16x16x32_bf16 v[96:99], a[128:131], a[112:115], v[96:99]
    ds_read_b64_tr_b16 a[156:157], v15 offset:0
    ds_read_b64_tr_b16 a[158:159], v15 offset:4096
    s_waitcnt lgkmcnt(12)
    v_mfma_f32_16x16x32_bf16 v[100:103], a[132:135], a[112:115], v[100:103]
    ds_read_b64_tr_b16 a[160:161], v8 offset:8192
    ds_read_b64_tr_b16 a[162:163], v8 offset:12288
    s_waitcnt lgkmcnt(12)
    v_mfma_f32_16x16x32_bf16 v[104:107], a[136:139], a[112:115], v[104:107]
    ds_read_b64_tr_b16 a[164:165], v9 offset:8192
    ds_read_b64_tr_b16 a[166:167], v9 offset:12288
    s_waitcnt lgkmcnt(12)
    v_mfma_f32_16x16x32_bf16 v[108:111], a[140:143], a[112:115], v[108:111]
    ds_read_b64_tr_b16 a[168:169], v10 offset:8192
    ds_read_b64_tr_b16 a[170:171], v10 offset:12288
    s_waitcnt lgkmcnt(12)
    v_mfma_f32_16x16x32_bf16 v[112:115], a[144:147], a[112:115], v[112:115]
    ds_read_b64_tr_b16 a[172:173], v11 offset:8192
    ds_read_b64_tr_b16 a[174:175], v11 offset:12288
    s_waitcnt lgkmcnt(12)
    v_mfma_f32_16x16x32_bf16 v[116:119], a[148:151], a[112:115], v[116:119]
    ds_read_b64_tr_b16 a[176:177], v12 offset:8192
    ds_read_b64_tr_b16 a[178:179], v12 offset:12288
    s_waitcnt lgkmcnt(12)
    v_mfma_f32_16x16x32_bf16 v[120:123], a[152:155], a[112:115], v[120:123]
    ds_read_b64_tr_b16 a[180:181], v13 offset:8192
    ds_read_b64_tr_b16 a[182:183], v13 offset:12288
    s_waitcnt lgkmcnt(12)
    v_mfma_f32_16x16x32_bf16 v[124:127], a[156:159], a[112:115], v[124:127]
    ds_read_b64_tr_b16 a[184:185], v14 offset:8192
    ds_read_b64_tr_b16 a[186:187], v14 offset:12288
    s_waitcnt lgkmcnt(12)
    v_mfma_f32_16x16x32_bf16 v[96:99], a[160:163], a[116:119], v[96:99]
    ds_read_b64_tr_b16 a[188:189], v15 offset:8192
    ds_read_b64_tr_b16 a[190:191], v15 offset:12288
    s_waitcnt lgkmcnt(12)
    v_mfma_f32_16x16x32_bf16 v[100:103], a[164:167], a[116:119], v[100:103]
    ds_read_b64_tr_b16 a[128:129], v8 offset:16384
    ds_read_b64_tr_b16 a[130:131], v8 offset:20480
    s_waitcnt lgkmcnt(12)
    v_mfma_f32_16x16x32_bf16 v[104:107], a[168:171], a[116:119], v[104:107]
    ds_read_b64_tr_b16 a[132:133], v9 offset:16384
    ds_read_b64_tr_b16 a[134:135], v9 offset:20480
    s_waitcnt lgkmcnt(12)
    v_mfma_f32_16x16x32_bf16 v[108:111], a[172:175], a[116:119], v[108:111]
    ds_read_b64_tr_b16 a[136:137], v10 offset:16384
    ds_read_b64_tr_b16 a[138:139], v10 offset:20480
    s_waitcnt lgkmcnt(12)
    v_mfma_f32_16x16x32_bf16 v[112:115], a[176:179], a[116:119], v[112:115]
    ds_read_b64_tr_b16 a[140:141], v11 offset:16384
    ds_read_b64_tr_b16 a[142:143], v11 offset:20480
    s_waitcnt lgkmcnt(12)
    v_mfma_f32_16x16x32_bf16 v[116:119], a[180:183], a[116:119], v[116:119]
    ds_read_b64_tr_b16 a[144:145], v12 offset:16384
    ds_read_b64_tr_b16 a[146:147], v12 offset:20480
    s_waitcnt lgkmcnt(12)
    v_mfma_f32_16x16x32_bf16 v[120:123], a[184:187], a[116:119], v[120:123]
    ds_read_b64_tr_b16 a[148:149], v13 offset:16384
    ds_read_b64_tr_b16 a[150:151], v13 offset:20480
    s_waitcnt lgkmcnt(12)
    v_mfma_f32_16x16x32_bf16 v[124:127], a[188:191], a[116:119], v[124:127]
    ds_read_b64_tr_b16 a[152:153], v14 offset:16384
    ds_read_b64_tr_b16 a[154:155], v14 offset:20480
    s_waitcnt vmcnt(13)
    s_barrier
    s_waitcnt lgkmcnt(12)
    v_mfma_f32_16x16x32_bf16 v[96:99], a[128:131], a[120:123], v[96:99]
    ds_read_b64_tr_b16 a[156:157], v15 offset:16384
    ds_read_b64_tr_b16 a[158:159], v15 offset:20480
    s_mov_b32 s82, 1703936
    s_add_u32 m0, s3, 114688
    s_nop 0
    buffer_load_dwordx4 v17, s[52:55], s82 offen lds
    s_waitcnt lgkmcnt(12)
    v_mfma_f32_16x16x32_bf16 v[100:103], a[132:135], a[120:123], v[100:103]
    ds_read_b64_tr_b16 a[160:161], v8 offset:24576
    ds_read_b64_tr_b16 a[162:163], v8 offset:28672
    s_waitcnt lgkmcnt(12)
    v_mfma_f32_16x16x32_bf16 v[104:107], a[136:139], a[120:123], v[104:107]
    ds_read_b64_tr_b16 a[164:165], v9 offset:24576
    ds_read_b64_tr_b16 a[166:167], v9 offset:28672
    s_waitcnt lgkmcnt(12)
    v_mfma_f32_16x16x32_bf16 v[108:111], a[140:143], a[120:123], v[108:111]
    ds_read_b64_tr_b16 a[168:169], v10 offset:24576
    ds_read_b64_tr_b16 a[170:171], v10 offset:28672
    buffer_load_dwordx4 v18, s[52:55], s82 offen offset:1024 lds
    s_waitcnt lgkmcnt(12)
    v_mfma_f32_16x16x32_bf16 v[112:115], a[144:147], a[120:123], v[112:115]
    ds_read_b64_tr_b16 a[172:173], v11 offset:24576
    ds_read_b64_tr_b16 a[174:175], v11 offset:28672
    s_waitcnt lgkmcnt(12)
    v_mfma_f32_16x16x32_bf16 v[116:119], a[148:151], a[120:123], v[116:119]
    ds_read_b64_tr_b16 a[176:177], v12 offset:24576
    ds_read_b64_tr_b16 a[178:179], v12 offset:28672
    s_waitcnt lgkmcnt(12)
    v_mfma_f32_16x16x32_bf16 v[120:123], a[152:155], a[120:123], v[120:123]
    ds_read_b64_tr_b16 a[180:181], v13 offset:24576
    ds_read_b64_tr_b16 a[182:183], v13 offset:28672
    s_mov_b32 s83, 1769472
    s_add_u32 m0, s3, 122880
    s_nop 0
    buffer_load_dwordx4 v17, s[52:55], s83 offen lds
    s_waitcnt lgkmcnt(12)
    v_mfma_f32_16x16x32_bf16 v[124:127], a[156:159], a[120:123], v[124:127]
    ds_read_b64_tr_b16 a[184:185], v14 offset:24576
    ds_read_b64_tr_b16 a[186:187], v14 offset:28672
    s_waitcnt lgkmcnt(12)
    v_mfma_f32_16x16x32_bf16 v[96:99], a[160:163], a[124:127], v[96:99]
    ds_read_b64_tr_b16 a[188:189], v15 offset:24576
    ds_read_b64_tr_b16 a[190:191], v15 offset:28672
    buffer_load_dword v43, off, s[56:59], s77 sc1
    s_waitcnt lgkmcnt(12)
    v_mfma_f32_16x16x32_bf16 v[100:103], a[164:167], a[124:127], v[100:103]
    ds_read_b64_tr_b16 a[128:129], v8 offset:32768
    ds_read_b64_tr_b16 a[130:131], v8 offset:36864
    buffer_load_dwordx4 v18, s[52:55], s83 offen offset:1024 lds
    s_waitcnt lgkmcnt(12)
    v_mfma_f32_16x16x32_bf16 v[104:107], a[168:171], a[124:127], v[104:107]
    ds_read_b64_tr_b16 a[132:133], v9 offset:32768
    ds_read_b64_tr_b16 a[134:135], v9 offset:36864
    s_waitcnt lgkmcnt(12)
    v_mfma_f32_16x16x32_bf16 v[108:111], a[172:175], a[124:127], v[108:111]
    ds_read_b64_tr_b16 a[136:137], v10 offset:32768
    ds_read_b64_tr_b16 a[138:139], v10 offset:36864
    s_waitcnt lgkmcnt(12)
    v_mfma_f32_16x16x32_bf16 v[112:115], a[176:179], a[124:127], v[112:115]
    ds_read_b64_tr_b16 a[140:141], v11 offset:32768
    ds_read_b64_tr_b16 a[142:143], v11 offset:36864
    s_mov_b32 s82, 1835008
    s_add_u32 m0, s3, 131072
    s_nop 0
    buffer_load_dwordx4 v17, s[52:55], s82 offen lds
    s_waitcnt lgkmcnt(12)
    v_mfma_f32_16x16x32_bf16 v[116:119], a[180:183], a[124:127], v[116:119]
    ds_read_b64_tr_b16 a[144:145], v12 offset:32768
    ds_read_b64_tr_b16 a[146:147], v12 offset:36864
    s_waitcnt lgkmcnt(12)
    v_mfma_f32_16x16x32_bf16 v[120:123], a[184:187], a[124:127], v[120:123]
    ds_read_b64_tr_b16 a[148:149], v13 offset:32768
    ds_read_b64_tr_b16 a[150:151], v13 offset:36864
    s_waitcnt lgkmcnt(12)
    v_mfma_f32_16x16x32_bf16 v[124:127], a[188:191], a[124:127], v[124:127]
    ds_read_b64_tr_b16 a[152:153], v14 offset:32768
    ds_read_b64_tr_b16 a[154:155], v14 offset:36864
    buffer_load_dwordx4 v18, s[52:55], s82 offen offset:1024 lds
    s_waitcnt lgkmcnt(12)
    v_mfma_f32_16x16x32_bf16 v[96:99], a[128:131], a[0:3], v[96:99]
    ds_read_b64_tr_b16 a[156:157], v15 offset:32768
    ds_read_b64_tr_b16 a[158:159], v15 offset:36864
    s_waitcnt lgkmcnt(12)
    v_mfma_f32_16x16x32_bf16 v[100:103], a[132:135], a[0:3], v[100:103]
    ds_read_b64_tr_b16 a[160:161], v8 offset:40960
    ds_read_b64_tr_b16 a[162:163], v8 offset:45056
    s_waitcnt lgkmcnt(12)
    v_mfma_f32_16x16x32_bf16 v[104:107], a[136:139], a[0:3], v[104:107]
    ds_read_b64_tr_b16 a[164:165], v9 offset:40960
    ds_read_b64_tr_b16 a[166:167], v9 offset:45056
    s_mov_b32 s83, 1900544
    s_add_u32 m0, s3, 139264
    s_nop 0
    buffer_load_dwordx4 v17, s[52:55], s83 offen lds
    s_waitcnt lgkmcnt(12)
    v_mfma_f32_16x16x32_bf16 v[108:111], a[140:143], a[0:3], v[108:111]
    ds_read_b64_tr_b16 a[168:169], v10 offset:40960
    ds_read_b64_tr_b16 a[170:171], v10 offset:45056
    s_waitcnt lgkmcnt(12)
    v_mfma_f32_16x16x32_bf16 v[112:115], a[144:147], a[0:3], v[112:115]
    ds_read_b64_tr_b16 a[172:173], v11 offset:40960
    ds_read_b64_tr_b16 a[174:175], v11 offset:45056
    s_waitcnt lgkmcnt(12)
    v_mfma_f32_16x16x32_bf16 v[116:119], a[148:151], a[0:3], v[116:119]
    ds_read_b64_tr_b16 a[176:177], v12 offset:40960
    ds_read_b64_tr_b16 a[178:179], v12 offset:45056
    buffer_load_dwordx4 v18, s[52:55], s83 offen offset:1024 lds
    s_waitcnt lgkmcnt(12)
    v_mfma_f32_16x16x32_bf16 v[120:123], a[152:155], a[0:3], v[120:123]
    ds_read_b64_tr_b16 a[180:181], v13 offset:40960
    ds_read_b64_tr_b16 a[182:183], v13 offset:45056
    s_waitcnt lgkmcnt(12)
    v_mfma_f32_16x16x32_bf16 v[124:127], a[156:159], a[0:3], v[124:127]
    ds_read_b64_tr_b16 a[184:185], v14 offset:40960
    ds_read_b64_tr_b16 a[186:187], v14 offset:45056
    s_waitcnt lgkmcnt(12)
    v_mfma_f32_16x16x32_bf16 v[96:99], a[160:163], a[4:7], v[96:99]
    ds_read_b64_tr_b16 a[188:189], v15 offset:40960
    ds_read_b64_tr_b16 a[190:191], v15 offset:45056
    s_mov_b32 s82, 1966080
    s_add_u32 m0, s3, 147456
    s_nop 0
    buffer_load_dwordx4 v17, s[52:55], s82 offen lds
    s_waitcnt lgkmcnt(12)
    v_mfma_f32_16x16x32_bf16 v[100:103], a[164:167], a[4:7], v[100:103]
    ds_read_b64_tr_b16 a[128:129], v8 offset:49152
    ds_read_b64_tr_b16 a[130:131], v8 offset:53248
    s_waitcnt lgkmcnt(12)
    v_mfma_f32_16x16x32_bf16 v[104:107], a[168:171], a[4:7], v[104:107]
    ds_read_b64_tr_b16 a[132:133], v9 offset:49152
    ds_read_b64_tr_b16 a[134:135], v9 offset:53248
    s_waitcnt lgkmcnt(12)
    v_mfma_f32_16x16x32_bf16 v[108:111], a[172:175], a[4:7], v[108:111]
    ds_read_b64_tr_b16 a[136:137], v10 offset:49152
    ds_read_b64_tr_b16 a[138:139], v10 offset:53248
    buffer_load_dwordx4 v18, s[52:55], s82 offen offset:1024 lds
    s_waitcnt lgkmcnt(12)
    v_mfma_f32_16x16x32_bf16 v[112:115], a[176:179], a[4:7], v[112:115]
    ds_read_b64_tr_b16 a[140:141], v11 offset:49152
    ds_read_b64_tr_b16 a[142:143], v11 offset:53248
    s_waitcnt lgkmcnt(12)
    v_mfma_f32_16x16x32_bf16 v[116:119], a[180:183], a[4:7], v[116:119]
    ds_read_b64_tr_b16 a[144:145], v12 offset:49152
    ds_read_b64_tr_b16 a[146:147], v12 offset:53248
    s_waitcnt lgkmcnt(12)
    v_mfma_f32_16x16x32_bf16 v[120:123], a[184:187], a[4:7], v[120:123]
    ds_read_b64_tr_b16 a[148:149], v13 offset:49152
    ds_read_b64_tr_b16 a[150:151], v13 offset:53248
    s_mov_b32 s83, 2031616
    s_add_u32 m0, s3, 155648
    s_nop 0
    buffer_load_dwordx4 v17, s[52:55], s83 offen lds
    s_waitcnt lgkmcnt(12)
    v_mfma_f32_16x16x32_bf16 v[124:127], a[188:191], a[4:7], v[124:127]
    ds_read_b64_tr_b16 a[152:153], v14 offset:49152
    ds_read_b64_tr_b16 a[154:155], v14 offset:53248
    s_waitcnt vmcnt(12)
    s_barrier
    s_waitcnt lgkmcnt(12)
    v_mfma_f32_16x16x32_bf16 v[96:99], a[128:131], a[8:11], v[96:99]
    ds_read_b64_tr_b16 a[156:157], v15 offset:49152
    ds_read_b64_tr_b16 a[158:159], v15 offset:53248
    s_waitcnt lgkmcnt(12)
    v_mfma_f32_16x16x32_bf16 v[100:103], a[132:135], a[8:11], v[100:103]
    ds_read_b64_tr_b16 a[160:161], v8 offset:57344
    ds_read_b64_tr_b16 a[162:163], v8 offset:61440
    buffer_load_dwordx4 v18, s[52:55], s83 offen offset:1024 lds
    s_waitcnt lgkmcnt(12)
    v_mfma_f32_16x16x32_bf16 v[104:107], a[136:139], a[8:11], v[104:107]
    ds_read_b64_tr_b16 a[164:165], v9 offset:57344
    ds_read_b64_tr_b16 a[166:167], v9 offset:61440
    s_waitcnt lgkmcnt(12)
    v_mfma_f32_16x16x32_bf16 v[108:111], a[140:143], a[8:11], v[108:111]
    ds_read_b64_tr_b16 a[168:169], v10 offset:57344
    ds_read_b64_tr_b16 a[170:171], v10 offset:61440
    s_waitcnt lgkmcnt(12)
    v_mfma_f32_16x16x32_bf16 v[112:115], a[144:147], a[8:11], v[112:115]
    ds_read_b64_tr_b16 a[172:173], v11 offset:57344
    ds_read_b64_tr_b16 a[174:175], v11 offset:61440
    s_waitcnt lgkmcnt(12)
    v_mfma_f32_16x16x32_bf16 v[116:119], a[148:151], a[8:11], v[116:119]
    ds_read_b64_tr_b16 a[176:177], v12 offset:57344
    ds_read_b64_tr_b16 a[178:179], v12 offset:61440
    s_waitcnt lgkmcnt(12)
    v_mfma_f32_16x16x32_bf16 v[120:123], a[152:155], a[8:11], v[120:123]
    ds_read_b64_tr_b16 a[180:181], v13 offset:57344
    ds_read_b64_tr_b16 a[182:183], v13 offset:61440
    s_waitcnt lgkmcnt(12)
    v_mfma_f32_16x16x32_bf16 v[124:127], a[156:159], a[8:11], v[124:127]
    ds_read_b64_tr_b16 a[184:185], v14 offset:57344
    ds_read_b64_tr_b16 a[186:187], v14 offset:61440
    s_waitcnt lgkmcnt(12)
    v_mfma_f32_16x16x32_bf16 v[96:99], a[160:163], a[12:15], v[96:99]
    ds_read_b64_tr_b16 a[188:189], v15 offset:57344
    ds_read_b64_tr_b16 a[190:191], v15 offset:61440
    s_waitcnt lgkmcnt(12)
    v_mfma_f32_16x16x32_bf16 v[100:103], a[164:167], a[12:15], v[100:103]
    ds_read_b64_tr_b16 a[128:129], v48 offset:0
    ds_read_b64_tr_b16 a[130:131], v48 offset:4096
    s_waitcnt lgkmcnt(12)
    v_mfma_f32_16x16x32_bf16 v[104:107], a[168:171], a[12:15], v[104:107]
    ds_read_b64_tr_b16 a[132:133], v49 offset:0
    ds_read_b64_tr_b16 a[134:135], v49 offset:4096
    s_waitcnt lgkmcnt(12)
    v_mfma_f32_16x16x32_bf16 v[108:111], a[172:175], a[12:15], v[108:111]
    ds_read_b64_tr_b16 a[136:137], v50 offset:0
    ds_read_b64_tr_b16 a[138:139], v50 offset:4096
    s_waitcnt lgkmcnt(12)
    v_mfma_f32_16x16x32_bf16 v[112:115], a[176:179], a[12:15], v[112:115]
    ds_read_b64_tr_b16 a[140:141], v51 offset:0
    ds_read_b64_tr_b16 a[142:143], v51 offset:4096
    s_waitcnt lgkmcnt(12)
    v_mfma_f32_16x16x32_bf16 v[116:119], a[180:183], a[12:15], v[116:119]
    ds_read_b64_tr_b16 a[144:145], v52 offset:0
    ds_read_b64_tr_b16 a[146:147], v52 offset:4096
    s_waitcnt lgkmcnt(12)
    v_mfma_f32_16x16x32_bf16 v[120:123], a[184:187], a[12:15], v[120:123]
    ds_read_b64_tr_b16 a[148:149], v53 offset:0
    ds_read_b64_tr_b16 a[150:151], v53 offset:4096
    s_waitcnt lgkmcnt(12)
    v_mfma_f32_16x16x32_bf16 v[124:127], a[188:191], a[12:15], v[124:127]
    ds_read_b64_tr_b16 a[152:153], v54 offset:0
    ds_read_b64_tr_b16 a[154:155], v54 offset:4096
    s_waitcnt lgkmcnt(12)
    v_mfma_f32_16x16x32_bf16 v[96:99], a[128:131], a[16:19], v[96:99]
    ds_read_b64_tr_b16 a[156:157], v55 offset:0
    ds_read_b64_tr_b16 a[158:159], v55 offset:4096
    s_waitcnt vmcnt(9)
    v_readfirstlane_b32 s86, v43
    s_cmp_eq_u32 s86, 4
    s_cbranch_scc0 L_spP
L_okP:
    buffer_load_dwordx4 v[164:167], v16, s[56:59], s73 offen offset:0 sc1
    s_waitcnt lgkmcnt(12)
    v_mfma_f32_16x16x32_bf16 v[100:103], a[132:135], a[16:19], v[100:103]
    ds_read_b64_tr_b16 a[160:161], v48 offset:8192
    ds_read_b64_tr_b16 a[162:163], v48 offset:12288
    buffer_load_dwordx4 v[172:175], v16, s[56:59], s73 offen offset:1024 sc1
    s_waitcnt lgkmcnt(12)
    v_mfma_f32_16x16x32_bf16 v[104:107], a[136:139], a[16:19], v[104:107]
    ds_read_b64_tr_b16 a[164:165], v49 offset:8192
    ds_read_b64_tr_b16 a[166:167], v49 offset:12288
    buffer_load_dwordx4 v[180:183], v16, s[56:59], s73 offen offset:2048 sc1
    s_waitcnt lgkmcnt(12)
    v_mfma_f32_16x16x32_bf16 v[108:111], a[140:143], a[16:19], v[108:111]
    ds_read_b64_tr_b16 a[168:169], v50 offset:8192
    ds_read_b64_tr_b16 a[170:171], v50 offset:12288
    buffer_load_dwordx4 v[188:191], v16, s[56:59], s73 offen offset:3072 sc1
    s_waitcnt lgkmcnt(12)
    v_mfma_f32_16x16x32_bf16 v[112:115], a[144:147], a[16:19], v[112:115]
    ds_read_b64_tr_b16 a[172:173], v51 offset:8192
    ds_read_b64_tr_b16 a[174:175], v51 offset:12288
    buffer_load_dwordx4 v[196:199], v16, s[56:59], s74 offen offset:0 sc1
    s_waitcnt lgkmcnt(12)
    v_mfma_f32_16x16x32_bf16 v[116:119], a[148:151], a[16:19], v[116:119]
    ds_read_b64_tr_b16 a[176:177], v52 offset:8192
    ds_read_b64_tr_b16 a[178:179], v52 offset:12288
    buffer_load_dwordx4 v[204:207], v16, s[56:59], s74 offen offset:1024 sc1
    s_waitcnt lgkmcnt(12)
    v_mfma_f32_16x16x32_bf16 v[120:123], a[152:155], a[16:19], v[120:123]
    ds_read_b64_tr_b16 a[180:181], v53 offset:8192
    ds_read_b64_tr_b16 a[182:183], v53 offset:12288
    buffer_load_dwordx4 v[212:215], v16, s[56:59], s74 offen offset:2048 sc1
    s_waitcnt lgkmcnt(12)
    v_mfma_f32_16x16x32_bf16 v[124:127], a[156:159], a[16:19], v[124:127]
    ds_read_b64_tr_b16 a[184:185], v54 offset:8192
    ds_read_b64_tr_b16 a[186:187], v54 offset:12288
    buffer_load_dwordx4 v[220:223], v16, s[56:59], s74 offen offset:3072 sc1
    s_waitcnt lgkmcnt(12)
    v_mfma_f32_16x16x32_bf16 v[96:99], a[160:163], a[20:23], v[96:99]
    ds_read_b64_tr_b16 a[188:189], v55 offset:8192
    ds_read_b64_tr_b16 a[190:191], v55 offset:12288
    buffer_load_dwordx4 v[228:231], v16, s[56:59], s75 offen offset:0 sc1
    s_waitcnt lgkmcnt(12)
    v_mfma_f32_16x16x32_bf16 v[100:103], a[164:167], a[20:23], v[100:103]
    ds_read_b64_tr_b16 a[128:129], v48 offset:16384
    ds_read_b64_tr_b16 a[130:131], v48 offset:20480
    buffer_load_dwordx4 v[236:239], v16, s[56:59], s75 offen offset:1024 sc1
    s_waitcnt lgkmcnt(12)
    v_mfma_f32_16x16x32_bf16 v[104:107], a[168:171], a[20:23], v[104:107]
    ds_read_b64_tr_b16 a[132:133], v49 offset:16384
    ds_read_b64_tr_b16 a[134:135], v49 offset:20480
    buffer_load_dwordx4 v[244:247], v16, s[56:59], s75 offen offset:2048 sc1
    s_waitcnt lgkmcnt(12)
    v_mfma_f32_16x16x32_bf16 v[108:111], a[172:175], a[20:23], v[108:111]
    ds_read_b64_tr_b16 a[136:137], v50 offset:16384
    ds_read_b64_tr_b16 a[138:139], v50 offset:20480
    buffer_load_dwordx4 v[252:255], v16, s[56:59], s75 offen offset:3072 sc1
    s_waitcnt lgkmcnt(12)
    v_mfma_f32_16x16x32_bf16 v[112:115], a[176:179], a[20:23], v[112:115]
    ds_read_b64_tr_b16 a[140:141], v51 offset:16384
    ds_read_b64_tr_b16 a[142:143], v51 offset:20480
    s_waitcnt lgkmcnt(12)
    v_mfma_f32_16x16x32_bf16 v[116:119], a[180:183], a[20:23], v[116:119]
    ds_read_b64_tr_b16 a[144:145], v52 offset:16384
    ds_read_b64_tr_b16 a[146:147], v52 offset:20480
    s_waitcnt lgkmcnt(12)
    v_mfma_f32_16x16x32_bf16 v[120:123], a[184:187], a[20:23], v[120:123]
    ds_read_b64_tr_b16 a[148:149], v53 offset:16384
    ds_read_b64_tr_b16 a[150:151], v53 offset:20480
    s_waitcnt lgkmcnt(12)
    v_mfma_f32_16x16x32_bf16 v[124:127], a[188:191], a[20:23], v[124:127]
    ds_read_b64_tr_b16 a[152:153], v54 offset:16384
    ds_read_b64_tr_b16 a[154:155], v54 offset:20480
    s_waitcnt lgkmcnt(12)
    v_mfma_f32_16x16x32_bf16 v[96:99], a[128:131], a[24:27], v[96:99]
    ds_read_b64_tr_b16 a[156:157], v55 offset:16384
    ds_read_b64_tr_b16 a[158:159], v55 offset:20480
    s_waitcnt lgkmcnt(12)
    v_mfma_f32_16x16x32_bf16 v[100:103], a[132:135], a[24:27], v[100:103]
    ds_read_b64_tr_b16 a[160:161], v48 offset:24576
    ds_read_b64_tr_b16 a[162:163], v48 offset:28672
    s_waitcnt lgkmcnt(12)
    v_mfma_f32_16x16x32_bf16 v[104:107], a[136:139], a[24:27], v[104:107]
    ds_read_b64_tr_b16 a[164:165], v49 offset:24576
    ds_read_b64_tr_b16 a[166:167], v49 offset:28672
    s_waitcnt lgkmcnt(12)
    v_mfma_f32_16x16x32_bf16 v[108:111], a[140:143], a[24:27], v[108:111]
    ds_read_b64_tr_b16 a[168:169], v50 offset:24576
    ds_read_b64_tr_b16 a[170:171], v50 offset:28672
    s_waitcnt lgkmcnt(12)
    v_mfma_f32_16x16x32_bf16 v[112:115], a[144:147], a[24:27], v[112:115]
    ds_read_b64_tr_b16 a[172:173], v51 offset:24576
    ds_read_b64_tr_b16 a[174:175], v51 offset:28672
    s_waitcnt lgkmcnt(12)
    v_mfma_f32_16x16x32_bf16 v[116:119], a[148:151], a[24:27], v[116:119]
    ds_read_b64_tr_b16 a[176:177], v52 offset:24576
    ds_read_b64_tr_b16 a[178:179], v52 offset:28672
    s_waitcnt lgkmcnt(12)
    v_mfma_f32_16x16x32_bf16 v[120:123], a[152:155], a[24:27], v[120:123]
    ds_read_b64_tr_b16 a[180:181], v53 offset:24576
    ds_read_b64_tr_b16 a[182:183], v53 offset:28672
    s_waitcnt lgkmcnt(12)
    v_mfma_f32_16x16x32_bf16 v[124:127], a[156:159], a[24:27], v[124:127]
    ds_read_b64_tr_b16 a[184:185], v54 offset:24576
    ds_read_b64_tr_b16 a[186:187], v54 offset:28672
    s_waitcnt lgkmcnt(12)
    v_mfma_f32_16x16x32_bf16 v[96:99], a[160:163], a[28:31], v[96:99]
    ds_read_b64_tr_b16 a[188:189], v55 offset:24576
    ds_read_b64_tr_b16 a[190:191], v55 offset:28672
    s_waitcnt lgkmcnt(12)
    v_mfma_f32_16x16x32_bf16 v[100:103], a[164:167], a[28:31], v[100:103]
    ds_read_b64_tr_b16 a[128:129], v48 offset:32768
    ds_read_b64_tr_b16 a[130:131], v48 offset:36864
    s_waitcnt lgkmcnt(12)
    v_mfma_f32_16x16x32_bf16 v[104:107], a[168:171], a[28:31], v[104:107]
    ds_read_b64_tr_b16 a[132:133], v49 offset:32768
    ds_read_b64_tr_b16 a[134:135], v49 offset:36864
    s_waitcnt lgkmcnt(12)
    v_mfma_f32_16x16x32_bf16 v[108:111], a[172:175], a[28:31], v[108:111]
    ds_read_b64_tr_b16 a[136:137], v50 offset:32768
    ds_read_b64_tr_b16 a[138:139], v50 offset:36864
    s_waitcnt lgkmcnt(12)
    v_mfma_f32_16x16x32_bf16 v[112:115], a[176:179], a[28:31], v[112:115]
    ds_read_b64_tr_b16 a[140:141], v51 offset:32768
    ds_read_b64_tr_b16 a[142:143], v51 offset:36864
    s_waitcnt lgkmcnt(12)
    v_mfma_f32_16x16x32_bf16 v[116:119], a[180:183], a[28:31], v[116:119]
    ds_read_b64_tr_b16 a[144:145], v52 offset:32768
    ds_read_b64_tr_b16 a[146:147], v52 offset:36864
    s_waitcnt lgkmcnt(12)
    v_mfma_f32_16x16x32_bf16 v[120:123], a[184:187], a[28:31], v[120:123]
    ds_read_b64_tr_b16 a[148:149], v53 offset:32768
    ds_read_b64_tr_b16 a[150:151], v53 offset:36864
    s_waitcnt lgkmcnt(12)
    v_mfma_f32_16x16x32_bf16 v[124:127], a[188:191], a[28:31], v[124:127]
    ds_read_b64_tr_b16 a[152:153], v54 offset:32768
    ds_read_b64_tr_b16 a[154:155], v54 offset:36864
    s_waitcnt vmcnt(12)
    s_barrier
    s_waitcnt lgkmcnt(12)
    v_mfma_f32_16x16x32_bf16 v[96:99], a[128:131], a[32:35], v[96:99]
    ds_read_b64_tr_b16 a[156:157], v55 offset:32768
    ds_read_b64_tr_b16 a[158:159], v55 offset:36864
    s_waitcnt lgkmcnt(12)
    v_mfma_f32_16x16x32_bf16 v[100:103], a[132:135], a[32:35], v[100:103]
    ds_read_b64_tr_b16 a[160:161], v48 offset:40960
    ds_read_b64_tr_b16 a[162:163], v48 offset:45056
    s_waitcnt lgkmcnt(12)
    v_mfma_f32_16x16x32_bf16 v[104:107], a[136:139], a[32:35], v[104:107]
    ds_read_b64_tr_b16 a[164:165], v49 offset:40960
    ds_read_b64_tr_b16 a[166:167], v49 offset:45056
    s_waitcnt lgkmcnt(12)
    v_mfma_f32_16x16x32_bf16 v[108:111], a[140:143], a[32:35], v[108:111]
    ds_read_b64_tr_b16 a[168:169], v50 offset:40960
    ds_read_b64_tr_b16 a[170:171], v50 offset:45056
    s_waitcnt lgkmcnt(12)
    v_mfma_f32_16x16x32_bf16 v[112:115], a[144:147], a[32:35], v[112:115]
    ds_read_b64_tr_b16 a[172:173], v51 offset:40960
    ds_read_b64_tr_b16 a[174:175], v51 offset:45056
    s_waitcnt lgkmcnt(12)
    v_mfma_f32_16x16x32_bf16 v[116:119], a[148:151], a[32:35], v[116:119]
    ds_read_b64_tr_b16 a[176:177], v52 offset:40960
    ds_read_b64_tr_b16 a[178:179], v52 offset:45056
    s_waitcnt lgkmcnt(12)
    v_mfma_f32_16x16x32_bf16 v[120:123], a[152:155], a[32:35], v[120:123]
    ds_read_b64_tr_b16 a[180:181], v53 offset:40960
    ds_read_b64_tr_b16 a[182:183], v53 offset:45056
    s_waitcnt lgkmcnt(12)
    v_mfma_f32_16x16x32_bf16 v[124:127], a[156:159], a[32:35], v[124:127]
    ds_read_b64_tr_b16 a[184:185], v54 offset:40960
    ds_read_b64_tr_b16 a[186:187], v54 offset:45056
    s_waitcnt lgkmcnt(12)
    v_mfma_f32_16x16x32_bf16 v[96:99], a[160:163], a[36:39], v[96:99]
    ds_read_b64_tr_b16 a[188:189], v55 offset:40960
    ds_read_b64_tr_b16 a[190:191], v55 offset:45056
    s_waitcnt lgkmcnt(12)
    v_mfma_f32_16x16x32_bf16 v[100:103], a[164:167], a[36:39], v[100:103]
    ds_read_b64_tr_b16 a[128:129], v48 offset:49152
    ds_read_b64_tr_b16 a[130:131], v48 offset:53248
    s_waitcnt lgkmcnt(12)
    v_mfma_f32_16x16x32_bf16 v[104:107], a[168:171], a[36:39], v[104:107]
    ds_read_b64_tr_b16 a[132:133], v49 offset:49152
    ds_read_b64_tr_b16 a[134:135], v49 offset:53248
    s_waitcnt lgkmcnt(12)
    v_mfma_f32_16x16x32_bf16 v[108:111], a[172:175], a[36:39], v[108:111]
    ds_read_b64_tr_b16 a[136:137], v50 offset:49152
    ds_read_b64_tr_b16 a[138:139], v50 offset:53248
    s_waitcnt lgkmcnt(12)
    v_mfma_f32_16x16x32_bf16 v[112:115], a[176:179], a[36:39], v[112:115]
    ds_read_b64_tr_b16 a[140:141], v51 offset:49152
    ds_read_b64_tr_b16 a[142:143], v51 offset:53248
    s_waitcnt lgkmcnt(12)
    v_mfma_f32_16x16x32_bf16 v[116:119], a[180:183], a[36:39], v[116:119]
    ds_read_b64_tr_b16 a[144:145], v52 offset:49152
    ds_read_b64_tr_b16 a[146:147], v52 offset:53248
    s_waitcnt lgkmcnt(12)
    v_mfma_f32_16x16x32_bf16 v[120:123], a[184:187], a[36:39], v[120:123]
    ds_read_b64_tr_b16 a[148:149], v53 offset:49152
    ds_read_b64_tr_b16 a[150:151], v53 offset:53248
    s_waitcnt lgkmcnt(12)
    v_mfma_f32_16x16x32_bf16 v[124:127], a[188:191], a[36:39], v[124:127]
    ds_read_b64_tr_b16 a[152:153], v54 offset:49152
    ds_read_b64_tr_b16 a[154:155], v54 offset:53248
    s_waitcnt lgkmcnt(12)
    v_mfma_f32_16x16x32_bf16 v[96:99], a[128:131], a[40:43], v[96:99]
    ds_read_b64_tr_b16 a[156:157], v55 offset:49152
    ds_read_b64_tr_b16 a[158:159], v55 offset:53248
    s_waitcnt lgkmcnt(12)
    v_mfma_f32_16x16x32_bf16 v[100:103], a[132:135], a[40:43], v[100:103]
    ds_read_b64_tr_b16 a[160:161], v48 offset:57344
    ds_read_b64_tr_b16 a[162:163], v48 offset:61440
    s_waitcnt lgkmcnt(12)
    v_mfma_f32_16x16x32_bf16 v[104:107], a[136:139], a[40:43], v[104:107]
    ds_read_b64_tr_b16 a[164:165], v49 offset:57344
    ds_read_b64_tr_b16 a[166:167], v49 offset:61440
    s_waitcnt lgkmcnt(12)
    v_mfma_f32_16x16x32_bf16 v[108:111], a[140:143], a[40:43], v[108:111]
    ds_read_b64_tr_b16 a[168:169], v50 offset:57344
    ds_read_b64_tr_b16 a[170:171], v50 offset:61440
    s_waitcnt lgkmcnt(12)
    v_mfma_f32_16x16x32_bf16 v[112:115], a[144:147], a[40:43], v[112:115]
    ds_read_b64_tr_b16 a[172:173], v51 offset:57344
    ds_read_b64_tr_b16 a[174:175], v51 offset:61440
    s_waitcnt lgkmcnt(12)
    v_mfma_f32_16x16x32_bf16 v[116:119], a[148:151], a[40:43], v[116:119]
    ds_read_b64_tr_b16 a[176:177], v52 offset:57344
    ds_read_b64_tr_b16 a[178:179], v52 offset:61440
    s_waitcnt lgkmcnt(12)
    v_mfma_f32_16x16x32_bf16 v[120:123], a[152:155], a[40:43], v[120:123]
    ds_read_b64_tr_b16 a[180:181], v53 offset:57344
    ds_read_b64_tr_b16 a[182:183], v53 offset:61440
    s_waitcnt lgkmcnt(12)
    v_mfma_f32_16x16x32_bf16 v[124:127], a[156:159], a[40:43], v[124:127]
    ds_read_b64_tr_b16 a[184:185], v54 offset:57344
    ds_read_b64_tr_b16 a[186:187], v54 offset:61440
    s_waitcnt lgkmcnt(12)
    v_mfma_f32_16x16x32_bf16 v[96:99], a[160:163], a[44:47], v[96:99]
    ds_read_b64_tr_b16 a[188:189], v55 offset:57344
    ds_read_b64_tr_b16 a[190:191], v55 offset:61440
    s_waitcnt lgkmcnt(12)
    v_mfma_f32_16x16x32_bf16 v[100:103], a[164:167], a[44:47], v[100:103]
    ds_read_b64_tr_b16 a[128:129], v56 offset:0
    ds_read_b64_tr_b16 a[130:131], v56 offset:4096
    s_waitcnt lgkmcnt(12)
    v_mfma_f32_16x16x32_bf16 v[104:107], a[168:171], a[44:47], v[104:107]
    ds_read_b64_tr_b16 a[132:133], v57 offset:0
    ds_read_b64_tr_b16 a[134:135], v57 offset:4096
    s_waitcnt lgkmcnt(12)
    v_mfma_f32_16x16x32_bf16 v[108:111], a[172:175], a[44:47], v[108:111]
    ds_read_b64_tr_b16 a[136:137], v58 offset:0
    ds_read_b64_tr_b16 a[138:139], v58 offset:4096
    s_waitcnt lgkmcnt(12)
    v_mfma_f32_16x16x32_bf16 v[112:115], a[176:179], a[44:47], v[112:115]
    ds_read_b64_tr_b16 a[140:141], v59 offset:0
    ds_read_b64_tr_b16 a[142:143], v59 offset:4096
    s_waitcnt lgkmcnt(12)
    v_mfma_f32_16x16x32_bf16 v[116:119], a[180:183], a[44:47], v[116:119]
    ds_read_b64_tr_b16 a[144:145], v60 offset:0
    ds_read_b64_tr_b16 a[146:147], v60 offset:4096
    s_waitcnt lgkmcnt(12)
    v_mfma_f32_16x16x32_bf16 v[120:123], a[184:187], a[44:47], v[120:123]
    ds_read_b64_tr_b16 a[148:149], v61 offset:0
    ds_read_b64_tr_b16 a[150:151], v61 offset:4096
    s_waitcnt lgkmcnt(12)
    v_mfma_f32_16x16x32_bf16 v[124:127], a[188:191], a[44:47], v[124:127]
    ds_read_b64_tr_b16 a[152:153], v62 offset:0
    ds_read_b64_tr_b16 a[154:155], v62 offset:4096
    s_waitcnt lgkmcnt(12)
    v_mfma_f32_16x16x32_bf16 v[96:99], a[128:131], a[48:51], v[96:99]
    ds_read_b64_tr_b16 a[156:157], v63 offset:0
    ds_read_b64_tr_b16 a[158:159], v63 offset:4096
    s_waitcnt lgkmcnt(12)
    v_mfma_f32_16x16x32_bf16 v[100:103], a[132:135], a[48:51], v[100:103]
    ds_read_b64_tr_b16 a[160:161], v56 offset:8192
    ds_read_b64_tr_b16 a[162:163], v56 offset:12288
    s_waitcnt lgkmcnt(12)
    v_mfma_f32_16x16x32_bf16 v[104:107], a[136:139], a[48:51], v[104:107]
    ds_read_b64_tr_b16 a[164:165], v57 offset:8192
    ds_read_b64_tr_b16 a[166:167], v57 offset:12288
    s_waitcnt lgkmcnt(12)
    v_mfma_f32_16x16x32_bf16 v[108:111], a[140:143], a[48:51], v[108:111]
    ds_read_b64_tr_b16 a[168:169], v58 offset:8192
    ds_read_b64_tr_b16 a[170:171], v58 offset:12288
    s_waitcnt lgkmcnt(12)
    v_mfma_f32_16x16x32_bf16 v[112:115], a[144:147], a[48:51], v[112:115]
    ds_read_b64_tr_b16 a[172:173], v59 offset:8192
    ds_read_b64_tr_b16 a[174:175], v59 offset:12288
    s_waitcnt lgkmcnt(12)
    v_mfma_f32_16x16x32_bf16 v[116:119], a[148:151], a[48:51], v[116:119]
    ds_read_b64_tr_b16 a[176:177], v60 offset:8192
    ds_read_b64_tr_b16 a[178:179], v60 offset:12288
    s_waitcnt lgkmcnt(12)
    v_mfma_f32_16x16x32_bf16 v[120:123], a[152:155], a[48:51], v[120:123]
    ds_read_b64_tr_b16 a[180:181], v61 offset:8192
    ds_read_b64_tr_b16 a[182:183], v61 offset:12288
    s_waitcnt lgkmcnt(12)
    v_mfma_f32_16x16x32_bf16 v[124:127], a[156:159], a[48:51], v[124:127]
    ds_read_b64_tr_b16 a[184:185], v62 offset:8192
    ds_read_b64_tr_b16 a[186:187], v62 offset:12288
    s_waitcnt lgkmcnt(12)
    v_mfma_f32_16x16x32_bf16 v[96:99], a[160:163], a[52:55], v[96:99]
    ds_read_b64_tr_b16 a[188:189], v63 offset:8192
    ds_read_b64_tr_b16 a[190:191], v63 offset:12288
    s_waitcnt lgkmcnt(12)
    v_mfma_f32_16x16x32_bf16 v[100:103], a[164:167], a[52:55], v[100:103]
    ds_read_b64_tr_b16 a[128:129], v56 offset:16384
    ds_read_b64_tr_b16 a[130:131], v56 offset:20480
    s_waitcnt lgkmcnt(12)
    v_mfma_f32_16x16x32_bf16 v[104:107], a[168:171], a[52:55], v[104:107]
    ds_read_b64_tr_b16 a[132:133], v57 offset:16384
    ds_read_b64_tr_b16 a[134:135], v57 offset:20480
    s_waitcnt lgkmcnt(12)
    v_mfma_f32_16x16x32_bf16 v[108:111], a[172:175], a[52:55], v[108:111]
    ds_read_b64_tr_b16 a[136:137], v58 offset:16384
    ds_read_b64_tr_b16 a[138:139], v58 offset:20480
    s_waitcnt lgkmcnt(12)
    v_mfma_f32_16x16x32_bf16 v[112:115], a[176:179], a[52:55], v[112:115]
    ds_read_b64_tr_b16 a[140:141], v59 offset:16384
    ds_read_b64_tr_b16 a[142:143], v59 offset:20480
    s_waitcnt lgkmcnt(12)
    v_mfma_f32_16x16x32_bf16 v[116:119], a[180:183], a[52:55], v[116:119]
    ds_read_b64_tr_b16 a[144:145], v60 offset:16384
    ds_read_b64_tr_b16 a[146:147], v60 offset:20480
    s_waitcnt lgkmcnt(12)
    v_mfma_f32_16x16x32_bf16 v[120:123], a[184:187], a[52:55], v[120:123]
    ds_read_b64_tr_b16 a[148:149], v61 offset:16384
    ds_read_b64_tr_b16 a[150:151], v61 offset:20480
    s_waitcnt lgkmcnt(12)
    v_mfma_f32_16x16x32_bf16 v[124:127], a[188:191], a[52:55], v[124:127]
    ds_read_b64_tr_b16 a[152:153], v62 offset:16384
    ds_read_b64_tr_b16 a[154:155], v62 offset:20480
    s_waitcnt lgkmcnt(12)
    v_mfma_f32_16x16x32_bf16 v[96:99], a[128:131], a[56:59], v[96:99]
    ds_read_b64_tr_b16 a[156:157], v63 offset:16384
    ds_read_b64_tr_b16 a[158:159], v63 offset:20480
    s_waitcnt lgkmcnt(12)
    v_mfma_f32_16x16x32_bf16 v[100:103], a[132:135], a[56:59], v[100:103]
    ds_read_b64_tr_b16 a[160:161], v56 offset:24576
    ds_read_b64_tr_b16 a[162:163], v56 offset:28672
    s_waitcnt lgkmcnt(12)
    v_mfma_f32_16x16x32_bf16 v[104:107], a[136:139], a[56:59], v[104:107]
    ds_read_b64_tr_b16 a[164:165], v57 offset:24576
    ds_read_b64_tr_b16 a[166:167], v57 offset:28672
    s_waitcnt lgkmcnt(12)
    v_mfma_f32_16x16x32_bf16 v[108:111], a[140:143], a[56:59], v[108:111]
    ds_read_b64_tr_b16 a[168:169], v58 offset:24576
    ds_read_b64_tr_b16 a[170:171], v58 offset:28672
    s_waitcnt lgkmcnt(12)
    v_mfma_f32_16x16x32_bf16 v[112:115], a[144:147], a[56:59], v[112:115]
    ds_read_b64_tr_b16 a[172:173], v59 offset:24576
    ds_read_b64_tr_b16 a[174:175], v59 offset:28672
    s_waitcnt lgkmcnt(12)
    v_mfma_f32_16x16x32_bf16 v[116:119], a[148:151], a[56:59], v[116:119]
    ds_read_b64_tr_b16 a[176:177], v60 offset:24576
    ds_read_b64_tr_b16 a[178:179], v60 offset:28672
    s_waitcnt lgkmcnt(12)
    v_mfma_f32_16x16x32_bf16 v[120:123], a[152:155], a[56:59], v[120:123]
    ds_read_b64_tr_b16 a[180:181], v61 offset:24576
    ds_read_b64_tr_b16 a[182:183], v61 offset:28672
    s_waitcnt lgkmcnt(12)
    v_mfma_f32_16x16x32_bf16 v[124:127], a[156:159], a[56:59], v[124:127]
    ds_read_b64_tr_b16 a[184:185], v62 offset:24576
    ds_read_b64_tr_b16 a[186:187], v62 offset:28672
    s_waitcnt lgkmcnt(12)
    v_mfma_f32_16x16x32_bf16 v[96:99], a[160:163], a[60:63], v[96:99]
    ds_read_b64_tr_b16 a[188:189], v63 offset:24576
    ds_read_b64_tr_b16 a[190:191], v63 offset:28672
    s_waitcnt lgkmcnt(12)
    v_mfma_f32_16x16x32_bf16 v[100:103], a[164:167], a[60:63], v[100:103]
    s_waitcnt lgkmcnt(10)
    v_mfma_f32_16x16x32_bf16 v[104:107], a[168:171], a[60:63], v[104:107]
    s_waitcnt lgkmcnt(8)
    v_mfma_f32_16x16x32_bf16 v[108:111], a[172:175], a[60:63], v[108:111]
    s_waitcnt lgkmcnt(6)
    v_mfma_f32_16x16x32_bf16 v[112:115], a[176:179], a[60:63], v[112:115]
    s_waitcnt lgkmcnt(4)
    v_mfma_f32_16x16x32_bf16 v[116:119], a[180:183], a[60:63], v[116:119]
    s_waitcnt lgkmcnt(2)
    v_mfma_f32_16x16x32_bf16 v[120:123], a[184:187], a[60:63], v[120:123]
    s_waitcnt lgkmcnt(0)
    v_mfma_f32_16x16x32_bf16 v[124:127], a[188:191], a[60:63], v[124:127]
    s_waitcnt vmcnt(11)
    v_mfma_f32_16x16x32_bf16 v[128:131], v[28:31], v[164:167], v[128:131]
    v_mfma_f32_16x16x32_bf16 v[132:135], v[26:29], v[164:167], v[132:135]
    s_waitcnt vmcnt(10)
    v_mfma_f32_16x16x32_bf16 v[136:139], v[28:31], v[172:175], v[136:139]
    v_mfma_f32_16x16x32_bf16 v[140:143], v[26:29], v[172:175], v[140:143]
    s_waitcnt vmcnt(9)
    v_mfma_f32_16x16x32_bf16 v[144:147], v[28:31], v[180:183], v[144:147]
    v_mfma_f32_16x16x32_bf16 v[148:151], v[26:29], v[180:183], v[148:151]
    s_waitcnt vmcnt(8)
    v_mfma_f32_16x16x32_bf16 v[152:155], v[28:31], v[188:191], v[152:155]
    v_mfma_f32_16x16x32_bf16 v[156:159], v[26:29], v[188:191], v[156:159]
    s_waitcnt vmcnt(7)
    v_mfma_f32_16x16x32_bf16 v[128:131], v[28:31], v[196:199], v[128:131]
    v_mfma_f32_16x16x32_bf16 v[132:135], v[26:29], v[196:199], v[132:135]
    s_waitcnt vmcnt(6)
    v_mfma_f32_16x16x32_bf16 v[136:139], v[28:31], v[204:207], v[136:139]
    v_mfma_f32_16x16x32_bf16 v[140:143], v[26:29], v[204:207], v[140:143]
    s_waitcnt vmcnt(5)
    v_mfma_f32_16x16x32_bf16 v[144:147], v[28:31], v[212:215], v[144:147]
    v_mfma_f32_16x16x32_bf16 v[148:151], v[26:29], v[212:215], v[148:151]
    s_waitcnt vmcnt(4)
    v_mfma_f32_16x16x32_bf16 v[152:155], v[28:31], v[220:223], v[152:155]
    v_mfma_f32_16x16x32_bf16 v[156:159], v[26:29], v[220:223], v[156:159]
    s_waitcnt vmcnt(3)
    v_mfma_f32_16x16x32_bf16 v[128:131], v[28:31], v[228:231], v[128:131]
    v_mfma_f32_16x16x32_bf16 v[132:135], v[26:29], v[228:231], v[132:135]
    s_waitcnt vmcnt(2)
    v_mfma_f32_16x16x32_bf16 v[136:139], v[28:31], v[236:239], v[136:139]
    v_mfma_f32_16x16x32_bf16 v[140:143], v[26:29], v[236:239], v[140:143]
    s_waitcnt vmcnt(1)
    v_mfma_f32_16x16x32_bf16 v[144:147], v[28:31], v[244:247], v[144:147]
    v_mfma_f32_16x16x32_bf16 v[148:151], v[26:29], v[244:247], v[148:151]
    s_waitcnt vmcnt(0)
    v_mfma_f32_16x16x32_bf16 v[152:155], v[28:31], v[252:255], v[152:155]
    v_mfma_f32_16x16x32_bf16 v[156:159], v[26:29], v[252:255], v[156:159]
    v_pk_mul_f32 v[34:35], v[128:129], s[14:15]
    v_pk_mul_f32 v[36:37], v[130:131], s[14:15]
    v_pk_mul_f32 v[38:39], v[132:133], s[14:15]
    v_pk_mul_f32 v[40:41], v[134:135], s[14:15]
    v_exp_f32 v34, v34
    v_exp_f32 v35, v35
    v_exp_f32 v36, v36
    v_exp_f32 v37, v37
    v_exp_f32 v38, v38
    v_exp_f32 v39, v39
    v_exp_f32 v40, v40
    v_exp_f32 v41, v41
    v_pk_mul_f32 v[96:97], v[96:97], v[128:129]
    v_pk_mul_f32 v[98:99], v[98:99], v[130:131]
    v_pk_mul_f32 v[100:101], v[100:101], v[132:133]
    v_pk_mul_f32 v[102:103], v[102:103], v[134:135]
    v_pk_add_f32 v[34:35], v[34:35], 1.0 op_sel_hi:[1,0]
    v_pk_add_f32 v[36:37], v[36:37], 1.0 op_sel_hi:[1,0]
    v_pk_add_f32 v[38:39], v[38:39], 1.0 op_sel_hi:[1,0]
    v_pk_add_f32 v[40:41], v[40:41], 1.0 op_sel_hi:[1,0]
    v_rcp_f32 v34, v34
    v_rcp_f32 v35, v35
    v_rcp_f32 v36, v36
    v_rcp_f32 v37, v37
    v_rcp_f32 v38, v38
    v_rcp_f32 v39, v39
    v_rcp_f32 v40, v40
    v_rcp_f32 v41, v41
    v_pk_fma_f32 v[96:97], v[96:97], v[34:35], v[64:65]
    v_pk_fma_f32 v[98:99], v[98:99], v[36:37], v[66:67]
    v_pk_fma_f32 v[100:101], v[100:101], v[38:39], v[68:69]
    v_pk_fma_f32 v[102:103], v[102:103], v[40:41], v[70:71]
    v_cvt_pk_bf16_f32 v96, v96, v97
    v_cvt_pk_bf16_f32 v97, v98, v99
    v_cvt_pk_bf16_f32 v98, v100, v101
    v_cvt_pk_bf16_f32 v99, v102, v103
    s_nop 0
    v_permlane16_swap_b32 v96, v98
    v_permlane16_swap_b32 v97, v99
    global_store_dwordx4 v2, v[96:99], s[22:23] offset:0 sc1
    v_pk_mul_f32 v[34:35], v[136:137], s[14:15]
    v_pk_mul_f32 v[36:37], v[138:139], s[14:15]
    v_pk_mul_f32 v[38:39], v[140:141], s[14:15]
    v_pk_mul_f32 v[40:41], v[142:143], s[14:15]
    v_exp_f32 v34, v34
    v_exp_f32 v35, v35
    v_exp_f32 v36, v36
    v_exp_f32 v37, v37
    v_exp_f32 v38, v38
    v_exp_f32 v39, v39
    v_exp_f32 v40, v40
    v_exp_f32 v41, v41
    v_pk_mul_f32 v[104:105], v[104:105], v[136:137]
    v_pk_mul_f32 v[106:107], v[106:107], v[138:139]
    v_pk_mul_f32 v[108:109], v[108:109], v[140:141]
    v_pk_mul_f32 v[110:111], v[110:111], v[142:143]
    v_pk_add_f32 v[34:35], v[34:35], 1.0 op_sel_hi:[1,0]
    v_pk_add_f32 v[36:37], v[36:37], 1.0 op_sel_hi:[1,0]
    v_pk_add_f32 v[38:39], v[38:39], 1.0 op_sel_hi:[1,0]
    v_pk_add_f32 v[40:41], v[40:41], 1.0 op_sel_hi:[1,0]
    v_rcp_f32 v34, v34
    v_rcp_f32 v35, v35
    v_rcp_f32 v36, v36
    v_rcp_f32 v37, v37
    v_rcp_f32 v38, v38
    v_rcp_f32 v39, v39
    v_rcp_f32 v40, v40
    v_rcp_f32 v41, v41
    v_pk_fma_f32 v[104:105], v[104:105], v[34:35], v[72:73]
    v_pk_fma_f32 v[106:107], v[106:107], v[36:37], v[74:75]
    v_pk_fma_f32 v[108:109], v[108:109], v[38:39], v[76:77]
    v_pk_fma_f32 v[110:111], v[110:111], v[40:41], v[78:79]
    v_cvt_pk_bf16_f32 v104, v104, v105
    v_cvt_pk_bf16_f32 v105, v106, v107
    v_cvt_pk_bf16_f32 v106, v108, v109
    v_cvt_pk_bf16_f32 v107, v110, v111
    s_nop 0
    v_permlane16_swap_b32 v104, v106
    v_permlane16_swap_b32 v105, v107
    global_store_dwordx4 v2, v[104:107], s[22:23] offset:64 sc1
    v_pk_mul_f32 v[34:35], v[144:145], s[14:15]
    v_pk_mul_f32 v[36:37], v[146:147], s[14:15]
    v_pk_mul_f32 v[38:39], v[148:149], s[14:15]
    v_pk_mul_f32 v[40:41], v[150:151], s[14:15]
    v_exp_f32 v34, v34
    v_exp_f32 v35, v35
    v_exp_f32 v36, v36
    v_exp_f32 v37, v37
    v_exp_f32 v38, v38
    v_exp_f32 v39, v39
    v_exp_f32 v40, v40
    v_exp_f32 v41, v41
    v_pk_mul_f32 v[112:113], v[112:113], v[144:145]
    v_pk_mul_f32 v[114:115], v[114:115], v[146:147]
    v_pk_mul_f32 v[116:117], v[116:117], v[148:149]
    v_pk_mul_f32 v[118:119], v[118:119], v[150:151]
    v_pk_add_f32 v[34:35], v[34:35], 1.0 op_sel_hi:[1,0]
    v_pk_add_f32 v[36:37], v[36:37], 1.0 op_sel_hi:[1,0]
    v_pk_add_f32 v[38:39], v[38:39], 1.0 op_sel_hi:[1,0]
    v_pk_add_f32 v[40:41], v[40:41], 1.0 op_sel_hi:[1,0]
    v_rcp_f32 v34, v34
    v_rcp_f32 v35, v35
    v_rcp_f32 v36, v36
    v_rcp_f32 v37, v37
    v_rcp_f32 v38, v38
    v_rcp_f32 v39, v39
    v_rcp_f32 v40, v40
    v_rcp_f32 v41, v41
    v_pk_fma_f32 v[112:113], v[112:113], v[34:35], v[80:81]
    v_pk_fma_f32 v[114:115], v[114:115], v[36:37], v[82:83]
    v_pk_fma_f32 v[116:117], v[116:117], v[38:39], v[84:85]
    v_pk_fma_f32 v[118:119], v[118:119], v[40:41], v[86:87]
    v_cvt_pk_bf16_f32 v112, v112, v113
    v_cvt_pk_bf16_f32 v113, v114, v115
    v_cvt_pk_bf16_f32 v114, v116, v117
    v_cvt_pk_bf16_f32 v115, v118, v119
    s_nop 0
    v_permlane16_swap_b32 v112, v114
    v_permlane16_swap_b32 v113, v115
    global_store_dwordx4 v2, v[112:115], s[22:23] offset:128 sc1
    v_pk_mul_f32 v[34:35], v[152:153], s[14:15]
    v_pk_mul_f32 v[36:37], v[154:155], s[14:15]
    v_pk_mul_f32 v[38:39], v[156:157], s[14:15]
    v_pk_mul_f32 v[40:41], v[158:159], s[14:15]
    v_exp_f32 v34, v34
    v_exp_f32 v35, v35
    v_exp_f32 v36, v36
    v_exp_f32 v37, v37
    v_exp_f32 v38, v38
    v_exp_f32 v39, v39
    v_exp_f32 v40, v40
    v_exp_f32 v41, v41
    v_pk_mul_f32 v[120:121], v[120:121], v[152:153]
    v_pk_mul_f32 v[122:123], v[122:123], v[154:155]
    v_pk_mul_f32 v[124:125], v[124:125], v[156:157]
    v_pk_mul_f32 v[126:127], v[126:127], v[158:159]
    v_pk_add_f32 v[34:35], v[34:35], 1.0 op_sel_hi:[1,0]
    v_pk_add_f32 v[36:37], v[36:37], 1.0 op_sel_hi:[1,0]
    v_pk_add_f32 v[38:39], v[38:39], 1.0 op_sel_hi:[1,0]
    v_pk_add_f32 v[40:41], v[40:41], 1.0 op_sel_hi:[1,0]
    v_rcp_f32 v34, v34
    v_rcp_f32 v35, v35
    v_rcp_f32 v36, v36
    v_rcp_f32 v37, v37
    v_rcp_f32 v38, v38
    v_rcp_f32 v39, v39
    v_rcp_f32 v40, v40
    v_rcp_f32 v41, v41
    v_pk_fma_f32 v[120:121], v[120:121], v[34:35], v[88:89]
    v_pk_fma_f32 v[122:123], v[122:123], v[36:37], v[90:91]
    v_pk_fma_f32 v[124:125], v[124:125], v[38:39], v[92:93]
    v_pk_fma_f32 v[126:127], v[126:127], v[40:41], v[94:95]
    v_cvt_pk_bf16_f32 v120, v120, v121
    v_cvt_pk_bf16_f32 v121, v122, v123
    v_cvt_pk_bf16_f32 v122, v124, v125
    v_cvt_pk_bf16_f32 v123, v126, v127
    s_nop 0
    v_permlane16_swap_b32 v120, v122
    v_permlane16_swap_b32 v121, v123
    global_store_dwordx4 v2, v[120:123], s[22:23] offset:192 sc1
L_end:
    s_endpgm
L_spB:
    buffer_load_dword v43, off, s[56:59], s92 sc1
    s_waitcnt vmcnt(0)
    v_readfirstlane_b32 s86, v43
    s_bfe_u32 s86, s86, 0x80008
    s_cmp_eq_u32 s86, 16
    s_cbranch_scc1 L_okB
    s_add_u32 s67, s67, 1
    s_cmp_lt_u32 s67, 0x40000
    s_cbranch_scc1 L_spB
    s_branch L_okB
L_spC:
    buffer_load_dword v43, off, s[56:59], s92 sc1
    s_waitcnt vmcnt(0)
    v_readfirstlane_b32 s86, v43
    s_bfe_u32 s86, s86, 0x80010
    s_cmp_eq_u32 s86, 16
    s_cbranch_scc1 L_okC
    s_add_u32 s67, s67, 1
    s_cmp_lt_u32 s67, 0x40000
    s_cbranch_scc1 L_spC
    s_branch L_okC
L_spO:
    buffer_load_dword v43, off, s[56:59], s76 sc1
    s_waitcnt vmcnt(0)
    v_readfirstlane_b32 s86, v43
    s_cmp_eq_u32 s86, 64
    s_cbranch_scc1 L_okO
    s_add_u32 s67, s67, 1
    s_cmp_lt_u32 s67, 0x40000
    s_cbranch_scc1 L_spO
    s_branch L_okO
L_spP:
    buffer_load_dword v43, off, s[56:59], s77 sc1
    s_waitcnt vmcnt(0)
    v_readfirstlane_b32 s86, v43
    s_cmp_eq_u32 s86, 4
    s_cbranch_scc1 L_okP
    s_add_u32 s67, s67, 1
    s_cmp_lt_u32 s67, 0x40000
    s_cbranch_scc1 L_spP
    s_branch L_okP
L_code_end:
.section .rodata,"a"
.p2align 6
.amdhsa_kernel recurrent_scan__sliding_local_dilated__glu_gated_geglu__prompt_kernel
  .amdhsa_next_free_vgpr 512
  .amdhsa_next_free_sgpr 102
  .amdhsa_accum_offset 256
  .amdhsa_group_segment_fixed_size 0
  .amdhsa_kernarg_size 80
  .amdhsa_user_sgpr_count 2
  .amdhsa_user_sgpr_kernarg_segment_ptr 1
  .amdhsa_system_sgpr_workgroup_id_x 1
.end_amdhsa_kernel
```

```asm
; @launch grid=(256,1,1) block=(256,1,1) lds=163840
.amdgcn_target "amdgcn-amd-amdhsa--gfx950"
.text
.p2align 8
.globl recurrent_scan__sliding_local_dilated__glu_gated_geglu__prompt_kernel
.type recurrent_scan__sliding_local_dilated__glu_gated_geglu__prompt_kernel,@function
recurrent_scan__sliding_local_dilated__glu_gated_geglu__prompt_kernel:
    s_cmp_ge_u32 s2, 256
    s_cbranch_scc1 L_end
    s_load_dwordx16 s[8:23], s[0:1], 0
    s_load_dwordx4 s[24:27], s[0:1], 64
    v_lshrrev_b32 v1, 6, v0
    v_and_b32 v0, 63, v0
    v_readfirstlane_b32 s60, v1
    s_getpc_b64 s[86:87]
L_pc:
    s_lshr_b32 s82, s2, 3
    s_lshl_b32 s82, s82, 2
    s_add_u32 s82, s82, s60
    s_lshl_b32 s82, s82, 10
    v_lshl_add_u32 v2, v0, 4, s82
    v_min_u32 v2, L_code_end-L_pc-4, v2
    global_load_dword v7, v2, s[86:87]
    s_and_b32 s82, s2, 7
    s_lshr_b32 s83, s2, 3
    s_lshr_b32 s65, s82, 1
    s_and_b32 s63, s82, 1
    s_lshl_b32 s63, s63, 2
    s_and_b32 s84, s83, 3
    s_add_u32 s63, s63, s84
    s_lshr_b32 s66, s83, 2
    s_lshl_b32 s64, s65, 3
    s_add_u32 s64, s64, s66
    s_lshr_b32 s61, s60, 1
    s_and_b32 s62, s60, 1
    v_lshlrev_b32 v16, 4, v0
    s_lshl_b32 s84, s64, 2
    s_add_u32 s84, s84, s60
    s_lshl_b32 s85, s63, 7
    s_add_u32 s84, s84, s85
    s_lshl_b32 s85, s84, 12
    v_add_u32 v36, s85, v16
    s_lshl_b32 s84, s84, 2
    s_add_u32 s84, s84, 39845888
    v_mov_b32 v37, s84
    s_waitcnt lgkmcnt(0)
    global_load_dwordx4 v[48:51], v36, s[8:9] offset:0
    global_load_dwordx4 v[52:55], v36, s[8:9] offset:1024
    global_load_dwordx4 v[56:59], v36, s[8:9] offset:2048
    global_load_dwordx4 v[60:63], v36, s[8:9] offset:3072
    s_lshl_b32 s84, s63, 9
    s_lshl_b32 s85, s61, 8
    s_add_u32 s85, s85, s84
    s_sub_u32 s84, s84, 32
    s_max_i32 s84, s84, 0
    s_cmp_eq_u32 s62, 0
    s_cselect_b32 s85, s85, s84
    s_cselect_b32 s84, 63, 7
    s_add_u32 s85, s85, 39845888
    v_and_b32 v38, s84, v0
    v_lshlrev_b32 v38, 2, v38
    v_add_u32 v38, s85, v38
    global_load_dword v39, v38, s[26:27] sc1
    global_load_dword v40, v37, s[26:27] sc1
    v_lshlrev_b32 v2, 6, v0
    v_sub_u32 v2, v2, v16
    v_add_u32 v2, v2, v36
    global_load_dword v7, v2, s[26:27] sc1
    s_sub_u32 s84, s63, s62
    s_max_i32 s84, s84, 0
    s_lshl_b32 s84, s84, 5
    v_mov_b32 v41, s84
    s_mov_b32 s56, s26
    s_and_b32 s57, s27, 0xffff
    s_mov_b32 s58, 0x10000000
    s_mov_b32 s59, 0x20000
    s_lshl_b32 s84, s63, 2
    s_add_u32 s84, s84, s65
    s_lshl_b32 s92, s84, 8
    s_add_u32 s92, s92, 39849984
    s_mul_i32 s88, s84, 458752
    s_add_u32 s88, s88, 8388608
    s_lshl_b32 s93, s63, 8
    s_add_u32 s93, s93, 39858176
    s_cmp_lg_u32 s60, 3
    s_cbranch_scc1 L_nozero
    s_lshl_b32 s84, s63, 3
    s_add_u32 s84, s84, s66
    s_lshl_b32 s84, s84, 2
    s_add_u32 s84, s84, s65
    s_lshl_b32 s84, s84, 8
    s_add_u32 s84, s84, 39862272
    v_mov_b32 v2, s84
    v_writelane_b32 v2, s92, 1
    v_writelane_b32 v2, s93, 2
    s_cmp_eq_u32 s66, 0
    s_cselect_b32 s84, 3, 1
    s_cmp_eq_u32 s64, 0
    s_cselect_b32 s84, 7, s84
    v_mov_b32 v3, 0
    s_mov_b32 exec_hi, 0
    s_mov_b32 exec_lo, s84
    global_store_dword v2, v3, s[26:27] sc1
    s_mov_b64 exec, -1
L_nozero:
    v_lshrrev_b32 v20, 2, v0
    v_and_b32 v21, 3, v0
    v_lshrrev_b32 v22, 4, v0
    v_and_b32 v23, 15, v0
    v_lshrrev_b32 v24, 3, v20
    v_lshlrev_b32 v24, 1, v24
    v_xor_b32 v24, v21, v24
    v_mul_u32_u24 v2, 6144, v20
    v_lshl_add_u32 v2, v24, 4, v2
    v_mul_u32_u24 v25, 7168, v20
    v_lshl_add_u32 v3, v24, 4, v25
    s_mul_i32 s84, s61, 98304
    s_lshl_b32 s85, s64, 6
    s_add_u32 s84, s84, s85
    s_add_u32 s32, s10, s84
    s_addc_u32 s33, s11, 0
    s_sub_u32 s32, s32, 4096
    s_subb_u32 s33, s33, 0
    s_and_b32 s33, s33, 0xffff
    s_sub_u32 s34, 6295552, s84
    s_mov_b32 s35, 0x20000
    s_mul_i32 s84, s61, 114688
    s_mul_i32 s85, s64, 224
    s_add_u32 s84, s84, s85
    s_add_u32 s36, s16, s84
    s_addc_u32 s37, s17, 0
    s_sub_u32 s36, s36, 4096
    s_subb_u32 s37, s37, 0
    s_and_b32 s37, s37, 0xffff
    s_sub_u32 s38, 7344128, s84
    s_mov_b32 s39, 0x20000
    s_add_u32 s40, s18, s84
    s_addc_u32 s41, s19, 0
    s_sub_u32 s40, s40, 4096
    s_subb_u32 s41, s41, 0
    s_and_b32 s41, s41, 0xffff
    s_sub_u32 s42, 7344128, s84
    s_mov_b32 s43, 0x20000
    v_cmp_lt_u32 vcc, 1, v24
    v_and_b32 v24, 1, v24
    v_lshl_add_u32 v24, v24, 4, v25
    v_add_u32 v24, 3264, v24
    v_mov_b32 v25, 0
    s_add_u32 s82, s16, s84
    s_addc_u32 s83, s17, 0
    s_sub_u32 s82, s82, 4096
    s_subb_u32 s83, s83, 0
    v_lshl_add_u64 v[4:5], v[24:25], 0, s[82:83]
    s_add_u32 s82, s18, s84
    s_addc_u32 s83, s19, 0
    s_sub_u32 s82, s82, 4096
    s_subb_u32 s83, s83, 0
    v_lshl_add_u64 v[24:25], v[24:25], 0, s[82:83]
    v_cndmask_b32 v4, v4, v24, vcc
    v_cndmask_b32 v5, v5, v25, vcc
    s_mov_b32 s80, 229376
    s_mov_b32 s81, 0
    s_cmp_eq_u32 s62, 1
    s_cbranch_scc1 L_init1
    s_lshl_b32 s78, s61, 14
    s_mov_b32 s68, 4096
    s_mov_b32 s69, 19456
    s_mov_b32 s70, 34816
    s_mov_b32 s71, 50176
    s_mov_b32 s72, 69632
    s_mov_b32 s73, 84992
    s_mov_b32 s74, 100352
    s_mov_b32 s75, 115712
    s_lshl_b32 s84, s63, 1
    s_add_u32 s84, s84, s61
    s_lshl_b32 s84, s84, 18
    s_branch L_init2
L_init1:
    s_mul_i32 s78, s61, 10240
    s_add_u32 s78, s78, 69632
    s_mov_b32 s68, 6144
    s_mov_b32 s69, 7168
    s_mov_b32 s70, 2048
    s_mov_b32 s71, 1024
    s_mov_b32 s72, 4096
    s_mov_b32 s73, 3136
    s_mov_b32 s74, 2112
    s_mov_b32 s75, 1152
    s_mov_b32 s76, 4224
    s_mov_b32 s14, 151552
    s_cmp_eq_u32 s61, 0
    s_cselect_b32 s15, 67584, s14
    s_cselect_b32 s14, 32768, s14
    s_lshl_b32 s84, s63, 19
    s_sub_u32 s84, s84, 32768
    s_max_i32 s84, s84, 0
L_init2:
    s_add_u32 s28, s26, s84
    s_addc_u32 s29, s27, 0
    s_sub_u32 s28, s28, 4096
    s_subb_u32 s29, s29, 0
    s_and_b32 s29, s29, 0xffff
    s_sub_u32 s30, 4198400, s84
    s_mov_b32 s31, 0x20000
    v_lshrrev_b32 v24, 3, v0
    v_and_b32 v25, 6, v24
    v_and_b32 v1, 7, v0
    v_xor_b32 v25, v25, v1
    v_lshlrev_b32 v25, 4, v25
    v_lshl_add_u32 v1, v24, 11, v25
    s_cmp_eq_u32 s63, 0
    s_cselect_b32 s84, 1, 3
    s_and_b32 s85, s60, s84
    s_cmp_eq_u32 s85, s84
    s_cselect_b32 s85, 0x40000000, 0
    s_cselect_b32 s87, 1, 0
    v_add_u32 v1, s85, v1
    s_lshr_b32 s83, s2, 3
    v_lshrrev_b32 v24, 3, v0
    v_and_b32 v25, 7, v0
    s_lshr_b32 s84, s63, 2
    s_lshl_b32 s84, s84, 4
    s_lshr_b32 s85, s83, 1
    s_add_u32 s84, s84, s85
    s_and_b32 s83, s83, 1
    s_cmp_eq_u32 s60, 0
    s_cbranch_scc1 L_pf0
    s_cmp_eq_u32 s60, 1
    s_cselect_b32 s44, s16, s18
    s_cselect_b32 s45, s17, s19
    s_cmp_eq_u32 s60, 3
    s_cselect_b32 s46, 0, 7340032
    s_mov_b32 s79, 229376
    s_mul_i32 s84, s84, 7168
    s_lshl_b32 s85, s65, 1
    s_add_u32 s85, s85, s83
    s_mul_i32 s85, s85, 896
    s_add_u32 s84, s84, s85
    v_cmp_gt_u32 vcc, 7, v25
    v_lshlrev_b32 v25, 7, v25
    s_branch L_pfd
L_pf0:
    s_mov_b32 s44, s10
    s_mov_b32 s45, s11
    s_mov_b32 s46, 6291456
    s_mov_b32 s79, 196608
    s_mul_i32 s84, s84, 6144
    s_lshl_b32 s85, s65, 1
    s_add_u32 s85, s85, s83
    s_lshl_b32 s85, s85, 8
    s_add_u32 s84, s84, s85
    v_cmp_gt_u32 vcc, 6, v25
    v_and_b32 v6, 1, v25
    v_lshrrev_b32 v25, 1, v25
    v_lshlrev_b32 v25, 11, v25
    v_lshl_add_u32 v25, v6, 7, v25
L_pfd:
    v_add_u32 v25, s84, v25
    v_mov_b32 v6, 0x40000000
    v_cndmask_b32 v25, v6, v25, vcc
    v_mul_lo_u32 v42, v24, s79
    v_add_u32 v42, v42, v25
    v_cmp_gt_u32 vcc, 2, v24
    s_nop 1
    v_cndmask_b32 v6, v6, v42, vcc
    s_mul_i32 s84, s79, 8
    v_add_u32 v6, s84, v6
    s_lshl_b32 s86, s79, 3
    s_mul_i32 s79, s79, 2
    s_lshr_b32 s84, s2, 3
    s_and_b32 s84, s84, 0
    s_cmp_eq_u32 s84, 0
    s_cselect_b32 s4, 0, 0x40000000
    s_cmp_lg_u32 s60, 3
    s_cbranch_scc1 L_pf3d
    s_and_b32 s84, s2, 7
    s_lshl_b32 s84, s84, 5
    s_lshr_b32 s85, s2, 3
    s_add_u32 s84, s84, s85
    s_mul_i32 s84, s84, 28672
    s_add_u32 s44, s20, s84
    s_addc_u32 s45, s21, 0
    s_mov_b32 s46, 28672
    s_mov_b32 s79, 0
    v_lshlrev_b32 v6, 7, v0
    v_subrev_u32 v6, 0, v6
    v_mov_b32 v42, 0x40000000
    v_cmp_gt_u32 vcc, 0, v0
    s_nop 1
    v_cndmask_b32 v6, v42, v6, vcc
L_pf3d:
    s_and_b32 s45, s45, 0xffff
    s_mov_b32 s47, 0x20000
    v_and_b32 v24, 6, v23
    v_xor_b32 v24, v24, v22
    v_lshlrev_b32 v24, 4, v24
    v_lshl_add_u32 v24, v23, 7, v24
    v_xor_b32 v25, 64, v24
    s_lshl_b32 s84, s61, 14
    v_add_u32 v8, s84, v24
    v_add_u32 v9, s84, v25
    s_mul_i32 s84, s61, -18432
    s_add_u32 s84, s84, 32768
    v_add_u32 v10, s84, v24
    v_add_u32 v11, s84, v25
    v_lshrrev_b32 v24, 5, v0
    v_mul_u32_u24 v24, 10240, v24
    v_and_b32 v26, 1, v22
    v_bfe_u32 v25, v0, 2, 2
    v_lshl_add_u32 v25, v26, 3, v25
    v_lshl_add_u32 v24, v25, 6, v24
    v_and_b32 v25, 1, v0
    v_lshl_add_u32 v24, v25, 3, v24
    v_bfe_u32 v27, v0, 1, 1
    v_lshlrev_b32 v26, 1, v26
    s_mul_i32 s84, s62, 5120
    s_add_u32 s84, s84, 69632
    v_add_u32 v24, s84, v24
    v_add_u32 v25, 0, v27
    v_xor_b32 v25, v25, v26
    v_lshl_add_u32 v12, v25, 4, v24
    v_add_u32 v13, 40960, v12
    v_add_u32 v25, 2, v27
    v_xor_b32 v25, v25, v26
    v_lshl_add_u32 v14, v25, 4, v24
    v_add_u32 v15, 40960, v14
    v_mov_b32 v28, 0
    v_mov_b32 v29, 0
    v_mov_b32 v30, 0
    v_mov_b32 v31, 0
    s_cmp_eq_u32 s62, 1
    s_cbranch_scc1 L_early1
    v_mfma_f32_32x32x16_bf16 a[128:143], v[28:31], v[28:31], 0
    v_mfma_f32_32x32x16_bf16 a[144:159], v[28:31], v[28:31], 0
    v_mfma_f32_32x32x16_bf16 a[160:175], v[28:31], v[28:31], 0
    v_mfma_f32_32x32x16_bf16 a[176:191], v[28:31], v[28:31], 0
    v_mfma_f32_32x32x16_bf16 a[192:207], v[28:31], v[28:31], 0
    v_mfma_f32_32x32x16_bf16 a[208:223], v[28:31], v[28:31], 0
    v_mfma_f32_32x32x16_bf16 a[224:239], v[28:31], v[28:31], 0
    v_mfma_f32_32x32x16_bf16 a[240:255], v[28:31], v[28:31], 0
    v_mfma_f32_32x32x16_bf16 v[128:143], v[28:31], v[28:31], 0
    v_mfma_f32_32x32x16_bf16 v[144:159], v[28:31], v[28:31], 0
    v_mfma_f32_32x32x16_bf16 v[160:175], v[28:31], v[28:31], 0
    v_mfma_f32_32x32x16_bf16 v[176:191], v[28:31], v[28:31], 0
    v_mfma_f32_32x32x16_bf16 v[192:207], v[28:31], v[28:31], 0
    v_mfma_f32_32x32x16_bf16 v[208:223], v[28:31], v[28:31], 0
    v_mfma_f32_32x32x16_bf16 v[224:239], v[28:31], v[28:31], 0
    v_mfma_f32_32x32x16_bf16 v[240:255], v[28:31], v[28:31], 0
    s_waitcnt vmcnt(3)
    s_branch L_ln
L_early1:
    v_mfma_f32_32x32x16_bf16 a[128:143], v[28:31], v[28:31], 0
    v_mfma_f32_32x32x16_bf16 a[144:159], v[28:31], v[28:31], 0
    v_mfma_f32_32x32x16_bf16 a[160:175], v[28:31], v[28:31], 0
    v_mfma_f32_32x32x16_bf16 a[176:191], v[28:31], v[28:31], 0
    v_mfma_f32_32x32x16_bf16 a[192:207], v[28:31], v[28:31], 0
    v_mfma_f32_32x32x16_bf16 a[208:223], v[28:31], v[28:31], 0
    v_mfma_f32_32x32x16_bf16 a[224:239], v[28:31], v[28:31], 0
    v_mfma_f32_32x32x16_bf16 a[240:255], v[28:31], v[28:31], 0
    v_mfma_f32_32x32x16_bf16 v[128:143], v[28:31], v[28:31], 0
    v_mfma_f32_32x32x16_bf16 v[144:159], v[28:31], v[28:31], 0
    v_mfma_f32_32x32x16_bf16 v[160:175], v[28:31], v[28:31], 0
    v_mfma_f32_32x32x16_bf16 v[176:191], v[28:31], v[28:31], 0
    v_mfma_f32_32x32x16_bf16 v[192:207], v[28:31], v[28:31], 0
    v_mfma_f32_32x32x16_bf16 v[208:223], v[28:31], v[28:31], 0
    v_mfma_f32_32x32x16_bf16 v[224:239], v[28:31], v[28:31], 0
    v_mfma_f32_32x32x16_bf16 v[240:255], v[28:31], v[28:31], 0
    s_waitcnt vmcnt(3)
L_ln:
    v_lshlrev_b32 v64, 16, v48
    v_and_b32 v65, 0xffff0000, v48
    v_lshlrev_b32 v66, 16, v49
    v_and_b32 v67, 0xffff0000, v49
    v_lshlrev_b32 v68, 16, v50
    v_and_b32 v69, 0xffff0000, v50
    v_lshlrev_b32 v70, 16, v51
    v_and_b32 v71, 0xffff0000, v51
    v_lshlrev_b32 v72, 16, v52
    v_and_b32 v73, 0xffff0000, v52
    v_lshlrev_b32 v74, 16, v53
    v_and_b32 v75, 0xffff0000, v53
    v_lshlrev_b32 v76, 16, v54
    v_and_b32 v77, 0xffff0000, v54
    v_lshlrev_b32 v78, 16, v55
    v_and_b32 v79, 0xffff0000, v55
    v_lshlrev_b32 v80, 16, v56
    v_and_b32 v81, 0xffff0000, v56
    v_lshlrev_b32 v82, 16, v57
    v_and_b32 v83, 0xffff0000, v57
    v_lshlrev_b32 v84, 16, v58
    v_and_b32 v85, 0xffff0000, v58
    v_lshlrev_b32 v86, 16, v59
    v_and_b32 v87, 0xffff0000, v59
    v_lshlrev_b32 v88, 16, v60
    v_and_b32 v89, 0xffff0000, v60
    v_lshlrev_b32 v90, 16, v61
    v_and_b32 v91, 0xffff0000, v61
    v_lshlrev_b32 v92, 16, v62
    v_and_b32 v93, 0xffff0000, v62
    v_lshlrev_b32 v94, 16, v63
    v_and_b32 v95, 0xffff0000, v63
    v_pk_add_f32 v[96:97], v[64:65], v[66:67]
    v_pk_add_f32 v[98:99], v[80:81], v[82:83]
    v_pk_add_f32 v[96:97], v[96:97], v[68:69]
    v_pk_add_f32 v[98:99], v[98:99], v[84:85]
    v_pk_add_f32 v[96:97], v[96:97], v[70:71]
    v_pk_add_f32 v[98:99], v[98:99], v[86:87]
    v_pk_add_f32 v[96:97], v[96:97], v[72:73]
    v_pk_add_f32 v[98:99], v[98:99], v[88:89]
    v_pk_add_f32 v[96:97], v[96:97], v[74:75]
    v_pk_add_f32 v[98:99], v[98:99], v[90:91]
    v_pk_add_f32 v[96:97], v[96:97], v[76:77]
    v_pk_add_f32 v[98:99], v[98:99], v[92:93]
    v_pk_add_f32 v[96:97], v[96:97], v[78:79]
    v_pk_add_f32 v[98:99], v[98:99], v[94:95]
    v_add_f32 v102, v96, v97
    v_add_f32 v103, v98, v99
    s_nop 1
    v_permlane32_swap_b32 v102, v103
    v_add_f32 v102, v102, v103
    v_mov_b32 v100, v102
    s_nop 1
    v_permlane16_swap_b32 v102, v100
    v_add_f32 v102, v102, v100
    s_nop 1
    v_add_f32_dpp v102, v102, v102 quad_perm:[1,0,3,2] row_mask:0xf bank_mask:0xf
    s_nop 1
    v_add_f32_dpp v102, v102, v102 quad_perm:[2,3,0,1] row_mask:0xf bank_mask:0xf
    s_nop 1
    v_add_f32_dpp v102, v102, v102 row_half_mirror row_mask:0xf bank_mask:0xf
    s_nop 1
    v_add_f32_dpp v102, v102, v102 row_mirror row_mask:0xf bank_mask:0xf
    v_mul_f32 v102, 0xba800000, v102
    v_cvt_pk_bf16_f32 v106, v102, v102
    v_lshlrev_b32 v106, 16, v106
    v_mov_b32 v103, v102
    s_nop 1
    v_permlane32_swap_b32 v102, v103
    v_mov_b32 v107, v106
    s_nop 1
    v_permlane32_swap_b32 v106, v107
    v_pk_add_f32 v[108:109], v[64:65], v[102:103] op_sel_hi:[1,0]
    v_pk_add_f32 v[110:111], v[80:81], v[102:103] op_sel:[0,1] op_sel_hi:[1,1]
    v_pk_mul_f32 v[96:97], v[108:109], v[108:109]
    v_pk_mul_f32 v[98:99], v[110:111], v[110:111]
    v_pk_add_f32 v[108:109], v[66:67], v[102:103] op_sel_hi:[1,0]
    v_pk_add_f32 v[110:111], v[82:83], v[102:103] op_sel:[0,1] op_sel_hi:[1,1]
    v_pk_fma_f32 v[96:97], v[108:109], v[108:109], v[96:97]
    v_pk_fma_f32 v[98:99], v[110:111], v[110:111], v[98:99]
    v_pk_add_f32 v[108:109], v[68:69], v[102:103] op_sel_hi:[1,0]
    v_pk_add_f32 v[110:111], v[84:85], v[102:103] op_sel:[0,1] op_sel_hi:[1,1]
    v_pk_fma_f32 v[96:97], v[108:109], v[108:109], v[96:97]
    v_pk_fma_f32 v[98:99], v[110:111], v[110:111], v[98:99]
    v_pk_add_f32 v[108:109], v[70:71], v[102:103] op_sel_hi:[1,0]
    v_pk_add_f32 v[110:111], v[86:87], v[102:103] op_sel:[0,1] op_sel_hi:[1,1]
    v_pk_fma_f32 v[96:97], v[108:109], v[108:109], v[96:97]
    v_pk_fma_f32 v[98:99], v[110:111], v[110:111], v[98:99]
    v_pk_add_f32 v[108:109], v[72:73], v[102:103] op_sel_hi:[1,0]
    v_pk_add_f32 v[110:111], v[88:89], v[102:103] op_sel:[0,1] op_sel_hi:[1,1]
    v_pk_fma_f32 v[96:97], v[108:109], v[108:109], v[96:97]
    v_pk_fma_f32 v[98:99], v[110:111], v[110:111], v[98:99]
    v_pk_add_f32 v[108:109], v[74:75], v[102:103] op_sel_hi:[1,0]
    v_pk_add_f32 v[110:111], v[90:91], v[102:103] op_sel:[0,1] op_sel_hi:[1,1]
    v_pk_fma_f32 v[96:97], v[108:109], v[108:109], v[96:97]
    v_pk_fma_f32 v[98:99], v[110:111], v[110:111], v[98:99]
    v_pk_add_f32 v[108:109], v[76:77], v[102:103] op_sel_hi:[1,0]
    v_pk_add_f32 v[110:111], v[92:93], v[102:103] op_sel:[0,1] op_sel_hi:[1,1]
    v_pk_fma_f32 v[96:97], v[108:109], v[108:109], v[96:97]
    v_pk_fma_f32 v[98:99], v[110:111], v[110:111], v[98:99]
    v_pk_add_f32 v[108:109], v[78:79], v[102:103] op_sel_hi:[1,0]
    v_pk_add_f32 v[110:111], v[94:95], v[102:103] op_sel:[0,1] op_sel_hi:[1,1]
    v_pk_fma_f32 v[96:97], v[108:109], v[108:109], v[96:97]
    v_pk_fma_f32 v[98:99], v[110:111], v[110:111], v[98:99]
    v_add_f32 v104, v96, v97
    v_add_f32 v105, v98, v99
    s_nop 1
    v_permlane32_swap_b32 v104, v105
    v_add_f32 v104, v104, v105
    v_mov_b32 v100, v104
    s_nop 1
    v_permlane16_swap_b32 v104, v100
    v_add_f32 v104, v104, v100
    s_nop 1
    v_add_f32_dpp v104, v104, v104 quad_perm:[1,0,3,2] row_mask:0xf bank_mask:0xf
    s_nop 1
    v_add_f32_dpp v104, v104, v104 quad_perm:[2,3,0,1] row_mask:0xf bank_mask:0xf
    s_nop 1
    v_add_f32_dpp v104, v104, v104 row_half_mirror row_mask:0xf bank_mask:0xf
    s_nop 1
    v_add_f32_dpp v104, v104, v104 row_mirror row_mask:0xf bank_mask:0xf
    v_mul_f32 v104, 0x3a800000, v104
    v_cvt_pk_bf16_f32 v104, v104, v104
    v_lshlrev_b32 v104, 16, v104
    v_add_f32 v104, 0x3727c5ac, v104
    v_cvt_pk_bf16_f32 v104, v104, v104
    v_lshlrev_b32 v104, 16, v104
    v_sqrt_f32 v104, v104
    s_nop 0
    v_cvt_pk_bf16_f32 v104, v104, v104
    v_lshlrev_b32 v104, 16, v104
    v_rcp_f32 v100, v104
    s_nop 0
    v_fma_f32 v104, -v104, v100, 1.0
    v_fma_f32 v104, v104, v100, v100
    v_mov_b32 v105, v104
    s_nop 1
    v_permlane32_swap_b32 v104, v105
    v_pk_add_f32 v[64:65], v[64:65], v[106:107] op_sel_hi:[1,0]
    v_pk_add_f32 v[66:67], v[66:67], v[106:107] op_sel_hi:[1,0]
    v_pk_add_f32 v[68:69], v[68:69], v[106:107] op_sel_hi:[1,0]
    v_pk_add_f32 v[70:71], v[70:71], v[106:107] op_sel_hi:[1,0]
    v_cvt_pk_bf16_f32 v65, v64, v65
    v_cvt_pk_bf16_f32 v67, v66, v67
    v_cvt_pk_bf16_f32 v69, v68, v69
    v_cvt_pk_bf16_f32 v71, v70, v71
    v_lshlrev_b32 v64, 16, v65
    v_and_b32 v65, 0xffff0000, v65
    v_lshlrev_b32 v66, 16, v67
    v_and_b32 v67, 0xffff0000, v67
    v_lshlrev_b32 v68, 16, v69
    v_and_b32 v69, 0xffff0000, v69
    v_lshlrev_b32 v70, 16, v71
    v_and_b32 v71, 0xffff0000, v71
    v_pk_mul_f32 v[64:65], v[64:65], v[104:105] op_sel_hi:[1,0]
    v_pk_mul_f32 v[66:67], v[66:67], v[104:105] op_sel_hi:[1,0]
    v_pk_mul_f32 v[68:69], v[68:69], v[104:105] op_sel_hi:[1,0]
    v_pk_mul_f32 v[70:71], v[70:71], v[104:105] op_sel_hi:[1,0]
    s_waitcnt vmcnt(0)
    v_cvt_pk_bf16_f32 v48, v64, v65
    v_cvt_pk_bf16_f32 v49, v66, v67
    v_cvt_pk_bf16_f32 v50, v68, v69
    v_cvt_pk_bf16_f32 v51, v70, v71
    global_store_dwordx4 v36, v[48:51], s[26:27] offset:0 sc1
    v_pk_add_f32 v[72:73], v[72:73], v[106:107] op_sel_hi:[1,0]
    v_pk_add_f32 v[74:75], v[74:75], v[106:107] op_sel_hi:[1,0]
    v_pk_add_f32 v[76:77], v[76:77], v[106:107] op_sel_hi:[1,0]
    v_pk_add_f32 v[78:79], v[78:79], v[106:107] op_sel_hi:[1,0]
    v_cvt_pk_bf16_f32 v73, v72, v73
    v_cvt_pk_bf16_f32 v75, v74, v75
    v_cvt_pk_bf16_f32 v77, v76, v77
    v_cvt_pk_bf16_f32 v79, v78, v79
    v_lshlrev_b32 v72, 16, v73
    v_and_b32 v73, 0xffff0000, v73
    v_lshlrev_b32 v74, 16, v75
    v_and_b32 v75, 0xffff0000, v75
    v_lshlrev_b32 v76, 16, v77
    v_and_b32 v77, 0xffff0000, v77
    v_lshlrev_b32 v78, 16, v79
    v_and_b32 v79, 0xffff0000, v79
    v_pk_mul_f32 v[72:73], v[72:73], v[104:105] op_sel_hi:[1,0]
    v_pk_mul_f32 v[74:75], v[74:75], v[104:105] op_sel_hi:[1,0]
    v_pk_mul_f32 v[76:77], v[76:77], v[104:105] op_sel_hi:[1,0]
    v_pk_mul_f32 v[78:79], v[78:79], v[104:105] op_sel_hi:[1,0]
    v_cvt_pk_bf16_f32 v52, v72, v73
    v_cvt_pk_bf16_f32 v53, v74, v75
    v_cvt_pk_bf16_f32 v54, v76, v77
    v_cvt_pk_bf16_f32 v55, v78, v79
    global_store_dwordx4 v36, v[52:55], s[26:27] offset:1024 sc1
    v_pk_add_f32 v[80:81], v[80:81], v[106:107] op_sel:[0,1] op_sel_hi:[1,1]
    v_pk_add_f32 v[82:83], v[82:83], v[106:107] op_sel:[0,1] op_sel_hi:[1,1]
    v_pk_add_f32 v[84:85], v[84:85], v[106:107] op_sel:[0,1] op_sel_hi:[1,1]
    v_pk_add_f32 v[86:87], v[86:87], v[106:107] op_sel:[0,1] op_sel_hi:[1,1]
    v_cvt_pk_bf16_f32 v81, v80, v81
    v_cvt_pk_bf16_f32 v83, v82, v83
    v_cvt_pk_bf16_f32 v85, v84, v85
    v_cvt_pk_bf16_f32 v87, v86, v87
    v_lshlrev_b32 v80, 16, v81
    v_and_b32 v81, 0xffff0000, v81
    v_lshlrev_b32 v82, 16, v83
    v_and_b32 v83, 0xffff0000, v83
    v_lshlrev_b32 v84, 16, v85
    v_and_b32 v85, 0xffff0000, v85
    v_lshlrev_b32 v86, 16, v87
    v_and_b32 v87, 0xffff0000, v87
    v_pk_mul_f32 v[80:81], v[80:81], v[104:105] op_sel:[0,1] op_sel_hi:[1,1]
    v_pk_mul_f32 v[82:83], v[82:83], v[104:105] op_sel:[0,1] op_sel_hi:[1,1]
    v_pk_mul_f32 v[84:85], v[84:85], v[104:105] op_sel:[0,1] op_sel_hi:[1,1]
    v_pk_mul_f32 v[86:87], v[86:87], v[104:105] op_sel:[0,1] op_sel_hi:[1,1]
    v_cvt_pk_bf16_f32 v56, v80, v81
    v_cvt_pk_bf16_f32 v57, v82, v83
    v_cvt_pk_bf16_f32 v58, v84, v85
    v_cvt_pk_bf16_f32 v59, v86, v87
    global_store_dwordx4 v36, v[56:59], s[26:27] offset:2048 sc1
    v_pk_add_f32 v[88:89], v[88:89], v[106:107] op_sel:[0,1] op_sel_hi:[1,1]
    v_pk_add_f32 v[90:91], v[90:91], v[106:107] op_sel:[0,1] op_sel_hi:[1,1]
    v_pk_add_f32 v[92:93], v[92:93], v[106:107] op_sel:[0,1] op_sel_hi:[1,1]
    v_pk_add_f32 v[94:95], v[94:95], v[106:107] op_sel:[0,1] op_sel_hi:[1,1]
    v_cvt_pk_bf16_f32 v89, v88, v89
    v_cvt_pk_bf16_f32 v91, v90, v91
    v_cvt_pk_bf16_f32 v93, v92, v93
    v_cvt_pk_bf16_f32 v95, v94, v95
    v_lshlrev_b32 v88, 16, v89
    v_and_b32 v89, 0xffff0000, v89
    v_lshlrev_b32 v90, 16, v91
    v_and_b32 v91, 0xffff0000, v91
    v_lshlrev_b32 v92, 16, v93
    v_and_b32 v93, 0xffff0000, v93
    v_lshlrev_b32 v94, 16, v95
    v_and_b32 v95, 0xffff0000, v95
    v_pk_mul_f32 v[88:89], v[88:89], v[104:105] op_sel:[0,1] op_sel_hi:[1,1]
    v_pk_mul_f32 v[90:91], v[90:91], v[104:105] op_sel:[0,1] op_sel_hi:[1,1]
    v_pk_mul_f32 v[92:93], v[92:93], v[104:105] op_sel:[0,1] op_sel_hi:[1,1]
    v_pk_mul_f32 v[94:95], v[94:95], v[104:105] op_sel:[0,1] op_sel_hi:[1,1]
    v_cvt_pk_bf16_f32 v60, v88, v89
    v_cvt_pk_bf16_f32 v61, v90, v91
    v_cvt_pk_bf16_f32 v62, v92, v93
    v_cvt_pk_bf16_f32 v63, v94, v95
    global_store_dwordx4 v36, v[60:63], s[26:27] offset:3072 sc1
    v_add_u32 v40, 1, v40
    s_waitcnt vmcnt(0)
    s_mov_b64 exec, 1
    global_store_dword v37, v40, s[26:27] sc1
    s_mov_b64 exec, -1
    buffer_load_dword v7, v42, s[44:47], 0 offen
    v_add_u32_e64 v42, s86, v42
    s_barrier
    v_mfma_f32_32x32x16_bf16 v[48:63], v[28:31], v[28:31], 0
    v_mfma_f32_32x32x16_bf16 v[64:79], v[28:31], v[28:31], 0
    v_mfma_f32_32x32x16_bf16 v[80:95], v[28:31], v[28:31], 0
    v_mfma_f32_32x32x16_bf16 v[96:111], v[28:31], v[28:31], 0
    v_mfma_f32_32x32x16_bf16 v[112:127], v[28:31], v[28:31], 0
    s_mov_b32 s67, 0
    s_cmp_lg_u32 s60, 3
    s_cbranch_scc1 L_noarr
    s_lshl_b32 s84, s63, 5
    v_mov_b32 v20, s84
    v_mov_b32 v21, 1
    s_mov_b64 exec, 1
    global_atomic_add v20, v21, s[24:25] sc1
    s_mov_b64 exec, -1
L_noarr:
    s_cmp_eq_u32 s62, 0
    s_cbranch_scc1 L_now
    s_add_u32 m0, s78, 0
    s_nop 0
    buffer_load_dwordx4 v2, s[32:35], s68 offen offset:0 lds
    buffer_load_dwordx4 v2, s[32:35], s69 offen offset:1024 lds
    buffer_load_dwordx4 v2, s[32:35], s70 offen offset:2048 lds
    v_add_u32 v2, 196608, v2
    buffer_load_dwordx4 v3, s[36:39], s71 offen offset:3072 lds
    s_add_u32 m0, s78, 4096
    s_nop 0
    buffer_load_dwordx4 v3, s[40:43], s72 offen offset:0 lds
    buffer_load_dwordx4 v3, s[36:39], s73 offen offset:1024 lds
    buffer_load_dwordx4 v3, s[40:43], s74 offen offset:2048 lds
    buffer_load_dwordx4 v3, s[36:39], s75 offen offset:3072 lds
    s_add_u32 m0, s78, 8192
    s_nop 0
    buffer_load_dwordx4 v3, s[40:43], s76 offen offset:0 lds
    v_add_u32 v3, 229376, v3
    global_load_lds_dwordx4 v[4:5], off offset:1024
    v_lshl_add_u64 v[4:5], v[4:5], 0, s[80:81]
    s_add_u32 m0, s78, 20480
    s_nop 0
    buffer_load_dwordx4 v2, s[32:35], s68 offen offset:0 lds
    buffer_load_dwordx4 v2, s[32:35], s69 offen offset:1024 lds
    buffer_load_dwordx4 v2, s[32:35], s70 offen offset:2048 lds
    v_add_u32 v2, 196608, v2
    buffer_load_dwordx4 v3, s[36:39], s71 offen offset:3072 lds
    s_add_u32 m0, s78, 24576
    s_nop 0
    buffer_load_dwordx4 v3, s[40:43], s72 offen offset:0 lds
    buffer_load_dwordx4 v3, s[36:39], s73 offen offset:1024 lds
    buffer_load_dwordx4 v3, s[40:43], s74 offen offset:2048 lds
    buffer_load_dwordx4 v3, s[36:39], s75 offen offset:3072 lds
    s_add_u32 m0, s78, 28672
    s_nop 0
    buffer_load_dwordx4 v3, s[40:43], s76 offen offset:0 lds
    v_add_u32 v3, 229376, v3
    global_load_lds_dwordx4 v[4:5], off offset:1024
    v_lshl_add_u64 v[4:5], v[4:5], 0, s[80:81]
    s_add_u32 m0, s78, 40960
    s_nop 0
    buffer_load_dwordx4 v2, s[32:35], s68 offen offset:0 lds
    buffer_load_dwordx4 v2, s[32:35], s69 offen offset:1024 lds
    buffer_load_dwordx4 v2, s[32:35], s70 offen offset:2048 lds
    v_add_u32 v2, 196608, v2
    buffer_load_dwordx4 v3, s[36:39], s71 offen offset:3072 lds
    s_add_u32 m0, s78, 45056
    s_nop 0
    buffer_load_dwordx4 v3, s[40:43], s72 offen offset:0 lds
    buffer_load_dwordx4 v3, s[36:39], s73 offen offset:1024 lds
    buffer_load_dwordx4 v3, s[40:43], s74 offen offset:2048 lds
    buffer_load_dwordx4 v3, s[36:39], s75 offen offset:3072 lds
    s_add_u32 m0, s78, 49152
    s_nop 0
    buffer_load_dwordx4 v3, s[40:43], s76 offen offset:0 lds
    v_add_u32 v3, 229376, v3
    global_load_lds_dwordx4 v[4:5], off offset:1024
    v_lshl_add_u64 v[4:5], v[4:5], 0, s[80:81]
    s_add_u32 m0, s78, 61440
    s_nop 0
    buffer_load_dwordx4 v2, s[32:35], s68 offen offset:0 lds
    buffer_load_dwordx4 v2, s[32:35], s69 offen offset:1024 lds
    buffer_load_dwordx4 v2, s[32:35], s70 offen offset:2048 lds
    v_add_u32 v2, 196608, v2
    buffer_load_dwordx4 v3, s[36:39], s71 offen offset:3072 lds
    s_add_u32 m0, s78, 65536
    s_nop 0
    buffer_load_dwordx4 v3, s[40:43], s72 offen offset:0 lds
    buffer_load_dwordx4 v3, s[36:39], s73 offen offset:1024 lds
    buffer_load_dwordx4 v3, s[40:43], s74 offen offset:2048 lds
    buffer_load_dwordx4 v3, s[36:39], s75 offen offset:3072 lds
    s_add_u32 m0, s78, 69632
    s_nop 0
    buffer_load_dwordx4 v3, s[40:43], s76 offen offset:0 lds
    v_add_u32 v3, 229376, v3
    global_load_lds_dwordx4 v[4:5], off offset:1024
    v_lshl_add_u64 v[4:5], v[4:5], 0, s[80:81]
L_now:
    s_cmp_eq_u32 s87, 1
    s_cbranch_scc1 L_lnok
L_lnpoll:
    global_load_dword v20, v38, s[26:27] sc1
    s_waitcnt vmcnt(0)
    v_cmp_ne_u32 vcc, v20, v39
    s_cmp_eq_u64 vcc, -1
    s_cbranch_scc1 L_lnok
    s_add_u32 s67, s67, 1
    s_and_b32 s84, s67, 3
    s_cbranch_scc1 L_lnpoll
    global_load_dword v20, v41, s[24:25] sc1
    s_waitcnt vmcnt(0)
    v_readfirstlane_b32 s84, v20
    s_cmp_ge_u32 s84, 32
    s_cbranch_scc1 L_lnok
    s_cmp_lt_u32 s67, 0x40000
    s_cbranch_scc1 L_lnpoll
L_lnok:
    s_cmp_eq_u32 s62, 1
    s_cbranch_scc1 L_g1_1
    v_add_u32 v2, 131072, v1
    s_add_u32 m0, s78, 0
    s_nop 0
    buffer_load_dwordx4 v1, s[28:31], s68 offen offset:0 sc1 lds
    buffer_load_dwordx4 v1, s[28:31], s69 offen offset:1024 sc1 lds
    buffer_load_dwordx4 v1, s[28:31], s70 offen offset:2048 sc1 lds
    buffer_load_dwordx4 v1, s[28:31], s71 offen offset:3072 sc1 lds
    s_add_u32 m0, s78, 4096
    s_nop 0
    buffer_load_dwordx4 v1, s[28:31], s72 offen offset:0 sc1 lds
    buffer_load_dwordx4 v1, s[28:31], s73 offen offset:1024 sc1 lds
    buffer_load_dwordx4 v1, s[28:31], s74 offen offset:2048 sc1 lds
    buffer_load_dwordx4 v1, s[28:31], s75 offen offset:3072 sc1 lds
    v_add_u32 v1, 128, v1
    s_add_u32 m0, s78, 8192
    s_nop 0
    buffer_load_dwordx4 v2, s[28:31], s68 offen offset:0 sc1 lds
    buffer_load_dwordx4 v2, s[28:31], s69 offen offset:1024 sc1 lds
    buffer_load_dwordx4 v2, s[28:31], s70 offen offset:2048 sc1 lds
    buffer_load_dwordx4 v2, s[28:31], s71 offen offset:3072 sc1 lds
    s_add_u32 m0, s78, 12288
    s_nop 0
    buffer_load_dwordx4 v2, s[28:31], s72 offen offset:0 sc1 lds
    buffer_load_dwordx4 v2, s[28:31], s73 offen offset:1024 sc1 lds
    buffer_load_dwordx4 v2, s[28:31], s74 offen offset:2048 sc1 lds
    buffer_load_dwordx4 v2, s[28:31], s75 offen offset:3072 sc1 lds
    v_add_u32 v2, 128, v2
    s_add_u32 m0, s78, 34816
    s_nop 0
    buffer_load_dwordx4 v1, s[28:31], s68 offen offset:0 sc1 lds
    buffer_load_dwordx4 v1, s[28:31], s69 offen offset:1024 sc1 lds
    buffer_load_dwordx4 v1, s[28:31], s70 offen offset:2048 sc1 lds
    buffer_load_dwordx4 v1, s[28:31], s71 offen offset:3072 sc1 lds
    s_add_u32 m0, s78, 38912
    s_nop 0
    buffer_load_dwordx4 v1, s[28:31], s72 offen offset:0 sc1 lds
    buffer_load_dwordx4 v1, s[28:31], s73 offen offset:1024 sc1 lds
    buffer_load_dwordx4 v1, s[28:31], s74 offen offset:2048 sc1 lds
    buffer_load_dwordx4 v1, s[28:31], s75 offen offset:3072 sc1 lds
    v_add_u32 v1, 128, v1
    s_add_u32 m0, s78, 43008
    s_nop 0
    buffer_load_dwordx4 v2, s[28:31], s68 offen offset:0 sc1 lds
    buffer_load_dwordx4 v2, s[28:31], s69 offen offset:1024 sc1 lds
    buffer_load_dwordx4 v2, s[28:31], s70 offen offset:2048 sc1 lds
    buffer_load_dwordx4 v2, s[28:31], s71 offen offset:3072 sc1 lds
    s_add_u32 m0, s78, 47104
    s_nop 0
    buffer_load_dwordx4 v2, s[28:31], s72 offen offset:0 sc1 lds
    buffer_load_dwordx4 v2, s[28:31], s73 offen offset:1024 sc1 lds
    buffer_load_dwordx4 v2, s[28:31], s74 offen offset:2048 sc1 lds
    buffer_load_dwordx4 v2, s[28:31], s75 offen offset:3072 sc1 lds
    v_add_u32 v2, 128, v2
    s_waitcnt vmcnt(16)
    s_barrier
    ds_read_b64_tr_b16 a[64:65], v12 offset:0
    ds_read_b64_tr_b16 a[66:67], v12 offset:256
    ds_read_b64_tr_b16 a[68:69], v14 offset:0
    ds_read_b64_tr_b16 a[70:71], v14 offset:256
    ds_read_b64_tr_b16 a[72:73], v12 offset:1024
    ds_read_b64_tr_b16 a[74:75], v12 offset:1280
    ds_read_b64_tr_b16 a[76:77], v14 offset:1024
    ds_read_b64_tr_b16 a[78:79], v14 offset:1280
    ds_read_b64_tr_b16 a[80:81], v12 offset:2048
    ds_read_b64_tr_b16 a[82:83], v12 offset:2304
    ds_read_b64_tr_b16 a[84:85], v14 offset:2048
    ds_read_b64_tr_b16 a[86:87], v14 offset:2304
    ds_read_b64_tr_b16 a[88:89], v12 offset:3072
    ds_read_b64_tr_b16 a[90:91], v12 offset:3328
    ds_read_b64_tr_b16 a[92:93], v14 offset:3072
    ds_read_b64_tr_b16 a[94:95], v14 offset:3328
    ds_read_b64_tr_b16 a[96:97], v12 offset:4096
    ds_read_b64_tr_b16 a[98:99], v12 offset:4352
    ds_read_b64_tr_b16 a[100:101], v14 offset:4096
    ds_read_b64_tr_b16 a[102:103], v14 offset:4352
    ds_read_b128 a[0:3], v8 offset:0
    ds_read_b128 a[4:7], v8 offset:2048
    ds_read_b128 a[8:11], v8 offset:4096
    ds_read_b128 a[12:15], v8 offset:6144
    ds_read_b128 a[16:19], v8 offset:8192
    ds_read_b128 a[20:23], v8 offset:10240
    ds_read_b128 a[24:27], v8 offset:12288
    ds_read_b128 a[28:31], v8 offset:14336
    ds_read_b128 a[112:115], v10 offset:0
    s_mov_b32 s67, 7
    v_mov_b32 v20, 0x7ff00000
.p2align 3
L_loop0:
    s_waitcnt lgkmcnt(0)
    s_barrier
    v_mfma_f32_16x16x32_bf16 a[128:131], a[64:67], a[0:3], a[128:131]
    buffer_load_dword v7, v6, s[44:47], s4 offen
    v_add_u32_e64 v6, s79, v6
    v_mfma_f32_16x16x32_bf16 a[136:139], a[64:67], a[4:7], a[136:139]
    v_mfma_f32_16x16x32_bf16 a[144:147], a[64:67], a[8:11], a[144:147]
    ds_read_b128 a[32:35], v9 offset:0
    v_mfma_f32_16x16x32_bf16 a[152:155], a[64:67], a[12:15], a[152:155]
    v_mfma_f32_16x16x32_bf16 a[160:163], a[64:67], a[16:19], a[160:163]
    v_mfma_f32_16x16x32_bf16 a[168:171], a[64:67], a[20:23], a[168:171]
    v_mfma_f32_16x16x32_bf16 a[176:179], a[64:67], a[24:27], a[176:179]
    ds_read_b128 a[36:39], v9 offset:2048
    v_mfma_f32_16x16x32_bf16 a[184:187], a[64:67], a[28:31], a[184:187]
    v_mfma_f32_16x16x32_bf16 v[120:123], a[64:67], a[112:115], v[120:123]
    ds_read_b64_tr_b16 a[64:65], v12 offset:20480
    v_mfma_f32_16x16x32_bf16 a[132:135], a[68:71], a[0:3], a[132:135]
    ds_read_b64_tr_b16 a[66:67], v12 offset:20736
    v_mfma_f32_16x16x32_bf16 a[140:143], a[68:71], a[4:7], a[140:143]
    ds_read_b128 a[40:43], v9 offset:4096
    v_mfma_f32_16x16x32_bf16 a[148:151], a[68:71], a[8:11], a[148:151]
    v_mfma_f32_16x16x32_bf16 a[156:159], a[68:71], a[12:15], a[156:159]
    v_mfma_f32_16x16x32_bf16 a[164:167], a[68:71], a[16:19], a[164:167]
    v_mfma_f32_16x16x32_bf16 a[172:175], a[68:71], a[20:23], a[172:175]
    ds_read_b128 a[44:47], v9 offset:6144
    v_mfma_f32_16x16x32_bf16 a[180:183], a[68:71], a[24:27], a[180:183]
    v_mfma_f32_16x16x32_bf16 a[188:191], a[68:71], a[28:31], a[188:191]
    v_mfma_f32_16x16x32_bf16 v[124:127], a[68:71], a[112:115], v[124:127]
    ds_read_b64_tr_b16 a[68:69], v14 offset:20480
    v_mfma_f32_16x16x32_bf16 v[52:55], a[0:3], a[72:75], v[52:55]
    ds_read_b64_tr_b16 a[70:71], v14 offset:20736
    v_mfma_f32_16x16x32_bf16 v[56:59], a[4:7], a[72:75], v[56:59]
    v_mfma_f32_16x16x32_bf16 v[60:63], a[8:11], a[72:75], v[60:63]
    ds_read_b128 a[48:51], v9 offset:8192
    v_mfma_f32_16x16x32_bf16 v[64:67], a[12:15], a[72:75], v[64:67]
    v_mfma_f32_16x16x32_bf16 v[68:71], a[16:19], a[72:75], v[68:71]
    ds_read_b128 a[52:55], v9 offset:10240
    v_mfma_f32_16x16x32_bf16 v[72:75], a[20:23], a[72:75], v[72:75]
    v_mfma_f32_16x16x32_bf16 v[76:79], a[24:27], a[72:75], v[76:79]
    v_mfma_f32_16x16x32_bf16 v[80:83], a[28:31], a[72:75], v[80:83]
    v_mfma_f32_16x16x32_bf16 v[48:51], a[112:115], a[72:75], v[48:51]
    ds_read_b64_tr_b16 a[72:73], v12 offset:21504
    v_mfma_f32_16x16x32_bf16 v[88:91], a[0:3], a[76:79], v[88:91]
    ds_read_b64_tr_b16 a[74:75], v12 offset:21760
    v_mfma_f32_16x16x32_bf16 v[92:95], a[4:7], a[76:79], v[92:95]
    ds_read_b128 a[56:59], v9 offset:12288
    v_mfma_f32_16x16x32_bf16 v[96:99], a[8:11], a[76:79], v[96:99]
    v_mfma_f32_16x16x32_bf16 v[100:103], a[12:15], a[76:79], v[100:103]
    ds_read_b128 a[60:63], v9 offset:14336
    v_mfma_f32_16x16x32_bf16 v[104:107], a[16:19], a[76:79], v[104:107]
    v_mfma_f32_16x16x32_bf16 v[108:111], a[20:23], a[76:79], v[108:111]
    v_mfma_f32_16x16x32_bf16 v[112:115], a[24:27], a[76:79], v[112:115]
    v_mfma_f32_16x16x32_bf16 v[116:119], a[28:31], a[76:79], v[116:119]
    ds_read_b128 a[116:119], v11 offset:0
    v_mfma_f32_16x16x32_bf16 v[84:87], a[112:115], a[76:79], v[84:87]
    ds_read_b64_tr_b16 a[76:77], v14 offset:21504
    v_mfma_f32_16x16x32_bf16 a[192:195], a[80:83], a[0:3], a[192:195]
    ds_read_b64_tr_b16 a[78:79], v14 offset:21760
    v_mfma_f32_16x16x32_bf16 a[200:203], a[80:83], a[4:7], a[200:203]
    v_mfma_f32_16x16x32_bf16 a[208:211], a[80:83], a[8:11], a[208:211]
    ds_read_b64_tr_b16 a[104:105], v12 offset:24576
    v_mfma_f32_16x16x32_bf16 a[216:219], a[80:83], a[12:15], a[216:219]
    v_mfma_f32_16x16x32_bf16 a[224:227], a[80:83], a[16:19], a[224:227]
    v_mfma_f32_16x16x32_bf16 a[232:235], a[80:83], a[20:23], a[232:235]
    v_mfma_f32_16x16x32_bf16 a[240:243], a[80:83], a[24:27], a[240:243]
    ds_read_b64_tr_b16 a[106:107], v12 offset:24832
    v_mfma_f32_16x16x32_bf16 a[248:251], a[80:83], a[28:31], a[248:251]
    ds_read_b64_tr_b16 a[80:81], v12 offset:22528
    v_mfma_f32_16x16x32_bf16 a[196:199], a[84:87], a[0:3], a[196:199]
    ds_read_b64_tr_b16 a[82:83], v12 offset:22784
    v_mfma_f32_16x16x32_bf16 a[204:207], a[84:87], a[4:7], a[204:207]
    v_mfma_f32_16x16x32_bf16 a[212:215], a[84:87], a[8:11], a[212:215]
    ds_read_b64_tr_b16 a[108:109], v14 offset:24576
    v_mfma_f32_16x16x32_bf16 a[220:223], a[84:87], a[12:15], a[220:223]
    v_mfma_f32_16x16x32_bf16 a[228:231], a[84:87], a[16:19], a[228:231]
    v_mfma_f32_16x16x32_bf16 a[236:239], a[84:87], a[20:23], a[236:239]
    v_mfma_f32_16x16x32_bf16 a[244:247], a[84:87], a[24:27], a[244:247]
    ds_read_b64_tr_b16 a[110:111], v14 offset:24832
    v_mfma_f32_16x16x32_bf16 a[252:255], a[84:87], a[28:31], a[252:255]
    ds_read_b64_tr_b16 a[84:85], v14 offset:22528
    v_mfma_f32_16x16x32_bf16 v[128:131], a[88:91], a[0:3], v[128:131]
    ds_read_b64_tr_b16 a[86:87], v14 offset:22784
    v_mfma_f32_16x16x32_bf16 v[144:147], a[88:91], a[4:7], v[144:147]
    v_mfma_f32_16x16x32_bf16 v[160:163], a[88:91], a[8:11], v[160:163]
    v_mfma_f32_16x16x32_bf16 v[176:179], a[88:91], a[12:15], v[176:179]
    v_mfma_f32_16x16x32_bf16 v[192:195], a[88:91], a[16:19], v[192:195]
    v_mfma_f32_16x16x32_bf16 v[208:211], a[88:91], a[20:23], v[208:211]
    v_mfma_f32_16x16x32_bf16 v[224:227], a[88:91], a[24:27], v[224:227]
    v_mfma_f32_16x16x32_bf16 v[240:243], a[88:91], a[28:31], v[240:243]
    ds_read_b64_tr_b16 a[88:89], v12 offset:23552
    v_mfma_f32_16x16x32_bf16 v[132:135], a[92:95], a[0:3], v[132:135]
    ds_read_b64_tr_b16 a[90:91], v12 offset:23808
    v_mfma_f32_16x16x32_bf16 v[148:151], a[92:95], a[4:7], v[148:151]
    v_mfma_f32_16x16x32_bf16 v[164:167], a[92:95], a[8:11], v[164:167]
    v_mfma_f32_16x16x32_bf16 v[180:183], a[92:95], a[12:15], v[180:183]
    v_mfma_f32_16x16x32_bf16 v[196:199], a[92:95], a[16:19], v[196:199]
    v_mfma_f32_16x16x32_bf16 v[212:215], a[92:95], a[20:23], v[212:215]
    v_mfma_f32_16x16x32_bf16 v[228:231], a[92:95], a[24:27], v[228:231]
    v_mfma_f32_16x16x32_bf16 v[244:247], a[92:95], a[28:31], v[244:247]
    ds_read_b64_tr_b16 a[92:93], v14 offset:23552
    v_mfma_f32_16x16x32_bf16 v[136:139], a[96:99], a[0:3], v[136:139]
    ds_read_b64_tr_b16 a[94:95], v14 offset:23808
    v_mfma_f32_16x16x32_bf16 v[152:155], a[96:99], a[4:7], v[152:155]
    v_mfma_f32_16x16x32_bf16 v[168:171], a[96:99], a[8:11], v[168:171]
    v_mfma_f32_16x16x32_bf16 v[184:187], a[96:99], a[12:15], v[184:187]
    v_mfma_f32_16x16x32_bf16 v[200:203], a[96:99], a[16:19], v[200:203]
    v_mfma_f32_16x16x32_bf16 v[216:219], a[96:99], a[20:23], v[216:219]
    v_mfma_f32_16x16x32_bf16 v[232:235], a[96:99], a[24:27], v[232:235]
    v_mfma_f32_16x16x32_bf16 v[248:251], a[96:99], a[28:31], v[248:251]
    v_mfma_f32_16x16x32_bf16 v[140:143], a[100:103], a[0:3], v[140:143]
    v_mfma_f32_16x16x32_bf16 v[156:159], a[100:103], a[4:7], v[156:159]
    v_mfma_f32_16x16x32_bf16 v[172:175], a[100:103], a[8:11], v[172:175]
    v_mfma_f32_16x16x32_bf16 v[188:191], a[100:103], a[12:15], v[188:191]
    v_mfma_f32_16x16x32_bf16 v[204:207], a[100:103], a[16:19], v[204:207]
    v_mfma_f32_16x16x32_bf16 v[220:223], a[100:103], a[20:23], v[220:223]
    v_mfma_f32_16x16x32_bf16 v[236:239], a[100:103], a[24:27], v[236:239]
    v_mfma_f32_16x16x32_bf16 v[252:255], a[100:103], a[28:31], v[252:255]
    s_waitcnt vmcnt(1) lgkmcnt(0)
    s_barrier
    v_mfma_f32_16x16x32_bf16 a[128:131], a[64:67], a[32:35], a[128:131]
    s_add_u32 m0, s78, 0
    v_mfma_f32_16x16x32_bf16 a[136:139], a[64:67], a[36:39], a[136:139]
    buffer_load_dwordx4 v1, s[28:31], s68 offen offset:0 sc1 lds
    v_mfma_f32_16x16x32_bf16 a[144:147], a[64:67], a[40:43], a[144:147]
    ds_read_b128 a[0:3], v8 offset:34816
    v_mfma_f32_16x16x32_bf16 a[152:155], a[64:67], a[44:47], a[152:155]
    v_mfma_f32_16x16x32_bf16 a[160:163], a[64:67], a[48:51], a[160:163]
    buffer_load_dwordx4 v1, s[28:31], s69 offen offset:1024 sc1 lds
    v_mfma_f32_16x16x32_bf16 a[168:171], a[64:67], a[52:55], a[168:171]
    v_mfma_f32_16x16x32_bf16 a[176:179], a[64:67], a[56:59], a[176:179]
    ds_read_b128 a[4:7], v8 offset:36864
    v_mfma_f32_16x16x32_bf16 a[184:187], a[64:67], a[60:63], a[184:187]
    v_mfma_f32_16x16x32_bf16 v[120:123], a[64:67], a[116:119], v[120:123]
    ds_read_b64_tr_b16 a[64:65], v13 offset:0
    v_mfma_f32_16x16x32_bf16 a[132:135], a[68:71], a[32:35], a[132:135]
    ds_read_b64_tr_b16 a[66:67], v13 offset:256
    v_mfma_f32_16x16x32_bf16 a[140:143], a[68:71], a[36:39], a[140:143]
    ds_read_b128 a[8:11], v8 offset:38912
    v_mfma_f32_16x16x32_bf16 a[148:151], a[68:71], a[40:43], a[148:151]
    buffer_load_dwordx4 v1, s[28:31], s70 offen offset:2048 sc1 lds
    v_mfma_f32_16x16x32_bf16 a[156:159], a[68:71], a[44:47], a[156:159]
    buffer_load_dwordx4 v1, s[28:31], s71 offen offset:3072 sc1 lds
    v_mfma_f32_16x16x32_bf16 a[164:167], a[68:71], a[48:51], a[164:167]
    v_mfma_f32_16x16x32_bf16 a[172:175], a[68:71], a[52:55], a[172:175]
    ds_read_b128 a[12:15], v8 offset:40960
    v_mfma_f32_16x16x32_bf16 a[180:183], a[68:71], a[56:59], a[180:183]
    s_add_u32 m0, s78, 4096
    v_mfma_f32_16x16x32_bf16 a[188:191], a[68:71], a[60:63], a[188:191]
    buffer_load_dwordx4 v1, s[28:31], s72 offen offset:0 sc1 lds
    v_mfma_f32_16x16x32_bf16 v[124:127], a[68:71], a[116:119], v[124:127]
    ds_read_b64_tr_b16 a[68:69], v15 offset:0
    v_mfma_f32_16x16x32_bf16 v[52:55], a[32:35], a[72:75], v[52:55]
    ds_read_b64_tr_b16 a[70:71], v15 offset:256
    v_mfma_f32_16x16x32_bf16 v[56:59], a[36:39], a[72:75], v[56:59]
    v_mfma_f32_16x16x32_bf16 v[60:63], a[40:43], a[72:75], v[60:63]
    ds_read_b128 a[16:19], v8 offset:43008
    v_mfma_f32_16x16x32_bf16 v[64:67], a[44:47], a[72:75], v[64:67]
    buffer_load_dwordx4 v1, s[28:31], s73 offen offset:1024 sc1 lds
    v_mfma_f32_16x16x32_bf16 v[68:71], a[48:51], a[72:75], v[68:71]
    ds_read_b128 a[20:23], v8 offset:45056
    v_mfma_f32_16x16x32_bf16 v[72:75], a[52:55], a[72:75], v[72:75]
    v_mfma_f32_16x16x32_bf16 v[76:79], a[56:59], a[72:75], v[76:79]
    buffer_load_dwordx4 v1, s[28:31], s74 offen offset:2048 sc1 lds
    v_mfma_f32_16x16x32_bf16 v[80:83], a[60:63], a[72:75], v[80:83]
    v_mfma_f32_16x16x32_bf16 v[48:51], a[116:119], a[72:75], v[48:51]
    ds_read_b64_tr_b16 a[72:73], v13 offset:1024
    v_mfma_f32_16x16x32_bf16 v[88:91], a[32:35], a[76:79], v[88:91]
    ds_read_b64_tr_b16 a[74:75], v13 offset:1280
    v_mfma_f32_16x16x32_bf16 v[92:95], a[36:39], a[76:79], v[92:95]
    ds_read_b128 a[24:27], v8 offset:47104
    v_mfma_f32_16x16x32_bf16 v[96:99], a[40:43], a[76:79], v[96:99]
    buffer_load_dwordx4 v1, s[28:31], s75 offen offset:3072 sc1 lds
    v_add_u32 v1, 128, v1
    v_mfma_f32_16x16x32_bf16 v[100:103], a[44:47], a[76:79], v[100:103]
    ds_read_b128 a[28:31], v8 offset:49152
    v_mfma_f32_16x16x32_bf16 v[104:107], a[48:51], a[76:79], v[104:107]
    s_add_u32 m0, s78, 8192
    v_mfma_f32_16x16x32_bf16 v[108:111], a[52:55], a[76:79], v[108:111]
    buffer_load_dwordx4 v2, s[28:31], s68 offen offset:0 sc1 lds
    v_mfma_f32_16x16x32_bf16 v[112:115], a[56:59], a[76:79], v[112:115]
    v_mfma_f32_16x16x32_bf16 v[116:119], a[60:63], a[76:79], v[116:119]
    ds_read_b128 a[112:115], v10 offset:34816
    v_mfma_f32_16x16x32_bf16 v[84:87], a[116:119], a[76:79], v[84:87]
    ds_read_b64_tr_b16 a[76:77], v15 offset:1024
    v_mfma_f32_16x16x32_bf16 a[192:195], a[80:83], a[32:35], a[192:195]
    ds_read_b64_tr_b16 a[78:79], v15 offset:1280
    v_mfma_f32_16x16x32_bf16 a[200:203], a[80:83], a[36:39], a[200:203]
    buffer_load_dwordx4 v2, s[28:31], s69 offen offset:1024 sc1 lds
    v_mfma_f32_16x16x32_bf16 a[208:211], a[80:83], a[40:43], a[208:211]
    ds_read_b64_tr_b16 a[96:97], v13 offset:4096
    v_mfma_f32_16x16x32_bf16 a[216:219], a[80:83], a[44:47], a[216:219]
    buffer_load_dwordx4 v2, s[28:31], s70 offen offset:2048 sc1 lds
    v_mfma_f32_16x16x32_bf16 a[224:227], a[80:83], a[48:51], a[224:227]
    v_mfma_f32_16x16x32_bf16 a[232:235], a[80:83], a[52:55], a[232:235]
    v_mfma_f32_16x16x32_bf16 a[240:243], a[80:83], a[56:59], a[240:243]
    ds_read_b64_tr_b16 a[98:99], v13 offset:4352
    v_mfma_f32_16x16x32_bf16 a[248:251], a[80:83], a[60:63], a[248:251]
    ds_read_b64_tr_b16 a[80:81], v13 offset:2048
    v_mfma_f32_16x16x32_bf16 a[196:199], a[84:87], a[32:35], a[196:199]
    ds_read_b64_tr_b16 a[82:83], v13 offset:2304
    v_mfma_f32_16x16x32_bf16 a[204:207], a[84:87], a[36:39], a[204:207]
    buffer_load_dwordx4 v2, s[28:31], s71 offen offset:3072 sc1 lds
    v_mfma_f32_16x16x32_bf16 a[212:215], a[84:87], a[40:43], a[212:215]
    ds_read_b64_tr_b16 a[100:101], v15 offset:4096
    s_add_u32 m0, s78, 12288
    v_mfma_f32_16x16x32_bf16 a[220:223], a[84:87], a[44:47], a[220:223]
    buffer_load_dwordx4 v2, s[28:31], s72 offen offset:0 sc1 lds
    v_mfma_f32_16x16x32_bf16 a[228:231], a[84:87], a[48:51], a[228:231]
    v_mfma_f32_16x16x32_bf16 a[236:239], a[84:87], a[52:55], a[236:239]
    v_mfma_f32_16x16x32_bf16 a[244:247], a[84:87], a[56:59], a[244:247]
    ds_read_b64_tr_b16 a[102:103], v15 offset:4352
    v_mfma_f32_16x16x32_bf16 a[252:255], a[84:87], a[60:63], a[252:255]
    ds_read_b64_tr_b16 a[84:85], v15 offset:2048
    v_mfma_f32_16x16x32_bf16 v[128:131], a[88:91], a[32:35], v[128:131]
    ds_read_b64_tr_b16 a[86:87], v15 offset:2304
    v_mfma_f32_16x16x32_bf16 v[144:147], a[88:91], a[36:39], v[144:147]
    buffer_load_dwordx4 v2, s[28:31], s73 offen offset:1024 sc1 lds
    v_mfma_f32_16x16x32_bf16 v[160:163], a[88:91], a[40:43], v[160:163]
    v_mfma_f32_16x16x32_bf16 v[176:179], a[88:91], a[44:47], v[176:179]
    buffer_load_dwordx4 v2, s[28:31], s74 offen offset:2048 sc1 lds
    v_mfma_f32_16x16x32_bf16 v[192:195], a[88:91], a[48:51], v[192:195]
    v_mfma_f32_16x16x32_bf16 v[208:211], a[88:91], a[52:55], v[208:211]
    v_mfma_f32_16x16x32_bf16 v[224:227], a[88:91], a[56:59], v[224:227]
    v_mfma_f32_16x16x32_bf16 v[240:243], a[88:91], a[60:63], v[240:243]
    ds_read_b64_tr_b16 a[88:89], v13 offset:3072
    v_mfma_f32_16x16x32_bf16 v[132:135], a[92:95], a[32:35], v[132:135]
    ds_read_b64_tr_b16 a[90:91], v13 offset:3328
    v_mfma_f32_16x16x32_bf16 v[148:151], a[92:95], a[36:39], v[148:151]
    buffer_load_dwordx4 v2, s[28:31], s75 offen offset:3072 sc1 lds
    v_add_u32 v2, 128, v2
    v_mfma_f32_16x16x32_bf16 v[164:167], a[92:95], a[40:43], v[164:167]
    v_mfma_f32_16x16x32_bf16 v[180:183], a[92:95], a[44:47], v[180:183]
    v_mfma_f32_16x16x32_bf16 v[196:199], a[92:95], a[48:51], v[196:199]
    v_mfma_f32_16x16x32_bf16 v[212:215], a[92:95], a[52:55], v[212:215]
    v_mfma_f32_16x16x32_bf16 v[228:231], a[92:95], a[56:59], v[228:231]
    v_mfma_f32_16x16x32_bf16 v[244:247], a[92:95], a[60:63], v[244:247]
    ds_read_b64_tr_b16 a[92:93], v15 offset:3072
    v_mfma_f32_16x16x32_bf16 v[136:139], a[104:107], a[32:35], v[136:139]
    ds_read_b64_tr_b16 a[94:95], v15 offset:3328
    v_mfma_f32_16x16x32_bf16 v[152:155], a[104:107], a[36:39], v[152:155]
    v_mfma_f32_16x16x32_bf16 v[168:171], a[104:107], a[40:43], v[168:171]
    v_mfma_f32_16x16x32_bf16 v[184:187], a[104:107], a[44:47], v[184:187]
    v_mfma_f32_16x16x32_bf16 v[200:203], a[104:107], a[48:51], v[200:203]
    v_mfma_f32_16x16x32_bf16 v[216:219], a[104:107], a[52:55], v[216:219]
    v_mfma_f32_16x16x32_bf16 v[232:235], a[104:107], a[56:59], v[232:235]
    v_mfma_f32_16x16x32_bf16 v[248:251], a[104:107], a[60:63], v[248:251]
    v_mfma_f32_16x16x32_bf16 v[140:143], a[108:111], a[32:35], v[140:143]
    v_mfma_f32_16x16x32_bf16 v[156:159], a[108:111], a[36:39], v[156:159]
    v_mfma_f32_16x16x32_bf16 v[172:175], a[108:111], a[40:43], v[172:175]
    v_mfma_f32_16x16x32_bf16 v[188:191], a[108:111], a[44:47], v[188:191]
    v_mfma_f32_16x16x32_bf16 v[204:207], a[108:111], a[48:51], v[204:207]
    v_mfma_f32_16x16x32_bf16 v[220:223], a[108:111], a[52:55], v[220:223]
    v_mfma_f32_16x16x32_bf16 v[236:239], a[108:111], a[56:59], v[236:239]
    v_mfma_f32_16x16x32_bf16 v[252:255], a[108:111], a[60:63], v[252:255]
    s_waitcnt lgkmcnt(0)
    s_barrier
    v_mfma_f32_16x16x32_bf16 a[128:131], a[64:67], a[0:3], a[128:131]
    buffer_load_dword v7, v6, s[44:47], s4 offen
    v_add_u32_e64 v6, s79, v6
    v_mfma_f32_16x16x32_bf16 a[136:139], a[64:67], a[4:7], a[136:139]
    v_mfma_f32_16x16x32_bf16 a[144:147], a[64:67], a[8:11], a[144:147]
    ds_read_b128 a[32:35], v9 offset:34816
    v_mfma_f32_16x16x32_bf16 a[152:155], a[64:67], a[12:15], a[152:155]
    v_mfma_f32_16x16x32_bf16 a[160:163], a[64:67], a[16:19], a[160:163]
    v_mfma_f32_16x16x32_bf16 a[168:171], a[64:67], a[20:23], a[168:171]
    v_mfma_f32_16x16x32_bf16 a[176:179], a[64:67], a[24:27], a[176:179]
    ds_read_b128 a[36:39], v9 offset:36864
    v_mfma_f32_16x16x32_bf16 a[184:187], a[64:67], a[28:31], a[184:187]
    v_mfma_f32_16x16x32_bf16 v[120:123], a[64:67], a[112:115], v[120:123]
    ds_read_b64_tr_b16 a[64:65], v13 offset:20480
    v_mfma_f32_16x16x32_bf16 a[132:135], a[68:71], a[0:3], a[132:135]
    ds_read_b64_tr_b16 a[66:67], v13 offset:20736
    v_mfma_f32_16x16x32_bf16 a[140:143], a[68:71], a[4:7], a[140:143]
    ds_read_b128 a[40:43], v9 offset:38912
    v_mfma_f32_16x16x32_bf16 a[148:151], a[68:71], a[8:11], a[148:151]
    v_mfma_f32_16x16x32_bf16 a[156:159], a[68:71], a[12:15], a[156:159]
    v_mfma_f32_16x16x32_bf16 a[164:167], a[68:71], a[16:19], a[164:167]
    v_mfma_f32_16x16x32_bf16 a[172:175], a[68:71], a[20:23], a[172:175]
    ds_read_b128 a[44:47], v9 offset:40960
    v_mfma_f32_16x16x32_bf16 a[180:183], a[68:71], a[24:27], a[180:183]
    v_mfma_f32_16x16x32_bf16 a[188:191], a[68:71], a[28:31], a[188:191]
    v_mfma_f32_16x16x32_bf16 v[124:127], a[68:71], a[112:115], v[124:127]
    ds_read_b64_tr_b16 a[68:69], v15 offset:20480
    v_mfma_f32_16x16x32_bf16 v[52:55], a[0:3], a[72:75], v[52:55]
    ds_read_b64_tr_b16 a[70:71], v15 offset:20736
    v_mfma_f32_16x16x32_bf16 v[56:59], a[4:7], a[72:75], v[56:59]
    v_mfma_f32_16x16x32_bf16 v[60:63], a[8:11], a[72:75], v[60:63]
    ds_read_b128 a[48:51], v9 offset:43008
    v_mfma_f32_16x16x32_bf16 v[64:67], a[12:15], a[72:75], v[64:67]
    v_mfma_f32_16x16x32_bf16 v[68:71], a[16:19], a[72:75], v[68:71]
    ds_read_b128 a[52:55], v9 offset:45056
    v_mfma_f32_16x16x32_bf16 v[72:75], a[20:23], a[72:75], v[72:75]
    v_mfma_f32_16x16x32_bf16 v[76:79], a[24:27], a[72:75], v[76:79]
    v_mfma_f32_16x16x32_bf16 v[80:83], a[28:31], a[72:75], v[80:83]
    v_mfma_f32_16x16x32_bf16 v[48:51], a[112:115], a[72:75], v[48:51]
    ds_read_b64_tr_b16 a[72:73], v13 offset:21504
    v_mfma_f32_16x16x32_bf16 v[88:91], a[0:3], a[76:79], v[88:91]
    ds_read_b64_tr_b16 a[74:75], v13 offset:21760
    v_mfma_f32_16x16x32_bf16 v[92:95], a[4:7], a[76:79], v[92:95]
    ds_read_b128 a[56:59], v9 offset:47104
    v_mfma_f32_16x16x32_bf16 v[96:99], a[8:11], a[76:79], v[96:99]
    v_mfma_f32_16x16x32_bf16 v[100:103], a[12:15], a[76:79], v[100:103]
    ds_read_b128 a[60:63], v9 offset:49152
    v_mfma_f32_16x16x32_bf16 v[104:107], a[16:19], a[76:79], v[104:107]
    v_mfma_f32_16x16x32_bf16 v[108:111], a[20:23], a[76:79], v[108:111]
    v_mfma_f32_16x16x32_bf16 v[112:115], a[24:27], a[76:79], v[112:115]
    v_mfma_f32_16x16x32_bf16 v[116:119], a[28:31], a[76:79], v[116:119]
    ds_read_b128 a[116:119], v11 offset:34816
    v_mfma_f32_16x16x32_bf16 v[84:87], a[112:115], a[76:79], v[84:87]
    ds_read_b64_tr_b16 a[76:77], v15 offset:21504
    v_mfma_f32_16x16x32_bf16 a[192:195], a[80:83], a[0:3], a[192:195]
    ds_read_b64_tr_b16 a[78:79], v15 offset:21760
    v_mfma_f32_16x16x32_bf16 a[200:203], a[80:83], a[4:7], a[200:203]
    v_mfma_f32_16x16x32_bf16 a[208:211], a[80:83], a[8:11], a[208:211]
    ds_read_b64_tr_b16 a[104:105], v13 offset:24576
    v_mfma_f32_16x16x32_bf16 a[216:219], a[80:83], a[12:15], a[216:219]
    v_mfma_f32_16x16x32_bf16 a[224:227], a[80:83], a[16:19], a[224:227]
    v_mfma_f32_16x16x32_bf16 a[232:235], a[80:83], a[20:23], a[232:235]
    v_mfma_f32_16x16x32_bf16 a[240:243], a[80:83], a[24:27], a[240:243]
    ds_read_b64_tr_b16 a[106:107], v13 offset:24832
    v_mfma_f32_16x16x32_bf16 a[248:251], a[80:83], a[28:31], a[248:251]
    ds_read_b64_tr_b16 a[80:81], v13 offset:22528
    v_mfma_f32_16x16x32_bf16 a[196:199], a[84:87], a[0:3], a[196:199]
    ds_read_b64_tr_b16 a[82:83], v13 offset:22784
    v_mfma_f32_16x16x32_bf16 a[204:207], a[84:87], a[4:7], a[204:207]
    v_mfma_f32_16x16x32_bf16 a[212:215], a[84:87], a[8:11], a[212:215]
    ds_read_b64_tr_b16 a[108:109], v15 offset:24576
    v_mfma_f32_16x16x32_bf16 a[220:223], a[84:87], a[12:15], a[220:223]
    v_mfma_f32_16x16x32_bf16 a[228:231], a[84:87], a[16:19], a[228:231]
    v_mfma_f32_16x16x32_bf16 a[236:239], a[84:87], a[20:23], a[236:239]
    v_mfma_f32_16x16x32_bf16 a[244:247], a[84:87], a[24:27], a[244:247]
    ds_read_b64_tr_b16 a[110:111], v15 offset:24832
    v_mfma_f32_16x16x32_bf16 a[252:255], a[84:87], a[28:31], a[252:255]
    ds_read_b64_tr_b16 a[84:85], v15 offset:22528
    v_mfma_f32_16x16x32_bf16 v[128:131], a[88:91], a[0:3], v[128:131]
    ds_read_b64_tr_b16 a[86:87], v15 offset:22784
    v_mfma_f32_16x16x32_bf16 v[144:147], a[88:91], a[4:7], v[144:147]
    v_mfma_f32_16x16x32_bf16 v[160:163], a[88:91], a[8:11], v[160:163]
    v_mfma_f32_16x16x32_bf16 v[176:179], a[88:91], a[12:15], v[176:179]
    v_mfma_f32_16x16x32_bf16 v[192:195], a[88:91], a[16:19], v[192:195]
    v_mfma_f32_16x16x32_bf16 v[208:211], a[88:91], a[20:23], v[208:211]
    v_mfma_f32_16x16x32_bf16 v[224:227], a[88:91], a[24:27], v[224:227]
    v_mfma_f32_16x16x32_bf16 v[240:243], a[88:91], a[28:31], v[240:243]
    ds_read_b64_tr_b16 a[88:89], v13 offset:23552
    v_mfma_f32_16x16x32_bf16 v[132:135], a[92:95], a[0:3], v[132:135]
    ds_read_b64_tr_b16 a[90:91], v13 offset:23808
    v_mfma_f32_16x16x32_bf16 v[148:151], a[92:95], a[4:7], v[148:151]
    v_mfma_f32_16x16x32_bf16 v[164:167], a[92:95], a[8:11], v[164:167]
    v_mfma_f32_16x16x32_bf16 v[180:183], a[92:95], a[12:15], v[180:183]
    v_mfma_f32_16x16x32_bf16 v[196:199], a[92:95], a[16:19], v[196:199]
    v_mfma_f32_16x16x32_bf16 v[212:215], a[92:95], a[20:23], v[212:215]
    v_mfma_f32_16x16x32_bf16 v[228:231], a[92:95], a[24:27], v[228:231]
    v_mfma_f32_16x16x32_bf16 v[244:247], a[92:95], a[28:31], v[244:247]
    ds_read_b64_tr_b16 a[92:93], v15 offset:23552
    v_mfma_f32_16x16x32_bf16 v[136:139], a[96:99], a[0:3], v[136:139]
    ds_read_b64_tr_b16 a[94:95], v15 offset:23808
    v_mfma_f32_16x16x32_bf16 v[152:155], a[96:99], a[4:7], v[152:155]
    v_mfma_f32_16x16x32_bf16 v[168:171], a[96:99], a[8:11], v[168:171]
    v_mfma_f32_16x16x32_bf16 v[184:187], a[96:99], a[12:15], v[184:187]
    v_mfma_f32_16x16x32_bf16 v[200:203], a[96:99], a[16:19], v[200:203]
    v_mfma_f32_16x16x32_bf16 v[216:219], a[96:99], a[20:23], v[216:219]
    v_mfma_f32_16x16x32_bf16 v[232:235], a[96:99], a[24:27], v[232:235]
    v_mfma_f32_16x16x32_bf16 v[248:251], a[96:99], a[28:31], v[248:251]
    v_mfma_f32_16x16x32_bf16 v[140:143], a[100:103], a[0:3], v[140:143]
    v_mfma_f32_16x16x32_bf16 v[156:159], a[100:103], a[4:7], v[156:159]
    v_mfma_f32_16x16x32_bf16 v[172:175], a[100:103], a[8:11], v[172:175]
    v_mfma_f32_16x16x32_bf16 v[188:191], a[100:103], a[12:15], v[188:191]
    v_mfma_f32_16x16x32_bf16 v[204:207], a[100:103], a[16:19], v[204:207]
    v_mfma_f32_16x16x32_bf16 v[220:223], a[100:103], a[20:23], v[220:223]
    v_mfma_f32_16x16x32_bf16 v[236:239], a[100:103], a[24:27], v[236:239]
    v_mfma_f32_16x16x32_bf16 v[252:255], a[100:103], a[28:31], v[252:255]
    s_waitcnt vmcnt(1) lgkmcnt(0)
    s_barrier
    v_mfma_f32_16x16x32_bf16 a[128:131], a[64:67], a[32:35], a[128:131]
    s_add_u32 m0, s78, 34816
    v_mfma_f32_16x16x32_bf16 a[136:139], a[64:67], a[36:39], a[136:139]
    buffer_load_dwordx4 v1, s[28:31], s68 offen offset:0 sc1 lds
    v_mfma_f32_16x16x32_bf16 a[144:147], a[64:67], a[40:43], a[144:147]
    ds_read_b128 a[0:3], v8 offset:0
    v_mfma_f32_16x16x32_bf16 a[152:155], a[64:67], a[44:47], a[152:155]
    v_mfma_f32_16x16x32_bf16 a[160:163], a[64:67], a[48:51], a[160:163]
    buffer_load_dwordx4 v1, s[28:31], s69 offen offset:1024 sc1 lds
    v_mfma_f32_16x16x32_bf16 a[168:171], a[64:67], a[52:55], a[168:171]
    v_mfma_f32_16x16x32_bf16 a[176:179], a[64:67], a[56:59], a[176:179]
    ds_read_b128 a[4:7], v8 offset:2048
    v_mfma_f32_16x16x32_bf16 a[184:187], a[64:67], a[60:63], a[184:187]
    v_mfma_f32_16x16x32_bf16 v[120:123], a[64:67], a[116:119], v[120:123]
    ds_read_b64_tr_b16 a[64:65], v12 offset:0
    v_mfma_f32_16x16x32_bf16 a[132:135], a[68:71], a[32:35], a[132:135]
    ds_read_b64_tr_b16 a[66:67], v12 offset:256
    v_mfma_f32_16x16x32_bf16 a[140:143], a[68:71], a[36:39], a[140:143]
    ds_read_b128 a[8:11], v8 offset:4096
    v_mfma_f32_16x16x32_bf16 a[148:151], a[68:71], a[40:43], a[148:151]
    buffer_load_dwordx4 v1, s[28:31], s70 offen offset:2048 sc1 lds
    v_mfma_f32_16x16x32_bf16 a[156:159], a[68:71], a[44:47], a[156:159]
    buffer_load_dwordx4 v1, s[28:31], s71 offen offset:3072 sc1 lds
    v_mfma_f32_16x16x32_bf16 a[164:167], a[68:71], a[48:51], a[164:167]
    v_mfma_f32_16x16x32_bf16 a[172:175], a[68:71], a[52:55], a[172:175]
    ds_read_b128 a[12:15], v8 offset:6144
    v_mfma_f32_16x16x32_bf16 a[180:183], a[68:71], a[56:59], a[180:183]
    s_add_u32 m0, s78, 38912
    v_mfma_f32_16x16x32_bf16 a[188:191], a[68:71], a[60:63], a[188:191]
    buffer_load_dwordx4 v1, s[28:31], s72 offen offset:0 sc1 lds
    v_mfma_f32_16x16x32_bf16 v[124:127], a[68:71], a[116:119], v[124:127]
    ds_read_b64_tr_b16 a[68:69], v14 offset:0
    v_mfma_f32_16x16x32_bf16 v[52:55], a[32:35], a[72:75], v[52:55]
    ds_read_b64_tr_b16 a[70:71], v14 offset:256
    v_mfma_f32_16x16x32_bf16 v[56:59], a[36:39], a[72:75], v[56:59]
    v_mfma_f32_16x16x32_bf16 v[60:63], a[40:43], a[72:75], v[60:63]
    ds_read_b128 a[16:19], v8 offset:8192
    v_mfma_f32_16x16x32_bf16 v[64:67], a[44:47], a[72:75], v[64:67]
    buffer_load_dwordx4 v1, s[28:31], s73 offen offset:1024 sc1 lds
    v_mfma_f32_16x16x32_bf16 v[68:71], a[48:51], a[72:75], v[68:71]
    ds_read_b128 a[20:23], v8 offset:10240
    v_mfma_f32_16x16x32_bf16 v[72:75], a[52:55], a[72:75], v[72:75]
    v_mfma_f32_16x16x32_bf16 v[76:79], a[56:59], a[72:75], v[76:79]
    buffer_load_dwordx4 v1, s[28:31], s74 offen offset:2048 sc1 lds
    v_mfma_f32_16x16x32_bf16 v[80:83], a[60:63], a[72:75], v[80:83]
    v_mfma_f32_16x16x32_bf16 v[48:51], a[116:119], a[72:75], v[48:51]
    ds_read_b64_tr_b16 a[72:73], v12 offset:1024
    v_mfma_f32_16x16x32_bf16 v[88:91], a[32:35], a[76:79], v[88:91]
    ds_read_b64_tr_b16 a[74:75], v12 offset:1280
    v_mfma_f32_16x16x32_bf16 v[92:95], a[36:39], a[76:79], v[92:95]
    ds_read_b128 a[24:27], v8 offset:12288
    v_mfma_f32_16x16x32_bf16 v[96:99], a[40:43], a[76:79], v[96:99]
    buffer_load_dwordx4 v1, s[28:31], s75 offen offset:3072 sc1 lds
    v_add_u32 v1, 128, v1
    v_mfma_f32_16x16x32_bf16 v[100:103], a[44:47], a[76:79], v[100:103]
    ds_read_b128 a[28:31], v8 offset:14336
    v_mfma_f32_16x16x32_bf16 v[104:107], a[48:51], a[76:79], v[104:107]
    s_add_u32 m0, s78, 43008
    v_mfma_f32_16x16x32_bf16 v[108:111], a[52:55], a[76:79], v[108:111]
    buffer_load_dwordx4 v2, s[28:31], s68 offen offset:0 sc1 lds
    v_mfma_f32_16x16x32_bf16 v[112:115], a[56:59], a[76:79], v[112:115]
    v_mfma_f32_16x16x32_bf16 v[116:119], a[60:63], a[76:79], v[116:119]
    ds_read_b128 a[112:115], v10 offset:0
    v_mfma_f32_16x16x32_bf16 v[84:87], a[116:119], a[76:79], v[84:87]
    ds_read_b64_tr_b16 a[76:77], v14 offset:1024
    v_mfma_f32_16x16x32_bf16 a[192:195], a[80:83], a[32:35], a[192:195]
    ds_read_b64_tr_b16 a[78:79], v14 offset:1280
    v_mfma_f32_16x16x32_bf16 a[200:203], a[80:83], a[36:39], a[200:203]
    buffer_load_dwordx4 v2, s[28:31], s69 offen offset:1024 sc1 lds
    v_mfma_f32_16x16x32_bf16 a[208:211], a[80:83], a[40:43], a[208:211]
    ds_read_b64_tr_b16 a[96:97], v12 offset:4096
    v_mfma_f32_16x16x32_bf16 a[216:219], a[80:83], a[44:47], a[216:219]
    buffer_load_dwordx4 v2, s[28:31], s70 offen offset:2048 sc1 lds
    v_mfma_f32_16x16x32_bf16 a[224:227], a[80:83], a[48:51], a[224:227]
    v_mfma_f32_16x16x32_bf16 a[232:235], a[80:83], a[52:55], a[232:235]
    v_mfma_f32_16x16x32_bf16 a[240:243], a[80:83], a[56:59], a[240:243]
    ds_read_b64_tr_b16 a[98:99], v12 offset:4352
    v_mfma_f32_16x16x32_bf16 a[248:251], a[80:83], a[60:63], a[248:251]
    ds_read_b64_tr_b16 a[80:81], v12 offset:2048
    v_mfma_f32_16x16x32_bf16 a[196:199], a[84:87], a[32:35], a[196:199]
    ds_read_b64_tr_b16 a[82:83], v12 offset:2304
    v_mfma_f32_16x16x32_bf16 a[204:207], a[84:87], a[36:39], a[204:207]
    buffer_load_dwordx4 v2, s[28:31], s71 offen offset:3072 sc1 lds
    v_mfma_f32_16x16x32_bf16 a[212:215], a[84:87], a[40:43], a[212:215]
    ds_read_b64_tr_b16 a[100:101], v14 offset:4096
    s_add_u32 m0, s78, 47104
    v_mfma_f32_16x16x32_bf16 a[220:223], a[84:87], a[44:47], a[220:223]
    buffer_load_dwordx4 v2, s[28:31], s72 offen offset:0 sc1 lds
    v_mfma_f32_16x16x32_bf16 a[228:231], a[84:87], a[48:51], a[228:231]
    v_mfma_f32_16x16x32_bf16 a[236:239], a[84:87], a[52:55], a[236:239]
    v_mfma_f32_16x16x32_bf16 a[244:247], a[84:87], a[56:59], a[244:247]
    ds_read_b64_tr_b16 a[102:103], v14 offset:4352
    v_mfma_f32_16x16x32_bf16 a[252:255], a[84:87], a[60:63], a[252:255]
    ds_read_b64_tr_b16 a[84:85], v14 offset:2048
    v_mfma_f32_16x16x32_bf16 v[128:131], a[88:91], a[32:35], v[128:131]
    ds_read_b64_tr_b16 a[86:87], v14 offset:2304
    v_mfma_f32_16x16x32_bf16 v[144:147], a[88:91], a[36:39], v[144:147]
    buffer_load_dwordx4 v2, s[28:31], s73 offen offset:1024 sc1 lds
    v_mfma_f32_16x16x32_bf16 v[160:163], a[88:91], a[40:43], v[160:163]
    v_mfma_f32_16x16x32_bf16 v[176:179], a[88:91], a[44:47], v[176:179]
    buffer_load_dwordx4 v2, s[28:31], s74 offen offset:2048 sc1 lds
    v_mfma_f32_16x16x32_bf16 v[192:195], a[88:91], a[48:51], v[192:195]
    v_mfma_f32_16x16x32_bf16 v[208:211], a[88:91], a[52:55], v[208:211]
    v_mfma_f32_16x16x32_bf16 v[224:227], a[88:91], a[56:59], v[224:227]
    v_mfma_f32_16x16x32_bf16 v[240:243], a[88:91], a[60:63], v[240:243]
    ds_read_b64_tr_b16 a[88:89], v12 offset:3072
    v_mfma_f32_16x16x32_bf16 v[132:135], a[92:95], a[32:35], v[132:135]
    ds_read_b64_tr_b16 a[90:91], v12 offset:3328
    v_mfma_f32_16x16x32_bf16 v[148:151], a[92:95], a[36:39], v[148:151]
    buffer_load_dwordx4 v2, s[28:31], s75 offen offset:3072 sc1 lds
    v_add_u32 v2, 128, v2
    v_mfma_f32_16x16x32_bf16 v[164:167], a[92:95], a[40:43], v[164:167]
    v_mfma_f32_16x16x32_bf16 v[180:183], a[92:95], a[44:47], v[180:183]
    v_mfma_f32_16x16x32_bf16 v[196:199], a[92:95], a[48:51], v[196:199]
    v_mfma_f32_16x16x32_bf16 v[212:215], a[92:95], a[52:55], v[212:215]
    v_mfma_f32_16x16x32_bf16 v[228:231], a[92:95], a[56:59], v[228:231]
    v_mfma_f32_16x16x32_bf16 v[244:247], a[92:95], a[60:63], v[244:247]
    ds_read_b64_tr_b16 a[92:93], v14 offset:3072
    v_mfma_f32_16x16x32_bf16 v[136:139], a[104:107], a[32:35], v[136:139]
    ds_read_b64_tr_b16 a[94:95], v14 offset:3328
    v_mfma_f32_16x16x32_bf16 v[152:155], a[104:107], a[36:39], v[152:155]
    v_mfma_f32_16x16x32_bf16 v[168:171], a[104:107], a[40:43], v[168:171]
    v_mfma_f32_16x16x32_bf16 v[184:187], a[104:107], a[44:47], v[184:187]
    v_mfma_f32_16x16x32_bf16 v[200:203], a[104:107], a[48:51], v[200:203]
    v_mfma_f32_16x16x32_bf16 v[216:219], a[104:107], a[52:55], v[216:219]
    v_mfma_f32_16x16x32_bf16 v[232:235], a[104:107], a[56:59], v[232:235]
    v_mfma_f32_16x16x32_bf16 v[248:251], a[104:107], a[60:63], v[248:251]
    v_mfma_f32_16x16x32_bf16 v[140:143], a[108:111], a[32:35], v[140:143]
    v_mfma_f32_16x16x32_bf16 v[156:159], a[108:111], a[36:39], v[156:159]
    v_mfma_f32_16x16x32_bf16 v[172:175], a[108:111], a[40:43], v[172:175]
    v_mfma_f32_16x16x32_bf16 v[188:191], a[108:111], a[44:47], v[188:191]
    v_mfma_f32_16x16x32_bf16 v[204:207], a[108:111], a[48:51], v[204:207]
    v_mfma_f32_16x16x32_bf16 v[220:223], a[108:111], a[52:55], v[220:223]
    v_mfma_f32_16x16x32_bf16 v[236:239], a[108:111], a[56:59], v[236:239]
    v_mfma_f32_16x16x32_bf16 v[252:255], a[108:111], a[60:63], v[252:255]
    s_sub_u32 s67, s67, 1
    s_cmp_lg_u32 s67, 0
    s_cbranch_scc1 L_loop0
L_tail0:
    s_waitcnt lgkmcnt(0)
    s_barrier
    v_mfma_f32_16x16x32_bf16 a[128:131], a[64:67], a[0:3], a[128:131]
    s_getpc_b64 s[86:87]
L_pc0:
    s_sub_u32 s86, s86, L_pc0-L_tail0
    s_subb_u32 s87, s87, 0
    s_lshr_b32 s82, s2, 3
    s_lshl_b32 s82, s82, 2
    s_add_u32 s82, s82, s60
    s_lshl_b32 s82, s82, 10
    v_add_u32 v34, s82, v16
    v_min_u32 v34, L_code_end-L_tail0-4, v34
    global_load_dword v7, v34, s[86:87]
    v_mfma_f32_16x16x32_bf16 a[136:139], a[64:67], a[4:7], a[136:139]
    v_mfma_f32_16x16x32_bf16 a[144:147], a[64:67], a[8:11], a[144:147]
    ds_read_b128 a[32:35], v9 offset:0
    s_and_b32 s82, s2, 7
    s_lshl_b32 s82, s82, 5
    s_lshr_b32 s83, s2, 3
    s_add_u32 s82, s82, s83
    s_lshl_b32 s82, s82, 2
    s_add_u32 s82, s82, s60
    s_mul_i32 s82, s82, 7168
    v_min_u32 v34, 55, v0
    v_lshlrev_b32 v34, 7, v34
    v_add_u32 v34, s82, v34
    global_load_dword v7, v34, s[20:21]
    v_mfma_f32_16x16x32_bf16 a[152:155], a[64:67], a[12:15], a[152:155]
    v_mfma_f32_16x16x32_bf16 a[160:163], a[64:67], a[16:19], a[160:163]
    v_mfma_f32_16x16x32_bf16 a[168:171], a[64:67], a[20:23], a[168:171]
    v_mfma_f32_16x16x32_bf16 a[176:179], a[64:67], a[24:27], a[176:179]
    ds_read_b128 a[36:39], v9 offset:2048
    v_mfma_f32_16x16x32_bf16 a[184:187], a[64:67], a[28:31], a[184:187]
    v_mfma_f32_16x16x32_bf16 v[120:123], a[64:67], a[112:115], v[120:123]
    ds_read_b64_tr_b16 a[64:65], v12 offset:20480
    v_mfma_f32_16x16x32_bf16 a[132:135], a[68:71], a[0:3], a[132:135]
    ds_read_b64_tr_b16 a[66:67], v12 offset:20736
    v_mfma_f32_16x16x32_bf16 a[140:143], a[68:71], a[4:7], a[140:143]
    ds_read_b128 a[40:43], v9 offset:4096
    v_mfma_f32_16x16x32_bf16 a[148:151], a[68:71], a[8:11], a[148:151]
    v_mfma_f32_16x16x32_bf16 a[156:159], a[68:71], a[12:15], a[156:159]
    v_mfma_f32_16x16x32_bf16 a[164:167], a[68:71], a[16:19], a[164:167]
    v_mfma_f32_16x16x32_bf16 a[172:175], a[68:71], a[20:23], a[172:175]
    ds_read_b128 a[44:47], v9 offset:6144
    v_mfma_f32_16x16x32_bf16 a[180:183], a[68:71], a[24:27], a[180:183]
    v_mfma_f32_16x16x32_bf16 a[188:191], a[68:71], a[28:31], a[188:191]
    v_mfma_f32_16x16x32_bf16 v[124:127], a[68:71], a[112:115], v[124:127]
    ds_read_b64_tr_b16 a[68:69], v14 offset:20480
    v_mfma_f32_16x16x32_bf16 v[52:55], a[0:3], a[72:75], v[52:55]
    ds_read_b64_tr_b16 a[70:71], v14 offset:20736
    v_mfma_f32_16x16x32_bf16 v[56:59], a[4:7], a[72:75], v[56:59]
    v_mfma_f32_16x16x32_bf16 v[60:63], a[8:11], a[72:75], v[60:63]
    ds_read_b128 a[48:51], v9 offset:8192
    s_lshl_b32 s82, s2, 2
    s_add_u32 s82, s82, s60
    s_lshl_b32 s82, s82, 11
    v_and_b32 v35, 31, v0
    v_lshlrev_b32 v35, 6, v35
    v_add_u32 v35, s82, v35
    global_load_dword v7, v35, s[12:13]
    v_mfma_f32_16x16x32_bf16 v[64:67], a[12:15], a[72:75], v[64:67]
    v_mfma_f32_16x16x32_bf16 v[68:71], a[16:19], a[72:75], v[68:71]
    ds_read_b128 a[52:55], v9 offset:10240
    v_mfma_f32_16x16x32_bf16 v[72:75], a[20:23], a[72:75], v[72:75]
    v_mfma_f32_16x16x32_bf16 v[76:79], a[24:27], a[72:75], v[76:79]
    v_mfma_f32_16x16x32_bf16 v[80:83], a[28:31], a[72:75], v[80:83]
    v_mfma_f32_16x16x32_bf16 v[48:51], a[112:115], a[72:75], v[48:51]
    ds_read_b64_tr_b16 a[72:73], v12 offset:21504
    v_mfma_f32_16x16x32_bf16 v[88:91], a[0:3], a[76:79], v[88:91]
    ds_read_b64_tr_b16 a[74:75], v12 offset:21760
    v_mfma_f32_16x16x32_bf16 v[92:95], a[4:7], a[76:79], v[92:95]
    ds_read_b128 a[56:59], v9 offset:12288
    v_mfma_f32_16x16x32_bf16 v[96:99], a[8:11], a[76:79], v[96:99]
    v_mfma_f32_16x16x32_bf16 v[100:103], a[12:15], a[76:79], v[100:103]
    ds_read_b128 a[60:63], v9 offset:14336
    v_mfma_f32_16x16x32_bf16 v[104:107], a[16:19], a[76:79], v[104:107]
    v_mfma_f32_16x16x32_bf16 v[108:111], a[20:23], a[76:79], v[108:111]
    v_mfma_f32_16x16x32_bf16 v[112:115], a[24:27], a[76:79], v[112:115]
    v_mfma_f32_16x16x32_bf16 v[116:119], a[28:31], a[76:79], v[116:119]
    ds_read_b128 a[116:119], v11 offset:0
    v_mfma_f32_16x16x32_bf16 v[84:87], a[112:115], a[76:79], v[84:87]
    ds_read_b64_tr_b16 a[76:77], v14 offset:21504
    v_mfma_f32_16x16x32_bf16 a[192:195], a[80:83], a[0:3], a[192:195]
    ds_read_b64_tr_b16 a[78:79], v14 offset:21760
    v_mfma_f32_16x16x32_bf16 a[200:203], a[80:83], a[4:7], a[200:203]
    v_mfma_f32_16x16x32_bf16 a[208:211], a[80:83], a[8:11], a[208:211]
    ds_read_b64_tr_b16 a[104:105], v12 offset:24576
    v_mfma_f32_16x16x32_bf16 a[216:219], a[80:83], a[12:15], a[216:219]
    v_mfma_f32_16x16x32_bf16 a[224:227], a[80:83], a[16:19], a[224:227]
    v_mfma_f32_16x16x32_bf16 a[232:235], a[80:83], a[20:23], a[232:235]
    v_mfma_f32_16x16x32_bf16 a[240:243], a[80:83], a[24:27], a[240:243]
    ds_read_b64_tr_b16 a[106:107], v12 offset:24832
    v_mfma_f32_16x16x32_bf16 a[248:251], a[80:83], a[28:31], a[248:251]
    ds_read_b64_tr_b16 a[80:81], v12 offset:22528
    v_mfma_f32_16x16x32_bf16 a[196:199], a[84:87], a[0:3], a[196:199]
    ds_read_b64_tr_b16 a[82:83], v12 offset:22784
    v_mfma_f32_16x16x32_bf16 a[204:207], a[84:87], a[4:7], a[204:207]
    v_mfma_f32_16x16x32_bf16 a[212:215], a[84:87], a[8:11], a[212:215]
    ds_read_b64_tr_b16 a[108:109], v14 offset:24576
    v_mfma_f32_16x16x32_bf16 a[220:223], a[84:87], a[12:15], a[220:223]
    v_mfma_f32_16x16x32_bf16 a[228:231], a[84:87], a[16:19], a[228:231]
    v_mfma_f32_16x16x32_bf16 a[236:239], a[84:87], a[20:23], a[236:239]
    v_mfma_f32_16x16x32_bf16 a[244:247], a[84:87], a[24:27], a[244:247]
    ds_read_b64_tr_b16 a[110:111], v14 offset:24832
    v_mfma_f32_16x16x32_bf16 a[252:255], a[84:87], a[28:31], a[252:255]
    ds_read_b64_tr_b16 a[84:85], v14 offset:22528
    v_mfma_f32_16x16x32_bf16 v[128:131], a[88:91], a[0:3], v[128:131]
    ds_read_b64_tr_b16 a[86:87], v14 offset:22784
    v_mfma_f32_16x16x32_bf16 v[144:147], a[88:91], a[4:7], v[144:147]
    v_mfma_f32_16x16x32_bf16 v[160:163], a[88:91], a[8:11], v[160:163]
    v_mfma_f32_16x16x32_bf16 v[176:179], a[88:91], a[12:15], v[176:179]
    v_mfma_f32_16x16x32_bf16 v[192:195], a[88:91], a[16:19], v[192:195]
    v_mfma_f32_16x16x32_bf16 v[208:211], a[88:91], a[20:23], v[208:211]
    v_mfma_f32_16x16x32_bf16 v[224:227], a[88:91], a[24:27], v[224:227]
    v_mfma_f32_16x16x32_bf16 v[240:243], a[88:91], a[28:31], v[240:243]
    ds_read_b64_tr_b16 a[88:89], v12 offset:23552
    v_mfma_f32_16x16x32_bf16 v[132:135], a[92:95], a[0:3], v[132:135]
    ds_read_b64_tr_b16 a[90:91], v12 offset:23808
    v_mfma_f32_16x16x32_bf16 v[148:151], a[92:95], a[4:7], v[148:151]
    v_mfma_f32_16x16x32_bf16 v[164:167], a[92:95], a[8:11], v[164:167]
    v_mfma_f32_16x16x32_bf16 v[180:183], a[92:95], a[12:15], v[180:183]
    v_mfma_f32_16x16x32_bf16 v[196:199], a[92:95], a[16:19], v[196:199]
    v_mfma_f32_16x16x32_bf16 v[212:215], a[92:95], a[20:23], v[212:215]
    v_mfma_f32_16x16x32_bf16 v[228:231], a[92:95], a[24:27], v[228:231]
    v_mfma_f32_16x16x32_bf16 v[244:247], a[92:95], a[28:31], v[244:247]
    ds_read_b64_tr_b16 a[92:93], v14 offset:23552
    v_mfma_f32_16x16x32_bf16 v[136:139], a[96:99], a[0:3], v[136:139]
    ds_read_b64_tr_b16 a[94:95], v14 offset:23808
    v_mfma_f32_16x16x32_bf16 v[152:155], a[96:99], a[4:7], v[152:155]
    v_mfma_f32_16x16x32_bf16 v[168:171], a[96:99], a[8:11], v[168:171]
    v_mfma_f32_16x16x32_bf16 v[184:187], a[96:99], a[12:15], v[184:187]
    v_mfma_f32_16x16x32_bf16 v[200:203], a[96:99], a[16:19], v[200:203]
    v_mfma_f32_16x16x32_bf16 v[216:219], a[96:99], a[20:23], v[216:219]
    v_mfma_f32_16x16x32_bf16 v[232:235], a[96:99], a[24:27], v[232:235]
    v_mfma_f32_16x16x32_bf16 v[248:251], a[96:99], a[28:31], v[248:251]
    v_mfma_f32_16x16x32_bf16 v[140:143], a[100:103], a[0:3], v[140:143]
    v_mfma_f32_16x16x32_bf16 v[156:159], a[100:103], a[4:7], v[156:159]
    v_mfma_f32_16x16x32_bf16 v[172:175], a[100:103], a[8:11], v[172:175]
    v_mfma_f32_16x16x32_bf16 v[188:191], a[100:103], a[12:15], v[188:191]
    v_mfma_f32_16x16x32_bf16 v[204:207], a[100:103], a[16:19], v[204:207]
    v_mfma_f32_16x16x32_bf16 v[220:223], a[100:103], a[20:23], v[220:223]
    v_mfma_f32_16x16x32_bf16 v[236:239], a[100:103], a[24:27], v[236:239]
    v_mfma_f32_16x16x32_bf16 v[252:255], a[100:103], a[28:31], v[252:255]
    s_waitcnt vmcnt(3) lgkmcnt(0)
    s_barrier
    v_mfma_f32_16x16x32_bf16 a[128:131], a[64:67], a[32:35], a[128:131]
    v_mfma_f32_16x16x32_bf16 a[136:139], a[64:67], a[36:39], a[136:139]
    v_mfma_f32_16x16x32_bf16 a[144:147], a[64:67], a[40:43], a[144:147]
    ds_read_b128 a[0:3], v8 offset:34816
    v_mfma_f32_16x16x32_bf16 a[152:155], a[64:67], a[44:47], a[152:155]
    v_mfma_f32_16x16x32_bf16 a[160:163], a[64:67], a[48:51], a[160:163]
    s_mul_i32 s82, s65, 1835008
    s_lshl_b32 s83, s66, 8
    v_mfma_f32_16x16x32_bf16 a[168:171], a[64:67], a[52:55], a[168:171]
    s_add_u32 s82, s82, s83
    s_add_u32 s48, s20, s82
    v_mfma_f32_16x16x32_bf16 a[176:179], a[64:67], a[56:59], a[176:179]
    ds_read_b128 a[4:7], v8 offset:36864
    s_addc_u32 s49, s21, 0
    s_and_b32 s49, s49, 0xffff
    v_mfma_f32_16x16x32_bf16 a[184:187], a[64:67], a[60:63], a[184:187]
    s_sub_u32 s50, 7340032, s82
    s_mov_b32 s51, 0x20000
    v_mfma_f32_16x16x32_bf16 v[120:123], a[64:67], a[116:119], v[120:123]
    ds_read_b64_tr_b16 a[64:65], v13 offset:0
    s_add_u32 s52, s12, s83
    s_addc_u32 s53, s13, 0
    v_mfma_f32_16x16x32_bf16 a[132:135], a[68:71], a[32:35], a[132:135]
    ds_read_b64_tr_b16 a[66:67], v13 offset:256
    s_and_b32 s53, s53, 0xffff
    s_sub_u32 s54, 2097152, s83
    v_mfma_f32_16x16x32_bf16 a[140:143], a[68:71], a[36:39], a[140:143]
    ds_read_b128 a[8:11], v8 offset:38912
    s_mov_b32 s55, 0x20000
    s_lshl_b32 s3, s60, 11
    v_mfma_f32_16x16x32_bf16 a[148:151], a[68:71], a[40:43], a[148:151]
    v_lshrrev_b32 v34, 4, v0
    v_and_b32 v35, 15, v0
    v_mfma_f32_16x16x32_bf16 a[156:159], a[68:71], a[44:47], a[156:159]
    v_lshlrev_b32 v36, 1, v34
    v_add_u32 v36, 0, v36
    v_mfma_f32_16x16x32_bf16 a[164:167], a[68:71], a[48:51], a[164:167]
    v_xor_b32 v36, v36, v35
    v_lshlrev_b32 v36, 4, v36
    v_mfma_f32_16x16x32_bf16 a[172:175], a[68:71], a[52:55], a[172:175]
    ds_read_b128 a[12:15], v8 offset:40960
    v_lshl_add_u32 v36, v34, 11, v36
    s_lshl_b32 s82, s60, 14
    v_mfma_f32_16x16x32_bf16 a[180:183], a[68:71], a[56:59], a[180:183]
    s_add_u32 s82, s82, 0
    v_add_u32 v17, s82, v36
    v_mfma_f32_16x16x32_bf16 a[188:191], a[68:71], a[60:63], a[188:191]
    s_lshl_b32 s82, s62, 1
    s_add_u32 s82, s82, 0
    v_mfma_f32_16x16x32_bf16 v[124:127], a[68:71], a[116:119], v[124:127]
    ds_read_b64_tr_b16 a[68:69], v15 offset:0
    s_lshl_b32 s82, s82, 3
    s_lshl_b32 s83, s61, 2
    v_mfma_f32_16x16x32_bf16 v[52:55], a[32:35], a[72:75], v[52:55]
    ds_read_b64_tr_b16 a[70:71], v15 offset:256
    s_add_u32 s82, s82, s83
    s_mul_i32 s83, s62, 96
    v_mfma_f32_16x16x32_bf16 v[56:59], a[36:39], a[72:75], v[56:59]
    s_add_u32 s82, s82, s83
    s_lshl_b32 s82, s82, 11
    v_mfma_f32_16x16x32_bf16 v[60:63], a[40:43], a[72:75], v[60:63]
    ds_read_b128 a[16:19], v8 offset:43008
    s_sub_u32 s82, s82, 0
    v_add_u32 v19, s82, v36
    v_mfma_f32_16x16x32_bf16 v[64:67], a[44:47], a[72:75], v[64:67]
    v_lshlrev_b32 v36, 1, v34
    v_add_u32 v36, 8, v36
    v_mfma_f32_16x16x32_bf16 v[68:71], a[48:51], a[72:75], v[68:71]
    ds_read_b128 a[20:23], v8 offset:45056
    v_xor_b32 v36, v36, v35
    v_lshlrev_b32 v36, 4, v36
    v_mfma_f32_16x16x32_bf16 v[72:75], a[52:55], a[72:75], v[72:75]
    v_lshl_add_u32 v36, v34, 11, v36
    s_lshl_b32 s82, s60, 14
    v_mfma_f32_16x16x32_bf16 v[76:79], a[56:59], a[72:75], v[76:79]
    s_add_u32 s82, s82, 7168
    v_add_u32 v18, s82, v36
    v_mfma_f32_16x16x32_bf16 v[80:83], a[60:63], a[72:75], v[80:83]
    s_lshl_b32 s82, s62, 1
    s_add_u32 s82, s82, 1
    v_mfma_f32_16x16x32_bf16 v[48:51], a[116:119], a[72:75], v[48:51]
    ds_read_b64_tr_b16 a[72:73], v13 offset:1024
    s_lshl_b32 s82, s82, 3
    s_lshl_b32 s83, s61, 2
    v_mfma_f32_16x16x32_bf16 v[88:91], a[32:35], a[76:79], v[88:91]
    ds_read_b64_tr_b16 a[74:75], v13 offset:1280
    s_add_u32 s82, s82, s83
    s_mul_i32 s83, s62, 96
    v_mfma_f32_16x16x32_bf16 v[92:95], a[36:39], a[76:79], v[92:95]
    ds_read_b128 a[24:27], v8 offset:47104
    s_add_u32 s82, s82, s83
    s_lshl_b32 s82, s82, 11
    v_mfma_f32_16x16x32_bf16 v[96:99], a[40:43], a[76:79], v[96:99]
    s_sub_u32 s82, s82, 1024
    v_add_u32 v20, s82, v36
    v_mfma_f32_16x16x32_bf16 v[100:103], a[44:47], a[76:79], v[100:103]
    ds_read_b128 a[28:31], v8 offset:49152
    s_xor_b32 s82, s65, 0
    s_lshl_b32 s82, s82, 10
    v_mfma_f32_16x16x32_bf16 v[104:107], a[48:51], a[76:79], v[104:107]
    v_add_u32 v21, s82, v16
    s_xor_b32 s82, s65, 1
    v_mfma_f32_16x16x32_bf16 v[108:111], a[52:55], a[76:79], v[108:111]
    s_lshl_b32 s82, s82, 10
    v_add_u32 v22, s82, v16
    v_mfma_f32_16x16x32_bf16 v[112:115], a[56:59], a[76:79], v[112:115]
    s_xor_b32 s82, s65, 2
    s_lshl_b32 s82, s82, 10
    v_mfma_f32_16x16x32_bf16 v[116:119], a[60:63], a[76:79], v[116:119]
    ds_read_b128 a[112:115], v10 offset:34816
    v_add_u32 v23, s82, v16
    s_xor_b32 s82, s65, 3
    v_mfma_f32_16x16x32_bf16 v[84:87], a[116:119], a[76:79], v[84:87]
    ds_read_b64_tr_b16 a[76:77], v15 offset:1024
    s_lshl_b32 s82, s82, 10
    v_add_u32 v24, s82, v16
    v_mfma_f32_16x16x32_bf16 a[192:195], a[80:83], a[32:35], a[192:195]
    ds_read_b64_tr_b16 a[78:79], v15 offset:1280
    s_mov_b32 s94, 0xbdd2d3e8
    s_mov_b32 s95, 0xbdd2d3e8
    v_mfma_f32_16x16x32_bf16 a[200:203], a[80:83], a[36:39], a[200:203]
    v_mov_b32 v26, 0xc0135761
    v_mov_b32 v27, 0xc0135761
    v_mfma_f32_16x16x32_bf16 a[208:211], a[80:83], a[40:43], a[208:211]
    ds_read_b64_tr_b16 a[96:97], v13 offset:4096
    v_mov_b32 v25, 1
    s_lshl_b32 s82, s60, 12
    v_mfma_f32_16x16x32_bf16 a[216:219], a[80:83], a[44:47], a[216:219]
    s_add_u32 s68, s88, s82
    s_lshl_b32 s82, s61, 13
    v_mfma_f32_16x16x32_bf16 a[224:227], a[80:83], a[48:51], a[224:227]
    s_add_u32 s88, s88, s82
    s_lshr_b32 s82, s66, 1
    v_mfma_f32_16x16x32_bf16 a[232:235], a[80:83], a[52:55], a[232:235]
    s_add_u32 s82, s82, 24
    s_lshl_b32 s82, s82, 14
    v_mfma_f32_16x16x32_bf16 a[240:243], a[80:83], a[56:59], a[240:243]
    ds_read_b64_tr_b16 a[98:99], v13 offset:4352
    s_add_u32 s90, s88, s82
    s_lshl_b32 s82, s66, 14
    v_mfma_f32_16x16x32_bf16 a[248:251], a[80:83], a[60:63], a[248:251]
    ds_read_b64_tr_b16 a[80:81], v13 offset:2048
    v_mfma_f32_16x16x32_bf16 a[196:199], a[84:87], a[32:35], a[196:199]
    ds_read_b64_tr_b16 a[82:83], v13 offset:2304
    v_mfma_f32_16x16x32_bf16 a[204:207], a[84:87], a[36:39], a[204:207]
    v_mfma_f32_16x16x32_bf16 a[212:215], a[84:87], a[40:43], a[212:215]
    ds_read_b64_tr_b16 a[100:101], v15 offset:4096
    v_mfma_f32_16x16x32_bf16 a[220:223], a[84:87], a[44:47], a[220:223]
    v_mfma_f32_16x16x32_bf16 a[228:231], a[84:87], a[48:51], a[228:231]
    v_mfma_f32_16x16x32_bf16 a[236:239], a[84:87], a[52:55], a[236:239]
    v_mfma_f32_16x16x32_bf16 a[244:247], a[84:87], a[56:59], a[244:247]
    ds_read_b64_tr_b16 a[102:103], v15 offset:4352
    v_mfma_f32_16x16x32_bf16 a[252:255], a[84:87], a[60:63], a[252:255]
    ds_read_b64_tr_b16 a[84:85], v15 offset:2048
    v_mfma_f32_16x16x32_bf16 v[128:131], a[88:91], a[32:35], v[128:131]
    ds_read_b64_tr_b16 a[86:87], v15 offset:2304
    v_mfma_f32_16x16x32_bf16 v[144:147], a[88:91], a[36:39], v[144:147]
    v_mfma_f32_16x16x32_bf16 v[160:163], a[88:91], a[40:43], v[160:163]
    v_mfma_f32_16x16x32_bf16 v[176:179], a[88:91], a[44:47], v[176:179]
    v_mfma_f32_16x16x32_bf16 v[192:195], a[88:91], a[48:51], v[192:195]
    v_mfma_f32_16x16x32_bf16 v[208:211], a[88:91], a[52:55], v[208:211]
    v_mfma_f32_16x16x32_bf16 v[224:227], a[88:91], a[56:59], v[224:227]
    v_mfma_f32_16x16x32_bf16 v[240:243], a[88:91], a[60:63], v[240:243]
    ds_read_b64_tr_b16 a[88:89], v13 offset:3072
    v_mfma_f32_16x16x32_bf16 v[132:135], a[92:95], a[32:35], v[132:135]
    ds_read_b64_tr_b16 a[90:91], v13 offset:3328
    v_mfma_f32_16x16x32_bf16 v[148:151], a[92:95], a[36:39], v[148:151]
    v_mfma_f32_16x16x32_bf16 v[164:167], a[92:95], a[40:43], v[164:167]
    v_mfma_f32_16x16x32_bf16 v[180:183], a[92:95], a[44:47], v[180:183]
    v_mfma_f32_16x16x32_bf16 v[196:199], a[92:95], a[48:51], v[196:199]
    v_mfma_f32_16x16x32_bf16 v[212:215], a[92:95], a[52:55], v[212:215]
    v_mfma_f32_16x16x32_bf16 v[228:231], a[92:95], a[56:59], v[228:231]
    v_mfma_f32_16x16x32_bf16 v[244:247], a[92:95], a[60:63], v[244:247]
    ds_read_b64_tr_b16 a[92:93], v15 offset:3072
    v_mfma_f32_16x16x32_bf16 v[136:139], a[104:107], a[32:35], v[136:139]
    ds_read_b64_tr_b16 a[94:95], v15 offset:3328
    v_mfma_f32_16x16x32_bf16 v[152:155], a[104:107], a[36:39], v[152:155]
    v_mfma_f32_16x16x32_bf16 v[168:171], a[104:107], a[40:43], v[168:171]
    v_mfma_f32_16x16x32_bf16 v[184:187], a[104:107], a[44:47], v[184:187]
    v_mfma_f32_16x16x32_bf16 v[200:203], a[104:107], a[48:51], v[200:203]
    v_mfma_f32_16x16x32_bf16 v[216:219], a[104:107], a[52:55], v[216:219]
    v_mfma_f32_16x16x32_bf16 v[232:235], a[104:107], a[56:59], v[232:235]
    v_mfma_f32_16x16x32_bf16 v[248:251], a[104:107], a[60:63], v[248:251]
    v_mfma_f32_16x16x32_bf16 v[140:143], a[108:111], a[32:35], v[140:143]
    v_mfma_f32_16x16x32_bf16 v[156:159], a[108:111], a[36:39], v[156:159]
    v_mfma_f32_16x16x32_bf16 v[172:175], a[108:111], a[40:43], v[172:175]
    v_mfma_f32_16x16x32_bf16 v[188:191], a[108:111], a[44:47], v[188:191]
    v_mfma_f32_16x16x32_bf16 v[204:207], a[108:111], a[48:51], v[204:207]
    v_mfma_f32_16x16x32_bf16 v[220:223], a[108:111], a[52:55], v[220:223]
    v_mfma_f32_16x16x32_bf16 v[236:239], a[108:111], a[56:59], v[236:239]
    v_mfma_f32_16x16x32_bf16 v[252:255], a[108:111], a[60:63], v[252:255]
    s_waitcnt lgkmcnt(0)
    s_barrier
    v_mfma_f32_16x16x32_bf16 a[128:131], a[64:67], a[0:3], a[128:131]
    v_mfma_f32_16x16x32_bf16 a[136:139], a[64:67], a[4:7], a[136:139]
    v_mfma_f32_16x16x32_bf16 a[144:147], a[64:67], a[8:11], a[144:147]
    ds_read_b128 a[32:35], v9 offset:34816
    v_mfma_f32_16x16x32_bf16 a[152:155], a[64:67], a[12:15], a[152:155]
    v_mfma_f32_16x16x32_bf16 a[160:163], a[64:67], a[16:19], a[160:163]
    s_add_u32 s88, s88, s82
    s_add_u32 s89, s88, 262144
    v_mfma_f32_16x16x32_bf16 a[168:171], a[64:67], a[20:23], a[168:171]
    s_mov_b32 s76, s93
    s_lshl_b32 s82, s63, 4
    v_mfma_f32_16x16x32_bf16 a[176:179], a[64:67], a[24:27], a[176:179]
    ds_read_b128 a[36:39], v9 offset:36864
    s_lshl_b32 s83, s60, 2
    s_add_u32 s83, s83, s82
    v_mfma_f32_16x16x32_bf16 a[184:187], a[64:67], a[28:31], a[184:187]
    s_add_u32 s83, s83, s65
    s_lshl_b32 s83, s83, 15
    v_mfma_f32_16x16x32_bf16 v[120:123], a[64:67], a[112:115], v[120:123]
    ds_read_b64_tr_b16 a[64:65], v13 offset:20480
    s_add_u32 s69, s83, 4194304
    s_lshl_b32 s84, s63, 3
    v_mfma_f32_16x16x32_bf16 a[132:135], a[68:71], a[0:3], a[132:135]
    ds_read_b64_tr_b16 a[66:67], v13 offset:20736
    s_add_u32 s84, s84, s66
    s_lshl_b32 s85, s84, 2
    v_mfma_f32_16x16x32_bf16 a[140:143], a[68:71], a[4:7], a[140:143]
    ds_read_b128 a[40:43], v9 offset:38912
    s_add_u32 s85, s85, s60
    s_lshl_b32 s85, s85, 8
    v_mfma_f32_16x16x32_bf16 a[148:151], a[68:71], a[8:11], a[148:151]
    s_add_u32 s77, s85, 39862272
    s_lshl_b32 s84, s84, 18
    v_mfma_f32_16x16x32_bf16 a[156:159], a[68:71], a[12:15], a[156:159]
    s_lshl_b32 s85, s60, 12
    s_add_u32 s84, s84, s85
    v_mfma_f32_16x16x32_bf16 a[164:167], a[68:71], a[16:19], a[164:167]
    s_add_u32 s84, s84, 23068672
    s_xor_b32 s85, s65, 1
    v_mfma_f32_16x16x32_bf16 a[172:175], a[68:71], a[20:23], a[172:175]
    ds_read_b128 a[44:47], v9 offset:40960
    s_lshl_b32 s85, s85, 16
    s_add_u32 s70, s84, s85
    v_mfma_f32_16x16x32_bf16 a[180:183], a[68:71], a[24:27], a[180:183]
    s_add_u32 s70, s70, 16384
    s_lshl_b32 s85, s65, 16
    v_mfma_f32_16x16x32_bf16 a[188:191], a[68:71], a[28:31], a[188:191]
    s_add_u32 s73, s84, s85
    s_add_u32 s73, s73, 16384
    v_mfma_f32_16x16x32_bf16 v[124:127], a[68:71], a[112:115], v[124:127]
    ds_read_b64_tr_b16 a[68:69], v15 offset:20480
    s_xor_b32 s85, s65, 2
    s_lshl_b32 s85, s85, 16
    v_mfma_f32_16x16x32_bf16 v[52:55], a[0:3], a[72:75], v[52:55]
    ds_read_b64_tr_b16 a[70:71], v15 offset:20736
    s_add_u32 s71, s84, s85
    s_add_u32 s71, s71, 32768
    v_mfma_f32_16x16x32_bf16 v[56:59], a[4:7], a[72:75], v[56:59]
    s_lshl_b32 s85, s65, 16
    s_add_u32 s74, s84, s85
    v_mfma_f32_16x16x32_bf16 v[60:63], a[8:11], a[72:75], v[60:63]
    ds_read_b128 a[48:51], v9 offset:43008
    s_add_u32 s74, s74, 32768
    s_xor_b32 s85, s65, 3
    v_mfma_f32_16x16x32_bf16 v[64:67], a[12:15], a[72:75], v[64:67]
    s_lshl_b32 s85, s85, 16
    s_add_u32 s72, s84, s85
    v_mfma_f32_16x16x32_bf16 v[68:71], a[16:19], a[72:75], v[68:71]
    ds_read_b128 a[52:55], v9 offset:45056
    s_add_u32 s72, s72, 49152
    s_lshl_b32 s85, s65, 16
    v_mfma_f32_16x16x32_bf16 v[72:75], a[20:23], a[72:75], v[72:75]
    s_add_u32 s75, s84, s85
    s_add_u32 s75, s75, 49152
    v_mfma_f32_16x16x32_bf16 v[76:79], a[24:27], a[72:75], v[76:79]
    s_lshl_b32 s83, s61, 3
    s_add_u32 s82, s82, s83
    v_mfma_f32_16x16x32_bf16 v[80:83], a[28:31], a[72:75], v[80:83]
    s_lshl_b32 s82, s82, 5
    s_add_u32 s82, s82, s64
    v_mfma_f32_16x16x32_bf16 v[48:51], a[112:115], a[72:75], v[48:51]
    ds_read_b64_tr_b16 a[72:73], v13 offset:21504
    s_lshl_b32 s82, s82, 10
    s_add_u32 s91, s82, 4194304
    v_mfma_f32_16x16x32_bf16 v[88:91], a[0:3], a[76:79], v[88:91]
    ds_read_b64_tr_b16 a[74:75], v13 offset:21760
    v_mov_b32 v42, 1
    v_and_b32 v37, 1, v35
    v_mfma_f32_16x16x32_bf16 v[92:95], a[4:7], a[76:79], v[92:95]
    ds_read_b128 a[56:59], v9 offset:47104
    v_lshl_add_u32 v36, v34, 2, v37
    v_cmp_le_u32 s[4:5], v36, v35
    v_mfma_f32_16x16x32_bf16 v[96:99], a[8:11], a[76:79], v[96:99]
    v_add_u32 v36, 2, v36
    v_cmp_le_u32 s[6:7], v36, v35
    v_mfma_f32_16x16x32_bf16 v[100:103], a[12:15], a[76:79], v[100:103]
    ds_read_b128 a[60:63], v9 offset:49152
    v_mul_u32_u24 v36, 0x0202, v37
    v_lshlrev_b32 v36, 16, v36
    v_mfma_f32_16x16x32_bf16 v[104:107], a[16:19], a[76:79], v[104:107]
    v_add_u32 v36, 0x01000c0c, v36
    v_add_u32 v38, 0x04040000, v36
    v_mfma_f32_16x16x32_bf16 v[108:111], a[20:23], a[76:79], v[108:111]
    v_cndmask_b32 v28, v36, v38, s[4:5]
    v_cndmask_b32 v29, v36, v38, s[6:7]
    v_mfma_f32_16x16x32_bf16 v[112:115], a[24:27], a[76:79], v[112:115]
    v_cmp_eq_u32 vcc, 1, v37
    v_mov_b32 v36, 0x0c0c0100
    v_mfma_f32_16x16x32_bf16 v[116:119], a[28:31], a[76:79], v[116:119]
    ds_read_b128 a[116:119], v11 offset:34816
    v_mov_b32 v38, 0x01000c0c
    v_cndmask_b32 v36, v36, v38, vcc
    v_mfma_f32_16x16x32_bf16 v[84:87], a[112:115], a[76:79], v[84:87]
    ds_read_b64_tr_b16 a[76:77], v15 offset:21504
    v_mov_b32 v38, 0x0c0c0302
    v_mov_b32 v39, 0x03020c0c
    v_mfma_f32_16x16x32_bf16 a[192:195], a[80:83], a[0:3], a[192:195]
    ds_read_b64_tr_b16 a[78:79], v15 offset:21760
    v_cndmask_b32 v38, v38, v39, vcc
    v_mov_b32 v39, 0x0c0c0c0c
    v_mfma_f32_16x16x32_bf16 a[200:203], a[80:83], a[4:7], a[200:203]
    v_cndmask_b32 v30, v36, v39, s[4:5]
    v_cndmask_b32 v31, v38, v39, s[6:7]
    v_mfma_f32_16x16x32_bf16 a[208:211], a[80:83], a[8:11], a[208:211]
    ds_read_b64_tr_b16 a[104:105], v13 offset:24576
    v_cndmask_b32 v32, v39, v36, s[4:5]
    v_cndmask_b32 v33, v39, v38, s[6:7]
    v_mfma_f32_16x16x32_bf16 a[216:219], a[80:83], a[12:15], a[216:219]
    s_or_b32 s82, s63, s61
    s_cmp_eq_u32 s82, 0
    v_mfma_f32_16x16x32_bf16 a[224:227], a[80:83], a[16:19], a[224:227]
    s_cselect_b64 s[4:5], s[4:5], -1
    s_cselect_b64 s[6:7], s[6:7], -1
    v_mfma_f32_16x16x32_bf16 a[232:235], a[80:83], a[20:23], a[232:235]
    s_mov_b32 s14, 0x3e3504f3
    s_mov_b32 s15, 0x3e3504f3
    v_mfma_f32_16x16x32_bf16 a[240:243], a[80:83], a[24:27], a[240:243]
    ds_read_b64_tr_b16 a[106:107], v13 offset:24832
    s_mov_b32 s98, 0x3fb8aa3b
    s_mov_b32 s99, 0x3fb8aa3b
    v_mfma_f32_16x16x32_bf16 a[248:251], a[80:83], a[28:31], a[248:251]
    ds_read_b64_tr_b16 a[80:81], v13 offset:22528
    v_mfma_f32_16x16x32_bf16 a[196:199], a[84:87], a[0:3], a[196:199]
    ds_read_b64_tr_b16 a[82:83], v13 offset:22784
    v_mfma_f32_16x16x32_bf16 a[204:207], a[84:87], a[4:7], a[204:207]
    v_mfma_f32_16x16x32_bf16 a[212:215], a[84:87], a[8:11], a[212:215]
    ds_read_b64_tr_b16 a[108:109], v15 offset:24576
    v_mfma_f32_16x16x32_bf16 a[220:223], a[84:87], a[12:15], a[220:223]
    v_mfma_f32_16x16x32_bf16 a[228:231], a[84:87], a[16:19], a[228:231]
    v_mfma_f32_16x16x32_bf16 a[236:239], a[84:87], a[20:23], a[236:239]
    v_mfma_f32_16x16x32_bf16 a[244:247], a[84:87], a[24:27], a[244:247]
    ds_read_b64_tr_b16 a[110:111], v15 offset:24832
    v_mfma_f32_16x16x32_bf16 a[252:255], a[84:87], a[28:31], a[252:255]
    ds_read_b64_tr_b16 a[84:85], v15 offset:22528
    v_mfma_f32_16x16x32_bf16 v[128:131], a[88:91], a[0:3], v[128:131]
    ds_read_b64_tr_b16 a[86:87], v15 offset:22784
    v_mfma_f32_16x16x32_bf16 v[144:147], a[88:91], a[4:7], v[144:147]
    v_mfma_f32_16x16x32_bf16 v[160:163], a[88:91], a[8:11], v[160:163]
    v_mfma_f32_16x16x32_bf16 v[176:179], a[88:91], a[12:15], v[176:179]
    v_mfma_f32_16x16x32_bf16 v[192:195], a[88:91], a[16:19], v[192:195]
    v_mfma_f32_16x16x32_bf16 v[208:211], a[88:91], a[20:23], v[208:211]
    v_mfma_f32_16x16x32_bf16 v[224:227], a[88:91], a[24:27], v[224:227]
    v_mfma_f32_16x16x32_bf16 v[240:243], a[88:91], a[28:31], v[240:243]
    ds_read_b64_tr_b16 a[88:89], v13 offset:23552
    v_mfma_f32_16x16x32_bf16 v[132:135], a[92:95], a[0:3], v[132:135]
    ds_read_b64_tr_b16 a[90:91], v13 offset:23808
    v_mfma_f32_16x16x32_bf16 v[148:151], a[92:95], a[4:7], v[148:151]
    v_mfma_f32_16x16x32_bf16 v[164:167], a[92:95], a[8:11], v[164:167]
    v_mfma_f32_16x16x32_bf16 v[180:183], a[92:95], a[12:15], v[180:183]
    v_mfma_f32_16x16x32_bf16 v[196:199], a[92:95], a[16:19], v[196:199]
    v_mfma_f32_16x16x32_bf16 v[212:215], a[92:95], a[20:23], v[212:215]
    v_mfma_f32_16x16x32_bf16 v[228:231], a[92:95], a[24:27], v[228:231]
    v_mfma_f32_16x16x32_bf16 v[244:247], a[92:95], a[28:31], v[244:247]
    ds_read_b64_tr_b16 a[92:93], v15 offset:23552
    v_mfma_f32_16x16x32_bf16 v[136:139], a[96:99], a[0:3], v[136:139]
    ds_read_b64_tr_b16 a[94:95], v15 offset:23808
    v_mfma_f32_16x16x32_bf16 v[152:155], a[96:99], a[4:7], v[152:155]
    v_mfma_f32_16x16x32_bf16 v[168:171], a[96:99], a[8:11], v[168:171]
    v_mfma_f32_16x16x32_bf16 v[184:187], a[96:99], a[12:15], v[184:187]
    v_mfma_f32_16x16x32_bf16 v[200:203], a[96:99], a[16:19], v[200:203]
    v_mfma_f32_16x16x32_bf16 v[216:219], a[96:99], a[20:23], v[216:219]
    v_mfma_f32_16x16x32_bf16 v[232:235], a[96:99], a[24:27], v[232:235]
    v_mfma_f32_16x16x32_bf16 v[248:251], a[96:99], a[28:31], v[248:251]
    v_mfma_f32_16x16x32_bf16 v[140:143], a[100:103], a[0:3], v[140:143]
    v_mfma_f32_16x16x32_bf16 v[156:159], a[100:103], a[4:7], v[156:159]
    v_mfma_f32_16x16x32_bf16 v[172:175], a[100:103], a[8:11], v[172:175]
    v_mfma_f32_16x16x32_bf16 v[188:191], a[100:103], a[12:15], v[188:191]
    v_mfma_f32_16x16x32_bf16 v[204:207], a[100:103], a[16:19], v[204:207]
    v_mfma_f32_16x16x32_bf16 v[220:223], a[100:103], a[20:23], v[220:223]
    v_mfma_f32_16x16x32_bf16 v[236:239], a[100:103], a[24:27], v[236:239]
    v_mfma_f32_16x16x32_bf16 v[252:255], a[100:103], a[28:31], v[252:255]
    s_waitcnt lgkmcnt(0)
    s_barrier
    v_mfma_f32_16x16x32_bf16 a[128:131], a[64:67], a[32:35], a[128:131]
    v_mfma_f32_16x16x32_bf16 a[136:139], a[64:67], a[36:39], a[136:139]
    v_mfma_f32_16x16x32_bf16 a[144:147], a[64:67], a[40:43], a[144:147]
    s_mov_b32 s82, 0
    s_add_u32 m0, s3, 0
    v_mfma_f32_16x16x32_bf16 a[152:155], a[64:67], a[44:47], a[152:155]
    buffer_load_dwordx4 v17, s[48:51], s82 offen lds
    v_mfma_f32_16x16x32_bf16 a[160:163], a[64:67], a[48:51], a[160:163]
    v_mfma_f32_16x16x32_bf16 a[168:171], a[64:67], a[52:55], a[168:171]
    v_mfma_f32_16x16x32_bf16 a[176:179], a[64:67], a[56:59], a[176:179]
    v_mfma_f32_16x16x32_bf16 a[184:187], a[64:67], a[60:63], a[184:187]
    buffer_load_dwordx4 v18, s[48:51], s82 offen offset:1024 lds
    v_mfma_f32_16x16x32_bf16 v[120:123], a[64:67], a[116:119], v[120:123]
    v_mfma_f32_16x16x32_bf16 a[132:135], a[68:71], a[32:35], a[132:135]
    v_mfma_f32_16x16x32_bf16 a[140:143], a[68:71], a[36:39], a[140:143]
    v_mfma_f32_16x16x32_bf16 a[148:151], a[68:71], a[40:43], a[148:151]
    s_mov_b32 s83, 229376
    s_add_u32 m0, s3, 8192
    v_mfma_f32_16x16x32_bf16 a[156:159], a[68:71], a[44:47], a[156:159]
    buffer_load_dwordx4 v17, s[48:51], s83 offen lds
    v_mfma_f32_16x16x32_bf16 a[164:167], a[68:71], a[48:51], a[164:167]
    v_mfma_f32_16x16x32_bf16 a[172:175], a[68:71], a[52:55], a[172:175]
    v_mfma_f32_16x16x32_bf16 a[180:183], a[68:71], a[56:59], a[180:183]
    v_mfma_f32_16x16x32_bf16 a[188:191], a[68:71], a[60:63], a[188:191]
    buffer_load_dwordx4 v18, s[48:51], s83 offen offset:1024 lds
    v_mfma_f32_16x16x32_bf16 v[124:127], a[68:71], a[116:119], v[124:127]
    v_mfma_f32_16x16x32_bf16 v[52:55], a[32:35], a[72:75], v[52:55]
    v_mfma_f32_16x16x32_bf16 v[56:59], a[36:39], a[72:75], v[56:59]
    v_mfma_f32_16x16x32_bf16 v[60:63], a[40:43], a[72:75], v[60:63]
    s_mov_b32 s82, 458752
    s_add_u32 m0, s3, 16384
    v_mfma_f32_16x16x32_bf16 v[64:67], a[44:47], a[72:75], v[64:67]
    buffer_load_dwordx4 v17, s[48:51], s82 offen lds
    v_mfma_f32_16x16x32_bf16 v[68:71], a[48:51], a[72:75], v[68:71]
    v_mfma_f32_16x16x32_bf16 v[72:75], a[52:55], a[72:75], v[72:75]
    v_mfma_f32_16x16x32_bf16 v[76:79], a[56:59], a[72:75], v[76:79]
    v_mfma_f32_16x16x32_bf16 v[80:83], a[60:63], a[72:75], v[80:83]
    buffer_load_dwordx4 v18, s[48:51], s82 offen offset:1024 lds
    v_mfma_f32_16x16x32_bf16 v[48:51], a[116:119], a[72:75], v[48:51]
    v_mfma_f32_16x16x32_bf16 v[88:91], a[32:35], a[76:79], v[88:91]
    v_mfma_f32_16x16x32_bf16 v[92:95], a[36:39], a[76:79], v[92:95]
    v_mfma_f32_16x16x32_bf16 v[96:99], a[40:43], a[76:79], v[96:99]
    s_mov_b32 s83, 688128
    s_add_u32 m0, s3, 24576
    v_mfma_f32_16x16x32_bf16 v[100:103], a[44:47], a[76:79], v[100:103]
    buffer_load_dwordx4 v17, s[48:51], s83 offen lds
    v_mfma_f32_16x16x32_bf16 v[104:107], a[48:51], a[76:79], v[104:107]
    v_mfma_f32_16x16x32_bf16 v[108:111], a[52:55], a[76:79], v[108:111]
    v_mfma_f32_16x16x32_bf16 v[112:115], a[56:59], a[76:79], v[112:115]
    v_mfma_f32_16x16x32_bf16 v[116:119], a[60:63], a[76:79], v[116:119]
    buffer_load_dwordx4 v18, s[48:51], s83 offen offset:1024 lds
    v_mfma_f32_16x16x32_bf16 v[84:87], a[116:119], a[76:79], v[84:87]
    v_mfma_f32_16x16x32_bf16 a[192:195], a[80:83], a[32:35], a[192:195]
    v_mfma_f32_16x16x32_bf16 a[200:203], a[80:83], a[36:39], a[200:203]
    v_mfma_f32_16x16x32_bf16 a[208:211], a[80:83], a[40:43], a[208:211]
    s_mov_b32 s82, 917504
    s_add_u32 m0, s3, 32768
    v_mfma_f32_16x16x32_bf16 a[216:219], a[80:83], a[44:47], a[216:219]
    buffer_load_dwordx4 v17, s[48:51], s82 offen lds
    v_mfma_f32_16x16x32_bf16 a[224:227], a[80:83], a[48:51], a[224:227]
    v_mfma_f32_16x16x32_bf16 a[232:235], a[80:83], a[52:55], a[232:235]
    v_mfma_f32_16x16x32_bf16 a[240:243], a[80:83], a[56:59], a[240:243]
    v_mfma_f32_16x16x32_bf16 a[248:251], a[80:83], a[60:63], a[248:251]
    buffer_load_dwordx4 v18, s[48:51], s82 offen offset:1024 lds
    v_mfma_f32_16x16x32_bf16 a[196:199], a[84:87], a[32:35], a[196:199]
    v_mfma_f32_16x16x32_bf16 a[204:207], a[84:87], a[36:39], a[204:207]
    v_mfma_f32_16x16x32_bf16 a[212:215], a[84:87], a[40:43], a[212:215]
    v_mfma_f32_16x16x32_bf16 a[220:223], a[84:87], a[44:47], a[220:223]
    s_mov_b32 s83, 1146880
    s_add_u32 m0, s3, 40960
    v_mfma_f32_16x16x32_bf16 a[228:231], a[84:87], a[48:51], a[228:231]
    buffer_load_dwordx4 v17, s[48:51], s83 offen lds
    v_mfma_f32_16x16x32_bf16 a[236:239], a[84:87], a[52:55], a[236:239]
    v_mfma_f32_16x16x32_bf16 a[244:247], a[84:87], a[56:59], a[244:247]
    v_mfma_f32_16x16x32_bf16 a[252:255], a[84:87], a[60:63], a[252:255]
    v_mfma_f32_16x16x32_bf16 v[128:131], a[88:91], a[32:35], v[128:131]
    buffer_load_dwordx4 v18, s[48:51], s83 offen offset:1024 lds
    v_mfma_f32_16x16x32_bf16 v[144:147], a[88:91], a[36:39], v[144:147]
    v_mfma_f32_16x16x32_bf16 v[160:163], a[88:91], a[40:43], v[160:163]
    v_mfma_f32_16x16x32_bf16 v[176:179], a[88:91], a[44:47], v[176:179]
    v_mfma_f32_16x16x32_bf16 v[192:195], a[88:91], a[48:51], v[192:195]
    s_mov_b32 s82, 1376256
    s_add_u32 m0, s3, 49152
    v_mfma_f32_16x16x32_bf16 v[208:211], a[88:91], a[52:55], v[208:211]
    buffer_load_dwordx4 v17, s[48:51], s82 offen lds
    v_mfma_f32_16x16x32_bf16 v[224:227], a[88:91], a[56:59], v[224:227]
    v_mfma_f32_16x16x32_bf16 v[240:243], a[88:91], a[60:63], v[240:243]
    v_mfma_f32_16x16x32_bf16 v[132:135], a[92:95], a[32:35], v[132:135]
    v_mfma_f32_16x16x32_bf16 v[148:151], a[92:95], a[36:39], v[148:151]
    buffer_load_dwordx4 v18, s[48:51], s82 offen offset:1024 lds
    v_mfma_f32_16x16x32_bf16 v[164:167], a[92:95], a[40:43], v[164:167]
    v_mfma_f32_16x16x32_bf16 v[180:183], a[92:95], a[44:47], v[180:183]
    v_mfma_f32_16x16x32_bf16 v[196:199], a[92:95], a[48:51], v[196:199]
    v_mfma_f32_16x16x32_bf16 v[212:215], a[92:95], a[52:55], v[212:215]
    s_mov_b32 s83, 1605632
    s_add_u32 m0, s3, 57344
    v_mfma_f32_16x16x32_bf16 v[228:231], a[92:95], a[56:59], v[228:231]
    buffer_load_dwordx4 v17, s[48:51], s83 offen lds
    v_mfma_f32_16x16x32_bf16 v[244:247], a[92:95], a[60:63], v[244:247]
    v_mfma_f32_16x16x32_bf16 v[136:139], a[104:107], a[32:35], v[136:139]
    v_mfma_f32_16x16x32_bf16 v[152:155], a[104:107], a[36:39], v[152:155]
    v_mfma_f32_16x16x32_bf16 v[168:171], a[104:107], a[40:43], v[168:171]
    buffer_load_dwordx4 v18, s[48:51], s83 offen offset:1024 lds
    v_mfma_f32_16x16x32_bf16 v[184:187], a[104:107], a[44:47], v[184:187]
    v_mfma_f32_16x16x32_bf16 v[200:203], a[104:107], a[48:51], v[200:203]
    v_mfma_f32_16x16x32_bf16 v[216:219], a[104:107], a[52:55], v[216:219]
    v_mfma_f32_16x16x32_bf16 v[232:235], a[104:107], a[56:59], v[232:235]
    v_mfma_f32_16x16x32_bf16 v[248:251], a[104:107], a[60:63], v[248:251]
    v_mfma_f32_16x16x32_bf16 v[140:143], a[108:111], a[32:35], v[140:143]
    v_mfma_f32_16x16x32_bf16 v[156:159], a[108:111], a[36:39], v[156:159]
    v_mfma_f32_16x16x32_bf16 v[172:175], a[108:111], a[40:43], v[172:175]
    v_mfma_f32_16x16x32_bf16 v[188:191], a[108:111], a[44:47], v[188:191]
    v_mfma_f32_16x16x32_bf16 v[204:207], a[108:111], a[48:51], v[204:207]
    v_mfma_f32_16x16x32_bf16 v[220:223], a[108:111], a[52:55], v[220:223]
    v_mfma_f32_16x16x32_bf16 v[236:239], a[108:111], a[56:59], v[236:239]
    v_mfma_f32_16x16x32_bf16 v[252:255], a[108:111], a[60:63], v[252:255]
    s_branch L_epi
L_g1_1:
    s_mov_b32 m0, s14
    s_mov_b32 s77, 4096
    buffer_load_dwordx4 v1, s[28:31], s77 offen sc1 lds
    s_mov_b32 s77, 19456
    buffer_load_dwordx4 v1, s[28:31], s77 offen offset:1024 sc1 lds
    v_add_u32 v1, 128, v1
    s_mov_b32 m0, s15
    s_mov_b32 s77, 4096
    buffer_load_dwordx4 v1, s[28:31], s77 offen sc1 lds
    s_mov_b32 s77, 19456
    buffer_load_dwordx4 v1, s[28:31], s77 offen offset:1024 sc1 lds
    v_add_u32 v1, 128, v1
    s_waitcnt vmcnt(0)
    s_barrier
    ds_read_b64_tr_b16 a[64:65], v12 offset:0
    ds_read_b64_tr_b16 a[66:67], v12 offset:256
    ds_read_b64_tr_b16 a[68:69], v14 offset:0
    ds_read_b64_tr_b16 a[70:71], v14 offset:256
    ds_read_b64_tr_b16 a[72:73], v12 offset:1024
    ds_read_b64_tr_b16 a[74:75], v12 offset:1280
    ds_read_b64_tr_b16 a[76:77], v14 offset:1024
    ds_read_b64_tr_b16 a[78:79], v14 offset:1280
    ds_read_b64_tr_b16 a[80:81], v12 offset:2048
    ds_read_b64_tr_b16 a[82:83], v12 offset:2304
    ds_read_b64_tr_b16 a[84:85], v14 offset:2048
    ds_read_b64_tr_b16 a[86:87], v14 offset:2304
    ds_read_b64_tr_b16 a[88:89], v12 offset:3072
    ds_read_b64_tr_b16 a[90:91], v12 offset:3328
    ds_read_b64_tr_b16 a[92:93], v14 offset:3072
    ds_read_b64_tr_b16 a[94:95], v14 offset:3328
    ds_read_b64_tr_b16 a[96:97], v12 offset:4096
    ds_read_b64_tr_b16 a[98:99], v12 offset:4352
    ds_read_b64_tr_b16 a[100:101], v14 offset:4096
    ds_read_b64_tr_b16 a[102:103], v14 offset:4352
    ds_read_b128 a[0:3], v8 offset:0
    ds_read_b128 a[4:7], v8 offset:2048
    ds_read_b128 a[8:11], v8 offset:4096
    ds_read_b128 a[12:15], v8 offset:6144
    ds_read_b128 a[16:19], v8 offset:8192
    ds_read_b128 a[20:23], v8 offset:10240
    ds_read_b128 a[24:27], v8 offset:12288
    ds_read_b128 a[28:31], v8 offset:14336
    s_mov_b32 s67, 7
    v_mov_b32 v20, 0x7ff00000
.p2align 3
L_loop1:
    s_waitcnt vmcnt(23) lgkmcnt(0)
    s_barrier
    v_mfma_f32_16x16x32_bf16 v[128:131], a[64:67], a[0:3], v[128:131]
    s_add_u32 m0, s78, 0
    buffer_load_dword v7, v6, s[44:47], s4 offen
    v_add_u32_e64 v6, s79, v6
    v_mfma_f32_16x16x32_bf16 v[144:147], a[64:67], a[4:7], v[144:147]
    buffer_load_dwordx4 v2, s[32:35], s68 offen offset:0 lds
    v_mfma_f32_16x16x32_bf16 v[160:163], a[64:67], a[8:11], v[160:163]
    ds_read_b128 a[32:35], v9 offset:0
    v_mfma_f32_16x16x32_bf16 v[176:179], a[64:67], a[12:15], v[176:179]
    v_mfma_f32_16x16x32_bf16 v[192:195], a[64:67], a[16:19], v[192:195]
    v_mfma_f32_16x16x32_bf16 v[208:211], a[64:67], a[20:23], v[208:211]
    v_mfma_f32_16x16x32_bf16 v[224:227], a[64:67], a[24:27], v[224:227]
    ds_read_b128 a[36:39], v9 offset:2048
    v_mfma_f32_16x16x32_bf16 v[240:243], a[64:67], a[28:31], v[240:243]
    ds_read_b64_tr_b16 a[64:65], v12 offset:20480
    v_mfma_f32_16x16x32_bf16 v[132:135], a[68:71], a[0:3], v[132:135]
    ds_read_b64_tr_b16 a[66:67], v12 offset:20736
    v_mfma_f32_16x16x32_bf16 v[148:151], a[68:71], a[4:7], v[148:151]
    buffer_load_dwordx4 v2, s[32:35], s69 offen offset:1024 lds
    v_mfma_f32_16x16x32_bf16 v[164:167], a[68:71], a[8:11], v[164:167]
    ds_read_b128 a[40:43], v9 offset:4096
    v_mfma_f32_16x16x32_bf16 v[180:183], a[68:71], a[12:15], v[180:183]
    v_mfma_f32_16x16x32_bf16 v[196:199], a[68:71], a[16:19], v[196:199]
    v_mfma_f32_16x16x32_bf16 v[212:215], a[68:71], a[20:23], v[212:215]
    buffer_load_dwordx4 v2, s[32:35], s70 offen offset:2048 lds
    v_add_u32 v2, 196608, v2
    v_mfma_f32_16x16x32_bf16 v[228:231], a[68:71], a[24:27], v[228:231]
    ds_read_b128 a[44:47], v9 offset:6144
    v_mfma_f32_16x16x32_bf16 v[244:247], a[68:71], a[28:31], v[244:247]
    ds_read_b64_tr_b16 a[68:69], v14 offset:20480
    v_mfma_f32_16x16x32_bf16 v[136:139], a[72:75], a[0:3], v[136:139]
    ds_read_b64_tr_b16 a[70:71], v14 offset:20736
    v_mfma_f32_16x16x32_bf16 v[152:155], a[72:75], a[4:7], v[152:155]
    v_mfma_f32_16x16x32_bf16 v[168:171], a[72:75], a[8:11], v[168:171]
    ds_read_b128 a[48:51], v9 offset:8192
    v_mfma_f32_16x16x32_bf16 v[184:187], a[72:75], a[12:15], v[184:187]
    buffer_load_dwordx4 v3, s[36:39], s71 offen offset:3072 lds
    v_mfma_f32_16x16x32_bf16 v[200:203], a[72:75], a[16:19], v[200:203]
    v_mfma_f32_16x16x32_bf16 v[216:219], a[72:75], a[20:23], v[216:219]
    v_mfma_f32_16x16x32_bf16 v[232:235], a[72:75], a[24:27], v[232:235]
    ds_read_b128 a[52:55], v9 offset:10240
    v_mfma_f32_16x16x32_bf16 v[248:251], a[72:75], a[28:31], v[248:251]
    ds_read_b64_tr_b16 a[72:73], v12 offset:21504
    v_mfma_f32_16x16x32_bf16 v[140:143], a[76:79], a[0:3], v[140:143]
    ds_read_b64_tr_b16 a[74:75], v12 offset:21760
    s_add_u32 m0, s78, 4096
    v_mfma_f32_16x16x32_bf16 v[156:159], a[76:79], a[4:7], v[156:159]
    buffer_load_dwordx4 v3, s[40:43], s72 offen offset:0 lds
    v_mfma_f32_16x16x32_bf16 v[172:175], a[76:79], a[8:11], v[172:175]
    ds_read_b128 a[56:59], v9 offset:12288
    v_mfma_f32_16x16x32_bf16 v[188:191], a[76:79], a[12:15], v[188:191]
    v_mfma_f32_16x16x32_bf16 v[204:207], a[76:79], a[16:19], v[204:207]
    v_mfma_f32_16x16x32_bf16 v[220:223], a[76:79], a[20:23], v[220:223]
    v_mfma_f32_16x16x32_bf16 v[236:239], a[76:79], a[24:27], v[236:239]
    ds_read_b128 a[60:63], v9 offset:14336
    v_mfma_f32_16x16x32_bf16 v[252:255], a[76:79], a[28:31], v[252:255]
    ds_read_b64_tr_b16 a[76:77], v14 offset:21504
    v_mfma_f32_16x16x32_bf16 a[128:131], a[80:83], a[0:3], a[128:131]
    ds_read_b64_tr_b16 a[78:79], v14 offset:21760
    v_mfma_f32_16x16x32_bf16 a[144:147], a[80:83], a[4:7], a[144:147]
    buffer_load_dwordx4 v3, s[36:39], s73 offen offset:1024 lds
    v_mfma_f32_16x16x32_bf16 a[160:163], a[80:83], a[8:11], a[160:163]
    ds_read_b64_tr_b16 a[104:105], v12 offset:24576
    v_mfma_f32_16x16x32_bf16 a[176:179], a[80:83], a[12:15], a[176:179]
    v_mfma_f32_16x16x32_bf16 a[192:195], a[80:83], a[16:19], a[192:195]
    v_mfma_f32_16x16x32_bf16 a[208:211], a[80:83], a[20:23], a[208:211]
    v_mfma_f32_16x16x32_bf16 a[224:227], a[80:83], a[24:27], a[224:227]
    ds_read_b64_tr_b16 a[106:107], v12 offset:24832
    v_mfma_f32_16x16x32_bf16 a[240:243], a[80:83], a[28:31], a[240:243]
    ds_read_b64_tr_b16 a[80:81], v12 offset:22528
    v_mfma_f32_16x16x32_bf16 a[132:135], a[84:87], a[0:3], a[132:135]
    ds_read_b64_tr_b16 a[82:83], v12 offset:22784
    v_mfma_f32_16x16x32_bf16 a[148:151], a[84:87], a[4:7], a[148:151]
    buffer_load_dwordx4 v3, s[40:43], s74 offen offset:2048 lds
    v_mfma_f32_16x16x32_bf16 a[164:167], a[84:87], a[8:11], a[164:167]
    ds_read_b64_tr_b16 a[108:109], v14 offset:24576
    v_mfma_f32_16x16x32_bf16 a[180:183], a[84:87], a[12:15], a[180:183]
    v_mfma_f32_16x16x32_bf16 a[196:199], a[84:87], a[16:19], a[196:199]
    buffer_load_dwordx4 v3, s[36:39], s75 offen offset:3072 lds
    v_mfma_f32_16x16x32_bf16 a[212:215], a[84:87], a[20:23], a[212:215]
    v_mfma_f32_16x16x32_bf16 a[228:231], a[84:87], a[24:27], a[228:231]
    ds_read_b64_tr_b16 a[110:111], v14 offset:24832
    v_mfma_f32_16x16x32_bf16 a[244:247], a[84:87], a[28:31], a[244:247]
    ds_read_b64_tr_b16 a[84:85], v14 offset:22528
    v_mfma_f32_16x16x32_bf16 a[136:139], a[88:91], a[0:3], a[136:139]
    ds_read_b64_tr_b16 a[86:87], v14 offset:22784
    v_mfma_f32_16x16x32_bf16 a[152:155], a[88:91], a[4:7], a[152:155]
    s_add_u32 m0, s78, 8192
    v_mfma_f32_16x16x32_bf16 a[168:171], a[88:91], a[8:11], a[168:171]
    buffer_load_dwordx4 v3, s[40:43], s76 offen offset:0 lds
    v_add_u32 v3, 229376, v3
    v_mfma_f32_16x16x32_bf16 a[184:187], a[88:91], a[12:15], a[184:187]
    v_mfma_f32_16x16x32_bf16 a[200:203], a[88:91], a[16:19], a[200:203]
    v_mfma_f32_16x16x32_bf16 a[216:219], a[88:91], a[20:23], a[216:219]
    v_mfma_f32_16x16x32_bf16 a[232:235], a[88:91], a[24:27], a[232:235]
    v_mfma_f32_16x16x32_bf16 a[248:251], a[88:91], a[28:31], a[248:251]
    ds_read_b64_tr_b16 a[88:89], v12 offset:23552
    v_mfma_f32_16x16x32_bf16 a[140:143], a[92:95], a[0:3], a[140:143]
    ds_read_b64_tr_b16 a[90:91], v12 offset:23808
    v_mfma_f32_16x16x32_bf16 a[156:159], a[92:95], a[4:7], a[156:159]
    global_load_lds_dwordx4 v[4:5], off offset:1024
    v_lshl_add_u64 v[4:5], v[4:5], 0, s[80:81]
    v_mfma_f32_16x16x32_bf16 a[172:175], a[92:95], a[8:11], a[172:175]
    v_mfma_f32_16x16x32_bf16 a[188:191], a[92:95], a[12:15], a[188:191]
    v_mfma_f32_16x16x32_bf16 a[204:207], a[92:95], a[16:19], a[204:207]
    v_mfma_f32_16x16x32_bf16 a[220:223], a[92:95], a[20:23], a[220:223]
    v_mfma_f32_16x16x32_bf16 a[236:239], a[92:95], a[24:27], a[236:239]
    v_mfma_f32_16x16x32_bf16 a[252:255], a[92:95], a[28:31], a[252:255]
    ds_read_b64_tr_b16 a[92:93], v14 offset:23552
    v_mfma_f32_16x16x32_bf16 v[48:51], a[96:99], a[0:3], v[48:51]
    ds_read_b64_tr_b16 a[94:95], v14 offset:23808
    v_mfma_f32_16x16x32_bf16 v[52:55], a[96:99], a[4:7], v[52:55]
    v_mfma_f32_16x16x32_bf16 v[64:67], a[96:99], a[8:11], v[64:67]
    v_mfma_f32_16x16x32_bf16 v[68:71], a[96:99], a[12:15], v[68:71]
    v_mfma_f32_16x16x32_bf16 v[80:83], a[96:99], a[16:19], v[80:83]
    v_mfma_f32_16x16x32_bf16 v[84:87], a[96:99], a[20:23], v[84:87]
    v_mfma_f32_16x16x32_bf16 v[96:99], a[96:99], a[24:27], v[96:99]
    v_mfma_f32_16x16x32_bf16 v[100:103], a[96:99], a[28:31], v[100:103]
    v_mfma_f32_16x16x32_bf16 v[56:59], a[100:103], a[0:3], v[56:59]
    v_mfma_f32_16x16x32_bf16 v[60:63], a[100:103], a[4:7], v[60:63]
    v_mfma_f32_16x16x32_bf16 v[72:75], a[100:103], a[8:11], v[72:75]
    v_mfma_f32_16x16x32_bf16 v[76:79], a[100:103], a[12:15], v[76:79]
    v_mfma_f32_16x16x32_bf16 v[88:91], a[100:103], a[16:19], v[88:91]
    v_mfma_f32_16x16x32_bf16 v[92:95], a[100:103], a[20:23], v[92:95]
    v_mfma_f32_16x16x32_bf16 v[104:107], a[100:103], a[24:27], v[104:107]
    v_mfma_f32_16x16x32_bf16 v[108:111], a[100:103], a[28:31], v[108:111]
    s_waitcnt vmcnt(21) lgkmcnt(0)
    s_barrier
    v_mfma_f32_16x16x32_bf16 v[128:131], a[64:67], a[32:35], v[128:131]
    s_mov_b32 m0, s14
    s_mov_b32 s77, 4096
    v_mfma_f32_16x16x32_bf16 v[144:147], a[64:67], a[36:39], v[144:147]
    buffer_load_dwordx4 v1, s[28:31], s77 offen sc1 lds
    v_mfma_f32_16x16x32_bf16 v[160:163], a[64:67], a[40:43], v[160:163]
    ds_read_b128 a[0:3], v8 offset:34816
    v_mfma_f32_16x16x32_bf16 v[176:179], a[64:67], a[44:47], v[176:179]
    v_mfma_f32_16x16x32_bf16 v[192:195], a[64:67], a[48:51], v[192:195]
    v_mfma_f32_16x16x32_bf16 v[208:211], a[64:67], a[52:55], v[208:211]
    v_mfma_f32_16x16x32_bf16 v[224:227], a[64:67], a[56:59], v[224:227]
    ds_read_b128 a[4:7], v8 offset:36864
    v_mfma_f32_16x16x32_bf16 v[240:243], a[64:67], a[60:63], v[240:243]
    ds_read_b64_tr_b16 a[64:65], v13 offset:0
    v_mfma_f32_16x16x32_bf16 v[132:135], a[68:71], a[32:35], v[132:135]
    ds_read_b64_tr_b16 a[66:67], v13 offset:256
    s_mov_b32 s77, 19456
    v_mfma_f32_16x16x32_bf16 v[148:151], a[68:71], a[36:39], v[148:151]
    buffer_load_dwordx4 v1, s[28:31], s77 offen offset:1024 sc1 lds
    v_add_u32 v1, 128, v1
    v_mfma_f32_16x16x32_bf16 v[164:167], a[68:71], a[40:43], v[164:167]
    ds_read_b128 a[8:11], v8 offset:38912
    s_add_u32 m0, s78, 20480
    v_mfma_f32_16x16x32_bf16 v[180:183], a[68:71], a[44:47], v[180:183]
    buffer_load_dwordx4 v2, s[32:35], s68 offen offset:0 lds
    v_mfma_f32_16x16x32_bf16 v[196:199], a[68:71], a[48:51], v[196:199]
    v_mfma_f32_16x16x32_bf16 v[212:215], a[68:71], a[52:55], v[212:215]
    v_mfma_f32_16x16x32_bf16 v[228:231], a[68:71], a[56:59], v[228:231]
    ds_read_b128 a[12:15], v8 offset:40960
    v_mfma_f32_16x16x32_bf16 v[244:247], a[68:71], a[60:63], v[244:247]
    ds_read_b64_tr_b16 a[68:69], v15 offset:0
    v_mfma_f32_16x16x32_bf16 v[136:139], a[72:75], a[32:35], v[136:139]
    ds_read_b64_tr_b16 a[70:71], v15 offset:256
    v_mfma_f32_16x16x32_bf16 v[152:155], a[72:75], a[36:39], v[152:155]
    buffer_load_dwordx4 v2, s[32:35], s69 offen offset:1024 lds
    v_mfma_f32_16x16x32_bf16 v[168:171], a[72:75], a[40:43], v[168:171]
    ds_read_b128 a[16:19], v8 offset:43008
    v_mfma_f32_16x16x32_bf16 v[184:187], a[72:75], a[44:47], v[184:187]
    v_mfma_f32_16x16x32_bf16 v[200:203], a[72:75], a[48:51], v[200:203]
    v_mfma_f32_16x16x32_bf16 v[216:219], a[72:75], a[52:55], v[216:219]
    buffer_load_dwordx4 v2, s[32:35], s70 offen offset:2048 lds
    v_add_u32 v2, 196608, v2
    v_mfma_f32_16x16x32_bf16 v[232:235], a[72:75], a[56:59], v[232:235]
    ds_read_b128 a[20:23], v8 offset:45056
    v_mfma_f32_16x16x32_bf16 v[248:251], a[72:75], a[60:63], v[248:251]
    ds_read_b64_tr_b16 a[72:73], v13 offset:1024
    v_mfma_f32_16x16x32_bf16 v[140:143], a[76:79], a[32:35], v[140:143]
    ds_read_b64_tr_b16 a[74:75], v13 offset:1280
    v_mfma_f32_16x16x32_bf16 v[156:159], a[76:79], a[36:39], v[156:159]
    v_mfma_f32_16x16x32_bf16 v[172:175], a[76:79], a[40:43], v[172:175]
    ds_read_b128 a[24:27], v8 offset:47104
    v_mfma_f32_16x16x32_bf16 v[188:191], a[76:79], a[44:47], v[188:191]
    buffer_load_dwordx4 v3, s[36:39], s71 offen offset:3072 lds
    v_mfma_f32_16x16x32_bf16 v[204:207], a[76:79], a[48:51], v[204:207]
    v_mfma_f32_16x16x32_bf16 v[220:223], a[76:79], a[52:55], v[220:223]
    v_mfma_f32_16x16x32_bf16 v[236:239], a[76:79], a[56:59], v[236:239]
    ds_read_b128 a[28:31], v8 offset:49152
    v_mfma_f32_16x16x32_bf16 v[252:255], a[76:79], a[60:63], v[252:255]
    ds_read_b64_tr_b16 a[76:77], v15 offset:1024
    v_mfma_f32_16x16x32_bf16 a[128:131], a[80:83], a[32:35], a[128:131]
    ds_read_b64_tr_b16 a[78:79], v15 offset:1280
    s_add_u32 m0, s78, 24576
    v_mfma_f32_16x16x32_bf16 a[144:147], a[80:83], a[36:39], a[144:147]
    buffer_load_dwordx4 v3, s[40:43], s72 offen offset:0 lds
    v_mfma_f32_16x16x32_bf16 a[160:163], a[80:83], a[40:43], a[160:163]
    ds_read_b64_tr_b16 a[96:97], v13 offset:4096
    v_mfma_f32_16x16x32_bf16 a[176:179], a[80:83], a[44:47], a[176:179]
    v_mfma_f32_16x16x32_bf16 a[192:195], a[80:83], a[48:51], a[192:195]
    v_mfma_f32_16x16x32_bf16 a[208:211], a[80:83], a[52:55], a[208:211]
    buffer_load_dwordx4 v3, s[36:39], s73 offen offset:1024 lds
    v_mfma_f32_16x16x32_bf16 a[224:227], a[80:83], a[56:59], a[224:227]
    ds_read_b64_tr_b16 a[98:99], v13 offset:4352
    v_mfma_f32_16x16x32_bf16 a[240:243], a[80:83], a[60:63], a[240:243]
    ds_read_b64_tr_b16 a[80:81], v13 offset:2048
    v_mfma_f32_16x16x32_bf16 a[132:135], a[84:87], a[32:35], a[132:135]
    ds_read_b64_tr_b16 a[82:83], v13 offset:2304
    v_mfma_f32_16x16x32_bf16 a[148:151], a[84:87], a[36:39], a[148:151]
    v_mfma_f32_16x16x32_bf16 a[164:167], a[84:87], a[40:43], a[164:167]
    ds_read_b64_tr_b16 a[100:101], v15 offset:4096
    v_mfma_f32_16x16x32_bf16 a[180:183], a[84:87], a[44:47], a[180:183]
    buffer_load_dwordx4 v3, s[40:43], s74 offen offset:2048 lds
    v_mfma_f32_16x16x32_bf16 a[196:199], a[84:87], a[48:51], a[196:199]
    v_mfma_f32_16x16x32_bf16 a[212:215], a[84:87], a[52:55], a[212:215]
    v_mfma_f32_16x16x32_bf16 a[228:231], a[84:87], a[56:59], a[228:231]
    ds_read_b64_tr_b16 a[102:103], v15 offset:4352
    v_mfma_f32_16x16x32_bf16 a[244:247], a[84:87], a[60:63], a[244:247]
    ds_read_b64_tr_b16 a[84:85], v15 offset:2048
    v_mfma_f32_16x16x32_bf16 a[136:139], a[88:91], a[32:35], a[136:139]
    ds_read_b64_tr_b16 a[86:87], v15 offset:2304
    v_mfma_f32_16x16x32_bf16 a[152:155], a[88:91], a[36:39], a[152:155]
    buffer_load_dwordx4 v3, s[36:39], s75 offen offset:3072 lds
    v_mfma_f32_16x16x32_bf16 a[168:171], a[88:91], a[40:43], a[168:171]
    v_mfma_f32_16x16x32_bf16 a[184:187], a[88:91], a[44:47], a[184:187]
    s_add_u32 m0, s78, 28672
    v_mfma_f32_16x16x32_bf16 a[200:203], a[88:91], a[48:51], a[200:203]
    buffer_load_dwordx4 v3, s[40:43], s76 offen offset:0 lds
    v_add_u32 v3, 229376, v3
    v_mfma_f32_16x16x32_bf16 a[216:219], a[88:91], a[52:55], a[216:219]
    v_mfma_f32_16x16x32_bf16 a[232:235], a[88:91], a[56:59], a[232:235]
    v_mfma_f32_16x16x32_bf16 a[248:251], a[88:91], a[60:63], a[248:251]
    ds_read_b64_tr_b16 a[88:89], v13 offset:3072
    v_mfma_f32_16x16x32_bf16 a[140:143], a[92:95], a[32:35], a[140:143]
    ds_read_b64_tr_b16 a[90:91], v13 offset:3328
    v_mfma_f32_16x16x32_bf16 a[156:159], a[92:95], a[36:39], a[156:159]
    global_load_lds_dwordx4 v[4:5], off offset:1024
    v_lshl_add_u64 v[4:5], v[4:5], 0, s[80:81]
    v_mfma_f32_16x16x32_bf16 a[172:175], a[92:95], a[40:43], a[172:175]
    v_mfma_f32_16x16x32_bf16 a[188:191], a[92:95], a[44:47], a[188:191]
    v_mfma_f32_16x16x32_bf16 a[204:207], a[92:95], a[48:51], a[204:207]
    v_mfma_f32_16x16x32_bf16 a[220:223], a[92:95], a[52:55], a[220:223]
    v_mfma_f32_16x16x32_bf16 a[236:239], a[92:95], a[56:59], a[236:239]
    v_mfma_f32_16x16x32_bf16 a[252:255], a[92:95], a[60:63], a[252:255]
    ds_read_b64_tr_b16 a[92:93], v15 offset:3072
    v_mfma_f32_16x16x32_bf16 v[48:51], a[104:107], a[32:35], v[48:51]
    ds_read_b64_tr_b16 a[94:95], v15 offset:3328
    v_mfma_f32_16x16x32_bf16 v[52:55], a[104:107], a[36:39], v[52:55]
    v_mfma_f32_16x16x32_bf16 v[64:67], a[104:107], a[40:43], v[64:67]
    v_mfma_f32_16x16x32_bf16 v[68:71], a[104:107], a[44:47], v[68:71]
    v_mfma_f32_16x16x32_bf16 v[80:83], a[104:107], a[48:51], v[80:83]
    v_mfma_f32_16x16x32_bf16 v[84:87], a[104:107], a[52:55], v[84:87]
    v_mfma_f32_16x16x32_bf16 v[96:99], a[104:107], a[56:59], v[96:99]
    v_mfma_f32_16x16x32_bf16 v[100:103], a[104:107], a[60:63], v[100:103]
    v_mfma_f32_16x16x32_bf16 v[56:59], a[108:111], a[32:35], v[56:59]
    v_mfma_f32_16x16x32_bf16 v[60:63], a[108:111], a[36:39], v[60:63]
    v_mfma_f32_16x16x32_bf16 v[72:75], a[108:111], a[40:43], v[72:75]
    v_mfma_f32_16x16x32_bf16 v[76:79], a[108:111], a[44:47], v[76:79]
    v_mfma_f32_16x16x32_bf16 v[88:91], a[108:111], a[48:51], v[88:91]
    v_mfma_f32_16x16x32_bf16 v[92:95], a[108:111], a[52:55], v[92:95]
    v_mfma_f32_16x16x32_bf16 v[104:107], a[108:111], a[56:59], v[104:107]
    v_mfma_f32_16x16x32_bf16 v[108:111], a[108:111], a[60:63], v[108:111]
    s_waitcnt vmcnt(23) lgkmcnt(0)
    s_barrier
    v_mfma_f32_16x16x32_bf16 v[128:131], a[64:67], a[0:3], v[128:131]
    s_add_u32 m0, s78, 40960
    buffer_load_dword v7, v6, s[44:47], s4 offen
    v_add_u32_e64 v6, s79, v6
    v_mfma_f32_16x16x32_bf16 v[144:147], a[64:67], a[4:7], v[144:147]
    buffer_load_dwordx4 v2, s[32:35], s68 offen offset:0 lds
    v_mfma_f32_16x16x32_bf16 v[160:163], a[64:67], a[8:11], v[160:163]
    ds_read_b128 a[32:35], v9 offset:34816
    v_mfma_f32_16x16x32_bf16 v[176:179], a[64:67], a[12:15], v[176:179]
    v_mfma_f32_16x16x32_bf16 v[192:195], a[64:67], a[16:19], v[192:195]
    v_mfma_f32_16x16x32_bf16 v[208:211], a[64:67], a[20:23], v[208:211]
    v_mfma_f32_16x16x32_bf16 v[224:227], a[64:67], a[24:27], v[224:227]
    ds_read_b128 a[36:39], v9 offset:36864
    v_mfma_f32_16x16x32_bf16 v[240:243], a[64:67], a[28:31], v[240:243]
    ds_read_b64_tr_b16 a[64:65], v13 offset:20480
    v_mfma_f32_16x16x32_bf16 v[132:135], a[68:71], a[0:3], v[132:135]
    ds_read_b64_tr_b16 a[66:67], v13 offset:20736
    v_mfma_f32_16x16x32_bf16 v[148:151], a[68:71], a[4:7], v[148:151]
    buffer_load_dwordx4 v2, s[32:35], s69 offen offset:1024 lds
    v_mfma_f32_16x16x32_bf16 v[164:167], a[68:71], a[8:11], v[164:167]
    ds_read_b128 a[40:43], v9 offset:38912
    v_mfma_f32_16x16x32_bf16 v[180:183], a[68:71], a[12:15], v[180:183]
    v_mfma_f32_16x16x32_bf16 v[196:199], a[68:71], a[16:19], v[196:199]
    v_mfma_f32_16x16x32_bf16 v[212:215], a[68:71], a[20:23], v[212:215]
    buffer_load_dwordx4 v2, s[32:35], s70 offen offset:2048 lds
    v_add_u32 v2, 196608, v2
    v_mfma_f32_16x16x32_bf16 v[228:231], a[68:71], a[24:27], v[228:231]
    ds_read_b128 a[44:47], v9 offset:40960
    v_mfma_f32_16x16x32_bf16 v[244:247], a[68:71], a[28:31], v[244:247]
    ds_read_b64_tr_b16 a[68:69], v15 offset:20480
    v_mfma_f32_16x16x32_bf16 v[136:139], a[72:75], a[0:3], v[136:139]
    ds_read_b64_tr_b16 a[70:71], v15 offset:20736
    v_mfma_f32_16x16x32_bf16 v[152:155], a[72:75], a[4:7], v[152:155]
    v_mfma_f32_16x16x32_bf16 v[168:171], a[72:75], a[8:11], v[168:171]
    ds_read_b128 a[48:51], v9 offset:43008
    v_mfma_f32_16x16x32_bf16 v[184:187], a[72:75], a[12:15], v[184:187]
    buffer_load_dwordx4 v3, s[36:39], s71 offen offset:3072 lds
    v_mfma_f32_16x16x32_bf16 v[200:203], a[72:75], a[16:19], v[200:203]
    v_mfma_f32_16x16x32_bf16 v[216:219], a[72:75], a[20:23], v[216:219]
    v_mfma_f32_16x16x32_bf16 v[232:235], a[72:75], a[24:27], v[232:235]
    ds_read_b128 a[52:55], v9 offset:45056
    v_mfma_f32_16x16x32_bf16 v[248:251], a[72:75], a[28:31], v[248:251]
    ds_read_b64_tr_b16 a[72:73], v13 offset:21504
    v_mfma_f32_16x16x32_bf16 v[140:143], a[76:79], a[0:3], v[140:143]
    ds_read_b64_tr_b16 a[74:75], v13 offset:21760
    s_add_u32 m0, s78, 45056
    v_mfma_f32_16x16x32_bf16 v[156:159], a[76:79], a[4:7], v[156:159]
    buffer_load_dwordx4 v3, s[40:43], s72 offen offset:0 lds
    v_mfma_f32_16x16x32_bf16 v[172:175], a[76:79], a[8:11], v[172:175]
    ds_read_b128 a[56:59], v9 offset:47104
    v_mfma_f32_16x16x32_bf16 v[188:191], a[76:79], a[12:15], v[188:191]
    v_mfma_f32_16x16x32_bf16 v[204:207], a[76:79], a[16:19], v[204:207]
    v_mfma_f32_16x16x32_bf16 v[220:223], a[76:79], a[20:23], v[220:223]
    v_mfma_f32_16x16x32_bf16 v[236:239], a[76:79], a[24:27], v[236:239]
    ds_read_b128 a[60:63], v9 offset:49152
    v_mfma_f32_16x16x32_bf16 v[252:255], a[76:79], a[28:31], v[252:255]
    ds_read_b64_tr_b16 a[76:77], v15 offset:21504
    v_mfma_f32_16x16x32_bf16 a[128:131], a[80:83], a[0:3], a[128:131]
    ds_read_b64_tr_b16 a[78:79], v15 offset:21760
    v_mfma_f32_16x16x32_bf16 a[144:147], a[80:83], a[4:7], a[144:147]
    buffer_load_dwordx4 v3, s[36:39], s73 offen offset:1024 lds
    v_mfma_f32_16x16x32_bf16 a[160:163], a[80:83], a[8:11], a[160:163]
    ds_read_b64_tr_b16 a[104:105], v13 offset:24576
    v_mfma_f32_16x16x32_bf16 a[176:179], a[80:83], a[12:15], a[176:179]
    v_mfma_f32_16x16x32_bf16 a[192:195], a[80:83], a[16:19], a[192:195]
    v_mfma_f32_16x16x32_bf16 a[208:211], a[80:83], a[20:23], a[208:211]
    v_mfma_f32_16x16x32_bf16 a[224:227], a[80:83], a[24:27], a[224:227]
    ds_read_b64_tr_b16 a[106:107], v13 offset:24832
    v_mfma_f32_16x16x32_bf16 a[240:243], a[80:83], a[28:31], a[240:243]
    ds_read_b64_tr_b16 a[80:81], v13 offset:22528
    v_mfma_f32_16x16x32_bf16 a[132:135], a[84:87], a[0:3], a[132:135]
    ds_read_b64_tr_b16 a[82:83], v13 offset:22784
    v_mfma_f32_16x16x32_bf16 a[148:151], a[84:87], a[4:7], a[148:151]
    buffer_load_dwordx4 v3, s[40:43], s74 offen offset:2048 lds
    v_mfma_f32_16x16x32_bf16 a[164:167], a[84:87], a[8:11], a[164:167]
    ds_read_b64_tr_b16 a[108:109], v15 offset:24576
    v_mfma_f32_16x16x32_bf16 a[180:183], a[84:87], a[12:15], a[180:183]
    v_mfma_f32_16x16x32_bf16 a[196:199], a[84:87], a[16:19], a[196:199]
    buffer_load_dwordx4 v3, s[36:39], s75 offen offset:3072 lds
    v_mfma_f32_16x16x32_bf16 a[212:215], a[84:87], a[20:23], a[212:215]
    v_mfma_f32_16x16x32_bf16 a[228:231], a[84:87], a[24:27], a[228:231]
    ds_read_b64_tr_b16 a[110:111], v15 offset:24832
    v_mfma_f32_16x16x32_bf16 a[244:247], a[84:87], a[28:31], a[244:247]
    ds_read_b64_tr_b16 a[84:85], v15 offset:22528
    v_mfma_f32_16x16x32_bf16 a[136:139], a[88:91], a[0:3], a[136:139]
    ds_read_b64_tr_b16 a[86:87], v15 offset:22784
    v_mfma_f32_16x16x32_bf16 a[152:155], a[88:91], a[4:7], a[152:155]
    s_add_u32 m0, s78, 49152
    v_mfma_f32_16x16x32_bf16 a[168:171], a[88:91], a[8:11], a[168:171]
    buffer_load_dwordx4 v3, s[40:43], s76 offen offset:0 lds
    v_add_u32 v3, 229376, v3
    v_mfma_f32_16x16x32_bf16 a[184:187], a[88:91], a[12:15], a[184:187]
    v_mfma_f32_16x16x32_bf16 a[200:203], a[88:91], a[16:19], a[200:203]
    v_mfma_f32_16x16x32_bf16 a[216:219], a[88:91], a[20:23], a[216:219]
    v_mfma_f32_16x16x32_bf16 a[232:235], a[88:91], a[24:27], a[232:235]
    v_mfma_f32_16x16x32_bf16 a[248:251], a[88:91], a[28:31], a[248:251]
    ds_read_b64_tr_b16 a[88:89], v13 offset:23552
    v_mfma_f32_16x16x32_bf16 a[140:143], a[92:95], a[0:3], a[140:143]
    ds_read_b64_tr_b16 a[90:91], v13 offset:23808
    v_mfma_f32_16x16x32_bf16 a[156:159], a[92:95], a[4:7], a[156:159]
    global_load_lds_dwordx4 v[4:5], off offset:1024
    v_lshl_add_u64 v[4:5], v[4:5], 0, s[80:81]
    v_mfma_f32_16x16x32_bf16 a[172:175], a[92:95], a[8:11], a[172:175]
    v_mfma_f32_16x16x32_bf16 a[188:191], a[92:95], a[12:15], a[188:191]
    v_mfma_f32_16x16x32_bf16 a[204:207], a[92:95], a[16:19], a[204:207]
    v_mfma_f32_16x16x32_bf16 a[220:223], a[92:95], a[20:23], a[220:223]
    v_mfma_f32_16x16x32_bf16 a[236:239], a[92:95], a[24:27], a[236:239]
    v_mfma_f32_16x16x32_bf16 a[252:255], a[92:95], a[28:31], a[252:255]
    ds_read_b64_tr_b16 a[92:93], v15 offset:23552
    v_mfma_f32_16x16x32_bf16 v[48:51], a[96:99], a[0:3], v[48:51]
    ds_read_b64_tr_b16 a[94:95], v15 offset:23808
    v_mfma_f32_16x16x32_bf16 v[52:55], a[96:99], a[4:7], v[52:55]
    v_mfma_f32_16x16x32_bf16 v[64:67], a[96:99], a[8:11], v[64:67]
    v_mfma_f32_16x16x32_bf16 v[68:71], a[96:99], a[12:15], v[68:71]
    v_mfma_f32_16x16x32_bf16 v[80:83], a[96:99], a[16:19], v[80:83]
    v_mfma_f32_16x16x32_bf16 v[84:87], a[96:99], a[20:23], v[84:87]
    v_mfma_f32_16x16x32_bf16 v[96:99], a[96:99], a[24:27], v[96:99]
    v_mfma_f32_16x16x32_bf16 v[100:103], a[96:99], a[28:31], v[100:103]
    v_mfma_f32_16x16x32_bf16 v[56:59], a[100:103], a[0:3], v[56:59]
    v_mfma_f32_16x16x32_bf16 v[60:63], a[100:103], a[4:7], v[60:63]
    v_mfma_f32_16x16x32_bf16 v[72:75], a[100:103], a[8:11], v[72:75]
    v_mfma_f32_16x16x32_bf16 v[76:79], a[100:103], a[12:15], v[76:79]
    v_mfma_f32_16x16x32_bf16 v[88:91], a[100:103], a[16:19], v[88:91]
    v_mfma_f32_16x16x32_bf16 v[92:95], a[100:103], a[20:23], v[92:95]
    v_mfma_f32_16x16x32_bf16 v[104:107], a[100:103], a[24:27], v[104:107]
    v_mfma_f32_16x16x32_bf16 v[108:111], a[100:103], a[28:31], v[108:111]
    s_waitcnt vmcnt(21) lgkmcnt(0)
    s_barrier
    v_mfma_f32_16x16x32_bf16 v[128:131], a[64:67], a[32:35], v[128:131]
    s_mov_b32 m0, s15
    s_mov_b32 s77, 4096
    v_mfma_f32_16x16x32_bf16 v[144:147], a[64:67], a[36:39], v[144:147]
    buffer_load_dwordx4 v1, s[28:31], s77 offen sc1 lds
    v_mfma_f32_16x16x32_bf16 v[160:163], a[64:67], a[40:43], v[160:163]
    ds_read_b128 a[0:3], v8 offset:0
    v_mfma_f32_16x16x32_bf16 v[176:179], a[64:67], a[44:47], v[176:179]
    v_mfma_f32_16x16x32_bf16 v[192:195], a[64:67], a[48:51], v[192:195]
    v_mfma_f32_16x16x32_bf16 v[208:211], a[64:67], a[52:55], v[208:211]
    v_mfma_f32_16x16x32_bf16 v[224:227], a[64:67], a[56:59], v[224:227]
    ds_read_b128 a[4:7], v8 offset:2048
    v_mfma_f32_16x16x32_bf16 v[240:243], a[64:67], a[60:63], v[240:243]
    ds_read_b64_tr_b16 a[64:65], v12 offset:0
    v_mfma_f32_16x16x32_bf16 v[132:135], a[68:71], a[32:35], v[132:135]
    ds_read_b64_tr_b16 a[66:67], v12 offset:256
    s_mov_b32 s77, 19456
    v_mfma_f32_16x16x32_bf16 v[148:151], a[68:71], a[36:39], v[148:151]
    buffer_load_dwordx4 v1, s[28:31], s77 offen offset:1024 sc1 lds
    v_add_u32 v1, 128, v1
    v_mfma_f32_16x16x32_bf16 v[164:167], a[68:71], a[40:43], v[164:167]
    ds_read_b128 a[8:11], v8 offset:4096
    s_add_u32 m0, s78, 61440
    v_mfma_f32_16x16x32_bf16 v[180:183], a[68:71], a[44:47], v[180:183]
    buffer_load_dwordx4 v2, s[32:35], s68 offen offset:0 lds
    v_mfma_f32_16x16x32_bf16 v[196:199], a[68:71], a[48:51], v[196:199]
    v_mfma_f32_16x16x32_bf16 v[212:215], a[68:71], a[52:55], v[212:215]
    v_mfma_f32_16x16x32_bf16 v[228:231], a[68:71], a[56:59], v[228:231]
    ds_read_b128 a[12:15], v8 offset:6144
    v_mfma_f32_16x16x32_bf16 v[244:247], a[68:71], a[60:63], v[244:247]
    ds_read_b64_tr_b16 a[68:69], v14 offset:0
    v_mfma_f32_16x16x32_bf16 v[136:139], a[72:75], a[32:35], v[136:139]
    ds_read_b64_tr_b16 a[70:71], v14 offset:256
    v_mfma_f32_16x16x32_bf16 v[152:155], a[72:75], a[36:39], v[152:155]
    buffer_load_dwordx4 v2, s[32:35], s69 offen offset:1024 lds
    v_mfma_f32_16x16x32_bf16 v[168:171], a[72:75], a[40:43], v[168:171]
    ds_read_b128 a[16:19], v8 offset:8192
    v_mfma_f32_16x16x32_bf16 v[184:187], a[72:75], a[44:47], v[184:187]
    v_mfma_f32_16x16x32_bf16 v[200:203], a[72:75], a[48:51], v[200:203]
    v_mfma_f32_16x16x32_bf16 v[216:219], a[72:75], a[52:55], v[216:219]
    buffer_load_dwordx4 v2, s[32:35], s70 offen offset:2048 lds
    v_add_u32 v2, 196608, v2
    v_mfma_f32_16x16x32_bf16 v[232:235], a[72:75], a[56:59], v[232:235]
    ds_read_b128 a[20:23], v8 offset:10240
    v_mfma_f32_16x16x32_bf16 v[248:251], a[72:75], a[60:63], v[248:251]
    ds_read_b64_tr_b16 a[72:73], v12 offset:1024
    v_mfma_f32_16x16x32_bf16 v[140:143], a[76:79], a[32:35], v[140:143]
    ds_read_b64_tr_b16 a[74:75], v12 offset:1280
    v_mfma_f32_16x16x32_bf16 v[156:159], a[76:79], a[36:39], v[156:159]
    v_mfma_f32_16x16x32_bf16 v[172:175], a[76:79], a[40:43], v[172:175]
    ds_read_b128 a[24:27], v8 offset:12288
    v_mfma_f32_16x16x32_bf16 v[188:191], a[76:79], a[44:47], v[188:191]
    buffer_load_dwordx4 v3, s[36:39], s71 offen offset:3072 lds
    v_mfma_f32_16x16x32_bf16 v[204:207], a[76:79], a[48:51], v[204:207]
    v_mfma_f32_16x16x32_bf16 v[220:223], a[76:79], a[52:55], v[220:223]
    v_mfma_f32_16x16x32_bf16 v[236:239], a[76:79], a[56:59], v[236:239]
    ds_read_b128 a[28:31], v8 offset:14336
    v_mfma_f32_16x16x32_bf16 v[252:255], a[76:79], a[60:63], v[252:255]
    ds_read_b64_tr_b16 a[76:77], v14 offset:1024
    v_mfma_f32_16x16x32_bf16 a[128:131], a[80:83], a[32:35], a[128:131]
    ds_read_b64_tr_b16 a[78:79], v14 offset:1280
    s_add_u32 m0, s78, 65536
    v_mfma_f32_16x16x32_bf16 a[144:147], a[80:83], a[36:39], a[144:147]
    buffer_load_dwordx4 v3, s[40:43], s72 offen offset:0 lds
    v_mfma_f32_16x16x32_bf16 a[160:163], a[80:83], a[40:43], a[160:163]
    ds_read_b64_tr_b16 a[96:97], v12 offset:4096
    v_mfma_f32_16x16x32_bf16 a[176:179], a[80:83], a[44:47], a[176:179]
    v_mfma_f32_16x16x32_bf16 a[192:195], a[80:83], a[48:51], a[192:195]
    v_mfma_f32_16x16x32_bf16 a[208:211], a[80:83], a[52:55], a[208:211]
    buffer_load_dwordx4 v3, s[36:39], s73 offen offset:1024 lds
    v_mfma_f32_16x16x32_bf16 a[224:227], a[80:83], a[56:59], a[224:227]
    ds_read_b64_tr_b16 a[98:99], v12 offset:4352
    v_mfma_f32_16x16x32_bf16 a[240:243], a[80:83], a[60:63], a[240:243]
    ds_read_b64_tr_b16 a[80:81], v12 offset:2048
    v_mfma_f32_16x16x32_bf16 a[132:135], a[84:87], a[32:35], a[132:135]
    ds_read_b64_tr_b16 a[82:83], v12 offset:2304
    v_mfma_f32_16x16x32_bf16 a[148:151], a[84:87], a[36:39], a[148:151]
    v_mfma_f32_16x16x32_bf16 a[164:167], a[84:87], a[40:43], a[164:167]
    ds_read_b64_tr_b16 a[100:101], v14 offset:4096
    v_mfma_f32_16x16x32_bf16 a[180:183], a[84:87], a[44:47], a[180:183]
    buffer_load_dwordx4 v3, s[40:43], s74 offen offset:2048 lds
    v_mfma_f32_16x16x32_bf16 a[196:199], a[84:87], a[48:51], a[196:199]
    v_mfma_f32_16x16x32_bf16 a[212:215], a[84:87], a[52:55], a[212:215]
    v_mfma_f32_16x16x32_bf16 a[228:231], a[84:87], a[56:59], a[228:231]
    ds_read_b64_tr_b16 a[102:103], v14 offset:4352
    v_mfma_f32_16x16x32_bf16 a[244:247], a[84:87], a[60:63], a[244:247]
    ds_read_b64_tr_b16 a[84:85], v14 offset:2048
    v_mfma_f32_16x16x32_bf16 a[136:139], a[88:91], a[32:35], a[136:139]
    ds_read_b64_tr_b16 a[86:87], v14 offset:2304
    v_mfma_f32_16x16x32_bf16 a[152:155], a[88:91], a[36:39], a[152:155]
    buffer_load_dwordx4 v3, s[36:39], s75 offen offset:3072 lds
    v_mfma_f32_16x16x32_bf16 a[168:171], a[88:91], a[40:43], a[168:171]
    v_mfma_f32_16x16x32_bf16 a[184:187], a[88:91], a[44:47], a[184:187]
    s_add_u32 m0, s78, 69632
    v_mfma_f32_16x16x32_bf16 a[200:203], a[88:91], a[48:51], a[200:203]
    buffer_load_dwordx4 v3, s[40:43], s76 offen offset:0 lds
    v_add_u32 v3, 229376, v3
    v_mfma_f32_16x16x32_bf16 a[216:219], a[88:91], a[52:55], a[216:219]
    v_mfma_f32_16x16x32_bf16 a[232:235], a[88:91], a[56:59], a[232:235]
    v_mfma_f32_16x16x32_bf16 a[248:251], a[88:91], a[60:63], a[248:251]
    ds_read_b64_tr_b16 a[88:89], v12 offset:3072
    v_mfma_f32_16x16x32_bf16 a[140:143], a[92:95], a[32:35], a[140:143]
    ds_read_b64_tr_b16 a[90:91], v12 offset:3328
    v_mfma_f32_16x16x32_bf16 a[156:159], a[92:95], a[36:39], a[156:159]
    global_load_lds_dwordx4 v[4:5], off offset:1024
    v_lshl_add_u64 v[4:5], v[4:5], 0, s[80:81]
    v_mfma_f32_16x16x32_bf16 a[172:175], a[92:95], a[40:43], a[172:175]
    v_mfma_f32_16x16x32_bf16 a[188:191], a[92:95], a[44:47], a[188:191]
    v_mfma_f32_16x16x32_bf16 a[204:207], a[92:95], a[48:51], a[204:207]
    v_mfma_f32_16x16x32_bf16 a[220:223], a[92:95], a[52:55], a[220:223]
    v_mfma_f32_16x16x32_bf16 a[236:239], a[92:95], a[56:59], a[236:239]
    v_mfma_f32_16x16x32_bf16 a[252:255], a[92:95], a[60:63], a[252:255]
    ds_read_b64_tr_b16 a[92:93], v14 offset:3072
    v_mfma_f32_16x16x32_bf16 v[48:51], a[104:107], a[32:35], v[48:51]
    ds_read_b64_tr_b16 a[94:95], v14 offset:3328
    v_mfma_f32_16x16x32_bf16 v[52:55], a[104:107], a[36:39], v[52:55]
    v_mfma_f32_16x16x32_bf16 v[64:67], a[104:107], a[40:43], v[64:67]
    v_mfma_f32_16x16x32_bf16 v[68:71], a[104:107], a[44:47], v[68:71]
    v_mfma_f32_16x16x32_bf16 v[80:83], a[104:107], a[48:51], v[80:83]
    v_mfma_f32_16x16x32_bf16 v[84:87], a[104:107], a[52:55], v[84:87]
    v_mfma_f32_16x16x32_bf16 v[96:99], a[104:107], a[56:59], v[96:99]
    v_mfma_f32_16x16x32_bf16 v[100:103], a[104:107], a[60:63], v[100:103]
    v_mfma_f32_16x16x32_bf16 v[56:59], a[108:111], a[32:35], v[56:59]
    v_mfma_f32_16x16x32_bf16 v[60:63], a[108:111], a[36:39], v[60:63]
    v_mfma_f32_16x16x32_bf16 v[72:75], a[108:111], a[40:43], v[72:75]
    v_mfma_f32_16x16x32_bf16 v[76:79], a[108:111], a[44:47], v[76:79]
    v_mfma_f32_16x16x32_bf16 v[88:91], a[108:111], a[48:51], v[88:91]
    v_mfma_f32_16x16x32_bf16 v[92:95], a[108:111], a[52:55], v[92:95]
    v_mfma_f32_16x16x32_bf16 v[104:107], a[108:111], a[56:59], v[104:107]
    v_mfma_f32_16x16x32_bf16 v[108:111], a[108:111], a[60:63], v[108:111]
    s_sub_u32 s67, s67, 1
    s_cmp_lg_u32 s67, 0
    s_cbranch_scc1 L_loop1
L_tail1:
    s_waitcnt vmcnt(23) lgkmcnt(0)
    s_barrier
    v_mfma_f32_16x16x32_bf16 v[128:131], a[64:67], a[0:3], v[128:131]
    s_getpc_b64 s[86:87]
L_pc1:
    s_sub_u32 s86, s86, L_pc1-L_tail0
    s_subb_u32 s87, s87, 0
    s_lshr_b32 s82, s2, 3
    s_lshl_b32 s82, s82, 2
    s_add_u32 s82, s82, s60
    s_lshl_b32 s82, s82, 10
    v_add_u32 v34, s82, v16
    v_min_u32 v34, L_code_end-L_tail0-4, v34
    global_load_dword v7, v34, s[86:87]
    v_mfma_f32_16x16x32_bf16 v[144:147], a[64:67], a[4:7], v[144:147]
    v_mfma_f32_16x16x32_bf16 v[160:163], a[64:67], a[8:11], v[160:163]
    ds_read_b128 a[32:35], v9 offset:0
    s_and_b32 s82, s2, 7
    s_lshl_b32 s82, s82, 5
    s_lshr_b32 s83, s2, 3
    s_add_u32 s82, s82, s83
    s_lshl_b32 s82, s82, 2
    s_add_u32 s82, s82, s60
    s_mul_i32 s82, s82, 7168
    v_min_u32 v34, 55, v0
    v_lshlrev_b32 v34, 7, v34
    v_add_u32 v34, s82, v34
    global_load_dword v7, v34, s[20:21]
    v_mfma_f32_16x16x32_bf16 v[176:179], a[64:67], a[12:15], v[176:179]
    v_mfma_f32_16x16x32_bf16 v[192:195], a[64:67], a[16:19], v[192:195]
    v_mfma_f32_16x16x32_bf16 v[208:211], a[64:67], a[20:23], v[208:211]
    v_mfma_f32_16x16x32_bf16 v[224:227], a[64:67], a[24:27], v[224:227]
    ds_read_b128 a[36:39], v9 offset:2048
    v_mfma_f32_16x16x32_bf16 v[240:243], a[64:67], a[28:31], v[240:243]
    ds_read_b64_tr_b16 a[64:65], v12 offset:20480
    v_mfma_f32_16x16x32_bf16 v[132:135], a[68:71], a[0:3], v[132:135]
    ds_read_b64_tr_b16 a[66:67], v12 offset:20736
    v_mfma_f32_16x16x32_bf16 v[148:151], a[68:71], a[4:7], v[148:151]
    v_mfma_f32_16x16x32_bf16 v[164:167], a[68:71], a[8:11], v[164:167]
    ds_read_b128 a[40:43], v9 offset:4096
    v_mfma_f32_16x16x32_bf16 v[180:183], a[68:71], a[12:15], v[180:183]
    v_mfma_f32_16x16x32_bf16 v[196:199], a[68:71], a[16:19], v[196:199]
    v_mfma_f32_16x16x32_bf16 v[212:215], a[68:71], a[20:23], v[212:215]
    v_mfma_f32_16x16x32_bf16 v[228:231], a[68:71], a[24:27], v[228:231]
    ds_read_b128 a[44:47], v9 offset:6144
    v_mfma_f32_16x16x32_bf16 v[244:247], a[68:71], a[28:31], v[244:247]
    ds_read_b64_tr_b16 a[68:69], v14 offset:20480
    v_mfma_f32_16x16x32_bf16 v[136:139], a[72:75], a[0:3], v[136:139]
    ds_read_b64_tr_b16 a[70:71], v14 offset:20736
    v_mfma_f32_16x16x32_bf16 v[152:155], a[72:75], a[4:7], v[152:155]
    v_mfma_f32_16x16x32_bf16 v[168:171], a[72:75], a[8:11], v[168:171]
    ds_read_b128 a[48:51], v9 offset:8192
    v_mfma_f32_16x16x32_bf16 v[184:187], a[72:75], a[12:15], v[184:187]
    v_mfma_f32_16x16x32_bf16 v[200:203], a[72:75], a[16:19], v[200:203]
    s_lshl_b32 s82, s2, 2
    s_add_u32 s82, s82, s60
    s_lshl_b32 s82, s82, 11
    v_and_b32 v35, 31, v0
    v_lshlrev_b32 v35, 6, v35
    v_add_u32 v35, s82, v35
    global_load_dword v7, v35, s[12:13]
    v_mfma_f32_16x16x32_bf16 v[216:219], a[72:75], a[20:23], v[216:219]
    v_mfma_f32_16x16x32_bf16 v[232:235], a[72:75], a[24:27], v[232:235]
    ds_read_b128 a[52:55], v9 offset:10240
    v_mfma_f32_16x16x32_bf16 v[248:251], a[72:75], a[28:31], v[248:251]
    ds_read_b64_tr_b16 a[72:73], v12 offset:21504
    v_mfma_f32_16x16x32_bf16 v[140:143], a[76:79], a[0:3], v[140:143]
    ds_read_b64_tr_b16 a[74:75], v12 offset:21760
    v_mfma_f32_16x16x32_bf16 v[156:159], a[76:79], a[4:7], v[156:159]
    v_mfma_f32_16x16x32_bf16 v[172:175], a[76:79], a[8:11], v[172:175]
    ds_read_b128 a[56:59], v9 offset:12288
    v_mfma_f32_16x16x32_bf16 v[188:191], a[76:79], a[12:15], v[188:191]
    v_mfma_f32_16x16x32_bf16 v[204:207], a[76:79], a[16:19], v[204:207]
    v_mfma_f32_16x16x32_bf16 v[220:223], a[76:79], a[20:23], v[220:223]
    v_mfma_f32_16x16x32_bf16 v[236:239], a[76:79], a[24:27], v[236:239]
    ds_read_b128 a[60:63], v9 offset:14336
    v_mfma_f32_16x16x32_bf16 v[252:255], a[76:79], a[28:31], v[252:255]
    ds_read_b64_tr_b16 a[76:77], v14 offset:21504
    v_mfma_f32_16x16x32_bf16 a[128:131], a[80:83], a[0:3], a[128:131]
    ds_read_b64_tr_b16 a[78:79], v14 offset:21760
    v_mfma_f32_16x16x32_bf16 a[144:147], a[80:83], a[4:7], a[144:147]
    v_mfma_f32_16x16x32_bf16 a[160:163], a[80:83], a[8:11], a[160:163]
    ds_read_b64_tr_b16 a[104:105], v12 offset:24576
    v_mfma_f32_16x16x32_bf16 a[176:179], a[80:83], a[12:15], a[176:179]
    v_mfma_f32_16x16x32_bf16 a[192:195], a[80:83], a[16:19], a[192:195]
    v_mfma_f32_16x16x32_bf16 a[208:211], a[80:83], a[20:23], a[208:211]
    v_mfma_f32_16x16x32_bf16 a[224:227], a[80:83], a[24:27], a[224:227]
    ds_read_b64_tr_b16 a[106:107], v12 offset:24832
    v_mfma_f32_16x16x32_bf16 a[240:243], a[80:83], a[28:31], a[240:243]
    ds_read_b64_tr_b16 a[80:81], v12 offset:22528
    v_mfma_f32_16x16x32_bf16 a[132:135], a[84:87], a[0:3], a[132:135]
    ds_read_b64_tr_b16 a[82:83], v12 offset:22784
    v_mfma_f32_16x16x32_bf16 a[148:151], a[84:87], a[4:7], a[148:151]
    v_mfma_f32_16x16x32_bf16 a[164:167], a[84:87], a[8:11], a[164:167]
    ds_read_b64_tr_b16 a[108:109], v14 offset:24576
    v_mfma_f32_16x16x32_bf16 a[180:183], a[84:87], a[12:15], a[180:183]
    v_mfma_f32_16x16x32_bf16 a[196:199], a[84:87], a[16:19], a[196:199]
    v_mfma_f32_16x16x32_bf16 a[212:215], a[84:87], a[20:23], a[212:215]
    v_mfma_f32_16x16x32_bf16 a[228:231], a[84:87], a[24:27], a[228:231]
    ds_read_b64_tr_b16 a[110:111], v14 offset:24832
    v_mfma_f32_16x16x32_bf16 a[244:247], a[84:87], a[28:31], a[244:247]
    ds_read_b64_tr_b16 a[84:85], v14 offset:22528
    v_mfma_f32_16x16x32_bf16 a[136:139], a[88:91], a[0:3], a[136:139]
    ds_read_b64_tr_b16 a[86:87], v14 offset:22784
    v_mfma_f32_16x16x32_bf16 a[152:155], a[88:91], a[4:7], a[152:155]
    v_mfma_f32_16x16x32_bf16 a[168:171], a[88:91], a[8:11], a[168:171]
    v_mfma_f32_16x16x32_bf16 a[184:187], a[88:91], a[12:15], a[184:187]
    v_mfma_f32_16x16x32_bf16 a[200:203], a[88:91], a[16:19], a[200:203]
    v_mfma_f32_16x16x32_bf16 a[216:219], a[88:91], a[20:23], a[216:219]
    v_mfma_f32_16x16x32_bf16 a[232:235], a[88:91], a[24:27], a[232:235]
    v_mfma_f32_16x16x32_bf16 a[248:251], a[88:91], a[28:31], a[248:251]
    ds_read_b64_tr_b16 a[88:89], v12 offset:23552
    v_mfma_f32_16x16x32_bf16 a[140:143], a[92:95], a[0:3], a[140:143]
    ds_read_b64_tr_b16 a[90:91], v12 offset:23808
    v_mfma_f32_16x16x32_bf16 a[156:159], a[92:95], a[4:7], a[156:159]
    v_mfma_f32_16x16x32_bf16 a[172:175], a[92:95], a[8:11], a[172:175]
    v_mfma_f32_16x16x32_bf16 a[188:191], a[92:95], a[12:15], a[188:191]
    v_mfma_f32_16x16x32_bf16 a[204:207], a[92:95], a[16:19], a[204:207]
    v_mfma_f32_16x16x32_bf16 a[220:223], a[92:95], a[20:23], a[220:223]
    v_mfma_f32_16x16x32_bf16 a[236:239], a[92:95], a[24:27], a[236:239]
    v_mfma_f32_16x16x32_bf16 a[252:255], a[92:95], a[28:31], a[252:255]
    ds_read_b64_tr_b16 a[92:93], v14 offset:23552
    v_mfma_f32_16x16x32_bf16 v[48:51], a[96:99], a[0:3], v[48:51]
    ds_read_b64_tr_b16 a[94:95], v14 offset:23808
    v_mfma_f32_16x16x32_bf16 v[52:55], a[96:99], a[4:7], v[52:55]
    v_mfma_f32_16x16x32_bf16 v[64:67], a[96:99], a[8:11], v[64:67]
    v_mfma_f32_16x16x32_bf16 v[68:71], a[96:99], a[12:15], v[68:71]
    v_mfma_f32_16x16x32_bf16 v[80:83], a[96:99], a[16:19], v[80:83]
    v_mfma_f32_16x16x32_bf16 v[84:87], a[96:99], a[20:23], v[84:87]
    v_mfma_f32_16x16x32_bf16 v[96:99], a[96:99], a[24:27], v[96:99]
    v_mfma_f32_16x16x32_bf16 v[100:103], a[96:99], a[28:31], v[100:103]
    v_mfma_f32_16x16x32_bf16 v[56:59], a[100:103], a[0:3], v[56:59]
    v_mfma_f32_16x16x32_bf16 v[60:63], a[100:103], a[4:7], v[60:63]
    v_mfma_f32_16x16x32_bf16 v[72:75], a[100:103], a[8:11], v[72:75]
    v_mfma_f32_16x16x32_bf16 v[76:79], a[100:103], a[12:15], v[76:79]
    v_mfma_f32_16x16x32_bf16 v[88:91], a[100:103], a[16:19], v[88:91]
    v_mfma_f32_16x16x32_bf16 v[92:95], a[100:103], a[20:23], v[92:95]
    v_mfma_f32_16x16x32_bf16 v[104:107], a[100:103], a[24:27], v[104:107]
    v_mfma_f32_16x16x32_bf16 v[108:111], a[100:103], a[28:31], v[108:111]
    s_waitcnt vmcnt(13) lgkmcnt(0)
    s_barrier
    v_mfma_f32_16x16x32_bf16 v[128:131], a[64:67], a[32:35], v[128:131]
    v_mfma_f32_16x16x32_bf16 v[144:147], a[64:67], a[36:39], v[144:147]
    v_mfma_f32_16x16x32_bf16 v[160:163], a[64:67], a[40:43], v[160:163]
    ds_read_b128 a[0:3], v8 offset:34816
    v_mfma_f32_16x16x32_bf16 v[176:179], a[64:67], a[44:47], v[176:179]
    v_mfma_f32_16x16x32_bf16 v[192:195], a[64:67], a[48:51], v[192:195]
    s_mul_i32 s82, s65, 1835008
    v_mfma_f32_16x16x32_bf16 v[208:211], a[64:67], a[52:55], v[208:211]
    s_lshl_b32 s83, s66, 8
    v_mfma_f32_16x16x32_bf16 v[224:227], a[64:67], a[56:59], v[224:227]
    ds_read_b128 a[4:7], v8 offset:36864
    s_add_u32 s82, s82, s83
    v_mfma_f32_16x16x32_bf16 v[240:243], a[64:67], a[60:63], v[240:243]
    ds_read_b64_tr_b16 a[64:65], v13 offset:0
    s_add_u32 s48, s20, s82
    v_mfma_f32_16x16x32_bf16 v[132:135], a[68:71], a[32:35], v[132:135]
    ds_read_b64_tr_b16 a[66:67], v13 offset:256
    s_addc_u32 s49, s21, 0
    v_mfma_f32_16x16x32_bf16 v[148:151], a[68:71], a[36:39], v[148:151]
    s_and_b32 s49, s49, 0xffff
    v_mfma_f32_16x16x32_bf16 v[164:167], a[68:71], a[40:43], v[164:167]
    ds_read_b128 a[8:11], v8 offset:38912
    s_sub_u32 s50, 7340032, s82
    v_mfma_f32_16x16x32_bf16 v[180:183], a[68:71], a[44:47], v[180:183]
    s_mov_b32 s51, 0x20000
    v_mfma_f32_16x16x32_bf16 v[196:199], a[68:71], a[48:51], v[196:199]
    s_add_u32 s52, s12, s83
    v_mfma_f32_16x16x32_bf16 v[212:215], a[68:71], a[52:55], v[212:215]
    s_addc_u32 s53, s13, 0
    v_mfma_f32_16x16x32_bf16 v[228:231], a[68:71], a[56:59], v[228:231]
    ds_read_b128 a[12:15], v8 offset:40960
    s_and_b32 s53, s53, 0xffff
    v_mfma_f32_16x16x32_bf16 v[244:247], a[68:71], a[60:63], v[244:247]
    ds_read_b64_tr_b16 a[68:69], v15 offset:0
    s_sub_u32 s54, 2097152, s83
    v_mfma_f32_16x16x32_bf16 v[136:139], a[72:75], a[32:35], v[136:139]
    ds_read_b64_tr_b16 a[70:71], v15 offset:256
    s_mov_b32 s55, 0x20000
    v_mfma_f32_16x16x32_bf16 v[152:155], a[72:75], a[36:39], v[152:155]
    s_lshl_b32 s3, s60, 11
    v_mfma_f32_16x16x32_bf16 v[168:171], a[72:75], a[40:43], v[168:171]
    ds_read_b128 a[16:19], v8 offset:43008
    v_lshrrev_b32 v34, 4, v0
    v_mfma_f32_16x16x32_bf16 v[184:187], a[72:75], a[44:47], v[184:187]
    v_and_b32 v35, 15, v0
    v_mfma_f32_16x16x32_bf16 v[200:203], a[72:75], a[48:51], v[200:203]
    v_lshlrev_b32 v36, 1, v34
    v_mfma_f32_16x16x32_bf16 v[216:219], a[72:75], a[52:55], v[216:219]
    v_add_u32 v36, 0, v36
    v_mfma_f32_16x16x32_bf16 v[232:235], a[72:75], a[56:59], v[232:235]
    ds_read_b128 a[20:23], v8 offset:45056
    v_xor_b32 v36, v36, v35
    v_mfma_f32_16x16x32_bf16 v[248:251], a[72:75], a[60:63], v[248:251]
    ds_read_b64_tr_b16 a[72:73], v13 offset:1024
    v_lshlrev_b32 v36, 4, v36
    v_mfma_f32_16x16x32_bf16 v[140:143], a[76:79], a[32:35], v[140:143]
    ds_read_b64_tr_b16 a[74:75], v13 offset:1280
    v_lshl_add_u32 v36, v34, 11, v36
    v_mfma_f32_16x16x32_bf16 v[156:159], a[76:79], a[36:39], v[156:159]
    s_lshl_b32 s82, s60, 14
    v_mfma_f32_16x16x32_bf16 v[172:175], a[76:79], a[40:43], v[172:175]
    ds_read_b128 a[24:27], v8 offset:47104
    s_add_u32 s82, s82, 0
    v_mfma_f32_16x16x32_bf16 v[188:191], a[76:79], a[44:47], v[188:191]
    v_add_u32 v17, s82, v36
    v_mfma_f32_16x16x32_bf16 v[204:207], a[76:79], a[48:51], v[204:207]
    s_lshl_b32 s82, s62, 1
    v_mfma_f32_16x16x32_bf16 v[220:223], a[76:79], a[52:55], v[220:223]
    s_add_u32 s82, s82, 0
    v_mfma_f32_16x16x32_bf16 v[236:239], a[76:79], a[56:59], v[236:239]
    ds_read_b128 a[28:31], v8 offset:49152
    s_lshl_b32 s82, s82, 3
    v_mfma_f32_16x16x32_bf16 v[252:255], a[76:79], a[60:63], v[252:255]
    ds_read_b64_tr_b16 a[76:77], v15 offset:1024
    s_lshl_b32 s83, s61, 2
    v_mfma_f32_16x16x32_bf16 a[128:131], a[80:83], a[32:35], a[128:131]
    ds_read_b64_tr_b16 a[78:79], v15 offset:1280
    s_add_u32 s82, s82, s83
    v_mfma_f32_16x16x32_bf16 a[144:147], a[80:83], a[36:39], a[144:147]
    s_mul_i32 s83, s62, 96
    v_mfma_f32_16x16x32_bf16 a[160:163], a[80:83], a[40:43], a[160:163]
    ds_read_b64_tr_b16 a[96:97], v13 offset:4096
    s_add_u32 s82, s82, s83
    v_mfma_f32_16x16x32_bf16 a[176:179], a[80:83], a[44:47], a[176:179]
    s_lshl_b32 s82, s82, 11
    v_mfma_f32_16x16x32_bf16 a[192:195], a[80:83], a[48:51], a[192:195]
    s_sub_u32 s82, s82, 0
    v_mfma_f32_16x16x32_bf16 a[208:211], a[80:83], a[52:55], a[208:211]
    v_add_u32 v19, s82, v36
    v_mfma_f32_16x16x32_bf16 a[224:227], a[80:83], a[56:59], a[224:227]
    ds_read_b64_tr_b16 a[98:99], v13 offset:4352
    v_lshlrev_b32 v36, 1, v34
    v_mfma_f32_16x16x32_bf16 a[240:243], a[80:83], a[60:63], a[240:243]
    ds_read_b64_tr_b16 a[80:81], v13 offset:2048
    v_add_u32 v36, 8, v36
    v_mfma_f32_16x16x32_bf16 a[132:135], a[84:87], a[32:35], a[132:135]
    ds_read_b64_tr_b16 a[82:83], v13 offset:2304
    v_xor_b32 v36, v36, v35
    v_mfma_f32_16x16x32_bf16 a[148:151], a[84:87], a[36:39], a[148:151]
    v_lshlrev_b32 v36, 4, v36
    v_mfma_f32_16x16x32_bf16 a[164:167], a[84:87], a[40:43], a[164:167]
    ds_read_b64_tr_b16 a[100:101], v15 offset:4096
    v_lshl_add_u32 v36, v34, 11, v36
    v_mfma_f32_16x16x32_bf16 a[180:183], a[84:87], a[44:47], a[180:183]
    s_lshl_b32 s82, s60, 14
    v_mfma_f32_16x16x32_bf16 a[196:199], a[84:87], a[48:51], a[196:199]
    s_add_u32 s82, s82, 7168
    v_mfma_f32_16x16x32_bf16 a[212:215], a[84:87], a[52:55], a[212:215]
    v_add_u32 v18, s82, v36
    v_mfma_f32_16x16x32_bf16 a[228:231], a[84:87], a[56:59], a[228:231]
    ds_read_b64_tr_b16 a[102:103], v15 offset:4352
    s_lshl_b32 s82, s62, 1
    v_mfma_f32_16x16x32_bf16 a[244:247], a[84:87], a[60:63], a[244:247]
    ds_read_b64_tr_b16 a[84:85], v15 offset:2048
    s_add_u32 s82, s82, 1
    v_mfma_f32_16x16x32_bf16 a[136:139], a[88:91], a[32:35], a[136:139]
    ds_read_b64_tr_b16 a[86:87], v15 offset:2304
    s_lshl_b32 s82, s82, 3
    v_mfma_f32_16x16x32_bf16 a[152:155], a[88:91], a[36:39], a[152:155]
    s_lshl_b32 s83, s61, 2
    v_mfma_f32_16x16x32_bf16 a[168:171], a[88:91], a[40:43], a[168:171]
    s_add_u32 s82, s82, s83
    v_mfma_f32_16x16x32_bf16 a[184:187], a[88:91], a[44:47], a[184:187]
    s_mul_i32 s83, s62, 96
    v_mfma_f32_16x16x32_bf16 a[200:203], a[88:91], a[48:51], a[200:203]
    s_add_u32 s82, s82, s83
    v_mfma_f32_16x16x32_bf16 a[216:219], a[88:91], a[52:55], a[216:219]
    s_lshl_b32 s82, s82, 11
    v_mfma_f32_16x16x32_bf16 a[232:235], a[88:91], a[56:59], a[232:235]
    s_sub_u32 s82, s82, 1024
    v_mfma_f32_16x16x32_bf16 a[248:251], a[88:91], a[60:63], a[248:251]
    ds_read_b64_tr_b16 a[88:89], v13 offset:3072
    v_add_u32 v20, s82, v36
    v_mfma_f32_16x16x32_bf16 a[140:143], a[92:95], a[32:35], a[140:143]
    ds_read_b64_tr_b16 a[90:91], v13 offset:3328
    s_xor_b32 s82, s65, 0
    v_mfma_f32_16x16x32_bf16 a[156:159], a[92:95], a[36:39], a[156:159]
    s_lshl_b32 s82, s82, 10
    v_mfma_f32_16x16x32_bf16 a[172:175], a[92:95], a[40:43], a[172:175]
    v_add_u32 v21, s82, v16
    v_mfma_f32_16x16x32_bf16 a[188:191], a[92:95], a[44:47], a[188:191]
    s_xor_b32 s82, s65, 1
    v_mfma_f32_16x16x32_bf16 a[204:207], a[92:95], a[48:51], a[204:207]
    s_lshl_b32 s82, s82, 10
    v_mfma_f32_16x16x32_bf16 a[220:223], a[92:95], a[52:55], a[220:223]
    v_add_u32 v22, s82, v16
    v_mfma_f32_16x16x32_bf16 a[236:239], a[92:95], a[56:59], a[236:239]
    s_xor_b32 s82, s65, 2
    v_mfma_f32_16x16x32_bf16 a[252:255], a[92:95], a[60:63], a[252:255]
    ds_read_b64_tr_b16 a[92:93], v15 offset:3072
    s_lshl_b32 s82, s82, 10
    v_mfma_f32_16x16x32_bf16 v[48:51], a[104:107], a[32:35], v[48:51]
    ds_read_b64_tr_b16 a[94:95], v15 offset:3328
    v_add_u32 v23, s82, v16
    v_mfma_f32_16x16x32_bf16 v[52:55], a[104:107], a[36:39], v[52:55]
    s_xor_b32 s82, s65, 3
    v_mfma_f32_16x16x32_bf16 v[64:67], a[104:107], a[40:43], v[64:67]
    s_lshl_b32 s82, s82, 10
    v_mfma_f32_16x16x32_bf16 v[68:71], a[104:107], a[44:47], v[68:71]
    v_add_u32 v24, s82, v16
    v_mfma_f32_16x16x32_bf16 v[80:83], a[104:107], a[48:51], v[80:83]
    s_mov_b32 s94, 0xbdd2d3e8
    v_mfma_f32_16x16x32_bf16 v[84:87], a[104:107], a[52:55], v[84:87]
    v_mfma_f32_16x16x32_bf16 v[96:99], a[104:107], a[56:59], v[96:99]
    v_mfma_f32_16x16x32_bf16 v[100:103], a[104:107], a[60:63], v[100:103]
    v_mfma_f32_16x16x32_bf16 v[56:59], a[108:111], a[32:35], v[56:59]
    v_mfma_f32_16x16x32_bf16 v[60:63], a[108:111], a[36:39], v[60:63]
    v_mfma_f32_16x16x32_bf16 v[72:75], a[108:111], a[40:43], v[72:75]
    v_mfma_f32_16x16x32_bf16 v[76:79], a[108:111], a[44:47], v[76:79]
    v_mfma_f32_16x16x32_bf16 v[88:91], a[108:111], a[48:51], v[88:91]
    v_mfma_f32_16x16x32_bf16 v[92:95], a[108:111], a[52:55], v[92:95]
    v_mfma_f32_16x16x32_bf16 v[104:107], a[108:111], a[56:59], v[104:107]
    v_mfma_f32_16x16x32_bf16 v[108:111], a[108:111], a[60:63], v[108:111]
    s_waitcnt vmcnt(3) lgkmcnt(0)
    s_barrier
    v_mfma_f32_16x16x32_bf16 v[128:131], a[64:67], a[0:3], v[128:131]
    v_mfma_f32_16x16x32_bf16 v[144:147], a[64:67], a[4:7], v[144:147]
    v_mfma_f32_16x16x32_bf16 v[160:163], a[64:67], a[8:11], v[160:163]
    ds_read_b128 a[32:35], v9 offset:34816
    v_mfma_f32_16x16x32_bf16 v[176:179], a[64:67], a[12:15], v[176:179]
    v_mfma_f32_16x16x32_bf16 v[192:195], a[64:67], a[16:19], v[192:195]
    s_mov_b32 s95, 0xbdd2d3e8
    v_mfma_f32_16x16x32_bf16 v[208:211], a[64:67], a[20:23], v[208:211]
    v_mov_b32 v26, 0xc0135761
    v_mfma_f32_16x16x32_bf16 v[224:227], a[64:67], a[24:27], v[224:227]
    ds_read_b128 a[36:39], v9 offset:36864
    v_mov_b32 v27, 0xc0135761
    v_mfma_f32_16x16x32_bf16 v[240:243], a[64:67], a[28:31], v[240:243]
    ds_read_b64_tr_b16 a[64:65], v13 offset:20480
    v_mov_b32 v25, 1
    v_mfma_f32_16x16x32_bf16 v[132:135], a[68:71], a[0:3], v[132:135]
    ds_read_b64_tr_b16 a[66:67], v13 offset:20736
    s_lshl_b32 s82, s60, 12
    v_mfma_f32_16x16x32_bf16 v[148:151], a[68:71], a[4:7], v[148:151]
    s_add_u32 s68, s88, s82
    v_mfma_f32_16x16x32_bf16 v[164:167], a[68:71], a[8:11], v[164:167]
    ds_read_b128 a[40:43], v9 offset:38912
    s_lshl_b32 s82, s61, 13
    v_mfma_f32_16x16x32_bf16 v[180:183], a[68:71], a[12:15], v[180:183]
    s_add_u32 s88, s88, s82
    v_mfma_f32_16x16x32_bf16 v[196:199], a[68:71], a[16:19], v[196:199]
    s_lshr_b32 s82, s66, 1
    v_mfma_f32_16x16x32_bf16 v[212:215], a[68:71], a[20:23], v[212:215]
    s_add_u32 s82, s82, 24
    v_mfma_f32_16x16x32_bf16 v[228:231], a[68:71], a[24:27], v[228:231]
    ds_read_b128 a[44:47], v9 offset:40960
    s_lshl_b32 s82, s82, 14
    v_mfma_f32_16x16x32_bf16 v[244:247], a[68:71], a[28:31], v[244:247]
    ds_read_b64_tr_b16 a[68:69], v15 offset:20480
    s_add_u32 s90, s88, s82
    v_mfma_f32_16x16x32_bf16 v[136:139], a[72:75], a[0:3], v[136:139]
    ds_read_b64_tr_b16 a[70:71], v15 offset:20736
    s_lshl_b32 s82, s66, 14
    v_mfma_f32_16x16x32_bf16 v[152:155], a[72:75], a[4:7], v[152:155]
    s_add_u32 s88, s88, s82
    v_mfma_f32_16x16x32_bf16 v[168:171], a[72:75], a[8:11], v[168:171]
    ds_read_b128 a[48:51], v9 offset:43008
    s_add_u32 s89, s88, 262144
    v_mfma_f32_16x16x32_bf16 v[184:187], a[72:75], a[12:15], v[184:187]
    s_add_u32 s88, s88, 131072
    v_mfma_f32_16x16x32_bf16 v[200:203], a[72:75], a[16:19], v[200:203]
    s_mov_b32 s76, s93
    v_mfma_f32_16x16x32_bf16 v[216:219], a[72:75], a[20:23], v[216:219]
    s_lshl_b32 s82, s63, 4
    v_mfma_f32_16x16x32_bf16 v[232:235], a[72:75], a[24:27], v[232:235]
    ds_read_b128 a[52:55], v9 offset:45056
    s_lshl_b32 s83, s60, 2
    v_mfma_f32_16x16x32_bf16 v[248:251], a[72:75], a[28:31], v[248:251]
    ds_read_b64_tr_b16 a[72:73], v13 offset:21504
    s_add_u32 s83, s83, s82
    v_mfma_f32_16x16x32_bf16 v[140:143], a[76:79], a[0:3], v[140:143]
    ds_read_b64_tr_b16 a[74:75], v13 offset:21760
    s_add_u32 s83, s83, s65
    v_mfma_f32_16x16x32_bf16 v[156:159], a[76:79], a[4:7], v[156:159]
    s_lshl_b32 s83, s83, 15
    v_mfma_f32_16x16x32_bf16 v[172:175], a[76:79], a[8:11], v[172:175]
    ds_read_b128 a[56:59], v9 offset:47104
    s_add_u32 s69, s83, 4194304
    v_mfma_f32_16x16x32_bf16 v[188:191], a[76:79], a[12:15], v[188:191]
    s_lshl_b32 s84, s63, 3
    v_mfma_f32_16x16x32_bf16 v[204:207], a[76:79], a[16:19], v[204:207]
    s_add_u32 s84, s84, s66
    v_mfma_f32_16x16x32_bf16 v[220:223], a[76:79], a[20:23], v[220:223]
    s_lshl_b32 s85, s84, 2
    v_mfma_f32_16x16x32_bf16 v[236:239], a[76:79], a[24:27], v[236:239]
    ds_read_b128 a[60:63], v9 offset:49152
    s_add_u32 s85, s85, s60
    v_mfma_f32_16x16x32_bf16 v[252:255], a[76:79], a[28:31], v[252:255]
    ds_read_b64_tr_b16 a[76:77], v15 offset:21504
    s_lshl_b32 s85, s85, 8
    v_mfma_f32_16x16x32_bf16 a[128:131], a[80:83], a[0:3], a[128:131]
    ds_read_b64_tr_b16 a[78:79], v15 offset:21760
    s_add_u32 s77, s85, 39862272
    v_mfma_f32_16x16x32_bf16 a[144:147], a[80:83], a[4:7], a[144:147]
    s_lshl_b32 s84, s84, 18
    v_mfma_f32_16x16x32_bf16 a[160:163], a[80:83], a[8:11], a[160:163]
    ds_read_b64_tr_b16 a[104:105], v13 offset:24576
    s_lshl_b32 s85, s60, 12
    v_mfma_f32_16x16x32_bf16 a[176:179], a[80:83], a[12:15], a[176:179]
    s_add_u32 s84, s84, s85
    v_mfma_f32_16x16x32_bf16 a[192:195], a[80:83], a[16:19], a[192:195]
    s_add_u32 s84, s84, 23068672
    v_mfma_f32_16x16x32_bf16 a[208:211], a[80:83], a[20:23], a[208:211]
    s_xor_b32 s85, s65, 1
    v_mfma_f32_16x16x32_bf16 a[224:227], a[80:83], a[24:27], a[224:227]
    ds_read_b64_tr_b16 a[106:107], v13 offset:24832
    s_lshl_b32 s85, s85, 16
    v_mfma_f32_16x16x32_bf16 a[240:243], a[80:83], a[28:31], a[240:243]
    ds_read_b64_tr_b16 a[80:81], v13 offset:22528
    s_add_u32 s70, s84, s85
    v_mfma_f32_16x16x32_bf16 a[132:135], a[84:87], a[0:3], a[132:135]
    ds_read_b64_tr_b16 a[82:83], v13 offset:22784
    s_add_u32 s70, s70, 16384
    v_mfma_f32_16x16x32_bf16 a[148:151], a[84:87], a[4:7], a[148:151]
    s_lshl_b32 s85, s65, 16
    v_mfma_f32_16x16x32_bf16 a[164:167], a[84:87], a[8:11], a[164:167]
    ds_read_b64_tr_b16 a[108:109], v15 offset:24576
    s_add_u32 s73, s84, s85
    v_mfma_f32_16x16x32_bf16 a[180:183], a[84:87], a[12:15], a[180:183]
    s_add_u32 s73, s73, 16384
    v_mfma_f32_16x16x32_bf16 a[196:199], a[84:87], a[16:19], a[196:199]
    s_xor_b32 s85, s65, 2
    v_mfma_f32_16x16x32_bf16 a[212:215], a[84:87], a[20:23], a[212:215]
    s_lshl_b32 s85, s85, 16
    v_mfma_f32_16x16x32_bf16 a[228:231], a[84:87], a[24:27], a[228:231]
    ds_read_b64_tr_b16 a[110:111], v15 offset:24832
    s_add_u32 s71, s84, s85
    v_mfma_f32_16x16x32_bf16 a[244:247], a[84:87], a[28:31], a[244:247]
    ds_read_b64_tr_b16 a[84:85], v15 offset:22528
    s_add_u32 s71, s71, 32768
    v_mfma_f32_16x16x32_bf16 a[136:139], a[88:91], a[0:3], a[136:139]
    ds_read_b64_tr_b16 a[86:87], v15 offset:22784
    s_lshl_b32 s85, s65, 16
    v_mfma_f32_16x16x32_bf16 a[152:155], a[88:91], a[4:7], a[152:155]
    s_add_u32 s74, s84, s85
    v_mfma_f32_16x16x32_bf16 a[168:171], a[88:91], a[8:11], a[168:171]
    s_add_u32 s74, s74, 32768
    v_mfma_f32_16x16x32_bf16 a[184:187], a[88:91], a[12:15], a[184:187]
    s_xor_b32 s85, s65, 3
    v_mfma_f32_16x16x32_bf16 a[200:203], a[88:91], a[16:19], a[200:203]
    s_lshl_b32 s85, s85, 16
    v_mfma_f32_16x16x32_bf16 a[216:219], a[88:91], a[20:23], a[216:219]
    s_add_u32 s72, s84, s85
    v_mfma_f32_16x16x32_bf16 a[232:235], a[88:91], a[24:27], a[232:235]
    s_add_u32 s72, s72, 49152
    v_mfma_f32_16x16x32_bf16 a[248:251], a[88:91], a[28:31], a[248:251]
    ds_read_b64_tr_b16 a[88:89], v13 offset:23552
    s_lshl_b32 s85, s65, 16
    v_mfma_f32_16x16x32_bf16 a[140:143], a[92:95], a[0:3], a[140:143]
    ds_read_b64_tr_b16 a[90:91], v13 offset:23808
    s_add_u32 s75, s84, s85
    v_mfma_f32_16x16x32_bf16 a[156:159], a[92:95], a[4:7], a[156:159]
    s_add_u32 s75, s75, 49152
    v_mfma_f32_16x16x32_bf16 a[172:175], a[92:95], a[8:11], a[172:175]
    v_and_b32 v36, 1, v34
    v_mfma_f32_16x16x32_bf16 a[188:191], a[92:95], a[12:15], a[188:191]
    v_lshlrev_b32 v36, 10, v36
    v_mfma_f32_16x16x32_bf16 a[204:207], a[92:95], a[16:19], a[204:207]
    v_lshrrev_b32 v34, 1, v34
    v_mfma_f32_16x16x32_bf16 a[220:223], a[92:95], a[20:23], a[220:223]
    v_lshl_add_u32 v36, v34, 8, v36
    v_mfma_f32_16x16x32_bf16 a[236:239], a[92:95], a[24:27], a[236:239]
    v_lshl_add_u32 v36, v35, 4, v36
    v_mfma_f32_16x16x32_bf16 a[252:255], a[92:95], a[28:31], a[252:255]
    ds_read_b64_tr_b16 a[92:93], v15 offset:23552
    s_and_b32 s82, s66, 1
    v_mfma_f32_16x16x32_bf16 v[48:51], a[96:99], a[0:3], v[48:51]
    ds_read_b64_tr_b16 a[94:95], v15 offset:23808
    s_lshl_b32 s82, s82, 9
    v_mfma_f32_16x16x32_bf16 v[52:55], a[96:99], a[4:7], v[52:55]
    v_add_u32 v28, s82, v36
    v_mfma_f32_16x16x32_bf16 v[64:67], a[96:99], a[8:11], v[64:67]
    v_mov_b32 v29, 0x100
    v_mfma_f32_16x16x32_bf16 v[68:71], a[96:99], a[12:15], v[68:71]
    v_mov_b32 v42, 0x10000
    v_mfma_f32_16x16x32_bf16 v[80:83], a[96:99], a[16:19], v[80:83]
    s_mov_b32 s93, s92
    v_mfma_f32_16x16x32_bf16 v[84:87], a[96:99], a[20:23], v[84:87]
    v_mfma_f32_16x16x32_bf16 v[96:99], a[96:99], a[24:27], v[96:99]
    v_mfma_f32_16x16x32_bf16 v[100:103], a[96:99], a[28:31], v[100:103]
    v_mfma_f32_16x16x32_bf16 v[56:59], a[100:103], a[0:3], v[56:59]
    v_mfma_f32_16x16x32_bf16 v[60:63], a[100:103], a[4:7], v[60:63]
    v_mfma_f32_16x16x32_bf16 v[72:75], a[100:103], a[8:11], v[72:75]
    v_mfma_f32_16x16x32_bf16 v[76:79], a[100:103], a[12:15], v[76:79]
    v_mfma_f32_16x16x32_bf16 v[88:91], a[100:103], a[16:19], v[88:91]
    v_mfma_f32_16x16x32_bf16 v[92:95], a[100:103], a[20:23], v[92:95]
    v_mfma_f32_16x16x32_bf16 v[104:107], a[100:103], a[24:27], v[104:107]
    v_mfma_f32_16x16x32_bf16 v[108:111], a[100:103], a[28:31], v[108:111]
    s_waitcnt lgkmcnt(0)
    s_barrier
    v_mfma_f32_16x16x32_bf16 v[128:131], a[64:67], a[32:35], v[128:131]
    v_mfma_f32_16x16x32_bf16 v[144:147], a[64:67], a[36:39], v[144:147]
    v_mfma_f32_16x16x32_bf16 v[160:163], a[64:67], a[40:43], v[160:163]
    s_mov_b32 s82, 0
    s_add_u32 m0, s3, 0
    v_mfma_f32_16x16x32_bf16 v[176:179], a[64:67], a[44:47], v[176:179]
    buffer_load_dwordx4 v17, s[48:51], s82 offen lds
    v_mfma_f32_16x16x32_bf16 v[192:195], a[64:67], a[48:51], v[192:195]
    v_mfma_f32_16x16x32_bf16 v[208:211], a[64:67], a[52:55], v[208:211]
    v_mfma_f32_16x16x32_bf16 v[224:227], a[64:67], a[56:59], v[224:227]
    v_mfma_f32_16x16x32_bf16 v[240:243], a[64:67], a[60:63], v[240:243]
    buffer_load_dwordx4 v18, s[48:51], s82 offen offset:1024 lds
    v_mfma_f32_16x16x32_bf16 v[132:135], a[68:71], a[32:35], v[132:135]
    v_mfma_f32_16x16x32_bf16 v[148:151], a[68:71], a[36:39], v[148:151]
    v_mfma_f32_16x16x32_bf16 v[164:167], a[68:71], a[40:43], v[164:167]
    v_mfma_f32_16x16x32_bf16 v[180:183], a[68:71], a[44:47], v[180:183]
    s_mov_b32 s83, 229376
    s_add_u32 m0, s3, 8192
    v_mfma_f32_16x16x32_bf16 v[196:199], a[68:71], a[48:51], v[196:199]
    buffer_load_dwordx4 v17, s[48:51], s83 offen lds
    v_mfma_f32_16x16x32_bf16 v[212:215], a[68:71], a[52:55], v[212:215]
    v_mfma_f32_16x16x32_bf16 v[228:231], a[68:71], a[56:59], v[228:231]
    v_mfma_f32_16x16x32_bf16 v[244:247], a[68:71], a[60:63], v[244:247]
    v_mfma_f32_16x16x32_bf16 v[136:139], a[72:75], a[32:35], v[136:139]
    buffer_load_dwordx4 v18, s[48:51], s83 offen offset:1024 lds
    v_mfma_f32_16x16x32_bf16 v[152:155], a[72:75], a[36:39], v[152:155]
    v_mfma_f32_16x16x32_bf16 v[168:171], a[72:75], a[40:43], v[168:171]
    v_mfma_f32_16x16x32_bf16 v[184:187], a[72:75], a[44:47], v[184:187]
    v_mfma_f32_16x16x32_bf16 v[200:203], a[72:75], a[48:51], v[200:203]
    s_mov_b32 s82, 458752
    s_add_u32 m0, s3, 16384
    v_mfma_f32_16x16x32_bf16 v[216:219], a[72:75], a[52:55], v[216:219]
    buffer_load_dwordx4 v17, s[48:51], s82 offen lds
    v_mfma_f32_16x16x32_bf16 v[232:235], a[72:75], a[56:59], v[232:235]
    v_mfma_f32_16x16x32_bf16 v[248:251], a[72:75], a[60:63], v[248:251]
    v_mfma_f32_16x16x32_bf16 v[140:143], a[76:79], a[32:35], v[140:143]
    v_mfma_f32_16x16x32_bf16 v[156:159], a[76:79], a[36:39], v[156:159]
    buffer_load_dwordx4 v18, s[48:51], s82 offen offset:1024 lds
    v_mfma_f32_16x16x32_bf16 v[172:175], a[76:79], a[40:43], v[172:175]
    v_mfma_f32_16x16x32_bf16 v[188:191], a[76:79], a[44:47], v[188:191]
    v_mfma_f32_16x16x32_bf16 v[204:207], a[76:79], a[48:51], v[204:207]
    v_mfma_f32_16x16x32_bf16 v[220:223], a[76:79], a[52:55], v[220:223]
    s_mov_b32 s83, 688128
    s_add_u32 m0, s3, 24576
    v_mfma_f32_16x16x32_bf16 v[236:239], a[76:79], a[56:59], v[236:239]
    buffer_load_dwordx4 v17, s[48:51], s83 offen lds
    v_mfma_f32_16x16x32_bf16 v[252:255], a[76:79], a[60:63], v[252:255]
    v_mfma_f32_16x16x32_bf16 a[128:131], a[80:83], a[32:35], a[128:131]
    v_mfma_f32_16x16x32_bf16 a[144:147], a[80:83], a[36:39], a[144:147]
    v_mfma_f32_16x16x32_bf16 a[160:163], a[80:83], a[40:43], a[160:163]
    buffer_load_dwordx4 v18, s[48:51], s83 offen offset:1024 lds
    v_mfma_f32_16x16x32_bf16 a[176:179], a[80:83], a[44:47], a[176:179]
    v_mfma_f32_16x16x32_bf16 a[192:195], a[80:83], a[48:51], a[192:195]
    v_mfma_f32_16x16x32_bf16 a[208:211], a[80:83], a[52:55], a[208:211]
    v_mfma_f32_16x16x32_bf16 a[224:227], a[80:83], a[56:59], a[224:227]
    s_mov_b32 s82, 917504
    s_add_u32 m0, s3, 32768
    v_mfma_f32_16x16x32_bf16 a[240:243], a[80:83], a[60:63], a[240:243]
    buffer_load_dwordx4 v17, s[48:51], s82 offen lds
    v_mfma_f32_16x16x32_bf16 a[132:135], a[84:87], a[32:35], a[132:135]
    v_mfma_f32_16x16x32_bf16 a[148:151], a[84:87], a[36:39], a[148:151]
    v_mfma_f32_16x16x32_bf16 a[164:167], a[84:87], a[40:43], a[164:167]
    v_mfma_f32_16x16x32_bf16 a[180:183], a[84:87], a[44:47], a[180:183]
    buffer_load_dwordx4 v18, s[48:51], s82 offen offset:1024 lds
    v_mfma_f32_16x16x32_bf16 a[196:199], a[84:87], a[48:51], a[196:199]
    v_mfma_f32_16x16x32_bf16 a[212:215], a[84:87], a[52:55], a[212:215]
    v_mfma_f32_16x16x32_bf16 a[228:231], a[84:87], a[56:59], a[228:231]
    v_mfma_f32_16x16x32_bf16 a[244:247], a[84:87], a[60:63], a[244:247]
    s_mov_b32 s83, 1146880
    s_add_u32 m0, s3, 40960
    v_mfma_f32_16x16x32_bf16 a[136:139], a[88:91], a[32:35], a[136:139]
    buffer_load_dwordx4 v17, s[48:51], s83 offen lds
    v_mfma_f32_16x16x32_bf16 a[152:155], a[88:91], a[36:39], a[152:155]
    v_mfma_f32_16x16x32_bf16 a[168:171], a[88:91], a[40:43], a[168:171]
    v_mfma_f32_16x16x32_bf16 a[184:187], a[88:91], a[44:47], a[184:187]
    v_mfma_f32_16x16x32_bf16 a[200:203], a[88:91], a[48:51], a[200:203]
    buffer_load_dwordx4 v18, s[48:51], s83 offen offset:1024 lds
    v_mfma_f32_16x16x32_bf16 a[216:219], a[88:91], a[52:55], a[216:219]
    v_mfma_f32_16x16x32_bf16 a[232:235], a[88:91], a[56:59], a[232:235]
    v_mfma_f32_16x16x32_bf16 a[248:251], a[88:91], a[60:63], a[248:251]
    v_mfma_f32_16x16x32_bf16 a[140:143], a[92:95], a[32:35], a[140:143]
    s_mov_b32 s82, 1376256
    s_add_u32 m0, s3, 49152
    v_mfma_f32_16x16x32_bf16 a[156:159], a[92:95], a[36:39], a[156:159]
    buffer_load_dwordx4 v17, s[48:51], s82 offen lds
    v_mfma_f32_16x16x32_bf16 a[172:175], a[92:95], a[40:43], a[172:175]
    v_mfma_f32_16x16x32_bf16 a[188:191], a[92:95], a[44:47], a[188:191]
    v_mfma_f32_16x16x32_bf16 a[204:207], a[92:95], a[48:51], a[204:207]
    v_mfma_f32_16x16x32_bf16 a[220:223], a[92:95], a[52:55], a[220:223]
    buffer_load_dwordx4 v18, s[48:51], s82 offen offset:1024 lds
    v_mfma_f32_16x16x32_bf16 a[236:239], a[92:95], a[56:59], a[236:239]
    v_mfma_f32_16x16x32_bf16 a[252:255], a[92:95], a[60:63], a[252:255]
    v_mfma_f32_16x16x32_bf16 v[48:51], a[104:107], a[32:35], v[48:51]
    v_mfma_f32_16x16x32_bf16 v[52:55], a[104:107], a[36:39], v[52:55]
    s_mov_b32 s83, 1605632
    s_add_u32 m0, s3, 57344
    v_mfma_f32_16x16x32_bf16 v[64:67], a[104:107], a[40:43], v[64:67]
    buffer_load_dwordx4 v17, s[48:51], s83 offen lds
    v_mfma_f32_16x16x32_bf16 v[68:71], a[104:107], a[44:47], v[68:71]
    v_mfma_f32_16x16x32_bf16 v[80:83], a[104:107], a[48:51], v[80:83]
    v_mfma_f32_16x16x32_bf16 v[84:87], a[104:107], a[52:55], v[84:87]
    v_mfma_f32_16x16x32_bf16 v[96:99], a[104:107], a[56:59], v[96:99]
    buffer_load_dwordx4 v18, s[48:51], s83 offen offset:1024 lds
    v_mfma_f32_16x16x32_bf16 v[100:103], a[104:107], a[60:63], v[100:103]
    v_mfma_f32_16x16x32_bf16 v[56:59], a[108:111], a[32:35], v[56:59]
    v_mfma_f32_16x16x32_bf16 v[60:63], a[108:111], a[36:39], v[60:63]
    v_mfma_f32_16x16x32_bf16 v[72:75], a[108:111], a[40:43], v[72:75]
    v_mfma_f32_16x16x32_bf16 v[76:79], a[108:111], a[44:47], v[76:79]
    v_mfma_f32_16x16x32_bf16 v[88:91], a[108:111], a[48:51], v[88:91]
    v_mfma_f32_16x16x32_bf16 v[92:95], a[108:111], a[52:55], v[92:95]
    v_mfma_f32_16x16x32_bf16 v[104:107], a[108:111], a[56:59], v[104:107]
    v_mfma_f32_16x16x32_bf16 v[108:111], a[108:111], a[60:63], v[108:111]
L_epi:
    v_pk_mul_f32 v[34:35], v[128:129], v[128:129]
    v_pk_mul_f32 v[36:37], v[130:131], v[130:131]
    v_pk_mul_f32 v[38:39], v[132:133], v[132:133]
    v_pk_mul_f32 v[40:41], v[134:135], v[134:135]
    v_pk_fma_f32 v[34:35], v[34:35], s[94:95], v[26:27]
    v_pk_fma_f32 v[36:37], v[36:37], s[94:95], v[26:27]
    v_pk_fma_f32 v[38:39], v[38:39], s[94:95], v[26:27]
    v_pk_fma_f32 v[40:41], v[40:41], s[94:95], v[26:27]
    v_pk_mul_f32 v[34:35], v[34:35], v[128:129]
    v_pk_mul_f32 v[36:37], v[36:37], v[130:131]
    v_pk_mul_f32 v[38:39], v[38:39], v[132:133]
    v_pk_mul_f32 v[40:41], v[40:41], v[134:135]
    v_exp_f32 v34, v34
    v_exp_f32 v35, v35
    v_exp_f32 v36, v36
    v_exp_f32 v37, v37
    v_exp_f32 v38, v38
    v_exp_f32 v39, v39
    v_exp_f32 v40, v40
    v_exp_f32 v41, v41
    v_pk_mul_f32 v[136:137], v[136:137], v[128:129]
    v_pk_mul_f32 v[138:139], v[138:139], v[130:131]
    v_pk_mul_f32 v[140:141], v[140:141], v[132:133]
    v_pk_mul_f32 v[142:143], v[142:143], v[134:135]
    v_pk_add_f32 v[34:35], v[34:35], 1.0 op_sel_hi:[1,0]
    v_pk_add_f32 v[36:37], v[36:37], 1.0 op_sel_hi:[1,0]
    v_pk_add_f32 v[38:39], v[38:39], 1.0 op_sel_hi:[1,0]
    v_pk_add_f32 v[40:41], v[40:41], 1.0 op_sel_hi:[1,0]
    v_rcp_f32 v34, v34
    v_rcp_f32 v35, v35
    v_rcp_f32 v36, v36
    v_rcp_f32 v37, v37
    v_rcp_f32 v38, v38
    v_rcp_f32 v39, v39
    v_rcp_f32 v40, v40
    v_rcp_f32 v41, v41
    v_pk_mul_f32 v[136:137], v[136:137], v[34:35]
    v_pk_mul_f32 v[138:139], v[138:139], v[36:37]
    v_pk_mul_f32 v[140:141], v[140:141], v[38:39]
    v_pk_mul_f32 v[142:143], v[142:143], v[40:41]
    v_cvt_pk_bf16_f32 v128, v136, v137
    v_cvt_pk_bf16_f32 v129, v138, v139
    v_cvt_pk_bf16_f32 v130, v140, v141
    v_cvt_pk_bf16_f32 v131, v142, v143
    buffer_store_dwordx4 v[128:131], v16, s[56:59], s88 offen offset:0 sc1
    v_pk_mul_f32 v[34:35], v[144:145], v[144:145]
    v_pk_mul_f32 v[36:37], v[146:147], v[146:147]
    v_pk_mul_f32 v[38:39], v[148:149], v[148:149]
    v_pk_mul_f32 v[40:41], v[150:151], v[150:151]
    v_pk_fma_f32 v[34:35], v[34:35], s[94:95], v[26:27]
    v_pk_fma_f32 v[36:37], v[36:37], s[94:95], v[26:27]
    v_pk_fma_f32 v[38:39], v[38:39], s[94:95], v[26:27]
    v_pk_fma_f32 v[40:41], v[40:41], s[94:95], v[26:27]
    v_pk_mul_f32 v[34:35], v[34:35], v[144:145]
    v_pk_mul_f32 v[36:37], v[36:37], v[146:147]
    v_pk_mul_f32 v[38:39], v[38:39], v[148:149]
    v_pk_mul_f32 v[40:41], v[40:41], v[150:151]
    v_exp_f32 v34, v34
    v_exp_f32 v35, v35
    v_exp_f32 v36, v36
    v_exp_f32 v37, v37
    v_exp_f32 v38, v38
    v_exp_f32 v39, v39
    v_exp_f32 v40, v40
    v_exp_f32 v41, v41
    v_pk_mul_f32 v[152:153], v[152:153], v[144:145]
    v_pk_mul_f32 v[154:155], v[154:155], v[146:147]
    v_pk_mul_f32 v[156:157], v[156:157], v[148:149]
    v_pk_mul_f32 v[158:159], v[158:159], v[150:151]
    v_pk_add_f32 v[34:35], v[34:35], 1.0 op_sel_hi:[1,0]
    v_pk_add_f32 v[36:37], v[36:37], 1.0 op_sel_hi:[1,0]
    v_pk_add_f32 v[38:39], v[38:39], 1.0 op_sel_hi:[1,0]
    v_pk_add_f32 v[40:41], v[40:41], 1.0 op_sel_hi:[1,0]
    v_rcp_f32 v34, v34
    v_rcp_f32 v35, v35
    v_rcp_f32 v36, v36
    v_rcp_f32 v37, v37
    v_rcp_f32 v38, v38
    v_rcp_f32 v39, v39
    v_rcp_f32 v40, v40
    v_rcp_f32 v41, v41
    v_pk_mul_f32 v[152:153], v[152:153], v[34:35]
    v_pk_mul_f32 v[154:155], v[154:155], v[36:37]
    v_pk_mul_f32 v[156:157], v[156:157], v[38:39]
    v_pk_mul_f32 v[158:159], v[158:159], v[40:41]
    v_cvt_pk_bf16_f32 v144, v152, v153
    v_cvt_pk_bf16_f32 v145, v154, v155
    v_cvt_pk_bf16_f32 v146, v156, v157
    v_cvt_pk_bf16_f32 v147, v158, v159
    buffer_store_dwordx4 v[144:147], v16, s[56:59], s88 offen offset:1024 sc1
    v_pk_mul_f32 v[34:35], v[160:161], v[160:161]
    v_pk_mul_f32 v[36:37], v[162:163], v[162:163]
    v_pk_mul_f32 v[38:39], v[164:165], v[164:165]
    v_pk_mul_f32 v[40:41], v[166:167], v[166:167]
    v_pk_fma_f32 v[34:35], v[34:35], s[94:95], v[26:27]
    v_pk_fma_f32 v[36:37], v[36:37], s[94:95], v[26:27]
    v_pk_fma_f32 v[38:39], v[38:39], s[94:95], v[26:27]
    v_pk_fma_f32 v[40:41], v[40:41], s[94:95], v[26:27]
    v_pk_mul_f32 v[34:35], v[34:35], v[160:161]
    v_pk_mul_f32 v[36:37], v[36:37], v[162:163]
    v_pk_mul_f32 v[38:39], v[38:39], v[164:165]
    v_pk_mul_f32 v[40:41], v[40:41], v[166:167]
    v_exp_f32 v34, v34
    v_exp_f32 v35, v35
    v_exp_f32 v36, v36
    v_exp_f32 v37, v37
    v_exp_f32 v38, v38
    v_exp_f32 v39, v39
    v_exp_f32 v40, v40
    v_exp_f32 v41, v41
    v_pk_mul_f32 v[168:169], v[168:169], v[160:161]
    v_pk_mul_f32 v[170:171], v[170:171], v[162:163]
    v_pk_mul_f32 v[172:173], v[172:173], v[164:165]
    v_pk_mul_f32 v[174:175], v[174:175], v[166:167]
    v_pk_add_f32 v[34:35], v[34:35], 1.0 op_sel_hi:[1,0]
    v_pk_add_f32 v[36:37], v[36:37], 1.0 op_sel_hi:[1,0]
    v_pk_add_f32 v[38:39], v[38:39], 1.0 op_sel_hi:[1,0]
    v_pk_add_f32 v[40:41], v[40:41], 1.0 op_sel_hi:[1,0]
    v_rcp_f32 v34, v34
    v_rcp_f32 v35, v35
    v_rcp_f32 v36, v36
    v_rcp_f32 v37, v37
    v_rcp_f32 v38, v38
    v_rcp_f32 v39, v39
    v_rcp_f32 v40, v40
    v_rcp_f32 v41, v41
    v_pk_mul_f32 v[168:169], v[168:169], v[34:35]
    v_pk_mul_f32 v[170:171], v[170:171], v[36:37]
    v_pk_mul_f32 v[172:173], v[172:173], v[38:39]
    v_pk_mul_f32 v[174:175], v[174:175], v[40:41]
    v_cvt_pk_bf16_f32 v160, v168, v169
    v_cvt_pk_bf16_f32 v161, v170, v171
    v_cvt_pk_bf16_f32 v162, v172, v173
    v_cvt_pk_bf16_f32 v163, v174, v175
    buffer_store_dwordx4 v[160:163], v16, s[56:59], s88 offen offset:2048 sc1
    v_pk_mul_f32 v[34:35], v[176:177], v[176:177]
    v_pk_mul_f32 v[36:37], v[178:179], v[178:179]
    v_pk_mul_f32 v[38:39], v[180:181], v[180:181]
    v_pk_mul_f32 v[40:41], v[182:183], v[182:183]
    v_pk_fma_f32 v[34:35], v[34:35], s[94:95], v[26:27]
    v_pk_fma_f32 v[36:37], v[36:37], s[94:95], v[26:27]
    v_pk_fma_f32 v[38:39], v[38:39], s[94:95], v[26:27]
    v_pk_fma_f32 v[40:41], v[40:41], s[94:95], v[26:27]
    v_pk_mul_f32 v[34:35], v[34:35], v[176:177]
    v_pk_mul_f32 v[36:37], v[36:37], v[178:179]
    v_pk_mul_f32 v[38:39], v[38:39], v[180:181]
    v_pk_mul_f32 v[40:41], v[40:41], v[182:183]
    v_exp_f32 v34, v34
    v_exp_f32 v35, v35
    v_exp_f32 v36, v36
    v_exp_f32 v37, v37
    v_exp_f32 v38, v38
    v_exp_f32 v39, v39
    v_exp_f32 v40, v40
    v_exp_f32 v41, v41
    v_pk_mul_f32 v[184:185], v[184:185], v[176:177]
    v_pk_mul_f32 v[186:187], v[186:187], v[178:179]
    v_pk_mul_f32 v[188:189], v[188:189], v[180:181]
    v_pk_mul_f32 v[190:191], v[190:191], v[182:183]
    v_pk_add_f32 v[34:35], v[34:35], 1.0 op_sel_hi:[1,0]
    v_pk_add_f32 v[36:37], v[36:37], 1.0 op_sel_hi:[1,0]
    v_pk_add_f32 v[38:39], v[38:39], 1.0 op_sel_hi:[1,0]
    v_pk_add_f32 v[40:41], v[40:41], 1.0 op_sel_hi:[1,0]
    v_rcp_f32 v34, v34
    v_rcp_f32 v35, v35
    v_rcp_f32 v36, v36
    v_rcp_f32 v37, v37
    v_rcp_f32 v38, v38
    v_rcp_f32 v39, v39
    v_rcp_f32 v40, v40
    v_rcp_f32 v41, v41
    v_pk_mul_f32 v[184:185], v[184:185], v[34:35]
    v_pk_mul_f32 v[186:187], v[186:187], v[36:37]
    v_pk_mul_f32 v[188:189], v[188:189], v[38:39]
    v_pk_mul_f32 v[190:191], v[190:191], v[40:41]
    v_cvt_pk_bf16_f32 v176, v184, v185
    v_cvt_pk_bf16_f32 v177, v186, v187
    v_cvt_pk_bf16_f32 v178, v188, v189
    v_cvt_pk_bf16_f32 v179, v190, v191
    buffer_store_dwordx4 v[176:179], v16, s[56:59], s88 offen offset:3072 sc1
    v_pk_mul_f32 v[34:35], v[192:193], v[192:193]
    v_pk_mul_f32 v[36:37], v[194:195], v[194:195]
    v_pk_mul_f32 v[38:39], v[196:197], v[196:197]
    v_pk_mul_f32 v[40:41], v[198:199], v[198:199]
    v_pk_fma_f32 v[34:35], v[34:35], s[94:95], v[26:27]
    v_pk_fma_f32 v[36:37], v[36:37], s[94:95], v[26:27]
    v_pk_fma_f32 v[38:39], v[38:39], s[94:95], v[26:27]
    v_pk_fma_f32 v[40:41], v[40:41], s[94:95], v[26:27]
    v_pk_mul_f32 v[34:35], v[34:35], v[192:193]
    v_pk_mul_f32 v[36:37], v[36:37], v[194:195]
    v_pk_mul_f32 v[38:39], v[38:39], v[196:197]
    v_pk_mul_f32 v[40:41], v[40:41], v[198:199]
    v_exp_f32 v34, v34
    v_exp_f32 v35, v35
    v_exp_f32 v36, v36
    v_exp_f32 v37, v37
    v_exp_f32 v38, v38
    v_exp_f32 v39, v39
    v_exp_f32 v40, v40
    v_exp_f32 v41, v41
    v_pk_mul_f32 v[200:201], v[200:201], v[192:193]
    v_pk_mul_f32 v[202:203], v[202:203], v[194:195]
    v_pk_mul_f32 v[204:205], v[204:205], v[196:197]
    v_pk_mul_f32 v[206:207], v[206:207], v[198:199]
    v_pk_add_f32 v[34:35], v[34:35], 1.0 op_sel_hi:[1,0]
    v_pk_add_f32 v[36:37], v[36:37], 1.0 op_sel_hi:[1,0]
    v_pk_add_f32 v[38:39], v[38:39], 1.0 op_sel_hi:[1,0]
    v_pk_add_f32 v[40:41], v[40:41], 1.0 op_sel_hi:[1,0]
    v_rcp_f32 v34, v34
    v_rcp_f32 v35, v35
    v_rcp_f32 v36, v36
    v_rcp_f32 v37, v37
    v_rcp_f32 v38, v38
    v_rcp_f32 v39, v39
    v_rcp_f32 v40, v40
    v_rcp_f32 v41, v41
    v_pk_mul_f32 v[200:201], v[200:201], v[34:35]
    v_pk_mul_f32 v[202:203], v[202:203], v[36:37]
    v_pk_mul_f32 v[204:205], v[204:205], v[38:39]
    v_pk_mul_f32 v[206:207], v[206:207], v[40:41]
    v_cvt_pk_bf16_f32 v192, v200, v201
    v_cvt_pk_bf16_f32 v193, v202, v203
    v_cvt_pk_bf16_f32 v194, v204, v205
    v_cvt_pk_bf16_f32 v195, v206, v207
    s_add_u32 s88, s88, 4096
    buffer_store_dwordx4 v[192:195], v16, s[56:59], s88 offen offset:0 sc1
    v_pk_mul_f32 v[34:35], v[208:209], v[208:209]
    v_pk_mul_f32 v[36:37], v[210:211], v[210:211]
    v_pk_mul_f32 v[38:39], v[212:213], v[212:213]
    v_pk_mul_f32 v[40:41], v[214:215], v[214:215]
    v_pk_fma_f32 v[34:35], v[34:35], s[94:95], v[26:27]
    v_pk_fma_f32 v[36:37], v[36:37], s[94:95], v[26:27]
    v_pk_fma_f32 v[38:39], v[38:39], s[94:95], v[26:27]
    v_pk_fma_f32 v[40:41], v[40:41], s[94:95], v[26:27]
    v_pk_mul_f32 v[34:35], v[34:35], v[208:209]
    v_pk_mul_f32 v[36:37], v[36:37], v[210:211]
    v_pk_mul_f32 v[38:39], v[38:39], v[212:213]
    v_pk_mul_f32 v[40:41], v[40:41], v[214:215]
    v_exp_f32 v34, v34
    v_exp_f32 v35, v35
    v_exp_f32 v36, v36
    v_exp_f32 v37, v37
    v_exp_f32 v38, v38
    v_exp_f32 v39, v39
    v_exp_f32 v40, v40
    v_exp_f32 v41, v41
    v_pk_mul_f32 v[216:217], v[216:217], v[208:209]
    v_pk_mul_f32 v[218:219], v[218:219], v[210:211]
    v_pk_mul_f32 v[220:221], v[220:221], v[212:213]
    v_pk_mul_f32 v[222:223], v[222:223], v[214:215]
    v_pk_add_f32 v[34:35], v[34:35], 1.0 op_sel_hi:[1,0]
    v_pk_add_f32 v[36:37], v[36:37], 1.0 op_sel_hi:[1,0]
    v_pk_add_f32 v[38:39], v[38:39], 1.0 op_sel_hi:[1,0]
    v_pk_add_f32 v[40:41], v[40:41], 1.0 op_sel_hi:[1,0]
    v_rcp_f32 v34, v34
    v_rcp_f32 v35, v35
    v_rcp_f32 v36, v36
    v_rcp_f32 v37, v37
    v_rcp_f32 v38, v38
    v_rcp_f32 v39, v39
    v_rcp_f32 v40, v40
    v_rcp_f32 v41, v41
    v_pk_mul_f32 v[216:217], v[216:217], v[34:35]
    v_pk_mul_f32 v[218:219], v[218:219], v[36:37]
    v_pk_mul_f32 v[220:221], v[220:221], v[38:39]
    v_pk_mul_f32 v[222:223], v[222:223], v[40:41]
    v_cvt_pk_bf16_f32 v208, v216, v217
    v_cvt_pk_bf16_f32 v209, v218, v219
    v_cvt_pk_bf16_f32 v210, v220, v221
    v_cvt_pk_bf16_f32 v211, v222, v223
    buffer_store_dwordx4 v[208:211], v16, s[56:59], s88 offen offset:1024 sc1
    v_pk_mul_f32 v[34:35], v[224:225], v[224:225]
    v_pk_mul_f32 v[36:37], v[226:227], v[226:227]
    v_pk_mul_f32 v[38:39], v[228:229], v[228:229]
    v_pk_mul_f32 v[40:41], v[230:231], v[230:231]
    v_pk_fma_f32 v[34:35], v[34:35], s[94:95], v[26:27]
    v_pk_fma_f32 v[36:37], v[36:37], s[94:95], v[26:27]
    v_pk_fma_f32 v[38:39], v[38:39], s[94:95], v[26:27]
    v_pk_fma_f32 v[40:41], v[40:41], s[94:95], v[26:27]
    v_pk_mul_f32 v[34:35], v[34:35], v[224:225]
    v_pk_mul_f32 v[36:37], v[36:37], v[226:227]
    v_pk_mul_f32 v[38:39], v[38:39], v[228:229]
    v_pk_mul_f32 v[40:41], v[40:41], v[230:231]
    v_exp_f32 v34, v34
    v_exp_f32 v35, v35
    v_exp_f32 v36, v36
    v_exp_f32 v37, v37
    v_exp_f32 v38, v38
    v_exp_f32 v39, v39
    v_exp_f32 v40, v40
    v_exp_f32 v41, v41
    v_pk_mul_f32 v[232:233], v[232:233], v[224:225]
    v_pk_mul_f32 v[234:235], v[234:235], v[226:227]
    v_pk_mul_f32 v[236:237], v[236:237], v[228:229]
    v_pk_mul_f32 v[238:239], v[238:239], v[230:231]
    v_pk_add_f32 v[34:35], v[34:35], 1.0 op_sel_hi:[1,0]
    v_pk_add_f32 v[36:37], v[36:37], 1.0 op_sel_hi:[1,0]
    v_pk_add_f32 v[38:39], v[38:39], 1.0 op_sel_hi:[1,0]
    v_pk_add_f32 v[40:41], v[40:41], 1.0 op_sel_hi:[1,0]
    v_rcp_f32 v34, v34
    v_rcp_f32 v35, v35
    v_rcp_f32 v36, v36
    v_rcp_f32 v37, v37
    v_rcp_f32 v38, v38
    v_rcp_f32 v39, v39
    v_rcp_f32 v40, v40
    v_rcp_f32 v41, v41
    v_pk_mul_f32 v[232:233], v[232:233], v[34:35]
    v_pk_mul_f32 v[234:235], v[234:235], v[36:37]
    v_pk_mul_f32 v[236:237], v[236:237], v[38:39]
    v_pk_mul_f32 v[238:239], v[238:239], v[40:41]
    v_cvt_pk_bf16_f32 v224, v232, v233
    v_cvt_pk_bf16_f32 v225, v234, v235
    v_cvt_pk_bf16_f32 v226, v236, v237
    v_cvt_pk_bf16_f32 v227, v238, v239
    buffer_store_dwordx4 v[224:227], v16, s[56:59], s88 offen offset:2048 sc1
    v_pk_mul_f32 v[34:35], v[240:241], v[240:241]
    v_pk_mul_f32 v[36:37], v[242:243], v[242:243]
    v_pk_mul_f32 v[38:39], v[244:245], v[244:245]
    v_pk_mul_f32 v[40:41], v[246:247], v[246:247]
    v_pk_fma_f32 v[34:35], v[34:35], s[94:95], v[26:27]
    v_pk_fma_f32 v[36:37], v[36:37], s[94:95], v[26:27]
    v_pk_fma_f32 v[38:39], v[38:39], s[94:95], v[26:27]
    v_pk_fma_f32 v[40:41], v[40:41], s[94:95], v[26:27]
    v_pk_mul_f32 v[34:35], v[34:35], v[240:241]
    v_pk_mul_f32 v[36:37], v[36:37], v[242:243]
    v_pk_mul_f32 v[38:39], v[38:39], v[244:245]
    v_pk_mul_f32 v[40:41], v[40:41], v[246:247]
    v_exp_f32 v34, v34
    v_exp_f32 v35, v35
    v_exp_f32 v36, v36
    v_exp_f32 v37, v37
    v_exp_f32 v38, v38
    v_exp_f32 v39, v39
    v_exp_f32 v40, v40
    v_exp_f32 v41, v41
    v_pk_mul_f32 v[248:249], v[248:249], v[240:241]
    v_pk_mul_f32 v[250:251], v[250:251], v[242:243]
    v_pk_mul_f32 v[252:253], v[252:253], v[244:245]
    v_pk_mul_f32 v[254:255], v[254:255], v[246:247]
    v_pk_add_f32 v[34:35], v[34:35], 1.0 op_sel_hi:[1,0]
    v_pk_add_f32 v[36:37], v[36:37], 1.0 op_sel_hi:[1,0]
    v_pk_add_f32 v[38:39], v[38:39], 1.0 op_sel_hi:[1,0]
    v_pk_add_f32 v[40:41], v[40:41], 1.0 op_sel_hi:[1,0]
    v_rcp_f32 v34, v34
    v_rcp_f32 v35, v35
    v_rcp_f32 v36, v36
    v_rcp_f32 v37, v37
    v_rcp_f32 v38, v38
    v_rcp_f32 v39, v39
    v_rcp_f32 v40, v40
    v_rcp_f32 v41, v41
    v_pk_mul_f32 v[248:249], v[248:249], v[34:35]
    v_pk_mul_f32 v[250:251], v[250:251], v[36:37]
    v_pk_mul_f32 v[252:253], v[252:253], v[38:39]
    v_pk_mul_f32 v[254:255], v[254:255], v[40:41]
    v_cvt_pk_bf16_f32 v240, v248, v249
    v_cvt_pk_bf16_f32 v241, v250, v251
    v_cvt_pk_bf16_f32 v242, v252, v253
    v_cvt_pk_bf16_f32 v243, v254, v255
    buffer_store_dwordx4 v[240:243], v16, s[56:59], s88 offen offset:3072 sc1
    s_cmp_eq_u32 s62, 1
    s_cbranch_scc1 L_epi1
    v_mov_b32 v244, 0xce6e6b28
    v_cvt_pk_bf16_f32 v128, v120, v121
    v_cvt_pk_bf16_f32 v129, v122, v123
    v_cvt_pk_bf16_f32 v130, v124, v125
    v_cvt_pk_bf16_f32 v131, v126, v127
    v_accvgpr_read_b32 v34, a128
    v_accvgpr_read_b32 v35, a129
    v_accvgpr_read_b32 v36, a130
    v_accvgpr_read_b32 v37, a131
    v_accvgpr_read_b32 v38, a132
    v_accvgpr_read_b32 v39, a133
    v_accvgpr_read_b32 v40, a134
    v_accvgpr_read_b32 v41, a135
    v_cvt_pk_bf16_f32 v132, v34, v35
    s_mov_b32 s82, 65536
    s_add_u32 m0, s3, 65536
    s_nop 0
    buffer_load_dwordx4 v17, s[48:51], s82 offen lds
    buffer_load_dwordx4 v18, s[48:51], s82 offen offset:1024 lds
    v_cvt_pk_bf16_f32 v133, v36, v37
    v_cvt_pk_bf16_f32 v134, v38, v39
    v_cvt_pk_bf16_f32 v135, v40, v41
    v_accvgpr_read_b32 v246, a192
    v_accvgpr_read_b32 v247, a193
    v_accvgpr_read_b32 v248, a194
    v_accvgpr_read_b32 v249, a195
    v_accvgpr_read_b32 v250, a196
    v_accvgpr_read_b32 v251, a197
    v_accvgpr_read_b32 v252, a198
    v_accvgpr_read_b32 v253, a199
    v_cvt_pk_bf16_f32 v164, v246, v247
    v_cvt_pk_bf16_f32 v165, v248, v249
    v_cvt_pk_bf16_f32 v166, v250, v251
    v_cvt_pk_bf16_f32 v167, v252, v253
    v_accvgpr_read_b32 v34, a136
    v_accvgpr_read_b32 v35, a137
    v_accvgpr_read_b32 v36, a138
    v_accvgpr_read_b32 v37, a139
    v_accvgpr_read_b32 v38, a140
    v_accvgpr_read_b32 v39, a141
    v_accvgpr_read_b32 v40, a142
    s_mov_b32 s83, 294912
    s_add_u32 m0, s3, 73728
    s_nop 0
    buffer_load_dwordx4 v17, s[48:51], s83 offen lds
    buffer_load_dwordx4 v18, s[48:51], s83 offen offset:1024 lds
    v_accvgpr_read_b32 v41, a143
    v_cvt_pk_bf16_f32 v136, v34, v35
    v_cvt_pk_bf16_f32 v137, v36, v37
    v_cvt_pk_bf16_f32 v138, v38, v39
    v_cvt_pk_bf16_f32 v139, v40, v41
    v_accvgpr_read_b32 v246, a200
    v_accvgpr_read_b32 v247, a201
    v_accvgpr_read_b32 v248, a202
    v_accvgpr_read_b32 v249, a203
    v_accvgpr_read_b32 v250, a204
    v_accvgpr_read_b32 v251, a205
    v_accvgpr_read_b32 v252, a206
    v_accvgpr_read_b32 v253, a207
    v_cvt_pk_bf16_f32 v168, v246, v247
    v_cvt_pk_bf16_f32 v169, v248, v249
    v_cvt_pk_bf16_f32 v170, v250, v251
    v_cvt_pk_bf16_f32 v171, v252, v253
    v_accvgpr_read_b32 v34, a144
    v_accvgpr_read_b32 v35, a145
    v_accvgpr_read_b32 v36, a146
    v_accvgpr_read_b32 v37, a147
    v_accvgpr_read_b32 v38, a148
    s_mov_b32 s82, 524288
    s_add_u32 m0, s3, 81920
    s_nop 0
    buffer_load_dwordx4 v17, s[48:51], s82 offen lds
    buffer_load_dwordx4 v18, s[48:51], s82 offen offset:1024 lds
    v_accvgpr_read_b32 v39, a149
    v_accvgpr_read_b32 v40, a150
    v_accvgpr_read_b32 v41, a151
    v_cvt_pk_bf16_f32 v140, v34, v35
    v_cvt_pk_bf16_f32 v141, v36, v37
    v_cvt_pk_bf16_f32 v142, v38, v39
    v_cvt_pk_bf16_f32 v143, v40, v41
    v_accvgpr_read_b32 v246, a208
    v_accvgpr_read_b32 v247, a209
    v_accvgpr_read_b32 v248, a210
    v_accvgpr_read_b32 v249, a211
    v_accvgpr_read_b32 v250, a212
    v_accvgpr_read_b32 v251, a213
    v_accvgpr_read_b32 v252, a214
    v_accvgpr_read_b32 v253, a215
    v_cvt_pk_bf16_f32 v172, v246, v247
    v_cvt_pk_bf16_f32 v173, v248, v249
    v_cvt_pk_bf16_f32 v174, v250, v251
    v_cvt_pk_bf16_f32 v175, v252, v253
    v_accvgpr_read_b32 v34, a152
    v_accvgpr_read_b32 v35, a153
    v_accvgpr_read_b32 v36, a154
    s_mov_b32 s83, 753664
    s_add_u32 m0, s3, 90112
    s_nop 0
    buffer_load_dwordx4 v17, s[48:51], s83 offen lds
    buffer_load_dwordx4 v18, s[48:51], s83 offen offset:1024 lds
    v_accvgpr_read_b32 v37, a155
    v_accvgpr_read_b32 v38, a156
    v_accvgpr_read_b32 v39, a157
    v_accvgpr_read_b32 v40, a158
    v_accvgpr_read_b32 v41, a159
    v_cvt_pk_bf16_f32 v144, v34, v35
    v_cvt_pk_bf16_f32 v145, v36, v37
    v_cvt_pk_bf16_f32 v146, v38, v39
    v_cvt_pk_bf16_f32 v147, v40, v41
    v_accvgpr_read_b32 v246, a216
    v_accvgpr_read_b32 v247, a217
    v_accvgpr_read_b32 v248, a218
    v_accvgpr_read_b32 v249, a219
    v_accvgpr_read_b32 v250, a220
    v_accvgpr_read_b32 v251, a221
    v_accvgpr_read_b32 v252, a222
    v_accvgpr_read_b32 v253, a223
    v_cvt_pk_bf16_f32 v176, v246, v247
    v_cvt_pk_bf16_f32 v177, v248, v249
    v_cvt_pk_bf16_f32 v178, v250, v251
    v_cvt_pk_bf16_f32 v179, v252, v253
    v_mfma_f32_16x16x32_bf16 v[196:199], v[128:131], v[164:167], 0
    v_mfma_f32_16x16x32_bf16 v[200:203], v[132:135], v[164:167], 0
    v_mfma_f32_16x16x32_bf16 v[204:207], v[132:135], v[168:171], 0
    v_mfma_f32_16x16x32_bf16 v[208:211], v[136:139], v[168:171], 0
    v_mfma_f32_16x16x32_bf16 v[212:215], v[136:139], v[172:175], 0
    v_mfma_f32_16x16x32_bf16 v[216:219], v[140:143], v[172:175], 0
    v_mfma_f32_16x16x32_bf16 v[220:223], v[140:143], v[176:179], 0
    v_mfma_f32_16x16x32_bf16 v[224:227], v[144:147], v[176:179], 0
    s_waitcnt vmcnt(8)
    s_mov_b64 exec, 1
    buffer_atomic_add v25, off, s[56:59], s92 sc1
    s_mov_b64 exec, -1
    v_cvt_pk_bf16_f32 v48, v48, v49
    v_cvt_pk_bf16_f32 v49, v50, v51
    v_cvt_pk_bf16_f32 v84, v84, v85
    v_cvt_pk_bf16_f32 v85, v86, v87
    v_cvt_pk_bf16_f32 v50, v52, v53
    v_cvt_pk_bf16_f32 v51, v54, v55
    v_cvt_pk_bf16_f32 v86, v88, v89
    v_cvt_pk_bf16_f32 v87, v90, v91
    v_cvt_pk_bf16_f32 v52, v56, v57
    v_cvt_pk_bf16_f32 v53, v58, v59
    v_cvt_pk_bf16_f32 v88, v92, v93
    v_cvt_pk_bf16_f32 v89, v94, v95
    v_cvt_pk_bf16_f32 v54, v60, v61
    v_cvt_pk_bf16_f32 v55, v62, v63
    v_cvt_pk_bf16_f32 v90, v96, v97
    v_cvt_pk_bf16_f32 v91, v98, v99
    v_cvt_pk_bf16_f32 v56, v64, v65
    v_cvt_pk_bf16_f32 v57, v66, v67
    v_cvt_pk_bf16_f32 v92, v100, v101
    v_cvt_pk_bf16_f32 v93, v102, v103
    v_cvt_pk_bf16_f32 v58, v68, v69
    v_cvt_pk_bf16_f32 v59, v70, v71
    v_cvt_pk_bf16_f32 v94, v104, v105
    v_cvt_pk_bf16_f32 v95, v106, v107
    v_cvt_pk_bf16_f32 v60, v72, v73
    v_cvt_pk_bf16_f32 v61, v74, v75
    v_cvt_pk_bf16_f32 v96, v108, v109
    v_cvt_pk_bf16_f32 v97, v110, v111
    v_cvt_pk_bf16_f32 v62, v76, v77
    v_cvt_pk_bf16_f32 v63, v78, v79
    v_cvt_pk_bf16_f32 v98, v112, v113
    v_cvt_pk_bf16_f32 v99, v114, v115
    v_cvt_pk_bf16_f32 v64, v80, v81
    v_cvt_pk_bf16_f32 v65, v82, v83
    v_cvt_pk_bf16_f32 v100, v116, v117
    v_cvt_pk_bf16_f32 v101, v118, v119
    v_cvt_pk_bf16_f32 v196, v196, v197
    s_mov_b32 s82, 983040
    s_add_u32 m0, s3, 98304
    s_nop 0
    buffer_load_dwordx4 v17, s[48:51], s82 offen lds
    buffer_load_dwordx4 v18, s[48:51], s82 offen offset:1024 lds
    v_cvt_pk_bf16_f32 v198, v198, v199
    v_cvt_pk_bf16_f32 v200, v200, v201
    v_cvt_pk_bf16_f32 v202, v202, v203
    v_cvt_pk_bf16_f32 v204, v204, v205
    v_cvt_pk_bf16_f32 v206, v206, v207
    v_cvt_pk_bf16_f32 v208, v208, v209
    v_cvt_pk_bf16_f32 v210, v210, v211
    v_cvt_pk_bf16_f32 v212, v212, v213
    v_cvt_pk_bf16_f32 v214, v214, v215
    v_cvt_pk_bf16_f32 v216, v216, v217
    v_cvt_pk_bf16_f32 v218, v218, v219
    v_cvt_pk_bf16_f32 v220, v220, v221
    v_cvt_pk_bf16_f32 v222, v222, v223
    v_cvt_pk_bf16_f32 v224, v224, v225
    v_cvt_pk_bf16_f32 v226, v226, v227
    v_perm_b32 v228, v200, v196, v28
    v_perm_b32 v229, v202, v198, v29
    v_perm_b32 v230, v208, v204, v28
    v_perm_b32 v231, v210, v206, v29
    v_perm_b32 v232, v216, v212, v28
    v_perm_b32 v233, v218, v214, v29
    v_perm_b32 v234, v224, v220, v28
    v_perm_b32 v235, v226, v222, v29
    v_pk_mul_f32 v[228:229], v[228:229], s[14:15]
    v_pk_mul_f32 v[230:231], v[230:231], s[14:15]
    v_pk_mul_f32 v[232:233], v[232:233], s[14:15]
    v_pk_mul_f32 v[234:235], v[234:235], s[14:15]
    v_cvt_pk_bf16_f32 v229, v228, v229
    s_mov_b32 s83, 1212416
    s_add_u32 m0, s3, 106496
    s_nop 0
    buffer_load_dwordx4 v17, s[48:51], s83 offen lds
    buffer_load_dwordx4 v18, s[48:51], s83 offen offset:1024 lds
    v_cvt_pk_bf16_f32 v231, v230, v231
    v_cvt_pk_bf16_f32 v233, v232, v233
    v_cvt_pk_bf16_f32 v235, v234, v235
    v_lshlrev_b32 v228, 16, v229
    v_and_b32 v229, 0xffff0000, v229
    v_lshlrev_b32 v230, 16, v231
    v_and_b32 v231, 0xffff0000, v231
    v_lshlrev_b32 v232, 16, v233
    v_and_b32 v233, 0xffff0000, v233
    v_lshlrev_b32 v234, 16, v235
    v_and_b32 v235, 0xffff0000, v235
    v_cndmask_b32 v228, v244, v228, s[4:5]
    v_cndmask_b32 v229, v244, v229, s[6:7]
    v_max_f32 v236, v228, v229
    v_max_f32 v238, v230, v231
    v_max_f32 v240, v232, v233
    v_max_f32 v242, v234, v235
    v_permlane16_swap_b32 v236, v238
    s_nop 0
    v_permlane16_swap_b32 v240, v242
    v_max_f32 v236, v236, v238
    v_max_f32 v240, v240, v242
    s_nop 1
    v_permlane32_swap_b32 v236, v240
    v_max_f32 v236, v236, v240
    v_mul_f32 v236, 0xbfb8aa3b, v236
    v_mov_b32 v240, v236
    s_nop 1
    v_permlane32_swap_b32 v236, v240
    v_mov_b32 v238, v236
    v_mov_b32 v242, v240
    s_mov_b32 s82, 1441792
    s_add_u32 m0, s3, 114688
    s_nop 0
    buffer_load_dwordx4 v17, s[48:51], s82 offen lds
    buffer_load_dwordx4 v18, s[48:51], s82 offen offset:1024 lds
    v_permlane16_swap_b32 v236, v238
    v_permlane16_swap_b32 v240, v242
    v_pk_fma_f32 v[228:229], v[228:229], s[98:99], v[236:237] op_sel_hi:[1,1,0]
    v_pk_fma_f32 v[230:231], v[230:231], s[98:99], v[238:239] op_sel_hi:[1,1,0]
    v_pk_fma_f32 v[232:233], v[232:233], s[98:99], v[240:241] op_sel_hi:[1,1,0]
    v_pk_fma_f32 v[234:235], v[234:235], s[98:99], v[242:243] op_sel_hi:[1,1,0]
    v_exp_f32 v228, v228
    v_exp_f32 v229, v229
    v_exp_f32 v230, v230
    v_exp_f32 v231, v231
    v_exp_f32 v232, v232
    v_exp_f32 v233, v233
    v_exp_f32 v234, v234
    v_exp_f32 v235, v235
    v_add_f32 v236, v228, v229
    v_add_f32 v238, v230, v231
    v_add_f32 v240, v232, v233
    v_add_f32 v242, v234, v235
    v_permlane16_swap_b32 v236, v238
    s_nop 0
    v_permlane16_swap_b32 v240, v242
    v_add_f32 v236, v236, v238
    v_add_f32 v240, v240, v242
    s_nop 1
    v_permlane32_swap_b32 v236, v240
    v_add_f32 v236, v236, v240
    v_rcp_f32 v236, v236
    s_nop 0
    v_mov_b32 v240, v236
    s_nop 1
    v_permlane32_swap_b32 v236, v240
    v_mov_b32 v238, v236
    s_mov_b32 s83, 1671168
    s_add_u32 m0, s3, 122880
    s_nop 0
    buffer_load_dwordx4 v17, s[48:51], s83 offen lds
    buffer_load_dwordx4 v18, s[48:51], s83 offen offset:1024 lds
    v_mov_b32 v242, v240
    v_permlane16_swap_b32 v236, v238
    s_nop 0
    v_permlane16_swap_b32 v240, v242
    v_pk_mul_f32 v[228:229], v[228:229], v[236:237] op_sel_hi:[1,0]
    v_pk_mul_f32 v[230:231], v[230:231], v[238:239] op_sel_hi:[1,0]
    v_pk_mul_f32 v[232:233], v[232:233], v[240:241] op_sel_hi:[1,0]
    v_pk_mul_f32 v[234:235], v[234:235], v[242:243] op_sel_hi:[1,0]
    v_cvt_pk_bf16_f32 v228, v228, v229
    v_cvt_pk_bf16_f32 v230, v230, v231
    v_cvt_pk_bf16_f32 v232, v232, v233
    v_cvt_pk_bf16_f32 v234, v234, v235
    v_perm_b32 v164, v228, v228, v30
    v_perm_b32 v165, v228, v228, v31
    v_perm_b32 v166, v228, v228, v32
    v_perm_b32 v167, v228, v228, v33
    v_perm_b32 v168, v230, v230, v30
    v_perm_b32 v169, v230, v230, v31
    v_perm_b32 v170, v230, v230, v32
    v_perm_b32 v171, v230, v230, v33
    v_perm_b32 v172, v232, v232, v30
    v_perm_b32 v173, v232, v232, v31
    v_perm_b32 v174, v232, v232, v32
    v_perm_b32 v175, v232, v232, v33
    v_perm_b32 v176, v234, v234, v30
    v_perm_b32 v177, v234, v234, v31
    v_perm_b32 v178, v234, v234, v32
    v_perm_b32 v179, v234, v234, v33
    v_mfma_f32_16x16x32_bf16 v[196:199], v[48:51], v[164:167], 0
    v_mfma_f32_16x16x32_bf16 v[200:203], v[84:87], v[164:167], 0
    v_mfma_f32_16x16x32_bf16 v[204:207], v[50:53], v[168:171], 0
    v_mfma_f32_16x16x32_bf16 v[208:211], v[86:89], v[168:171], 0
    v_mfma_f32_16x16x32_bf16 v[212:215], v[52:55], v[172:175], 0
    v_mfma_f32_16x16x32_bf16 v[216:219], v[88:91], v[172:175], 0
    v_mfma_f32_16x16x32_bf16 v[220:223], v[54:57], v[176:179], 0
    v_mfma_f32_16x16x32_bf16 v[224:227], v[90:93], v[176:179], 0
    v_accvgpr_read_b32 v34, a160
    s_mov_b32 s82, 131072
    s_add_u32 m0, s3, 131072
    s_nop 0
    buffer_load_dwordx4 v17, s[48:51], s82 offen lds
    buffer_load_dwordx4 v18, s[48:51], s82 offen offset:1024 lds
    v_accvgpr_read_b32 v35, a161
    v_accvgpr_read_b32 v36, a162
    v_accvgpr_read_b32 v37, a163
    v_accvgpr_read_b32 v38, a164
    v_accvgpr_read_b32 v39, a165
    v_accvgpr_read_b32 v40, a166
    v_accvgpr_read_b32 v41, a167
    v_cvt_pk_bf16_f32 v148, v34, v35
    v_cvt_pk_bf16_f32 v149, v36, v37
    v_cvt_pk_bf16_f32 v150, v38, v39
    v_cvt_pk_bf16_f32 v151, v40, v41
    v_accvgpr_read_b32 v246, a224
    v_accvgpr_read_b32 v247, a225
    v_accvgpr_read_b32 v248, a226
    v_accvgpr_read_b32 v249, a227
    v_accvgpr_read_b32 v250, a228
    v_accvgpr_read_b32 v251, a229
    v_accvgpr_read_b32 v252, a230
    v_accvgpr_read_b32 v253, a231
    v_cvt_pk_bf16_f32 v180, v246, v247
    v_cvt_pk_bf16_f32 v181, v248, v249
    v_cvt_pk_bf16_f32 v182, v250, v251
    v_cvt_pk_bf16_f32 v183, v252, v253
    v_accvgpr_read_b32 v34, a168
    s_mov_b32 s83, 360448
    s_add_u32 m0, s3, 139264
    s_nop 0
    buffer_load_dwordx4 v17, s[48:51], s83 offen lds
    buffer_load_dwordx4 v18, s[48:51], s83 offen offset:1024 lds
    v_accvgpr_read_b32 v35, a169
    v_accvgpr_read_b32 v36, a170
    v_accvgpr_read_b32 v37, a171
    v_accvgpr_read_b32 v38, a172
    v_accvgpr_read_b32 v39, a173
    v_accvgpr_read_b32 v40, a174
    v_accvgpr_read_b32 v41, a175
    v_cvt_pk_bf16_f32 v152, v34, v35
    v_cvt_pk_bf16_f32 v153, v36, v37
    v_cvt_pk_bf16_f32 v154, v38, v39
    v_cvt_pk_bf16_f32 v155, v40, v41
    v_accvgpr_read_b32 v246, a232
    v_accvgpr_read_b32 v247, a233
    v_accvgpr_read_b32 v248, a234
    v_accvgpr_read_b32 v249, a235
    v_accvgpr_read_b32 v250, a236
    v_accvgpr_read_b32 v251, a237
    v_accvgpr_read_b32 v252, a238
    v_accvgpr_read_b32 v253, a239
    v_cvt_pk_bf16_f32 v184, v246, v247
    v_cvt_pk_bf16_f32 v185, v248, v249
    v_cvt_pk_bf16_f32 v186, v250, v251
    v_cvt_pk_bf16_f32 v187, v252, v253
    v_accvgpr_read_b32 v34, a176
    s_mov_b32 s82, 589824
    s_add_u32 m0, s3, 147456
    s_nop 0
    buffer_load_dwordx4 v17, s[48:51], s82 offen lds
    buffer_load_dwordx4 v18, s[48:51], s82 offen offset:1024 lds
    v_accvgpr_read_b32 v35, a177
    v_accvgpr_read_b32 v36, a178
    v_accvgpr_read_b32 v37, a179
    v_accvgpr_read_b32 v38, a180
    v_accvgpr_read_b32 v39, a181
    v_accvgpr_read_b32 v40, a182
    v_accvgpr_read_b32 v41, a183
    v_cvt_pk_bf16_f32 v156, v34, v35
    v_cvt_pk_bf16_f32 v157, v36, v37
    v_cvt_pk_bf16_f32 v158, v38, v39
    v_cvt_pk_bf16_f32 v159, v40, v41
    v_accvgpr_read_b32 v246, a240
    v_accvgpr_read_b32 v247, a241
    v_accvgpr_read_b32 v248, a242
    v_accvgpr_read_b32 v249, a243
    v_accvgpr_read_b32 v250, a244
    v_accvgpr_read_b32 v251, a245
    v_accvgpr_read_b32 v252, a246
    v_accvgpr_read_b32 v253, a247
    v_cvt_pk_bf16_f32 v188, v246, v247
    v_cvt_pk_bf16_f32 v189, v248, v249
    v_cvt_pk_bf16_f32 v190, v250, v251
    v_cvt_pk_bf16_f32 v191, v252, v253
    v_accvgpr_read_b32 v34, a184
    s_mov_b32 s83, 819200
    s_add_u32 m0, s3, 155648
    s_nop 0
    buffer_load_dwordx4 v17, s[48:51], s83 offen lds
    buffer_load_dwordx4 v18, s[48:51], s83 offen offset:1024 lds
    v_accvgpr_read_b32 v35, a185
    v_accvgpr_read_b32 v36, a186
    v_accvgpr_read_b32 v37, a187
    v_accvgpr_read_b32 v38, a188
    v_accvgpr_read_b32 v39, a189
    v_accvgpr_read_b32 v40, a190
    v_accvgpr_read_b32 v41, a191
    v_cvt_pk_bf16_f32 v160, v34, v35
    v_cvt_pk_bf16_f32 v161, v36, v37
    v_cvt_pk_bf16_f32 v162, v38, v39
    v_cvt_pk_bf16_f32 v163, v40, v41
    v_accvgpr_read_b32 v246, a248
    v_accvgpr_read_b32 v247, a249
    v_accvgpr_read_b32 v248, a250
    v_accvgpr_read_b32 v249, a251
    v_accvgpr_read_b32 v250, a252
    v_accvgpr_read_b32 v251, a253
    v_accvgpr_read_b32 v252, a254
    v_accvgpr_read_b32 v253, a255
    v_cvt_pk_bf16_f32 v192, v246, v247
    v_cvt_pk_bf16_f32 v193, v248, v249
    v_cvt_pk_bf16_f32 v194, v250, v251
    v_cvt_pk_bf16_f32 v195, v252, v253
    v_cvt_pk_bf16_f32 v196, v196, v197
    v_cvt_pk_bf16_f32 v197, v198, v199
    v_cvt_pk_bf16_f32 v198, v200, v201
    v_cvt_pk_bf16_f32 v199, v202, v203
    buffer_store_dwordx4 v[196:199], v16, s[56:59], s91 offen offset:0 sc1
    s_add_u32 s91, s91, 32768
    v_cvt_pk_bf16_f32 v204, v204, v205
    v_cvt_pk_bf16_f32 v205, v206, v207
    v_cvt_pk_bf16_f32 v206, v208, v209
    v_cvt_pk_bf16_f32 v207, v210, v211
    buffer_store_dwordx4 v[204:207], v16, s[56:59], s91 offen offset:0 sc1
    s_add_u32 s91, s91, 32768
    v_cvt_pk_bf16_f32 v212, v212, v213
    v_cvt_pk_bf16_f32 v213, v214, v215
    v_cvt_pk_bf16_f32 v214, v216, v217
    v_cvt_pk_bf16_f32 v215, v218, v219
    buffer_store_dwordx4 v[212:215], v16, s[56:59], s91 offen offset:0 sc1
    s_add_u32 s91, s91, 32768
    v_cvt_pk_bf16_f32 v220, v220, v221
    v_cvt_pk_bf16_f32 v221, v222, v223
    v_cvt_pk_bf16_f32 v222, v224, v225
    v_cvt_pk_bf16_f32 v223, v226, v227
    buffer_store_dwordx4 v[220:223], v16, s[56:59], s91 offen offset:0 sc1
    s_add_u32 s91, s91, 32768
    v_mfma_f32_16x16x32_bf16 v[196:199], v[144:147], v[180:183], 0
    v_mfma_f32_16x16x32_bf16 v[200:203], v[148:151], v[180:183], 0
    v_mfma_f32_16x16x32_bf16 v[204:207], v[148:151], v[184:187], 0
    v_mfma_f32_16x16x32_bf16 v[208:211], v[152:155], v[184:187], 0
    v_mfma_f32_16x16x32_bf16 v[212:215], v[152:155], v[188:191], 0
    v_mfma_f32_16x16x32_bf16 v[216:219], v[156:159], v[188:191], 0
    v_mfma_f32_16x16x32_bf16 v[220:223], v[156:159], v[192:195], 0
    v_mfma_f32_16x16x32_bf16 v[224:227], v[160:163], v[192:195], 0
    s_nop 0
    v_cvt_pk_bf16_f32 v196, v196, v197
    v_cvt_pk_bf16_f32 v198, v198, v199
    v_cvt_pk_bf16_f32 v200, v200, v201
    v_cvt_pk_bf16_f32 v202, v202, v203
    v_cvt_pk_bf16_f32 v204, v204, v205
    v_cvt_pk_bf16_f32 v206, v206, v207
    v_cvt_pk_bf16_f32 v208, v208, v209
    v_cvt_pk_bf16_f32 v210, v210, v211
    v_cvt_pk_bf16_f32 v212, v212, v213
    v_cvt_pk_bf16_f32 v214, v214, v215
    v_cvt_pk_bf16_f32 v216, v216, v217
    v_cvt_pk_bf16_f32 v218, v218, v219
    v_cvt_pk_bf16_f32 v220, v220, v221
    v_cvt_pk_bf16_f32 v222, v222, v223
    v_cvt_pk_bf16_f32 v224, v224, v225
    v_cvt_pk_bf16_f32 v226, v226, v227
    v_perm_b32 v228, v200, v196, v28
    v_perm_b32 v229, v202, v198, v29
    v_perm_b32 v230, v208, v204, v28
    v_perm_b32 v231, v210, v206, v29
    v_perm_b32 v232, v216, v212, v28
    v_perm_b32 v233, v218, v214, v29
    v_perm_b32 v234, v224, v220, v28
    v_perm_b32 v235, v226, v222, v29
    v_pk_mul_f32 v[228:229], v[228:229], s[14:15]
    v_pk_mul_f32 v[230:231], v[230:231], s[14:15]
    v_pk_mul_f32 v[232:233], v[232:233], s[14:15]
    v_pk_mul_f32 v[234:235], v[234:235], s[14:15]
    v_cvt_pk_bf16_f32 v229, v228, v229
    v_cvt_pk_bf16_f32 v231, v230, v231
    v_cvt_pk_bf16_f32 v233, v232, v233
    v_cvt_pk_bf16_f32 v235, v234, v235
    v_lshlrev_b32 v228, 16, v229
    v_and_b32 v229, 0xffff0000, v229
    v_lshlrev_b32 v230, 16, v231
    v_and_b32 v231, 0xffff0000, v231
    v_lshlrev_b32 v232, 16, v233
    v_and_b32 v233, 0xffff0000, v233
    v_lshlrev_b32 v234, 16, v235
    v_and_b32 v235, 0xffff0000, v235
    v_max_f32 v236, v228, v229
    v_max_f32 v238, v230, v231
    v_max_f32 v240, v232, v233
    v_max_f32 v242, v234, v235
    v_permlane16_swap_b32 v236, v238
    s_nop 0
    v_permlane16_swap_b32 v240, v242
    v_max_f32 v236, v236, v238
    v_max_f32 v240, v240, v242
    s_nop 1
    v_permlane32_swap_b32 v236, v240
    v_max_f32 v236, v236, v240
    v_mul_f32 v236, 0xbfb8aa3b, v236
    v_mov_b32 v240, v236
    s_nop 1
    v_permlane32_swap_b32 v236, v240
    v_mov_b32 v238, v236
    v_mov_b32 v242, v240
    s_nop 0
    v_permlane16_swap_b32 v236, v238
    v_permlane16_swap_b32 v240, v242
    v_pk_fma_f32 v[228:229], v[228:229], s[98:99], v[236:237] op_sel_hi:[1,1,0]
    v_pk_fma_f32 v[230:231], v[230:231], s[98:99], v[238:239] op_sel_hi:[1,1,0]
    v_pk_fma_f32 v[232:233], v[232:233], s[98:99], v[240:241] op_sel_hi:[1,1,0]
    v_pk_fma_f32 v[234:235], v[234:235], s[98:99], v[242:243] op_sel_hi:[1,1,0]
    v_exp_f32 v228, v228
    v_exp_f32 v229, v229
    v_exp_f32 v230, v230
    v_exp_f32 v231, v231
    v_exp_f32 v232, v232
    v_exp_f32 v233, v233
    v_exp_f32 v234, v234
    v_exp_f32 v235, v235
    v_add_f32 v236, v228, v229
    v_add_f32 v238, v230, v231
    v_add_f32 v240, v232, v233
    v_add_f32 v242, v234, v235
    v_permlane16_swap_b32 v236, v238
    s_nop 0
    v_permlane16_swap_b32 v240, v242
    v_add_f32 v236, v236, v238
    v_add_f32 v240, v240, v242
    s_nop 1
    v_permlane32_swap_b32 v236, v240
    v_add_f32 v236, v236, v240
    v_rcp_f32 v236, v236
    s_nop 0
    v_mov_b32 v240, v236
    s_nop 1
    v_permlane32_swap_b32 v236, v240
    v_mov_b32 v238, v236
    v_mov_b32 v242, v240
    s_nop 0
    v_permlane16_swap_b32 v236, v238
    v_permlane16_swap_b32 v240, v242
    v_pk_mul_f32 v[228:229], v[228:229], v[236:237] op_sel_hi:[1,0]
    v_pk_mul_f32 v[230:231], v[230:231], v[238:239] op_sel_hi:[1,0]
    v_pk_mul_f32 v[232:233], v[232:233], v[240:241] op_sel_hi:[1,0]
    v_pk_mul_f32 v[234:235], v[234:235], v[242:243] op_sel_hi:[1,0]
    v_cvt_pk_bf16_f32 v228, v228, v229
    v_cvt_pk_bf16_f32 v230, v230, v231
    v_cvt_pk_bf16_f32 v232, v232, v233
    v_cvt_pk_bf16_f32 v234, v234, v235
    v_perm_b32 v180, v228, v228, v30
    v_perm_b32 v181, v228, v228, v31
    v_perm_b32 v182, v228, v228, v32
    v_perm_b32 v183, v228, v228, v33
    v_perm_b32 v184, v230, v230, v30
    v_perm_b32 v185, v230, v230, v31
    v_perm_b32 v186, v230, v230, v32
    v_perm_b32 v187, v230, v230, v33
    v_perm_b32 v188, v232, v232, v30
    v_perm_b32 v189, v232, v232, v31
    v_perm_b32 v190, v232, v232, v32
    v_perm_b32 v191, v232, v232, v33
    v_perm_b32 v192, v234, v234, v30
    v_perm_b32 v193, v234, v234, v31
    v_perm_b32 v194, v234, v234, v32
    v_perm_b32 v195, v234, v234, v33
    v_mfma_f32_16x16x32_bf16 v[196:199], v[56:59], v[180:183], 0
    v_mfma_f32_16x16x32_bf16 v[200:203], v[92:95], v[180:183], 0
    v_mfma_f32_16x16x32_bf16 v[204:207], v[58:61], v[184:187], 0
    v_mfma_f32_16x16x32_bf16 v[208:211], v[94:97], v[184:187], 0
    v_mfma_f32_16x16x32_bf16 v[212:215], v[60:63], v[188:191], 0
    v_mfma_f32_16x16x32_bf16 v[216:219], v[96:99], v[188:191], 0
    v_mfma_f32_16x16x32_bf16 v[220:223], v[62:65], v[192:195], 0
    v_mfma_f32_16x16x32_bf16 v[224:227], v[98:101], v[192:195], 0
    s_nop 0
    v_cvt_pk_bf16_f32 v196, v196, v197
    v_cvt_pk_bf16_f32 v197, v198, v199
    v_cvt_pk_bf16_f32 v198, v200, v201
    v_cvt_pk_bf16_f32 v199, v202, v203
    buffer_store_dwordx4 v[196:199], v16, s[56:59], s91 offen offset:0 sc1
    s_add_u32 s91, s91, 32768
    v_cvt_pk_bf16_f32 v204, v204, v205
    v_cvt_pk_bf16_f32 v205, v206, v207
    v_cvt_pk_bf16_f32 v206, v208, v209
    v_cvt_pk_bf16_f32 v207, v210, v211
    buffer_store_dwordx4 v[204:207], v16, s[56:59], s91 offen offset:0 sc1
    s_add_u32 s91, s91, 32768
    v_cvt_pk_bf16_f32 v212, v212, v213
    v_cvt_pk_bf16_f32 v213, v214, v215
    v_cvt_pk_bf16_f32 v214, v216, v217
    v_cvt_pk_bf16_f32 v215, v218, v219
    buffer_store_dwordx4 v[212:215], v16, s[56:59], s91 offen offset:0 sc1
    s_add_u32 s91, s91, 32768
    v_cvt_pk_bf16_f32 v220, v220, v221
    v_cvt_pk_bf16_f32 v221, v222, v223
    v_cvt_pk_bf16_f32 v222, v224, v225
    v_cvt_pk_bf16_f32 v223, v226, v227
    buffer_store_dwordx4 v[220:223], v16, s[56:59], s91 offen offset:0 sc1
    s_add_u32 s91, s91, 32768
    s_mov_b32 s67, 0
L_spA:
    buffer_load_dword v43, off, s[56:59], s92 sc1
    s_waitcnt vmcnt(0)
    v_readfirstlane_b32 s86, v43
    s_bfe_u32 s86, s86, 0x80000
    s_cmp_eq_u32 s86, 32
    s_cbranch_scc1 L_okA
    s_add_u32 s67, s67, 1
    s_cmp_lt_u32 s67, 0x40000
    s_cbranch_scc1 L_spA
L_okA:
    buffer_load_dwordx4 a[0:3], v21, s[56:59], s68 offen sc1
    buffer_load_dwordx4 a[4:7], v22, s[56:59], s68 offen sc1
    buffer_load_dwordx4 a[8:11], v23, s[56:59], s68 offen sc1
    buffer_load_dwordx4 a[12:15], v24, s[56:59], s68 offen sc1
    s_add_u32 s68, s68, 16384
    buffer_load_dwordx4 a[16:19], v21, s[56:59], s68 offen sc1
    buffer_load_dwordx4 a[20:23], v22, s[56:59], s68 offen sc1
    buffer_load_dwordx4 a[24:27], v23, s[56:59], s68 offen sc1
    buffer_load_dwordx4 a[28:31], v24, s[56:59], s68 offen sc1
    s_add_u32 s68, s68, 16384
    buffer_load_dwordx4 a[32:35], v21, s[56:59], s68 offen sc1
    buffer_load_dwordx4 a[36:39], v22, s[56:59], s68 offen sc1
    buffer_load_dwordx4 a[40:43], v23, s[56:59], s68 offen sc1
    buffer_load_dwordx4 a[44:47], v24, s[56:59], s68 offen sc1
    s_add_u32 s68, s68, 16384
    buffer_load_dwordx4 a[48:51], v21, s[56:59], s68 offen sc1
    buffer_load_dwordx4 a[52:55], v22, s[56:59], s68 offen sc1
    buffer_load_dwordx4 a[56:59], v23, s[56:59], s68 offen sc1
    buffer_load_dwordx4 a[60:63], v24, s[56:59], s68 offen sc1
    s_add_u32 s68, s68, 16384
    buffer_load_dwordx4 a[64:67], v21, s[56:59], s68 offen sc1
    buffer_load_dwordx4 a[68:71], v22, s[56:59], s68 offen sc1
    buffer_load_dwordx4 a[72:75], v23, s[56:59], s68 offen sc1
    buffer_load_dwordx4 a[76:79], v24, s[56:59], s68 offen sc1
    s_add_u32 s68, s68, 16384
    buffer_load_dwordx4 a[80:83], v21, s[56:59], s68 offen sc1
    buffer_load_dwordx4 a[84:87], v22, s[56:59], s68 offen sc1
    buffer_load_dwordx4 a[88:91], v23, s[56:59], s68 offen sc1
    buffer_load_dwordx4 a[92:95], v24, s[56:59], s68 offen sc1
    s_add_u32 s68, s68, 16384
    buffer_load_dwordx4 a[96:99], v21, s[56:59], s68 offen sc1
    buffer_load_dwordx4 a[100:103], v22, s[56:59], s68 offen sc1
    buffer_load_dwordx4 a[104:107], v23, s[56:59], s68 offen sc1
    buffer_load_dwordx4 a[108:111], v24, s[56:59], s68 offen sc1
    s_add_u32 s68, s68, 16384
    buffer_load_dwordx4 a[112:115], v21, s[56:59], s68 offen sc1
    buffer_load_dwordx4 a[116:119], v22, s[56:59], s68 offen sc1
    buffer_load_dwordx4 a[120:123], v23, s[56:59], s68 offen sc1
    buffer_load_dwordx4 a[124:127], v24, s[56:59], s68 offen sc1
    s_add_u32 s68, s68, 16384
    s_barrier
    s_branch L_D
L_epi1:
    v_accvgpr_read_b32 v128, a128
    v_accvgpr_read_b32 v129, a129
    v_accvgpr_read_b32 v130, a130
    v_accvgpr_read_b32 v131, a131
    v_accvgpr_read_b32 v132, a132
    s_mov_b32 s82, 65536
    s_add_u32 m0, s3, 65536
    s_nop 0
    buffer_load_dwordx4 v17, s[48:51], s82 offen lds
    buffer_load_dwordx4 v18, s[48:51], s82 offen offset:1024 lds
    v_accvgpr_read_b32 v133, a133
    v_accvgpr_read_b32 v134, a134
    v_accvgpr_read_b32 v135, a135
    v_accvgpr_read_b32 v136, a136
    v_accvgpr_read_b32 v137, a137
    v_accvgpr_read_b32 v138, a138
    v_accvgpr_read_b32 v139, a139
    v_accvgpr_read_b32 v140, a140
    v_accvgpr_read_b32 v141, a141
    v_accvgpr_read_b32 v142, a142
    v_accvgpr_read_b32 v143, a143
    v_pk_mul_f32 v[34:35], v[128:129], v[128:129]
    v_pk_mul_f32 v[36:37], v[130:131], v[130:131]
    v_pk_mul_f32 v[38:39], v[132:133], v[132:133]
    v_pk_mul_f32 v[40:41], v[134:135], v[134:135]
    v_pk_fma_f32 v[34:35], v[34:35], s[94:95], v[26:27]
    v_pk_fma_f32 v[36:37], v[36:37], s[94:95], v[26:27]
    v_pk_fma_f32 v[38:39], v[38:39], s[94:95], v[26:27]
    v_pk_fma_f32 v[40:41], v[40:41], s[94:95], v[26:27]
    v_pk_mul_f32 v[34:35], v[34:35], v[128:129]
    v_pk_mul_f32 v[36:37], v[36:37], v[130:131]
    v_pk_mul_f32 v[38:39], v[38:39], v[132:133]
    v_pk_mul_f32 v[40:41], v[40:41], v[134:135]
    v_exp_f32 v34, v34
    v_exp_f32 v35, v35
    v_exp_f32 v36, v36
    v_exp_f32 v37, v37
    v_exp_f32 v38, v38
    s_mov_b32 s83, 294912
    s_add_u32 m0, s3, 73728
    s_nop 0
    buffer_load_dwordx4 v17, s[48:51], s83 offen lds
    buffer_load_dwordx4 v18, s[48:51], s83 offen offset:1024 lds
    v_exp_f32 v39, v39
    v_exp_f32 v40, v40
    v_exp_f32 v41, v41
    v_pk_mul_f32 v[136:137], v[136:137], v[128:129]
    v_pk_mul_f32 v[138:139], v[138:139], v[130:131]
    v_pk_mul_f32 v[140:141], v[140:141], v[132:133]
    v_pk_mul_f32 v[142:143], v[142:143], v[134:135]
    v_pk_add_f32 v[34:35], v[34:35], 1.0 op_sel_hi:[1,0]
    v_pk_add_f32 v[36:37], v[36:37], 1.0 op_sel_hi:[1,0]
    v_pk_add_f32 v[38:39], v[38:39], 1.0 op_sel_hi:[1,0]
    v_pk_add_f32 v[40:41], v[40:41], 1.0 op_sel_hi:[1,0]
    v_rcp_f32 v34, v34
    v_rcp_f32 v35, v35
    v_rcp_f32 v36, v36
    v_rcp_f32 v37, v37
    v_rcp_f32 v38, v38
    v_rcp_f32 v39, v39
    v_rcp_f32 v40, v40
    v_rcp_f32 v41, v41
    v_pk_mul_f32 v[136:137], v[136:137], v[34:35]
    v_pk_mul_f32 v[138:139], v[138:139], v[36:37]
    v_pk_mul_f32 v[140:141], v[140:141], v[38:39]
    v_pk_mul_f32 v[142:143], v[142:143], v[40:41]
    v_cvt_pk_bf16_f32 v128, v136, v137
    v_cvt_pk_bf16_f32 v129, v138, v139
    v_cvt_pk_bf16_f32 v130, v140, v141
    v_cvt_pk_bf16_f32 v131, v142, v143
    buffer_store_dwordx4 v[128:131], v16, s[56:59], s89 offen offset:0 sc1
    s_waitcnt vmcnt(5)
    s_mov_b64 exec, 1
    buffer_atomic_add v25, off, s[56:59], s92 sc1
    s_mov_b64 exec, -1
    v_accvgpr_read_b32 v144, a144
    v_accvgpr_read_b32 v145, a145
    v_accvgpr_read_b32 v146, a146
    v_accvgpr_read_b32 v147, a147
    v_accvgpr_read_b32 v148, a148
    s_mov_b32 s82, 524288
    s_add_u32 m0, s3, 81920
    s_nop 0
    buffer_load_dwordx4 v17, s[48:51], s82 offen lds
    buffer_load_dwordx4 v18, s[48:51], s82 offen offset:1024 lds
    v_accvgpr_read_b32 v149, a149
    v_accvgpr_read_b32 v150, a150
    v_accvgpr_read_b32 v151, a151
    v_accvgpr_read_b32 v152, a152
    v_accvgpr_read_b32 v153, a153
    v_accvgpr_read_b32 v154, a154
    v_accvgpr_read_b32 v155, a155
    v_accvgpr_read_b32 v156, a156
    v_accvgpr_read_b32 v157, a157
    v_accvgpr_read_b32 v158, a158
    v_accvgpr_read_b32 v159, a159
    v_pk_mul_f32 v[34:35], v[144:145], v[144:145]
    v_pk_mul_f32 v[36:37], v[146:147], v[146:147]
    v_pk_mul_f32 v[38:39], v[148:149], v[148:149]
    v_pk_mul_f32 v[40:41], v[150:151], v[150:151]
    v_pk_fma_f32 v[34:35], v[34:35], s[94:95], v[26:27]
    v_pk_fma_f32 v[36:37], v[36:37], s[94:95], v[26:27]
    v_pk_fma_f32 v[38:39], v[38:39], s[94:95], v[26:27]
    v_pk_fma_f32 v[40:41], v[40:41], s[94:95], v[26:27]
    v_pk_mul_f32 v[34:35], v[34:35], v[144:145]
    v_pk_mul_f32 v[36:37], v[36:37], v[146:147]
    v_pk_mul_f32 v[38:39], v[38:39], v[148:149]
    v_pk_mul_f32 v[40:41], v[40:41], v[150:151]
    v_exp_f32 v34, v34
    v_exp_f32 v35, v35
    v_exp_f32 v36, v36
    v_exp_f32 v37, v37
    v_exp_f32 v38, v38
    s_mov_b32 s83, 753664
    s_add_u32 m0, s3, 90112
    s_nop 0
    buffer_load_dwordx4 v17, s[48:51], s83 offen lds
    buffer_load_dwordx4 v18, s[48:51], s83 offen offset:1024 lds
    v_exp_f32 v39, v39
    v_exp_f32 v40, v40
    v_exp_f32 v41, v41
    v_pk_mul_f32 v[152:153], v[152:153], v[144:145]
    v_pk_mul_f32 v[154:155], v[154:155], v[146:147]
    v_pk_mul_f32 v[156:157], v[156:157], v[148:149]
    v_pk_mul_f32 v[158:159], v[158:159], v[150:151]
    v_pk_add_f32 v[34:35], v[34:35], 1.0 op_sel_hi:[1,0]
    v_pk_add_f32 v[36:37], v[36:37], 1.0 op_sel_hi:[1,0]
    v_pk_add_f32 v[38:39], v[38:39], 1.0 op_sel_hi:[1,0]
    v_pk_add_f32 v[40:41], v[40:41], 1.0 op_sel_hi:[1,0]
    v_rcp_f32 v34, v34
    v_rcp_f32 v35, v35
    v_rcp_f32 v36, v36
    v_rcp_f32 v37, v37
    v_rcp_f32 v38, v38
    v_rcp_f32 v39, v39
    v_rcp_f32 v40, v40
    v_rcp_f32 v41, v41
    v_pk_mul_f32 v[152:153], v[152:153], v[34:35]
    v_pk_mul_f32 v[154:155], v[154:155], v[36:37]
    v_pk_mul_f32 v[156:157], v[156:157], v[38:39]
    v_pk_mul_f32 v[158:159], v[158:159], v[40:41]
    v_cvt_pk_bf16_f32 v144, v152, v153
    v_cvt_pk_bf16_f32 v145, v154, v155
    v_cvt_pk_bf16_f32 v146, v156, v157
    v_cvt_pk_bf16_f32 v147, v158, v159
    buffer_store_dwordx4 v[144:147], v16, s[56:59], s89 offen offset:1024 sc1
    v_accvgpr_read_b32 v160, a160
    v_accvgpr_read_b32 v161, a161
    v_accvgpr_read_b32 v162, a162
    v_accvgpr_read_b32 v163, a163
    v_accvgpr_read_b32 v164, a164
    s_mov_b32 s82, 983040
    s_add_u32 m0, s3, 98304
    s_nop 0
    buffer_load_dwordx4 v17, s[48:51], s82 offen lds
    buffer_load_dwordx4 v18, s[48:51], s82 offen offset:1024 lds
    v_accvgpr_read_b32 v165, a165
    v_accvgpr_read_b32 v166, a166
    v_accvgpr_read_b32 v167, a167
    v_accvgpr_read_b32 v168, a168
    v_accvgpr_read_b32 v169, a169
    v_accvgpr_read_b32 v170, a170
    v_accvgpr_read_b32 v171, a171
    v_accvgpr_read_b32 v172, a172
    v_accvgpr_read_b32 v173, a173
    v_accvgpr_read_b32 v174, a174
    v_accvgpr_read_b32 v175, a175
    v_pk_mul_f32 v[34:35], v[160:161], v[160:161]
    v_pk_mul_f32 v[36:37], v[162:163], v[162:163]
    v_pk_mul_f32 v[38:39], v[164:165], v[164:165]
    v_pk_mul_f32 v[40:41], v[166:167], v[166:167]
    v_pk_fma_f32 v[34:35], v[34:35], s[94:95], v[26:27]
    v_pk_fma_f32 v[36:37], v[36:37], s[94:95], v[26:27]
    v_pk_fma_f32 v[38:39], v[38:39], s[94:95], v[26:27]
    v_pk_fma_f32 v[40:41], v[40:41], s[94:95], v[26:27]
    v_pk_mul_f32 v[34:35], v[34:35], v[160:161]
    v_pk_mul_f32 v[36:37], v[36:37], v[162:163]
    v_pk_mul_f32 v[38:39], v[38:39], v[164:165]
    v_pk_mul_f32 v[40:41], v[40:41], v[166:167]
    v_exp_f32 v34, v34
    v_exp_f32 v35, v35
    v_exp_f32 v36, v36
    v_exp_f32 v37, v37
    v_exp_f32 v38, v38
    s_mov_b32 s83, 1212416
    s_add_u32 m0, s3, 106496
    s_nop 0
    buffer_load_dwordx4 v17, s[48:51], s83 offen lds
    buffer_load_dwordx4 v18, s[48:51], s83 offen offset:1024 lds
    v_exp_f32 v39, v39
    v_exp_f32 v40, v40
    v_exp_f32 v41, v41
    v_pk_mul_f32 v[168:169], v[168:169], v[160:161]
    v_pk_mul_f32 v[170:171], v[170:171], v[162:163]
    v_pk_mul_f32 v[172:173], v[172:173], v[164:165]
    v_pk_mul_f32 v[174:175], v[174:175], v[166:167]
    v_pk_add_f32 v[34:35], v[34:35], 1.0 op_sel_hi:[1,0]
    v_pk_add_f32 v[36:37], v[36:37], 1.0 op_sel_hi:[1,0]
    v_pk_add_f32 v[38:39], v[38:39], 1.0 op_sel_hi:[1,0]
    v_pk_add_f32 v[40:41], v[40:41], 1.0 op_sel_hi:[1,0]
    v_rcp_f32 v34, v34
    v_rcp_f32 v35, v35
    v_rcp_f32 v36, v36
    v_rcp_f32 v37, v37
    v_rcp_f32 v38, v38
    v_rcp_f32 v39, v39
    v_rcp_f32 v40, v40
    v_rcp_f32 v41, v41
    v_pk_mul_f32 v[168:169], v[168:169], v[34:35]
    v_pk_mul_f32 v[170:171], v[170:171], v[36:37]
    v_pk_mul_f32 v[172:173], v[172:173], v[38:39]
    v_pk_mul_f32 v[174:175], v[174:175], v[40:41]
    v_cvt_pk_bf16_f32 v160, v168, v169
    v_cvt_pk_bf16_f32 v161, v170, v171
    v_cvt_pk_bf16_f32 v162, v172, v173
    v_cvt_pk_bf16_f32 v163, v174, v175
    buffer_store_dwordx4 v[160:163], v16, s[56:59], s89 offen offset:2048 sc1
    v_accvgpr_read_b32 v176, a176
    v_accvgpr_read_b32 v177, a177
    v_accvgpr_read_b32 v178, a178
    v_accvgpr_read_b32 v179, a179
    v_accvgpr_read_b32 v180, a180
    s_mov_b32 s82, 1441792
    s_add_u32 m0, s3, 114688
    s_nop 0
    buffer_load_dwordx4 v17, s[48:51], s82 offen lds
    buffer_load_dwordx4 v18, s[48:51], s82 offen offset:1024 lds
    v_accvgpr_read_b32 v181, a181
    v_accvgpr_read_b32 v182, a182
    v_accvgpr_read_b32 v183, a183
    v_accvgpr_read_b32 v184, a184
    v_accvgpr_read_b32 v185, a185
    v_accvgpr_read_b32 v186, a186
    v_accvgpr_read_b32 v187, a187
    v_accvgpr_read_b32 v188, a188
    v_accvgpr_read_b32 v189, a189
    v_accvgpr_read_b32 v190, a190
    v_accvgpr_read_b32 v191, a191
    v_pk_mul_f32 v[34:35], v[176:177], v[176:177]
    v_pk_mul_f32 v[36:37], v[178:179], v[178:179]
    v_pk_mul_f32 v[38:39], v[180:181], v[180:181]
    v_pk_mul_f32 v[40:41], v[182:183], v[182:183]
    v_pk_fma_f32 v[34:35], v[34:35], s[94:95], v[26:27]
    v_pk_fma_f32 v[36:37], v[36:37], s[94:95], v[26:27]
    v_pk_fma_f32 v[38:39], v[38:39], s[94:95], v[26:27]
    v_pk_fma_f32 v[40:41], v[40:41], s[94:95], v[26:27]
    v_pk_mul_f32 v[34:35], v[34:35], v[176:177]
    v_pk_mul_f32 v[36:37], v[36:37], v[178:179]
    v_pk_mul_f32 v[38:39], v[38:39], v[180:181]
    v_pk_mul_f32 v[40:41], v[40:41], v[182:183]
    v_exp_f32 v34, v34
    v_exp_f32 v35, v35
    v_exp_f32 v36, v36
    v_exp_f32 v37, v37
    v_exp_f32 v38, v38
    s_mov_b32 s83, 1671168
    s_add_u32 m0, s3, 122880
    s_nop 0
    buffer_load_dwordx4 v17, s[48:51], s83 offen lds
    buffer_load_dwordx4 v18, s[48:51], s83 offen offset:1024 lds
    v_exp_f32 v39, v39
    v_exp_f32 v40, v40
    v_exp_f32 v41, v41
    v_pk_mul_f32 v[184:185], v[184:185], v[176:177]
    v_pk_mul_f32 v[186:187], v[186:187], v[178:179]
    v_pk_mul_f32 v[188:189], v[188:189], v[180:181]
    v_pk_mul_f32 v[190:191], v[190:191], v[182:183]
    v_pk_add_f32 v[34:35], v[34:35], 1.0 op_sel_hi:[1,0]
    v_pk_add_f32 v[36:37], v[36:37], 1.0 op_sel_hi:[1,0]
    v_pk_add_f32 v[38:39], v[38:39], 1.0 op_sel_hi:[1,0]
    v_pk_add_f32 v[40:41], v[40:41], 1.0 op_sel_hi:[1,0]
    v_rcp_f32 v34, v34
    v_rcp_f32 v35, v35
    v_rcp_f32 v36, v36
    v_rcp_f32 v37, v37
    v_rcp_f32 v38, v38
    v_rcp_f32 v39, v39
    v_rcp_f32 v40, v40
    v_rcp_f32 v41, v41
    v_pk_mul_f32 v[184:185], v[184:185], v[34:35]
    v_pk_mul_f32 v[186:187], v[186:187], v[36:37]
    v_pk_mul_f32 v[188:189], v[188:189], v[38:39]
    v_pk_mul_f32 v[190:191], v[190:191], v[40:41]
    v_cvt_pk_bf16_f32 v176, v184, v185
    v_cvt_pk_bf16_f32 v177, v186, v187
    v_cvt_pk_bf16_f32 v178, v188, v189
    v_cvt_pk_bf16_f32 v179, v190, v191
    buffer_store_dwordx4 v[176:179], v16, s[56:59], s89 offen offset:3072 sc1
    v_accvgpr_read_b32 v128, a192
    v_accvgpr_read_b32 v129, a193
    v_accvgpr_read_b32 v130, a194
    v_accvgpr_read_b32 v131, a195
    v_accvgpr_read_b32 v132, a196
    s_mov_b32 s82, 131072
    s_add_u32 m0, s3, 131072
    s_nop 0
    buffer_load_dwordx4 v17, s[48:51], s82 offen lds
    buffer_load_dwordx4 v18, s[48:51], s82 offen offset:1024 lds
    v_accvgpr_read_b32 v133, a197
    v_accvgpr_read_b32 v134, a198
    v_accvgpr_read_b32 v135, a199
    v_accvgpr_read_b32 v136, a200
    v_accvgpr_read_b32 v137, a201
    v_accvgpr_read_b32 v138, a202
    v_accvgpr_read_b32 v139, a203
    v_accvgpr_read_b32 v140, a204
    v_accvgpr_read_b32 v141, a205
    v_accvgpr_read_b32 v142, a206
    v_accvgpr_read_b32 v143, a207
    v_pk_mul_f32 v[34:35], v[128:129], v[128:129]
    v_pk_mul_f32 v[36:37], v[130:131], v[130:131]
    v_pk_mul_f32 v[38:39], v[132:133], v[132:133]
    v_pk_mul_f32 v[40:41], v[134:135], v[134:135]
    v_pk_fma_f32 v[34:35], v[34:35], s[94:95], v[26:27]
    v_pk_fma_f32 v[36:37], v[36:37], s[94:95], v[26:27]
    v_pk_fma_f32 v[38:39], v[38:39], s[94:95], v[26:27]
    v_pk_fma_f32 v[40:41], v[40:41], s[94:95], v[26:27]
    v_pk_mul_f32 v[34:35], v[34:35], v[128:129]
    v_pk_mul_f32 v[36:37], v[36:37], v[130:131]
    v_pk_mul_f32 v[38:39], v[38:39], v[132:133]
    v_pk_mul_f32 v[40:41], v[40:41], v[134:135]
    v_exp_f32 v34, v34
    v_exp_f32 v35, v35
    v_exp_f32 v36, v36
    v_exp_f32 v37, v37
    v_exp_f32 v38, v38
    s_mov_b32 s83, 360448
    s_add_u32 m0, s3, 139264
    s_nop 0
    buffer_load_dwordx4 v17, s[48:51], s83 offen lds
    buffer_load_dwordx4 v18, s[48:51], s83 offen offset:1024 lds
    v_exp_f32 v39, v39
    v_exp_f32 v40, v40
    v_exp_f32 v41, v41
    v_pk_mul_f32 v[136:137], v[136:137], v[128:129]
    v_pk_mul_f32 v[138:139], v[138:139], v[130:131]
    v_pk_mul_f32 v[140:141], v[140:141], v[132:133]
    v_pk_mul_f32 v[142:143], v[142:143], v[134:135]
    v_pk_add_f32 v[34:35], v[34:35], 1.0 op_sel_hi:[1,0]
    v_pk_add_f32 v[36:37], v[36:37], 1.0 op_sel_hi:[1,0]
    v_pk_add_f32 v[38:39], v[38:39], 1.0 op_sel_hi:[1,0]
    v_pk_add_f32 v[40:41], v[40:41], 1.0 op_sel_hi:[1,0]
    v_rcp_f32 v34, v34
    v_rcp_f32 v35, v35
    v_rcp_f32 v36, v36
    v_rcp_f32 v37, v37
    v_rcp_f32 v38, v38
    v_rcp_f32 v39, v39
    v_rcp_f32 v40, v40
    v_rcp_f32 v41, v41
    v_pk_mul_f32 v[136:137], v[136:137], v[34:35]
    v_pk_mul_f32 v[138:139], v[138:139], v[36:37]
    v_pk_mul_f32 v[140:141], v[140:141], v[38:39]
    v_pk_mul_f32 v[142:143], v[142:143], v[40:41]
    v_cvt_pk_bf16_f32 v128, v136, v137
    v_cvt_pk_bf16_f32 v129, v138, v139
    v_cvt_pk_bf16_f32 v130, v140, v141
    v_cvt_pk_bf16_f32 v131, v142, v143
    s_add_u32 s89, s89, 4096
    buffer_store_dwordx4 v[128:131], v16, s[56:59], s89 offen offset:0 sc1
    v_accvgpr_read_b32 v144, a208
    v_accvgpr_read_b32 v145, a209
    v_accvgpr_read_b32 v146, a210
    v_accvgpr_read_b32 v147, a211
    v_accvgpr_read_b32 v148, a212
    s_mov_b32 s82, 589824
    s_add_u32 m0, s3, 147456
    s_nop 0
    buffer_load_dwordx4 v17, s[48:51], s82 offen lds
    buffer_load_dwordx4 v18, s[48:51], s82 offen offset:1024 lds
    v_accvgpr_read_b32 v149, a213
    v_accvgpr_read_b32 v150, a214
    v_accvgpr_read_b32 v151, a215
    v_accvgpr_read_b32 v152, a216
    v_accvgpr_read_b32 v153, a217
    v_accvgpr_read_b32 v154, a218
    v_accvgpr_read_b32 v155, a219
    v_accvgpr_read_b32 v156, a220
    v_accvgpr_read_b32 v157, a221
    v_accvgpr_read_b32 v158, a222
    v_accvgpr_read_b32 v159, a223
    v_pk_mul_f32 v[34:35], v[144:145], v[144:145]
    v_pk_mul_f32 v[36:37], v[146:147], v[146:147]
    v_pk_mul_f32 v[38:39], v[148:149], v[148:149]
    v_pk_mul_f32 v[40:41], v[150:151], v[150:151]
    v_pk_fma_f32 v[34:35], v[34:35], s[94:95], v[26:27]
    v_pk_fma_f32 v[36:37], v[36:37], s[94:95], v[26:27]
    v_pk_fma_f32 v[38:39], v[38:39], s[94:95], v[26:27]
    v_pk_fma_f32 v[40:41], v[40:41], s[94:95], v[26:27]
    v_pk_mul_f32 v[34:35], v[34:35], v[144:145]
    v_pk_mul_f32 v[36:37], v[36:37], v[146:147]
    v_pk_mul_f32 v[38:39], v[38:39], v[148:149]
    v_pk_mul_f32 v[40:41], v[40:41], v[150:151]
    v_exp_f32 v34, v34
    v_exp_f32 v35, v35
    v_exp_f32 v36, v36
    v_exp_f32 v37, v37
    v_exp_f32 v38, v38
    s_mov_b32 s83, 819200
    s_add_u32 m0, s3, 155648
    s_nop 0
    buffer_load_dwordx4 v17, s[48:51], s83 offen lds
    buffer_load_dwordx4 v18, s[48:51], s83 offen offset:1024 lds
    v_exp_f32 v39, v39
    v_exp_f32 v40, v40
    v_exp_f32 v41, v41
    v_pk_mul_f32 v[152:153], v[152:153], v[144:145]
    v_pk_mul_f32 v[154:155], v[154:155], v[146:147]
    v_pk_mul_f32 v[156:157], v[156:157], v[148:149]
    v_pk_mul_f32 v[158:159], v[158:159], v[150:151]
    v_pk_add_f32 v[34:35], v[34:35], 1.0 op_sel_hi:[1,0]
    v_pk_add_f32 v[36:37], v[36:37], 1.0 op_sel_hi:[1,0]
    v_pk_add_f32 v[38:39], v[38:39], 1.0 op_sel_hi:[1,0]
    v_pk_add_f32 v[40:41], v[40:41], 1.0 op_sel_hi:[1,0]
    v_rcp_f32 v34, v34
    v_rcp_f32 v35, v35
    v_rcp_f32 v36, v36
    v_rcp_f32 v37, v37
    v_rcp_f32 v38, v38
    v_rcp_f32 v39, v39
    v_rcp_f32 v40, v40
    v_rcp_f32 v41, v41
    v_pk_mul_f32 v[152:153], v[152:153], v[34:35]
    v_pk_mul_f32 v[154:155], v[154:155], v[36:37]
    v_pk_mul_f32 v[156:157], v[156:157], v[38:39]
    v_pk_mul_f32 v[158:159], v[158:159], v[40:41]
    v_cvt_pk_bf16_f32 v144, v152, v153
    v_cvt_pk_bf16_f32 v145, v154, v155
    v_cvt_pk_bf16_f32 v146, v156, v157
    v_cvt_pk_bf16_f32 v147, v158, v159
    buffer_store_dwordx4 v[144:147], v16, s[56:59], s89 offen offset:1024 sc1
    v_accvgpr_read_b32 v160, a224
    v_accvgpr_read_b32 v161, a225
    v_accvgpr_read_b32 v162, a226
    v_accvgpr_read_b32 v163, a227
    v_accvgpr_read_b32 v164, a228
    v_accvgpr_read_b32 v165, a229
    v_accvgpr_read_b32 v166, a230
    v_accvgpr_read_b32 v167, a231
    v_accvgpr_read_b32 v168, a232
    v_accvgpr_read_b32 v169, a233
    v_accvgpr_read_b32 v170, a234
    v_accvgpr_read_b32 v171, a235
    v_accvgpr_read_b32 v172, a236
    v_accvgpr_read_b32 v173, a237
    v_accvgpr_read_b32 v174, a238
    v_accvgpr_read_b32 v175, a239
    v_pk_mul_f32 v[34:35], v[160:161], v[160:161]
    v_pk_mul_f32 v[36:37], v[162:163], v[162:163]
    v_pk_mul_f32 v[38:39], v[164:165], v[164:165]
    v_pk_mul_f32 v[40:41], v[166:167], v[166:167]
    v_pk_fma_f32 v[34:35], v[34:35], s[94:95], v[26:27]
    v_pk_fma_f32 v[36:37], v[36:37], s[94:95], v[26:27]
    v_pk_fma_f32 v[38:39], v[38:39], s[94:95], v[26:27]
    v_pk_fma_f32 v[40:41], v[40:41], s[94:95], v[26:27]
    v_pk_mul_f32 v[34:35], v[34:35], v[160:161]
    v_pk_mul_f32 v[36:37], v[36:37], v[162:163]
    v_pk_mul_f32 v[38:39], v[38:39], v[164:165]
    v_pk_mul_f32 v[40:41], v[40:41], v[166:167]
    v_exp_f32 v34, v34
    v_exp_f32 v35, v35
    v_exp_f32 v36, v36
    v_exp_f32 v37, v37
    v_exp_f32 v38, v38
    v_exp_f32 v39, v39
    v_exp_f32 v40, v40
    v_exp_f32 v41, v41
    v_pk_mul_f32 v[168:169], v[168:169], v[160:161]
    v_pk_mul_f32 v[170:171], v[170:171], v[162:163]
    v_pk_mul_f32 v[172:173], v[172:173], v[164:165]
    v_pk_mul_f32 v[174:175], v[174:175], v[166:167]
    v_pk_add_f32 v[34:35], v[34:35], 1.0 op_sel_hi:[1,0]
    v_pk_add_f32 v[36:37], v[36:37], 1.0 op_sel_hi:[1,0]
    v_pk_add_f32 v[38:39], v[38:39], 1.0 op_sel_hi:[1,0]
    v_pk_add_f32 v[40:41], v[40:41], 1.0 op_sel_hi:[1,0]
    v_rcp_f32 v34, v34
    v_rcp_f32 v35, v35
    v_rcp_f32 v36, v36
    v_rcp_f32 v37, v37
    v_rcp_f32 v38, v38
    v_rcp_f32 v39, v39
    v_rcp_f32 v40, v40
    v_rcp_f32 v41, v41
    v_pk_mul_f32 v[168:169], v[168:169], v[34:35]
    v_pk_mul_f32 v[170:171], v[170:171], v[36:37]
    v_pk_mul_f32 v[172:173], v[172:173], v[38:39]
    v_pk_mul_f32 v[174:175], v[174:175], v[40:41]
    v_cvt_pk_bf16_f32 v160, v168, v169
    v_cvt_pk_bf16_f32 v161, v170, v171
    v_cvt_pk_bf16_f32 v162, v172, v173
    v_cvt_pk_bf16_f32 v163, v174, v175
    buffer_store_dwordx4 v[160:163], v16, s[56:59], s89 offen offset:2048 sc1
    v_accvgpr_read_b32 v176, a240
    v_accvgpr_read_b32 v177, a241
    v_accvgpr_read_b32 v178, a242
    v_accvgpr_read_b32 v179, a243
    v_accvgpr_read_b32 v180, a244
    v_accvgpr_read_b32 v181, a245
    v_accvgpr_read_b32 v182, a246
    v_accvgpr_read_b32 v183, a247
    v_accvgpr_read_b32 v184, a248
    v_accvgpr_read_b32 v185, a249
    v_accvgpr_read_b32 v186, a250
    v_accvgpr_read_b32 v187, a251
    v_accvgpr_read_b32 v188, a252
    v_accvgpr_read_b32 v189, a253
    v_accvgpr_read_b32 v190, a254
    v_accvgpr_read_b32 v191, a255
    v_pk_mul_f32 v[34:35], v[176:177], v[176:177]
    v_pk_mul_f32 v[36:37], v[178:179], v[178:179]
    v_pk_mul_f32 v[38:39], v[180:181], v[180:181]
    v_pk_mul_f32 v[40:41], v[182:183], v[182:183]
    v_pk_fma_f32 v[34:35], v[34:35], s[94:95], v[26:27]
    v_pk_fma_f32 v[36:37], v[36:37], s[94:95], v[26:27]
    v_pk_fma_f32 v[38:39], v[38:39], s[94:95], v[26:27]
    v_pk_fma_f32 v[40:41], v[40:41], s[94:95], v[26:27]
    v_pk_mul_f32 v[34:35], v[34:35], v[176:177]
    v_pk_mul_f32 v[36:37], v[36:37], v[178:179]
    v_pk_mul_f32 v[38:39], v[38:39], v[180:181]
    v_pk_mul_f32 v[40:41], v[40:41], v[182:183]
    v_exp_f32 v34, v34
    v_exp_f32 v35, v35
    v_exp_f32 v36, v36
    v_exp_f32 v37, v37
    v_exp_f32 v38, v38
    v_exp_f32 v39, v39
    v_exp_f32 v40, v40
    v_exp_f32 v41, v41
    v_pk_mul_f32 v[184:185], v[184:185], v[176:177]
    v_pk_mul_f32 v[186:187], v[186:187], v[178:179]
    v_pk_mul_f32 v[188:189], v[188:189], v[180:181]
    v_pk_mul_f32 v[190:191], v[190:191], v[182:183]
    v_pk_add_f32 v[34:35], v[34:35], 1.0 op_sel_hi:[1,0]
    v_pk_add_f32 v[36:37], v[36:37], 1.0 op_sel_hi:[1,0]
    v_pk_add_f32 v[38:39], v[38:39], 1.0 op_sel_hi:[1,0]
    v_pk_add_f32 v[40:41], v[40:41], 1.0 op_sel_hi:[1,0]
    v_rcp_f32 v34, v34
    v_rcp_f32 v35, v35
    v_rcp_f32 v36, v36
    v_rcp_f32 v37, v37
    v_rcp_f32 v38, v38
    v_rcp_f32 v39, v39
    v_rcp_f32 v40, v40
    v_rcp_f32 v41, v41
    v_pk_mul_f32 v[184:185], v[184:185], v[34:35]
    v_pk_mul_f32 v[186:187], v[186:187], v[36:37]
    v_pk_mul_f32 v[188:189], v[188:189], v[38:39]
    v_pk_mul_f32 v[190:191], v[190:191], v[40:41]
    v_cvt_pk_bf16_f32 v176, v184, v185
    v_cvt_pk_bf16_f32 v177, v186, v187
    v_cvt_pk_bf16_f32 v178, v188, v189
    v_cvt_pk_bf16_f32 v179, v190, v191
    buffer_store_dwordx4 v[176:179], v16, s[56:59], s89 offen offset:3072 sc1
    v_pk_mul_f32 v[34:35], v[48:49], v[48:49]
    v_pk_mul_f32 v[36:37], v[50:51], v[50:51]
    v_pk_mul_f32 v[38:39], v[52:53], v[52:53]
    v_pk_mul_f32 v[40:41], v[54:55], v[54:55]
    v_pk_fma_f32 v[34:35], v[34:35], s[94:95], v[26:27]
    v_pk_fma_f32 v[36:37], v[36:37], s[94:95], v[26:27]
    v_pk_fma_f32 v[38:39], v[38:39], s[94:95], v[26:27]
    v_pk_fma_f32 v[40:41], v[40:41], s[94:95], v[26:27]
    v_pk_mul_f32 v[34:35], v[34:35], v[48:49]
    v_pk_mul_f32 v[36:37], v[36:37], v[50:51]
    v_pk_mul_f32 v[38:39], v[38:39], v[52:53]
    v_pk_mul_f32 v[40:41], v[40:41], v[54:55]
    v_exp_f32 v34, v34
    v_exp_f32 v35, v35
    v_exp_f32 v36, v36
    v_exp_f32 v37, v37
    v_exp_f32 v38, v38
    v_exp_f32 v39, v39
    v_exp_f32 v40, v40
    v_exp_f32 v41, v41
    v_pk_mul_f32 v[56:57], v[56:57], v[48:49]
    v_pk_mul_f32 v[58:59], v[58:59], v[50:51]
    v_pk_mul_f32 v[60:61], v[60:61], v[52:53]
    v_pk_mul_f32 v[62:63], v[62:63], v[54:55]
    v_pk_add_f32 v[34:35], v[34:35], 1.0 op_sel_hi:[1,0]
    v_pk_add_f32 v[36:37], v[36:37], 1.0 op_sel_hi:[1,0]
    v_pk_add_f32 v[38:39], v[38:39], 1.0 op_sel_hi:[1,0]
    v_pk_add_f32 v[40:41], v[40:41], 1.0 op_sel_hi:[1,0]
    v_rcp_f32 v34, v34
    v_rcp_f32 v35, v35
    v_rcp_f32 v36, v36
    v_rcp_f32 v37, v37
    v_rcp_f32 v38, v38
    v_rcp_f32 v39, v39
    v_rcp_f32 v40, v40
    v_rcp_f32 v41, v41
    v_pk_mul_f32 v[56:57], v[56:57], v[34:35]
    v_pk_mul_f32 v[58:59], v[58:59], v[36:37]
    v_pk_mul_f32 v[60:61], v[60:61], v[38:39]
    v_pk_mul_f32 v[62:63], v[62:63], v[40:41]
    v_cvt_pk_bf16_f32 v48, v56, v57
    v_cvt_pk_bf16_f32 v49, v58, v59
    v_cvt_pk_bf16_f32 v50, v60, v61
    v_cvt_pk_bf16_f32 v51, v62, v63
    s_nop 0
    v_permlane16_swap_b32 v48, v50
    v_permlane16_swap_b32 v49, v51
    buffer_store_dwordx4 v[48:51], v28, s[56:59], s90 offen offset:0 sc1
    v_pk_mul_f32 v[34:35], v[64:65], v[64:65]
    v_pk_mul_f32 v[36:37], v[66:67], v[66:67]
    v_pk_mul_f32 v[38:39], v[68:69], v[68:69]
    v_pk_mul_f32 v[40:41], v[70:71], v[70:71]
    v_pk_fma_f32 v[34:35], v[34:35], s[94:95], v[26:27]
    v_pk_fma_f32 v[36:37], v[36:37], s[94:95], v[26:27]
    v_pk_fma_f32 v[38:39], v[38:39], s[94:95], v[26:27]
    v_pk_fma_f32 v[40:41], v[40:41], s[94:95], v[26:27]
    v_pk_mul_f32 v[34:35], v[34:35], v[64:65]
    v_pk_mul_f32 v[36:37], v[36:37], v[66:67]
    v_pk_mul_f32 v[38:39], v[38:39], v[68:69]
    v_pk_mul_f32 v[40:41], v[40:41], v[70:71]
    v_exp_f32 v34, v34
    v_exp_f32 v35, v35
    v_exp_f32 v36, v36
    v_exp_f32 v37, v37
    v_exp_f32 v38, v38
    v_exp_f32 v39, v39
    v_exp_f32 v40, v40
    v_exp_f32 v41, v41
    v_pk_mul_f32 v[72:73], v[72:73], v[64:65]
    v_pk_mul_f32 v[74:75], v[74:75], v[66:67]
    v_pk_mul_f32 v[76:77], v[76:77], v[68:69]
    v_pk_mul_f32 v[78:79], v[78:79], v[70:71]
    v_pk_add_f32 v[34:35], v[34:35], 1.0 op_sel_hi:[1,0]
    v_pk_add_f32 v[36:37], v[36:37], 1.0 op_sel_hi:[1,0]
    v_pk_add_f32 v[38:39], v[38:39], 1.0 op_sel_hi:[1,0]
    v_pk_add_f32 v[40:41], v[40:41], 1.0 op_sel_hi:[1,0]
    v_rcp_f32 v34, v34
    v_rcp_f32 v35, v35
    v_rcp_f32 v36, v36
    v_rcp_f32 v37, v37
    v_rcp_f32 v38, v38
    v_rcp_f32 v39, v39
    v_rcp_f32 v40, v40
    v_rcp_f32 v41, v41
    v_pk_mul_f32 v[72:73], v[72:73], v[34:35]
    v_pk_mul_f32 v[74:75], v[74:75], v[36:37]
    v_pk_mul_f32 v[76:77], v[76:77], v[38:39]
    v_pk_mul_f32 v[78:79], v[78:79], v[40:41]
    v_cvt_pk_bf16_f32 v64, v72, v73
    v_cvt_pk_bf16_f32 v65, v74, v75
    v_cvt_pk_bf16_f32 v66, v76, v77
    v_cvt_pk_bf16_f32 v67, v78, v79
    s_nop 0
    v_permlane16_swap_b32 v64, v66
    v_permlane16_swap_b32 v65, v67
    buffer_store_dwordx4 v[64:67], v28, s[56:59], s90 offen offset:2048 sc1
    s_waitcnt vmcnt(2)
    s_mov_b64 exec, 1
    buffer_atomic_add v29, off, s[56:59], s92 sc1
    s_mov_b64 exec, -1
    v_pk_mul_f32 v[34:35], v[80:81], v[80:81]
    v_pk_mul_f32 v[36:37], v[82:83], v[82:83]
    v_pk_mul_f32 v[38:39], v[84:85], v[84:85]
    v_pk_mul_f32 v[40:41], v[86:87], v[86:87]
    v_pk_fma_f32 v[34:35], v[34:35], s[94:95], v[26:27]
    v_pk_fma_f32 v[36:37], v[36:37], s[94:95], v[26:27]
    v_pk_fma_f32 v[38:39], v[38:39], s[94:95], v[26:27]
    v_pk_fma_f32 v[40:41], v[40:41], s[94:95], v[26:27]
    v_pk_mul_f32 v[34:35], v[34:35], v[80:81]
    v_pk_mul_f32 v[36:37], v[36:37], v[82:83]
    v_pk_mul_f32 v[38:39], v[38:39], v[84:85]
    v_pk_mul_f32 v[40:41], v[40:41], v[86:87]
    v_exp_f32 v34, v34
    v_exp_f32 v35, v35
    v_exp_f32 v36, v36
    v_exp_f32 v37, v37
    v_exp_f32 v38, v38
    v_exp_f32 v39, v39
    v_exp_f32 v40, v40
    v_exp_f32 v41, v41
    v_pk_mul_f32 v[88:89], v[88:89], v[80:81]
    v_pk_mul_f32 v[90:91], v[90:91], v[82:83]
    v_pk_mul_f32 v[92:93], v[92:93], v[84:85]
    v_pk_mul_f32 v[94:95], v[94:95], v[86:87]
    v_pk_add_f32 v[34:35], v[34:35], 1.0 op_sel_hi:[1,0]
    v_pk_add_f32 v[36:37], v[36:37], 1.0 op_sel_hi:[1,0]
    v_pk_add_f32 v[38:39], v[38:39], 1.0 op_sel_hi:[1,0]
    v_pk_add_f32 v[40:41], v[40:41], 1.0 op_sel_hi:[1,0]
    v_rcp_f32 v34, v34
    v_rcp_f32 v35, v35
    v_rcp_f32 v36, v36
    v_rcp_f32 v37, v37
    v_rcp_f32 v38, v38
    v_rcp_f32 v39, v39
    v_rcp_f32 v40, v40
    v_rcp_f32 v41, v41
    v_pk_mul_f32 v[88:89], v[88:89], v[34:35]
    v_pk_mul_f32 v[90:91], v[90:91], v[36:37]
    v_pk_mul_f32 v[92:93], v[92:93], v[38:39]
    v_pk_mul_f32 v[94:95], v[94:95], v[40:41]
    v_cvt_pk_bf16_f32 v80, v88, v89
    v_cvt_pk_bf16_f32 v81, v90, v91
    v_cvt_pk_bf16_f32 v82, v92, v93
    v_cvt_pk_bf16_f32 v83, v94, v95
    s_nop 0
    v_permlane16_swap_b32 v80, v82
    v_permlane16_swap_b32 v81, v83
    s_add_u32 s90, s90, 4096
    buffer_store_dwordx4 v[80:83], v28, s[56:59], s90 offen offset:0 sc1
    v_pk_mul_f32 v[34:35], v[96:97], v[96:97]
    v_pk_mul_f32 v[36:37], v[98:99], v[98:99]
    v_pk_mul_f32 v[38:39], v[100:101], v[100:101]
    v_pk_mul_f32 v[40:41], v[102:103], v[102:103]
    v_pk_fma_f32 v[34:35], v[34:35], s[94:95], v[26:27]
    v_pk_fma_f32 v[36:37], v[36:37], s[94:95], v[26:27]
    v_pk_fma_f32 v[38:39], v[38:39], s[94:95], v[26:27]
    v_pk_fma_f32 v[40:41], v[40:41], s[94:95], v[26:27]
    v_pk_mul_f32 v[34:35], v[34:35], v[96:97]
    v_pk_mul_f32 v[36:37], v[36:37], v[98:99]
    v_pk_mul_f32 v[38:39], v[38:39], v[100:101]
    v_pk_mul_f32 v[40:41], v[40:41], v[102:103]
    v_exp_f32 v34, v34
    v_exp_f32 v35, v35
    v_exp_f32 v36, v36
    v_exp_f32 v37, v37
    v_exp_f32 v38, v38
    v_exp_f32 v39, v39
    v_exp_f32 v40, v40
    v_exp_f32 v41, v41
    v_pk_mul_f32 v[104:105], v[104:105], v[96:97]
    v_pk_mul_f32 v[106:107], v[106:107], v[98:99]
    v_pk_mul_f32 v[108:109], v[108:109], v[100:101]
    v_pk_mul_f32 v[110:111], v[110:111], v[102:103]
    v_pk_add_f32 v[34:35], v[34:35], 1.0 op_sel_hi:[1,0]
    v_pk_add_f32 v[36:37], v[36:37], 1.0 op_sel_hi:[1,0]
    v_pk_add_f32 v[38:39], v[38:39], 1.0 op_sel_hi:[1,0]
    v_pk_add_f32 v[40:41], v[40:41], 1.0 op_sel_hi:[1,0]
    v_rcp_f32 v34, v34
    v_rcp_f32 v35, v35
    v_rcp_f32 v36, v36
    v_rcp_f32 v37, v37
    v_rcp_f32 v38, v38
    v_rcp_f32 v39, v39
    v_rcp_f32 v40, v40
    v_rcp_f32 v41, v41
    v_pk_mul_f32 v[104:105], v[104:105], v[34:35]
    v_pk_mul_f32 v[106:107], v[106:107], v[36:37]
    v_pk_mul_f32 v[108:109], v[108:109], v[38:39]
    v_pk_mul_f32 v[110:111], v[110:111], v[40:41]
    v_cvt_pk_bf16_f32 v96, v104, v105
    v_cvt_pk_bf16_f32 v97, v106, v107
    v_cvt_pk_bf16_f32 v98, v108, v109
    v_cvt_pk_bf16_f32 v99, v110, v111
    s_nop 0
    v_permlane16_swap_b32 v96, v98
    v_permlane16_swap_b32 v97, v99
    buffer_store_dwordx4 v[96:99], v28, s[56:59], s90 offen offset:2048 sc1
    s_mov_b32 s67, 0
    s_barrier
    buffer_load_dwordx4 a[0:3], v21, s[56:59], s68 offen sc1
    buffer_load_dwordx4 a[4:7], v22, s[56:59], s68 offen sc1
    buffer_load_dwordx4 a[8:11], v23, s[56:59], s68 offen sc1
    buffer_load_dwordx4 a[12:15], v24, s[56:59], s68 offen sc1
    s_add_u32 s68, s68, 16384
    buffer_load_dwordx4 a[16:19], v21, s[56:59], s68 offen sc1
    buffer_load_dwordx4 a[20:23], v22, s[56:59], s68 offen sc1
    buffer_load_dwordx4 a[24:27], v23, s[56:59], s68 offen sc1
    buffer_load_dwordx4 a[28:31], v24, s[56:59], s68 offen sc1
    s_add_u32 s68, s68, 16384
    buffer_load_dwordx4 a[32:35], v21, s[56:59], s68 offen sc1
    buffer_load_dwordx4 a[36:39], v22, s[56:59], s68 offen sc1
    buffer_load_dwordx4 a[40:43], v23, s[56:59], s68 offen sc1
    buffer_load_dwordx4 a[44:47], v24, s[56:59], s68 offen sc1
    s_add_u32 s68, s68, 16384
    buffer_load_dwordx4 a[48:51], v21, s[56:59], s68 offen sc1
    buffer_load_dwordx4 a[52:55], v22, s[56:59], s68 offen sc1
    buffer_load_dwordx4 a[56:59], v23, s[56:59], s68 offen sc1
    buffer_load_dwordx4 a[60:63], v24, s[56:59], s68 offen sc1
    s_add_u32 s68, s68, 16384
    buffer_load_dwordx4 a[64:67], v21, s[56:59], s68 offen sc1
    buffer_load_dwordx4 a[68:71], v22, s[56:59], s68 offen sc1
    buffer_load_dwordx4 a[72:75], v23, s[56:59], s68 offen sc1
    buffer_load_dwordx4 a[76:79], v24, s[56:59], s68 offen sc1
    s_add_u32 s68, s68, 16384
    buffer_load_dwordx4 a[80:83], v21, s[56:59], s68 offen sc1
    buffer_load_dwordx4 a[84:87], v22, s[56:59], s68 offen sc1
    buffer_load_dwordx4 a[88:91], v23, s[56:59], s68 offen sc1
    buffer_load_dwordx4 a[92:95], v24, s[56:59], s68 offen sc1
    s_add_u32 s68, s68, 16384
    buffer_load_dwordx4 a[96:99], v21, s[56:59], s68 offen sc1
    buffer_load_dwordx4 a[100:103], v22, s[56:59], s68 offen sc1
    buffer_load_dwordx4 a[104:107], v23, s[56:59], s68 offen sc1
    buffer_load_dwordx4 a[108:111], v24, s[56:59], s68 offen sc1
    s_add_u32 s68, s68, 16384
    buffer_load_dwordx4 a[112:115], v21, s[56:59], s68 offen sc1
    buffer_load_dwordx4 a[116:119], v22, s[56:59], s68 offen sc1
    buffer_load_dwordx4 a[120:123], v23, s[56:59], s68 offen sc1
    buffer_load_dwordx4 a[124:127], v24, s[56:59], s68 offen sc1
    s_add_u32 s68, s68, 16384
L_D:
    v_lshrrev_b32 v34, 2, v0
    v_and_b32 v35, 3, v0
    v_lshlrev_b32 v35, 3, v35
    v_lshl_add_u32 v35, v34, 8, v35
    v_and_b32 v34, 7, v34
    v_xor_b32 v36, 0, v34
    v_lshl_add_u32 v8, v36, 5, v35
    v_xor_b32 v36, 1, v34
    v_lshl_add_u32 v9, v36, 5, v35
    v_xor_b32 v36, 2, v34
    v_lshl_add_u32 v10, v36, 5, v35
    v_xor_b32 v36, 3, v34
    v_lshl_add_u32 v11, v36, 5, v35
    v_xor_b32 v36, 4, v34
    v_lshl_add_u32 v12, v36, 5, v35
    v_xor_b32 v36, 5, v34
    v_lshl_add_u32 v13, v36, 5, v35
    v_xor_b32 v36, 6, v34
    v_lshl_add_u32 v14, v36, 5, v35
    v_xor_b32 v36, 7, v34
    v_lshl_add_u32 v15, v36, 5, v35
    ds_read_b64_tr_b16 a[128:129], v8 offset:0
    ds_read_b64_tr_b16 a[130:131], v8 offset:4096
    ds_read_b64_tr_b16 a[132:133], v9 offset:0
    ds_read_b64_tr_b16 a[134:135], v9 offset:4096
    ds_read_b64_tr_b16 a[136:137], v10 offset:0
    ds_read_b64_tr_b16 a[138:139], v10 offset:4096
    ds_read_b64_tr_b16 a[140:141], v11 offset:0
    ds_read_b64_tr_b16 a[142:143], v11 offset:4096
    ds_read_b64_tr_b16 a[144:145], v12 offset:0
    ds_read_b64_tr_b16 a[146:147], v12 offset:4096
    ds_read_b64_tr_b16 a[148:149], v13 offset:0
    ds_read_b64_tr_b16 a[150:151], v13 offset:4096
    ds_read_b64_tr_b16 a[152:153], v14 offset:0
    ds_read_b64_tr_b16 a[154:155], v14 offset:4096
    ds_read_b64_tr_b16 a[156:157], v15 offset:0
    ds_read_b64_tr_b16 a[158:159], v15 offset:4096
    v_add_u32 v48, 0x10000, v8
    v_add_u32 v56, 0x20000, v8
    v_add_u32 v49, 0x10000, v9
    v_add_u32 v57, 0x20000, v9
    v_add_u32 v50, 0x10000, v10
    v_add_u32 v58, 0x20000, v10
    v_add_u32 v51, 0x10000, v11
    v_add_u32 v59, 0x20000, v11
    v_add_u32 v52, 0x10000, v12
    v_add_u32 v60, 0x20000, v12
    v_add_u32 v53, 0x10000, v13
    v_add_u32 v61, 0x20000, v13
    v_add_u32 v54, 0x10000, v14
    v_add_u32 v62, 0x20000, v14
    v_add_u32 v55, 0x10000, v15
    v_add_u32 v63, 0x20000, v15
    s_lshl_b32 s84, s63, 2
    s_add_u32 s84, s84, s60
    s_lshl_b32 s84, s84, 2
    s_add_u32 s84, s84, s65
    s_lshl_b32 s84, s84, 15
    s_lshl_b32 s85, s66, 8
    s_add_u32 s84, s84, s85
    v_and_b32 v34, 15, v0
    v_lshrrev_b32 v35, 4, v0
    v_lshlrev_b32 v36, 11, v34
    v_add_u32 v36, s84, v36
    v_lshl_add_u32 v1, v35, 3, v36
    v_and_b32 v2, 1, v35
    v_lshl_add_u32 v36, v2, 5, v36
    v_lshrrev_b32 v2, 1, v35
    v_lshl_add_u32 v2, v2, 4, v36
    v_lshlrev_b32 v35, 2, v35
    v_sub_u32 v34, v34, v35
    v_mov_b32 v26, 0
    v_mov_b32 v27, 0
    v_mov_b32 v30, 0
    v_mov_b32 v31, 0
    v_mov_b32 v35, 0x3f80
    v_mov_b32 v36, 0x3f800000
    v_cmp_eq_u32 vcc, 0, v34
    s_nop 1
    v_cndmask_b32 v28, v26, v35, vcc
    v_cmp_eq_u32 vcc, 1, v34
    s_nop 1
    v_cndmask_b32 v28, v28, v36, vcc
    v_cmp_eq_u32 vcc, 2, v34
    s_nop 1
    v_cndmask_b32 v29, v26, v35, vcc
    v_cmp_eq_u32 vcc, 3, v34
    s_nop 1
    v_cndmask_b32 v29, v29, v36, vcc
    s_mov_b32 s14, 0xbfb8aa3b
    s_mov_b32 s15, 0xbfb8aa3b
    s_waitcnt vmcnt(31) lgkmcnt(14)
    v_mfma_f32_16x16x32_bf16 v[128:131], a[128:131], a[0:3], 0
    s_waitcnt vmcnt(30)
    v_mfma_f32_16x16x32_bf16 v[160:163], a[128:131], a[4:7], 0
    ds_read_b64_tr_b16 a[160:161], v8 offset:8192
    s_waitcnt vmcnt(29)
    v_mfma_f32_16x16x32_bf16 v[192:195], a[128:131], a[8:11], 0
    ds_read_b64_tr_b16 a[162:163], v8 offset:12288
    s_waitcnt vmcnt(28)
    v_mfma_f32_16x16x32_bf16 v[224:227], a[128:131], a[12:15], 0
    s_waitcnt lgkmcnt(14)
    v_mfma_f32_16x16x32_bf16 v[132:135], a[132:135], a[0:3], 0
    ds_read_b64_tr_b16 a[164:165], v9 offset:8192
    v_mfma_f32_16x16x32_bf16 v[164:167], a[132:135], a[4:7], 0
    ds_read_b64_tr_b16 a[166:167], v9 offset:12288
    v_mfma_f32_16x16x32_bf16 v[196:199], a[132:135], a[8:11], 0
    v_mfma_f32_16x16x32_bf16 v[228:231], a[132:135], a[12:15], 0
    ds_read_b64_tr_b16 a[168:169], v10 offset:8192
    s_waitcnt lgkmcnt(15)
    v_mfma_f32_16x16x32_bf16 v[136:139], a[136:139], a[0:3], 0
    ds_read_b64_tr_b16 a[170:171], v10 offset:12288
    v_mfma_f32_16x16x32_bf16 v[168:171], a[136:139], a[4:7], 0
    v_mfma_f32_16x16x32_bf16 v[200:203], a[136:139], a[8:11], 0
    ds_read_b64_tr_b16 a[172:173], v11 offset:8192
    v_mfma_f32_16x16x32_bf16 v[232:235], a[136:139], a[12:15], 0
    ds_read_b64_tr_b16 a[174:175], v11 offset:12288
    s_waitcnt lgkmcnt(15)
    v_mfma_f32_16x16x32_bf16 v[140:143], a[140:143], a[0:3], 0
    v_mfma_f32_16x16x32_bf16 v[172:175], a[140:143], a[4:7], 0
    ds_read_b64_tr_b16 a[176:177], v12 offset:8192
    v_mfma_f32_16x16x32_bf16 v[204:207], a[140:143], a[8:11], 0
    ds_read_b64_tr_b16 a[178:179], v12 offset:12288
    v_mfma_f32_16x16x32_bf16 v[236:239], a[140:143], a[12:15], 0
    s_waitcnt lgkmcnt(15)
    v_mfma_f32_16x16x32_bf16 v[144:147], a[144:147], a[0:3], 0
    ds_read_b64_tr_b16 a[180:181], v13 offset:8192
    v_mfma_f32_16x16x32_bf16 v[176:179], a[144:147], a[4:7], 0
    ds_read_b64_tr_b16 a[182:183], v13 offset:12288
    v_mfma_f32_16x16x32_bf16 v[208:211], a[144:147], a[8:11], 0
    v_mfma_f32_16x16x32_bf16 v[240:243], a[144:147], a[12:15], 0
    ds_read_b64_tr_b16 a[184:185], v14 offset:8192
    s_waitcnt lgkmcnt(15)
    v_mfma_f32_16x16x32_bf16 v[148:151], a[148:151], a[0:3], 0
    ds_read_b64_tr_b16 a[186:187], v14 offset:12288
    s_mov_b64 exec, 1
    buffer_atomic_add v42, off, s[56:59], s93 sc1
    s_mov_b64 exec, -1
    v_mfma_f32_16x16x32_bf16 v[180:183], a[148:151], a[4:7], 0
    v_mfma_f32_16x16x32_bf16 v[212:215], a[148:151], a[8:11], 0
    ds_read_b64_tr_b16 a[188:189], v15 offset:8192
    v_mfma_f32_16x16x32_bf16 v[244:247], a[148:151], a[12:15], 0
    ds_read_b64_tr_b16 a[190:191], v15 offset:12288
    v_mfma_f32_16x16x32_bf16 v[152:155], a[152:155], a[0:3], 0
    v_mfma_f32_16x16x32_bf16 v[184:187], a[152:155], a[4:7], 0
    v_mfma_f32_16x16x32_bf16 v[216:219], a[152:155], a[8:11], 0
    v_mfma_f32_16x16x32_bf16 v[248:251], a[152:155], a[12:15], 0
    s_waitcnt lgkmcnt(15)
    v_mfma_f32_16x16x32_bf16 v[156:159], a[156:159], a[0:3], 0
    v_mfma_f32_16x16x32_bf16 v[188:191], a[156:159], a[4:7], 0
    v_mfma_f32_16x16x32_bf16 v[220:223], a[156:159], a[8:11], 0
    v_mfma_f32_16x16x32_bf16 v[252:255], a[156:159], a[12:15], 0
    s_waitcnt vmcnt(28) lgkmcnt(14)
    v_mfma_f32_16x16x32_bf16 v[128:131], a[160:163], a[16:19], v[128:131]
    buffer_load_dwordx4 a[0:3], v21, s[56:59], s68 offen sc1
    s_waitcnt vmcnt(28)
    v_mfma_f32_16x16x32_bf16 v[160:163], a[160:163], a[20:23], v[160:163]
    ds_read_b64_tr_b16 a[128:129], v8 offset:16384
    s_waitcnt vmcnt(27)
    v_mfma_f32_16x16x32_bf16 v[192:195], a[160:163], a[24:27], v[192:195]
    ds_read_b64_tr_b16 a[130:131], v8 offset:20480
    buffer_load_dwordx4 a[4:7], v22, s[56:59], s68 offen sc1
    s_waitcnt vmcnt(27)
    v_mfma_f32_16x16x32_bf16 v[224:227], a[160:163], a[28:31], v[224:227]
    s_waitcnt lgkmcnt(14)
    v_mfma_f32_16x16x32_bf16 v[132:135], a[164:167], a[16:19], v[132:135]
    ds_read_b64_tr_b16 a[132:133], v9 offset:16384
    buffer_load_dwordx4 a[8:11], v23, s[56:59], s68 offen sc1
    v_mfma_f32_16x16x32_bf16 v[164:167], a[164:167], a[20:23], v[164:167]
    ds_read_b64_tr_b16 a[134:135], v9 offset:20480
    v_mfma_f32_16x16x32_bf16 v[196:199], a[164:167], a[24:27], v[196:199]
    buffer_load_dwordx4 a[12:15], v24, s[56:59], s68 offen sc1
    v_mfma_f32_16x16x32_bf16 v[228:231], a[164:167], a[28:31], v[228:231]
    ds_read_b64_tr_b16 a[136:137], v10 offset:16384
    s_waitcnt lgkmcnt(15)
    v_mfma_f32_16x16x32_bf16 v[136:139], a[168:171], a[16:19], v[136:139]
    ds_read_b64_tr_b16 a[138:139], v10 offset:20480
    s_add_u32 s68, s68, 16384
    v_mfma_f32_16x16x32_bf16 v[168:171], a[168:171], a[20:23], v[168:171]
    v_mfma_f32_16x16x32_bf16 v[200:203], a[168:171], a[24:27], v[200:203]
    ds_read_b64_tr_b16 a[140:141], v11 offset:16384
    v_mfma_f32_16x16x32_bf16 v[232:235], a[168:171], a[28:31], v[232:235]
    ds_read_b64_tr_b16 a[142:143], v11 offset:20480
    s_waitcnt lgkmcnt(15)
    v_mfma_f32_16x16x32_bf16 v[140:143], a[172:175], a[16:19], v[140:143]
    v_mfma_f32_16x16x32_bf16 v[172:175], a[172:175], a[20:23], v[172:175]
    ds_read_b64_tr_b16 a[144:145], v12 offset:16384
    v_mfma_f32_16x16x32_bf16 v[204:207], a[172:175], a[24:27], v[204:207]
    ds_read_b64_tr_b16 a[146:147], v12 offset:20480
    v_mfma_f32_16x16x32_bf16 v[236:239], a[172:175], a[28:31], v[236:239]
    s_waitcnt lgkmcnt(15)
    v_mfma_f32_16x16x32_bf16 v[144:147], a[176:179], a[16:19], v[144:147]
    ds_read_b64_tr_b16 a[148:149], v13 offset:16384
    v_mfma_f32_16x16x32_bf16 v[176:179], a[176:179], a[20:23], v[176:179]
    ds_read_b64_tr_b16 a[150:151], v13 offset:20480
    v_mfma_f32_16x16x32_bf16 v[208:211], a[176:179], a[24:27], v[208:211]
    v_mfma_f32_16x16x32_bf16 v[240:243], a[176:179], a[28:31], v[240:243]
    ds_read_b64_tr_b16 a[152:153], v14 offset:16384
    s_waitcnt lgkmcnt(15)
    v_mfma_f32_16x16x32_bf16 v[148:151], a[180:183], a[16:19], v[148:151]
    ds_read_b64_tr_b16 a[154:155], v14 offset:20480
    v_mfma_f32_16x16x32_bf16 v[180:183], a[180:183], a[20:23], v[180:183]
    v_mfma_f32_16x16x32_bf16 v[212:215], a[180:183], a[24:27], v[212:215]
    ds_read_b64_tr_b16 a[156:157], v15 offset:16384
    v_mfma_f32_16x16x32_bf16 v[244:247], a[180:183], a[28:31], v[244:247]
    ds_read_b64_tr_b16 a[158:159], v15 offset:20480
    v_mfma_f32_16x16x32_bf16 v[152:155], a[184:187], a[16:19], v[152:155]
    v_mfma_f32_16x16x32_bf16 v[184:187], a[184:187], a[20:23], v[184:187]
    v_mfma_f32_16x16x32_bf16 v[216:219], a[184:187], a[24:27], v[216:219]
    v_mfma_f32_16x16x32_bf16 v[248:251], a[184:187], a[28:31], v[248:251]
    s_waitcnt lgkmcnt(15)
    v_mfma_f32_16x16x32_bf16 v[156:159], a[188:191], a[16:19], v[156:159]
    v_mfma_f32_16x16x32_bf16 v[188:191], a[188:191], a[20:23], v[188:191]
    v_mfma_f32_16x16x32_bf16 v[220:223], a[188:191], a[24:27], v[220:223]
    v_mfma_f32_16x16x32_bf16 v[252:255], a[188:191], a[28:31], v[252:255]
    s_waitcnt vmcnt(28) lgkmcnt(14)
    v_mfma_f32_16x16x32_bf16 v[128:131], a[128:131], a[32:35], v[128:131]
    buffer_load_dwordx4 a[16:19], v21, s[56:59], s68 offen sc1
    s_waitcnt vmcnt(28)
    v_mfma_f32_16x16x32_bf16 v[160:163], a[128:131], a[36:39], v[160:163]
    ds_read_b64_tr_b16 a[160:161], v8 offset:24576
    s_waitcnt vmcnt(27)
    v_mfma_f32_16x16x32_bf16 v[192:195], a[128:131], a[40:43], v[192:195]
    ds_read_b64_tr_b16 a[162:163], v8 offset:28672
    buffer_load_dwordx4 a[20:23], v22, s[56:59], s68 offen sc1
    s_waitcnt vmcnt(27)
    v_mfma_f32_16x16x32_bf16 v[224:227], a[128:131], a[44:47], v[224:227]
    s_waitcnt lgkmcnt(14)
    v_mfma_f32_16x16x32_bf16 v[132:135], a[132:135], a[32:35], v[132:135]
    ds_read_b64_tr_b16 a[164:165], v9 offset:24576
    buffer_load_dwordx4 a[24:27], v23, s[56:59], s68 offen sc1
    v_mfma_f32_16x16x32_bf16 v[164:167], a[132:135], a[36:39], v[164:167]
    ds_read_b64_tr_b16 a[166:167], v9 offset:28672
    v_mfma_f32_16x16x32_bf16 v[196:199], a[132:135], a[40:43], v[196:199]
    buffer_load_dwordx4 a[28:31], v24, s[56:59], s68 offen sc1
    v_mfma_f32_16x16x32_bf16 v[228:231], a[132:135], a[44:47], v[228:231]
    ds_read_b64_tr_b16 a[168:169], v10 offset:24576
    s_waitcnt lgkmcnt(15)
    v_mfma_f32_16x16x32_bf16 v[136:139], a[136:139], a[32:35], v[136:139]
    ds_read_b64_tr_b16 a[170:171], v10 offset:28672
    s_add_u32 s68, s68, 16384
    v_mfma_f32_16x16x32_bf16 v[168:171], a[136:139], a[36:39], v[168:171]
    v_mfma_f32_16x16x32_bf16 v[200:203], a[136:139], a[40:43], v[200:203]
    ds_read_b64_tr_b16 a[172:173], v11 offset:24576
    global_load_dwordx2 v[66:67], v1, s[8:9] offset:0
    v_mfma_f32_16x16x32_bf16 v[232:235], a[136:139], a[44:47], v[232:235]
    ds_read_b64_tr_b16 a[174:175], v11 offset:28672
    s_waitcnt lgkmcnt(15)
    v_mfma_f32_16x16x32_bf16 v[140:143], a[140:143], a[32:35], v[140:143]
    global_load_dwordx2 v[70:71], v1, s[8:9] offset:32
    v_mfma_f32_16x16x32_bf16 v[172:175], a[140:143], a[36:39], v[172:175]
    ds_read_b64_tr_b16 a[176:177], v12 offset:24576
    v_mfma_f32_16x16x32_bf16 v[204:207], a[140:143], a[40:43], v[204:207]
    ds_read_b64_tr_b16 a[178:179], v12 offset:28672
    global_load_dwordx2 v[74:75], v1, s[8:9] offset:64
    v_mfma_f32_16x16x32_bf16 v[236:239], a[140:143], a[44:47], v[236:239]
    s_waitcnt lgkmcnt(15)
    v_mfma_f32_16x16x32_bf16 v[144:147], a[144:147], a[32:35], v[144:147]
    ds_read_b64_tr_b16 a[180:181], v13 offset:24576
    global_load_dwordx2 v[78:79], v1, s[8:9] offset:96
    v_mfma_f32_16x16x32_bf16 v[176:179], a[144:147], a[36:39], v[176:179]
    ds_read_b64_tr_b16 a[182:183], v13 offset:28672
    v_mfma_f32_16x16x32_bf16 v[208:211], a[144:147], a[40:43], v[208:211]
    global_load_dwordx2 v[82:83], v1, s[8:9] offset:128
    v_mfma_f32_16x16x32_bf16 v[240:243], a[144:147], a[44:47], v[240:243]
    ds_read_b64_tr_b16 a[184:185], v14 offset:24576
    s_waitcnt lgkmcnt(15)
    v_mfma_f32_16x16x32_bf16 v[148:151], a[148:151], a[32:35], v[148:151]
    ds_read_b64_tr_b16 a[186:187], v14 offset:28672
    global_load_dwordx2 v[86:87], v1, s[8:9] offset:160
    v_mfma_f32_16x16x32_bf16 v[180:183], a[148:151], a[36:39], v[180:183]
    v_mfma_f32_16x16x32_bf16 v[212:215], a[148:151], a[40:43], v[212:215]
    ds_read_b64_tr_b16 a[188:189], v15 offset:24576
    global_load_dwordx2 v[90:91], v1, s[8:9] offset:192
    v_mfma_f32_16x16x32_bf16 v[244:247], a[148:151], a[44:47], v[244:247]
    ds_read_b64_tr_b16 a[190:191], v15 offset:28672
    v_mfma_f32_16x16x32_bf16 v[152:155], a[152:155], a[32:35], v[152:155]
    global_load_dwordx2 v[94:95], v1, s[8:9] offset:224
    v_mfma_f32_16x16x32_bf16 v[184:187], a[152:155], a[36:39], v[184:187]
    v_mfma_f32_16x16x32_bf16 v[216:219], a[152:155], a[40:43], v[216:219]
    v_mfma_f32_16x16x32_bf16 v[248:251], a[152:155], a[44:47], v[248:251]
    s_waitcnt lgkmcnt(15)
    v_mfma_f32_16x16x32_bf16 v[156:159], a[156:159], a[32:35], v[156:159]
    v_mfma_f32_16x16x32_bf16 v[188:191], a[156:159], a[36:39], v[188:191]
    v_mfma_f32_16x16x32_bf16 v[220:223], a[156:159], a[40:43], v[220:223]
    v_mfma_f32_16x16x32_bf16 v[252:255], a[156:159], a[44:47], v[252:255]
    s_waitcnt vmcnt(36) lgkmcnt(14)
    v_mfma_f32_16x16x32_bf16 v[128:131], a[160:163], a[48:51], v[128:131]
    buffer_load_dwordx4 a[32:35], v21, s[56:59], s68 offen sc1
    s_waitcnt vmcnt(36)
    v_mfma_f32_16x16x32_bf16 v[160:163], a[160:163], a[52:55], v[160:163]
    ds_read_b64_tr_b16 a[128:129], v8 offset:32768
    s_waitcnt vmcnt(35)
    v_mfma_f32_16x16x32_bf16 v[192:195], a[160:163], a[56:59], v[192:195]
    ds_read_b64_tr_b16 a[130:131], v8 offset:36864
    buffer_load_dwordx4 a[36:39], v22, s[56:59], s68 offen sc1
    s_waitcnt vmcnt(35)
    v_mfma_f32_16x16x32_bf16 v[224:227], a[160:163], a[60:63], v[224:227]
    s_waitcnt lgkmcnt(14)
    v_mfma_f32_16x16x32_bf16 v[132:135], a[164:167], a[48:51], v[132:135]
    ds_read_b64_tr_b16 a[132:133], v9 offset:32768
    buffer_load_dwordx4 a[40:43], v23, s[56:59], s68 offen sc1
    v_mfma_f32_16x16x32_bf16 v[164:167], a[164:167], a[52:55], v[164:167]
    ds_read_b64_tr_b16 a[134:135], v9 offset:36864
    v_mfma_f32_16x16x32_bf16 v[196:199], a[164:167], a[56:59], v[196:199]
    buffer_load_dwordx4 a[44:47], v24, s[56:59], s68 offen sc1
    v_mfma_f32_16x16x32_bf16 v[228:231], a[164:167], a[60:63], v[228:231]
    ds_read_b64_tr_b16 a[136:137], v10 offset:32768
    s_waitcnt lgkmcnt(15)
    v_mfma_f32_16x16x32_bf16 v[136:139], a[168:171], a[48:51], v[136:139]
    ds_read_b64_tr_b16 a[138:139], v10 offset:36864
    s_add_u32 s68, s68, 16384
    v_mfma_f32_16x16x32_bf16 v[168:171], a[168:171], a[52:55], v[168:171]
    v_mfma_f32_16x16x32_bf16 v[200:203], a[168:171], a[56:59], v[200:203]
    ds_read_b64_tr_b16 a[140:141], v11 offset:32768
    v_mfma_f32_16x16x32_bf16 v[232:235], a[168:171], a[60:63], v[232:235]
    ds_read_b64_tr_b16 a[142:143], v11 offset:36864
    s_waitcnt lgkmcnt(15)
    v_mfma_f32_16x16x32_bf16 v[140:143], a[172:175], a[48:51], v[140:143]
    v_mfma_f32_16x16x32_bf16 v[172:175], a[172:175], a[52:55], v[172:175]
    ds_read_b64_tr_b16 a[144:145], v12 offset:32768
    v_mfma_f32_16x16x32_bf16 v[204:207], a[172:175], a[56:59], v[204:207]
    ds_read_b64_tr_b16 a[146:147], v12 offset:36864
    v_mfma_f32_16x16x32_bf16 v[236:239], a[172:175], a[60:63], v[236:239]
    s_waitcnt lgkmcnt(15)
    v_mfma_f32_16x16x32_bf16 v[144:147], a[176:179], a[48:51], v[144:147]
    ds_read_b64_tr_b16 a[148:149], v13 offset:32768
    v_mfma_f32_16x16x32_bf16 v[176:179], a[176:179], a[52:55], v[176:179]
    ds_read_b64_tr_b16 a[150:151], v13 offset:36864
    v_mfma_f32_16x16x32_bf16 v[208:211], a[176:179], a[56:59], v[208:211]
    v_mfma_f32_16x16x32_bf16 v[240:243], a[176:179], a[60:63], v[240:243]
    ds_read_b64_tr_b16 a[152:153], v14 offset:32768
    s_waitcnt lgkmcnt(15)
    v_mfma_f32_16x16x32_bf16 v[148:151], a[180:183], a[48:51], v[148:151]
    ds_read_b64_tr_b16 a[154:155], v14 offset:36864
    v_mfma_f32_16x16x32_bf16 v[180:183], a[180:183], a[52:55], v[180:183]
    v_mfma_f32_16x16x32_bf16 v[212:215], a[180:183], a[56:59], v[212:215]
    ds_read_b64_tr_b16 a[156:157], v15 offset:32768
    v_mfma_f32_16x16x32_bf16 v[244:247], a[180:183], a[60:63], v[244:247]
    ds_read_b64_tr_b16 a[158:159], v15 offset:36864
    v_mfma_f32_16x16x32_bf16 v[152:155], a[184:187], a[48:51], v[152:155]
    v_mfma_f32_16x16x32_bf16 v[184:187], a[184:187], a[52:55], v[184:187]
    v_mfma_f32_16x16x32_bf16 v[216:219], a[184:187], a[56:59], v[216:219]
    v_mfma_f32_16x16x32_bf16 v[248:251], a[184:187], a[60:63], v[248:251]
    s_waitcnt lgkmcnt(15)
    v_mfma_f32_16x16x32_bf16 v[156:159], a[188:191], a[48:51], v[156:159]
    buffer_load_dword v43, off, s[56:59], s92 sc1
    v_mfma_f32_16x16x32_bf16 v[188:191], a[188:191], a[52:55], v[188:191]
    v_mfma_f32_16x16x32_bf16 v[220:223], a[188:191], a[56:59], v[220:223]
    v_mfma_f32_16x16x32_bf16 v[252:255], a[188:191], a[60:63], v[252:255]
    s_waitcnt vmcnt(37) lgkmcnt(14)
    v_mfma_f32_16x16x32_bf16 v[128:131], a[128:131], a[64:67], v[128:131]
    buffer_load_dwordx4 a[48:51], v21, s[56:59], s68 offen sc1
    s_waitcnt vmcnt(37)
    v_mfma_f32_16x16x32_bf16 v[160:163], a[128:131], a[68:71], v[160:163]
    ds_read_b64_tr_b16 a[160:161], v8 offset:40960
    s_waitcnt vmcnt(36)
    v_mfma_f32_16x16x32_bf16 v[192:195], a[128:131], a[72:75], v[192:195]
    ds_read_b64_tr_b16 a[162:163], v8 offset:45056
    buffer_load_dwordx4 a[52:55], v22, s[56:59], s68 offen sc1
    s_waitcnt vmcnt(36)
    v_mfma_f32_16x16x32_bf16 v[224:227], a[128:131], a[76:79], v[224:227]
    s_waitcnt lgkmcnt(14)
    v_mfma_f32_16x16x32_bf16 v[132:135], a[132:135], a[64:67], v[132:135]
    ds_read_b64_tr_b16 a[164:165], v9 offset:40960
    buffer_load_dwordx4 a[56:59], v23, s[56:59], s68 offen sc1
    v_mfma_f32_16x16x32_bf16 v[164:167], a[132:135], a[68:71], v[164:167]
    ds_read_b64_tr_b16 a[166:167], v9 offset:45056
    v_mfma_f32_16x16x32_bf16 v[196:199], a[132:135], a[72:75], v[196:199]
    buffer_load_dwordx4 a[60:63], v24, s[56:59], s68 offen sc1
    v_mfma_f32_16x16x32_bf16 v[228:231], a[132:135], a[76:79], v[228:231]
    ds_read_b64_tr_b16 a[168:169], v10 offset:40960
    s_waitcnt lgkmcnt(15)
    v_mfma_f32_16x16x32_bf16 v[136:139], a[136:139], a[64:67], v[136:139]
    ds_read_b64_tr_b16 a[170:171], v10 offset:45056
    s_add_u32 s68, s68, 16384
    v_mfma_f32_16x16x32_bf16 v[168:171], a[136:139], a[68:71], v[168:171]
    v_mfma_f32_16x16x32_bf16 v[200:203], a[136:139], a[72:75], v[200:203]
    ds_read_b64_tr_b16 a[172:173], v11 offset:40960
    v_mfma_f32_16x16x32_bf16 v[232:235], a[136:139], a[76:79], v[232:235]
    ds_read_b64_tr_b16 a[174:175], v11 offset:45056
    s_waitcnt lgkmcnt(15)
    v_mfma_f32_16x16x32_bf16 v[140:143], a[140:143], a[64:67], v[140:143]
    v_mfma_f32_16x16x32_bf16 v[172:175], a[140:143], a[68:71], v[172:175]
    ds_read_b64_tr_b16 a[176:177], v12 offset:40960
    v_mfma_f32_16x16x32_bf16 v[204:207], a[140:143], a[72:75], v[204:207]
    ds_read_b64_tr_b16 a[178:179], v12 offset:45056
    v_mfma_f32_16x16x32_bf16 v[236:239], a[140:143], a[76:79], v[236:239]
    s_waitcnt lgkmcnt(15)
    v_mfma_f32_16x16x32_bf16 v[144:147], a[144:147], a[64:67], v[144:147]
    ds_read_b64_tr_b16 a[180:181], v13 offset:40960
    v_mfma_f32_16x16x32_bf16 v[176:179], a[144:147], a[68:71], v[176:179]
    ds_read_b64_tr_b16 a[182:183], v13 offset:45056
    v_mfma_f32_16x16x32_bf16 v[208:211], a[144:147], a[72:75], v[208:211]
    v_mfma_f32_16x16x32_bf16 v[240:243], a[144:147], a[76:79], v[240:243]
    ds_read_b64_tr_b16 a[184:185], v14 offset:40960
    s_waitcnt lgkmcnt(15)
    v_mfma_f32_16x16x32_bf16 v[148:151], a[148:151], a[64:67], v[148:151]
    ds_read_b64_tr_b16 a[186:187], v14 offset:45056
    v_mfma_f32_16x16x32_bf16 v[180:183], a[148:151], a[68:71], v[180:183]
    v_mfma_f32_16x16x32_bf16 v[212:215], a[148:151], a[72:75], v[212:215]
    ds_read_b64_tr_b16 a[188:189], v15 offset:40960
    v_mfma_f32_16x16x32_bf16 v[244:247], a[148:151], a[76:79], v[244:247]
    ds_read_b64_tr_b16 a[190:191], v15 offset:45056
    v_mfma_f32_16x16x32_bf16 v[152:155], a[152:155], a[64:67], v[152:155]
    v_mfma_f32_16x16x32_bf16 v[184:187], a[152:155], a[68:71], v[184:187]
    v_mfma_f32_16x16x32_bf16 v[216:219], a[152:155], a[72:75], v[216:219]
    v_mfma_f32_16x16x32_bf16 v[248:251], a[152:155], a[76:79], v[248:251]
    s_waitcnt lgkmcnt(15)
    v_mfma_f32_16x16x32_bf16 v[156:159], a[156:159], a[64:67], v[156:159]
    v_mfma_f32_16x16x32_bf16 v[188:191], a[156:159], a[68:71], v[188:191]
    v_mfma_f32_16x16x32_bf16 v[220:223], a[156:159], a[72:75], v[220:223]
    v_mfma_f32_16x16x32_bf16 v[252:255], a[156:159], a[76:79], v[252:255]
    s_waitcnt vmcnt(37) lgkmcnt(14)
    v_mfma_f32_16x16x32_bf16 v[128:131], a[160:163], a[80:83], v[128:131]
    buffer_load_dwordx4 a[64:67], v21, s[56:59], s68 offen sc1
    s_waitcnt vmcnt(37)
    v_mfma_f32_16x16x32_bf16 v[160:163], a[160:163], a[84:87], v[160:163]
    ds_read_b64_tr_b16 a[128:129], v8 offset:49152
    s_waitcnt vmcnt(36)
    v_mfma_f32_16x16x32_bf16 v[192:195], a[160:163], a[88:91], v[192:195]
    ds_read_b64_tr_b16 a[130:131], v8 offset:53248
    buffer_load_dwordx4 a[68:71], v22, s[56:59], s68 offen sc1
    s_waitcnt vmcnt(36)
    v_mfma_f32_16x16x32_bf16 v[224:227], a[160:163], a[92:95], v[224:227]
    s_waitcnt lgkmcnt(14)
    v_mfma_f32_16x16x32_bf16 v[132:135], a[164:167], a[80:83], v[132:135]
    ds_read_b64_tr_b16 a[132:133], v9 offset:49152
    buffer_load_dwordx4 a[72:75], v23, s[56:59], s68 offen sc1
    v_mfma_f32_16x16x32_bf16 v[164:167], a[164:167], a[84:87], v[164:167]
    ds_read_b64_tr_b16 a[134:135], v9 offset:53248
    v_mfma_f32_16x16x32_bf16 v[196:199], a[164:167], a[88:91], v[196:199]
    buffer_load_dwordx4 a[76:79], v24, s[56:59], s68 offen sc1
    v_mfma_f32_16x16x32_bf16 v[228:231], a[164:167], a[92:95], v[228:231]
    ds_read_b64_tr_b16 a[136:137], v10 offset:49152
    s_waitcnt lgkmcnt(15)
    v_mfma_f32_16x16x32_bf16 v[136:139], a[168:171], a[80:83], v[136:139]
    ds_read_b64_tr_b16 a[138:139], v10 offset:53248
    s_add_u32 s68, s68, 16384
    v_mfma_f32_16x16x32_bf16 v[168:171], a[168:171], a[84:87], v[168:171]
    v_mfma_f32_16x16x32_bf16 v[200:203], a[168:171], a[88:91], v[200:203]
    ds_read_b64_tr_b16 a[140:141], v11 offset:49152
    v_mfma_f32_16x16x32_bf16 v[232:235], a[168:171], a[92:95], v[232:235]
    ds_read_b64_tr_b16 a[142:143], v11 offset:53248
    s_waitcnt lgkmcnt(15)
    v_mfma_f32_16x16x32_bf16 v[140:143], a[172:175], a[80:83], v[140:143]
    v_mfma_f32_16x16x32_bf16 v[172:175], a[172:175], a[84:87], v[172:175]
    ds_read_b64_tr_b16 a[144:145], v12 offset:49152
    v_mfma_f32_16x16x32_bf16 v[204:207], a[172:175], a[88:91], v[204:207]
    ds_read_b64_tr_b16 a[146:147], v12 offset:53248
    v_mfma_f32_16x16x32_bf16 v[236:239], a[172:175], a[92:95], v[236:239]
    s_waitcnt lgkmcnt(15)
    v_mfma_f32_16x16x32_bf16 v[144:147], a[176:179], a[80:83], v[144:147]
    ds_read_b64_tr_b16 a[148:149], v13 offset:49152
    v_mfma_f32_16x16x32_bf16 v[176:179], a[176:179], a[84:87], v[176:179]
    ds_read_b64_tr_b16 a[150:151], v13 offset:53248
    v_mfma_f32_16x16x32_bf16 v[208:211], a[176:179], a[88:91], v[208:211]
    v_mfma_f32_16x16x32_bf16 v[240:243], a[176:179], a[92:95], v[240:243]
    ds_read_b64_tr_b16 a[152:153], v14 offset:49152
    s_waitcnt lgkmcnt(15)
    v_mfma_f32_16x16x32_bf16 v[148:151], a[180:183], a[80:83], v[148:151]
    ds_read_b64_tr_b16 a[154:155], v14 offset:53248
    v_mfma_f32_16x16x32_bf16 v[180:183], a[180:183], a[84:87], v[180:183]
    v_mfma_f32_16x16x32_bf16 v[212:215], a[180:183], a[88:91], v[212:215]
    ds_read_b64_tr_b16 a[156:157], v15 offset:49152
    v_mfma_f32_16x16x32_bf16 v[244:247], a[180:183], a[92:95], v[244:247]
    ds_read_b64_tr_b16 a[158:159], v15 offset:53248
    v_mfma_f32_16x16x32_bf16 v[152:155], a[184:187], a[80:83], v[152:155]
    v_mfma_f32_16x16x32_bf16 v[184:187], a[184:187], a[84:87], v[184:187]
    v_mfma_f32_16x16x32_bf16 v[216:219], a[184:187], a[88:91], v[216:219]
    v_mfma_f32_16x16x32_bf16 v[248:251], a[184:187], a[92:95], v[248:251]
    s_waitcnt lgkmcnt(15)
    v_mfma_f32_16x16x32_bf16 v[156:159], a[188:191], a[80:83], v[156:159]
    v_mfma_f32_16x16x32_bf16 v[188:191], a[188:191], a[84:87], v[188:191]
    v_mfma_f32_16x16x32_bf16 v[220:223], a[188:191], a[88:91], v[220:223]
    v_mfma_f32_16x16x32_bf16 v[252:255], a[188:191], a[92:95], v[252:255]
    s_waitcnt vmcnt(37) lgkmcnt(14)
    v_mfma_f32_16x16x32_bf16 v[128:131], a[128:131], a[96:99], v[128:131]
    buffer_load_dwordx4 a[80:83], v21, s[56:59], s68 offen sc1
    s_waitcnt vmcnt(37)
    v_mfma_f32_16x16x32_bf16 v[160:163], a[128:131], a[100:103], v[160:163]
    ds_read_b64_tr_b16 a[160:161], v8 offset:57344
    s_waitcnt vmcnt(36)
    v_mfma_f32_16x16x32_bf16 v[192:195], a[128:131], a[104:107], v[192:195]
    ds_read_b64_tr_b16 a[162:163], v8 offset:61440
    buffer_load_dwordx4 a[84:87], v22, s[56:59], s68 offen sc1
    s_waitcnt vmcnt(36)
    v_mfma_f32_16x16x32_bf16 v[224:227], a[128:131], a[108:111], v[224:227]
    s_waitcnt lgkmcnt(14)
    v_mfma_f32_16x16x32_bf16 v[132:135], a[132:135], a[96:99], v[132:135]
    ds_read_b64_tr_b16 a[164:165], v9 offset:57344
    buffer_load_dwordx4 a[88:91], v23, s[56:59], s68 offen sc1
    v_mfma_f32_16x16x32_bf16 v[164:167], a[132:135], a[100:103], v[164:167]
    ds_read_b64_tr_b16 a[166:167], v9 offset:61440
    v_mfma_f32_16x16x32_bf16 v[196:199], a[132:135], a[104:107], v[196:199]
    buffer_load_dwordx4 a[92:95], v24, s[56:59], s68 offen sc1
    v_mfma_f32_16x16x32_bf16 v[228:231], a[132:135], a[108:111], v[228:231]
    ds_read_b64_tr_b16 a[168:169], v10 offset:57344
    s_waitcnt lgkmcnt(15)
    v_mfma_f32_16x16x32_bf16 v[136:139], a[136:139], a[96:99], v[136:139]
    ds_read_b64_tr_b16 a[170:171], v10 offset:61440
    s_add_u32 s68, s68, 16384
    v_mfma_f32_16x16x32_bf16 v[168:171], a[136:139], a[100:103], v[168:171]
    v_mfma_f32_16x16x32_bf16 v[200:203], a[136:139], a[104:107], v[200:203]
    ds_read_b64_tr_b16 a[172:173], v11 offset:57344
    v_mfma_f32_16x16x32_bf16 v[232:235], a[136:139], a[108:111], v[232:235]
    ds_read_b64_tr_b16 a[174:175], v11 offset:61440
    s_waitcnt lgkmcnt(15)
    v_mfma_f32_16x16x32_bf16 v[140:143], a[140:143], a[96:99], v[140:143]
    v_mfma_f32_16x16x32_bf16 v[172:175], a[140:143], a[100:103], v[172:175]
    ds_read_b64_tr_b16 a[176:177], v12 offset:57344
    v_mfma_f32_16x16x32_bf16 v[204:207], a[140:143], a[104:107], v[204:207]
    ds_read_b64_tr_b16 a[178:179], v12 offset:61440
    v_mfma_f32_16x16x32_bf16 v[236:239], a[140:143], a[108:111], v[236:239]
    s_waitcnt lgkmcnt(15)
    v_mfma_f32_16x16x32_bf16 v[144:147], a[144:147], a[96:99], v[144:147]
    ds_read_b64_tr_b16 a[180:181], v13 offset:57344
    v_mfma_f32_16x16x32_bf16 v[176:179], a[144:147], a[100:103], v[176:179]
    ds_read_b64_tr_b16 a[182:183], v13 offset:61440
    v_mfma_f32_16x16x32_bf16 v[208:211], a[144:147], a[104:107], v[208:211]
    v_mfma_f32_16x16x32_bf16 v[240:243], a[144:147], a[108:111], v[240:243]
    ds_read_b64_tr_b16 a[184:185], v14 offset:57344
    s_waitcnt lgkmcnt(15)
    v_mfma_f32_16x16x32_bf16 v[148:151], a[148:151], a[96:99], v[148:151]
    ds_read_b64_tr_b16 a[186:187], v14 offset:61440
    v_mfma_f32_16x16x32_bf16 v[180:183], a[148:151], a[100:103], v[180:183]
    v_mfma_f32_16x16x32_bf16 v[212:215], a[148:151], a[104:107], v[212:215]
    ds_read_b64_tr_b16 a[188:189], v15 offset:57344
    v_mfma_f32_16x16x32_bf16 v[244:247], a[148:151], a[108:111], v[244:247]
    ds_read_b64_tr_b16 a[190:191], v15 offset:61440
    v_mfma_f32_16x16x32_bf16 v[152:155], a[152:155], a[96:99], v[152:155]
    v_mfma_f32_16x16x32_bf16 v[184:187], a[152:155], a[100:103], v[184:187]
    v_mfma_f32_16x16x32_bf16 v[216:219], a[152:155], a[104:107], v[216:219]
    v_mfma_f32_16x16x32_bf16 v[248:251], a[152:155], a[108:111], v[248:251]
    s_waitcnt lgkmcnt(15)
    v_mfma_f32_16x16x32_bf16 v[156:159], a[156:159], a[96:99], v[156:159]
    v_mfma_f32_16x16x32_bf16 v[188:191], a[156:159], a[100:103], v[188:191]
    v_mfma_f32_16x16x32_bf16 v[220:223], a[156:159], a[104:107], v[220:223]
    v_mfma_f32_16x16x32_bf16 v[252:255], a[156:159], a[108:111], v[252:255]
    s_waitcnt vmcnt(37) lgkmcnt(14)
    v_mfma_f32_16x16x32_bf16 v[128:131], a[160:163], a[112:115], v[128:131]
    buffer_load_dwordx4 a[96:99], v21, s[56:59], s68 offen sc1
    s_waitcnt vmcnt(37)
    v_mfma_f32_16x16x32_bf16 v[160:163], a[160:163], a[116:119], v[160:163]
    ds_read_b64_tr_b16 a[128:129], v48 offset:0
    s_waitcnt vmcnt(36)
    v_mfma_f32_16x16x32_bf16 v[192:195], a[160:163], a[120:123], v[192:195]
    ds_read_b64_tr_b16 a[130:131], v48 offset:4096
    buffer_load_dwordx4 a[100:103], v22, s[56:59], s68 offen sc1
    s_waitcnt vmcnt(36)
    v_mfma_f32_16x16x32_bf16 v[224:227], a[160:163], a[124:127], v[224:227]
    s_waitcnt lgkmcnt(14)
    v_mfma_f32_16x16x32_bf16 v[132:135], a[164:167], a[112:115], v[132:135]
    ds_read_b64_tr_b16 a[132:133], v49 offset:0
    buffer_load_dwordx4 a[104:107], v23, s[56:59], s68 offen sc1
    v_mfma_f32_16x16x32_bf16 v[164:167], a[164:167], a[116:119], v[164:167]
    ds_read_b64_tr_b16 a[134:135], v49 offset:4096
    v_mfma_f32_16x16x32_bf16 v[196:199], a[164:167], a[120:123], v[196:199]
    buffer_load_dwordx4 a[108:111], v24, s[56:59], s68 offen sc1
    v_mfma_f32_16x16x32_bf16 v[228:231], a[164:167], a[124:127], v[228:231]
    ds_read_b64_tr_b16 a[136:137], v50 offset:0
    s_waitcnt lgkmcnt(15)
    v_mfma_f32_16x16x32_bf16 v[136:139], a[168:171], a[112:115], v[136:139]
    ds_read_b64_tr_b16 a[138:139], v50 offset:4096
    s_add_u32 s68, s68, 16384
    v_mfma_f32_16x16x32_bf16 v[168:171], a[168:171], a[116:119], v[168:171]
    v_mfma_f32_16x16x32_bf16 v[200:203], a[168:171], a[120:123], v[200:203]
    ds_read_b64_tr_b16 a[140:141], v51 offset:0
    v_mfma_f32_16x16x32_bf16 v[232:235], a[168:171], a[124:127], v[232:235]
    ds_read_b64_tr_b16 a[142:143], v51 offset:4096
    s_waitcnt lgkmcnt(15)
    v_mfma_f32_16x16x32_bf16 v[140:143], a[172:175], a[112:115], v[140:143]
    v_mfma_f32_16x16x32_bf16 v[172:175], a[172:175], a[116:119], v[172:175]
    ds_read_b64_tr_b16 a[144:145], v52 offset:0
    v_mfma_f32_16x16x32_bf16 v[204:207], a[172:175], a[120:123], v[204:207]
    ds_read_b64_tr_b16 a[146:147], v52 offset:4096
    v_mfma_f32_16x16x32_bf16 v[236:239], a[172:175], a[124:127], v[236:239]
    s_waitcnt lgkmcnt(15)
    v_mfma_f32_16x16x32_bf16 v[144:147], a[176:179], a[112:115], v[144:147]
    ds_read_b64_tr_b16 a[148:149], v53 offset:0
    v_mfma_f32_16x16x32_bf16 v[176:179], a[176:179], a[116:119], v[176:179]
    ds_read_b64_tr_b16 a[150:151], v53 offset:4096
    v_mfma_f32_16x16x32_bf16 v[208:211], a[176:179], a[120:123], v[208:211]
    v_mfma_f32_16x16x32_bf16 v[240:243], a[176:179], a[124:127], v[240:243]
    ds_read_b64_tr_b16 a[152:153], v54 offset:0
    s_waitcnt lgkmcnt(15)
    v_mfma_f32_16x16x32_bf16 v[148:151], a[180:183], a[112:115], v[148:151]
    ds_read_b64_tr_b16 a[154:155], v54 offset:4096
    v_mfma_f32_16x16x32_bf16 v[180:183], a[180:183], a[116:119], v[180:183]
    v_mfma_f32_16x16x32_bf16 v[212:215], a[180:183], a[120:123], v[212:215]
    ds_read_b64_tr_b16 a[156:157], v55 offset:0
    v_mfma_f32_16x16x32_bf16 v[244:247], a[180:183], a[124:127], v[244:247]
    ds_read_b64_tr_b16 a[158:159], v55 offset:4096
    v_mfma_f32_16x16x32_bf16 v[152:155], a[184:187], a[112:115], v[152:155]
    v_mfma_f32_16x16x32_bf16 v[184:187], a[184:187], a[116:119], v[184:187]
    v_mfma_f32_16x16x32_bf16 v[216:219], a[184:187], a[120:123], v[216:219]
    v_mfma_f32_16x16x32_bf16 v[248:251], a[184:187], a[124:127], v[248:251]
    s_waitcnt lgkmcnt(15)
    v_mfma_f32_16x16x32_bf16 v[156:159], a[188:191], a[112:115], v[156:159]
    v_mfma_f32_16x16x32_bf16 v[188:191], a[188:191], a[116:119], v[188:191]
    v_mfma_f32_16x16x32_bf16 v[220:223], a[188:191], a[120:123], v[220:223]
    v_mfma_f32_16x16x32_bf16 v[252:255], a[188:191], a[124:127], v[252:255]
    s_barrier
    s_waitcnt vmcnt(36) lgkmcnt(14)
    v_mfma_f32_16x16x32_bf16 v[128:131], a[128:131], a[0:3], v[128:131]
    buffer_load_dwordx4 a[112:115], v21, s[56:59], s68 offen sc1
    s_waitcnt vmcnt(36)
    v_mfma_f32_16x16x32_bf16 v[160:163], a[128:131], a[4:7], v[160:163]
    ds_read_b64_tr_b16 a[160:161], v48 offset:8192
    s_waitcnt vmcnt(35)
    v_mfma_f32_16x16x32_bf16 v[192:195], a[128:131], a[8:11], v[192:195]
    ds_read_b64_tr_b16 a[162:163], v48 offset:12288
    buffer_load_dwordx4 a[116:119], v22, s[56:59], s68 offen sc1
    s_waitcnt vmcnt(35)
    v_mfma_f32_16x16x32_bf16 v[224:227], a[128:131], a[12:15], v[224:227]
    s_waitcnt lgkmcnt(14)
    v_mfma_f32_16x16x32_bf16 v[132:135], a[132:135], a[0:3], v[132:135]
    ds_read_b64_tr_b16 a[164:165], v49 offset:8192
    buffer_load_dwordx4 a[120:123], v23, s[56:59], s68 offen sc1
    v_mfma_f32_16x16x32_bf16 v[164:167], a[132:135], a[4:7], v[164:167]
    ds_read_b64_tr_b16 a[166:167], v49 offset:12288
    v_mfma_f32_16x16x32_bf16 v[196:199], a[132:135], a[8:11], v[196:199]
    buffer_load_dwordx4 a[124:127], v24, s[56:59], s68 offen sc1
    v_mfma_f32_16x16x32_bf16 v[228:231], a[132:135], a[12:15], v[228:231]
    ds_read_b64_tr_b16 a[168:169], v50 offset:8192
    s_waitcnt lgkmcnt(15)
    v_mfma_f32_16x16x32_bf16 v[136:139], a[136:139], a[0:3], v[136:139]
    ds_read_b64_tr_b16 a[170:171], v50 offset:12288
    s_add_u32 s68, s68, 16384
    v_mfma_f32_16x16x32_bf16 v[168:171], a[136:139], a[4:7], v[168:171]
    v_mfma_f32_16x16x32_bf16 v[200:203], a[136:139], a[8:11], v[200:203]
    ds_read_b64_tr_b16 a[172:173], v51 offset:8192
    v_mfma_f32_16x16x32_bf16 v[232:235], a[136:139], a[12:15], v[232:235]
    ds_read_b64_tr_b16 a[174:175], v51 offset:12288
    s_mov_b32 s82, 1048576
    s_add_u32 m0, s3, 0
    s_waitcnt lgkmcnt(15)
    v_mfma_f32_16x16x32_bf16 v[140:143], a[140:143], a[0:3], v[140:143]
    buffer_load_dwordx4 v17, s[48:51], s82 offen lds
    v_mfma_f32_16x16x32_bf16 v[172:175], a[140:143], a[4:7], v[172:175]
    ds_read_b64_tr_b16 a[176:177], v52 offset:8192
    v_mfma_f32_16x16x32_bf16 v[204:207], a[140:143], a[8:11], v[204:207]
    ds_read_b64_tr_b16 a[178:179], v52 offset:12288
    v_mfma_f32_16x16x32_bf16 v[236:239], a[140:143], a[12:15], v[236:239]
    s_waitcnt lgkmcnt(15)
    v_mfma_f32_16x16x32_bf16 v[144:147], a[144:147], a[0:3], v[144:147]
    ds_read_b64_tr_b16 a[180:181], v53 offset:8192
    buffer_load_dwordx4 v18, s[48:51], s82 offen offset:1024 lds
    v_mfma_f32_16x16x32_bf16 v[176:179], a[144:147], a[4:7], v[176:179]
    ds_read_b64_tr_b16 a[182:183], v53 offset:12288
    v_mfma_f32_16x16x32_bf16 v[208:211], a[144:147], a[8:11], v[208:211]
    v_mfma_f32_16x16x32_bf16 v[240:243], a[144:147], a[12:15], v[240:243]
    ds_read_b64_tr_b16 a[184:185], v54 offset:8192
    s_waitcnt lgkmcnt(15)
    v_mfma_f32_16x16x32_bf16 v[148:151], a[148:151], a[0:3], v[148:151]
    ds_read_b64_tr_b16 a[186:187], v54 offset:12288
    v_mfma_f32_16x16x32_bf16 v[180:183], a[148:151], a[4:7], v[180:183]
    s_mov_b32 s83, 1277952
    s_add_u32 m0, s3, 8192
    v_mfma_f32_16x16x32_bf16 v[212:215], a[148:151], a[8:11], v[212:215]
    ds_read_b64_tr_b16 a[188:189], v55 offset:8192
    buffer_load_dwordx4 v17, s[48:51], s83 offen lds
    v_mfma_f32_16x16x32_bf16 v[244:247], a[148:151], a[12:15], v[244:247]
    ds_read_b64_tr_b16 a[190:191], v55 offset:12288
    v_mfma_f32_16x16x32_bf16 v[152:155], a[152:155], a[0:3], v[152:155]
    v_mfma_f32_16x16x32_bf16 v[184:187], a[152:155], a[4:7], v[184:187]
    v_mfma_f32_16x16x32_bf16 v[216:219], a[152:155], a[8:11], v[216:219]
    buffer_load_dwordx4 v18, s[48:51], s83 offen offset:1024 lds
    v_mfma_f32_16x16x32_bf16 v[248:251], a[152:155], a[12:15], v[248:251]
    s_waitcnt lgkmcnt(15)
    v_mfma_f32_16x16x32_bf16 v[156:159], a[156:159], a[0:3], v[156:159]
    v_mfma_f32_16x16x32_bf16 v[188:191], a[156:159], a[4:7], v[188:191]
    v_mfma_f32_16x16x32_bf16 v[220:223], a[156:159], a[8:11], v[220:223]
    v_mfma_f32_16x16x32_bf16 v[252:255], a[156:159], a[12:15], v[252:255]
    s_waitcnt vmcnt(40) lgkmcnt(14)
    v_mfma_f32_16x16x32_bf16 v[128:131], a[160:163], a[16:19], v[128:131]
    s_waitcnt vmcnt(24)
    v_readfirstlane_b32 s86, v43
    s_bfe_u32 s86, s86, 0x80008
    s_cmp_eq_u32 s86, 16
    s_cbranch_scc0 L_spB
L_okB:
    buffer_load_dwordx4 a[0:3], v21, s[56:59], s68 offen sc1
    v_mfma_f32_16x16x32_bf16 v[160:163], a[160:163], a[20:23], v[160:163]
    ds_read_b64_tr_b16 a[128:129], v48 offset:16384
    v_mfma_f32_16x16x32_bf16 v[192:195], a[160:163], a[24:27], v[192:195]
    ds_read_b64_tr_b16 a[130:131], v48 offset:20480
    buffer_load_dwordx4 a[4:7], v22, s[56:59], s68 offen sc1
    v_mfma_f32_16x16x32_bf16 v[224:227], a[160:163], a[28:31], v[224:227]
    s_waitcnt lgkmcnt(14)
    v_mfma_f32_16x16x32_bf16 v[132:135], a[164:167], a[16:19], v[132:135]
    ds_read_b64_tr_b16 a[132:133], v49 offset:16384
    buffer_load_dwordx4 a[8:11], v23, s[56:59], s68 offen sc1
    v_mfma_f32_16x16x32_bf16 v[164:167], a[164:167], a[20:23], v[164:167]
    ds_read_b64_tr_b16 a[134:135], v49 offset:20480
    v_mfma_f32_16x16x32_bf16 v[196:199], a[164:167], a[24:27], v[196:199]
    buffer_load_dwordx4 a[12:15], v24, s[56:59], s68 offen sc1
    v_mfma_f32_16x16x32_bf16 v[228:231], a[164:167], a[28:31], v[228:231]
    ds_read_b64_tr_b16 a[136:137], v50 offset:16384
    s_waitcnt lgkmcnt(15)
    v_mfma_f32_16x16x32_bf16 v[136:139], a[168:171], a[16:19], v[136:139]
    ds_read_b64_tr_b16 a[138:139], v50 offset:20480
    s_add_u32 s68, s68, 16384
    v_mfma_f32_16x16x32_bf16 v[168:171], a[168:171], a[20:23], v[168:171]
    v_mfma_f32_16x16x32_bf16 v[200:203], a[168:171], a[24:27], v[200:203]
    ds_read_b64_tr_b16 a[140:141], v51 offset:16384
    v_mfma_f32_16x16x32_bf16 v[232:235], a[168:171], a[28:31], v[232:235]
    ds_read_b64_tr_b16 a[142:143], v51 offset:20480
    s_mov_b32 s82, 1507328
    s_add_u32 m0, s3, 16384
    s_waitcnt lgkmcnt(15)
    v_mfma_f32_16x16x32_bf16 v[140:143], a[172:175], a[16:19], v[140:143]
    buffer_load_dwordx4 v17, s[48:51], s82 offen lds
    v_mfma_f32_16x16x32_bf16 v[172:175], a[172:175], a[20:23], v[172:175]
    ds_read_b64_tr_b16 a[144:145], v52 offset:16384
    v_mfma_f32_16x16x32_bf16 v[204:207], a[172:175], a[24:27], v[204:207]
    ds_read_b64_tr_b16 a[146:147], v52 offset:20480
    v_mfma_f32_16x16x32_bf16 v[236:239], a[172:175], a[28:31], v[236:239]
    s_waitcnt lgkmcnt(15)
    v_mfma_f32_16x16x32_bf16 v[144:147], a[176:179], a[16:19], v[144:147]
    ds_read_b64_tr_b16 a[148:149], v53 offset:16384
    buffer_load_dwordx4 v18, s[48:51], s82 offen offset:1024 lds
    v_mfma_f32_16x16x32_bf16 v[176:179], a[176:179], a[20:23], v[176:179]
    ds_read_b64_tr_b16 a[150:151], v53 offset:20480
    v_mfma_f32_16x16x32_bf16 v[208:211], a[176:179], a[24:27], v[208:211]
    v_mfma_f32_16x16x32_bf16 v[240:243], a[176:179], a[28:31], v[240:243]
    ds_read_b64_tr_b16 a[152:153], v54 offset:16384
    s_waitcnt lgkmcnt(15)
    v_mfma_f32_16x16x32_bf16 v[148:151], a[180:183], a[16:19], v[148:151]
    ds_read_b64_tr_b16 a[154:155], v54 offset:20480
    v_mfma_f32_16x16x32_bf16 v[180:183], a[180:183], a[20:23], v[180:183]
    s_mov_b32 s83, 1736704
    s_add_u32 m0, s3, 24576
    v_mfma_f32_16x16x32_bf16 v[212:215], a[180:183], a[24:27], v[212:215]
    ds_read_b64_tr_b16 a[156:157], v55 offset:16384
    buffer_load_dwordx4 v17, s[48:51], s83 offen lds
    v_mfma_f32_16x16x32_bf16 v[244:247], a[180:183], a[28:31], v[244:247]
    ds_read_b64_tr_b16 a[158:159], v55 offset:20480
    v_mfma_f32_16x16x32_bf16 v[152:155], a[184:187], a[16:19], v[152:155]
    v_mfma_f32_16x16x32_bf16 v[184:187], a[184:187], a[20:23], v[184:187]
    v_mfma_f32_16x16x32_bf16 v[216:219], a[184:187], a[24:27], v[216:219]
    buffer_load_dwordx4 v18, s[48:51], s83 offen offset:1024 lds
    v_mfma_f32_16x16x32_bf16 v[248:251], a[184:187], a[28:31], v[248:251]
    s_waitcnt lgkmcnt(15)
    v_mfma_f32_16x16x32_bf16 v[156:159], a[188:191], a[16:19], v[156:159]
    v_mfma_f32_16x16x32_bf16 v[188:191], a[188:191], a[20:23], v[188:191]
    v_mfma_f32_16x16x32_bf16 v[220:223], a[188:191], a[24:27], v[220:223]
    v_mfma_f32_16x16x32_bf16 v[252:255], a[188:191], a[28:31], v[252:255]
    s_waitcnt lgkmcnt(14)
    v_mfma_f32_16x16x32_bf16 v[128:131], a[128:131], a[32:35], v[128:131]
    buffer_load_dwordx4 a[16:19], v21, s[56:59], s68 offen sc1
    v_mfma_f32_16x16x32_bf16 v[160:163], a[128:131], a[36:39], v[160:163]
    ds_read_b64_tr_b16 a[160:161], v48 offset:24576
    v_mfma_f32_16x16x32_bf16 v[192:195], a[128:131], a[40:43], v[192:195]
    ds_read_b64_tr_b16 a[162:163], v48 offset:28672
    buffer_load_dwordx4 a[20:23], v22, s[56:59], s68 offen sc1
    v_mfma_f32_16x16x32_bf16 v[224:227], a[128:131], a[44:47], v[224:227]
    s_waitcnt lgkmcnt(14)
    v_mfma_f32_16x16x32_bf16 v[132:135], a[132:135], a[32:35], v[132:135]
    ds_read_b64_tr_b16 a[164:165], v49 offset:24576
    buffer_load_dwordx4 a[24:27], v23, s[56:59], s68 offen sc1
    v_mfma_f32_16x16x32_bf16 v[164:167], a[132:135], a[36:39], v[164:167]
    ds_read_b64_tr_b16 a[166:167], v49 offset:28672
    v_mfma_f32_16x16x32_bf16 v[196:199], a[132:135], a[40:43], v[196:199]
    buffer_load_dwordx4 a[28:31], v24, s[56:59], s68 offen sc1
    v_mfma_f32_16x16x32_bf16 v[228:231], a[132:135], a[44:47], v[228:231]
    ds_read_b64_tr_b16 a[168:169], v50 offset:24576
    s_waitcnt lgkmcnt(15)
    v_mfma_f32_16x16x32_bf16 v[136:139], a[136:139], a[32:35], v[136:139]
    ds_read_b64_tr_b16 a[170:171], v50 offset:28672
    s_add_u32 s68, s68, 16384
    v_mfma_f32_16x16x32_bf16 v[168:171], a[136:139], a[36:39], v[168:171]
    v_mfma_f32_16x16x32_bf16 v[200:203], a[136:139], a[40:43], v[200:203]
    ds_read_b64_tr_b16 a[172:173], v51 offset:24576
    v_mfma_f32_16x16x32_bf16 v[232:235], a[136:139], a[44:47], v[232:235]
    ds_read_b64_tr_b16 a[174:175], v51 offset:28672
    s_mov_b32 s82, 196608
    s_add_u32 m0, s3, 32768
    s_waitcnt lgkmcnt(15)
    v_mfma_f32_16x16x32_bf16 v[140:143], a[140:143], a[32:35], v[140:143]
    buffer_load_dwordx4 v19, s[48:51], s82 offen lds
    v_mfma_f32_16x16x32_bf16 v[172:175], a[140:143], a[36:39], v[172:175]
    ds_read_b64_tr_b16 a[176:177], v52 offset:24576
    v_mfma_f32_16x16x32_bf16 v[204:207], a[140:143], a[40:43], v[204:207]
    ds_read_b64_tr_b16 a[178:179], v52 offset:28672
    v_mfma_f32_16x16x32_bf16 v[236:239], a[140:143], a[44:47], v[236:239]
    s_waitcnt lgkmcnt(15)
    v_mfma_f32_16x16x32_bf16 v[144:147], a[144:147], a[32:35], v[144:147]
    ds_read_b64_tr_b16 a[180:181], v53 offset:24576
    buffer_load_dwordx4 v20, s[48:51], s82 offen offset:1024 lds
    v_mfma_f32_16x16x32_bf16 v[176:179], a[144:147], a[36:39], v[176:179]
    ds_read_b64_tr_b16 a[182:183], v53 offset:28672
    v_mfma_f32_16x16x32_bf16 v[208:211], a[144:147], a[40:43], v[208:211]
    v_mfma_f32_16x16x32_bf16 v[240:243], a[144:147], a[44:47], v[240:243]
    ds_read_b64_tr_b16 a[184:185], v54 offset:24576
    s_waitcnt lgkmcnt(15)
    v_mfma_f32_16x16x32_bf16 v[148:151], a[148:151], a[32:35], v[148:151]
    ds_read_b64_tr_b16 a[186:187], v54 offset:28672
    v_mfma_f32_16x16x32_bf16 v[180:183], a[148:151], a[36:39], v[180:183]
    s_mov_b32 s83, 655360
    s_add_u32 m0, s3, 40960
    v_mfma_f32_16x16x32_bf16 v[212:215], a[148:151], a[40:43], v[212:215]
    ds_read_b64_tr_b16 a[188:189], v55 offset:24576
    buffer_load_dwordx4 v19, s[48:51], s83 offen lds
    v_mfma_f32_16x16x32_bf16 v[244:247], a[148:151], a[44:47], v[244:247]
    ds_read_b64_tr_b16 a[190:191], v55 offset:28672
    v_mfma_f32_16x16x32_bf16 v[152:155], a[152:155], a[32:35], v[152:155]
    v_mfma_f32_16x16x32_bf16 v[184:187], a[152:155], a[36:39], v[184:187]
    v_mfma_f32_16x16x32_bf16 v[216:219], a[152:155], a[40:43], v[216:219]
    buffer_load_dwordx4 v20, s[48:51], s83 offen offset:1024 lds
    v_mfma_f32_16x16x32_bf16 v[248:251], a[152:155], a[44:47], v[248:251]
    s_waitcnt lgkmcnt(15)
    v_mfma_f32_16x16x32_bf16 v[156:159], a[156:159], a[32:35], v[156:159]
    buffer_load_dword v43, off, s[56:59], s92 sc1
    v_mfma_f32_16x16x32_bf16 v[188:191], a[156:159], a[36:39], v[188:191]
    v_mfma_f32_16x16x32_bf16 v[220:223], a[156:159], a[40:43], v[220:223]
    v_mfma_f32_16x16x32_bf16 v[252:255], a[156:159], a[44:47], v[252:255]
    s_waitcnt vmcnt(40) lgkmcnt(14)
    v_mfma_f32_16x16x32_bf16 v[128:131], a[160:163], a[48:51], v[128:131]
    buffer_load_dwordx4 a[32:35], v21, s[56:59], s68 offen sc1
    s_waitcnt vmcnt(40)
    v_mfma_f32_16x16x32_bf16 v[160:163], a[160:163], a[52:55], v[160:163]
    ds_read_b64_tr_b16 a[128:129], v48 offset:32768
    s_waitcnt vmcnt(39)
    v_mfma_f32_16x16x32_bf16 v[192:195], a[160:163], a[56:59], v[192:195]
    ds_read_b64_tr_b16 a[130:131], v48 offset:36864
    buffer_load_dwordx4 a[36:39], v22, s[56:59], s68 offen sc1
    s_waitcnt vmcnt(39)
    v_mfma_f32_16x16x32_bf16 v[224:227], a[160:163], a[60:63], v[224:227]
    s_waitcnt lgkmcnt(14)
    v_mfma_f32_16x16x32_bf16 v[132:135], a[164:167], a[48:51], v[132:135]
    ds_read_b64_tr_b16 a[132:133], v49 offset:32768
    buffer_load_dwordx4 a[40:43], v23, s[56:59], s68 offen sc1
    v_mfma_f32_16x16x32_bf16 v[164:167], a[164:167], a[52:55], v[164:167]
    ds_read_b64_tr_b16 a[134:135], v49 offset:36864
    v_mfma_f32_16x16x32_bf16 v[196:199], a[164:167], a[56:59], v[196:199]
    buffer_load_dwordx4 a[44:47], v24, s[56:59], s68 offen sc1
    v_mfma_f32_16x16x32_bf16 v[228:231], a[164:167], a[60:63], v[228:231]
    ds_read_b64_tr_b16 a[136:137], v50 offset:32768
    s_waitcnt lgkmcnt(15)
    v_mfma_f32_16x16x32_bf16 v[136:139], a[168:171], a[48:51], v[136:139]
    ds_read_b64_tr_b16 a[138:139], v50 offset:36864
    s_add_u32 s68, s68, 16384
    v_mfma_f32_16x16x32_bf16 v[168:171], a[168:171], a[52:55], v[168:171]
    v_mfma_f32_16x16x32_bf16 v[200:203], a[168:171], a[56:59], v[200:203]
    ds_read_b64_tr_b16 a[140:141], v51 offset:32768
    v_mfma_f32_16x16x32_bf16 v[232:235], a[168:171], a[60:63], v[232:235]
    ds_read_b64_tr_b16 a[142:143], v51 offset:36864
    s_mov_b32 s82, 1114112
    s_add_u32 m0, s3, 49152
    s_waitcnt lgkmcnt(15)
    v_mfma_f32_16x16x32_bf16 v[140:143], a[172:175], a[48:51], v[140:143]
    buffer_load_dwordx4 v19, s[48:51], s82 offen lds
    v_mfma_f32_16x16x32_bf16 v[172:175], a[172:175], a[52:55], v[172:175]
    ds_read_b64_tr_b16 a[144:145], v52 offset:32768
    v_mfma_f32_16x16x32_bf16 v[204:207], a[172:175], a[56:59], v[204:207]
    ds_read_b64_tr_b16 a[146:147], v52 offset:36864
    v_mfma_f32_16x16x32_bf16 v[236:239], a[172:175], a[60:63], v[236:239]
    s_waitcnt lgkmcnt(15)
    v_mfma_f32_16x16x32_bf16 v[144:147], a[176:179], a[48:51], v[144:147]
    ds_read_b64_tr_b16 a[148:149], v53 offset:32768
    buffer_load_dwordx4 v20, s[48:51], s82 offen offset:1024 lds
    v_mfma_f32_16x16x32_bf16 v[176:179], a[176:179], a[52:55], v[176:179]
    ds_read_b64_tr_b16 a[150:151], v53 offset:36864
    v_mfma_f32_16x16x32_bf16 v[208:211], a[176:179], a[56:59], v[208:211]
    v_mfma_f32_16x16x32_bf16 v[240:243], a[176:179], a[60:63], v[240:243]
    ds_read_b64_tr_b16 a[152:153], v54 offset:32768
    s_waitcnt lgkmcnt(15)
    v_mfma_f32_16x16x32_bf16 v[148:151], a[180:183], a[48:51], v[148:151]
    ds_read_b64_tr_b16 a[154:155], v54 offset:36864
    v_mfma_f32_16x16x32_bf16 v[180:183], a[180:183], a[52:55], v[180:183]
    s_mov_b32 s83, 1572864
    s_add_u32 m0, s3, 57344
    v_mfma_f32_16x16x32_bf16 v[212:215], a[180:183], a[56:59], v[212:215]
    ds_read_b64_tr_b16 a[156:157], v55 offset:32768
    buffer_load_dwordx4 v19, s[48:51], s83 offen lds
    v_mfma_f32_16x16x32_bf16 v[244:247], a[180:183], a[60:63], v[244:247]
    ds_read_b64_tr_b16 a[158:159], v55 offset:36864
    v_mfma_f32_16x16x32_bf16 v[152:155], a[184:187], a[48:51], v[152:155]
    v_mfma_f32_16x16x32_bf16 v[184:187], a[184:187], a[52:55], v[184:187]
    v_mfma_f32_16x16x32_bf16 v[216:219], a[184:187], a[56:59], v[216:219]
    buffer_load_dwordx4 v20, s[48:51], s83 offen offset:1024 lds
    v_mfma_f32_16x16x32_bf16 v[248:251], a[184:187], a[60:63], v[248:251]
    s_waitcnt lgkmcnt(15)
    v_mfma_f32_16x16x32_bf16 v[156:159], a[188:191], a[48:51], v[156:159]
    v_mfma_f32_16x16x32_bf16 v[188:191], a[188:191], a[52:55], v[188:191]
    v_mfma_f32_16x16x32_bf16 v[220:223], a[188:191], a[56:59], v[220:223]
    v_mfma_f32_16x16x32_bf16 v[252:255], a[188:191], a[60:63], v[252:255]
    s_waitcnt vmcnt(44) lgkmcnt(14)
    v_mfma_f32_16x16x32_bf16 v[128:131], a[128:131], a[64:67], v[128:131]
    buffer_load_dwordx4 a[48:51], v21, s[56:59], s68 offen sc1
    s_waitcnt vmcnt(44)
    v_mfma_f32_16x16x32_bf16 v[160:163], a[128:131], a[68:71], v[160:163]
    ds_read_b64_tr_b16 a[160:161], v48 offset:40960
    s_waitcnt vmcnt(43)
    v_mfma_f32_16x16x32_bf16 v[192:195], a[128:131], a[72:75], v[192:195]
    ds_read_b64_tr_b16 a[162:163], v48 offset:45056
    buffer_load_dwordx4 a[52:55], v22, s[56:59], s68 offen sc1
    s_waitcnt vmcnt(43)
    v_mfma_f32_16x16x32_bf16 v[224:227], a[128:131], a[76:79], v[224:227]
    s_waitcnt lgkmcnt(14)
    v_mfma_f32_16x16x32_bf16 v[132:135], a[132:135], a[64:67], v[132:135]
    ds_read_b64_tr_b16 a[164:165], v49 offset:40960
    buffer_load_dwordx4 a[56:59], v23, s[56:59], s68 offen sc1
    v_mfma_f32_16x16x32_bf16 v[164:167], a[132:135], a[68:71], v[164:167]
    ds_read_b64_tr_b16 a[166:167], v49 offset:45056
    v_mfma_f32_16x16x32_bf16 v[196:199], a[132:135], a[72:75], v[196:199]
    buffer_load_dwordx4 a[60:63], v24, s[56:59], s68 offen sc1
    v_mfma_f32_16x16x32_bf16 v[228:231], a[132:135], a[76:79], v[228:231]
    ds_read_b64_tr_b16 a[168:169], v50 offset:40960
    s_waitcnt lgkmcnt(15)
    v_mfma_f32_16x16x32_bf16 v[136:139], a[136:139], a[64:67], v[136:139]
    ds_read_b64_tr_b16 a[170:171], v50 offset:45056
    s_add_u32 s68, s68, 16384
    v_mfma_f32_16x16x32_bf16 v[168:171], a[136:139], a[68:71], v[168:171]
    v_mfma_f32_16x16x32_bf16 v[200:203], a[136:139], a[72:75], v[200:203]
    ds_read_b64_tr_b16 a[172:173], v51 offset:40960
    v_lshlrev_b32 v64, 16, v66
    v_mfma_f32_16x16x32_bf16 v[232:235], a[136:139], a[76:79], v[232:235]
    ds_read_b64_tr_b16 a[174:175], v51 offset:45056
    v_and_b32 v65, 0xffff0000, v66
    s_waitcnt lgkmcnt(15)
    v_mfma_f32_16x16x32_bf16 v[140:143], a[140:143], a[64:67], v[140:143]
    v_lshlrev_b32 v66, 16, v67
    v_mfma_f32_16x16x32_bf16 v[172:175], a[140:143], a[68:71], v[172:175]
    ds_read_b64_tr_b16 a[176:177], v52 offset:40960
    v_and_b32 v67, 0xffff0000, v67
    v_mfma_f32_16x16x32_bf16 v[204:207], a[140:143], a[72:75], v[204:207]
    ds_read_b64_tr_b16 a[178:179], v52 offset:45056
    v_lshlrev_b32 v68, 16, v70
    v_mfma_f32_16x16x32_bf16 v[236:239], a[140:143], a[76:79], v[236:239]
    v_and_b32 v69, 0xffff0000, v70
    s_waitcnt lgkmcnt(15)
    v_mfma_f32_16x16x32_bf16 v[144:147], a[144:147], a[64:67], v[144:147]
    ds_read_b64_tr_b16 a[180:181], v53 offset:40960
    v_lshlrev_b32 v70, 16, v71
    v_mfma_f32_16x16x32_bf16 v[176:179], a[144:147], a[68:71], v[176:179]
    ds_read_b64_tr_b16 a[182:183], v53 offset:45056
    v_and_b32 v71, 0xffff0000, v71
    v_mfma_f32_16x16x32_bf16 v[208:211], a[144:147], a[72:75], v[208:211]
    v_lshlrev_b32 v72, 16, v74
    v_mfma_f32_16x16x32_bf16 v[240:243], a[144:147], a[76:79], v[240:243]
    ds_read_b64_tr_b16 a[184:185], v54 offset:40960
    v_and_b32 v73, 0xffff0000, v74
    s_waitcnt lgkmcnt(15)
    v_mfma_f32_16x16x32_bf16 v[148:151], a[148:151], a[64:67], v[148:151]
    ds_read_b64_tr_b16 a[186:187], v54 offset:45056
    v_lshlrev_b32 v74, 16, v75
    v_mfma_f32_16x16x32_bf16 v[180:183], a[148:151], a[68:71], v[180:183]
    v_and_b32 v75, 0xffff0000, v75
    v_mfma_f32_16x16x32_bf16 v[212:215], a[148:151], a[72:75], v[212:215]
    ds_read_b64_tr_b16 a[188:189], v55 offset:40960
    v_lshlrev_b32 v76, 16, v78
    v_mfma_f32_16x16x32_bf16 v[244:247], a[148:151], a[76:79], v[244:247]
    ds_read_b64_tr_b16 a[190:191], v55 offset:45056
    v_and_b32 v77, 0xffff0000, v78
    v_mfma_f32_16x16x32_bf16 v[152:155], a[152:155], a[64:67], v[152:155]
    v_lshlrev_b32 v78, 16, v79
    v_mfma_f32_16x16x32_bf16 v[184:187], a[152:155], a[68:71], v[184:187]
    v_and_b32 v79, 0xffff0000, v79
    v_mfma_f32_16x16x32_bf16 v[216:219], a[152:155], a[72:75], v[216:219]
    v_mfma_f32_16x16x32_bf16 v[248:251], a[152:155], a[76:79], v[248:251]
    s_waitcnt lgkmcnt(15)
    v_mfma_f32_16x16x32_bf16 v[156:159], a[156:159], a[64:67], v[156:159]
    v_mfma_f32_16x16x32_bf16 v[188:191], a[156:159], a[68:71], v[188:191]
    v_mfma_f32_16x16x32_bf16 v[220:223], a[156:159], a[72:75], v[220:223]
    v_mfma_f32_16x16x32_bf16 v[252:255], a[156:159], a[76:79], v[252:255]
    s_waitcnt vmcnt(44) lgkmcnt(14)
    v_mfma_f32_16x16x32_bf16 v[128:131], a[160:163], a[80:83], v[128:131]
    buffer_load_dwordx4 a[64:67], v21, s[56:59], s68 offen sc1
    s_waitcnt vmcnt(44)
    v_mfma_f32_16x16x32_bf16 v[160:163], a[160:163], a[84:87], v[160:163]
    ds_read_b64_tr_b16 a[128:129], v48 offset:49152
    s_waitcnt vmcnt(43)
    v_mfma_f32_16x16x32_bf16 v[192:195], a[160:163], a[88:91], v[192:195]
    ds_read_b64_tr_b16 a[130:131], v48 offset:53248
    buffer_load_dwordx4 a[68:71], v22, s[56:59], s68 offen sc1
    s_waitcnt vmcnt(43)
    v_mfma_f32_16x16x32_bf16 v[224:227], a[160:163], a[92:95], v[224:227]
    s_waitcnt lgkmcnt(14)
    v_mfma_f32_16x16x32_bf16 v[132:135], a[164:167], a[80:83], v[132:135]
    ds_read_b64_tr_b16 a[132:133], v49 offset:49152
    buffer_load_dwordx4 a[72:75], v23, s[56:59], s68 offen sc1
    v_mfma_f32_16x16x32_bf16 v[164:167], a[164:167], a[84:87], v[164:167]
    ds_read_b64_tr_b16 a[134:135], v49 offset:53248
    v_mfma_f32_16x16x32_bf16 v[196:199], a[164:167], a[88:91], v[196:199]
    buffer_load_dwordx4 a[76:79], v24, s[56:59], s68 offen sc1
    v_mfma_f32_16x16x32_bf16 v[228:231], a[164:167], a[92:95], v[228:231]
    ds_read_b64_tr_b16 a[136:137], v50 offset:49152
    s_waitcnt lgkmcnt(15)
    v_mfma_f32_16x16x32_bf16 v[136:139], a[168:171], a[80:83], v[136:139]
    ds_read_b64_tr_b16 a[138:139], v50 offset:53248
    s_add_u32 s68, s68, 16384
    v_mfma_f32_16x16x32_bf16 v[168:171], a[168:171], a[84:87], v[168:171]
    v_mfma_f32_16x16x32_bf16 v[200:203], a[168:171], a[88:91], v[200:203]
    ds_read_b64_tr_b16 a[140:141], v51 offset:49152
    v_lshlrev_b32 v80, 16, v82
    v_mfma_f32_16x16x32_bf16 v[232:235], a[168:171], a[92:95], v[232:235]
    ds_read_b64_tr_b16 a[142:143], v51 offset:53248
    v_and_b32 v81, 0xffff0000, v82
    s_waitcnt lgkmcnt(15)
    v_mfma_f32_16x16x32_bf16 v[140:143], a[172:175], a[80:83], v[140:143]
    v_lshlrev_b32 v82, 16, v83
    v_mfma_f32_16x16x32_bf16 v[172:175], a[172:175], a[84:87], v[172:175]
    ds_read_b64_tr_b16 a[144:145], v52 offset:49152
    v_and_b32 v83, 0xffff0000, v83
    v_mfma_f32_16x16x32_bf16 v[204:207], a[172:175], a[88:91], v[204:207]
    ds_read_b64_tr_b16 a[146:147], v52 offset:53248
    v_lshlrev_b32 v84, 16, v86
    v_mfma_f32_16x16x32_bf16 v[236:239], a[172:175], a[92:95], v[236:239]
    v_and_b32 v85, 0xffff0000, v86
    s_waitcnt lgkmcnt(15)
    v_mfma_f32_16x16x32_bf16 v[144:147], a[176:179], a[80:83], v[144:147]
    ds_read_b64_tr_b16 a[148:149], v53 offset:49152
    v_lshlrev_b32 v86, 16, v87
    v_mfma_f32_16x16x32_bf16 v[176:179], a[176:179], a[84:87], v[176:179]
    ds_read_b64_tr_b16 a[150:151], v53 offset:53248
    v_and_b32 v87, 0xffff0000, v87
    v_mfma_f32_16x16x32_bf16 v[208:211], a[176:179], a[88:91], v[208:211]
    v_lshlrev_b32 v88, 16, v90
    v_mfma_f32_16x16x32_bf16 v[240:243], a[176:179], a[92:95], v[240:243]
    ds_read_b64_tr_b16 a[152:153], v54 offset:49152
    v_and_b32 v89, 0xffff0000, v90
    s_waitcnt lgkmcnt(15)
    v_mfma_f32_16x16x32_bf16 v[148:151], a[180:183], a[80:83], v[148:151]
    ds_read_b64_tr_b16 a[154:155], v54 offset:53248
    v_lshlrev_b32 v90, 16, v91
    v_mfma_f32_16x16x32_bf16 v[180:183], a[180:183], a[84:87], v[180:183]
    v_and_b32 v91, 0xffff0000, v91
    v_mfma_f32_16x16x32_bf16 v[212:215], a[180:183], a[88:91], v[212:215]
    ds_read_b64_tr_b16 a[156:157], v55 offset:49152
    v_lshlrev_b32 v92, 16, v94
    v_mfma_f32_16x16x32_bf16 v[244:247], a[180:183], a[92:95], v[244:247]
    ds_read_b64_tr_b16 a[158:159], v55 offset:53248
    v_and_b32 v93, 0xffff0000, v94
    v_mfma_f32_16x16x32_bf16 v[152:155], a[184:187], a[80:83], v[152:155]
    v_lshlrev_b32 v94, 16, v95
    v_mfma_f32_16x16x32_bf16 v[184:187], a[184:187], a[84:87], v[184:187]
    v_and_b32 v95, 0xffff0000, v95
    v_mfma_f32_16x16x32_bf16 v[216:219], a[184:187], a[88:91], v[216:219]
    v_mfma_f32_16x16x32_bf16 v[248:251], a[184:187], a[92:95], v[248:251]
    s_waitcnt lgkmcnt(15)
    v_mfma_f32_16x16x32_bf16 v[156:159], a[188:191], a[80:83], v[156:159]
    buffer_load_dword v44, off, s[56:59], s76 sc1
    v_mfma_f32_16x16x32_bf16 v[188:191], a[188:191], a[84:87], v[188:191]
    v_mfma_f32_16x16x32_bf16 v[220:223], a[188:191], a[88:91], v[220:223]
    v_mfma_f32_16x16x32_bf16 v[252:255], a[188:191], a[92:95], v[252:255]
    s_waitcnt vmcnt(45) lgkmcnt(14)
    v_mfma_f32_16x16x32_bf16 v[128:131], a[128:131], a[96:99], v[128:131]
    buffer_load_dwordx4 a[80:83], v21, s[56:59], s68 offen sc1
    s_waitcnt vmcnt(45)
    v_mfma_f32_16x16x32_bf16 v[160:163], a[128:131], a[100:103], v[160:163]
    ds_read_b64_tr_b16 a[160:161], v48 offset:57344
    s_waitcnt vmcnt(44)
    v_mfma_f32_16x16x32_bf16 v[192:195], a[128:131], a[104:107], v[192:195]
    ds_read_b64_tr_b16 a[162:163], v48 offset:61440
    buffer_load_dwordx4 a[84:87], v22, s[56:59], s68 offen sc1
    s_waitcnt vmcnt(44)
    v_mfma_f32_16x16x32_bf16 v[224:227], a[128:131], a[108:111], v[224:227]
    s_waitcnt lgkmcnt(14)
    v_mfma_f32_16x16x32_bf16 v[132:135], a[132:135], a[96:99], v[132:135]
    ds_read_b64_tr_b16 a[164:165], v49 offset:57344
    buffer_load_dwordx4 a[88:91], v23, s[56:59], s68 offen sc1
    v_mfma_f32_16x16x32_bf16 v[164:167], a[132:135], a[100:103], v[164:167]
    ds_read_b64_tr_b16 a[166:167], v49 offset:61440
    v_mfma_f32_16x16x32_bf16 v[196:199], a[132:135], a[104:107], v[196:199]
    buffer_load_dwordx4 a[92:95], v24, s[56:59], s68 offen sc1
    v_mfma_f32_16x16x32_bf16 v[228:231], a[132:135], a[108:111], v[228:231]
    ds_read_b64_tr_b16 a[168:169], v50 offset:57344
    s_waitcnt lgkmcnt(15)
    v_mfma_f32_16x16x32_bf16 v[136:139], a[136:139], a[96:99], v[136:139]
    ds_read_b64_tr_b16 a[170:171], v50 offset:61440
    s_add_u32 s68, s68, 16384
    v_mfma_f32_16x16x32_bf16 v[168:171], a[136:139], a[100:103], v[168:171]
    v_mfma_f32_16x16x32_bf16 v[200:203], a[136:139], a[104:107], v[200:203]
    ds_read_b64_tr_b16 a[172:173], v51 offset:57344
    v_mfma_f32_16x16x32_bf16 v[232:235], a[136:139], a[108:111], v[232:235]
    ds_read_b64_tr_b16 a[174:175], v51 offset:61440
    s_waitcnt lgkmcnt(15)
    v_mfma_f32_16x16x32_bf16 v[140:143], a[140:143], a[96:99], v[140:143]
    v_mfma_f32_16x16x32_bf16 v[172:175], a[140:143], a[100:103], v[172:175]
    ds_read_b64_tr_b16 a[176:177], v52 offset:57344
    v_mfma_f32_16x16x32_bf16 v[204:207], a[140:143], a[104:107], v[204:207]
    ds_read_b64_tr_b16 a[178:179], v52 offset:61440
    v_mfma_f32_16x16x32_bf16 v[236:239], a[140:143], a[108:111], v[236:239]
    s_waitcnt lgkmcnt(15)
    v_mfma_f32_16x16x32_bf16 v[144:147], a[144:147], a[96:99], v[144:147]
    ds_read_b64_tr_b16 a[180:181], v53 offset:57344
    v_mfma_f32_16x16x32_bf16 v[176:179], a[144:147], a[100:103], v[176:179]
    ds_read_b64_tr_b16 a[182:183], v53 offset:61440
    v_mfma_f32_16x16x32_bf16 v[208:211], a[144:147], a[104:107], v[208:211]
    v_mfma_f32_16x16x32_bf16 v[240:243], a[144:147], a[108:111], v[240:243]
    ds_read_b64_tr_b16 a[184:185], v54 offset:57344
    s_waitcnt lgkmcnt(15)
    v_mfma_f32_16x16x32_bf16 v[148:151], a[148:151], a[96:99], v[148:151]
    ds_read_b64_tr_b16 a[186:187], v54 offset:61440
    v_mfma_f32_16x16x32_bf16 v[180:183], a[148:151], a[100:103], v[180:183]
    v_mfma_f32_16x16x32_bf16 v[212:215], a[148:151], a[104:107], v[212:215]
    ds_read_b64_tr_b16 a[188:189], v55 offset:57344
    v_mfma_f32_16x16x32_bf16 v[244:247], a[148:151], a[108:111], v[244:247]
    ds_read_b64_tr_b16 a[190:191], v55 offset:61440
    v_mfma_f32_16x16x32_bf16 v[152:155], a[152:155], a[96:99], v[152:155]
    v_mfma_f32_16x16x32_bf16 v[184:187], a[152:155], a[100:103], v[184:187]
    v_mfma_f32_16x16x32_bf16 v[216:219], a[152:155], a[104:107], v[216:219]
    v_mfma_f32_16x16x32_bf16 v[248:251], a[152:155], a[108:111], v[248:251]
    s_waitcnt lgkmcnt(15)
    v_mfma_f32_16x16x32_bf16 v[156:159], a[156:159], a[96:99], v[156:159]
    v_mfma_f32_16x16x32_bf16 v[188:191], a[156:159], a[100:103], v[188:191]
    v_mfma_f32_16x16x32_bf16 v[220:223], a[156:159], a[104:107], v[220:223]
    v_mfma_f32_16x16x32_bf16 v[252:255], a[156:159], a[108:111], v[252:255]
    s_waitcnt vmcnt(45) lgkmcnt(14)
    v_mfma_f32_16x16x32_bf16 v[128:131], a[160:163], a[112:115], v[128:131]
    buffer_load_dwordx4 a[96:99], v21, s[56:59], s68 offen sc1
    s_waitcnt vmcnt(45)
    v_mfma_f32_16x16x32_bf16 v[160:163], a[160:163], a[116:119], v[160:163]
    ds_read_b64_tr_b16 a[128:129], v56 offset:0
    s_waitcnt vmcnt(44)
    v_mfma_f32_16x16x32_bf16 v[192:195], a[160:163], a[120:123], v[192:195]
    ds_read_b64_tr_b16 a[130:131], v56 offset:4096
    buffer_load_dwordx4 a[100:103], v22, s[56:59], s68 offen sc1
    s_waitcnt vmcnt(44)
    v_mfma_f32_16x16x32_bf16 v[224:227], a[160:163], a[124:127], v[224:227]
    s_waitcnt lgkmcnt(14)
    v_mfma_f32_16x16x32_bf16 v[132:135], a[164:167], a[112:115], v[132:135]
    ds_read_b64_tr_b16 a[132:133], v57 offset:0
    buffer_load_dwordx4 a[104:107], v23, s[56:59], s68 offen sc1
    v_mfma_f32_16x16x32_bf16 v[164:167], a[164:167], a[116:119], v[164:167]
    ds_read_b64_tr_b16 a[134:135], v57 offset:4096
    v_mfma_f32_16x16x32_bf16 v[196:199], a[164:167], a[120:123], v[196:199]
    buffer_load_dwordx4 a[108:111], v24, s[56:59], s68 offen sc1
    v_mfma_f32_16x16x32_bf16 v[228:231], a[164:167], a[124:127], v[228:231]
    ds_read_b64_tr_b16 a[136:137], v58 offset:0
    s_waitcnt lgkmcnt(15)
    v_mfma_f32_16x16x32_bf16 v[136:139], a[168:171], a[112:115], v[136:139]
    ds_read_b64_tr_b16 a[138:139], v58 offset:4096
    s_add_u32 s68, s68, 16384
    v_mfma_f32_16x16x32_bf16 v[168:171], a[168:171], a[116:119], v[168:171]
    v_mfma_f32_16x16x32_bf16 v[200:203], a[168:171], a[120:123], v[200:203]
    ds_read_b64_tr_b16 a[140:141], v59 offset:0
    v_mfma_f32_16x16x32_bf16 v[232:235], a[168:171], a[124:127], v[232:235]
    ds_read_b64_tr_b16 a[142:143], v59 offset:4096
    s_waitcnt lgkmcnt(15)
    v_mfma_f32_16x16x32_bf16 v[140:143], a[172:175], a[112:115], v[140:143]
    v_mfma_f32_16x16x32_bf16 v[172:175], a[172:175], a[116:119], v[172:175]
    ds_read_b64_tr_b16 a[144:145], v60 offset:0
    v_mfma_f32_16x16x32_bf16 v[204:207], a[172:175], a[120:123], v[204:207]
    ds_read_b64_tr_b16 a[146:147], v60 offset:4096
    v_mfma_f32_16x16x32_bf16 v[236:239], a[172:175], a[124:127], v[236:239]
    s_waitcnt lgkmcnt(15)
    v_mfma_f32_16x16x32_bf16 v[144:147], a[176:179], a[112:115], v[144:147]
    ds_read_b64_tr_b16 a[148:149], v61 offset:0
    v_mfma_f32_16x16x32_bf16 v[176:179], a[176:179], a[116:119], v[176:179]
    ds_read_b64_tr_b16 a[150:151], v61 offset:4096
    v_mfma_f32_16x16x32_bf16 v[208:211], a[176:179], a[120:123], v[208:211]
    v_mfma_f32_16x16x32_bf16 v[240:243], a[176:179], a[124:127], v[240:243]
    ds_read_b64_tr_b16 a[152:153], v62 offset:0
    s_waitcnt lgkmcnt(15)
    v_mfma_f32_16x16x32_bf16 v[148:151], a[180:183], a[112:115], v[148:151]
    ds_read_b64_tr_b16 a[154:155], v62 offset:4096
    v_mfma_f32_16x16x32_bf16 v[180:183], a[180:183], a[116:119], v[180:183]
    v_mfma_f32_16x16x32_bf16 v[212:215], a[180:183], a[120:123], v[212:215]
    ds_read_b64_tr_b16 a[156:157], v63 offset:0
    v_mfma_f32_16x16x32_bf16 v[244:247], a[180:183], a[124:127], v[244:247]
    ds_read_b64_tr_b16 a[158:159], v63 offset:4096
    v_mfma_f32_16x16x32_bf16 v[152:155], a[184:187], a[112:115], v[152:155]
    v_mfma_f32_16x16x32_bf16 v[184:187], a[184:187], a[116:119], v[184:187]
    v_mfma_f32_16x16x32_bf16 v[216:219], a[184:187], a[120:123], v[216:219]
    v_mfma_f32_16x16x32_bf16 v[248:251], a[184:187], a[124:127], v[248:251]
    s_waitcnt lgkmcnt(15)
    v_mfma_f32_16x16x32_bf16 v[156:159], a[188:191], a[112:115], v[156:159]
    v_mfma_f32_16x16x32_bf16 v[188:191], a[188:191], a[116:119], v[188:191]
    v_mfma_f32_16x16x32_bf16 v[220:223], a[188:191], a[120:123], v[220:223]
    v_mfma_f32_16x16x32_bf16 v[252:255], a[188:191], a[124:127], v[252:255]
    s_waitcnt vmcnt(17)
    s_barrier
    s_waitcnt lgkmcnt(14)
    v_mfma_f32_16x16x32_bf16 v[128:131], a[128:131], a[0:3], v[128:131]
    buffer_load_dwordx4 a[112:115], v21, s[56:59], s68 offen sc1
    v_mfma_f32_16x16x32_bf16 v[160:163], a[128:131], a[4:7], v[160:163]
    ds_read_b64_tr_b16 a[160:161], v56 offset:8192
    v_mfma_f32_16x16x32_bf16 v[192:195], a[128:131], a[8:11], v[192:195]
    ds_read_b64_tr_b16 a[162:163], v56 offset:12288
    buffer_load_dwordx4 a[116:119], v22, s[56:59], s68 offen sc1
    v_mfma_f32_16x16x32_bf16 v[224:227], a[128:131], a[12:15], v[224:227]
    s_waitcnt lgkmcnt(14)
    v_mfma_f32_16x16x32_bf16 v[132:135], a[132:135], a[0:3], v[132:135]
    ds_read_b64_tr_b16 a[164:165], v57 offset:8192
    buffer_load_dwordx4 a[120:123], v23, s[56:59], s68 offen sc1
    v_mfma_f32_16x16x32_bf16 v[164:167], a[132:135], a[4:7], v[164:167]
    ds_read_b64_tr_b16 a[166:167], v57 offset:12288
    v_mfma_f32_16x16x32_bf16 v[196:199], a[132:135], a[8:11], v[196:199]
    buffer_load_dwordx4 a[124:127], v24, s[56:59], s68 offen sc1
    v_mfma_f32_16x16x32_bf16 v[228:231], a[132:135], a[12:15], v[228:231]
    ds_read_b64_tr_b16 a[168:169], v58 offset:8192
    s_waitcnt lgkmcnt(15)
    v_mfma_f32_16x16x32_bf16 v[136:139], a[136:139], a[0:3], v[136:139]
    ds_read_b64_tr_b16 a[170:171], v58 offset:12288
    s_add_u32 s68, s68, 16384
    v_mfma_f32_16x16x32_bf16 v[168:171], a[136:139], a[4:7], v[168:171]
    v_mfma_f32_16x16x32_bf16 v[200:203], a[136:139], a[8:11], v[200:203]
    ds_read_b64_tr_b16 a[172:173], v59 offset:8192
    v_mfma_f32_16x16x32_bf16 v[232:235], a[136:139], a[12:15], v[232:235]
    ds_read_b64_tr_b16 a[174:175], v59 offset:12288
    s_mov_b32 s82, 0
    s_add_u32 m0, s3, 65536
    s_waitcnt lgkmcnt(15)
    v_mfma_f32_16x16x32_bf16 v[140:143], a[140:143], a[0:3], v[140:143]
    buffer_load_dwordx4 v17, s[52:55], s82 offen lds
    v_mfma_f32_16x16x32_bf16 v[172:175], a[140:143], a[4:7], v[172:175]
    ds_read_b64_tr_b16 a[176:177], v60 offset:8192
    v_mfma_f32_16x16x32_bf16 v[204:207], a[140:143], a[8:11], v[204:207]
    ds_read_b64_tr_b16 a[178:179], v60 offset:12288
    v_mfma_f32_16x16x32_bf16 v[236:239], a[140:143], a[12:15], v[236:239]
    s_waitcnt lgkmcnt(15)
    v_mfma_f32_16x16x32_bf16 v[144:147], a[144:147], a[0:3], v[144:147]
    ds_read_b64_tr_b16 a[180:181], v61 offset:8192
    buffer_load_dwordx4 v18, s[52:55], s82 offen offset:1024 lds
    v_mfma_f32_16x16x32_bf16 v[176:179], a[144:147], a[4:7], v[176:179]
    ds_read_b64_tr_b16 a[182:183], v61 offset:12288
    v_mfma_f32_16x16x32_bf16 v[208:211], a[144:147], a[8:11], v[208:211]
    v_mfma_f32_16x16x32_bf16 v[240:243], a[144:147], a[12:15], v[240:243]
    ds_read_b64_tr_b16 a[184:185], v62 offset:8192
    s_waitcnt lgkmcnt(15)
    v_mfma_f32_16x16x32_bf16 v[148:151], a[148:151], a[0:3], v[148:151]
    ds_read_b64_tr_b16 a[186:187], v62 offset:12288
    v_mfma_f32_16x16x32_bf16 v[180:183], a[148:151], a[4:7], v[180:183]
    s_mov_b32 s83, 65536
    s_add_u32 m0, s3, 73728
    v_mfma_f32_16x16x32_bf16 v[212:215], a[148:151], a[8:11], v[212:215]
    ds_read_b64_tr_b16 a[188:189], v63 offset:8192
    buffer_load_dwordx4 v17, s[52:55], s83 offen lds
    v_mfma_f32_16x16x32_bf16 v[244:247], a[148:151], a[12:15], v[244:247]
    ds_read_b64_tr_b16 a[190:191], v63 offset:12288
    v_mfma_f32_16x16x32_bf16 v[152:155], a[152:155], a[0:3], v[152:155]
    v_mfma_f32_16x16x32_bf16 v[184:187], a[152:155], a[4:7], v[184:187]
    v_mfma_f32_16x16x32_bf16 v[216:219], a[152:155], a[8:11], v[216:219]
    buffer_load_dwordx4 v18, s[52:55], s83 offen offset:1024 lds
    v_mfma_f32_16x16x32_bf16 v[248:251], a[152:155], a[12:15], v[248:251]
    s_waitcnt lgkmcnt(15)
    v_mfma_f32_16x16x32_bf16 v[156:159], a[156:159], a[0:3], v[156:159]
    v_mfma_f32_16x16x32_bf16 v[188:191], a[156:159], a[4:7], v[188:191]
    v_mfma_f32_16x16x32_bf16 v[220:223], a[156:159], a[8:11], v[220:223]
    v_mfma_f32_16x16x32_bf16 v[252:255], a[156:159], a[12:15], v[252:255]
    s_waitcnt lgkmcnt(14)
    v_mfma_f32_16x16x32_bf16 v[128:131], a[160:163], a[16:19], v[128:131]
    v_readfirstlane_b32 s86, v43
    s_bfe_u32 s86, s86, 0x80010
    s_cmp_eq_u32 s86, 16
    s_cbranch_scc0 L_spC
L_okC:
    buffer_load_dwordx4 a[0:3], v21, s[56:59], s68 offen sc1
    v_mfma_f32_16x16x32_bf16 v[160:163], a[160:163], a[20:23], v[160:163]
    ds_read_b64_tr_b16 a[128:129], v56 offset:16384
    v_mfma_f32_16x16x32_bf16 v[192:195], a[160:163], a[24:27], v[192:195]
    ds_read_b64_tr_b16 a[130:131], v56 offset:20480
    buffer_load_dwordx4 a[4:7], v22, s[56:59], s68 offen sc1
    v_mfma_f32_16x16x32_bf16 v[224:227], a[160:163], a[28:31], v[224:227]
    s_waitcnt lgkmcnt(14)
    v_mfma_f32_16x16x32_bf16 v[132:135], a[164:167], a[16:19], v[132:135]
    ds_read_b64_tr_b16 a[132:133], v57 offset:16384
    buffer_load_dwordx4 a[8:11], v23, s[56:59], s68 offen sc1
    v_mfma_f32_16x16x32_bf16 v[164:167], a[164:167], a[20:23], v[164:167]
    ds_read_b64_tr_b16 a[134:135], v57 offset:20480
    v_mfma_f32_16x16x32_bf16 v[196:199], a[164:167], a[24:27], v[196:199]
    buffer_load_dwordx4 a[12:15], v24, s[56:59], s68 offen sc1
    v_mfma_f32_16x16x32_bf16 v[228:231], a[164:167], a[28:31], v[228:231]
    ds_read_b64_tr_b16 a[136:137], v58 offset:16384
    s_waitcnt lgkmcnt(15)
    v_mfma_f32_16x16x32_bf16 v[136:139], a[168:171], a[16:19], v[136:139]
    ds_read_b64_tr_b16 a[138:139], v58 offset:20480
    s_add_u32 s68, s68, 16384
    v_mfma_f32_16x16x32_bf16 v[168:171], a[168:171], a[20:23], v[168:171]
    v_mfma_f32_16x16x32_bf16 v[200:203], a[168:171], a[24:27], v[200:203]
    ds_read_b64_tr_b16 a[140:141], v59 offset:16384
    v_mfma_f32_16x16x32_bf16 v[232:235], a[168:171], a[28:31], v[232:235]
    ds_read_b64_tr_b16 a[142:143], v59 offset:20480
    s_mov_b32 s82, 131072
    s_add_u32 m0, s3, 81920
    s_waitcnt lgkmcnt(15)
    v_mfma_f32_16x16x32_bf16 v[140:143], a[172:175], a[16:19], v[140:143]
    buffer_load_dwordx4 v17, s[52:55], s82 offen lds
    v_mfma_f32_16x16x32_bf16 v[172:175], a[172:175], a[20:23], v[172:175]
    ds_read_b64_tr_b16 a[144:145], v60 offset:16384
    v_mfma_f32_16x16x32_bf16 v[204:207], a[172:175], a[24:27], v[204:207]
    ds_read_b64_tr_b16 a[146:147], v60 offset:20480
    v_mfma_f32_16x16x32_bf16 v[236:239], a[172:175], a[28:31], v[236:239]
    s_waitcnt lgkmcnt(15)
    v_mfma_f32_16x16x32_bf16 v[144:147], a[176:179], a[16:19], v[144:147]
    ds_read_b64_tr_b16 a[148:149], v61 offset:16384
    buffer_load_dwordx4 v18, s[52:55], s82 offen offset:1024 lds
    v_mfma_f32_16x16x32_bf16 v[176:179], a[176:179], a[20:23], v[176:179]
    ds_read_b64_tr_b16 a[150:151], v61 offset:20480
    v_mfma_f32_16x16x32_bf16 v[208:211], a[176:179], a[24:27], v[208:211]
    v_mfma_f32_16x16x32_bf16 v[240:243], a[176:179], a[28:31], v[240:243]
    ds_read_b64_tr_b16 a[152:153], v62 offset:16384
    s_waitcnt lgkmcnt(15)
    v_mfma_f32_16x16x32_bf16 v[148:151], a[180:183], a[16:19], v[148:151]
    ds_read_b64_tr_b16 a[154:155], v62 offset:20480
    v_mfma_f32_16x16x32_bf16 v[180:183], a[180:183], a[20:23], v[180:183]
    s_mov_b32 s83, 196608
    s_add_u32 m0, s3, 90112
    v_mfma_f32_16x16x32_bf16 v[212:215], a[180:183], a[24:27], v[212:215]
    ds_read_b64_tr_b16 a[156:157], v63 offset:16384
    buffer_load_dwordx4 v17, s[52:55], s83 offen lds
    v_mfma_f32_16x16x32_bf16 v[244:247], a[180:183], a[28:31], v[244:247]
    ds_read_b64_tr_b16 a[158:159], v63 offset:20480
    v_mfma_f32_16x16x32_bf16 v[152:155], a[184:187], a[16:19], v[152:155]
    v_mfma_f32_16x16x32_bf16 v[184:187], a[184:187], a[20:23], v[184:187]
    v_mfma_f32_16x16x32_bf16 v[216:219], a[184:187], a[24:27], v[216:219]
    buffer_load_dwordx4 v18, s[52:55], s83 offen offset:1024 lds
    v_mfma_f32_16x16x32_bf16 v[248:251], a[184:187], a[28:31], v[248:251]
    s_waitcnt lgkmcnt(15)
    v_mfma_f32_16x16x32_bf16 v[156:159], a[188:191], a[16:19], v[156:159]
    v_mfma_f32_16x16x32_bf16 v[188:191], a[188:191], a[20:23], v[188:191]
    v_mfma_f32_16x16x32_bf16 v[220:223], a[188:191], a[24:27], v[220:223]
    v_mfma_f32_16x16x32_bf16 v[252:255], a[188:191], a[28:31], v[252:255]
    s_waitcnt lgkmcnt(14)
    v_mfma_f32_16x16x32_bf16 v[128:131], a[128:131], a[32:35], v[128:131]
    buffer_load_dwordx4 a[16:19], v21, s[56:59], s68 offen sc1
    v_mfma_f32_16x16x32_bf16 v[160:163], a[128:131], a[36:39], v[160:163]
    ds_read_b64_tr_b16 a[160:161], v56 offset:24576
    v_mfma_f32_16x16x32_bf16 v[192:195], a[128:131], a[40:43], v[192:195]
    ds_read_b64_tr_b16 a[162:163], v56 offset:28672
    buffer_load_dwordx4 a[20:23], v22, s[56:59], s68 offen sc1
    v_mfma_f32_16x16x32_bf16 v[224:227], a[128:131], a[44:47], v[224:227]
    s_waitcnt lgkmcnt(14)
    v_mfma_f32_16x16x32_bf16 v[132:135], a[132:135], a[32:35], v[132:135]
    ds_read_b64_tr_b16 a[164:165], v57 offset:24576
    buffer_load_dwordx4 a[24:27], v23, s[56:59], s68 offen sc1
    v_mfma_f32_16x16x32_bf16 v[164:167], a[132:135], a[36:39], v[164:167]
    ds_read_b64_tr_b16 a[166:167], v57 offset:28672
    v_mfma_f32_16x16x32_bf16 v[196:199], a[132:135], a[40:43], v[196:199]
    buffer_load_dwordx4 a[28:31], v24, s[56:59], s68 offen sc1
    v_mfma_f32_16x16x32_bf16 v[228:231], a[132:135], a[44:47], v[228:231]
    ds_read_b64_tr_b16 a[168:169], v58 offset:24576
    s_waitcnt lgkmcnt(15)
    v_mfma_f32_16x16x32_bf16 v[136:139], a[136:139], a[32:35], v[136:139]
    ds_read_b64_tr_b16 a[170:171], v58 offset:28672
    s_add_u32 s68, s68, 16384
    v_mfma_f32_16x16x32_bf16 v[168:171], a[136:139], a[36:39], v[168:171]
    v_mfma_f32_16x16x32_bf16 v[200:203], a[136:139], a[40:43], v[200:203]
    ds_read_b64_tr_b16 a[172:173], v59 offset:24576
    v_mfma_f32_16x16x32_bf16 v[232:235], a[136:139], a[44:47], v[232:235]
    ds_read_b64_tr_b16 a[174:175], v59 offset:28672
    s_mov_b32 s82, 262144
    s_add_u32 m0, s3, 98304
    s_waitcnt lgkmcnt(15)
    v_mfma_f32_16x16x32_bf16 v[140:143], a[140:143], a[32:35], v[140:143]
    buffer_load_dwordx4 v17, s[52:55], s82 offen lds
    v_mfma_f32_16x16x32_bf16 v[172:175], a[140:143], a[36:39], v[172:175]
    ds_read_b64_tr_b16 a[176:177], v60 offset:24576
    v_mfma_f32_16x16x32_bf16 v[204:207], a[140:143], a[40:43], v[204:207]
    ds_read_b64_tr_b16 a[178:179], v60 offset:28672
    v_mfma_f32_16x16x32_bf16 v[236:239], a[140:143], a[44:47], v[236:239]
    s_waitcnt lgkmcnt(15)
    v_mfma_f32_16x16x32_bf16 v[144:147], a[144:147], a[32:35], v[144:147]
    ds_read_b64_tr_b16 a[180:181], v61 offset:24576
    buffer_load_dwordx4 v18, s[52:55], s82 offen offset:1024 lds
    v_mfma_f32_16x16x32_bf16 v[176:179], a[144:147], a[36:39], v[176:179]
    ds_read_b64_tr_b16 a[182:183], v61 offset:28672
    v_mfma_f32_16x16x32_bf16 v[208:211], a[144:147], a[40:43], v[208:211]
    v_mfma_f32_16x16x32_bf16 v[240:243], a[144:147], a[44:47], v[240:243]
    ds_read_b64_tr_b16 a[184:185], v62 offset:24576
    s_waitcnt lgkmcnt(15)
    v_mfma_f32_16x16x32_bf16 v[148:151], a[148:151], a[32:35], v[148:151]
    ds_read_b64_tr_b16 a[186:187], v62 offset:28672
    v_mfma_f32_16x16x32_bf16 v[180:183], a[148:151], a[36:39], v[180:183]
    s_mov_b32 s83, 327680
    s_add_u32 m0, s3, 106496
    v_mfma_f32_16x16x32_bf16 v[212:215], a[148:151], a[40:43], v[212:215]
    ds_read_b64_tr_b16 a[188:189], v63 offset:24576
    buffer_load_dwordx4 v17, s[52:55], s83 offen lds
    v_mfma_f32_16x16x32_bf16 v[244:247], a[148:151], a[44:47], v[244:247]
    ds_read_b64_tr_b16 a[190:191], v63 offset:28672
    v_mfma_f32_16x16x32_bf16 v[152:155], a[152:155], a[32:35], v[152:155]
    v_mfma_f32_16x16x32_bf16 v[184:187], a[152:155], a[36:39], v[184:187]
    v_mfma_f32_16x16x32_bf16 v[216:219], a[152:155], a[40:43], v[216:219]
    buffer_load_dwordx4 v18, s[52:55], s83 offen offset:1024 lds
    v_mfma_f32_16x16x32_bf16 v[248:251], a[152:155], a[44:47], v[248:251]
    s_waitcnt lgkmcnt(15)
    v_mfma_f32_16x16x32_bf16 v[156:159], a[156:159], a[32:35], v[156:159]
    v_mfma_f32_16x16x32_bf16 v[188:191], a[156:159], a[36:39], v[188:191]
    v_mfma_f32_16x16x32_bf16 v[220:223], a[156:159], a[40:43], v[220:223]
    v_mfma_f32_16x16x32_bf16 v[252:255], a[156:159], a[44:47], v[252:255]
    s_waitcnt vmcnt(40) lgkmcnt(14)
    v_mfma_f32_16x16x32_bf16 v[128:131], a[160:163], a[48:51], v[128:131]
    buffer_load_dwordx4 a[32:35], v21, s[56:59], s68 offen sc1
    s_waitcnt vmcnt(40)
    v_mfma_f32_16x16x32_bf16 v[160:163], a[160:163], a[52:55], v[160:163]
    ds_read_b64_tr_b16 a[128:129], v8 offset:0
    s_waitcnt vmcnt(39)
    v_mfma_f32_16x16x32_bf16 v[192:195], a[160:163], a[56:59], v[192:195]
    ds_read_b64_tr_b16 a[130:131], v8 offset:4096
    buffer_load_dwordx4 a[36:39], v22, s[56:59], s68 offen sc1
    s_waitcnt vmcnt(39)
    v_mfma_f32_16x16x32_bf16 v[224:227], a[160:163], a[60:63], v[224:227]
    s_waitcnt lgkmcnt(14)
    v_mfma_f32_16x16x32_bf16 v[132:135], a[164:167], a[48:51], v[132:135]
    ds_read_b64_tr_b16 a[132:133], v9 offset:0
    buffer_load_dwordx4 a[40:43], v23, s[56:59], s68 offen sc1
    v_mfma_f32_16x16x32_bf16 v[164:167], a[164:167], a[52:55], v[164:167]
    ds_read_b64_tr_b16 a[134:135], v9 offset:4096
    v_mfma_f32_16x16x32_bf16 v[196:199], a[164:167], a[56:59], v[196:199]
    buffer_load_dwordx4 a[44:47], v24, s[56:59], s68 offen sc1
    v_mfma_f32_16x16x32_bf16 v[228:231], a[164:167], a[60:63], v[228:231]
    ds_read_b64_tr_b16 a[136:137], v10 offset:0
    s_waitcnt lgkmcnt(15)
    v_mfma_f32_16x16x32_bf16 v[136:139], a[168:171], a[48:51], v[136:139]
    ds_read_b64_tr_b16 a[138:139], v10 offset:4096
    s_add_u32 s68, s68, 16384
    v_mfma_f32_16x16x32_bf16 v[168:171], a[168:171], a[52:55], v[168:171]
    v_mfma_f32_16x16x32_bf16 v[200:203], a[168:171], a[56:59], v[200:203]
    ds_read_b64_tr_b16 a[140:141], v11 offset:0
    v_mfma_f32_16x16x32_bf16 v[232:235], a[168:171], a[60:63], v[232:235]
    ds_read_b64_tr_b16 a[142:143], v11 offset:4096
    s_mov_b32 s82, 393216
    s_add_u32 m0, s3, 114688
    s_waitcnt lgkmcnt(15)
    v_mfma_f32_16x16x32_bf16 v[140:143], a[172:175], a[48:51], v[140:143]
    buffer_load_dwordx4 v17, s[52:55], s82 offen lds
    v_mfma_f32_16x16x32_bf16 v[172:175], a[172:175], a[52:55], v[172:175]
    ds_read_b64_tr_b16 a[144:145], v12 offset:0
    v_mfma_f32_16x16x32_bf16 v[204:207], a[172:175], a[56:59], v[204:207]
    ds_read_b64_tr_b16 a[146:147], v12 offset:4096
    v_mfma_f32_16x16x32_bf16 v[236:239], a[172:175], a[60:63], v[236:239]
    s_waitcnt lgkmcnt(15)
    v_mfma_f32_16x16x32_bf16 v[144:147], a[176:179], a[48:51], v[144:147]
    ds_read_b64_tr_b16 a[148:149], v13 offset:0
    buffer_load_dwordx4 v18, s[52:55], s82 offen offset:1024 lds
    v_mfma_f32_16x16x32_bf16 v[176:179], a[176:179], a[52:55], v[176:179]
    ds_read_b64_tr_b16 a[150:151], v13 offset:4096
    v_mfma_f32_16x16x32_bf16 v[208:211], a[176:179], a[56:59], v[208:211]
    v_mfma_f32_16x16x32_bf16 v[240:243], a[176:179], a[60:63], v[240:243]
    ds_read_b64_tr_b16 a[152:153], v14 offset:0
    s_waitcnt lgkmcnt(15)
    v_mfma_f32_16x16x32_bf16 v[148:151], a[180:183], a[48:51], v[148:151]
    ds_read_b64_tr_b16 a[154:155], v14 offset:4096
    v_mfma_f32_16x16x32_bf16 v[180:183], a[180:183], a[52:55], v[180:183]
    s_mov_b32 s83, 458752
    s_add_u32 m0, s3, 122880
    v_mfma_f32_16x16x32_bf16 v[212:215], a[180:183], a[56:59], v[212:215]
    ds_read_b64_tr_b16 a[156:157], v15 offset:0
    buffer_load_dwordx4 v17, s[52:55], s83 offen lds
    v_mfma_f32_16x16x32_bf16 v[244:247], a[180:183], a[60:63], v[244:247]
    ds_read_b64_tr_b16 a[158:159], v15 offset:4096
    v_mfma_f32_16x16x32_bf16 v[152:155], a[184:187], a[48:51], v[152:155]
    v_mfma_f32_16x16x32_bf16 v[184:187], a[184:187], a[52:55], v[184:187]
    v_mfma_f32_16x16x32_bf16 v[216:219], a[184:187], a[56:59], v[216:219]
    buffer_load_dwordx4 v18, s[52:55], s83 offen offset:1024 lds
    v_mfma_f32_16x16x32_bf16 v[248:251], a[184:187], a[60:63], v[248:251]
    s_waitcnt lgkmcnt(15)
    v_mfma_f32_16x16x32_bf16 v[156:159], a[188:191], a[48:51], v[156:159]
    v_mfma_f32_16x16x32_bf16 v[188:191], a[188:191], a[52:55], v[188:191]
    v_mfma_f32_16x16x32_bf16 v[220:223], a[188:191], a[56:59], v[220:223]
    v_mfma_f32_16x16x32_bf16 v[252:255], a[188:191], a[60:63], v[252:255]
    s_waitcnt vmcnt(44) lgkmcnt(14)
    v_mfma_f32_16x16x32_bf16 v[128:131], a[128:131], a[64:67], v[128:131]
    buffer_load_dwordx4 a[48:51], v21, s[56:59], s68 offen sc1
    s_waitcnt vmcnt(44)
    v_mfma_f32_16x16x32_bf16 v[160:163], a[128:131], a[68:71], v[160:163]
    ds_read_b64_tr_b16 a[160:161], v8 offset:8192
    s_waitcnt vmcnt(43)
    v_mfma_f32_16x16x32_bf16 v[192:195], a[128:131], a[72:75], v[192:195]
    ds_read_b64_tr_b16 a[162:163], v8 offset:12288
    buffer_load_dwordx4 a[52:55], v22, s[56:59], s68 offen sc1
    s_waitcnt vmcnt(43)
    v_mfma_f32_16x16x32_bf16 v[224:227], a[128:131], a[76:79], v[224:227]
    s_waitcnt lgkmcnt(14)
    v_mfma_f32_16x16x32_bf16 v[132:135], a[132:135], a[64:67], v[132:135]
    ds_read_b64_tr_b16 a[164:165], v9 offset:8192
    buffer_load_dwordx4 a[56:59], v23, s[56:59], s68 offen sc1
    v_mfma_f32_16x16x32_bf16 v[164:167], a[132:135], a[68:71], v[164:167]
    ds_read_b64_tr_b16 a[166:167], v9 offset:12288
    v_mfma_f32_16x16x32_bf16 v[196:199], a[132:135], a[72:75], v[196:199]
    buffer_load_dwordx4 a[60:63], v24, s[56:59], s68 offen sc1
    v_mfma_f32_16x16x32_bf16 v[228:231], a[132:135], a[76:79], v[228:231]
    ds_read_b64_tr_b16 a[168:169], v10 offset:8192
    s_waitcnt lgkmcnt(15)
    v_mfma_f32_16x16x32_bf16 v[136:139], a[136:139], a[64:67], v[136:139]
    ds_read_b64_tr_b16 a[170:171], v10 offset:12288
    s_add_u32 s68, s68, 16384
    v_mfma_f32_16x16x32_bf16 v[168:171], a[136:139], a[68:71], v[168:171]
    v_mfma_f32_16x16x32_bf16 v[200:203], a[136:139], a[72:75], v[200:203]
    ds_read_b64_tr_b16 a[172:173], v11 offset:8192
    v_mfma_f32_16x16x32_bf16 v[232:235], a[136:139], a[76:79], v[232:235]
    ds_read_b64_tr_b16 a[174:175], v11 offset:12288
    s_waitcnt lgkmcnt(15)
    v_mfma_f32_16x16x32_bf16 v[140:143], a[140:143], a[64:67], v[140:143]
    v_mfma_f32_16x16x32_bf16 v[172:175], a[140:143], a[68:71], v[172:175]
    ds_read_b64_tr_b16 a[176:177], v12 offset:8192
    v_mfma_f32_16x16x32_bf16 v[204:207], a[140:143], a[72:75], v[204:207]
    ds_read_b64_tr_b16 a[178:179], v12 offset:12288
    v_mfma_f32_16x16x32_bf16 v[236:239], a[140:143], a[76:79], v[236:239]
    s_waitcnt lgkmcnt(15)
    v_mfma_f32_16x16x32_bf16 v[144:147], a[144:147], a[64:67], v[144:147]
    ds_read_b64_tr_b16 a[180:181], v13 offset:8192
    v_mfma_f32_16x16x32_bf16 v[176:179], a[144:147], a[68:71], v[176:179]
    ds_read_b64_tr_b16 a[182:183], v13 offset:12288
    v_mfma_f32_16x16x32_bf16 v[208:211], a[144:147], a[72:75], v[208:211]
    v_mfma_f32_16x16x32_bf16 v[240:243], a[144:147], a[76:79], v[240:243]
    ds_read_b64_tr_b16 a[184:185], v14 offset:8192
    s_waitcnt lgkmcnt(15)
    v_mfma_f32_16x16x32_bf16 v[148:151], a[148:151], a[64:67], v[148:151]
    ds_read_b64_tr_b16 a[186:187], v14 offset:12288
    v_mfma_f32_16x16x32_bf16 v[180:183], a[148:151], a[68:71], v[180:183]
    v_mfma_f32_16x16x32_bf16 v[212:215], a[148:151], a[72:75], v[212:215]
    ds_read_b64_tr_b16 a[188:189], v15 offset:8192
    v_mfma_f32_16x16x32_bf16 v[244:247], a[148:151], a[76:79], v[244:247]
    ds_read_b64_tr_b16 a[190:191], v15 offset:12288
    v_mfma_f32_16x16x32_bf16 v[152:155], a[152:155], a[64:67], v[152:155]
    v_mfma_f32_16x16x32_bf16 v[184:187], a[152:155], a[68:71], v[184:187]
    v_mfma_f32_16x16x32_bf16 v[216:219], a[152:155], a[72:75], v[216:219]
    v_mfma_f32_16x16x32_bf16 v[248:251], a[152:155], a[76:79], v[248:251]
    s_waitcnt lgkmcnt(15)
    v_mfma_f32_16x16x32_bf16 v[156:159], a[156:159], a[64:67], v[156:159]
    v_mfma_f32_16x16x32_bf16 v[188:191], a[156:159], a[68:71], v[188:191]
    v_mfma_f32_16x16x32_bf16 v[220:223], a[156:159], a[72:75], v[220:223]
    v_mfma_f32_16x16x32_bf16 v[252:255], a[156:159], a[76:79], v[252:255]
    s_waitcnt vmcnt(43) lgkmcnt(14)
    v_mfma_f32_16x16x32_bf16 v[128:131], a[160:163], a[80:83], v[128:131]
    v_readfirstlane_b32 s86, v44
    s_cmp_eq_u32 s86, 64
    s_cbranch_scc0 L_spO
L_okO:
    buffer_load_dwordx4 a[64:67], v16, s[56:59], s69 offen offset:0 sc1
    s_waitcnt vmcnt(43)
    v_mfma_f32_16x16x32_bf16 v[160:163], a[160:163], a[84:87], v[160:163]
    ds_read_b64_tr_b16 a[128:129], v8 offset:16384
    s_waitcnt vmcnt(42)
    v_mfma_f32_16x16x32_bf16 v[192:195], a[160:163], a[88:91], v[192:195]
    ds_read_b64_tr_b16 a[130:131], v8 offset:20480
    buffer_load_dwordx4 a[68:71], v16, s[56:59], s69 offen offset:1024 sc1
    s_waitcnt vmcnt(42)
    v_mfma_f32_16x16x32_bf16 v[224:227], a[160:163], a[92:95], v[224:227]
    s_waitcnt lgkmcnt(14)
    v_mfma_f32_16x16x32_bf16 v[132:135], a[164:167], a[80:83], v[132:135]
    ds_read_b64_tr_b16 a[132:133], v9 offset:16384
    buffer_load_dwordx4 a[72:75], v16, s[56:59], s69 offen offset:2048 sc1
    v_mfma_f32_16x16x32_bf16 v[164:167], a[164:167], a[84:87], v[164:167]
    ds_read_b64_tr_b16 a[134:135], v9 offset:20480
    v_mfma_f32_16x16x32_bf16 v[196:199], a[164:167], a[88:91], v[196:199]
    buffer_load_dwordx4 a[76:79], v16, s[56:59], s69 offen offset:3072 sc1
    v_mfma_f32_16x16x32_bf16 v[228:231], a[164:167], a[92:95], v[228:231]
    ds_read_b64_tr_b16 a[136:137], v10 offset:16384
    s_waitcnt lgkmcnt(15)
    v_mfma_f32_16x16x32_bf16 v[136:139], a[168:171], a[80:83], v[136:139]
    ds_read_b64_tr_b16 a[138:139], v10 offset:20480
    s_add_u32 s69, s69, 4096
    v_mfma_f32_16x16x32_bf16 v[168:171], a[168:171], a[84:87], v[168:171]
    v_mfma_f32_16x16x32_bf16 v[200:203], a[168:171], a[88:91], v[200:203]
    ds_read_b64_tr_b16 a[140:141], v11 offset:16384
    v_mfma_f32_16x16x32_bf16 v[232:235], a[168:171], a[92:95], v[232:235]
    ds_read_b64_tr_b16 a[142:143], v11 offset:20480
    s_waitcnt lgkmcnt(15)
    v_mfma_f32_16x16x32_bf16 v[140:143], a[172:175], a[80:83], v[140:143]
    v_mfma_f32_16x16x32_bf16 v[172:175], a[172:175], a[84:87], v[172:175]
    ds_read_b64_tr_b16 a[144:145], v12 offset:16384
    v_mfma_f32_16x16x32_bf16 v[204:207], a[172:175], a[88:91], v[204:207]
    ds_read_b64_tr_b16 a[146:147], v12 offset:20480
    v_mfma_f32_16x16x32_bf16 v[236:239], a[172:175], a[92:95], v[236:239]
    s_waitcnt lgkmcnt(15)
    v_mfma_f32_16x16x32_bf16 v[144:147], a[176:179], a[80:83], v[144:147]
    ds_read_b64_tr_b16 a[148:149], v13 offset:16384
    v_mfma_f32_16x16x32_bf16 v[176:179], a[176:179], a[84:87], v[176:179]
    ds_read_b64_tr_b16 a[150:151], v13 offset:20480
    v_mfma_f32_16x16x32_bf16 v[208:211], a[176:179], a[88:91], v[208:211]
    v_mfma_f32_16x16x32_bf16 v[240:243], a[176:179], a[92:95], v[240:243]
    ds_read_b64_tr_b16 a[152:153], v14 offset:16384
    s_waitcnt lgkmcnt(15)
    v_mfma_f32_16x16x32_bf16 v[148:151], a[180:183], a[80:83], v[148:151]
    ds_read_b64_tr_b16 a[154:155], v14 offset:20480
    v_mfma_f32_16x16x32_bf16 v[180:183], a[180:183], a[84:87], v[180:183]
    v_mfma_f32_16x16x32_bf16 v[212:215], a[180:183], a[88:91], v[212:215]
    ds_read_b64_tr_b16 a[156:157], v15 offset:16384
    v_mfma_f32_16x16x32_bf16 v[244:247], a[180:183], a[92:95], v[244:247]
    ds_read_b64_tr_b16 a[158:159], v15 offset:20480
    v_mfma_f32_16x16x32_bf16 v[152:155], a[184:187], a[80:83], v[152:155]
    v_mfma_f32_16x16x32_bf16 v[184:187], a[184:187], a[84:87], v[184:187]
    v_mfma_f32_16x16x32_bf16 v[216:219], a[184:187], a[88:91], v[216:219]
    v_mfma_f32_16x16x32_bf16 v[248:251], a[184:187], a[92:95], v[248:251]
    s_waitcnt lgkmcnt(15)
    v_mfma_f32_16x16x32_bf16 v[156:159], a[188:191], a[80:83], v[156:159]
    v_mfma_f32_16x16x32_bf16 v[188:191], a[188:191], a[84:87], v[188:191]
    v_mfma_f32_16x16x32_bf16 v[220:223], a[188:191], a[88:91], v[220:223]
    v_mfma_f32_16x16x32_bf16 v[252:255], a[188:191], a[92:95], v[252:255]
    s_waitcnt vmcnt(43) lgkmcnt(14)
    v_mfma_f32_16x16x32_bf16 v[128:131], a[128:131], a[96:99], v[128:131]
    buffer_load_dwordx4 a[80:83], v16, s[56:59], s69 offen offset:0 sc1
    s_waitcnt vmcnt(43)
    v_mfma_f32_16x16x32_bf16 v[160:163], a[128:131], a[100:103], v[160:163]
    ds_read_b64_tr_b16 a[160:161], v8 offset:24576
    s_waitcnt vmcnt(42)
    v_mfma_f32_16x16x32_bf16 v[192:195], a[128:131], a[104:107], v[192:195]
    ds_read_b64_tr_b16 a[162:163], v8 offset:28672
    buffer_load_dwordx4 a[84:87], v16, s[56:59], s69 offen offset:1024 sc1
    s_waitcnt vmcnt(42)
    v_mfma_f32_16x16x32_bf16 v[224:227], a[128:131], a[108:111], v[224:227]
    s_waitcnt lgkmcnt(14)
    v_mfma_f32_16x16x32_bf16 v[132:135], a[132:135], a[96:99], v[132:135]
    ds_read_b64_tr_b16 a[164:165], v9 offset:24576
    buffer_load_dwordx4 a[88:91], v16, s[56:59], s69 offen offset:2048 sc1
    v_mfma_f32_16x16x32_bf16 v[164:167], a[132:135], a[100:103], v[164:167]
    ds_read_b64_tr_b16 a[166:167], v9 offset:28672
    v_mfma_f32_16x16x32_bf16 v[196:199], a[132:135], a[104:107], v[196:199]
    buffer_load_dwordx4 a[92:95], v16, s[56:59], s69 offen offset:3072 sc1
    v_mfma_f32_16x16x32_bf16 v[228:231], a[132:135], a[108:111], v[228:231]
    ds_read_b64_tr_b16 a[168:169], v10 offset:24576
    s_waitcnt lgkmcnt(15)
    v_mfma_f32_16x16x32_bf16 v[136:139], a[136:139], a[96:99], v[136:139]
    ds_read_b64_tr_b16 a[170:171], v10 offset:28672
    s_add_u32 s69, s69, 4096
    v_mfma_f32_16x16x32_bf16 v[168:171], a[136:139], a[100:103], v[168:171]
    v_mfma_f32_16x16x32_bf16 v[200:203], a[136:139], a[104:107], v[200:203]
    ds_read_b64_tr_b16 a[172:173], v11 offset:24576
    v_mfma_f32_16x16x32_bf16 v[232:235], a[136:139], a[108:111], v[232:235]
    ds_read_b64_tr_b16 a[174:175], v11 offset:28672
    s_waitcnt lgkmcnt(15)
    v_mfma_f32_16x16x32_bf16 v[140:143], a[140:143], a[96:99], v[140:143]
    v_mfma_f32_16x16x32_bf16 v[172:175], a[140:143], a[100:103], v[172:175]
    ds_read_b64_tr_b16 a[176:177], v12 offset:24576
    v_mfma_f32_16x16x32_bf16 v[204:207], a[140:143], a[104:107], v[204:207]
    ds_read_b64_tr_b16 a[178:179], v12 offset:28672
    v_mfma_f32_16x16x32_bf16 v[236:239], a[140:143], a[108:111], v[236:239]
    s_waitcnt lgkmcnt(15)
    v_mfma_f32_16x16x32_bf16 v[144:147], a[144:147], a[96:99], v[144:147]
    ds_read_b64_tr_b16 a[180:181], v13 offset:24576
    v_mfma_f32_16x16x32_bf16 v[176:179], a[144:147], a[100:103], v[176:179]
    ds_read_b64_tr_b16 a[182:183], v13 offset:28672
    v_mfma_f32_16x16x32_bf16 v[208:211], a[144:147], a[104:107], v[208:211]
    v_mfma_f32_16x16x32_bf16 v[240:243], a[144:147], a[108:111], v[240:243]
    ds_read_b64_tr_b16 a[184:185], v14 offset:24576
    s_waitcnt lgkmcnt(15)
    v_mfma_f32_16x16x32_bf16 v[148:151], a[148:151], a[96:99], v[148:151]
    ds_read_b64_tr_b16 a[186:187], v14 offset:28672
    v_mfma_f32_16x16x32_bf16 v[180:183], a[148:151], a[100:103], v[180:183]
    v_mfma_f32_16x16x32_bf16 v[212:215], a[148:151], a[104:107], v[212:215]
    ds_read_b64_tr_b16 a[188:189], v15 offset:24576
    v_mfma_f32_16x16x32_bf16 v[244:247], a[148:151], a[108:111], v[244:247]
    ds_read_b64_tr_b16 a[190:191], v15 offset:28672
    v_mfma_f32_16x16x32_bf16 v[152:155], a[152:155], a[96:99], v[152:155]
    v_mfma_f32_16x16x32_bf16 v[184:187], a[152:155], a[100:103], v[184:187]
    v_mfma_f32_16x16x32_bf16 v[216:219], a[152:155], a[104:107], v[216:219]
    v_mfma_f32_16x16x32_bf16 v[248:251], a[152:155], a[108:111], v[248:251]
    s_waitcnt lgkmcnt(15)
    v_mfma_f32_16x16x32_bf16 v[156:159], a[156:159], a[96:99], v[156:159]
    v_mfma_f32_16x16x32_bf16 v[188:191], a[156:159], a[100:103], v[188:191]
    v_mfma_f32_16x16x32_bf16 v[220:223], a[156:159], a[104:107], v[220:223]
    v_mfma_f32_16x16x32_bf16 v[252:255], a[156:159], a[108:111], v[252:255]
    s_waitcnt vmcnt(43) lgkmcnt(14)
    v_mfma_f32_16x16x32_bf16 v[128:131], a[160:163], a[112:115], v[128:131]
    buffer_load_dwordx4 a[96:99], v16, s[56:59], s69 offen offset:0 sc1
    s_waitcnt vmcnt(43)
    v_mfma_f32_16x16x32_bf16 v[160:163], a[160:163], a[116:119], v[160:163]
    ds_read_b64_tr_b16 a[128:129], v8 offset:32768
    s_waitcnt vmcnt(42)
    v_mfma_f32_16x16x32_bf16 v[192:195], a[160:163], a[120:123], v[192:195]
    ds_read_b64_tr_b16 a[130:131], v8 offset:36864
    buffer_load_dwordx4 a[100:103], v16, s[56:59], s69 offen offset:1024 sc1
    s_waitcnt vmcnt(42)
    v_mfma_f32_16x16x32_bf16 v[224:227], a[160:163], a[124:127], v[224:227]
    s_waitcnt lgkmcnt(14)
    v_mfma_f32_16x16x32_bf16 v[132:135], a[164:167], a[112:115], v[132:135]
    ds_read_b64_tr_b16 a[132:133], v9 offset:32768
    buffer_load_dwordx4 a[104:107], v16, s[56:59], s69 offen offset:2048 sc1
    v_mfma_f32_16x16x32_bf16 v[164:167], a[164:167], a[116:119], v[164:167]
    ds_read_b64_tr_b16 a[134:135], v9 offset:36864
    v_mfma_f32_16x16x32_bf16 v[196:199], a[164:167], a[120:123], v[196:199]
    buffer_load_dwordx4 a[108:111], v16, s[56:59], s69 offen offset:3072 sc1
    v_mfma_f32_16x16x32_bf16 v[228:231], a[164:167], a[124:127], v[228:231]
    ds_read_b64_tr_b16 a[136:137], v10 offset:32768
    s_waitcnt lgkmcnt(15)
    v_mfma_f32_16x16x32_bf16 v[136:139], a[168:171], a[112:115], v[136:139]
    ds_read_b64_tr_b16 a[138:139], v10 offset:36864
    s_add_u32 s69, s69, 4096
    v_mfma_f32_16x16x32_bf16 v[168:171], a[168:171], a[116:119], v[168:171]
    v_mfma_f32_16x16x32_bf16 v[200:203], a[168:171], a[120:123], v[200:203]
    ds_read_b64_tr_b16 a[140:141], v11 offset:32768
    v_mfma_f32_16x16x32_bf16 v[232:235], a[168:171], a[124:127], v[232:235]
    ds_read_b64_tr_b16 a[142:143], v11 offset:36864
    s_waitcnt lgkmcnt(15)
    v_mfma_f32_16x16x32_bf16 v[140:143], a[172:175], a[112:115], v[140:143]
    v_mfma_f32_16x16x32_bf16 v[172:175], a[172:175], a[116:119], v[172:175]
    ds_read_b64_tr_b16 a[144:145], v12 offset:32768
    v_mfma_f32_16x16x32_bf16 v[204:207], a[172:175], a[120:123], v[204:207]
    ds_read_b64_tr_b16 a[146:147], v12 offset:36864
    v_mfma_f32_16x16x32_bf16 v[236:239], a[172:175], a[124:127], v[236:239]
    s_waitcnt lgkmcnt(15)
    v_mfma_f32_16x16x32_bf16 v[144:147], a[176:179], a[112:115], v[144:147]
    ds_read_b64_tr_b16 a[148:149], v13 offset:32768
    v_mfma_f32_16x16x32_bf16 v[176:179], a[176:179], a[116:119], v[176:179]
    ds_read_b64_tr_b16 a[150:151], v13 offset:36864
    v_mfma_f32_16x16x32_bf16 v[208:211], a[176:179], a[120:123], v[208:211]
    v_mfma_f32_16x16x32_bf16 v[240:243], a[176:179], a[124:127], v[240:243]
    ds_read_b64_tr_b16 a[152:153], v14 offset:32768
    s_waitcnt lgkmcnt(15)
    v_mfma_f32_16x16x32_bf16 v[148:151], a[180:183], a[112:115], v[148:151]
    ds_read_b64_tr_b16 a[154:155], v14 offset:36864
    v_mfma_f32_16x16x32_bf16 v[180:183], a[180:183], a[116:119], v[180:183]
    v_mfma_f32_16x16x32_bf16 v[212:215], a[180:183], a[120:123], v[212:215]
    ds_read_b64_tr_b16 a[156:157], v15 offset:32768
    v_mfma_f32_16x16x32_bf16 v[244:247], a[180:183], a[124:127], v[244:247]
    ds_read_b64_tr_b16 a[158:159], v15 offset:36864
    v_mfma_f32_16x16x32_bf16 v[152:155], a[184:187], a[112:115], v[152:155]
    v_mfma_f32_16x16x32_bf16 v[184:187], a[184:187], a[116:119], v[184:187]
    v_mfma_f32_16x16x32_bf16 v[216:219], a[184:187], a[120:123], v[216:219]
    v_mfma_f32_16x16x32_bf16 v[248:251], a[184:187], a[124:127], v[248:251]
    s_waitcnt lgkmcnt(15)
    v_mfma_f32_16x16x32_bf16 v[156:159], a[188:191], a[112:115], v[156:159]
    v_mfma_f32_16x16x32_bf16 v[188:191], a[188:191], a[116:119], v[188:191]
    v_mfma_f32_16x16x32_bf16 v[220:223], a[188:191], a[120:123], v[220:223]
    v_mfma_f32_16x16x32_bf16 v[252:255], a[188:191], a[124:127], v[252:255]
    s_waitcnt vmcnt(16)
    s_barrier
    s_waitcnt lgkmcnt(14)
    v_mfma_f32_16x16x32_bf16 v[128:131], a[128:131], a[0:3], v[128:131]
    buffer_load_dwordx4 a[112:115], v16, s[56:59], s69 offen offset:0 sc1
    v_mfma_f32_16x16x32_bf16 v[160:163], a[128:131], a[4:7], v[160:163]
    ds_read_b64_tr_b16 a[160:161], v8 offset:40960
    v_mfma_f32_16x16x32_bf16 v[192:195], a[128:131], a[8:11], v[192:195]
    ds_read_b64_tr_b16 a[162:163], v8 offset:45056
    buffer_load_dwordx4 a[116:119], v16, s[56:59], s69 offen offset:1024 sc1
    v_mfma_f32_16x16x32_bf16 v[224:227], a[128:131], a[12:15], v[224:227]
    s_waitcnt lgkmcnt(14)
    v_mfma_f32_16x16x32_bf16 v[132:135], a[132:135], a[0:3], v[132:135]
    ds_read_b64_tr_b16 a[164:165], v9 offset:40960
    buffer_load_dwordx4 a[120:123], v16, s[56:59], s69 offen offset:2048 sc1
    v_mfma_f32_16x16x32_bf16 v[164:167], a[132:135], a[4:7], v[164:167]
    ds_read_b64_tr_b16 a[166:167], v9 offset:45056
    v_mfma_f32_16x16x32_bf16 v[196:199], a[132:135], a[8:11], v[196:199]
    buffer_load_dwordx4 a[124:127], v16, s[56:59], s69 offen offset:3072 sc1
    v_mfma_f32_16x16x32_bf16 v[228:231], a[132:135], a[12:15], v[228:231]
    ds_read_b64_tr_b16 a[168:169], v10 offset:40960
    s_waitcnt lgkmcnt(15)
    v_mfma_f32_16x16x32_bf16 v[136:139], a[136:139], a[0:3], v[136:139]
    ds_read_b64_tr_b16 a[170:171], v10 offset:45056
    s_add_u32 s69, s69, 4096
    v_mfma_f32_16x16x32_bf16 v[168:171], a[136:139], a[4:7], v[168:171]
    v_mfma_f32_16x16x32_bf16 v[200:203], a[136:139], a[8:11], v[200:203]
    ds_read_b64_tr_b16 a[172:173], v11 offset:40960
    v_mfma_f32_16x16x32_bf16 v[232:235], a[136:139], a[12:15], v[232:235]
    ds_read_b64_tr_b16 a[174:175], v11 offset:45056
    s_mov_b32 s82, 524288
    s_add_u32 m0, s3, 131072
    s_waitcnt lgkmcnt(15)
    v_mfma_f32_16x16x32_bf16 v[140:143], a[140:143], a[0:3], v[140:143]
    buffer_load_dwordx4 v17, s[52:55], s82 offen lds
    v_mfma_f32_16x16x32_bf16 v[172:175], a[140:143], a[4:7], v[172:175]
    ds_read_b64_tr_b16 a[176:177], v12 offset:40960
    v_mfma_f32_16x16x32_bf16 v[204:207], a[140:143], a[8:11], v[204:207]
    ds_read_b64_tr_b16 a[178:179], v12 offset:45056
    v_mfma_f32_16x16x32_bf16 v[236:239], a[140:143], a[12:15], v[236:239]
    s_waitcnt lgkmcnt(15)
    v_mfma_f32_16x16x32_bf16 v[144:147], a[144:147], a[0:3], v[144:147]
    ds_read_b64_tr_b16 a[180:181], v13 offset:40960
    buffer_load_dwordx4 v18, s[52:55], s82 offen offset:1024 lds
    v_mfma_f32_16x16x32_bf16 v[176:179], a[144:147], a[4:7], v[176:179]
    ds_read_b64_tr_b16 a[182:183], v13 offset:45056
    v_mfma_f32_16x16x32_bf16 v[208:211], a[144:147], a[8:11], v[208:211]
    v_mfma_f32_16x16x32_bf16 v[240:243], a[144:147], a[12:15], v[240:243]
    ds_read_b64_tr_b16 a[184:185], v14 offset:40960
    s_waitcnt lgkmcnt(15)
    v_mfma_f32_16x16x32_bf16 v[148:151], a[148:151], a[0:3], v[148:151]
    ds_read_b64_tr_b16 a[186:187], v14 offset:45056
    v_mfma_f32_16x16x32_bf16 v[180:183], a[148:151], a[4:7], v[180:183]
    s_mov_b32 s83, 589824
    s_add_u32 m0, s3, 139264
    v_mfma_f32_16x16x32_bf16 v[212:215], a[148:151], a[8:11], v[212:215]
    ds_read_b64_tr_b16 a[188:189], v15 offset:40960
    buffer_load_dwordx4 v17, s[52:55], s83 offen lds
    v_mfma_f32_16x16x32_bf16 v[244:247], a[148:151], a[12:15], v[244:247]
    ds_read_b64_tr_b16 a[190:191], v15 offset:45056
    v_mfma_f32_16x16x32_bf16 v[152:155], a[152:155], a[0:3], v[152:155]
    v_mfma_f32_16x16x32_bf16 v[184:187], a[152:155], a[4:7], v[184:187]
    v_mfma_f32_16x16x32_bf16 v[216:219], a[152:155], a[8:11], v[216:219]
    buffer_load_dwordx4 v18, s[52:55], s83 offen offset:1024 lds
    v_mfma_f32_16x16x32_bf16 v[248:251], a[152:155], a[12:15], v[248:251]
    s_waitcnt lgkmcnt(15)
    v_mfma_f32_16x16x32_bf16 v[156:159], a[156:159], a[0:3], v[156:159]
    v_mfma_f32_16x16x32_bf16 v[188:191], a[156:159], a[4:7], v[188:191]
    v_mfma_f32_16x16x32_bf16 v[220:223], a[156:159], a[8:11], v[220:223]
    v_mfma_f32_16x16x32_bf16 v[252:255], a[156:159], a[12:15], v[252:255]
    s_waitcnt lgkmcnt(14)
    v_mfma_f32_16x16x32_bf16 v[128:131], a[160:163], a[16:19], v[128:131]
    buffer_load_dwordx4 a[0:3], v16, s[56:59], s69 offen offset:0 sc1
    v_mfma_f32_16x16x32_bf16 v[160:163], a[160:163], a[20:23], v[160:163]
    ds_read_b64_tr_b16 a[128:129], v8 offset:49152
    v_mfma_f32_16x16x32_bf16 v[192:195], a[160:163], a[24:27], v[192:195]
    ds_read_b64_tr_b16 a[130:131], v8 offset:53248
    buffer_load_dwordx4 a[4:7], v16, s[56:59], s69 offen offset:1024 sc1
    v_mfma_f32_16x16x32_bf16 v[224:227], a[160:163], a[28:31], v[224:227]
    s_waitcnt lgkmcnt(14)
    v_mfma_f32_16x16x32_bf16 v[132:135], a[164:167], a[16:19], v[132:135]
    ds_read_b64_tr_b16 a[132:133], v9 offset:49152
    buffer_load_dwordx4 a[8:11], v16, s[56:59], s69 offen offset:2048 sc1
    v_mfma_f32_16x16x32_bf16 v[164:167], a[164:167], a[20:23], v[164:167]
    ds_read_b64_tr_b16 a[134:135], v9 offset:53248
    v_mfma_f32_16x16x32_bf16 v[196:199], a[164:167], a[24:27], v[196:199]
    buffer_load_dwordx4 a[12:15], v16, s[56:59], s69 offen offset:3072 sc1
    v_mfma_f32_16x16x32_bf16 v[228:231], a[164:167], a[28:31], v[228:231]
    ds_read_b64_tr_b16 a[136:137], v10 offset:49152
    s_waitcnt lgkmcnt(15)
    v_mfma_f32_16x16x32_bf16 v[136:139], a[168:171], a[16:19], v[136:139]
    ds_read_b64_tr_b16 a[138:139], v10 offset:53248
    s_add_u32 s69, s69, 4096
    v_mfma_f32_16x16x32_bf16 v[168:171], a[168:171], a[20:23], v[168:171]
    v_mfma_f32_16x16x32_bf16 v[200:203], a[168:171], a[24:27], v[200:203]
    ds_read_b64_tr_b16 a[140:141], v11 offset:49152
    v_mfma_f32_16x16x32_bf16 v[232:235], a[168:171], a[28:31], v[232:235]
    ds_read_b64_tr_b16 a[142:143], v11 offset:53248
    s_mov_b32 s82, 655360
    s_add_u32 m0, s3, 147456
    s_waitcnt lgkmcnt(15)
    v_mfma_f32_16x16x32_bf16 v[140:143], a[172:175], a[16:19], v[140:143]
    buffer_load_dwordx4 v17, s[52:55], s82 offen lds
    v_mfma_f32_16x16x32_bf16 v[172:175], a[172:175], a[20:23], v[172:175]
    ds_read_b64_tr_b16 a[144:145], v12 offset:49152
    v_mfma_f32_16x16x32_bf16 v[204:207], a[172:175], a[24:27], v[204:207]
    ds_read_b64_tr_b16 a[146:147], v12 offset:53248
    v_mfma_f32_16x16x32_bf16 v[236:239], a[172:175], a[28:31], v[236:239]
    s_waitcnt lgkmcnt(15)
    v_mfma_f32_16x16x32_bf16 v[144:147], a[176:179], a[16:19], v[144:147]
    ds_read_b64_tr_b16 a[148:149], v13 offset:49152
    buffer_load_dwordx4 v18, s[52:55], s82 offen offset:1024 lds
    v_mfma_f32_16x16x32_bf16 v[176:179], a[176:179], a[20:23], v[176:179]
    ds_read_b64_tr_b16 a[150:151], v13 offset:53248
    v_mfma_f32_16x16x32_bf16 v[208:211], a[176:179], a[24:27], v[208:211]
    v_mfma_f32_16x16x32_bf16 v[240:243], a[176:179], a[28:31], v[240:243]
    ds_read_b64_tr_b16 a[152:153], v14 offset:49152
    s_waitcnt lgkmcnt(15)
    v_mfma_f32_16x16x32_bf16 v[148:151], a[180:183], a[16:19], v[148:151]
    ds_read_b64_tr_b16 a[154:155], v14 offset:53248
    v_mfma_f32_16x16x32_bf16 v[180:183], a[180:183], a[20:23], v[180:183]
    s_mov_b32 s83, 720896
    s_add_u32 m0, s3, 155648
    v_mfma_f32_16x16x32_bf16 v[212:215], a[180:183], a[24:27], v[212:215]
    ds_read_b64_tr_b16 a[156:157], v15 offset:49152
    buffer_load_dwordx4 v17, s[52:55], s83 offen lds
    v_mfma_f32_16x16x32_bf16 v[244:247], a[180:183], a[28:31], v[244:247]
    ds_read_b64_tr_b16 a[158:159], v15 offset:53248
    v_mfma_f32_16x16x32_bf16 v[152:155], a[184:187], a[16:19], v[152:155]
    v_mfma_f32_16x16x32_bf16 v[184:187], a[184:187], a[20:23], v[184:187]
    v_mfma_f32_16x16x32_bf16 v[216:219], a[184:187], a[24:27], v[216:219]
    buffer_load_dwordx4 v18, s[52:55], s83 offen offset:1024 lds
    v_mfma_f32_16x16x32_bf16 v[248:251], a[184:187], a[28:31], v[248:251]
    s_waitcnt lgkmcnt(15)
    v_mfma_f32_16x16x32_bf16 v[156:159], a[188:191], a[16:19], v[156:159]
    v_mfma_f32_16x16x32_bf16 v[188:191], a[188:191], a[20:23], v[188:191]
    v_mfma_f32_16x16x32_bf16 v[220:223], a[188:191], a[24:27], v[220:223]
    v_mfma_f32_16x16x32_bf16 v[252:255], a[188:191], a[28:31], v[252:255]
    s_waitcnt lgkmcnt(14)
    v_mfma_f32_16x16x32_bf16 v[128:131], a[128:131], a[32:35], v[128:131]
    buffer_load_dwordx4 a[16:19], v16, s[56:59], s69 offen offset:0 sc1
    v_mfma_f32_16x16x32_bf16 v[160:163], a[128:131], a[36:39], v[160:163]
    ds_read_b64_tr_b16 a[160:161], v8 offset:57344
    v_mfma_f32_16x16x32_bf16 v[192:195], a[128:131], a[40:43], v[192:195]
    ds_read_b64_tr_b16 a[162:163], v8 offset:61440
    buffer_load_dwordx4 a[20:23], v16, s[56:59], s69 offen offset:1024 sc1
    v_mfma_f32_16x16x32_bf16 v[224:227], a[128:131], a[44:47], v[224:227]
    s_waitcnt lgkmcnt(14)
    v_mfma_f32_16x16x32_bf16 v[132:135], a[132:135], a[32:35], v[132:135]
    ds_read_b64_tr_b16 a[164:165], v9 offset:57344
    buffer_load_dwordx4 a[24:27], v16, s[56:59], s69 offen offset:2048 sc1
    v_mfma_f32_16x16x32_bf16 v[164:167], a[132:135], a[36:39], v[164:167]
    ds_read_b64_tr_b16 a[166:167], v9 offset:61440
    v_mfma_f32_16x16x32_bf16 v[196:199], a[132:135], a[40:43], v[196:199]
    buffer_load_dwordx4 a[28:31], v16, s[56:59], s69 offen offset:3072 sc1
    v_mfma_f32_16x16x32_bf16 v[228:231], a[132:135], a[44:47], v[228:231]
    ds_read_b64_tr_b16 a[168:169], v10 offset:57344
    s_waitcnt lgkmcnt(15)
    v_mfma_f32_16x16x32_bf16 v[136:139], a[136:139], a[32:35], v[136:139]
    ds_read_b64_tr_b16 a[170:171], v10 offset:61440
    s_add_u32 s69, s69, 4096
    v_mfma_f32_16x16x32_bf16 v[168:171], a[136:139], a[36:39], v[168:171]
    v_mfma_f32_16x16x32_bf16 v[200:203], a[136:139], a[40:43], v[200:203]
    ds_read_b64_tr_b16 a[172:173], v11 offset:57344
    v_mfma_f32_16x16x32_bf16 v[232:235], a[136:139], a[44:47], v[232:235]
    ds_read_b64_tr_b16 a[174:175], v11 offset:61440
    s_mov_b32 s82, 786432
    s_add_u32 m0, s3, 0
    s_waitcnt lgkmcnt(15)
    v_mfma_f32_16x16x32_bf16 v[140:143], a[140:143], a[32:35], v[140:143]
    buffer_load_dwordx4 v17, s[52:55], s82 offen lds
    v_mfma_f32_16x16x32_bf16 v[172:175], a[140:143], a[36:39], v[172:175]
    ds_read_b64_tr_b16 a[176:177], v12 offset:57344
    v_mfma_f32_16x16x32_bf16 v[204:207], a[140:143], a[40:43], v[204:207]
    ds_read_b64_tr_b16 a[178:179], v12 offset:61440
    v_mfma_f32_16x16x32_bf16 v[236:239], a[140:143], a[44:47], v[236:239]
    s_waitcnt lgkmcnt(15)
    v_mfma_f32_16x16x32_bf16 v[144:147], a[144:147], a[32:35], v[144:147]
    ds_read_b64_tr_b16 a[180:181], v13 offset:57344
    buffer_load_dwordx4 v18, s[52:55], s82 offen offset:1024 lds
    v_mfma_f32_16x16x32_bf16 v[176:179], a[144:147], a[36:39], v[176:179]
    ds_read_b64_tr_b16 a[182:183], v13 offset:61440
    v_mfma_f32_16x16x32_bf16 v[208:211], a[144:147], a[40:43], v[208:211]
    v_mfma_f32_16x16x32_bf16 v[240:243], a[144:147], a[44:47], v[240:243]
    ds_read_b64_tr_b16 a[184:185], v14 offset:57344
    s_waitcnt lgkmcnt(15)
    v_mfma_f32_16x16x32_bf16 v[148:151], a[148:151], a[32:35], v[148:151]
    ds_read_b64_tr_b16 a[186:187], v14 offset:61440
    v_mfma_f32_16x16x32_bf16 v[180:183], a[148:151], a[36:39], v[180:183]
    s_mov_b32 s83, 851968
    s_add_u32 m0, s3, 8192
    v_mfma_f32_16x16x32_bf16 v[212:215], a[148:151], a[40:43], v[212:215]
    ds_read_b64_tr_b16 a[188:189], v15 offset:57344
    buffer_load_dwordx4 v17, s[52:55], s83 offen lds
    v_mfma_f32_16x16x32_bf16 v[244:247], a[148:151], a[44:47], v[244:247]
    ds_read_b64_tr_b16 a[190:191], v15 offset:61440
    v_mfma_f32_16x16x32_bf16 v[152:155], a[152:155], a[32:35], v[152:155]
    v_mfma_f32_16x16x32_bf16 v[184:187], a[152:155], a[36:39], v[184:187]
    v_mfma_f32_16x16x32_bf16 v[216:219], a[152:155], a[40:43], v[216:219]
    buffer_load_dwordx4 v18, s[52:55], s83 offen offset:1024 lds
    v_mfma_f32_16x16x32_bf16 v[248:251], a[152:155], a[44:47], v[248:251]
    s_waitcnt lgkmcnt(15)
    v_mfma_f32_16x16x32_bf16 v[156:159], a[156:159], a[32:35], v[156:159]
    v_mfma_f32_16x16x32_bf16 v[188:191], a[156:159], a[36:39], v[188:191]
    v_mfma_f32_16x16x32_bf16 v[220:223], a[156:159], a[40:43], v[220:223]
    v_mfma_f32_16x16x32_bf16 v[252:255], a[156:159], a[44:47], v[252:255]
    s_waitcnt vmcnt(38) lgkmcnt(14)
    v_mfma_f32_16x16x32_bf16 v[160:163], a[160:163], a[52:55], v[160:163]
    buffer_load_dwordx4 a[32:35], v16, s[56:59], s69 offen offset:0 sc1
    s_waitcnt lgkmcnt(12)
    v_mfma_f32_16x16x32_bf16 v[164:167], a[164:167], a[52:55], v[164:167]
    ds_read_b64_tr_b16 a[128:129], v48 offset:0
    s_waitcnt lgkmcnt(11)
    v_mfma_f32_16x16x32_bf16 v[168:171], a[168:171], a[52:55], v[168:171]
    ds_read_b64_tr_b16 a[130:131], v48 offset:4096
    buffer_load_dwordx4 a[36:39], v16, s[56:59], s69 offen offset:1024 sc1
    s_waitcnt lgkmcnt(10)
    v_mfma_f32_16x16x32_bf16 v[172:175], a[172:175], a[52:55], v[172:175]
    ds_read_b64_tr_b16 a[132:133], v49 offset:0
    s_waitcnt lgkmcnt(9)
    v_mfma_f32_16x16x32_bf16 v[176:179], a[176:179], a[52:55], v[176:179]
    ds_read_b64_tr_b16 a[134:135], v49 offset:4096
    buffer_load_dwordx4 a[40:43], v16, s[56:59], s69 offen offset:2048 sc1
    s_waitcnt lgkmcnt(8)
    v_mfma_f32_16x16x32_bf16 v[180:183], a[180:183], a[52:55], v[180:183]
    ds_read_b64_tr_b16 a[136:137], v50 offset:0
    s_waitcnt lgkmcnt(7)
    v_mfma_f32_16x16x32_bf16 v[184:187], a[184:187], a[52:55], v[184:187]
    ds_read_b64_tr_b16 a[138:139], v50 offset:4096
    buffer_load_dwordx4 a[44:47], v16, s[56:59], s69 offen offset:3072 sc1
    s_waitcnt lgkmcnt(6)
    v_mfma_f32_16x16x32_bf16 v[188:191], a[188:191], a[52:55], v[188:191]
    ds_read_b64_tr_b16 a[140:141], v51 offset:0
    s_waitcnt vmcnt(41)
    v_mfma_f32_16x16x32_bf16 v[192:195], a[160:163], a[56:59], v[192:195]
    ds_read_b64_tr_b16 a[142:143], v51 offset:4096
    s_add_u32 s69, s69, 4096
    v_mfma_f32_16x16x32_bf16 v[196:199], a[164:167], a[56:59], v[196:199]
    ds_read_b64_tr_b16 a[144:145], v52 offset:0
    v_mfma_f32_16x16x32_bf16 v[200:203], a[168:171], a[56:59], v[200:203]
    ds_read_b64_tr_b16 a[146:147], v52 offset:4096
    v_mfma_f32_16x16x32_bf16 v[204:207], a[172:175], a[56:59], v[204:207]
    ds_read_b64_tr_b16 a[148:149], v53 offset:0
    s_mov_b32 s82, 917504
    s_add_u32 m0, s3, 16384
    v_mfma_f32_16x16x32_bf16 v[208:211], a[176:179], a[56:59], v[208:211]
    ds_read_b64_tr_b16 a[150:151], v53 offset:4096
    buffer_load_dwordx4 v17, s[52:55], s82 offen lds
    v_cvt_pk_bf16_f32 v160, v160, v161
    v_cvt_pk_bf16_f32 v161, v162, v163
    v_mfma_f32_16x16x32_bf16 v[212:215], a[180:183], a[56:59], v[212:215]
    ds_read_b64_tr_b16 a[152:153], v54 offset:0
    v_cvt_pk_bf16_f32 v162, v164, v165
    v_cvt_pk_bf16_f32 v163, v166, v167
    v_mfma_f32_16x16x32_bf16 v[216:219], a[184:187], a[56:59], v[216:219]
    ds_read_b64_tr_b16 a[154:155], v54 offset:4096
    buffer_store_dwordx4 v[160:163], v16, s[56:59], s70 offen offset:0 sc1
    v_cvt_pk_bf16_f32 v168, v168, v169
    v_mfma_f32_16x16x32_bf16 v[220:223], a[188:191], a[56:59], v[220:223]
    v_cvt_pk_bf16_f32 v169, v170, v171
    v_cvt_pk_bf16_f32 v170, v172, v173
    s_waitcnt vmcnt(42)
    v_mfma_f32_16x16x32_bf16 v[224:227], a[160:163], a[60:63], v[224:227]
    buffer_load_dwordx4 v18, s[52:55], s82 offen offset:1024 lds
    v_cvt_pk_bf16_f32 v171, v174, v175
    buffer_store_dwordx4 v[168:171], v16, s[56:59], s70 offen offset:1024 sc1
    v_mfma_f32_16x16x32_bf16 v[228:231], a[164:167], a[60:63], v[228:231]
    v_cvt_pk_bf16_f32 v176, v176, v177
    v_cvt_pk_bf16_f32 v177, v178, v179
    v_mfma_f32_16x16x32_bf16 v[232:235], a[168:171], a[60:63], v[232:235]
    v_cvt_pk_bf16_f32 v178, v180, v181
    v_cvt_pk_bf16_f32 v179, v182, v183
    v_mfma_f32_16x16x32_bf16 v[236:239], a[172:175], a[60:63], v[236:239]
    buffer_store_dwordx4 v[176:179], v16, s[56:59], s70 offen offset:2048 sc1
    v_cvt_pk_bf16_f32 v184, v184, v185
    v_mfma_f32_16x16x32_bf16 v[240:243], a[176:179], a[60:63], v[240:243]
    v_cvt_pk_bf16_f32 v185, v186, v187
    v_cvt_pk_bf16_f32 v186, v188, v189
    v_mfma_f32_16x16x32_bf16 v[244:247], a[180:183], a[60:63], v[244:247]
    s_mov_b32 s83, 983040
    s_add_u32 m0, s3, 24576
    v_cvt_pk_bf16_f32 v187, v190, v191
    buffer_store_dwordx4 v[184:187], v16, s[56:59], s70 offen offset:3072 sc1
    v_mfma_f32_16x16x32_bf16 v[248:251], a[184:187], a[60:63], v[248:251]
    buffer_load_dwordx4 v17, s[52:55], s83 offen lds
    v_cvt_pk_bf16_f32 v192, v192, v193
    v_cvt_pk_bf16_f32 v193, v194, v195
    v_mfma_f32_16x16x32_bf16 v[252:255], a[188:191], a[60:63], v[252:255]
    v_cvt_pk_bf16_f32 v194, v196, v197
    v_cvt_pk_bf16_f32 v195, v198, v199
    v_mfma_f32_16x16x32_bf16 v[128:131], a[160:163], a[48:51], v[128:131]
    buffer_store_dwordx4 v[192:195], v16, s[56:59], s71 offen offset:0 sc1
    v_cvt_pk_bf16_f32 v200, v200, v201
    v_mfma_f32_16x16x32_bf16 v[132:135], a[164:167], a[48:51], v[132:135]
    v_cvt_pk_bf16_f32 v201, v202, v203
    v_cvt_pk_bf16_f32 v202, v204, v205
    v_mfma_f32_16x16x32_bf16 v[136:139], a[168:171], a[48:51], v[136:139]
    buffer_load_dwordx4 v18, s[52:55], s83 offen offset:1024 lds
    v_cvt_pk_bf16_f32 v203, v206, v207
    buffer_store_dwordx4 v[200:203], v16, s[56:59], s71 offen offset:1024 sc1
    v_mfma_f32_16x16x32_bf16 v[140:143], a[172:175], a[48:51], v[140:143]
    v_cvt_pk_bf16_f32 v208, v208, v209
    v_cvt_pk_bf16_f32 v209, v210, v211
    v_mfma_f32_16x16x32_bf16 v[144:147], a[176:179], a[48:51], v[144:147]
    v_cvt_pk_bf16_f32 v210, v212, v213
    v_cvt_pk_bf16_f32 v211, v214, v215
    v_mfma_f32_16x16x32_bf16 v[148:151], a[180:183], a[48:51], v[148:151]
    buffer_store_dwordx4 v[208:211], v16, s[56:59], s71 offen offset:2048 sc1
    v_cvt_pk_bf16_f32 v216, v216, v217
    v_mfma_f32_16x16x32_bf16 v[152:155], a[184:187], a[48:51], v[152:155]
    v_cvt_pk_bf16_f32 v217, v218, v219
    v_cvt_pk_bf16_f32 v218, v220, v221
    v_mfma_f32_16x16x32_bf16 v[156:159], a[188:191], a[48:51], v[156:159]
    v_cvt_pk_bf16_f32 v219, v222, v223
    buffer_store_dwordx4 v[216:219], v16, s[56:59], s71 offen offset:3072 sc1
    s_barrier
    buffer_load_dwordx4 a[48:51], v16, s[56:59], s69 offen offset:0 sc1
    buffer_load_dwordx4 a[52:55], v16, s[56:59], s69 offen offset:1024 sc1
    buffer_load_dwordx4 a[56:59], v16, s[56:59], s69 offen offset:2048 sc1
    buffer_load_dwordx4 a[60:63], v16, s[56:59], s69 offen offset:3072 sc1
    s_add_u32 s69, s69, 4096
    s_waitcnt vmcnt(55) lgkmcnt(12)
    v_mfma_f32_16x16x32_bf16 v[96:99], a[128:131], a[64:67], 0
    ds_read_b64_tr_b16 a[156:157], v55 offset:0
    ds_read_b64_tr_b16 a[158:159], v55 offset:4096
    v_cvt_pk_bf16_f32 v224, v224, v225
    v_cvt_pk_bf16_f32 v225, v226, v227
    s_waitcnt lgkmcnt(12)
    v_mfma_f32_16x16x32_bf16 v[100:103], a[132:135], a[64:67], 0
    ds_read_b64_tr_b16 a[160:161], v48 offset:8192
    ds_read_b64_tr_b16 a[162:163], v48 offset:12288
    v_cvt_pk_bf16_f32 v226, v228, v229
    v_cvt_pk_bf16_f32 v227, v230, v231
    s_waitcnt lgkmcnt(12)
    v_mfma_f32_16x16x32_bf16 v[104:107], a[136:139], a[64:67], 0
    ds_read_b64_tr_b16 a[164:165], v49 offset:8192
    ds_read_b64_tr_b16 a[166:167], v49 offset:12288
    buffer_store_dwordx4 v[224:227], v16, s[56:59], s72 offen offset:0 sc1
    v_cvt_pk_bf16_f32 v232, v232, v233
    s_waitcnt lgkmcnt(12)
    v_mfma_f32_16x16x32_bf16 v[108:111], a[140:143], a[64:67], 0
    ds_read_b64_tr_b16 a[168:169], v50 offset:8192
    ds_read_b64_tr_b16 a[170:171], v50 offset:12288
    v_cvt_pk_bf16_f32 v233, v234, v235
    v_cvt_pk_bf16_f32 v234, v236, v237
    s_waitcnt lgkmcnt(12)
    v_mfma_f32_16x16x32_bf16 v[112:115], a[144:147], a[64:67], 0
    ds_read_b64_tr_b16 a[172:173], v51 offset:8192
    ds_read_b64_tr_b16 a[174:175], v51 offset:12288
    v_cvt_pk_bf16_f32 v235, v238, v239
    buffer_store_dwordx4 v[232:235], v16, s[56:59], s72 offen offset:1024 sc1
    s_waitcnt lgkmcnt(12)
    v_mfma_f32_16x16x32_bf16 v[116:119], a[148:151], a[64:67], 0
    ds_read_b64_tr_b16 a[176:177], v52 offset:8192
    ds_read_b64_tr_b16 a[178:179], v52 offset:12288
    v_cvt_pk_bf16_f32 v240, v240, v241
    v_cvt_pk_bf16_f32 v241, v242, v243
    s_waitcnt lgkmcnt(12)
    v_mfma_f32_16x16x32_bf16 v[120:123], a[152:155], a[64:67], 0
    ds_read_b64_tr_b16 a[180:181], v53 offset:8192
    ds_read_b64_tr_b16 a[182:183], v53 offset:12288
    v_cvt_pk_bf16_f32 v242, v244, v245
    v_cvt_pk_bf16_f32 v243, v246, v247
    s_waitcnt lgkmcnt(12)
    v_mfma_f32_16x16x32_bf16 v[124:127], a[156:159], a[64:67], 0
    ds_read_b64_tr_b16 a[184:185], v54 offset:8192
    ds_read_b64_tr_b16 a[186:187], v54 offset:12288
    buffer_store_dwordx4 v[240:243], v16, s[56:59], s72 offen offset:2048 sc1
    v_cvt_pk_bf16_f32 v248, v248, v249
    s_waitcnt vmcnt(57) lgkmcnt(12)
    v_mfma_f32_16x16x32_bf16 v[96:99], a[160:163], a[68:71], v[96:99]
    ds_read_b64_tr_b16 a[188:189], v55 offset:8192
    ds_read_b64_tr_b16 a[190:191], v55 offset:12288
    v_cvt_pk_bf16_f32 v249, v250, v251
    v_cvt_pk_bf16_f32 v250, v252, v253
    s_waitcnt lgkmcnt(12)
    v_mfma_f32_16x16x32_bf16 v[100:103], a[164:167], a[68:71], v[100:103]
    ds_read_b64_tr_b16 a[128:129], v48 offset:16384
    ds_read_b64_tr_b16 a[130:131], v48 offset:20480
    v_cvt_pk_bf16_f32 v251, v254, v255
    buffer_store_dwordx4 v[248:251], v16, s[56:59], s72 offen offset:3072 sc1
    s_waitcnt lgkmcnt(12)
    v_mfma_f32_16x16x32_bf16 v[104:107], a[168:171], a[68:71], v[104:107]
    ds_read_b64_tr_b16 a[132:133], v49 offset:16384
    ds_read_b64_tr_b16 a[134:135], v49 offset:20480
    s_mov_b32 s82, 1048576
    s_add_u32 m0, s3, 32768
    s_nop 0
    buffer_load_dwordx4 v17, s[52:55], s82 offen lds
    s_waitcnt lgkmcnt(12)
    v_mfma_f32_16x16x32_bf16 v[108:111], a[172:175], a[68:71], v[108:111]
    ds_read_b64_tr_b16 a[136:137], v50 offset:16384
    ds_read_b64_tr_b16 a[138:139], v50 offset:20480
    s_waitcnt lgkmcnt(12)
    v_mfma_f32_16x16x32_bf16 v[112:115], a[176:179], a[68:71], v[112:115]
    ds_read_b64_tr_b16 a[140:141], v51 offset:16384
    ds_read_b64_tr_b16 a[142:143], v51 offset:20480
    s_waitcnt lgkmcnt(12)
    v_mfma_f32_16x16x32_bf16 v[116:119], a[180:183], a[68:71], v[116:119]
    ds_read_b64_tr_b16 a[144:145], v52 offset:16384
    ds_read_b64_tr_b16 a[146:147], v52 offset:20480
    buffer_load_dwordx4 v18, s[52:55], s82 offen offset:1024 lds
    s_waitcnt lgkmcnt(12)
    v_mfma_f32_16x16x32_bf16 v[120:123], a[184:187], a[68:71], v[120:123]
    ds_read_b64_tr_b16 a[148:149], v53 offset:16384
    ds_read_b64_tr_b16 a[150:151], v53 offset:20480
    s_waitcnt lgkmcnt(12)
    v_mfma_f32_16x16x32_bf16 v[124:127], a[188:191], a[68:71], v[124:127]
    ds_read_b64_tr_b16 a[152:153], v54 offset:16384
    ds_read_b64_tr_b16 a[154:155], v54 offset:20480
    s_waitcnt vmcnt(59) lgkmcnt(12)
    v_mfma_f32_16x16x32_bf16 v[96:99], a[128:131], a[72:75], v[96:99]
    ds_read_b64_tr_b16 a[156:157], v55 offset:16384
    ds_read_b64_tr_b16 a[158:159], v55 offset:20480
    s_mov_b32 s83, 1114112
    s_add_u32 m0, s3, 40960
    s_nop 0
    buffer_load_dwordx4 v17, s[52:55], s83 offen lds
    s_waitcnt lgkmcnt(12)
    v_mfma_f32_16x16x32_bf16 v[100:103], a[132:135], a[72:75], v[100:103]
    ds_read_b64_tr_b16 a[160:161], v48 offset:24576
    ds_read_b64_tr_b16 a[162:163], v48 offset:28672
    s_waitcnt lgkmcnt(12)
    v_mfma_f32_16x16x32_bf16 v[104:107], a[136:139], a[72:75], v[104:107]
    ds_read_b64_tr_b16 a[164:165], v49 offset:24576
    ds_read_b64_tr_b16 a[166:167], v49 offset:28672
    s_waitcnt lgkmcnt(12)
    v_mfma_f32_16x16x32_bf16 v[108:111], a[140:143], a[72:75], v[108:111]
    ds_read_b64_tr_b16 a[168:169], v50 offset:24576
    ds_read_b64_tr_b16 a[170:171], v50 offset:28672
    buffer_load_dwordx4 v18, s[52:55], s83 offen offset:1024 lds
    s_waitcnt lgkmcnt(12)
    v_mfma_f32_16x16x32_bf16 v[112:115], a[144:147], a[72:75], v[112:115]
    ds_read_b64_tr_b16 a[172:173], v51 offset:24576
    ds_read_b64_tr_b16 a[174:175], v51 offset:28672
    s_waitcnt lgkmcnt(12)
    v_mfma_f32_16x16x32_bf16 v[116:119], a[148:151], a[72:75], v[116:119]
    ds_read_b64_tr_b16 a[176:177], v52 offset:24576
    ds_read_b64_tr_b16 a[178:179], v52 offset:28672
    s_waitcnt lgkmcnt(12)
    v_mfma_f32_16x16x32_bf16 v[120:123], a[152:155], a[72:75], v[120:123]
    ds_read_b64_tr_b16 a[180:181], v53 offset:24576
    ds_read_b64_tr_b16 a[182:183], v53 offset:28672
    s_mov_b32 s82, 1179648
    s_add_u32 m0, s3, 49152
    s_nop 0
    buffer_load_dwordx4 v17, s[52:55], s82 offen lds
    s_waitcnt lgkmcnt(12)
    v_mfma_f32_16x16x32_bf16 v[124:127], a[156:159], a[72:75], v[124:127]
    ds_read_b64_tr_b16 a[184:185], v54 offset:24576
    ds_read_b64_tr_b16 a[186:187], v54 offset:28672
    s_waitcnt vmcnt(61) lgkmcnt(12)
    v_mfma_f32_16x16x32_bf16 v[96:99], a[160:163], a[76:79], v[96:99]
    ds_read_b64_tr_b16 a[188:189], v55 offset:24576
    ds_read_b64_tr_b16 a[190:191], v55 offset:28672
    s_waitcnt lgkmcnt(12)
    v_mfma_f32_16x16x32_bf16 v[100:103], a[164:167], a[76:79], v[100:103]
    ds_read_b64_tr_b16 a[128:129], v48 offset:32768
    ds_read_b64_tr_b16 a[130:131], v48 offset:36864
    buffer_load_dwordx4 v18, s[52:55], s82 offen offset:1024 lds
    s_waitcnt lgkmcnt(12)
    v_mfma_f32_16x16x32_bf16 v[104:107], a[168:171], a[76:79], v[104:107]
    ds_read_b64_tr_b16 a[132:133], v49 offset:32768
    ds_read_b64_tr_b16 a[134:135], v49 offset:36864
    s_waitcnt lgkmcnt(12)
    v_mfma_f32_16x16x32_bf16 v[108:111], a[172:175], a[76:79], v[108:111]
    ds_read_b64_tr_b16 a[136:137], v50 offset:32768
    ds_read_b64_tr_b16 a[138:139], v50 offset:36864
    s_waitcnt lgkmcnt(12)
    v_mfma_f32_16x16x32_bf16 v[112:115], a[176:179], a[76:79], v[112:115]
    ds_read_b64_tr_b16 a[140:141], v51 offset:32768
    ds_read_b64_tr_b16 a[142:143], v51 offset:36864
    s_mov_b32 s83, 1245184
    s_add_u32 m0, s3, 57344
    s_nop 0
    buffer_load_dwordx4 v17, s[52:55], s83 offen lds
    s_waitcnt lgkmcnt(12)
    v_mfma_f32_16x16x32_bf16 v[116:119], a[180:183], a[76:79], v[116:119]
    ds_read_b64_tr_b16 a[144:145], v52 offset:32768
    ds_read_b64_tr_b16 a[146:147], v52 offset:36864
    s_waitcnt lgkmcnt(12)
    v_mfma_f32_16x16x32_bf16 v[120:123], a[184:187], a[76:79], v[120:123]
    ds_read_b64_tr_b16 a[148:149], v53 offset:32768
    ds_read_b64_tr_b16 a[150:151], v53 offset:36864
    s_waitcnt lgkmcnt(12)
    v_mfma_f32_16x16x32_bf16 v[124:127], a[188:191], a[76:79], v[124:127]
    ds_read_b64_tr_b16 a[152:153], v54 offset:32768
    ds_read_b64_tr_b16 a[154:155], v54 offset:36864
    buffer_load_dwordx4 v18, s[52:55], s83 offen offset:1024 lds
    s_waitcnt vmcnt(63) lgkmcnt(12)
    v_mfma_f32_16x16x32_bf16 v[96:99], a[128:131], a[80:83], v[96:99]
    ds_read_b64_tr_b16 a[156:157], v55 offset:32768
    ds_read_b64_tr_b16 a[158:159], v55 offset:36864
    s_waitcnt lgkmcnt(12)
    v_mfma_f32_16x16x32_bf16 v[100:103], a[132:135], a[80:83], v[100:103]
    ds_read_b64_tr_b16 a[160:161], v48 offset:40960
    ds_read_b64_tr_b16 a[162:163], v48 offset:45056
    s_waitcnt lgkmcnt(12)
    v_mfma_f32_16x16x32_bf16 v[104:107], a[136:139], a[80:83], v[104:107]
    ds_read_b64_tr_b16 a[164:165], v49 offset:40960
    ds_read_b64_tr_b16 a[166:167], v49 offset:45056
    s_waitcnt lgkmcnt(12)
    v_mfma_f32_16x16x32_bf16 v[108:111], a[140:143], a[80:83], v[108:111]
    ds_read_b64_tr_b16 a[168:169], v50 offset:40960
    ds_read_b64_tr_b16 a[170:171], v50 offset:45056
    s_waitcnt lgkmcnt(12)
    v_mfma_f32_16x16x32_bf16 v[112:115], a[144:147], a[80:83], v[112:115]
    ds_read_b64_tr_b16 a[172:173], v51 offset:40960
    ds_read_b64_tr_b16 a[174:175], v51 offset:45056
    s_waitcnt lgkmcnt(12)
    v_mfma_f32_16x16x32_bf16 v[116:119], a[148:151], a[80:83], v[116:119]
    ds_read_b64_tr_b16 a[176:177], v52 offset:40960
    ds_read_b64_tr_b16 a[178:179], v52 offset:45056
    s_waitcnt lgkmcnt(12)
    v_mfma_f32_16x16x32_bf16 v[120:123], a[152:155], a[80:83], v[120:123]
    ds_read_b64_tr_b16 a[180:181], v53 offset:40960
    ds_read_b64_tr_b16 a[182:183], v53 offset:45056
    s_waitcnt lgkmcnt(12)
    v_mfma_f32_16x16x32_bf16 v[124:127], a[156:159], a[80:83], v[124:127]
    ds_read_b64_tr_b16 a[184:185], v54 offset:40960
    ds_read_b64_tr_b16 a[186:187], v54 offset:45056
    s_waitcnt vmcnt(62) lgkmcnt(12)
    v_mfma_f32_16x16x32_bf16 v[96:99], a[160:163], a[84:87], v[96:99]
    ds_read_b64_tr_b16 a[188:189], v55 offset:40960
    ds_read_b64_tr_b16 a[190:191], v55 offset:45056
    s_waitcnt lgkmcnt(12)
    v_mfma_f32_16x16x32_bf16 v[100:103], a[164:167], a[84:87], v[100:103]
    ds_read_b64_tr_b16 a[128:129], v48 offset:49152
    ds_read_b64_tr_b16 a[130:131], v48 offset:53248
    s_waitcnt lgkmcnt(12)
    v_mfma_f32_16x16x32_bf16 v[104:107], a[168:171], a[84:87], v[104:107]
    ds_read_b64_tr_b16 a[132:133], v49 offset:49152
    ds_read_b64_tr_b16 a[134:135], v49 offset:53248
    s_waitcnt lgkmcnt(12)
    v_mfma_f32_16x16x32_bf16 v[108:111], a[172:175], a[84:87], v[108:111]
    ds_read_b64_tr_b16 a[136:137], v50 offset:49152
    ds_read_b64_tr_b16 a[138:139], v50 offset:53248
    s_waitcnt lgkmcnt(12)
    v_mfma_f32_16x16x32_bf16 v[112:115], a[176:179], a[84:87], v[112:115]
    ds_read_b64_tr_b16 a[140:141], v51 offset:49152
    ds_read_b64_tr_b16 a[142:143], v51 offset:53248
    s_waitcnt lgkmcnt(12)
    v_mfma_f32_16x16x32_bf16 v[116:119], a[180:183], a[84:87], v[116:119]
    ds_read_b64_tr_b16 a[144:145], v52 offset:49152
    ds_read_b64_tr_b16 a[146:147], v52 offset:53248
    s_waitcnt lgkmcnt(12)
    v_mfma_f32_16x16x32_bf16 v[120:123], a[184:187], a[84:87], v[120:123]
    ds_read_b64_tr_b16 a[148:149], v53 offset:49152
    ds_read_b64_tr_b16 a[150:151], v53 offset:53248
    s_waitcnt lgkmcnt(12)
    v_mfma_f32_16x16x32_bf16 v[124:127], a[188:191], a[84:87], v[124:127]
    ds_read_b64_tr_b16 a[152:153], v54 offset:49152
    ds_read_b64_tr_b16 a[154:155], v54 offset:53248
    s_waitcnt vmcnt(19)
    s_barrier
    s_waitcnt lgkmcnt(12)
    v_mfma_f32_16x16x32_bf16 v[96:99], a[128:131], a[88:91], v[96:99]
    ds_read_b64_tr_b16 a[156:157], v55 offset:49152
    ds_read_b64_tr_b16 a[158:159], v55 offset:53248
    s_mov_b32 s82, 1310720
    s_add_u32 m0, s3, 65536
    s_nop 0
    buffer_load_dwordx4 v17, s[52:55], s82 offen lds
    s_waitcnt lgkmcnt(12)
    v_mfma_f32_16x16x32_bf16 v[100:103], a[132:135], a[88:91], v[100:103]
    ds_read_b64_tr_b16 a[160:161], v48 offset:57344
    ds_read_b64_tr_b16 a[162:163], v48 offset:61440
    s_waitcnt lgkmcnt(12)
    v_mfma_f32_16x16x32_bf16 v[104:107], a[136:139], a[88:91], v[104:107]
    ds_read_b64_tr_b16 a[164:165], v49 offset:57344
    ds_read_b64_tr_b16 a[166:167], v49 offset:61440
    s_waitcnt lgkmcnt(12)
    v_mfma_f32_16x16x32_bf16 v[108:111], a[140:143], a[88:91], v[108:111]
    ds_read_b64_tr_b16 a[168:169], v50 offset:57344
    ds_read_b64_tr_b16 a[170:171], v50 offset:61440
    buffer_load_dwordx4 v18, s[52:55], s82 offen offset:1024 lds
    s_waitcnt lgkmcnt(12)
    v_mfma_f32_16x16x32_bf16 v[112:115], a[144:147], a[88:91], v[112:115]
    ds_read_b64_tr_b16 a[172:173], v51 offset:57344
    ds_read_b64_tr_b16 a[174:175], v51 offset:61440
    s_waitcnt lgkmcnt(12)
    v_mfma_f32_16x16x32_bf16 v[116:119], a[148:151], a[88:91], v[116:119]
    ds_read_b64_tr_b16 a[176:177], v52 offset:57344
    ds_read_b64_tr_b16 a[178:179], v52 offset:61440
    s_waitcnt lgkmcnt(12)
    v_mfma_f32_16x16x32_bf16 v[120:123], a[152:155], a[88:91], v[120:123]
    ds_read_b64_tr_b16 a[180:181], v53 offset:57344
    ds_read_b64_tr_b16 a[182:183], v53 offset:61440
    s_mov_b32 s83, 1376256
    s_add_u32 m0, s3, 73728
    s_nop 0
    buffer_load_dwordx4 v17, s[52:55], s83 offen lds
    s_waitcnt lgkmcnt(12)
    v_mfma_f32_16x16x32_bf16 v[124:127], a[156:159], a[88:91], v[124:127]
    ds_read_b64_tr_b16 a[184:185], v54 offset:57344
    ds_read_b64_tr_b16 a[186:187], v54 offset:61440
    s_waitcnt lgkmcnt(12)
    v_mfma_f32_16x16x32_bf16 v[96:99], a[160:163], a[92:95], v[96:99]
    ds_read_b64_tr_b16 a[188:189], v55 offset:57344
    ds_read_b64_tr_b16 a[190:191], v55 offset:61440
    s_waitcnt vmcnt(11)
    s_mov_b64 exec, 1
    buffer_atomic_add v25, off, s[56:59], s77 sc1
    s_mov_b64 exec, -1
    s_waitcnt lgkmcnt(12)
    v_mfma_f32_16x16x32_bf16 v[100:103], a[164:167], a[92:95], v[100:103]
    ds_read_b64_tr_b16 a[128:129], v56 offset:0
    ds_read_b64_tr_b16 a[130:131], v56 offset:4096
    buffer_load_dwordx4 v18, s[52:55], s83 offen offset:1024 lds
    s_waitcnt lgkmcnt(12)
    v_mfma_f32_16x16x32_bf16 v[104:107], a[168:171], a[92:95], v[104:107]
    ds_read_b64_tr_b16 a[132:133], v57 offset:0
    ds_read_b64_tr_b16 a[134:135], v57 offset:4096
    s_waitcnt lgkmcnt(12)
    v_mfma_f32_16x16x32_bf16 v[108:111], a[172:175], a[92:95], v[108:111]
    ds_read_b64_tr_b16 a[136:137], v58 offset:0
    ds_read_b64_tr_b16 a[138:139], v58 offset:4096
    s_waitcnt lgkmcnt(12)
    v_mfma_f32_16x16x32_bf16 v[112:115], a[176:179], a[92:95], v[112:115]
    ds_read_b64_tr_b16 a[140:141], v59 offset:0
    ds_read_b64_tr_b16 a[142:143], v59 offset:4096
    s_mov_b32 s82, 1441792
    s_add_u32 m0, s3, 81920
    s_nop 0
    buffer_load_dwordx4 v17, s[52:55], s82 offen lds
    s_waitcnt lgkmcnt(12)
    v_mfma_f32_16x16x32_bf16 v[116:119], a[180:183], a[92:95], v[116:119]
    ds_read_b64_tr_b16 a[144:145], v60 offset:0
    ds_read_b64_tr_b16 a[146:147], v60 offset:4096
    s_waitcnt lgkmcnt(12)
    v_mfma_f32_16x16x32_bf16 v[120:123], a[184:187], a[92:95], v[120:123]
    ds_read_b64_tr_b16 a[148:149], v61 offset:0
    ds_read_b64_tr_b16 a[150:151], v61 offset:4096
    s_waitcnt lgkmcnt(12)
    v_mfma_f32_16x16x32_bf16 v[124:127], a[188:191], a[92:95], v[124:127]
    ds_read_b64_tr_b16 a[152:153], v62 offset:0
    ds_read_b64_tr_b16 a[154:155], v62 offset:4096
    buffer_load_dwordx4 v18, s[52:55], s82 offen offset:1024 lds
    s_waitcnt lgkmcnt(12)
    v_mfma_f32_16x16x32_bf16 v[96:99], a[128:131], a[96:99], v[96:99]
    ds_read_b64_tr_b16 a[156:157], v63 offset:0
    ds_read_b64_tr_b16 a[158:159], v63 offset:4096
    s_waitcnt lgkmcnt(12)
    v_mfma_f32_16x16x32_bf16 v[100:103], a[132:135], a[96:99], v[100:103]
    ds_read_b64_tr_b16 a[160:161], v56 offset:8192
    ds_read_b64_tr_b16 a[162:163], v56 offset:12288
    s_waitcnt lgkmcnt(12)
    v_mfma_f32_16x16x32_bf16 v[104:107], a[136:139], a[96:99], v[104:107]
    ds_read_b64_tr_b16 a[164:165], v57 offset:8192
    ds_read_b64_tr_b16 a[166:167], v57 offset:12288
    s_mov_b32 s83, 1507328
    s_add_u32 m0, s3, 90112
    s_nop 0
    buffer_load_dwordx4 v17, s[52:55], s83 offen lds
    s_waitcnt lgkmcnt(12)
    v_mfma_f32_16x16x32_bf16 v[108:111], a[140:143], a[96:99], v[108:111]
    ds_read_b64_tr_b16 a[168:169], v58 offset:8192
    ds_read_b64_tr_b16 a[170:171], v58 offset:12288
    s_waitcnt lgkmcnt(12)
    v_mfma_f32_16x16x32_bf16 v[112:115], a[144:147], a[96:99], v[112:115]
    ds_read_b64_tr_b16 a[172:173], v59 offset:8192
    ds_read_b64_tr_b16 a[174:175], v59 offset:12288
    s_waitcnt lgkmcnt(12)
    v_mfma_f32_16x16x32_bf16 v[116:119], a[148:151], a[96:99], v[116:119]
    ds_read_b64_tr_b16 a[176:177], v60 offset:8192
    ds_read_b64_tr_b16 a[178:179], v60 offset:12288
    buffer_load_dwordx4 v18, s[52:55], s83 offen offset:1024 lds
    s_waitcnt lgkmcnt(12)
    v_mfma_f32_16x16x32_bf16 v[120:123], a[152:155], a[96:99], v[120:123]
    ds_read_b64_tr_b16 a[180:181], v61 offset:8192
    ds_read_b64_tr_b16 a[182:183], v61 offset:12288
    s_waitcnt lgkmcnt(12)
    v_mfma_f32_16x16x32_bf16 v[124:127], a[156:159], a[96:99], v[124:127]
    ds_read_b64_tr_b16 a[184:185], v62 offset:8192
    ds_read_b64_tr_b16 a[186:187], v62 offset:12288
    s_waitcnt lgkmcnt(12)
    v_mfma_f32_16x16x32_bf16 v[96:99], a[160:163], a[100:103], v[96:99]
    ds_read_b64_tr_b16 a[188:189], v63 offset:8192
    ds_read_b64_tr_b16 a[190:191], v63 offset:12288
    s_mov_b32 s82, 1572864
    s_add_u32 m0, s3, 98304
    s_nop 0
    buffer_load_dwordx4 v17, s[52:55], s82 offen lds
    s_waitcnt lgkmcnt(12)
    v_mfma_f32_16x16x32_bf16 v[100:103], a[164:167], a[100:103], v[100:103]
    ds_read_b64_tr_b16 a[128:129], v56 offset:16384
    ds_read_b64_tr_b16 a[130:131], v56 offset:20480
    s_waitcnt lgkmcnt(12)
    v_mfma_f32_16x16x32_bf16 v[104:107], a[168:171], a[100:103], v[104:107]
    ds_read_b64_tr_b16 a[132:133], v57 offset:16384
    ds_read_b64_tr_b16 a[134:135], v57 offset:20480
    s_waitcnt lgkmcnt(12)
    v_mfma_f32_16x16x32_bf16 v[108:111], a[172:175], a[100:103], v[108:111]
    ds_read_b64_tr_b16 a[136:137], v58 offset:16384
    ds_read_b64_tr_b16 a[138:139], v58 offset:20480
    buffer_load_dwordx4 v18, s[52:55], s82 offen offset:1024 lds
    s_waitcnt lgkmcnt(12)
    v_mfma_f32_16x16x32_bf16 v[112:115], a[176:179], a[100:103], v[112:115]
    ds_read_b64_tr_b16 a[140:141], v59 offset:16384
    ds_read_b64_tr_b16 a[142:143], v59 offset:20480
    s_waitcnt lgkmcnt(12)
    v_mfma_f32_16x16x32_bf16 v[116:119], a[180:183], a[100:103], v[116:119]
    ds_read_b64_tr_b16 a[144:145], v60 offset:16384
    ds_read_b64_tr_b16 a[146:147], v60 offset:20480
    s_waitcnt lgkmcnt(12)
    v_mfma_f32_16x16x32_bf16 v[120:123], a[184:187], a[100:103], v[120:123]
    ds_read_b64_tr_b16 a[148:149], v61 offset:16384
    ds_read_b64_tr_b16 a[150:151], v61 offset:20480
    s_mov_b32 s83, 1638400
    s_add_u32 m0, s3, 106496
    s_nop 0
    buffer_load_dwordx4 v17, s[52:55], s83 offen lds
    s_waitcnt lgkmcnt(12)
    v_mfma_f32_16x16x32_bf16 v[124:127], a[188:191], a[100:103], v[124:127]
    ds_read_b64_tr_b16 a[152:153], v62 offset:16384
    ds_read_b64_tr_b16 a[154:155], v62 offset:20480
    s_waitcnt lgkmcnt(12)
    v_mfma_f32_16x16x32_bf16 v[96:99], a[128:131], a[104:107], v[96:99]
    ds_read_b64_tr_b16 a[156:157], v63 offset:16384
    ds_read_b64_tr_b16 a[158:159], v63 offset:20480
    s_waitcnt lgkmcnt(12)
    v_mfma_f32_16x16x32_bf16 v[100:103], a[132:135], a[104:107], v[100:103]
    ds_read_b64_tr_b16 a[160:161], v56 offset:24576
    ds_read_b64_tr_b16 a[162:163], v56 offset:28672
    buffer_load_dwordx4 v18, s[52:55], s83 offen offset:1024 lds
    s_waitcnt lgkmcnt(12)
    v_mfma_f32_16x16x32_bf16 v[104:107], a[136:139], a[104:107], v[104:107]
    ds_read_b64_tr_b16 a[164:165], v57 offset:24576
    ds_read_b64_tr_b16 a[166:167], v57 offset:28672
    s_waitcnt lgkmcnt(12)
    v_mfma_f32_16x16x32_bf16 v[108:111], a[140:143], a[104:107], v[108:111]
    ds_read_b64_tr_b16 a[168:169], v58 offset:24576
    ds_read_b64_tr_b16 a[170:171], v58 offset:28672
    s_waitcnt lgkmcnt(12)
    v_mfma_f32_16x16x32_bf16 v[112:115], a[144:147], a[104:107], v[112:115]
    ds_read_b64_tr_b16 a[172:173], v59 offset:24576
    ds_read_b64_tr_b16 a[174:175], v59 offset:28672
    s_waitcnt lgkmcnt(12)
    v_mfma_f32_16x16x32_bf16 v[116:119], a[148:151], a[104:107], v[116:119]
    ds_read_b64_tr_b16 a[176:177], v60 offset:24576
    ds_read_b64_tr_b16 a[178:179], v60 offset:28672
    s_waitcnt lgkmcnt(12)
    v_mfma_f32_16x16x32_bf16 v[120:123], a[152:155], a[104:107], v[120:123]
    ds_read_b64_tr_b16 a[180:181], v61 offset:24576
    ds_read_b64_tr_b16 a[182:183], v61 offset:28672
    s_waitcnt lgkmcnt(12)
    v_mfma_f32_16x16x32_bf16 v[124:127], a[156:159], a[104:107], v[124:127]
    ds_read_b64_tr_b16 a[184:185], v62 offset:24576
    ds_read_b64_tr_b16 a[186:187], v62 offset:28672
    s_waitcnt lgkmcnt(12)
    v_mfma_f32_16x16x32_bf16 v[96:99], a[160:163], a[108:111], v[96:99]
    ds_read_b64_tr_b16 a[188:189], v63 offset:24576
    ds_read_b64_tr_b16 a[190:191], v63 offset:28672
    s_waitcnt lgkmcnt(12)
    v_mfma_f32_16x16x32_bf16 v[100:103], a[164:167], a[108:111], v[100:103]
    ds_read_b64_tr_b16 a[128:129], v8 offset:0
    ds_read_b64_tr_b16 a[130:131], v8 offset:4096
    s_waitcnt lgkmcnt(12)
    v_mfma_f32_16x16x32_bf16 v[104:107], a[168:171], a[108:111], v[104:107]
    ds_read_b64_tr_b16 a[132:133], v9 offset:0
    ds_read_b64_tr_b16 a[134:135], v9 offset:4096
    s_waitcnt lgkmcnt(12)
    v_mfma_f32_16x16x32_bf16 v[108:111], a[172:175], a[108:111], v[108:111]
    ds_read_b64_tr_b16 a[136:137], v10 offset:0
    ds_read_b64_tr_b16 a[138:139], v10 offset:4096
    s_waitcnt lgkmcnt(12)
    v_mfma_f32_16x16x32_bf16 v[112:115], a[176:179], a[108:111], v[112:115]
    ds_read_b64_tr_b16 a[140:141], v11 offset:0
    ds_read_b64_tr_b16 a[142:143], v11 offset:4096
    s_waitcnt lgkmcnt(12)
    v_mfma_f32_16x16x32_bf16 v[116:119], a[180:183], a[108:111], v[116:119]
    ds_read_b64_tr_b16 a[144:145], v12 offset:0
    ds_read_b64_tr_b16 a[146:147], v12 offset:4096
    s_waitcnt lgkmcnt(12)
    v_mfma_f32_16x16x32_bf16 v[120:123], a[184:187], a[108:111], v[120:123]
    ds_read_b64_tr_b16 a[148:149], v13 offset:0
    ds_read_b64_tr_b16 a[150:151], v13 offset:4096
    s_waitcnt lgkmcnt(12)
    v_mfma_f32_16x16x32_bf16 v[124:127], a[188:191], a[108:111], v[124:127]
    ds_read_b64_tr_b16 a[152:153], v14 offset:0
    ds_read_b64_tr_b16 a[154:155], v14 offset:4096
    s_waitcnt lgkmcnt(12)
    v_mfma_f32_16x16x32_bf16 v[96:99], a[128:131], a[112:115], v[96:99]
    ds_read_b64_tr_b16 a[156:157], v15 offset:0
    ds_read_b64_tr_b16 a[158:159], v15 offset:4096
    s_waitcnt lgkmcnt(12)
    v_mfma_f32_16x16x32_bf16 v[100:103], a[132:135], a[112:115], v[100:103]
    ds_read_b64_tr_b16 a[160:161], v8 offset:8192
    ds_read_b64_tr_b16 a[162:163], v8 offset:12288
    s_waitcnt lgkmcnt(12)
    v_mfma_f32_16x16x32_bf16 v[104:107], a[136:139], a[112:115], v[104:107]
    ds_read_b64_tr_b16 a[164:165], v9 offset:8192
    ds_read_b64_tr_b16 a[166:167], v9 offset:12288
    s_waitcnt lgkmcnt(12)
    v_mfma_f32_16x16x32_bf16 v[108:111], a[140:143], a[112:115], v[108:111]
    ds_read_b64_tr_b16 a[168:169], v10 offset:8192
    ds_read_b64_tr_b16 a[170:171], v10 offset:12288
    s_waitcnt lgkmcnt(12)
    v_mfma_f32_16x16x32_bf16 v[112:115], a[144:147], a[112:115], v[112:115]
    ds_read_b64_tr_b16 a[172:173], v11 offset:8192
    ds_read_b64_tr_b16 a[174:175], v11 offset:12288
    s_waitcnt lgkmcnt(12)
    v_mfma_f32_16x16x32_bf16 v[116:119], a[148:151], a[112:115], v[116:119]
    ds_read_b64_tr_b16 a[176:177], v12 offset:8192
    ds_read_b64_tr_b16 a[178:179], v12 offset:12288
    s_waitcnt lgkmcnt(12)
    v_mfma_f32_16x16x32_bf16 v[120:123], a[152:155], a[112:115], v[120:123]
    ds_read_b64_tr_b16 a[180:181], v13 offset:8192
    ds_read_b64_tr_b16 a[182:183], v13 offset:12288
    s_waitcnt lgkmcnt(12)
    v_mfma_f32_16x16x32_bf16 v[124:127], a[156:159], a[112:115], v[124:127]
    ds_read_b64_tr_b16 a[184:185], v14 offset:8192
    ds_read_b64_tr_b16 a[186:187], v14 offset:12288
    s_waitcnt lgkmcnt(12)
    v_mfma_f32_16x16x32_bf16 v[96:99], a[160:163], a[116:119], v[96:99]
    ds_read_b64_tr_b16 a[188:189], v15 offset:8192
    ds_read_b64_tr_b16 a[190:191], v15 offset:12288
    s_waitcnt lgkmcnt(12)
    v_mfma_f32_16x16x32_bf16 v[100:103], a[164:167], a[116:119], v[100:103]
    ds_read_b64_tr_b16 a[128:129], v8 offset:16384
    ds_read_b64_tr_b16 a[130:131], v8 offset:20480
    s_waitcnt lgkmcnt(12)
    v_mfma_f32_16x16x32_bf16 v[104:107], a[168:171], a[116:119], v[104:107]
    ds_read_b64_tr_b16 a[132:133], v9 offset:16384
    ds_read_b64_tr_b16 a[134:135], v9 offset:20480
    s_waitcnt lgkmcnt(12)
    v_mfma_f32_16x16x32_bf16 v[108:111], a[172:175], a[116:119], v[108:111]
    ds_read_b64_tr_b16 a[136:137], v10 offset:16384
    ds_read_b64_tr_b16 a[138:139], v10 offset:20480
    s_waitcnt lgkmcnt(12)
    v_mfma_f32_16x16x32_bf16 v[112:115], a[176:179], a[116:119], v[112:115]
    ds_read_b64_tr_b16 a[140:141], v11 offset:16384
    ds_read_b64_tr_b16 a[142:143], v11 offset:20480
    s_waitcnt lgkmcnt(12)
    v_mfma_f32_16x16x32_bf16 v[116:119], a[180:183], a[116:119], v[116:119]
    ds_read_b64_tr_b16 a[144:145], v12 offset:16384
    ds_read_b64_tr_b16 a[146:147], v12 offset:20480
    s_waitcnt lgkmcnt(12)
    v_mfma_f32_16x16x32_bf16 v[120:123], a[184:187], a[116:119], v[120:123]
    ds_read_b64_tr_b16 a[148:149], v13 offset:16384
    ds_read_b64_tr_b16 a[150:151], v13 offset:20480
    s_waitcnt lgkmcnt(12)
    v_mfma_f32_16x16x32_bf16 v[124:127], a[188:191], a[116:119], v[124:127]
    ds_read_b64_tr_b16 a[152:153], v14 offset:16384
    ds_read_b64_tr_b16 a[154:155], v14 offset:20480
    s_waitcnt vmcnt(13)
    s_barrier
    s_waitcnt lgkmcnt(12)
    v_mfma_f32_16x16x32_bf16 v[96:99], a[128:131], a[120:123], v[96:99]
    ds_read_b64_tr_b16 a[156:157], v15 offset:16384
    ds_read_b64_tr_b16 a[158:159], v15 offset:20480
    s_mov_b32 s82, 1703936
    s_add_u32 m0, s3, 114688
    s_nop 0
    buffer_load_dwordx4 v17, s[52:55], s82 offen lds
    s_waitcnt lgkmcnt(12)
    v_mfma_f32_16x16x32_bf16 v[100:103], a[132:135], a[120:123], v[100:103]
    ds_read_b64_tr_b16 a[160:161], v8 offset:24576
    ds_read_b64_tr_b16 a[162:163], v8 offset:28672
    s_waitcnt lgkmcnt(12)
    v_mfma_f32_16x16x32_bf16 v[104:107], a[136:139], a[120:123], v[104:107]
    ds_read_b64_tr_b16 a[164:165], v9 offset:24576
    ds_read_b64_tr_b16 a[166:167], v9 offset:28672
    s_waitcnt lgkmcnt(12)
    v_mfma_f32_16x16x32_bf16 v[108:111], a[140:143], a[120:123], v[108:111]
    ds_read_b64_tr_b16 a[168:169], v10 offset:24576
    ds_read_b64_tr_b16 a[170:171], v10 offset:28672
    buffer_load_dwordx4 v18, s[52:55], s82 offen offset:1024 lds
    s_waitcnt lgkmcnt(12)
    v_mfma_f32_16x16x32_bf16 v[112:115], a[144:147], a[120:123], v[112:115]
    ds_read_b64_tr_b16 a[172:173], v11 offset:24576
    ds_read_b64_tr_b16 a[174:175], v11 offset:28672
    s_waitcnt lgkmcnt(12)
    v_mfma_f32_16x16x32_bf16 v[116:119], a[148:151], a[120:123], v[116:119]
    ds_read_b64_tr_b16 a[176:177], v12 offset:24576
    ds_read_b64_tr_b16 a[178:179], v12 offset:28672
    s_waitcnt lgkmcnt(12)
    v_mfma_f32_16x16x32_bf16 v[120:123], a[152:155], a[120:123], v[120:123]
    ds_read_b64_tr_b16 a[180:181], v13 offset:24576
    ds_read_b64_tr_b16 a[182:183], v13 offset:28672
    s_mov_b32 s83, 1769472
    s_add_u32 m0, s3, 122880
    s_nop 0
    buffer_load_dwordx4 v17, s[52:55], s83 offen lds
    s_waitcnt lgkmcnt(12)
    v_mfma_f32_16x16x32_bf16 v[124:127], a[156:159], a[120:123], v[124:127]
    ds_read_b64_tr_b16 a[184:185], v14 offset:24576
    ds_read_b64_tr_b16 a[186:187], v14 offset:28672
    s_waitcnt lgkmcnt(12)
    v_mfma_f32_16x16x32_bf16 v[96:99], a[160:163], a[124:127], v[96:99]
    ds_read_b64_tr_b16 a[188:189], v15 offset:24576
    ds_read_b64_tr_b16 a[190:191], v15 offset:28672
    buffer_load_dword v43, off, s[56:59], s77 sc1
    s_waitcnt lgkmcnt(12)
    v_mfma_f32_16x16x32_bf16 v[100:103], a[164:167], a[124:127], v[100:103]
    ds_read_b64_tr_b16 a[128:129], v8 offset:32768
    ds_read_b64_tr_b16 a[130:131], v8 offset:36864
    buffer_load_dwordx4 v18, s[52:55], s83 offen offset:1024 lds
    s_waitcnt lgkmcnt(12)
    v_mfma_f32_16x16x32_bf16 v[104:107], a[168:171], a[124:127], v[104:107]
    ds_read_b64_tr_b16 a[132:133], v9 offset:32768
    ds_read_b64_tr_b16 a[134:135], v9 offset:36864
    s_waitcnt lgkmcnt(12)
    v_mfma_f32_16x16x32_bf16 v[108:111], a[172:175], a[124:127], v[108:111]
    ds_read_b64_tr_b16 a[136:137], v10 offset:32768
    ds_read_b64_tr_b16 a[138:139], v10 offset:36864
    s_waitcnt lgkmcnt(12)
    v_mfma_f32_16x16x32_bf16 v[112:115], a[176:179], a[124:127], v[112:115]
    ds_read_b64_tr_b16 a[140:141], v11 offset:32768
    ds_read_b64_tr_b16 a[142:143], v11 offset:36864
    s_mov_b32 s82, 1835008
    s_add_u32 m0, s3, 131072
    s_nop 0
    buffer_load_dwordx4 v17, s[52:55], s82 offen lds
    s_waitcnt lgkmcnt(12)
    v_mfma_f32_16x16x32_bf16 v[116:119], a[180:183], a[124:127], v[116:119]
    ds_read_b64_tr_b16 a[144:145], v12 offset:32768
    ds_read_b64_tr_b16 a[146:147], v12 offset:36864
    s_waitcnt lgkmcnt(12)
    v_mfma_f32_16x16x32_bf16 v[120:123], a[184:187], a[124:127], v[120:123]
    ds_read_b64_tr_b16 a[148:149], v13 offset:32768
    ds_read_b64_tr_b16 a[150:151], v13 offset:36864
    s_waitcnt lgkmcnt(12)
    v_mfma_f32_16x16x32_bf16 v[124:127], a[188:191], a[124:127], v[124:127]
    ds_read_b64_tr_b16 a[152:153], v14 offset:32768
    ds_read_b64_tr_b16 a[154:155], v14 offset:36864
    buffer_load_dwordx4 v18, s[52:55], s82 offen offset:1024 lds
    s_waitcnt lgkmcnt(12)
    v_mfma_f32_16x16x32_bf16 v[96:99], a[128:131], a[0:3], v[96:99]
    ds_read_b64_tr_b16 a[156:157], v15 offset:32768
    ds_read_b64_tr_b16 a[158:159], v15 offset:36864
    s_waitcnt lgkmcnt(12)
    v_mfma_f32_16x16x32_bf16 v[100:103], a[132:135], a[0:3], v[100:103]
    ds_read_b64_tr_b16 a[160:161], v8 offset:40960
    ds_read_b64_tr_b16 a[162:163], v8 offset:45056
    s_waitcnt lgkmcnt(12)
    v_mfma_f32_16x16x32_bf16 v[104:107], a[136:139], a[0:3], v[104:107]
    ds_read_b64_tr_b16 a[164:165], v9 offset:40960
    ds_read_b64_tr_b16 a[166:167], v9 offset:45056
    s_mov_b32 s83, 1900544
    s_add_u32 m0, s3, 139264
    s_nop 0
    buffer_load_dwordx4 v17, s[52:55], s83 offen lds
    s_waitcnt lgkmcnt(12)
    v_mfma_f32_16x16x32_bf16 v[108:111], a[140:143], a[0:3], v[108:111]
    ds_read_b64_tr_b16 a[168:169], v10 offset:40960
    ds_read_b64_tr_b16 a[170:171], v10 offset:45056
    s_waitcnt lgkmcnt(12)
    v_mfma_f32_16x16x32_bf16 v[112:115], a[144:147], a[0:3], v[112:115]
    ds_read_b64_tr_b16 a[172:173], v11 offset:40960
    ds_read_b64_tr_b16 a[174:175], v11 offset:45056
    s_waitcnt lgkmcnt(12)
    v_mfma_f32_16x16x32_bf16 v[116:119], a[148:151], a[0:3], v[116:119]
    ds_read_b64_tr_b16 a[176:177], v12 offset:40960
    ds_read_b64_tr_b16 a[178:179], v12 offset:45056
    buffer_load_dwordx4 v18, s[52:55], s83 offen offset:1024 lds
    s_waitcnt lgkmcnt(12)
    v_mfma_f32_16x16x32_bf16 v[120:123], a[152:155], a[0:3], v[120:123]
    ds_read_b64_tr_b16 a[180:181], v13 offset:40960
    ds_read_b64_tr_b16 a[182:183], v13 offset:45056
    s_waitcnt lgkmcnt(12)
    v_mfma_f32_16x16x32_bf16 v[124:127], a[156:159], a[0:3], v[124:127]
    ds_read_b64_tr_b16 a[184:185], v14 offset:40960
    ds_read_b64_tr_b16 a[186:187], v14 offset:45056
    s_waitcnt lgkmcnt(12)
    v_mfma_f32_16x16x32_bf16 v[96:99], a[160:163], a[4:7], v[96:99]
    ds_read_b64_tr_b16 a[188:189], v15 offset:40960
    ds_read_b64_tr_b16 a[190:191], v15 offset:45056
    s_mov_b32 s82, 1966080
    s_add_u32 m0, s3, 147456
    s_nop 0
    buffer_load_dwordx4 v17, s[52:55], s82 offen lds
    s_waitcnt lgkmcnt(12)
    v_mfma_f32_16x16x32_bf16 v[100:103], a[164:167], a[4:7], v[100:103]
    ds_read_b64_tr_b16 a[128:129], v8 offset:49152
    ds_read_b64_tr_b16 a[130:131], v8 offset:53248
    s_waitcnt lgkmcnt(12)
    v_mfma_f32_16x16x32_bf16 v[104:107], a[168:171], a[4:7], v[104:107]
    ds_read_b64_tr_b16 a[132:133], v9 offset:49152
    ds_read_b64_tr_b16 a[134:135], v9 offset:53248
    s_waitcnt lgkmcnt(12)
    v_mfma_f32_16x16x32_bf16 v[108:111], a[172:175], a[4:7], v[108:111]
    ds_read_b64_tr_b16 a[136:137], v10 offset:49152
    ds_read_b64_tr_b16 a[138:139], v10 offset:53248
    buffer_load_dwordx4 v18, s[52:55], s82 offen offset:1024 lds
    s_waitcnt lgkmcnt(12)
    v_mfma_f32_16x16x32_bf16 v[112:115], a[176:179], a[4:7], v[112:115]
    ds_read_b64_tr_b16 a[140:141], v11 offset:49152
    ds_read_b64_tr_b16 a[142:143], v11 offset:53248
    s_waitcnt lgkmcnt(12)
    v_mfma_f32_16x16x32_bf16 v[116:119], a[180:183], a[4:7], v[116:119]
    ds_read_b64_tr_b16 a[144:145], v12 offset:49152
    ds_read_b64_tr_b16 a[146:147], v12 offset:53248
    s_waitcnt lgkmcnt(12)
    v_mfma_f32_16x16x32_bf16 v[120:123], a[184:187], a[4:7], v[120:123]
    ds_read_b64_tr_b16 a[148:149], v13 offset:49152
    ds_read_b64_tr_b16 a[150:151], v13 offset:53248
    s_mov_b32 s83, 2031616
    s_add_u32 m0, s3, 155648
    s_nop 0
    buffer_load_dwordx4 v17, s[52:55], s83 offen lds
    s_waitcnt lgkmcnt(12)
    v_mfma_f32_16x16x32_bf16 v[124:127], a[188:191], a[4:7], v[124:127]
    ds_read_b64_tr_b16 a[152:153], v14 offset:49152
    ds_read_b64_tr_b16 a[154:155], v14 offset:53248
    s_waitcnt vmcnt(12)
    s_barrier
    s_waitcnt lgkmcnt(12)
    v_mfma_f32_16x16x32_bf16 v[96:99], a[128:131], a[8:11], v[96:99]
    ds_read_b64_tr_b16 a[156:157], v15 offset:49152
    ds_read_b64_tr_b16 a[158:159], v15 offset:53248
    s_waitcnt lgkmcnt(12)
    v_mfma_f32_16x16x32_bf16 v[100:103], a[132:135], a[8:11], v[100:103]
    ds_read_b64_tr_b16 a[160:161], v8 offset:57344
    ds_read_b64_tr_b16 a[162:163], v8 offset:61440
    buffer_load_dwordx4 v18, s[52:55], s83 offen offset:1024 lds
    s_waitcnt lgkmcnt(12)
    v_mfma_f32_16x16x32_bf16 v[104:107], a[136:139], a[8:11], v[104:107]
    ds_read_b64_tr_b16 a[164:165], v9 offset:57344
    ds_read_b64_tr_b16 a[166:167], v9 offset:61440
    s_waitcnt lgkmcnt(12)
    v_mfma_f32_16x16x32_bf16 v[108:111], a[140:143], a[8:11], v[108:111]
    ds_read_b64_tr_b16 a[168:169], v10 offset:57344
    ds_read_b64_tr_b16 a[170:171], v10 offset:61440
    s_waitcnt lgkmcnt(12)
    v_mfma_f32_16x16x32_bf16 v[112:115], a[144:147], a[8:11], v[112:115]
    ds_read_b64_tr_b16 a[172:173], v11 offset:57344
    ds_read_b64_tr_b16 a[174:175], v11 offset:61440
    s_waitcnt lgkmcnt(12)
    v_mfma_f32_16x16x32_bf16 v[116:119], a[148:151], a[8:11], v[116:119]
    ds_read_b64_tr_b16 a[176:177], v12 offset:57344
    ds_read_b64_tr_b16 a[178:179], v12 offset:61440
    s_waitcnt lgkmcnt(12)
    v_mfma_f32_16x16x32_bf16 v[120:123], a[152:155], a[8:11], v[120:123]
    ds_read_b64_tr_b16 a[180:181], v13 offset:57344
    ds_read_b64_tr_b16 a[182:183], v13 offset:61440
    s_waitcnt lgkmcnt(12)
    v_mfma_f32_16x16x32_bf16 v[124:127], a[156:159], a[8:11], v[124:127]
    ds_read_b64_tr_b16 a[184:185], v14 offset:57344
    ds_read_b64_tr_b16 a[186:187], v14 offset:61440
    s_waitcnt lgkmcnt(12)
    v_mfma_f32_16x16x32_bf16 v[96:99], a[160:163], a[12:15], v[96:99]
    ds_read_b64_tr_b16 a[188:189], v15 offset:57344
    ds_read_b64_tr_b16 a[190:191], v15 offset:61440
    s_waitcnt lgkmcnt(12)
    v_mfma_f32_16x16x32_bf16 v[100:103], a[164:167], a[12:15], v[100:103]
    ds_read_b64_tr_b16 a[128:129], v48 offset:0
    ds_read_b64_tr_b16 a[130:131], v48 offset:4096
    s_waitcnt lgkmcnt(12)
    v_mfma_f32_16x16x32_bf16 v[104:107], a[168:171], a[12:15], v[104:107]
    ds_read_b64_tr_b16 a[132:133], v49 offset:0
    ds_read_b64_tr_b16 a[134:135], v49 offset:4096
    s_waitcnt lgkmcnt(12)
    v_mfma_f32_16x16x32_bf16 v[108:111], a[172:175], a[12:15], v[108:111]
    ds_read_b64_tr_b16 a[136:137], v50 offset:0
    ds_read_b64_tr_b16 a[138:139], v50 offset:4096
    s_waitcnt lgkmcnt(12)
    v_mfma_f32_16x16x32_bf16 v[112:115], a[176:179], a[12:15], v[112:115]
    ds_read_b64_tr_b16 a[140:141], v51 offset:0
    ds_read_b64_tr_b16 a[142:143], v51 offset:4096
    s_waitcnt lgkmcnt(12)
    v_mfma_f32_16x16x32_bf16 v[116:119], a[180:183], a[12:15], v[116:119]
    ds_read_b64_tr_b16 a[144:145], v52 offset:0
    ds_read_b64_tr_b16 a[146:147], v52 offset:4096
    s_waitcnt lgkmcnt(12)
    v_mfma_f32_16x16x32_bf16 v[120:123], a[184:187], a[12:15], v[120:123]
    ds_read_b64_tr_b16 a[148:149], v53 offset:0
    ds_read_b64_tr_b16 a[150:151], v53 offset:4096
    s_waitcnt lgkmcnt(12)
    v_mfma_f32_16x16x32_bf16 v[124:127], a[188:191], a[12:15], v[124:127]
    ds_read_b64_tr_b16 a[152:153], v54 offset:0
    ds_read_b64_tr_b16 a[154:155], v54 offset:4096
    s_waitcnt lgkmcnt(12)
    v_mfma_f32_16x16x32_bf16 v[96:99], a[128:131], a[16:19], v[96:99]
    ds_read_b64_tr_b16 a[156:157], v55 offset:0
    ds_read_b64_tr_b16 a[158:159], v55 offset:4096
    s_waitcnt vmcnt(9)
    v_readfirstlane_b32 s86, v43
    s_cmp_eq_u32 s86, 4
    s_cbranch_scc0 L_spP
L_okP:
    buffer_load_dwordx4 v[164:167], v16, s[56:59], s73 offen offset:0 sc1
    s_waitcnt lgkmcnt(12)
    v_mfma_f32_16x16x32_bf16 v[100:103], a[132:135], a[16:19], v[100:103]
    ds_read_b64_tr_b16 a[160:161], v48 offset:8192
    ds_read_b64_tr_b16 a[162:163], v48 offset:12288
    buffer_load_dwordx4 v[172:175], v16, s[56:59], s73 offen offset:1024 sc1
    s_waitcnt lgkmcnt(12)
    v_mfma_f32_16x16x32_bf16 v[104:107], a[136:139], a[16:19], v[104:107]
    ds_read_b64_tr_b16 a[164:165], v49 offset:8192
    ds_read_b64_tr_b16 a[166:167], v49 offset:12288
    buffer_load_dwordx4 v[180:183], v16, s[56:59], s73 offen offset:2048 sc1
    s_waitcnt lgkmcnt(12)
    v_mfma_f32_16x16x32_bf16 v[108:111], a[140:143], a[16:19], v[108:111]
    ds_read_b64_tr_b16 a[168:169], v50 offset:8192
    ds_read_b64_tr_b16 a[170:171], v50 offset:12288
    buffer_load_dwordx4 v[188:191], v16, s[56:59], s73 offen offset:3072 sc1
    s_waitcnt lgkmcnt(12)
    v_mfma_f32_16x16x32_bf16 v[112:115], a[144:147], a[16:19], v[112:115]
    ds_read_b64_tr_b16 a[172:173], v51 offset:8192
    ds_read_b64_tr_b16 a[174:175], v51 offset:12288
    buffer_load_dwordx4 v[196:199], v16, s[56:59], s74 offen offset:0 sc1
    s_waitcnt lgkmcnt(12)
    v_mfma_f32_16x16x32_bf16 v[116:119], a[148:151], a[16:19], v[116:119]
    ds_read_b64_tr_b16 a[176:177], v52 offset:8192
    ds_read_b64_tr_b16 a[178:179], v52 offset:12288
    buffer_load_dwordx4 v[204:207], v16, s[56:59], s74 offen offset:1024 sc1
    s_waitcnt lgkmcnt(12)
    v_mfma_f32_16x16x32_bf16 v[120:123], a[152:155], a[16:19], v[120:123]
    ds_read_b64_tr_b16 a[180:181], v53 offset:8192
    ds_read_b64_tr_b16 a[182:183], v53 offset:12288
    buffer_load_dwordx4 v[212:215], v16, s[56:59], s74 offen offset:2048 sc1
    s_waitcnt lgkmcnt(12)
    v_mfma_f32_16x16x32_bf16 v[124:127], a[156:159], a[16:19], v[124:127]
    ds_read_b64_tr_b16 a[184:185], v54 offset:8192
    ds_read_b64_tr_b16 a[186:187], v54 offset:12288
    buffer_load_dwordx4 v[220:223], v16, s[56:59], s74 offen offset:3072 sc1
    s_waitcnt lgkmcnt(12)
    v_mfma_f32_16x16x32_bf16 v[96:99], a[160:163], a[20:23], v[96:99]
    ds_read_b64_tr_b16 a[188:189], v55 offset:8192
    ds_read_b64_tr_b16 a[190:191], v55 offset:12288
    buffer_load_dwordx4 v[228:231], v16, s[56:59], s75 offen offset:0 sc1
    s_waitcnt lgkmcnt(12)
    v_mfma_f32_16x16x32_bf16 v[100:103], a[164:167], a[20:23], v[100:103]
    ds_read_b64_tr_b16 a[128:129], v48 offset:16384
    ds_read_b64_tr_b16 a[130:131], v48 offset:20480
    buffer_load_dwordx4 v[236:239], v16, s[56:59], s75 offen offset:1024 sc1
    s_waitcnt lgkmcnt(12)
    v_mfma_f32_16x16x32_bf16 v[104:107], a[168:171], a[20:23], v[104:107]
    ds_read_b64_tr_b16 a[132:133], v49 offset:16384
    ds_read_b64_tr_b16 a[134:135], v49 offset:20480
    buffer_load_dwordx4 v[244:247], v16, s[56:59], s75 offen offset:2048 sc1
    s_waitcnt lgkmcnt(12)
    v_mfma_f32_16x16x32_bf16 v[108:111], a[172:175], a[20:23], v[108:111]
    ds_read_b64_tr_b16 a[136:137], v50 offset:16384
    ds_read_b64_tr_b16 a[138:139], v50 offset:20480
    buffer_load_dwordx4 v[252:255], v16, s[56:59], s75 offen offset:3072 sc1
    s_waitcnt lgkmcnt(12)
    v_mfma_f32_16x16x32_bf16 v[112:115], a[176:179], a[20:23], v[112:115]
    ds_read_b64_tr_b16 a[140:141], v51 offset:16384
    ds_read_b64_tr_b16 a[142:143], v51 offset:20480
    s_waitcnt lgkmcnt(12)
    v_mfma_f32_16x16x32_bf16 v[116:119], a[180:183], a[20:23], v[116:119]
    ds_read_b64_tr_b16 a[144:145], v52 offset:16384
    ds_read_b64_tr_b16 a[146:147], v52 offset:20480
    s_waitcnt lgkmcnt(12)
    v_mfma_f32_16x16x32_bf16 v[120:123], a[184:187], a[20:23], v[120:123]
    ds_read_b64_tr_b16 a[148:149], v53 offset:16384
    ds_read_b64_tr_b16 a[150:151], v53 offset:20480
    s_waitcnt lgkmcnt(12)
    v_mfma_f32_16x16x32_bf16 v[124:127], a[188:191], a[20:23], v[124:127]
    ds_read_b64_tr_b16 a[152:153], v54 offset:16384
    ds_read_b64_tr_b16 a[154:155], v54 offset:20480
    s_waitcnt lgkmcnt(12)
    v_mfma_f32_16x16x32_bf16 v[96:99], a[128:131], a[24:27], v[96:99]
    ds_read_b64_tr_b16 a[156:157], v55 offset:16384
    ds_read_b64_tr_b16 a[158:159], v55 offset:20480
    s_waitcnt lgkmcnt(12)
    v_mfma_f32_16x16x32_bf16 v[100:103], a[132:135], a[24:27], v[100:103]
    ds_read_b64_tr_b16 a[160:161], v48 offset:24576
    ds_read_b64_tr_b16 a[162:163], v48 offset:28672
    s_waitcnt lgkmcnt(12)
    v_mfma_f32_16x16x32_bf16 v[104:107], a[136:139], a[24:27], v[104:107]
    ds_read_b64_tr_b16 a[164:165], v49 offset:24576
    ds_read_b64_tr_b16 a[166:167], v49 offset:28672
    s_waitcnt lgkmcnt(12)
    v_mfma_f32_16x16x32_bf16 v[108:111], a[140:143], a[24:27], v[108:111]
    ds_read_b64_tr_b16 a[168:169], v50 offset:24576
    ds_read_b64_tr_b16 a[170:171], v50 offset:28672
    s_waitcnt lgkmcnt(12)
    v_mfma_f32_16x16x32_bf16 v[112:115], a[144:147], a[24:27], v[112:115]
    ds_read_b64_tr_b16 a[172:173], v51 offset:24576
    ds_read_b64_tr_b16 a[174:175], v51 offset:28672
    s_waitcnt lgkmcnt(12)
    v_mfma_f32_16x16x32_bf16 v[116:119], a[148:151], a[24:27], v[116:119]
    ds_read_b64_tr_b16 a[176:177], v52 offset:24576
    ds_read_b64_tr_b16 a[178:179], v52 offset:28672
    s_waitcnt lgkmcnt(12)
    v_mfma_f32_16x16x32_bf16 v[120:123], a[152:155], a[24:27], v[120:123]
    ds_read_b64_tr_b16 a[180:181], v53 offset:24576
    ds_read_b64_tr_b16 a[182:183], v53 offset:28672
    s_waitcnt lgkmcnt(12)
    v_mfma_f32_16x16x32_bf16 v[124:127], a[156:159], a[24:27], v[124:127]
    ds_read_b64_tr_b16 a[184:185], v54 offset:24576
    ds_read_b64_tr_b16 a[186:187], v54 offset:28672
    s_waitcnt lgkmcnt(12)
    v_mfma_f32_16x16x32_bf16 v[96:99], a[160:163], a[28:31], v[96:99]
    ds_read_b64_tr_b16 a[188:189], v55 offset:24576
    ds_read_b64_tr_b16 a[190:191], v55 offset:28672
    s_waitcnt lgkmcnt(12)
    v_mfma_f32_16x16x32_bf16 v[100:103], a[164:167], a[28:31], v[100:103]
    ds_read_b64_tr_b16 a[128:129], v48 offset:32768
    ds_read_b64_tr_b16 a[130:131], v48 offset:36864
    s_waitcnt lgkmcnt(12)
    v_mfma_f32_16x16x32_bf16 v[104:107], a[168:171], a[28:31], v[104:107]
    ds_read_b64_tr_b16 a[132:133], v49 offset:32768
    ds_read_b64_tr_b16 a[134:135], v49 offset:36864
    s_waitcnt lgkmcnt(12)
    v_mfma_f32_16x16x32_bf16 v[108:111], a[172:175], a[28:31], v[108:111]
    ds_read_b64_tr_b16 a[136:137], v50 offset:32768
    ds_read_b64_tr_b16 a[138:139], v50 offset:36864
    s_waitcnt lgkmcnt(12)
    v_mfma_f32_16x16x32_bf16 v[112:115], a[176:179], a[28:31], v[112:115]
    ds_read_b64_tr_b16 a[140:141], v51 offset:32768
    ds_read_b64_tr_b16 a[142:143], v51 offset:36864
    s_waitcnt lgkmcnt(12)
    v_mfma_f32_16x16x32_bf16 v[116:119], a[180:183], a[28:31], v[116:119]
    ds_read_b64_tr_b16 a[144:145], v52 offset:32768
    ds_read_b64_tr_b16 a[146:147], v52 offset:36864
    s_waitcnt lgkmcnt(12)
    v_mfma_f32_16x16x32_bf16 v[120:123], a[184:187], a[28:31], v[120:123]
    ds_read_b64_tr_b16 a[148:149], v53 offset:32768
    ds_read_b64_tr_b16 a[150:151], v53 offset:36864
    s_waitcnt lgkmcnt(12)
    v_mfma_f32_16x16x32_bf16 v[124:127], a[188:191], a[28:31], v[124:127]
    ds_read_b64_tr_b16 a[152:153], v54 offset:32768
    ds_read_b64_tr_b16 a[154:155], v54 offset:36864
    s_waitcnt vmcnt(12)
    s_barrier
    s_waitcnt lgkmcnt(12)
    v_mfma_f32_16x16x32_bf16 v[96:99], a[128:131], a[32:35], v[96:99]
    ds_read_b64_tr_b16 a[156:157], v55 offset:32768
    ds_read_b64_tr_b16 a[158:159], v55 offset:36864
    s_waitcnt lgkmcnt(12)
    v_mfma_f32_16x16x32_bf16 v[100:103], a[132:135], a[32:35], v[100:103]
    ds_read_b64_tr_b16 a[160:161], v48 offset:40960
    ds_read_b64_tr_b16 a[162:163], v48 offset:45056
    s_waitcnt lgkmcnt(12)
    v_mfma_f32_16x16x32_bf16 v[104:107], a[136:139], a[32:35], v[104:107]
    ds_read_b64_tr_b16 a[164:165], v49 offset:40960
    ds_read_b64_tr_b16 a[166:167], v49 offset:45056
    s_waitcnt lgkmcnt(12)
    v_mfma_f32_16x16x32_bf16 v[108:111], a[140:143], a[32:35], v[108:111]
    ds_read_b64_tr_b16 a[168:169], v50 offset:40960
    ds_read_b64_tr_b16 a[170:171], v50 offset:45056
    s_waitcnt lgkmcnt(12)
    v_mfma_f32_16x16x32_bf16 v[112:115], a[144:147], a[32:35], v[112:115]
    ds_read_b64_tr_b16 a[172:173], v51 offset:40960
    ds_read_b64_tr_b16 a[174:175], v51 offset:45056
    s_waitcnt lgkmcnt(12)
    v_mfma_f32_16x16x32_bf16 v[116:119], a[148:151], a[32:35], v[116:119]
    ds_read_b64_tr_b16 a[176:177], v52 offset:40960
    ds_read_b64_tr_b16 a[178:179], v52 offset:45056
    s_waitcnt lgkmcnt(12)
    v_mfma_f32_16x16x32_bf16 v[120:123], a[152:155], a[32:35], v[120:123]
    ds_read_b64_tr_b16 a[180:181], v53 offset:40960
    ds_read_b64_tr_b16 a[182:183], v53 offset:45056
    s_waitcnt lgkmcnt(12)
    v_mfma_f32_16x16x32_bf16 v[124:127], a[156:159], a[32:35], v[124:127]
    ds_read_b64_tr_b16 a[184:185], v54 offset:40960
    ds_read_b64_tr_b16 a[186:187], v54 offset:45056
    s_waitcnt lgkmcnt(12)
    v_mfma_f32_16x16x32_bf16 v[96:99], a[160:163], a[36:39], v[96:99]
    ds_read_b64_tr_b16 a[188:189], v55 offset:40960
    ds_read_b64_tr_b16 a[190:191], v55 offset:45056
    s_waitcnt lgkmcnt(12)
    v_mfma_f32_16x16x32_bf16 v[100:103], a[164:167], a[36:39], v[100:103]
    ds_read_b64_tr_b16 a[128:129], v48 offset:49152
    ds_read_b64_tr_b16 a[130:131], v48 offset:53248
    s_waitcnt lgkmcnt(12)
    v_mfma_f32_16x16x32_bf16 v[104:107], a[168:171], a[36:39], v[104:107]
    ds_read_b64_tr_b16 a[132:133], v49 offset:49152
    ds_read_b64_tr_b16 a[134:135], v49 offset:53248
    s_waitcnt lgkmcnt(12)
    v_mfma_f32_16x16x32_bf16 v[108:111], a[172:175], a[36:39], v[108:111]
    ds_read_b64_tr_b16 a[136:137], v50 offset:49152
    ds_read_b64_tr_b16 a[138:139], v50 offset:53248
    s_waitcnt lgkmcnt(12)
    v_mfma_f32_16x16x32_bf16 v[112:115], a[176:179], a[36:39], v[112:115]
    ds_read_b64_tr_b16 a[140:141], v51 offset:49152
    ds_read_b64_tr_b16 a[142:143], v51 offset:53248
    s_waitcnt lgkmcnt(12)
    v_mfma_f32_16x16x32_bf16 v[116:119], a[180:183], a[36:39], v[116:119]
    ds_read_b64_tr_b16 a[144:145], v52 offset:49152
    ds_read_b64_tr_b16 a[146:147], v52 offset:53248
    s_waitcnt lgkmcnt(12)
    v_mfma_f32_16x16x32_bf16 v[120:123], a[184:187], a[36:39], v[120:123]
    ds_read_b64_tr_b16 a[148:149], v53 offset:49152
    ds_read_b64_tr_b16 a[150:151], v53 offset:53248
    s_waitcnt lgkmcnt(12)
    v_mfma_f32_16x16x32_bf16 v[124:127], a[188:191], a[36:39], v[124:127]
    ds_read_b64_tr_b16 a[152:153], v54 offset:49152
    ds_read_b64_tr_b16 a[154:155], v54 offset:53248
    s_waitcnt lgkmcnt(12)
    v_mfma_f32_16x16x32_bf16 v[96:99], a[128:131], a[40:43], v[96:99]
    ds_read_b64_tr_b16 a[156:157], v55 offset:49152
    ds_read_b64_tr_b16 a[158:159], v55 offset:53248
    s_waitcnt lgkmcnt(12)
    v_mfma_f32_16x16x32_bf16 v[100:103], a[132:135], a[40:43], v[100:103]
    ds_read_b64_tr_b16 a[160:161], v48 offset:57344
    ds_read_b64_tr_b16 a[162:163], v48 offset:61440
    s_waitcnt lgkmcnt(12)
    v_mfma_f32_16x16x32_bf16 v[104:107], a[136:139], a[40:43], v[104:107]
    ds_read_b64_tr_b16 a[164:165], v49 offset:57344
    ds_read_b64_tr_b16 a[166:167], v49 offset:61440
    s_waitcnt lgkmcnt(12)
    v_mfma_f32_16x16x32_bf16 v[108:111], a[140:143], a[40:43], v[108:111]
    ds_read_b64_tr_b16 a[168:169], v50 offset:57344
    ds_read_b64_tr_b16 a[170:171], v50 offset:61440
    s_waitcnt lgkmcnt(12)
    v_mfma_f32_16x16x32_bf16 v[112:115], a[144:147], a[40:43], v[112:115]
    ds_read_b64_tr_b16 a[172:173], v51 offset:57344
    ds_read_b64_tr_b16 a[174:175], v51 offset:61440
    s_waitcnt lgkmcnt(12)
    v_mfma_f32_16x16x32_bf16 v[116:119], a[148:151], a[40:43], v[116:119]
    ds_read_b64_tr_b16 a[176:177], v52 offset:57344
    ds_read_b64_tr_b16 a[178:179], v52 offset:61440
    s_waitcnt lgkmcnt(12)
    v_mfma_f32_16x16x32_bf16 v[120:123], a[152:155], a[40:43], v[120:123]
    ds_read_b64_tr_b16 a[180:181], v53 offset:57344
    ds_read_b64_tr_b16 a[182:183], v53 offset:61440
    s_waitcnt lgkmcnt(12)
    v_mfma_f32_16x16x32_bf16 v[124:127], a[156:159], a[40:43], v[124:127]
    ds_read_b64_tr_b16 a[184:185], v54 offset:57344
    ds_read_b64_tr_b16 a[186:187], v54 offset:61440
    s_waitcnt lgkmcnt(12)
    v_mfma_f32_16x16x32_bf16 v[96:99], a[160:163], a[44:47], v[96:99]
    ds_read_b64_tr_b16 a[188:189], v55 offset:57344
    ds_read_b64_tr_b16 a[190:191], v55 offset:61440
    s_waitcnt lgkmcnt(12)
    v_mfma_f32_16x16x32_bf16 v[100:103], a[164:167], a[44:47], v[100:103]
    ds_read_b64_tr_b16 a[128:129], v56 offset:0
    ds_read_b64_tr_b16 a[130:131], v56 offset:4096
    s_waitcnt lgkmcnt(12)
    v_mfma_f32_16x16x32_bf16 v[104:107], a[168:171], a[44:47], v[104:107]
    ds_read_b64_tr_b16 a[132:133], v57 offset:0
    ds_read_b64_tr_b16 a[134:135], v57 offset:4096
    s_waitcnt lgkmcnt(12)
    v_mfma_f32_16x16x32_bf16 v[108:111], a[172:175], a[44:47], v[108:111]
    ds_read_b64_tr_b16 a[136:137], v58 offset:0
    ds_read_b64_tr_b16 a[138:139], v58 offset:4096
    s_waitcnt lgkmcnt(12)
    v_mfma_f32_16x16x32_bf16 v[112:115], a[176:179], a[44:47], v[112:115]
    ds_read_b64_tr_b16 a[140:141], v59 offset:0
    ds_read_b64_tr_b16 a[142:143], v59 offset:4096
    s_waitcnt lgkmcnt(12)
    v_mfma_f32_16x16x32_bf16 v[116:119], a[180:183], a[44:47], v[116:119]
    ds_read_b64_tr_b16 a[144:145], v60 offset:0
    ds_read_b64_tr_b16 a[146:147], v60 offset:4096
    s_waitcnt lgkmcnt(12)
    v_mfma_f32_16x16x32_bf16 v[120:123], a[184:187], a[44:47], v[120:123]
    ds_read_b64_tr_b16 a[148:149], v61 offset:0
    ds_read_b64_tr_b16 a[150:151], v61 offset:4096
    s_waitcnt lgkmcnt(12)
    v_mfma_f32_16x16x32_bf16 v[124:127], a[188:191], a[44:47], v[124:127]
    ds_read_b64_tr_b16 a[152:153], v62 offset:0
    ds_read_b64_tr_b16 a[154:155], v62 offset:4096
    s_waitcnt lgkmcnt(12)
    v_mfma_f32_16x16x32_bf16 v[96:99], a[128:131], a[48:51], v[96:99]
    ds_read_b64_tr_b16 a[156:157], v63 offset:0
    ds_read_b64_tr_b16 a[158:159], v63 offset:4096
    s_waitcnt lgkmcnt(12)
    v_mfma_f32_16x16x32_bf16 v[100:103], a[132:135], a[48:51], v[100:103]
    ds_read_b64_tr_b16 a[160:161], v56 offset:8192
    ds_read_b64_tr_b16 a[162:163], v56 offset:12288
    s_waitcnt lgkmcnt(12)
    v_mfma_f32_16x16x32_bf16 v[104:107], a[136:139], a[48:51], v[104:107]
    ds_read_b64_tr_b16 a[164:165], v57 offset:8192
    ds_read_b64_tr_b16 a[166:167], v57 offset:12288
    s_waitcnt lgkmcnt(12)
    v_mfma_f32_16x16x32_bf16 v[108:111], a[140:143], a[48:51], v[108:111]
    ds_read_b64_tr_b16 a[168:169], v58 offset:8192
    ds_read_b64_tr_b16 a[170:171], v58 offset:12288
    s_waitcnt lgkmcnt(12)
    v_mfma_f32_16x16x32_bf16 v[112:115], a[144:147], a[48:51], v[112:115]
    ds_read_b64_tr_b16 a[172:173], v59 offset:8192
    ds_read_b64_tr_b16 a[174:175], v59 offset:12288
    s_waitcnt lgkmcnt(12)
    v_mfma_f32_16x16x32_bf16 v[116:119], a[148:151], a[48:51], v[116:119]
    ds_read_b64_tr_b16 a[176:177], v60 offset:8192
    ds_read_b64_tr_b16 a[178:179], v60 offset:12288
    s_waitcnt lgkmcnt(12)
    v_mfma_f32_16x16x32_bf16 v[120:123], a[152:155], a[48:51], v[120:123]
    ds_read_b64_tr_b16 a[180:181], v61 offset:8192
    ds_read_b64_tr_b16 a[182:183], v61 offset:12288
    s_waitcnt lgkmcnt(12)
    v_mfma_f32_16x16x32_bf16 v[124:127], a[156:159], a[48:51], v[124:127]
    ds_read_b64_tr_b16 a[184:185], v62 offset:8192
    ds_read_b64_tr_b16 a[186:187], v62 offset:12288
    s_waitcnt lgkmcnt(12)
    v_mfma_f32_16x16x32_bf16 v[96:99], a[160:163], a[52:55], v[96:99]
    ds_read_b64_tr_b16 a[188:189], v63 offset:8192
    ds_read_b64_tr_b16 a[190:191], v63 offset:12288
    s_waitcnt lgkmcnt(12)
    v_mfma_f32_16x16x32_bf16 v[100:103], a[164:167], a[52:55], v[100:103]
    ds_read_b64_tr_b16 a[128:129], v56 offset:16384
    ds_read_b64_tr_b16 a[130:131], v56 offset:20480
    s_waitcnt lgkmcnt(12)
    v_mfma_f32_16x16x32_bf16 v[104:107], a[168:171], a[52:55], v[104:107]
    ds_read_b64_tr_b16 a[132:133], v57 offset:16384
    ds_read_b64_tr_b16 a[134:135], v57 offset:20480
    s_waitcnt lgkmcnt(12)
    v_mfma_f32_16x16x32_bf16 v[108:111], a[172:175], a[52:55], v[108:111]
    ds_read_b64_tr_b16 a[136:137], v58 offset:16384
    ds_read_b64_tr_b16 a[138:139], v58 offset:20480
    s_waitcnt lgkmcnt(12)
    v_mfma_f32_16x16x32_bf16 v[112:115], a[176:179], a[52:55], v[112:115]
    ds_read_b64_tr_b16 a[140:141], v59 offset:16384
    ds_read_b64_tr_b16 a[142:143], v59 offset:20480
    s_waitcnt lgkmcnt(12)
    v_mfma_f32_16x16x32_bf16 v[116:119], a[180:183], a[52:55], v[116:119]
    ds_read_b64_tr_b16 a[144:145], v60 offset:16384
    ds_read_b64_tr_b16 a[146:147], v60 offset:20480
    s_waitcnt lgkmcnt(12)
    v_mfma_f32_16x16x32_bf16 v[120:123], a[184:187], a[52:55], v[120:123]
    ds_read_b64_tr_b16 a[148:149], v61 offset:16384
    ds_read_b64_tr_b16 a[150:151], v61 offset:20480
    s_waitcnt lgkmcnt(12)
    v_mfma_f32_16x16x32_bf16 v[124:127], a[188:191], a[52:55], v[124:127]
    ds_read_b64_tr_b16 a[152:153], v62 offset:16384
    ds_read_b64_tr_b16 a[154:155], v62 offset:20480
    s_waitcnt lgkmcnt(12)
    v_mfma_f32_16x16x32_bf16 v[96:99], a[128:131], a[56:59], v[96:99]
    ds_read_b64_tr_b16 a[156:157], v63 offset:16384
    ds_read_b64_tr_b16 a[158:159], v63 offset:20480
    s_waitcnt lgkmcnt(12)
    v_mfma_f32_16x16x32_bf16 v[100:103], a[132:135], a[56:59], v[100:103]
    ds_read_b64_tr_b16 a[160:161], v56 offset:24576
    ds_read_b64_tr_b16 a[162:163], v56 offset:28672
    s_waitcnt lgkmcnt(12)
    v_mfma_f32_16x16x32_bf16 v[104:107], a[136:139], a[56:59], v[104:107]
    ds_read_b64_tr_b16 a[164:165], v57 offset:24576
    ds_read_b64_tr_b16 a[166:167], v57 offset:28672
    s_waitcnt lgkmcnt(12)
    v_mfma_f32_16x16x32_bf16 v[108:111], a[140:143], a[56:59], v[108:111]
    ds_read_b64_tr_b16 a[168:169], v58 offset:24576
    ds_read_b64_tr_b16 a[170:171], v58 offset:28672
    s_waitcnt lgkmcnt(12)
    v_mfma_f32_16x16x32_bf16 v[112:115], a[144:147], a[56:59], v[112:115]
    ds_read_b64_tr_b16 a[172:173], v59 offset:24576
    ds_read_b64_tr_b16 a[174:175], v59 offset:28672
    s_waitcnt lgkmcnt(12)
    v_mfma_f32_16x16x32_bf16 v[116:119], a[148:151], a[56:59], v[116:119]
    ds_read_b64_tr_b16 a[176:177], v60 offset:24576
    ds_read_b64_tr_b16 a[178:179], v60 offset:28672
    s_waitcnt lgkmcnt(12)
    v_mfma_f32_16x16x32_bf16 v[120:123], a[152:155], a[56:59], v[120:123]
    ds_read_b64_tr_b16 a[180:181], v61 offset:24576
    ds_read_b64_tr_b16 a[182:183], v61 offset:28672
    s_waitcnt lgkmcnt(12)
    v_mfma_f32_16x16x32_bf16 v[124:127], a[156:159], a[56:59], v[124:127]
    ds_read_b64_tr_b16 a[184:185], v62 offset:24576
    ds_read_b64_tr_b16 a[186:187], v62 offset:28672
    s_waitcnt lgkmcnt(12)
    v_mfma_f32_16x16x32_bf16 v[96:99], a[160:163], a[60:63], v[96:99]
    ds_read_b64_tr_b16 a[188:189], v63 offset:24576
    ds_read_b64_tr_b16 a[190:191], v63 offset:28672
    s_waitcnt lgkmcnt(12)
    v_mfma_f32_16x16x32_bf16 v[100:103], a[164:167], a[60:63], v[100:103]
    s_waitcnt lgkmcnt(10)
    v_mfma_f32_16x16x32_bf16 v[104:107], a[168:171], a[60:63], v[104:107]
    s_waitcnt lgkmcnt(8)
    v_mfma_f32_16x16x32_bf16 v[108:111], a[172:175], a[60:63], v[108:111]
    s_waitcnt lgkmcnt(6)
    v_mfma_f32_16x16x32_bf16 v[112:115], a[176:179], a[60:63], v[112:115]
    s_waitcnt lgkmcnt(4)
    v_mfma_f32_16x16x32_bf16 v[116:119], a[180:183], a[60:63], v[116:119]
    s_waitcnt lgkmcnt(2)
    v_mfma_f32_16x16x32_bf16 v[120:123], a[184:187], a[60:63], v[120:123]
    s_waitcnt lgkmcnt(0)
    v_mfma_f32_16x16x32_bf16 v[124:127], a[188:191], a[60:63], v[124:127]
    s_waitcnt vmcnt(11)
    v_mfma_f32_16x16x32_bf16 v[128:131], v[28:31], v[164:167], v[128:131]
    v_mfma_f32_16x16x32_bf16 v[132:135], v[26:29], v[164:167], v[132:135]
    s_waitcnt vmcnt(10)
    v_mfma_f32_16x16x32_bf16 v[136:139], v[28:31], v[172:175], v[136:139]
    v_mfma_f32_16x16x32_bf16 v[140:143], v[26:29], v[172:175], v[140:143]
    s_waitcnt vmcnt(9)
    v_mfma_f32_16x16x32_bf16 v[144:147], v[28:31], v[180:183], v[144:147]
    v_mfma_f32_16x16x32_bf16 v[148:151], v[26:29], v[180:183], v[148:151]
    s_waitcnt vmcnt(8)
    v_mfma_f32_16x16x32_bf16 v[152:155], v[28:31], v[188:191], v[152:155]
    v_mfma_f32_16x16x32_bf16 v[156:159], v[26:29], v[188:191], v[156:159]
    s_waitcnt vmcnt(7)
    v_mfma_f32_16x16x32_bf16 v[128:131], v[28:31], v[196:199], v[128:131]
    v_mfma_f32_16x16x32_bf16 v[132:135], v[26:29], v[196:199], v[132:135]
    s_waitcnt vmcnt(6)
    v_mfma_f32_16x16x32_bf16 v[136:139], v[28:31], v[204:207], v[136:139]
    v_mfma_f32_16x16x32_bf16 v[140:143], v[26:29], v[204:207], v[140:143]
    s_waitcnt vmcnt(5)
    v_mfma_f32_16x16x32_bf16 v[144:147], v[28:31], v[212:215], v[144:147]
    v_mfma_f32_16x16x32_bf16 v[148:151], v[26:29], v[212:215], v[148:151]
    s_waitcnt vmcnt(4)
    v_mfma_f32_16x16x32_bf16 v[152:155], v[28:31], v[220:223], v[152:155]
    v_mfma_f32_16x16x32_bf16 v[156:159], v[26:29], v[220:223], v[156:159]
    s_waitcnt vmcnt(3)
    v_mfma_f32_16x16x32_bf16 v[128:131], v[28:31], v[228:231], v[128:131]
    v_mfma_f32_16x16x32_bf16 v[132:135], v[26:29], v[228:231], v[132:135]
    s_waitcnt vmcnt(2)
    v_mfma_f32_16x16x32_bf16 v[136:139], v[28:31], v[236:239], v[136:139]
    v_mfma_f32_16x16x32_bf16 v[140:143], v[26:29], v[236:239], v[140:143]
    s_waitcnt vmcnt(1)
    v_mfma_f32_16x16x32_bf16 v[144:147], v[28:31], v[244:247], v[144:147]
    v_mfma_f32_16x16x32_bf16 v[148:151], v[26:29], v[244:247], v[148:151]
    s_waitcnt vmcnt(0)
    v_mfma_f32_16x16x32_bf16 v[152:155], v[28:31], v[252:255], v[152:155]
    v_mfma_f32_16x16x32_bf16 v[156:159], v[26:29], v[252:255], v[156:159]
    v_pk_mul_f32 v[34:35], v[128:129], s[14:15]
    v_pk_mul_f32 v[36:37], v[130:131], s[14:15]
    v_pk_mul_f32 v[38:39], v[132:133], s[14:15]
    v_pk_mul_f32 v[40:41], v[134:135], s[14:15]
    v_exp_f32 v34, v34
    v_exp_f32 v35, v35
    v_exp_f32 v36, v36
    v_exp_f32 v37, v37
    v_exp_f32 v38, v38
    v_exp_f32 v39, v39
    v_exp_f32 v40, v40
    v_exp_f32 v41, v41
    v_pk_mul_f32 v[96:97], v[96:97], v[128:129]
    v_pk_mul_f32 v[98:99], v[98:99], v[130:131]
    v_pk_mul_f32 v[100:101], v[100:101], v[132:133]
    v_pk_mul_f32 v[102:103], v[102:103], v[134:135]
    v_pk_add_f32 v[34:35], v[34:35], 1.0 op_sel_hi:[1,0]
    v_pk_add_f32 v[36:37], v[36:37], 1.0 op_sel_hi:[1,0]
    v_pk_add_f32 v[38:39], v[38:39], 1.0 op_sel_hi:[1,0]
    v_pk_add_f32 v[40:41], v[40:41], 1.0 op_sel_hi:[1,0]
    v_rcp_f32 v34, v34
    v_rcp_f32 v35, v35
    v_rcp_f32 v36, v36
    v_rcp_f32 v37, v37
    v_rcp_f32 v38, v38
    v_rcp_f32 v39, v39
    v_rcp_f32 v40, v40
    v_rcp_f32 v41, v41
    v_pk_fma_f32 v[96:97], v[96:97], v[34:35], v[64:65]
    v_pk_fma_f32 v[98:99], v[98:99], v[36:37], v[66:67]
    v_pk_fma_f32 v[100:101], v[100:101], v[38:39], v[68:69]
    v_pk_fma_f32 v[102:103], v[102:103], v[40:41], v[70:71]
    v_cvt_pk_bf16_f32 v96, v96, v97
    v_cvt_pk_bf16_f32 v97, v98, v99
    v_cvt_pk_bf16_f32 v98, v100, v101
    v_cvt_pk_bf16_f32 v99, v102, v103
    s_nop 0
    v_permlane16_swap_b32 v96, v98
    v_permlane16_swap_b32 v97, v99
    global_store_dwordx4 v2, v[96:99], s[22:23] offset:0 sc1
    v_pk_mul_f32 v[34:35], v[136:137], s[14:15]
    v_pk_mul_f32 v[36:37], v[138:139], s[14:15]
    v_pk_mul_f32 v[38:39], v[140:141], s[14:15]
    v_pk_mul_f32 v[40:41], v[142:143], s[14:15]
    v_exp_f32 v34, v34
    v_exp_f32 v35, v35
    v_exp_f32 v36, v36
    v_exp_f32 v37, v37
    v_exp_f32 v38, v38
    v_exp_f32 v39, v39
    v_exp_f32 v40, v40
    v_exp_f32 v41, v41
    v_pk_mul_f32 v[104:105], v[104:105], v[136:137]
    v_pk_mul_f32 v[106:107], v[106:107], v[138:139]
    v_pk_mul_f32 v[108:109], v[108:109], v[140:141]
    v_pk_mul_f32 v[110:111], v[110:111], v[142:143]
    v_pk_add_f32 v[34:35], v[34:35], 1.0 op_sel_hi:[1,0]
    v_pk_add_f32 v[36:37], v[36:37], 1.0 op_sel_hi:[1,0]
    v_pk_add_f32 v[38:39], v[38:39], 1.0 op_sel_hi:[1,0]
    v_pk_add_f32 v[40:41], v[40:41], 1.0 op_sel_hi:[1,0]
    v_rcp_f32 v34, v34
    v_rcp_f32 v35, v35
    v_rcp_f32 v36, v36
    v_rcp_f32 v37, v37
    v_rcp_f32 v38, v38
    v_rcp_f32 v39, v39
    v_rcp_f32 v40, v40
    v_rcp_f32 v41, v41
    v_pk_fma_f32 v[104:105], v[104:105], v[34:35], v[72:73]
    v_pk_fma_f32 v[106:107], v[106:107], v[36:37], v[74:75]
    v_pk_fma_f32 v[108:109], v[108:109], v[38:39], v[76:77]
    v_pk_fma_f32 v[110:111], v[110:111], v[40:41], v[78:79]
    v_cvt_pk_bf16_f32 v104, v104, v105
    v_cvt_pk_bf16_f32 v105, v106, v107
    v_cvt_pk_bf16_f32 v106, v108, v109
    v_cvt_pk_bf16_f32 v107, v110, v111
    s_nop 0
    v_permlane16_swap_b32 v104, v106
    v_permlane16_swap_b32 v105, v107
    global_store_dwordx4 v2, v[104:107], s[22:23] offset:64 sc1
    v_pk_mul_f32 v[34:35], v[144:145], s[14:15]
    v_pk_mul_f32 v[36:37], v[146:147], s[14:15]
    v_pk_mul_f32 v[38:39], v[148:149], s[14:15]
    v_pk_mul_f32 v[40:41], v[150:151], s[14:15]
    v_exp_f32 v34, v34
    v_exp_f32 v35, v35
    v_exp_f32 v36, v36
    v_exp_f32 v37, v37
    v_exp_f32 v38, v38
    v_exp_f32 v39, v39
    v_exp_f32 v40, v40
    v_exp_f32 v41, v41
    v_pk_mul_f32 v[112:113], v[112:113], v[144:145]
    v_pk_mul_f32 v[114:115], v[114:115], v[146:147]
    v_pk_mul_f32 v[116:117], v[116:117], v[148:149]
    v_pk_mul_f32 v[118:119], v[118:119], v[150:151]
    v_pk_add_f32 v[34:35], v[34:35], 1.0 op_sel_hi:[1,0]
    v_pk_add_f32 v[36:37], v[36:37], 1.0 op_sel_hi:[1,0]
    v_pk_add_f32 v[38:39], v[38:39], 1.0 op_sel_hi:[1,0]
    v_pk_add_f32 v[40:41], v[40:41], 1.0 op_sel_hi:[1,0]
    v_rcp_f32 v34, v34
    v_rcp_f32 v35, v35
    v_rcp_f32 v36, v36
    v_rcp_f32 v37, v37
    v_rcp_f32 v38, v38
    v_rcp_f32 v39, v39
    v_rcp_f32 v40, v40
    v_rcp_f32 v41, v41
    v_pk_fma_f32 v[112:113], v[112:113], v[34:35], v[80:81]
    v_pk_fma_f32 v[114:115], v[114:115], v[36:37], v[82:83]
    v_pk_fma_f32 v[116:117], v[116:117], v[38:39], v[84:85]
    v_pk_fma_f32 v[118:119], v[118:119], v[40:41], v[86:87]
    v_cvt_pk_bf16_f32 v112, v112, v113
    v_cvt_pk_bf16_f32 v113, v114, v115
    v_cvt_pk_bf16_f32 v114, v116, v117
    v_cvt_pk_bf16_f32 v115, v118, v119
    s_nop 0
    v_permlane16_swap_b32 v112, v114
    v_permlane16_swap_b32 v113, v115
    global_store_dwordx4 v2, v[112:115], s[22:23] offset:128 sc1
    v_pk_mul_f32 v[34:35], v[152:153], s[14:15]
    v_pk_mul_f32 v[36:37], v[154:155], s[14:15]
    v_pk_mul_f32 v[38:39], v[156:157], s[14:15]
    v_pk_mul_f32 v[40:41], v[158:159], s[14:15]
    v_exp_f32 v34, v34
    v_exp_f32 v35, v35
    v_exp_f32 v36, v36
    v_exp_f32 v37, v37
    v_exp_f32 v38, v38
    v_exp_f32 v39, v39
    v_exp_f32 v40, v40
    v_exp_f32 v41, v41
    v_pk_mul_f32 v[120:121], v[120:121], v[152:153]
    v_pk_mul_f32 v[122:123], v[122:123], v[154:155]
    v_pk_mul_f32 v[124:125], v[124:125], v[156:157]
    v_pk_mul_f32 v[126:127], v[126:127], v[158:159]
    v_pk_add_f32 v[34:35], v[34:35], 1.0 op_sel_hi:[1,0]
    v_pk_add_f32 v[36:37], v[36:37], 1.0 op_sel_hi:[1,0]
    v_pk_add_f32 v[38:39], v[38:39], 1.0 op_sel_hi:[1,0]
    v_pk_add_f32 v[40:41], v[40:41], 1.0 op_sel_hi:[1,0]
    v_rcp_f32 v34, v34
    v_rcp_f32 v35, v35
    v_rcp_f32 v36, v36
    v_rcp_f32 v37, v37
    v_rcp_f32 v38, v38
    v_rcp_f32 v39, v39
    v_rcp_f32 v40, v40
    v_rcp_f32 v41, v41
    v_pk_fma_f32 v[120:121], v[120:121], v[34:35], v[88:89]
    v_pk_fma_f32 v[122:123], v[122:123], v[36:37], v[90:91]
    v_pk_fma_f32 v[124:125], v[124:125], v[38:39], v[92:93]
    v_pk_fma_f32 v[126:127], v[126:127], v[40:41], v[94:95]
    v_cvt_pk_bf16_f32 v120, v120, v121
    v_cvt_pk_bf16_f32 v121, v122, v123
    v_cvt_pk_bf16_f32 v122, v124, v125
    v_cvt_pk_bf16_f32 v123, v126, v127
    s_nop 0
    v_permlane16_swap_b32 v120, v122
    v_permlane16_swap_b32 v121, v123
    global_store_dwordx4 v2, v[120:123], s[22:23] offset:192 sc1
L_end:
    s_endpgm
L_spB:
    buffer_load_dword v43, off, s[56:59], s92 sc1
    s_waitcnt vmcnt(0)
    v_readfirstlane_b32 s86, v43
    s_bfe_u32 s86, s86, 0x80008
    s_cmp_eq_u32 s86, 16
    s_cbranch_scc1 L_okB
    s_add_u32 s67, s67, 1
    s_cmp_lt_u32 s67, 0x40000
    s_cbranch_scc1 L_spB
    s_branch L_okB
L_spC:
    buffer_load_dword v43, off, s[56:59], s92 sc1
    s_waitcnt vmcnt(0)
    v_readfirstlane_b32 s86, v43
    s_bfe_u32 s86, s86, 0x80010
    s_cmp_eq_u32 s86, 16
    s_cbranch_scc1 L_okC
    s_add_u32 s67, s67, 1
    s_cmp_lt_u32 s67, 0x40000
    s_cbranch_scc1 L_spC
    s_branch L_okC
L_spO:
    buffer_load_dword v43, off, s[56:59], s76 sc1
    s_waitcnt vmcnt(0)
    v_readfirstlane_b32 s86, v43
    s_cmp_eq_u32 s86, 64
    s_cbranch_scc1 L_okO
    s_add_u32 s67, s67, 1
    s_cmp_lt_u32 s67, 0x40000
    s_cbranch_scc1 L_spO
    s_branch L_okO
L_spP:
    buffer_load_dword v43, off, s[56:59], s77 sc1
    s_waitcnt vmcnt(0)
    v_readfirstlane_b32 s86, v43
    s_cmp_eq_u32 s86, 4
    s_cbranch_scc1 L_okP
    s_add_u32 s67, s67, 1
    s_cmp_lt_u32 s67, 0x40000
    s_cbranch_scc1 L_spP
    s_branch L_okP
L_code_end:
.section .rodata,"a"
.p2align 6
.amdhsa_kernel recurrent_scan__sliding_local_dilated__glu_gated_geglu__prompt_kernel
  .amdhsa_next_free_vgpr 512
  .amdhsa_next_free_sgpr 102
  .amdhsa_accum_offset 256
  .amdhsa_group_segment_fixed_size 0
  .amdhsa_kernarg_size 80
  .amdhsa_user_sgpr_count 2
  .amdhsa_user_sgpr_kernarg_segment_ptr 1
  .amdhsa_system_sgpr_workgroup_id_x 1
.end_amdhsa_kernel
```

```asm
; @launch grid=(256,1,1) block=(256,1,1) lds=163840
.amdgcn_target "amdgcn-amd-amdhsa--gfx950"
.text
.p2align 8
.globl recurrent_scan__sliding_local_dilated__glu_gated_geglu__prompt_kernel
.type recurrent_scan__sliding_local_dilated__glu_gated_geglu__prompt_kernel,@function
recurrent_scan__sliding_local_dilated__glu_gated_geglu__prompt_kernel:
    s_cmp_ge_u32 s2, 256
    s_cbranch_scc1 L_end
    s_load_dwordx16 s[8:23], s[0:1], 0
    s_load_dwordx4 s[24:27], s[0:1], 64
    v_lshrrev_b32 v1, 6, v0
    v_and_b32 v0, 63, v0
    v_readfirstlane_b32 s60, v1
    s_getpc_b64 s[86:87]
L_pc:
    s_lshr_b32 s82, s2, 3
    s_lshl_b32 s82, s82, 2
    s_add_u32 s82, s82, s60
    s_lshl_b32 s82, s82, 10
    v_lshl_add_u32 v2, v0, 4, s82
    v_min_u32 v2, L_code_end-L_pc-4, v2
    global_load_dword v7, v2, s[86:87]
    s_and_b32 s82, s2, 7
    s_lshr_b32 s83, s2, 3
    s_lshr_b32 s65, s82, 1
    s_and_b32 s63, s82, 1
    s_lshl_b32 s63, s63, 2
    s_and_b32 s84, s83, 3
    s_add_u32 s63, s63, s84
    s_lshr_b32 s66, s83, 2
    s_lshl_b32 s64, s65, 3
    s_add_u32 s64, s64, s66
    s_lshr_b32 s61, s60, 1
    s_and_b32 s62, s60, 1
    v_lshlrev_b32 v16, 4, v0
    s_lshl_b32 s84, s64, 2
    s_add_u32 s84, s84, s60
    s_lshl_b32 s85, s63, 7
    s_add_u32 s84, s84, s85
    s_lshl_b32 s85, s84, 12
    v_add_u32 v36, s85, v16
    s_lshl_b32 s84, s84, 2
    s_add_u32 s84, s84, 39845888
    v_mov_b32 v37, s84
    s_waitcnt lgkmcnt(0)
    global_load_dwordx4 v[48:51], v36, s[8:9] offset:0 nt
    global_load_dwordx4 v[52:55], v36, s[8:9] offset:1024 nt
    global_load_dwordx4 v[56:59], v36, s[8:9] offset:2048 nt
    global_load_dwordx4 v[60:63], v36, s[8:9] offset:3072 nt
    s_lshl_b32 s84, s63, 9
    s_lshl_b32 s85, s61, 8
    s_add_u32 s85, s85, s84
    s_sub_u32 s84, s84, 32
    s_max_i32 s84, s84, 0
    s_cmp_eq_u32 s62, 0
    s_cselect_b32 s85, s85, s84
    s_cselect_b32 s84, 63, 7
    s_add_u32 s85, s85, 39845888
    v_and_b32 v38, s84, v0
    v_lshlrev_b32 v38, 2, v38
    v_add_u32 v38, s85, v38
    global_load_dword v39, v38, s[26:27] sc1
    global_load_dword v40, v37, s[26:27] sc1
    v_lshlrev_b32 v2, 6, v0
    v_sub_u32 v2, v2, v16
    v_add_u32 v2, v2, v36
    s_sub_u32 s84, s63, s62
    s_max_i32 s84, s84, 0
    s_lshl_b32 s84, s84, 5
    v_mov_b32 v41, s84
    s_mov_b32 s56, s26
    s_and_b32 s57, s27, 0xffff
    s_mov_b32 s58, 0x10000000
    s_mov_b32 s59, 0x20000
    s_lshl_b32 s84, s63, 2
    s_add_u32 s84, s84, s65
    s_lshl_b32 s92, s84, 8
    s_add_u32 s92, s92, 39849984
    s_mul_i32 s88, s84, 458752
    s_add_u32 s88, s88, 8388608
    s_lshl_b32 s93, s63, 8
    s_add_u32 s93, s93, 39858176
    s_cmp_lg_u32 s60, 3
    s_cbranch_scc1 L_nozero
    s_lshl_b32 s84, s63, 3
    s_add_u32 s84, s84, s66
    s_lshl_b32 s84, s84, 2
    s_add_u32 s84, s84, s65
    s_lshl_b32 s84, s84, 8
    s_add_u32 s84, s84, 39862272
    v_mov_b32 v2, s84
    v_writelane_b32 v2, s92, 1
    v_writelane_b32 v2, s93, 2
    s_cmp_eq_u32 s66, 0
    s_cselect_b32 s84, 3, 1
    s_cmp_eq_u32 s64, 0
    s_cselect_b32 s84, 7, s84
    v_mov_b32 v3, 0
    s_mov_b32 exec_hi, 0
    s_mov_b32 exec_lo, s84
    global_store_dword v2, v3, s[26:27] sc1
    s_mov_b64 exec, -1
L_nozero:
    v_lshrrev_b32 v20, 2, v0
    v_and_b32 v21, 3, v0
    v_lshrrev_b32 v22, 4, v0
    v_and_b32 v23, 15, v0
    v_lshrrev_b32 v24, 3, v20
    v_lshlrev_b32 v24, 1, v24
    v_xor_b32 v24, v21, v24
    v_mul_u32_u24 v2, 6144, v20
    v_lshl_add_u32 v2, v24, 4, v2
    v_mul_u32_u24 v25, 7168, v20
    v_lshl_add_u32 v3, v24, 4, v25
    s_mul_i32 s84, s61, 98304
    s_lshl_b32 s85, s64, 6
    s_add_u32 s84, s84, s85
    s_add_u32 s32, s10, s84
    s_addc_u32 s33, s11, 0
    s_sub_u32 s32, s32, 4096
    s_subb_u32 s33, s33, 0
    s_and_b32 s33, s33, 0xffff
    s_sub_u32 s34, 6295552, s84
    s_mov_b32 s35, 0x20000
    s_mul_i32 s84, s61, 114688
    s_mul_i32 s85, s64, 224
    s_add_u32 s84, s84, s85
    s_add_u32 s36, s16, s84
    s_addc_u32 s37, s17, 0
    s_sub_u32 s36, s36, 4096
    s_subb_u32 s37, s37, 0
    s_and_b32 s37, s37, 0xffff
    s_sub_u32 s38, 7344128, s84
    s_mov_b32 s39, 0x20000
    s_add_u32 s40, s18, s84
    s_addc_u32 s41, s19, 0
    s_sub_u32 s40, s40, 4096
    s_subb_u32 s41, s41, 0
    s_and_b32 s41, s41, 0xffff
    s_sub_u32 s42, 7344128, s84
    s_mov_b32 s43, 0x20000
    v_cmp_lt_u32 vcc, 1, v24
    v_and_b32 v24, 1, v24
    v_lshl_add_u32 v24, v24, 4, v25
    v_add_u32 v24, 3264, v24
    v_mov_b32 v25, 0
    s_add_u32 s82, s16, s84
    s_addc_u32 s83, s17, 0
    s_sub_u32 s82, s82, 4096
    s_subb_u32 s83, s83, 0
    v_lshl_add_u64 v[4:5], v[24:25], 0, s[82:83]
    s_add_u32 s82, s18, s84
    s_addc_u32 s83, s19, 0
    s_sub_u32 s82, s82, 4096
    s_subb_u32 s83, s83, 0
    v_lshl_add_u64 v[24:25], v[24:25], 0, s[82:83]
    v_cndmask_b32 v4, v4, v24, vcc
    v_cndmask_b32 v5, v5, v25, vcc
    s_mov_b32 s80, 229376
    s_mov_b32 s81, 0
    s_cmp_eq_u32 s62, 1
    s_cbranch_scc1 L_init1
    s_lshl_b32 s78, s61, 14
    s_mov_b32 s68, 4096
    s_mov_b32 s69, 19456
    s_mov_b32 s70, 34816
    s_mov_b32 s71, 50176
    s_mov_b32 s72, 69632
    s_mov_b32 s73, 84992
    s_mov_b32 s74, 100352
    s_mov_b32 s75, 115712
    s_lshl_b32 s84, s63, 1
    s_add_u32 s84, s84, s61
    s_lshl_b32 s84, s84, 18
    s_branch L_init2
L_init1:
    s_mul_i32 s78, s61, 10240
    s_add_u32 s78, s78, 69632
    s_mov_b32 s68, 6144
    s_mov_b32 s69, 7168
    s_mov_b32 s70, 2048
    s_mov_b32 s71, 1024
    s_mov_b32 s72, 4096
    s_mov_b32 s73, 3136
    s_mov_b32 s74, 2112
    s_mov_b32 s75, 1152
    s_mov_b32 s76, 4224
    s_mov_b32 s14, 151552
    s_cmp_eq_u32 s61, 0
    s_cselect_b32 s15, 67584, s14
    s_cselect_b32 s14, 32768, s14
    s_lshl_b32 s84, s63, 19
    s_sub_u32 s84, s84, 32768
    s_max_i32 s84, s84, 0
L_init2:
    s_add_u32 s28, s26, s84
    s_addc_u32 s29, s27, 0
    s_sub_u32 s28, s28, 4096
    s_subb_u32 s29, s29, 0
    s_and_b32 s29, s29, 0xffff
    s_sub_u32 s30, 4198400, s84
    s_mov_b32 s31, 0x20000
    v_lshrrev_b32 v24, 3, v0
    v_and_b32 v25, 6, v24
    v_and_b32 v1, 7, v0
    v_xor_b32 v25, v25, v1
    v_lshlrev_b32 v25, 4, v25
    v_lshl_add_u32 v1, v24, 11, v25
    s_cmp_eq_u32 s63, 0
    s_cselect_b32 s84, 1, 3
    s_and_b32 s85, s60, s84
    s_cmp_eq_u32 s85, s84
    s_cselect_b32 s85, 0x40000000, 0
    s_cselect_b32 s87, 1, 0
    v_add_u32 v1, s85, v1
    s_lshr_b32 s83, s2, 3
    v_lshrrev_b32 v24, 3, v0
    v_and_b32 v25, 7, v0
    s_lshr_b32 s84, s63, 2
    s_lshl_b32 s84, s84, 4
    s_lshr_b32 s85, s83, 1
    s_add_u32 s84, s84, s85
    s_and_b32 s83, s83, 1
    s_cmp_eq_u32 s60, 0
    s_cbranch_scc1 L_pf0
    s_cmp_eq_u32 s60, 1
    s_cselect_b32 s44, s16, s18
    s_cselect_b32 s45, s17, s19
    s_cmp_eq_u32 s60, 3
    s_cselect_b32 s46, 0, 7340032
    s_mov_b32 s79, 229376
    s_mul_i32 s84, s84, 7168
    s_lshl_b32 s85, s65, 1
    s_add_u32 s85, s85, s83
    s_mul_i32 s85, s85, 896
    s_add_u32 s84, s84, s85
    v_cmp_gt_u32 vcc, 7, v25
    v_lshlrev_b32 v25, 7, v25
    s_branch L_pfd
L_pf0:
    s_mov_b32 s44, s10
    s_mov_b32 s45, s11
    s_mov_b32 s46, 6291456
    s_mov_b32 s79, 196608
    s_mul_i32 s84, s84, 6144
    s_lshl_b32 s85, s65, 1
    s_add_u32 s85, s85, s83
    s_lshl_b32 s85, s85, 8
    s_add_u32 s84, s84, s85
    v_cmp_gt_u32 vcc, 6, v25
    v_and_b32 v6, 1, v25
    v_lshrrev_b32 v25, 1, v25
    v_lshlrev_b32 v25, 11, v25
    v_lshl_add_u32 v25, v6, 7, v25
L_pfd:
    v_add_u32 v25, s84, v25
    v_mov_b32 v6, 0x40000000
    v_cndmask_b32 v25, v6, v25, vcc
    v_mul_lo_u32 v42, v24, s79
    v_add_u32 v42, v42, v25
    v_cmp_gt_u32 vcc, 2, v24
    s_nop 1
    v_cndmask_b32 v6, v6, v42, vcc
    s_mul_i32 s84, s79, 8
    v_add_u32 v6, s84, v6
    s_lshl_b32 s86, s79, 3
    s_mul_i32 s79, s79, 2
    s_lshr_b32 s84, s2, 3
    s_and_b32 s84, s84, 0
    s_cmp_eq_u32 s84, 0
    s_cselect_b32 s4, 0, 0x40000000
    s_cmp_lg_u32 s60, 3
    s_cbranch_scc1 L_pf3d
    s_and_b32 s84, s2, 7
    s_lshl_b32 s84, s84, 5
    s_lshr_b32 s85, s2, 3
    s_add_u32 s84, s84, s85
    s_mul_i32 s84, s84, 28672
    s_add_u32 s44, s20, s84
    s_addc_u32 s45, s21, 0
    s_mov_b32 s46, 28672
    s_mov_b32 s79, 0
    v_lshlrev_b32 v6, 7, v0
    v_subrev_u32 v6, 0, v6
    v_mov_b32 v42, 0x40000000
    v_cmp_gt_u32 vcc, 0, v0
    s_nop 1
    v_cndmask_b32 v6, v42, v6, vcc
L_pf3d:
    s_and_b32 s45, s45, 0xffff
    s_mov_b32 s47, 0x20000
    v_and_b32 v24, 6, v23
    v_xor_b32 v24, v24, v22
    v_lshlrev_b32 v24, 4, v24
    v_lshl_add_u32 v24, v23, 7, v24
    v_xor_b32 v25, 64, v24
    s_lshl_b32 s84, s61, 14
    v_add_u32 v8, s84, v24
    v_add_u32 v9, s84, v25
    s_mul_i32 s84, s61, -18432
    s_add_u32 s84, s84, 32768
    v_add_u32 v10, s84, v24
    v_add_u32 v11, s84, v25
    v_lshrrev_b32 v24, 5, v0
    v_mul_u32_u24 v24, 10240, v24
    v_and_b32 v26, 1, v22
    v_bfe_u32 v25, v0, 2, 2
    v_lshl_add_u32 v25, v26, 3, v25
    v_lshl_add_u32 v24, v25, 6, v24
    v_and_b32 v25, 1, v0
    v_lshl_add_u32 v24, v25, 3, v24
    v_bfe_u32 v27, v0, 1, 1
    v_lshlrev_b32 v26, 1, v26
    s_mul_i32 s84, s62, 5120
    s_add_u32 s84, s84, 69632
    v_add_u32 v24, s84, v24
    v_add_u32 v25, 0, v27
    v_xor_b32 v25, v25, v26
    v_lshl_add_u32 v12, v25, 4, v24
    v_add_u32 v13, 40960, v12
    v_add_u32 v25, 2, v27
    v_xor_b32 v25, v25, v26
    v_lshl_add_u32 v14, v25, 4, v24
    v_add_u32 v15, 40960, v14
    v_mov_b32 v28, 0
    v_mov_b32 v29, 0
    v_mov_b32 v30, 0
    v_mov_b32 v31, 0
    s_cmp_eq_u32 s62, 1
    s_cbranch_scc1 L_early1
    s_mov_b64 exec, 0xffffffff
    buffer_load_dword v7, v42, s[44:47], 0 offen
    s_mov_b64 exec, -1
    v_mfma_f32_32x32x16_bf16 a[128:143], v[28:31], v[28:31], 0
    v_mfma_f32_32x32x16_bf16 a[144:159], v[28:31], v[28:31], 0
    v_mfma_f32_32x32x16_bf16 a[160:175], v[28:31], v[28:31], 0
    v_mfma_f32_32x32x16_bf16 a[176:191], v[28:31], v[28:31], 0
    v_mfma_f32_32x32x16_bf16 a[192:207], v[28:31], v[28:31], 0
    v_mfma_f32_32x32x16_bf16 a[208:223], v[28:31], v[28:31], 0
    v_mfma_f32_32x32x16_bf16 a[224:239], v[28:31], v[28:31], 0
    v_mfma_f32_32x32x16_bf16 a[240:255], v[28:31], v[28:31], 0
    v_mfma_f32_32x32x16_bf16 v[128:143], v[28:31], v[28:31], 0
    v_mfma_f32_32x32x16_bf16 v[144:159], v[28:31], v[28:31], 0
    v_mfma_f32_32x32x16_bf16 v[160:175], v[28:31], v[28:31], 0
    v_mfma_f32_32x32x16_bf16 v[176:191], v[28:31], v[28:31], 0
    v_mfma_f32_32x32x16_bf16 v[192:207], v[28:31], v[28:31], 0
    v_mfma_f32_32x32x16_bf16 v[208:223], v[28:31], v[28:31], 0
    v_mfma_f32_32x32x16_bf16 v[224:239], v[28:31], v[28:31], 0
    v_mfma_f32_32x32x16_bf16 v[240:255], v[28:31], v[28:31], 0
    s_waitcnt vmcnt(3)
    s_branch L_ln
L_early1:
    s_mov_b64 exec, 0xffffffff
    buffer_load_dword v7, v42, s[44:47], 0 offen
    s_mov_b64 exec, -1
    v_mfma_f32_32x32x16_bf16 a[128:143], v[28:31], v[28:31], 0
    v_mfma_f32_32x32x16_bf16 a[144:159], v[28:31], v[28:31], 0
    v_mfma_f32_32x32x16_bf16 a[160:175], v[28:31], v[28:31], 0
    v_mfma_f32_32x32x16_bf16 a[176:191], v[28:31], v[28:31], 0
    v_mfma_f32_32x32x16_bf16 a[192:207], v[28:31], v[28:31], 0
    v_mfma_f32_32x32x16_bf16 a[208:223], v[28:31], v[28:31], 0
    v_mfma_f32_32x32x16_bf16 a[224:239], v[28:31], v[28:31], 0
    v_mfma_f32_32x32x16_bf16 a[240:255], v[28:31], v[28:31], 0
    v_mfma_f32_32x32x16_bf16 v[128:143], v[28:31], v[28:31], 0
    v_mfma_f32_32x32x16_bf16 v[144:159], v[28:31], v[28:31], 0
    v_mfma_f32_32x32x16_bf16 v[160:175], v[28:31], v[28:31], 0
    v_mfma_f32_32x32x16_bf16 v[176:191], v[28:31], v[28:31], 0
    v_mfma_f32_32x32x16_bf16 v[192:207], v[28:31], v[28:31], 0
    v_mfma_f32_32x32x16_bf16 v[208:223], v[28:31], v[28:31], 0
    v_mfma_f32_32x32x16_bf16 v[224:239], v[28:31], v[28:31], 0
    v_mfma_f32_32x32x16_bf16 v[240:255], v[28:31], v[28:31], 0
    s_waitcnt vmcnt(3)
L_ln:
    v_lshlrev_b32 v64, 16, v48
    v_and_b32 v65, 0xffff0000, v48
    v_lshlrev_b32 v66, 16, v49
    v_and_b32 v67, 0xffff0000, v49
    v_lshlrev_b32 v68, 16, v50
    v_and_b32 v69, 0xffff0000, v50
    v_lshlrev_b32 v70, 16, v51
    v_and_b32 v71, 0xffff0000, v51
    v_lshlrev_b32 v72, 16, v52
    v_and_b32 v73, 0xffff0000, v52
    v_lshlrev_b32 v74, 16, v53
    v_and_b32 v75, 0xffff0000, v53
    v_lshlrev_b32 v76, 16, v54
    v_and_b32 v77, 0xffff0000, v54
    v_lshlrev_b32 v78, 16, v55
    v_and_b32 v79, 0xffff0000, v55
    v_lshlrev_b32 v80, 16, v56
    v_and_b32 v81, 0xffff0000, v56
    v_lshlrev_b32 v82, 16, v57
    v_and_b32 v83, 0xffff0000, v57
    v_lshlrev_b32 v84, 16, v58
    v_and_b32 v85, 0xffff0000, v58
    v_lshlrev_b32 v86, 16, v59
    v_and_b32 v87, 0xffff0000, v59
    v_lshlrev_b32 v88, 16, v60
    v_and_b32 v89, 0xffff0000, v60
    v_lshlrev_b32 v90, 16, v61
    v_and_b32 v91, 0xffff0000, v61
    v_lshlrev_b32 v92, 16, v62
    v_and_b32 v93, 0xffff0000, v62
    v_lshlrev_b32 v94, 16, v63
    v_and_b32 v95, 0xffff0000, v63
    v_pk_add_f32 v[96:97], v[64:65], v[66:67]
    v_pk_add_f32 v[98:99], v[80:81], v[82:83]
    v_pk_add_f32 v[96:97], v[96:97], v[68:69]
    v_pk_add_f32 v[98:99], v[98:99], v[84:85]
    v_pk_add_f32 v[96:97], v[96:97], v[70:71]
    v_pk_add_f32 v[98:99], v[98:99], v[86:87]
    v_pk_add_f32 v[96:97], v[96:97], v[72:73]
    v_pk_add_f32 v[98:99], v[98:99], v[88:89]
    v_pk_add_f32 v[96:97], v[96:97], v[74:75]
    v_pk_add_f32 v[98:99], v[98:99], v[90:91]
    v_pk_add_f32 v[96:97], v[96:97], v[76:77]
    v_pk_add_f32 v[98:99], v[98:99], v[92:93]
    v_pk_add_f32 v[96:97], v[96:97], v[78:79]
    v_pk_add_f32 v[98:99], v[98:99], v[94:95]
    v_add_f32 v102, v96, v97
    v_add_f32 v103, v98, v99
    s_nop 1
    v_permlane32_swap_b32 v102, v103
    v_add_f32 v102, v102, v103
    v_mov_b32 v100, v102
    s_nop 1
    v_permlane16_swap_b32 v102, v100
    v_add_f32 v102, v102, v100
    s_nop 1
    v_add_f32_dpp v102, v102, v102 quad_perm:[1,0,3,2] row_mask:0xf bank_mask:0xf
    s_nop 1
    v_add_f32_dpp v102, v102, v102 quad_perm:[2,3,0,1] row_mask:0xf bank_mask:0xf
    s_nop 1
    v_add_f32_dpp v102, v102, v102 row_half_mirror row_mask:0xf bank_mask:0xf
    s_nop 1
    v_add_f32_dpp v102, v102, v102 row_mirror row_mask:0xf bank_mask:0xf
    v_mul_f32 v102, 0xba800000, v102
    v_cvt_pk_bf16_f32 v106, v102, v102
    v_lshlrev_b32 v106, 16, v106
    v_mov_b32 v103, v102
    s_nop 1
    v_permlane32_swap_b32 v102, v103
    v_mov_b32 v107, v106
    s_nop 1
    v_permlane32_swap_b32 v106, v107
    v_pk_add_f32 v[108:109], v[64:65], v[102:103] op_sel_hi:[1,0]
    v_pk_add_f32 v[110:111], v[80:81], v[102:103] op_sel:[0,1] op_sel_hi:[1,1]
    v_pk_mul_f32 v[96:97], v[108:109], v[108:109]
    v_pk_mul_f32 v[98:99], v[110:111], v[110:111]
    v_pk_add_f32 v[108:109], v[66:67], v[102:103] op_sel_hi:[1,0]
    v_pk_add_f32 v[110:111], v[82:83], v[102:103] op_sel:[0,1] op_sel_hi:[1,1]
    v_pk_fma_f32 v[96:97], v[108:109], v[108:109], v[96:97]
    v_pk_fma_f32 v[98:99], v[110:111], v[110:111], v[98:99]
    v_pk_add_f32 v[108:109], v[68:69], v[102:103] op_sel_hi:[1,0]
    v_pk_add_f32 v[110:111], v[84:85], v[102:103] op_sel:[0,1] op_sel_hi:[1,1]
    v_pk_fma_f32 v[96:97], v[108:109], v[108:109], v[96:97]
    v_pk_fma_f32 v[98:99], v[110:111], v[110:111], v[98:99]
    v_pk_add_f32 v[108:109], v[70:71], v[102:103] op_sel_hi:[1,0]
    v_pk_add_f32 v[110:111], v[86:87], v[102:103] op_sel:[0,1] op_sel_hi:[1,1]
    v_pk_fma_f32 v[96:97], v[108:109], v[108:109], v[96:97]
    v_pk_fma_f32 v[98:99], v[110:111], v[110:111], v[98:99]
    v_pk_add_f32 v[108:109], v[72:73], v[102:103] op_sel_hi:[1,0]
    v_pk_add_f32 v[110:111], v[88:89], v[102:103] op_sel:[0,1] op_sel_hi:[1,1]
    v_pk_fma_f32 v[96:97], v[108:109], v[108:109], v[96:97]
    v_pk_fma_f32 v[98:99], v[110:111], v[110:111], v[98:99]
    v_pk_add_f32 v[108:109], v[74:75], v[102:103] op_sel_hi:[1,0]
    v_pk_add_f32 v[110:111], v[90:91], v[102:103] op_sel:[0,1] op_sel_hi:[1,1]
    v_pk_fma_f32 v[96:97], v[108:109], v[108:109], v[96:97]
    v_pk_fma_f32 v[98:99], v[110:111], v[110:111], v[98:99]
    v_pk_add_f32 v[108:109], v[76:77], v[102:103] op_sel_hi:[1,0]
    v_pk_add_f32 v[110:111], v[92:93], v[102:103] op_sel:[0,1] op_sel_hi:[1,1]
    v_pk_fma_f32 v[96:97], v[108:109], v[108:109], v[96:97]
    v_pk_fma_f32 v[98:99], v[110:111], v[110:111], v[98:99]
    v_pk_add_f32 v[108:109], v[78:79], v[102:103] op_sel_hi:[1,0]
    v_pk_add_f32 v[110:111], v[94:95], v[102:103] op_sel:[0,1] op_sel_hi:[1,1]
    v_pk_fma_f32 v[96:97], v[108:109], v[108:109], v[96:97]
    v_pk_fma_f32 v[98:99], v[110:111], v[110:111], v[98:99]
    v_add_f32 v104, v96, v97
    v_add_f32 v105, v98, v99
    s_nop 1
    v_permlane32_swap_b32 v104, v105
    v_add_f32 v104, v104, v105
    v_mov_b32 v100, v104
    s_nop 1
    v_permlane16_swap_b32 v104, v100
    v_add_f32 v104, v104, v100
    s_nop 1
    v_add_f32_dpp v104, v104, v104 quad_perm:[1,0,3,2] row_mask:0xf bank_mask:0xf
    s_nop 1
    v_add_f32_dpp v104, v104, v104 quad_perm:[2,3,0,1] row_mask:0xf bank_mask:0xf
    s_nop 1
    v_add_f32_dpp v104, v104, v104 row_half_mirror row_mask:0xf bank_mask:0xf
    s_nop 1
    v_add_f32_dpp v104, v104, v104 row_mirror row_mask:0xf bank_mask:0xf
    v_mul_f32 v104, 0x3a800000, v104
    v_cvt_pk_bf16_f32 v104, v104, v104
    v_lshlrev_b32 v104, 16, v104
    v_add_f32 v104, 0x3727c5ac, v104
    v_cvt_pk_bf16_f32 v104, v104, v104
    v_lshlrev_b32 v104, 16, v104
    v_sqrt_f32 v104, v104
    s_nop 0
    v_cvt_pk_bf16_f32 v104, v104, v104
    v_lshlrev_b32 v104, 16, v104
    v_rcp_f32 v100, v104
    s_nop 0
    v_fma_f32 v104, -v104, v100, 1.0
    v_fma_f32 v104, v104, v100, v100
    v_mov_b32 v105, v104
    s_nop 1
    v_permlane32_swap_b32 v104, v105
    v_pk_add_f32 v[64:65], v[64:65], v[106:107] op_sel_hi:[1,0]
    v_pk_add_f32 v[66:67], v[66:67], v[106:107] op_sel_hi:[1,0]
    v_pk_add_f32 v[68:69], v[68:69], v[106:107] op_sel_hi:[1,0]
    v_pk_add_f32 v[70:71], v[70:71], v[106:107] op_sel_hi:[1,0]
    v_cvt_pk_bf16_f32 v65, v64, v65
    v_cvt_pk_bf16_f32 v67, v66, v67
    v_cvt_pk_bf16_f32 v69, v68, v69
    v_cvt_pk_bf16_f32 v71, v70, v71
    v_lshlrev_b32 v64, 16, v65
    v_and_b32 v65, 0xffff0000, v65
    v_lshlrev_b32 v66, 16, v67
    v_and_b32 v67, 0xffff0000, v67
    v_lshlrev_b32 v68, 16, v69
    v_and_b32 v69, 0xffff0000, v69
    v_lshlrev_b32 v70, 16, v71
    v_and_b32 v71, 0xffff0000, v71
    v_pk_mul_f32 v[64:65], v[64:65], v[104:105] op_sel_hi:[1,0]
    v_pk_mul_f32 v[66:67], v[66:67], v[104:105] op_sel_hi:[1,0]
    v_pk_mul_f32 v[68:69], v[68:69], v[104:105] op_sel_hi:[1,0]
    v_pk_mul_f32 v[70:71], v[70:71], v[104:105] op_sel_hi:[1,0]
    v_cvt_pk_bf16_f32 v48, v64, v65
    v_cvt_pk_bf16_f32 v49, v66, v67
    v_cvt_pk_bf16_f32 v50, v68, v69
    v_cvt_pk_bf16_f32 v51, v70, v71
    global_store_dwordx4 v36, v[48:51], s[26:27] offset:0 sc1
    v_pk_add_f32 v[72:73], v[72:73], v[106:107] op_sel_hi:[1,0]
    v_pk_add_f32 v[74:75], v[74:75], v[106:107] op_sel_hi:[1,0]
    v_pk_add_f32 v[76:77], v[76:77], v[106:107] op_sel_hi:[1,0]
    v_pk_add_f32 v[78:79], v[78:79], v[106:107] op_sel_hi:[1,0]
    v_cvt_pk_bf16_f32 v73, v72, v73
    v_cvt_pk_bf16_f32 v75, v74, v75
    v_cvt_pk_bf16_f32 v77, v76, v77
    v_cvt_pk_bf16_f32 v79, v78, v79
    v_lshlrev_b32 v72, 16, v73
    v_and_b32 v73, 0xffff0000, v73
    v_lshlrev_b32 v74, 16, v75
    v_and_b32 v75, 0xffff0000, v75
    v_lshlrev_b32 v76, 16, v77
    v_and_b32 v77, 0xffff0000, v77
    v_lshlrev_b32 v78, 16, v79
    v_and_b32 v79, 0xffff0000, v79
    v_pk_mul_f32 v[72:73], v[72:73], v[104:105] op_sel_hi:[1,0]
    v_pk_mul_f32 v[74:75], v[74:75], v[104:105] op_sel_hi:[1,0]
    v_pk_mul_f32 v[76:77], v[76:77], v[104:105] op_sel_hi:[1,0]
    v_pk_mul_f32 v[78:79], v[78:79], v[104:105] op_sel_hi:[1,0]
    v_cvt_pk_bf16_f32 v52, v72, v73
    v_cvt_pk_bf16_f32 v53, v74, v75
    v_cvt_pk_bf16_f32 v54, v76, v77
    v_cvt_pk_bf16_f32 v55, v78, v79
    global_store_dwordx4 v36, v[52:55], s[26:27] offset:1024 sc1
    v_pk_add_f32 v[80:81], v[80:81], v[106:107] op_sel:[0,1] op_sel_hi:[1,1]
    v_pk_add_f32 v[82:83], v[82:83], v[106:107] op_sel:[0,1] op_sel_hi:[1,1]
    v_pk_add_f32 v[84:85], v[84:85], v[106:107] op_sel:[0,1] op_sel_hi:[1,1]
    v_pk_add_f32 v[86:87], v[86:87], v[106:107] op_sel:[0,1] op_sel_hi:[1,1]
    v_cvt_pk_bf16_f32 v81, v80, v81
    v_cvt_pk_bf16_f32 v83, v82, v83
    v_cvt_pk_bf16_f32 v85, v84, v85
    v_cvt_pk_bf16_f32 v87, v86, v87
    v_lshlrev_b32 v80, 16, v81
    v_and_b32 v81, 0xffff0000, v81
    v_lshlrev_b32 v82, 16, v83
    v_and_b32 v83, 0xffff0000, v83
    v_lshlrev_b32 v84, 16, v85
    v_and_b32 v85, 0xffff0000, v85
    v_lshlrev_b32 v86, 16, v87
    v_and_b32 v87, 0xffff0000, v87
    v_pk_mul_f32 v[80:81], v[80:81], v[104:105] op_sel:[0,1] op_sel_hi:[1,1]
    v_pk_mul_f32 v[82:83], v[82:83], v[104:105] op_sel:[0,1] op_sel_hi:[1,1]
    v_pk_mul_f32 v[84:85], v[84:85], v[104:105] op_sel:[0,1] op_sel_hi:[1,1]
    v_pk_mul_f32 v[86:87], v[86:87], v[104:105] op_sel:[0,1] op_sel_hi:[1,1]
    v_cvt_pk_bf16_f32 v56, v80, v81
    v_cvt_pk_bf16_f32 v57, v82, v83
    v_cvt_pk_bf16_f32 v58, v84, v85
    v_cvt_pk_bf16_f32 v59, v86, v87
    global_store_dwordx4 v36, v[56:59], s[26:27] offset:2048 sc1
    v_pk_add_f32 v[88:89], v[88:89], v[106:107] op_sel:[0,1] op_sel_hi:[1,1]
    v_pk_add_f32 v[90:91], v[90:91], v[106:107] op_sel:[0,1] op_sel_hi:[1,1]
    v_pk_add_f32 v[92:93], v[92:93], v[106:107] op_sel:[0,1] op_sel_hi:[1,1]
    v_pk_add_f32 v[94:95], v[94:95], v[106:107] op_sel:[0,1] op_sel_hi:[1,1]
    v_cvt_pk_bf16_f32 v89, v88, v89
    v_cvt_pk_bf16_f32 v91, v90, v91
    v_cvt_pk_bf16_f32 v93, v92, v93
    v_cvt_pk_bf16_f32 v95, v94, v95
    v_lshlrev_b32 v88, 16, v89
    v_and_b32 v89, 0xffff0000, v89
    v_lshlrev_b32 v90, 16, v91
    v_and_b32 v91, 0xffff0000, v91
    v_lshlrev_b32 v92, 16, v93
    v_and_b32 v93, 0xffff0000, v93
    v_lshlrev_b32 v94, 16, v95
    v_and_b32 v95, 0xffff0000, v95
    v_pk_mul_f32 v[88:89], v[88:89], v[104:105] op_sel:[0,1] op_sel_hi:[1,1]
    v_pk_mul_f32 v[90:91], v[90:91], v[104:105] op_sel:[0,1] op_sel_hi:[1,1]
    v_pk_mul_f32 v[92:93], v[92:93], v[104:105] op_sel:[0,1] op_sel_hi:[1,1]
    v_pk_mul_f32 v[94:95], v[94:95], v[104:105] op_sel:[0,1] op_sel_hi:[1,1]
    v_cvt_pk_bf16_f32 v60, v88, v89
    v_cvt_pk_bf16_f32 v61, v90, v91
    v_cvt_pk_bf16_f32 v62, v92, v93
    v_cvt_pk_bf16_f32 v63, v94, v95
    global_store_dwordx4 v36, v[60:63], s[26:27] offset:3072 sc1
    s_waitcnt vmcnt(5)
    v_add_u32 v40, 1, v40
    s_waitcnt vmcnt(0)
    s_mov_b64 exec, 1
    global_store_dword v37, v40, s[26:27] sc1
    s_mov_b64 exec, -1
    buffer_load_dword v7, v42, s[44:47], 0 offen
    v_add_u32_e64 v42, s86, v42
    s_barrier
    v_mfma_f32_32x32x16_bf16 v[48:63], v[28:31], v[28:31], 0
    v_mfma_f32_32x32x16_bf16 v[64:79], v[28:31], v[28:31], 0
    v_mfma_f32_32x32x16_bf16 v[80:95], v[28:31], v[28:31], 0
    v_mfma_f32_32x32x16_bf16 v[96:111], v[28:31], v[28:31], 0
    v_mfma_f32_32x32x16_bf16 v[112:127], v[28:31], v[28:31], 0
    s_mov_b32 s67, 0
    s_cmp_lg_u32 s60, 3
    s_cbranch_scc1 L_noarr
    s_lshl_b32 s84, s63, 5
    v_mov_b32 v20, s84
    v_mov_b32 v21, 1
    s_mov_b64 exec, 1
    global_atomic_add v20, v21, s[24:25] sc1
    s_mov_b64 exec, -1
L_noarr:
    s_cmp_eq_u32 s62, 0
    s_cbranch_scc1 L_now
    s_add_u32 m0, s78, 0
    s_nop 0
    buffer_load_dwordx4 v2, s[32:35], s68 offen offset:0 lds
    buffer_load_dwordx4 v2, s[32:35], s69 offen offset:1024 lds
    buffer_load_dwordx4 v2, s[32:35], s70 offen offset:2048 lds
    v_add_u32 v2, 196608, v2
    buffer_load_dwordx4 v3, s[36:39], s71 offen offset:3072 lds
    s_add_u32 m0, s78, 4096
    s_nop 0
    buffer_load_dwordx4 v3, s[40:43], s72 offen offset:0 lds
    buffer_load_dwordx4 v3, s[36:39], s73 offen offset:1024 lds
    buffer_load_dwordx4 v3, s[40:43], s74 offen offset:2048 lds
    buffer_load_dwordx4 v3, s[36:39], s75 offen offset:3072 lds
    s_add_u32 m0, s78, 8192
    s_nop 0
    buffer_load_dwordx4 v3, s[40:43], s76 offen offset:0 lds
    v_add_u32 v3, 229376, v3
    global_load_lds_dwordx4 v[4:5], off offset:1024
    v_lshl_add_u64 v[4:5], v[4:5], 0, s[80:81]
    s_add_u32 m0, s78, 20480
    s_nop 0
    buffer_load_dwordx4 v2, s[32:35], s68 offen offset:0 lds
    buffer_load_dwordx4 v2, s[32:35], s69 offen offset:1024 lds
    buffer_load_dwordx4 v2, s[32:35], s70 offen offset:2048 lds
    v_add_u32 v2, 196608, v2
    buffer_load_dwordx4 v3, s[36:39], s71 offen offset:3072 lds
    s_add_u32 m0, s78, 24576
    s_nop 0
    buffer_load_dwordx4 v3, s[40:43], s72 offen offset:0 lds
    buffer_load_dwordx4 v3, s[36:39], s73 offen offset:1024 lds
    buffer_load_dwordx4 v3, s[40:43], s74 offen offset:2048 lds
    buffer_load_dwordx4 v3, s[36:39], s75 offen offset:3072 lds
    s_add_u32 m0, s78, 28672
    s_nop 0
    buffer_load_dwordx4 v3, s[40:43], s76 offen offset:0 lds
    v_add_u32 v3, 229376, v3
    global_load_lds_dwordx4 v[4:5], off offset:1024
    v_lshl_add_u64 v[4:5], v[4:5], 0, s[80:81]
L_now:
    s_cmp_eq_u32 s87, 1
    s_cbranch_scc1 L_lnok
L_lnpoll:
    global_load_dword v20, v38, s[26:27] sc1
    s_waitcnt vmcnt(0)
    v_cmp_ne_u32 vcc, v20, v39
    s_cmp_eq_u64 vcc, -1
    s_cbranch_scc1 L_lnok
    s_add_u32 s67, s67, 1
    s_and_b32 s84, s67, 3
    s_cbranch_scc1 L_lnpoll
    global_load_dword v20, v41, s[24:25] sc1
    s_waitcnt vmcnt(0)
    v_readfirstlane_b32 s84, v20
    s_cmp_ge_u32 s84, 32
    s_cbranch_scc1 L_lnok
    s_cmp_lt_u32 s67, 0x40000
    s_cbranch_scc1 L_lnpoll
L_lnok:
    s_cmp_eq_u32 s62, 1
    s_cbranch_scc1 L_g1_1
    v_add_u32 v2, 131072, v1
    s_add_u32 m0, s78, 0
    s_nop 0
    buffer_load_dwordx4 v1, s[28:31], s68 offen offset:0 sc1 lds
    buffer_load_dwordx4 v1, s[28:31], s69 offen offset:1024 sc1 lds
    buffer_load_dwordx4 v1, s[28:31], s70 offen offset:2048 sc1 lds
    buffer_load_dwordx4 v1, s[28:31], s71 offen offset:3072 sc1 lds
    s_add_u32 m0, s78, 4096
    s_nop 0
    buffer_load_dwordx4 v1, s[28:31], s72 offen offset:0 sc1 lds
    buffer_load_dwordx4 v1, s[28:31], s73 offen offset:1024 sc1 lds
    buffer_load_dwordx4 v1, s[28:31], s74 offen offset:2048 sc1 lds
    buffer_load_dwordx4 v1, s[28:31], s75 offen offset:3072 sc1 lds
    v_add_u32 v1, 128, v1
    s_add_u32 m0, s78, 8192
    s_nop 0
    buffer_load_dwordx4 v2, s[28:31], s68 offen offset:0 sc1 lds
    buffer_load_dwordx4 v2, s[28:31], s69 offen offset:1024 sc1 lds
    buffer_load_dwordx4 v2, s[28:31], s70 offen offset:2048 sc1 lds
    buffer_load_dwordx4 v2, s[28:31], s71 offen offset:3072 sc1 lds
    s_add_u32 m0, s78, 12288
    s_nop 0
    buffer_load_dwordx4 v2, s[28:31], s72 offen offset:0 sc1 lds
    buffer_load_dwordx4 v2, s[28:31], s73 offen offset:1024 sc1 lds
    buffer_load_dwordx4 v2, s[28:31], s74 offen offset:2048 sc1 lds
    buffer_load_dwordx4 v2, s[28:31], s75 offen offset:3072 sc1 lds
    v_add_u32 v2, 128, v2
    s_add_u32 m0, s78, 34816
    s_nop 0
    buffer_load_dwordx4 v1, s[28:31], s68 offen offset:0 sc1 lds
    buffer_load_dwordx4 v1, s[28:31], s69 offen offset:1024 sc1 lds
    buffer_load_dwordx4 v1, s[28:31], s70 offen offset:2048 sc1 lds
    buffer_load_dwordx4 v1, s[28:31], s71 offen offset:3072 sc1 lds
    s_add_u32 m0, s78, 38912
    s_nop 0
    buffer_load_dwordx4 v1, s[28:31], s72 offen offset:0 sc1 lds
    buffer_load_dwordx4 v1, s[28:31], s73 offen offset:1024 sc1 lds
    buffer_load_dwordx4 v1, s[28:31], s74 offen offset:2048 sc1 lds
    buffer_load_dwordx4 v1, s[28:31], s75 offen offset:3072 sc1 lds
    v_add_u32 v1, 128, v1
    s_add_u32 m0, s78, 43008
    s_nop 0
    buffer_load_dwordx4 v2, s[28:31], s68 offen offset:0 sc1 lds
    buffer_load_dwordx4 v2, s[28:31], s69 offen offset:1024 sc1 lds
    buffer_load_dwordx4 v2, s[28:31], s70 offen offset:2048 sc1 lds
    buffer_load_dwordx4 v2, s[28:31], s71 offen offset:3072 sc1 lds
    s_add_u32 m0, s78, 47104
    s_nop 0
    buffer_load_dwordx4 v2, s[28:31], s72 offen offset:0 sc1 lds
    buffer_load_dwordx4 v2, s[28:31], s73 offen offset:1024 sc1 lds
    buffer_load_dwordx4 v2, s[28:31], s74 offen offset:2048 sc1 lds
    buffer_load_dwordx4 v2, s[28:31], s75 offen offset:3072 sc1 lds
    v_add_u32 v2, 128, v2
    s_waitcnt vmcnt(16)
    s_barrier
    ds_read_b64_tr_b16 a[64:65], v12 offset:0
    ds_read_b64_tr_b16 a[66:67], v12 offset:256
    ds_read_b64_tr_b16 a[68:69], v14 offset:0
    ds_read_b64_tr_b16 a[70:71], v14 offset:256
    ds_read_b64_tr_b16 a[72:73], v12 offset:1024
    ds_read_b64_tr_b16 a[74:75], v12 offset:1280
    ds_read_b64_tr_b16 a[76:77], v14 offset:1024
    ds_read_b64_tr_b16 a[78:79], v14 offset:1280
    ds_read_b64_tr_b16 a[80:81], v12 offset:2048
    ds_read_b64_tr_b16 a[82:83], v12 offset:2304
    ds_read_b64_tr_b16 a[84:85], v14 offset:2048
    ds_read_b64_tr_b16 a[86:87], v14 offset:2304
    ds_read_b64_tr_b16 a[88:89], v12 offset:3072
    ds_read_b64_tr_b16 a[90:91], v12 offset:3328
    ds_read_b64_tr_b16 a[92:93], v14 offset:3072
    ds_read_b64_tr_b16 a[94:95], v14 offset:3328
    ds_read_b64_tr_b16 a[96:97], v12 offset:4096
    ds_read_b64_tr_b16 a[98:99], v12 offset:4352
    ds_read_b64_tr_b16 a[100:101], v14 offset:4096
    ds_read_b64_tr_b16 a[102:103], v14 offset:4352
    ds_read_b128 a[0:3], v8 offset:0
    ds_read_b128 a[4:7], v8 offset:2048
    ds_read_b128 a[8:11], v8 offset:4096
    ds_read_b128 a[12:15], v8 offset:6144
    ds_read_b128 a[16:19], v8 offset:8192
    ds_read_b128 a[20:23], v8 offset:10240
    ds_read_b128 a[24:27], v8 offset:12288
    ds_read_b128 a[28:31], v8 offset:14336
    ds_read_b128 a[112:115], v10 offset:0
    s_mov_b32 s67, 7
    v_mov_b32 v20, 0x7ff00000
.p2align 3
L_loop0:
    s_waitcnt lgkmcnt(0)
    s_barrier
    v_mfma_f32_16x16x32_bf16 a[128:131], a[64:67], a[0:3], a[128:131]
    buffer_load_dword v7, v6, s[44:47], s4 offen
    v_add_u32_e64 v6, s79, v6
    v_mfma_f32_16x16x32_bf16 a[136:139], a[64:67], a[4:7], a[136:139]
    v_mfma_f32_16x16x32_bf16 a[144:147], a[64:67], a[8:11], a[144:147]
    ds_read_b128 a[32:35], v9 offset:0
    v_mfma_f32_16x16x32_bf16 a[152:155], a[64:67], a[12:15], a[152:155]
    v_mfma_f32_16x16x32_bf16 a[160:163], a[64:67], a[16:19], a[160:163]
    v_mfma_f32_16x16x32_bf16 a[168:171], a[64:67], a[20:23], a[168:171]
    v_mfma_f32_16x16x32_bf16 a[176:179], a[64:67], a[24:27], a[176:179]
    ds_read_b128 a[36:39], v9 offset:2048
    v_mfma_f32_16x16x32_bf16 a[184:187], a[64:67], a[28:31], a[184:187]
    v_mfma_f32_16x16x32_bf16 v[120:123], a[64:67], a[112:115], v[120:123]
    ds_read_b64_tr_b16 a[64:65], v12 offset:20480
    v_mfma_f32_16x16x32_bf16 a[132:135], a[68:71], a[0:3], a[132:135]
    ds_read_b64_tr_b16 a[66:67], v12 offset:20736
    v_mfma_f32_16x16x32_bf16 a[140:143], a[68:71], a[4:7], a[140:143]
    ds_read_b128 a[40:43], v9 offset:4096
    v_mfma_f32_16x16x32_bf16 a[148:151], a[68:71], a[8:11], a[148:151]
    v_mfma_f32_16x16x32_bf16 a[156:159], a[68:71], a[12:15], a[156:159]
    v_mfma_f32_16x16x32_bf16 a[164:167], a[68:71], a[16:19], a[164:167]
    v_mfma_f32_16x16x32_bf16 a[172:175], a[68:71], a[20:23], a[172:175]
    ds_read_b128 a[44:47], v9 offset:6144
    v_mfma_f32_16x16x32_bf16 a[180:183], a[68:71], a[24:27], a[180:183]
    v_mfma_f32_16x16x32_bf16 a[188:191], a[68:71], a[28:31], a[188:191]
    v_mfma_f32_16x16x32_bf16 v[124:127], a[68:71], a[112:115], v[124:127]
    ds_read_b64_tr_b16 a[68:69], v14 offset:20480
    v_mfma_f32_16x16x32_bf16 v[52:55], a[0:3], a[72:75], v[52:55]
    ds_read_b64_tr_b16 a[70:71], v14 offset:20736
    v_mfma_f32_16x16x32_bf16 v[56:59], a[4:7], a[72:75], v[56:59]
    v_mfma_f32_16x16x32_bf16 v[60:63], a[8:11], a[72:75], v[60:63]
    ds_read_b128 a[48:51], v9 offset:8192
    v_mfma_f32_16x16x32_bf16 v[64:67], a[12:15], a[72:75], v[64:67]
    v_mfma_f32_16x16x32_bf16 v[68:71], a[16:19], a[72:75], v[68:71]
    ds_read_b128 a[52:55], v9 offset:10240
    v_mfma_f32_16x16x32_bf16 v[72:75], a[20:23], a[72:75], v[72:75]
    v_mfma_f32_16x16x32_bf16 v[76:79], a[24:27], a[72:75], v[76:79]
    v_mfma_f32_16x16x32_bf16 v[80:83], a[28:31], a[72:75], v[80:83]
    v_mfma_f32_16x16x32_bf16 v[48:51], a[112:115], a[72:75], v[48:51]
    ds_read_b64_tr_b16 a[72:73], v12 offset:21504
    v_mfma_f32_16x16x32_bf16 v[88:91], a[0:3], a[76:79], v[88:91]
    ds_read_b64_tr_b16 a[74:75], v12 offset:21760
    v_mfma_f32_16x16x32_bf16 v[92:95], a[4:7], a[76:79], v[92:95]
    ds_read_b128 a[56:59], v9 offset:12288
    v_mfma_f32_16x16x32_bf16 v[96:99], a[8:11], a[76:79], v[96:99]
    v_mfma_f32_16x16x32_bf16 v[100:103], a[12:15], a[76:79], v[100:103]
    ds_read_b128 a[60:63], v9 offset:14336
    v_mfma_f32_16x16x32_bf16 v[104:107], a[16:19], a[76:79], v[104:107]
    v_mfma_f32_16x16x32_bf16 v[108:111], a[20:23], a[76:79], v[108:111]
    v_mfma_f32_16x16x32_bf16 v[112:115], a[24:27], a[76:79], v[112:115]
    v_mfma_f32_16x16x32_bf16 v[116:119], a[28:31], a[76:79], v[116:119]
    ds_read_b128 a[116:119], v11 offset:0
    v_mfma_f32_16x16x32_bf16 v[84:87], a[112:115], a[76:79], v[84:87]
    ds_read_b64_tr_b16 a[76:77], v14 offset:21504
    v_mfma_f32_16x16x32_bf16 a[192:195], a[80:83], a[0:3], a[192:195]
    ds_read_b64_tr_b16 a[78:79], v14 offset:21760
    v_mfma_f32_16x16x32_bf16 a[200:203], a[80:83], a[4:7], a[200:203]
    v_mfma_f32_16x16x32_bf16 a[208:211], a[80:83], a[8:11], a[208:211]
    ds_read_b64_tr_b16 a[104:105], v12 offset:24576
    v_mfma_f32_16x16x32_bf16 a[216:219], a[80:83], a[12:15], a[216:219]
    v_mfma_f32_16x16x32_bf16 a[224:227], a[80:83], a[16:19], a[224:227]
    v_mfma_f32_16x16x32_bf16 a[232:235], a[80:83], a[20:23], a[232:235]
    v_mfma_f32_16x16x32_bf16 a[240:243], a[80:83], a[24:27], a[240:243]
    ds_read_b64_tr_b16 a[106:107], v12 offset:24832
    v_mfma_f32_16x16x32_bf16 a[248:251], a[80:83], a[28:31], a[248:251]
    ds_read_b64_tr_b16 a[80:81], v12 offset:22528
    v_mfma_f32_16x16x32_bf16 a[196:199], a[84:87], a[0:3], a[196:199]
    ds_read_b64_tr_b16 a[82:83], v12 offset:22784
    v_mfma_f32_16x16x32_bf16 a[204:207], a[84:87], a[4:7], a[204:207]
    v_mfma_f32_16x16x32_bf16 a[212:215], a[84:87], a[8:11], a[212:215]
    ds_read_b64_tr_b16 a[108:109], v14 offset:24576
    v_mfma_f32_16x16x32_bf16 a[220:223], a[84:87], a[12:15], a[220:223]
    v_mfma_f32_16x16x32_bf16 a[228:231], a[84:87], a[16:19], a[228:231]
    v_mfma_f32_16x16x32_bf16 a[236:239], a[84:87], a[20:23], a[236:239]
    v_mfma_f32_16x16x32_bf16 a[244:247], a[84:87], a[24:27], a[244:247]
    ds_read_b64_tr_b16 a[110:111], v14 offset:24832
    v_mfma_f32_16x16x32_bf16 a[252:255], a[84:87], a[28:31], a[252:255]
    ds_read_b64_tr_b16 a[84:85], v14 offset:22528
    v_mfma_f32_16x16x32_bf16 v[128:131], a[88:91], a[0:3], v[128:131]
    ds_read_b64_tr_b16 a[86:87], v14 offset:22784
    v_mfma_f32_16x16x32_bf16 v[144:147], a[88:91], a[4:7], v[144:147]
    v_mfma_f32_16x16x32_bf16 v[160:163], a[88:91], a[8:11], v[160:163]
    v_mfma_f32_16x16x32_bf16 v[176:179], a[88:91], a[12:15], v[176:179]
    v_mfma_f32_16x16x32_bf16 v[192:195], a[88:91], a[16:19], v[192:195]
    v_mfma_f32_16x16x32_bf16 v[208:211], a[88:91], a[20:23], v[208:211]
    v_mfma_f32_16x16x32_bf16 v[224:227], a[88:91], a[24:27], v[224:227]
    v_mfma_f32_16x16x32_bf16 v[240:243], a[88:91], a[28:31], v[240:243]
    ds_read_b64_tr_b16 a[88:89], v12 offset:23552
    v_mfma_f32_16x16x32_bf16 v[132:135], a[92:95], a[0:3], v[132:135]
    ds_read_b64_tr_b16 a[90:91], v12 offset:23808
    v_mfma_f32_16x16x32_bf16 v[148:151], a[92:95], a[4:7], v[148:151]
    v_mfma_f32_16x16x32_bf16 v[164:167], a[92:95], a[8:11], v[164:167]
    v_mfma_f32_16x16x32_bf16 v[180:183], a[92:95], a[12:15], v[180:183]
    v_mfma_f32_16x16x32_bf16 v[196:199], a[92:95], a[16:19], v[196:199]
    v_mfma_f32_16x16x32_bf16 v[212:215], a[92:95], a[20:23], v[212:215]
    v_mfma_f32_16x16x32_bf16 v[228:231], a[92:95], a[24:27], v[228:231]
    v_mfma_f32_16x16x32_bf16 v[244:247], a[92:95], a[28:31], v[244:247]
    ds_read_b64_tr_b16 a[92:93], v14 offset:23552
    v_mfma_f32_16x16x32_bf16 v[136:139], a[96:99], a[0:3], v[136:139]
    ds_read_b64_tr_b16 a[94:95], v14 offset:23808
    v_mfma_f32_16x16x32_bf16 v[152:155], a[96:99], a[4:7], v[152:155]
    v_mfma_f32_16x16x32_bf16 v[168:171], a[96:99], a[8:11], v[168:171]
    v_mfma_f32_16x16x32_bf16 v[184:187], a[96:99], a[12:15], v[184:187]
    v_mfma_f32_16x16x32_bf16 v[200:203], a[96:99], a[16:19], v[200:203]
    v_mfma_f32_16x16x32_bf16 v[216:219], a[96:99], a[20:23], v[216:219]
    v_mfma_f32_16x16x32_bf16 v[232:235], a[96:99], a[24:27], v[232:235]
    v_mfma_f32_16x16x32_bf16 v[248:251], a[96:99], a[28:31], v[248:251]
    v_mfma_f32_16x16x32_bf16 v[140:143], a[100:103], a[0:3], v[140:143]
    v_mfma_f32_16x16x32_bf16 v[156:159], a[100:103], a[4:7], v[156:159]
    v_mfma_f32_16x16x32_bf16 v[172:175], a[100:103], a[8:11], v[172:175]
    v_mfma_f32_16x16x32_bf16 v[188:191], a[100:103], a[12:15], v[188:191]
    v_mfma_f32_16x16x32_bf16 v[204:207], a[100:103], a[16:19], v[204:207]
    v_mfma_f32_16x16x32_bf16 v[220:223], a[100:103], a[20:23], v[220:223]
    v_mfma_f32_16x16x32_bf16 v[236:239], a[100:103], a[24:27], v[236:239]
    v_mfma_f32_16x16x32_bf16 v[252:255], a[100:103], a[28:31], v[252:255]
    s_waitcnt vmcnt(1) lgkmcnt(0)
    s_barrier
    v_mfma_f32_16x16x32_bf16 a[128:131], a[64:67], a[32:35], a[128:131]
    s_add_u32 m0, s78, 0
    v_mfma_f32_16x16x32_bf16 a[136:139], a[64:67], a[36:39], a[136:139]
    buffer_load_dwordx4 v1, s[28:31], s68 offen offset:0 sc1 lds
    v_mfma_f32_16x16x32_bf16 a[144:147], a[64:67], a[40:43], a[144:147]
    ds_read_b128 a[0:3], v8 offset:34816
    v_mfma_f32_16x16x32_bf16 a[152:155], a[64:67], a[44:47], a[152:155]
    v_mfma_f32_16x16x32_bf16 a[160:163], a[64:67], a[48:51], a[160:163]
    buffer_load_dwordx4 v1, s[28:31], s69 offen offset:1024 sc1 lds
    v_mfma_f32_16x16x32_bf16 a[168:171], a[64:67], a[52:55], a[168:171]
    v_mfma_f32_16x16x32_bf16 a[176:179], a[64:67], a[56:59], a[176:179]
    ds_read_b128 a[4:7], v8 offset:36864
    v_mfma_f32_16x16x32_bf16 a[184:187], a[64:67], a[60:63], a[184:187]
    v_mfma_f32_16x16x32_bf16 v[120:123], a[64:67], a[116:119], v[120:123]
    ds_read_b64_tr_b16 a[64:65], v13 offset:0
    v_mfma_f32_16x16x32_bf16 a[132:135], a[68:71], a[32:35], a[132:135]
    ds_read_b64_tr_b16 a[66:67], v13 offset:256
    v_mfma_f32_16x16x32_bf16 a[140:143], a[68:71], a[36:39], a[140:143]
    ds_read_b128 a[8:11], v8 offset:38912
    v_mfma_f32_16x16x32_bf16 a[148:151], a[68:71], a[40:43], a[148:151]
    buffer_load_dwordx4 v1, s[28:31], s70 offen offset:2048 sc1 lds
    v_mfma_f32_16x16x32_bf16 a[156:159], a[68:71], a[44:47], a[156:159]
    buffer_load_dwordx4 v1, s[28:31], s71 offen offset:3072 sc1 lds
    v_mfma_f32_16x16x32_bf16 a[164:167], a[68:71], a[48:51], a[164:167]
    v_mfma_f32_16x16x32_bf16 a[172:175], a[68:71], a[52:55], a[172:175]
    ds_read_b128 a[12:15], v8 offset:40960
    v_mfma_f32_16x16x32_bf16 a[180:183], a[68:71], a[56:59], a[180:183]
    s_add_u32 m0, s78, 4096
    v_mfma_f32_16x16x32_bf16 a[188:191], a[68:71], a[60:63], a[188:191]
    buffer_load_dwordx4 v1, s[28:31], s72 offen offset:0 sc1 lds
    v_mfma_f32_16x16x32_bf16 v[124:127], a[68:71], a[116:119], v[124:127]
    ds_read_b64_tr_b16 a[68:69], v15 offset:0
    v_mfma_f32_16x16x32_bf16 v[52:55], a[32:35], a[72:75], v[52:55]
    ds_read_b64_tr_b16 a[70:71], v15 offset:256
    v_mfma_f32_16x16x32_bf16 v[56:59], a[36:39], a[72:75], v[56:59]
    v_mfma_f32_16x16x32_bf16 v[60:63], a[40:43], a[72:75], v[60:63]
    ds_read_b128 a[16:19], v8 offset:43008
    v_mfma_f32_16x16x32_bf16 v[64:67], a[44:47], a[72:75], v[64:67]
    buffer_load_dwordx4 v1, s[28:31], s73 offen offset:1024 sc1 lds
    v_mfma_f32_16x16x32_bf16 v[68:71], a[48:51], a[72:75], v[68:71]
    ds_read_b128 a[20:23], v8 offset:45056
    v_mfma_f32_16x16x32_bf16 v[72:75], a[52:55], a[72:75], v[72:75]
    v_mfma_f32_16x16x32_bf16 v[76:79], a[56:59], a[72:75], v[76:79]
    buffer_load_dwordx4 v1, s[28:31], s74 offen offset:2048 sc1 lds
    v_mfma_f32_16x16x32_bf16 v[80:83], a[60:63], a[72:75], v[80:83]
    v_mfma_f32_16x16x32_bf16 v[48:51], a[116:119], a[72:75], v[48:51]
    ds_read_b64_tr_b16 a[72:73], v13 offset:1024
    v_mfma_f32_16x16x32_bf16 v[88:91], a[32:35], a[76:79], v[88:91]
    ds_read_b64_tr_b16 a[74:75], v13 offset:1280
    v_mfma_f32_16x16x32_bf16 v[92:95], a[36:39], a[76:79], v[92:95]
    ds_read_b128 a[24:27], v8 offset:47104
    v_mfma_f32_16x16x32_bf16 v[96:99], a[40:43], a[76:79], v[96:99]
    buffer_load_dwordx4 v1, s[28:31], s75 offen offset:3072 sc1 lds
    v_add_u32 v1, 128, v1
    v_mfma_f32_16x16x32_bf16 v[100:103], a[44:47], a[76:79], v[100:103]
    ds_read_b128 a[28:31], v8 offset:49152
    v_mfma_f32_16x16x32_bf16 v[104:107], a[48:51], a[76:79], v[104:107]
    s_add_u32 m0, s78, 8192
    v_mfma_f32_16x16x32_bf16 v[108:111], a[52:55], a[76:79], v[108:111]
    buffer_load_dwordx4 v2, s[28:31], s68 offen offset:0 sc1 lds
    v_mfma_f32_16x16x32_bf16 v[112:115], a[56:59], a[76:79], v[112:115]
    v_mfma_f32_16x16x32_bf16 v[116:119], a[60:63], a[76:79], v[116:119]
    ds_read_b128 a[112:115], v10 offset:34816
    v_mfma_f32_16x16x32_bf16 v[84:87], a[116:119], a[76:79], v[84:87]
    ds_read_b64_tr_b16 a[76:77], v15 offset:1024
    v_mfma_f32_16x16x32_bf16 a[192:195], a[80:83], a[32:35], a[192:195]
    ds_read_b64_tr_b16 a[78:79], v15 offset:1280
    v_mfma_f32_16x16x32_bf16 a[200:203], a[80:83], a[36:39], a[200:203]
    buffer_load_dwordx4 v2, s[28:31], s69 offen offset:1024 sc1 lds
    v_mfma_f32_16x16x32_bf16 a[208:211], a[80:83], a[40:43], a[208:211]
    ds_read_b64_tr_b16 a[96:97], v13 offset:4096
    v_mfma_f32_16x16x32_bf16 a[216:219], a[80:83], a[44:47], a[216:219]
    buffer_load_dwordx4 v2, s[28:31], s70 offen offset:2048 sc1 lds
    v_mfma_f32_16x16x32_bf16 a[224:227], a[80:83], a[48:51], a[224:227]
    v_mfma_f32_16x16x32_bf16 a[232:235], a[80:83], a[52:55], a[232:235]
    v_mfma_f32_16x16x32_bf16 a[240:243], a[80:83], a[56:59], a[240:243]
    ds_read_b64_tr_b16 a[98:99], v13 offset:4352
    v_mfma_f32_16x16x32_bf16 a[248:251], a[80:83], a[60:63], a[248:251]
    ds_read_b64_tr_b16 a[80:81], v13 offset:2048
    v_mfma_f32_16x16x32_bf16 a[196:199], a[84:87], a[32:35], a[196:199]
    ds_read_b64_tr_b16 a[82:83], v13 offset:2304
    v_mfma_f32_16x16x32_bf16 a[204:207], a[84:87], a[36:39], a[204:207]
    buffer_load_dwordx4 v2, s[28:31], s71 offen offset:3072 sc1 lds
    v_mfma_f32_16x16x32_bf16 a[212:215], a[84:87], a[40:43], a[212:215]
    ds_read_b64_tr_b16 a[100:101], v15 offset:4096
    s_add_u32 m0, s78, 12288
    v_mfma_f32_16x16x32_bf16 a[220:223], a[84:87], a[44:47], a[220:223]
    buffer_load_dwordx4 v2, s[28:31], s72 offen offset:0 sc1 lds
    v_mfma_f32_16x16x32_bf16 a[228:231], a[84:87], a[48:51], a[228:231]
    v_mfma_f32_16x16x32_bf16 a[236:239], a[84:87], a[52:55], a[236:239]
    v_mfma_f32_16x16x32_bf16 a[244:247], a[84:87], a[56:59], a[244:247]
    ds_read_b64_tr_b16 a[102:103], v15 offset:4352
    v_mfma_f32_16x16x32_bf16 a[252:255], a[84:87], a[60:63], a[252:255]
    ds_read_b64_tr_b16 a[84:85], v15 offset:2048
    v_mfma_f32_16x16x32_bf16 v[128:131], a[88:91], a[32:35], v[128:131]
    ds_read_b64_tr_b16 a[86:87], v15 offset:2304
    v_mfma_f32_16x16x32_bf16 v[144:147], a[88:91], a[36:39], v[144:147]
    buffer_load_dwordx4 v2, s[28:31], s73 offen offset:1024 sc1 lds
    v_mfma_f32_16x16x32_bf16 v[160:163], a[88:91], a[40:43], v[160:163]
    v_mfma_f32_16x16x32_bf16 v[176:179], a[88:91], a[44:47], v[176:179]
    buffer_load_dwordx4 v2, s[28:31], s74 offen offset:2048 sc1 lds
    v_mfma_f32_16x16x32_bf16 v[192:195], a[88:91], a[48:51], v[192:195]
    v_mfma_f32_16x16x32_bf16 v[208:211], a[88:91], a[52:55], v[208:211]
    v_mfma_f32_16x16x32_bf16 v[224:227], a[88:91], a[56:59], v[224:227]
    v_mfma_f32_16x16x32_bf16 v[240:243], a[88:91], a[60:63], v[240:243]
    ds_read_b64_tr_b16 a[88:89], v13 offset:3072
    v_mfma_f32_16x16x32_bf16 v[132:135], a[92:95], a[32:35], v[132:135]
    ds_read_b64_tr_b16 a[90:91], v13 offset:3328
    v_mfma_f32_16x16x32_bf16 v[148:151], a[92:95], a[36:39], v[148:151]
    buffer_load_dwordx4 v2, s[28:31], s75 offen offset:3072 sc1 lds
    v_add_u32 v2, 128, v2
    v_mfma_f32_16x16x32_bf16 v[164:167], a[92:95], a[40:43], v[164:167]
    v_mfma_f32_16x16x32_bf16 v[180:183], a[92:95], a[44:47], v[180:183]
    v_mfma_f32_16x16x32_bf16 v[196:199], a[92:95], a[48:51], v[196:199]
    v_mfma_f32_16x16x32_bf16 v[212:215], a[92:95], a[52:55], v[212:215]
    v_mfma_f32_16x16x32_bf16 v[228:231], a[92:95], a[56:59], v[228:231]
    v_mfma_f32_16x16x32_bf16 v[244:247], a[92:95], a[60:63], v[244:247]
    ds_read_b64_tr_b16 a[92:93], v15 offset:3072
    v_mfma_f32_16x16x32_bf16 v[136:139], a[104:107], a[32:35], v[136:139]
    ds_read_b64_tr_b16 a[94:95], v15 offset:3328
    v_mfma_f32_16x16x32_bf16 v[152:155], a[104:107], a[36:39], v[152:155]
    v_mfma_f32_16x16x32_bf16 v[168:171], a[104:107], a[40:43], v[168:171]
    v_mfma_f32_16x16x32_bf16 v[184:187], a[104:107], a[44:47], v[184:187]
    v_mfma_f32_16x16x32_bf16 v[200:203], a[104:107], a[48:51], v[200:203]
    v_mfma_f32_16x16x32_bf16 v[216:219], a[104:107], a[52:55], v[216:219]
    v_mfma_f32_16x16x32_bf16 v[232:235], a[104:107], a[56:59], v[232:235]
    v_mfma_f32_16x16x32_bf16 v[248:251], a[104:107], a[60:63], v[248:251]
    v_mfma_f32_16x16x32_bf16 v[140:143], a[108:111], a[32:35], v[140:143]
    v_mfma_f32_16x16x32_bf16 v[156:159], a[108:111], a[36:39], v[156:159]
    v_mfma_f32_16x16x32_bf16 v[172:175], a[108:111], a[40:43], v[172:175]
    v_mfma_f32_16x16x32_bf16 v[188:191], a[108:111], a[44:47], v[188:191]
    v_mfma_f32_16x16x32_bf16 v[204:207], a[108:111], a[48:51], v[204:207]
    v_mfma_f32_16x16x32_bf16 v[220:223], a[108:111], a[52:55], v[220:223]
    v_mfma_f32_16x16x32_bf16 v[236:239], a[108:111], a[56:59], v[236:239]
    v_mfma_f32_16x16x32_bf16 v[252:255], a[108:111], a[60:63], v[252:255]
    s_waitcnt lgkmcnt(0)
    s_barrier
    v_mfma_f32_16x16x32_bf16 a[128:131], a[64:67], a[0:3], a[128:131]
    buffer_load_dword v7, v6, s[44:47], s4 offen
    v_add_u32_e64 v6, s79, v6
    v_mfma_f32_16x16x32_bf16 a[136:139], a[64:67], a[4:7], a[136:139]
    v_mfma_f32_16x16x32_bf16 a[144:147], a[64:67], a[8:11], a[144:147]
    ds_read_b128 a[32:35], v9 offset:34816
    v_mfma_f32_16x16x32_bf16 a[152:155], a[64:67], a[12:15], a[152:155]
    v_mfma_f32_16x16x32_bf16 a[160:163], a[64:67], a[16:19], a[160:163]
    v_mfma_f32_16x16x32_bf16 a[168:171], a[64:67], a[20:23], a[168:171]
    v_mfma_f32_16x16x32_bf16 a[176:179], a[64:67], a[24:27], a[176:179]
    ds_read_b128 a[36:39], v9 offset:36864
    v_mfma_f32_16x16x32_bf16 a[184:187], a[64:67], a[28:31], a[184:187]
    v_mfma_f32_16x16x32_bf16 v[120:123], a[64:67], a[112:115], v[120:123]
    ds_read_b64_tr_b16 a[64:65], v13 offset:20480
    v_mfma_f32_16x16x32_bf16 a[132:135], a[68:71], a[0:3], a[132:135]
    ds_read_b64_tr_b16 a[66:67], v13 offset:20736
    v_mfma_f32_16x16x32_bf16 a[140:143], a[68:71], a[4:7], a[140:143]
    ds_read_b128 a[40:43], v9 offset:38912
    v_mfma_f32_16x16x32_bf16 a[148:151], a[68:71], a[8:11], a[148:151]
    v_mfma_f32_16x16x32_bf16 a[156:159], a[68:71], a[12:15], a[156:159]
    v_mfma_f32_16x16x32_bf16 a[164:167], a[68:71], a[16:19], a[164:167]
    v_mfma_f32_16x16x32_bf16 a[172:175], a[68:71], a[20:23], a[172:175]
    ds_read_b128 a[44:47], v9 offset:40960
    v_mfma_f32_16x16x32_bf16 a[180:183], a[68:71], a[24:27], a[180:183]
    v_mfma_f32_16x16x32_bf16 a[188:191], a[68:71], a[28:31], a[188:191]
    v_mfma_f32_16x16x32_bf16 v[124:127], a[68:71], a[112:115], v[124:127]
    ds_read_b64_tr_b16 a[68:69], v15 offset:20480
    v_mfma_f32_16x16x32_bf16 v[52:55], a[0:3], a[72:75], v[52:55]
    ds_read_b64_tr_b16 a[70:71], v15 offset:20736
    v_mfma_f32_16x16x32_bf16 v[56:59], a[4:7], a[72:75], v[56:59]
    v_mfma_f32_16x16x32_bf16 v[60:63], a[8:11], a[72:75], v[60:63]
    ds_read_b128 a[48:51], v9 offset:43008
    v_mfma_f32_16x16x32_bf16 v[64:67], a[12:15], a[72:75], v[64:67]
    v_mfma_f32_16x16x32_bf16 v[68:71], a[16:19], a[72:75], v[68:71]
    ds_read_b128 a[52:55], v9 offset:45056
    v_mfma_f32_16x16x32_bf16 v[72:75], a[20:23], a[72:75], v[72:75]
    v_mfma_f32_16x16x32_bf16 v[76:79], a[24:27], a[72:75], v[76:79]
    v_mfma_f32_16x16x32_bf16 v[80:83], a[28:31], a[72:75], v[80:83]
    v_mfma_f32_16x16x32_bf16 v[48:51], a[112:115], a[72:75], v[48:51]
    ds_read_b64_tr_b16 a[72:73], v13 offset:21504
    v_mfma_f32_16x16x32_bf16 v[88:91], a[0:3], a[76:79], v[88:91]
    ds_read_b64_tr_b16 a[74:75], v13 offset:21760
    v_mfma_f32_16x16x32_bf16 v[92:95], a[4:7], a[76:79], v[92:95]
    ds_read_b128 a[56:59], v9 offset:47104
    v_mfma_f32_16x16x32_bf16 v[96:99], a[8:11], a[76:79], v[96:99]
    v_mfma_f32_16x16x32_bf16 v[100:103], a[12:15], a[76:79], v[100:103]
    ds_read_b128 a[60:63], v9 offset:49152
    v_mfma_f32_16x16x32_bf16 v[104:107], a[16:19], a[76:79], v[104:107]
    v_mfma_f32_16x16x32_bf16 v[108:111], a[20:23], a[76:79], v[108:111]
    v_mfma_f32_16x16x32_bf16 v[112:115], a[24:27], a[76:79], v[112:115]
    v_mfma_f32_16x16x32_bf16 v[116:119], a[28:31], a[76:79], v[116:119]
    ds_read_b128 a[116:119], v11 offset:34816
    v_mfma_f32_16x16x32_bf16 v[84:87], a[112:115], a[76:79], v[84:87]
    ds_read_b64_tr_b16 a[76:77], v15 offset:21504
    v_mfma_f32_16x16x32_bf16 a[192:195], a[80:83], a[0:3], a[192:195]
    ds_read_b64_tr_b16 a[78:79], v15 offset:21760
    v_mfma_f32_16x16x32_bf16 a[200:203], a[80:83], a[4:7], a[200:203]
    v_mfma_f32_16x16x32_bf16 a[208:211], a[80:83], a[8:11], a[208:211]
    ds_read_b64_tr_b16 a[104:105], v13 offset:24576
    v_mfma_f32_16x16x32_bf16 a[216:219], a[80:83], a[12:15], a[216:219]
    v_mfma_f32_16x16x32_bf16 a[224:227], a[80:83], a[16:19], a[224:227]
    v_mfma_f32_16x16x32_bf16 a[232:235], a[80:83], a[20:23], a[232:235]
    v_mfma_f32_16x16x32_bf16 a[240:243], a[80:83], a[24:27], a[240:243]
    ds_read_b64_tr_b16 a[106:107], v13 offset:24832
    v_mfma_f32_16x16x32_bf16 a[248:251], a[80:83], a[28:31], a[248:251]
    ds_read_b64_tr_b16 a[80:81], v13 offset:22528
    v_mfma_f32_16x16x32_bf16 a[196:199], a[84:87], a[0:3], a[196:199]
    ds_read_b64_tr_b16 a[82:83], v13 offset:22784
    v_mfma_f32_16x16x32_bf16 a[204:207], a[84:87], a[4:7], a[204:207]
    v_mfma_f32_16x16x32_bf16 a[212:215], a[84:87], a[8:11], a[212:215]
    ds_read_b64_tr_b16 a[108:109], v15 offset:24576
    v_mfma_f32_16x16x32_bf16 a[220:223], a[84:87], a[12:15], a[220:223]
    v_mfma_f32_16x16x32_bf16 a[228:231], a[84:87], a[16:19], a[228:231]
    v_mfma_f32_16x16x32_bf16 a[236:239], a[84:87], a[20:23], a[236:239]
    v_mfma_f32_16x16x32_bf16 a[244:247], a[84:87], a[24:27], a[244:247]
    ds_read_b64_tr_b16 a[110:111], v15 offset:24832
    v_mfma_f32_16x16x32_bf16 a[252:255], a[84:87], a[28:31], a[252:255]
    ds_read_b64_tr_b16 a[84:85], v15 offset:22528
    v_mfma_f32_16x16x32_bf16 v[128:131], a[88:91], a[0:3], v[128:131]
    ds_read_b64_tr_b16 a[86:87], v15 offset:22784
    v_mfma_f32_16x16x32_bf16 v[144:147], a[88:91], a[4:7], v[144:147]
    v_mfma_f32_16x16x32_bf16 v[160:163], a[88:91], a[8:11], v[160:163]
    v_mfma_f32_16x16x32_bf16 v[176:179], a[88:91], a[12:15], v[176:179]
    v_mfma_f32_16x16x32_bf16 v[192:195], a[88:91], a[16:19], v[192:195]
    v_mfma_f32_16x16x32_bf16 v[208:211], a[88:91], a[20:23], v[208:211]
    v_mfma_f32_16x16x32_bf16 v[224:227], a[88:91], a[24:27], v[224:227]
    v_mfma_f32_16x16x32_bf16 v[240:243], a[88:91], a[28:31], v[240:243]
    ds_read_b64_tr_b16 a[88:89], v13 offset:23552
    v_mfma_f32_16x16x32_bf16 v[132:135], a[92:95], a[0:3], v[132:135]
    ds_read_b64_tr_b16 a[90:91], v13 offset:23808
    v_mfma_f32_16x16x32_bf16 v[148:151], a[92:95], a[4:7], v[148:151]
    v_mfma_f32_16x16x32_bf16 v[164:167], a[92:95], a[8:11], v[164:167]
    v_mfma_f32_16x16x32_bf16 v[180:183], a[92:95], a[12:15], v[180:183]
    v_mfma_f32_16x16x32_bf16 v[196:199], a[92:95], a[16:19], v[196:199]
    v_mfma_f32_16x16x32_bf16 v[212:215], a[92:95], a[20:23], v[212:215]
    v_mfma_f32_16x16x32_bf16 v[228:231], a[92:95], a[24:27], v[228:231]
    v_mfma_f32_16x16x32_bf16 v[244:247], a[92:95], a[28:31], v[244:247]
    ds_read_b64_tr_b16 a[92:93], v15 offset:23552
    v_mfma_f32_16x16x32_bf16 v[136:139], a[96:99], a[0:3], v[136:139]
    ds_read_b64_tr_b16 a[94:95], v15 offset:23808
    v_mfma_f32_16x16x32_bf16 v[152:155], a[96:99], a[4:7], v[152:155]
    v_mfma_f32_16x16x32_bf16 v[168:171], a[96:99], a[8:11], v[168:171]
    v_mfma_f32_16x16x32_bf16 v[184:187], a[96:99], a[12:15], v[184:187]
    v_mfma_f32_16x16x32_bf16 v[200:203], a[96:99], a[16:19], v[200:203]
    v_mfma_f32_16x16x32_bf16 v[216:219], a[96:99], a[20:23], v[216:219]
    v_mfma_f32_16x16x32_bf16 v[232:235], a[96:99], a[24:27], v[232:235]
    v_mfma_f32_16x16x32_bf16 v[248:251], a[96:99], a[28:31], v[248:251]
    v_mfma_f32_16x16x32_bf16 v[140:143], a[100:103], a[0:3], v[140:143]
    v_mfma_f32_16x16x32_bf16 v[156:159], a[100:103], a[4:7], v[156:159]
    v_mfma_f32_16x16x32_bf16 v[172:175], a[100:103], a[8:11], v[172:175]
    v_mfma_f32_16x16x32_bf16 v[188:191], a[100:103], a[12:15], v[188:191]
    v_mfma_f32_16x16x32_bf16 v[204:207], a[100:103], a[16:19], v[204:207]
    v_mfma_f32_16x16x32_bf16 v[220:223], a[100:103], a[20:23], v[220:223]
    v_mfma_f32_16x16x32_bf16 v[236:239], a[100:103], a[24:27], v[236:239]
    v_mfma_f32_16x16x32_bf16 v[252:255], a[100:103], a[28:31], v[252:255]
    s_waitcnt vmcnt(1) lgkmcnt(0)
    s_barrier
    v_mfma_f32_16x16x32_bf16 a[128:131], a[64:67], a[32:35], a[128:131]
    s_add_u32 m0, s78, 34816
    v_mfma_f32_16x16x32_bf16 a[136:139], a[64:67], a[36:39], a[136:139]
    buffer_load_dwordx4 v1, s[28:31], s68 offen offset:0 sc1 lds
    v_mfma_f32_16x16x32_bf16 a[144:147], a[64:67], a[40:43], a[144:147]
    ds_read_b128 a[0:3], v8 offset:0
    v_mfma_f32_16x16x32_bf16 a[152:155], a[64:67], a[44:47], a[152:155]
    v_mfma_f32_16x16x32_bf16 a[160:163], a[64:67], a[48:51], a[160:163]
    buffer_load_dwordx4 v1, s[28:31], s69 offen offset:1024 sc1 lds
    v_mfma_f32_16x16x32_bf16 a[168:171], a[64:67], a[52:55], a[168:171]
    v_mfma_f32_16x16x32_bf16 a[176:179], a[64:67], a[56:59], a[176:179]
    ds_read_b128 a[4:7], v8 offset:2048
    v_mfma_f32_16x16x32_bf16 a[184:187], a[64:67], a[60:63], a[184:187]
    v_mfma_f32_16x16x32_bf16 v[120:123], a[64:67], a[116:119], v[120:123]
    ds_read_b64_tr_b16 a[64:65], v12 offset:0
    v_mfma_f32_16x16x32_bf16 a[132:135], a[68:71], a[32:35], a[132:135]
    ds_read_b64_tr_b16 a[66:67], v12 offset:256
    v_mfma_f32_16x16x32_bf16 a[140:143], a[68:71], a[36:39], a[140:143]
    ds_read_b128 a[8:11], v8 offset:4096
    v_mfma_f32_16x16x32_bf16 a[148:151], a[68:71], a[40:43], a[148:151]
    buffer_load_dwordx4 v1, s[28:31], s70 offen offset:2048 sc1 lds
    v_mfma_f32_16x16x32_bf16 a[156:159], a[68:71], a[44:47], a[156:159]
    buffer_load_dwordx4 v1, s[28:31], s71 offen offset:3072 sc1 lds
    v_mfma_f32_16x16x32_bf16 a[164:167], a[68:71], a[48:51], a[164:167]
    v_mfma_f32_16x16x32_bf16 a[172:175], a[68:71], a[52:55], a[172:175]
    ds_read_b128 a[12:15], v8 offset:6144
    v_mfma_f32_16x16x32_bf16 a[180:183], a[68:71], a[56:59], a[180:183]
    s_add_u32 m0, s78, 38912
    v_mfma_f32_16x16x32_bf16 a[188:191], a[68:71], a[60:63], a[188:191]
    buffer_load_dwordx4 v1, s[28:31], s72 offen offset:0 sc1 lds
    v_mfma_f32_16x16x32_bf16 v[124:127], a[68:71], a[116:119], v[124:127]
    ds_read_b64_tr_b16 a[68:69], v14 offset:0
    v_mfma_f32_16x16x32_bf16 v[52:55], a[32:35], a[72:75], v[52:55]
    ds_read_b64_tr_b16 a[70:71], v14 offset:256
    v_mfma_f32_16x16x32_bf16 v[56:59], a[36:39], a[72:75], v[56:59]
    v_mfma_f32_16x16x32_bf16 v[60:63], a[40:43], a[72:75], v[60:63]
    ds_read_b128 a[16:19], v8 offset:8192
    v_mfma_f32_16x16x32_bf16 v[64:67], a[44:47], a[72:75], v[64:67]
    buffer_load_dwordx4 v1, s[28:31], s73 offen offset:1024 sc1 lds
    v_mfma_f32_16x16x32_bf16 v[68:71], a[48:51], a[72:75], v[68:71]
    ds_read_b128 a[20:23], v8 offset:10240
    v_mfma_f32_16x16x32_bf16 v[72:75], a[52:55], a[72:75], v[72:75]
    v_mfma_f32_16x16x32_bf16 v[76:79], a[56:59], a[72:75], v[76:79]
    buffer_load_dwordx4 v1, s[28:31], s74 offen offset:2048 sc1 lds
    v_mfma_f32_16x16x32_bf16 v[80:83], a[60:63], a[72:75], v[80:83]
    v_mfma_f32_16x16x32_bf16 v[48:51], a[116:119], a[72:75], v[48:51]
    ds_read_b64_tr_b16 a[72:73], v12 offset:1024
    v_mfma_f32_16x16x32_bf16 v[88:91], a[32:35], a[76:79], v[88:91]
    ds_read_b64_tr_b16 a[74:75], v12 offset:1280
    v_mfma_f32_16x16x32_bf16 v[92:95], a[36:39], a[76:79], v[92:95]
    ds_read_b128 a[24:27], v8 offset:12288
    v_mfma_f32_16x16x32_bf16 v[96:99], a[40:43], a[76:79], v[96:99]
    buffer_load_dwordx4 v1, s[28:31], s75 offen offset:3072 sc1 lds
    v_add_u32 v1, 128, v1
    v_mfma_f32_16x16x32_bf16 v[100:103], a[44:47], a[76:79], v[100:103]
    ds_read_b128 a[28:31], v8 offset:14336
    v_mfma_f32_16x16x32_bf16 v[104:107], a[48:51], a[76:79], v[104:107]
    s_add_u32 m0, s78, 43008
    v_mfma_f32_16x16x32_bf16 v[108:111], a[52:55], a[76:79], v[108:111]
    buffer_load_dwordx4 v2, s[28:31], s68 offen offset:0 sc1 lds
    v_mfma_f32_16x16x32_bf16 v[112:115], a[56:59], a[76:79], v[112:115]
    v_mfma_f32_16x16x32_bf16 v[116:119], a[60:63], a[76:79], v[116:119]
    ds_read_b128 a[112:115], v10 offset:0
    v_mfma_f32_16x16x32_bf16 v[84:87], a[116:119], a[76:79], v[84:87]
    ds_read_b64_tr_b16 a[76:77], v14 offset:1024
    v_mfma_f32_16x16x32_bf16 a[192:195], a[80:83], a[32:35], a[192:195]
    ds_read_b64_tr_b16 a[78:79], v14 offset:1280
    v_mfma_f32_16x16x32_bf16 a[200:203], a[80:83], a[36:39], a[200:203]
    buffer_load_dwordx4 v2, s[28:31], s69 offen offset:1024 sc1 lds
    v_mfma_f32_16x16x32_bf16 a[208:211], a[80:83], a[40:43], a[208:211]
    ds_read_b64_tr_b16 a[96:97], v12 offset:4096
    v_mfma_f32_16x16x32_bf16 a[216:219], a[80:83], a[44:47], a[216:219]
    buffer_load_dwordx4 v2, s[28:31], s70 offen offset:2048 sc1 lds
    v_mfma_f32_16x16x32_bf16 a[224:227], a[80:83], a[48:51], a[224:227]
    v_mfma_f32_16x16x32_bf16 a[232:235], a[80:83], a[52:55], a[232:235]
    v_mfma_f32_16x16x32_bf16 a[240:243], a[80:83], a[56:59], a[240:243]
    ds_read_b64_tr_b16 a[98:99], v12 offset:4352
    v_mfma_f32_16x16x32_bf16 a[248:251], a[80:83], a[60:63], a[248:251]
    ds_read_b64_tr_b16 a[80:81], v12 offset:2048
    v_mfma_f32_16x16x32_bf16 a[196:199], a[84:87], a[32:35], a[196:199]
    ds_read_b64_tr_b16 a[82:83], v12 offset:2304
    v_mfma_f32_16x16x32_bf16 a[204:207], a[84:87], a[36:39], a[204:207]
    buffer_load_dwordx4 v2, s[28:31], s71 offen offset:3072 sc1 lds
    v_mfma_f32_16x16x32_bf16 a[212:215], a[84:87], a[40:43], a[212:215]
    ds_read_b64_tr_b16 a[100:101], v14 offset:4096
    s_add_u32 m0, s78, 47104
    v_mfma_f32_16x16x32_bf16 a[220:223], a[84:87], a[44:47], a[220:223]
    buffer_load_dwordx4 v2, s[28:31], s72 offen offset:0 sc1 lds
    v_mfma_f32_16x16x32_bf16 a[228:231], a[84:87], a[48:51], a[228:231]
    v_mfma_f32_16x16x32_bf16 a[236:239], a[84:87], a[52:55], a[236:239]
    v_mfma_f32_16x16x32_bf16 a[244:247], a[84:87], a[56:59], a[244:247]
    ds_read_b64_tr_b16 a[102:103], v14 offset:4352
    v_mfma_f32_16x16x32_bf16 a[252:255], a[84:87], a[60:63], a[252:255]
    ds_read_b64_tr_b16 a[84:85], v14 offset:2048
    v_mfma_f32_16x16x32_bf16 v[128:131], a[88:91], a[32:35], v[128:131]
    ds_read_b64_tr_b16 a[86:87], v14 offset:2304
    v_mfma_f32_16x16x32_bf16 v[144:147], a[88:91], a[36:39], v[144:147]
    buffer_load_dwordx4 v2, s[28:31], s73 offen offset:1024 sc1 lds
    v_mfma_f32_16x16x32_bf16 v[160:163], a[88:91], a[40:43], v[160:163]
    v_mfma_f32_16x16x32_bf16 v[176:179], a[88:91], a[44:47], v[176:179]
    buffer_load_dwordx4 v2, s[28:31], s74 offen offset:2048 sc1 lds
    v_mfma_f32_16x16x32_bf16 v[192:195], a[88:91], a[48:51], v[192:195]
    v_mfma_f32_16x16x32_bf16 v[208:211], a[88:91], a[52:55], v[208:211]
    v_mfma_f32_16x16x32_bf16 v[224:227], a[88:91], a[56:59], v[224:227]
    v_mfma_f32_16x16x32_bf16 v[240:243], a[88:91], a[60:63], v[240:243]
    ds_read_b64_tr_b16 a[88:89], v12 offset:3072
    v_mfma_f32_16x16x32_bf16 v[132:135], a[92:95], a[32:35], v[132:135]
    ds_read_b64_tr_b16 a[90:91], v12 offset:3328
    v_mfma_f32_16x16x32_bf16 v[148:151], a[92:95], a[36:39], v[148:151]
    buffer_load_dwordx4 v2, s[28:31], s75 offen offset:3072 sc1 lds
    v_add_u32 v2, 128, v2
    v_mfma_f32_16x16x32_bf16 v[164:167], a[92:95], a[40:43], v[164:167]
    v_mfma_f32_16x16x32_bf16 v[180:183], a[92:95], a[44:47], v[180:183]
    v_mfma_f32_16x16x32_bf16 v[196:199], a[92:95], a[48:51], v[196:199]
    v_mfma_f32_16x16x32_bf16 v[212:215], a[92:95], a[52:55], v[212:215]
    v_mfma_f32_16x16x32_bf16 v[228:231], a[92:95], a[56:59], v[228:231]
    v_mfma_f32_16x16x32_bf16 v[244:247], a[92:95], a[60:63], v[244:247]
    ds_read_b64_tr_b16 a[92:93], v14 offset:3072
    v_mfma_f32_16x16x32_bf16 v[136:139], a[104:107], a[32:35], v[136:139]
    ds_read_b64_tr_b16 a[94:95], v14 offset:3328
    v_mfma_f32_16x16x32_bf16 v[152:155], a[104:107], a[36:39], v[152:155]
    v_mfma_f32_16x16x32_bf16 v[168:171], a[104:107], a[40:43], v[168:171]
    v_mfma_f32_16x16x32_bf16 v[184:187], a[104:107], a[44:47], v[184:187]
    v_mfma_f32_16x16x32_bf16 v[200:203], a[104:107], a[48:51], v[200:203]
    v_mfma_f32_16x16x32_bf16 v[216:219], a[104:107], a[52:55], v[216:219]
    v_mfma_f32_16x16x32_bf16 v[232:235], a[104:107], a[56:59], v[232:235]
    v_mfma_f32_16x16x32_bf16 v[248:251], a[104:107], a[60:63], v[248:251]
    v_mfma_f32_16x16x32_bf16 v[140:143], a[108:111], a[32:35], v[140:143]
    v_mfma_f32_16x16x32_bf16 v[156:159], a[108:111], a[36:39], v[156:159]
    v_mfma_f32_16x16x32_bf16 v[172:175], a[108:111], a[40:43], v[172:175]
    v_mfma_f32_16x16x32_bf16 v[188:191], a[108:111], a[44:47], v[188:191]
    v_mfma_f32_16x16x32_bf16 v[204:207], a[108:111], a[48:51], v[204:207]
    v_mfma_f32_16x16x32_bf16 v[220:223], a[108:111], a[52:55], v[220:223]
    v_mfma_f32_16x16x32_bf16 v[236:239], a[108:111], a[56:59], v[236:239]
    v_mfma_f32_16x16x32_bf16 v[252:255], a[108:111], a[60:63], v[252:255]
    s_sub_u32 s67, s67, 1
    s_cmp_lg_u32 s67, 0
    s_cbranch_scc1 L_loop0
L_tail0:
    s_waitcnt lgkmcnt(0)
    s_barrier
    v_mfma_f32_16x16x32_bf16 a[128:131], a[64:67], a[0:3], a[128:131]
    s_getpc_b64 s[86:87]
L_pc0:
    s_sub_u32 s86, s86, L_pc0-L_tail0
    s_subb_u32 s87, s87, 0
    s_lshr_b32 s82, s2, 3
    s_lshl_b32 s82, s82, 2
    s_add_u32 s82, s82, s60
    s_lshl_b32 s82, s82, 10
    v_add_u32 v34, s82, v16
    v_min_u32 v34, L_code_end-L_tail0-4, v34
    global_load_dword v7, v34, s[86:87]
    v_mfma_f32_16x16x32_bf16 a[136:139], a[64:67], a[4:7], a[136:139]
    v_mfma_f32_16x16x32_bf16 a[144:147], a[64:67], a[8:11], a[144:147]
    ds_read_b128 a[32:35], v9 offset:0
    s_and_b32 s82, s2, 7
    s_lshl_b32 s82, s82, 5
    s_lshr_b32 s83, s2, 3
    s_add_u32 s82, s82, s83
    s_lshl_b32 s82, s82, 2
    s_add_u32 s82, s82, s60
    s_mul_i32 s82, s82, 7168
    v_min_u32 v34, 55, v0
    v_lshlrev_b32 v34, 7, v34
    v_add_u32 v34, s82, v34
    global_load_dword v7, v34, s[20:21]
    v_mfma_f32_16x16x32_bf16 a[152:155], a[64:67], a[12:15], a[152:155]
    v_mfma_f32_16x16x32_bf16 a[160:163], a[64:67], a[16:19], a[160:163]
    v_mfma_f32_16x16x32_bf16 a[168:171], a[64:67], a[20:23], a[168:171]
    v_mfma_f32_16x16x32_bf16 a[176:179], a[64:67], a[24:27], a[176:179]
    ds_read_b128 a[36:39], v9 offset:2048
    v_mfma_f32_16x16x32_bf16 a[184:187], a[64:67], a[28:31], a[184:187]
    v_mfma_f32_16x16x32_bf16 v[120:123], a[64:67], a[112:115], v[120:123]
    ds_read_b64_tr_b16 a[64:65], v12 offset:20480
    v_mfma_f32_16x16x32_bf16 a[132:135], a[68:71], a[0:3], a[132:135]
    ds_read_b64_tr_b16 a[66:67], v12 offset:20736
    v_mfma_f32_16x16x32_bf16 a[140:143], a[68:71], a[4:7], a[140:143]
    ds_read_b128 a[40:43], v9 offset:4096
    v_mfma_f32_16x16x32_bf16 a[148:151], a[68:71], a[8:11], a[148:151]
    v_mfma_f32_16x16x32_bf16 a[156:159], a[68:71], a[12:15], a[156:159]
    v_mfma_f32_16x16x32_bf16 a[164:167], a[68:71], a[16:19], a[164:167]
    v_mfma_f32_16x16x32_bf16 a[172:175], a[68:71], a[20:23], a[172:175]
    ds_read_b128 a[44:47], v9 offset:6144
    v_mfma_f32_16x16x32_bf16 a[180:183], a[68:71], a[24:27], a[180:183]
    v_mfma_f32_16x16x32_bf16 a[188:191], a[68:71], a[28:31], a[188:191]
    v_mfma_f32_16x16x32_bf16 v[124:127], a[68:71], a[112:115], v[124:127]
    ds_read_b64_tr_b16 a[68:69], v14 offset:20480
    v_mfma_f32_16x16x32_bf16 v[52:55], a[0:3], a[72:75], v[52:55]
    ds_read_b64_tr_b16 a[70:71], v14 offset:20736
    v_mfma_f32_16x16x32_bf16 v[56:59], a[4:7], a[72:75], v[56:59]
    v_mfma_f32_16x16x32_bf16 v[60:63], a[8:11], a[72:75], v[60:63]
    ds_read_b128 a[48:51], v9 offset:8192
    s_lshl_b32 s82, s2, 2
    s_add_u32 s82, s82, s60
    s_lshl_b32 s82, s82, 11
    v_and_b32 v35, 31, v0
    v_lshlrev_b32 v35, 6, v35
    v_add_u32 v35, s82, v35
    global_load_dword v7, v35, s[12:13]
    v_mfma_f32_16x16x32_bf16 v[64:67], a[12:15], a[72:75], v[64:67]
    v_mfma_f32_16x16x32_bf16 v[68:71], a[16:19], a[72:75], v[68:71]
    ds_read_b128 a[52:55], v9 offset:10240
    v_mfma_f32_16x16x32_bf16 v[72:75], a[20:23], a[72:75], v[72:75]
    v_mfma_f32_16x16x32_bf16 v[76:79], a[24:27], a[72:75], v[76:79]
    v_mfma_f32_16x16x32_bf16 v[80:83], a[28:31], a[72:75], v[80:83]
    v_mfma_f32_16x16x32_bf16 v[48:51], a[112:115], a[72:75], v[48:51]
    ds_read_b64_tr_b16 a[72:73], v12 offset:21504
    v_mfma_f32_16x16x32_bf16 v[88:91], a[0:3], a[76:79], v[88:91]
    ds_read_b64_tr_b16 a[74:75], v12 offset:21760
    v_mfma_f32_16x16x32_bf16 v[92:95], a[4:7], a[76:79], v[92:95]
    ds_read_b128 a[56:59], v9 offset:12288
    v_mfma_f32_16x16x32_bf16 v[96:99], a[8:11], a[76:79], v[96:99]
    v_mfma_f32_16x16x32_bf16 v[100:103], a[12:15], a[76:79], v[100:103]
    ds_read_b128 a[60:63], v9 offset:14336
    v_mfma_f32_16x16x32_bf16 v[104:107], a[16:19], a[76:79], v[104:107]
    v_mfma_f32_16x16x32_bf16 v[108:111], a[20:23], a[76:79], v[108:111]
    v_mfma_f32_16x16x32_bf16 v[112:115], a[24:27], a[76:79], v[112:115]
    v_mfma_f32_16x16x32_bf16 v[116:119], a[28:31], a[76:79], v[116:119]
    ds_read_b128 a[116:119], v11 offset:0
    v_mfma_f32_16x16x32_bf16 v[84:87], a[112:115], a[76:79], v[84:87]
    ds_read_b64_tr_b16 a[76:77], v14 offset:21504
    v_mfma_f32_16x16x32_bf16 a[192:195], a[80:83], a[0:3], a[192:195]
    ds_read_b64_tr_b16 a[78:79], v14 offset:21760
    v_mfma_f32_16x16x32_bf16 a[200:203], a[80:83], a[4:7], a[200:203]
    v_mfma_f32_16x16x32_bf16 a[208:211], a[80:83], a[8:11], a[208:211]
    ds_read_b64_tr_b16 a[104:105], v12 offset:24576
    v_mfma_f32_16x16x32_bf16 a[216:219], a[80:83], a[12:15], a[216:219]
    v_mfma_f32_16x16x32_bf16 a[224:227], a[80:83], a[16:19], a[224:227]
    v_mfma_f32_16x16x32_bf16 a[232:235], a[80:83], a[20:23], a[232:235]
    v_mfma_f32_16x16x32_bf16 a[240:243], a[80:83], a[24:27], a[240:243]
    ds_read_b64_tr_b16 a[106:107], v12 offset:24832
    v_mfma_f32_16x16x32_bf16 a[248:251], a[80:83], a[28:31], a[248:251]
    ds_read_b64_tr_b16 a[80:81], v12 offset:22528
    v_mfma_f32_16x16x32_bf16 a[196:199], a[84:87], a[0:3], a[196:199]
    ds_read_b64_tr_b16 a[82:83], v12 offset:22784
    v_mfma_f32_16x16x32_bf16 a[204:207], a[84:87], a[4:7], a[204:207]
    v_mfma_f32_16x16x32_bf16 a[212:215], a[84:87], a[8:11], a[212:215]
    ds_read_b64_tr_b16 a[108:109], v14 offset:24576
    v_mfma_f32_16x16x32_bf16 a[220:223], a[84:87], a[12:15], a[220:223]
    v_mfma_f32_16x16x32_bf16 a[228:231], a[84:87], a[16:19], a[228:231]
    v_mfma_f32_16x16x32_bf16 a[236:239], a[84:87], a[20:23], a[236:239]
    v_mfma_f32_16x16x32_bf16 a[244:247], a[84:87], a[24:27], a[244:247]
    ds_read_b64_tr_b16 a[110:111], v14 offset:24832
    v_mfma_f32_16x16x32_bf16 a[252:255], a[84:87], a[28:31], a[252:255]
    ds_read_b64_tr_b16 a[84:85], v14 offset:22528
    v_mfma_f32_16x16x32_bf16 v[128:131], a[88:91], a[0:3], v[128:131]
    ds_read_b64_tr_b16 a[86:87], v14 offset:22784
    v_mfma_f32_16x16x32_bf16 v[144:147], a[88:91], a[4:7], v[144:147]
    v_mfma_f32_16x16x32_bf16 v[160:163], a[88:91], a[8:11], v[160:163]
    v_mfma_f32_16x16x32_bf16 v[176:179], a[88:91], a[12:15], v[176:179]
    v_mfma_f32_16x16x32_bf16 v[192:195], a[88:91], a[16:19], v[192:195]
    v_mfma_f32_16x16x32_bf16 v[208:211], a[88:91], a[20:23], v[208:211]
    v_mfma_f32_16x16x32_bf16 v[224:227], a[88:91], a[24:27], v[224:227]
    v_mfma_f32_16x16x32_bf16 v[240:243], a[88:91], a[28:31], v[240:243]
    ds_read_b64_tr_b16 a[88:89], v12 offset:23552
    v_mfma_f32_16x16x32_bf16 v[132:135], a[92:95], a[0:3], v[132:135]
    ds_read_b64_tr_b16 a[90:91], v12 offset:23808
    v_mfma_f32_16x16x32_bf16 v[148:151], a[92:95], a[4:7], v[148:151]
    v_mfma_f32_16x16x32_bf16 v[164:167], a[92:95], a[8:11], v[164:167]
    v_mfma_f32_16x16x32_bf16 v[180:183], a[92:95], a[12:15], v[180:183]
    v_mfma_f32_16x16x32_bf16 v[196:199], a[92:95], a[16:19], v[196:199]
    v_mfma_f32_16x16x32_bf16 v[212:215], a[92:95], a[20:23], v[212:215]
    v_mfma_f32_16x16x32_bf16 v[228:231], a[92:95], a[24:27], v[228:231]
    v_mfma_f32_16x16x32_bf16 v[244:247], a[92:95], a[28:31], v[244:247]
    ds_read_b64_tr_b16 a[92:93], v14 offset:23552
    v_mfma_f32_16x16x32_bf16 v[136:139], a[96:99], a[0:3], v[136:139]
    ds_read_b64_tr_b16 a[94:95], v14 offset:23808
    v_mfma_f32_16x16x32_bf16 v[152:155], a[96:99], a[4:7], v[152:155]
    v_mfma_f32_16x16x32_bf16 v[168:171], a[96:99], a[8:11], v[168:171]
    v_mfma_f32_16x16x32_bf16 v[184:187], a[96:99], a[12:15], v[184:187]
    v_mfma_f32_16x16x32_bf16 v[200:203], a[96:99], a[16:19], v[200:203]
    v_mfma_f32_16x16x32_bf16 v[216:219], a[96:99], a[20:23], v[216:219]
    v_mfma_f32_16x16x32_bf16 v[232:235], a[96:99], a[24:27], v[232:235]
    v_mfma_f32_16x16x32_bf16 v[248:251], a[96:99], a[28:31], v[248:251]
    v_mfma_f32_16x16x32_bf16 v[140:143], a[100:103], a[0:3], v[140:143]
    v_mfma_f32_16x16x32_bf16 v[156:159], a[100:103], a[4:7], v[156:159]
    v_mfma_f32_16x16x32_bf16 v[172:175], a[100:103], a[8:11], v[172:175]
    v_mfma_f32_16x16x32_bf16 v[188:191], a[100:103], a[12:15], v[188:191]
    v_mfma_f32_16x16x32_bf16 v[204:207], a[100:103], a[16:19], v[204:207]
    v_mfma_f32_16x16x32_bf16 v[220:223], a[100:103], a[20:23], v[220:223]
    v_mfma_f32_16x16x32_bf16 v[236:239], a[100:103], a[24:27], v[236:239]
    v_mfma_f32_16x16x32_bf16 v[252:255], a[100:103], a[28:31], v[252:255]
    s_waitcnt vmcnt(3) lgkmcnt(0)
    s_barrier
    v_mfma_f32_16x16x32_bf16 a[128:131], a[64:67], a[32:35], a[128:131]
    v_mfma_f32_16x16x32_bf16 a[136:139], a[64:67], a[36:39], a[136:139]
    v_mfma_f32_16x16x32_bf16 a[144:147], a[64:67], a[40:43], a[144:147]
    ds_read_b128 a[0:3], v8 offset:34816
    v_mfma_f32_16x16x32_bf16 a[152:155], a[64:67], a[44:47], a[152:155]
    v_mfma_f32_16x16x32_bf16 a[160:163], a[64:67], a[48:51], a[160:163]
    s_mul_i32 s82, s65, 1835008
    s_lshl_b32 s83, s66, 8
    v_mfma_f32_16x16x32_bf16 a[168:171], a[64:67], a[52:55], a[168:171]
    s_add_u32 s82, s82, s83
    s_add_u32 s48, s20, s82
    v_mfma_f32_16x16x32_bf16 a[176:179], a[64:67], a[56:59], a[176:179]
    ds_read_b128 a[4:7], v8 offset:36864
    s_addc_u32 s49, s21, 0
    s_and_b32 s49, s49, 0xffff
    v_mfma_f32_16x16x32_bf16 a[184:187], a[64:67], a[60:63], a[184:187]
    s_sub_u32 s50, 7340032, s82
    s_mov_b32 s51, 0x20000
    v_mfma_f32_16x16x32_bf16 v[120:123], a[64:67], a[116:119], v[120:123]
    ds_read_b64_tr_b16 a[64:65], v13 offset:0
    s_add_u32 s52, s12, s83
    s_addc_u32 s53, s13, 0
    v_mfma_f32_16x16x32_bf16 a[132:135], a[68:71], a[32:35], a[132:135]
    ds_read_b64_tr_b16 a[66:67], v13 offset:256
    s_and_b32 s53, s53, 0xffff
    s_sub_u32 s54, 2097152, s83
    v_mfma_f32_16x16x32_bf16 a[140:143], a[68:71], a[36:39], a[140:143]
    ds_read_b128 a[8:11], v8 offset:38912
    s_mov_b32 s55, 0x20000
    s_lshl_b32 s3, s60, 11
    v_mfma_f32_16x16x32_bf16 a[148:151], a[68:71], a[40:43], a[148:151]
    v_lshrrev_b32 v34, 4, v0
    v_and_b32 v35, 15, v0
    v_mfma_f32_16x16x32_bf16 a[156:159], a[68:71], a[44:47], a[156:159]
    v_lshlrev_b32 v36, 1, v34
    v_add_u32 v36, 0, v36
    v_mfma_f32_16x16x32_bf16 a[164:167], a[68:71], a[48:51], a[164:167]
    v_xor_b32 v36, v36, v35
    v_lshlrev_b32 v36, 4, v36
    v_mfma_f32_16x16x32_bf16 a[172:175], a[68:71], a[52:55], a[172:175]
    ds_read_b128 a[12:15], v8 offset:40960
    v_lshl_add_u32 v36, v34, 11, v36
    s_lshl_b32 s82, s60, 14
    v_mfma_f32_16x16x32_bf16 a[180:183], a[68:71], a[56:59], a[180:183]
    s_add_u32 s82, s82, 0
    v_add_u32 v17, s82, v36
    v_mfma_f32_16x16x32_bf16 a[188:191], a[68:71], a[60:63], a[188:191]
    s_lshl_b32 s82, s62, 1
    s_add_u32 s82, s82, 0
    v_mfma_f32_16x16x32_bf16 v[124:127], a[68:71], a[116:119], v[124:127]
    ds_read_b64_tr_b16 a[68:69], v15 offset:0
    s_lshl_b32 s82, s82, 3
    s_lshl_b32 s83, s61, 2
    v_mfma_f32_16x16x32_bf16 v[52:55], a[32:35], a[72:75], v[52:55]
    ds_read_b64_tr_b16 a[70:71], v15 offset:256
    s_add_u32 s82, s82, s83
    s_mul_i32 s83, s62, 96
    v_mfma_f32_16x16x32_bf16 v[56:59], a[36:39], a[72:75], v[56:59]
    s_add_u32 s82, s82, s83
    s_lshl_b32 s82, s82, 11
    v_mfma_f32_16x16x32_bf16 v[60:63], a[40:43], a[72:75], v[60:63]
    ds_read_b128 a[16:19], v8 offset:43008
    s_sub_u32 s82, s82, 0
    v_add_u32 v19, s82, v36
    v_mfma_f32_16x16x32_bf16 v[64:67], a[44:47], a[72:75], v[64:67]
    v_lshlrev_b32 v36, 1, v34
    v_add_u32 v36, 8, v36
    v_mfma_f32_16x16x32_bf16 v[68:71], a[48:51], a[72:75], v[68:71]
    ds_read_b128 a[20:23], v8 offset:45056
    v_xor_b32 v36, v36, v35
    v_lshlrev_b32 v36, 4, v36
    v_mfma_f32_16x16x32_bf16 v[72:75], a[52:55], a[72:75], v[72:75]
    v_lshl_add_u32 v36, v34, 11, v36
    s_lshl_b32 s82, s60, 14
    v_mfma_f32_16x16x32_bf16 v[76:79], a[56:59], a[72:75], v[76:79]
    s_add_u32 s82, s82, 7168
    v_add_u32 v18, s82, v36
    v_mfma_f32_16x16x32_bf16 v[80:83], a[60:63], a[72:75], v[80:83]
    s_lshl_b32 s82, s62, 1
    s_add_u32 s82, s82, 1
    v_mfma_f32_16x16x32_bf16 v[48:51], a[116:119], a[72:75], v[48:51]
    ds_read_b64_tr_b16 a[72:73], v13 offset:1024
    s_lshl_b32 s82, s82, 3
    s_lshl_b32 s83, s61, 2
    v_mfma_f32_16x16x32_bf16 v[88:91], a[32:35], a[76:79], v[88:91]
    ds_read_b64_tr_b16 a[74:75], v13 offset:1280
    s_add_u32 s82, s82, s83
    s_mul_i32 s83, s62, 96
    v_mfma_f32_16x16x32_bf16 v[92:95], a[36:39], a[76:79], v[92:95]
    ds_read_b128 a[24:27], v8 offset:47104
    s_add_u32 s82, s82, s83
    s_lshl_b32 s82, s82, 11
    v_mfma_f32_16x16x32_bf16 v[96:99], a[40:43], a[76:79], v[96:99]
    s_sub_u32 s82, s82, 1024
    v_add_u32 v20, s82, v36
    v_mfma_f32_16x16x32_bf16 v[100:103], a[44:47], a[76:79], v[100:103]
    ds_read_b128 a[28:31], v8 offset:49152
    s_xor_b32 s82, s65, 0
    s_lshl_b32 s82, s82, 10
    v_mfma_f32_16x16x32_bf16 v[104:107], a[48:51], a[76:79], v[104:107]
    v_add_u32 v21, s82, v16
    s_xor_b32 s82, s65, 1
    v_mfma_f32_16x16x32_bf16 v[108:111], a[52:55], a[76:79], v[108:111]
    s_lshl_b32 s82, s82, 10
    v_add_u32 v22, s82, v16
    v_mfma_f32_16x16x32_bf16 v[112:115], a[56:59], a[76:79], v[112:115]
    s_xor_b32 s82, s65, 2
    s_lshl_b32 s82, s82, 10
    v_mfma_f32_16x16x32_bf16 v[116:119], a[60:63], a[76:79], v[116:119]
    ds_read_b128 a[112:115], v10 offset:34816
    v_add_u32 v23, s82, v16
    s_xor_b32 s82, s65, 3
    v_mfma_f32_16x16x32_bf16 v[84:87], a[116:119], a[76:79], v[84:87]
    ds_read_b64_tr_b16 a[76:77], v15 offset:1024
    s_lshl_b32 s82, s82, 10
    v_add_u32 v24, s82, v16
    v_mfma_f32_16x16x32_bf16 a[192:195], a[80:83], a[32:35], a[192:195]
    ds_read_b64_tr_b16 a[78:79], v15 offset:1280
    s_mov_b32 s94, 0xbdd2d3e8
    s_mov_b32 s95, 0xbdd2d3e8
    v_mfma_f32_16x16x32_bf16 a[200:203], a[80:83], a[36:39], a[200:203]
    v_mov_b32 v26, 0xc0135761
    v_mov_b32 v27, 0xc0135761
    v_mfma_f32_16x16x32_bf16 a[208:211], a[80:83], a[40:43], a[208:211]
    ds_read_b64_tr_b16 a[96:97], v13 offset:4096
    v_mov_b32 v25, 1
    s_lshl_b32 s82, s60, 12
    v_mfma_f32_16x16x32_bf16 a[216:219], a[80:83], a[44:47], a[216:219]
    s_add_u32 s68, s88, s82
    s_lshl_b32 s82, s61, 13
    v_mfma_f32_16x16x32_bf16 a[224:227], a[80:83], a[48:51], a[224:227]
    s_add_u32 s88, s88, s82
    s_lshr_b32 s82, s66, 1
    v_mfma_f32_16x16x32_bf16 a[232:235], a[80:83], a[52:55], a[232:235]
    s_add_u32 s82, s82, 24
    s_lshl_b32 s82, s82, 14
    v_mfma_f32_16x16x32_bf16 a[240:243], a[80:83], a[56:59], a[240:243]
    ds_read_b64_tr_b16 a[98:99], v13 offset:4352
    s_add_u32 s90, s88, s82
    s_lshl_b32 s82, s66, 14
    v_mfma_f32_16x16x32_bf16 a[248:251], a[80:83], a[60:63], a[248:251]
    ds_read_b64_tr_b16 a[80:81], v13 offset:2048
    v_mfma_f32_16x16x32_bf16 a[196:199], a[84:87], a[32:35], a[196:199]
    ds_read_b64_tr_b16 a[82:83], v13 offset:2304
    v_mfma_f32_16x16x32_bf16 a[204:207], a[84:87], a[36:39], a[204:207]
    v_mfma_f32_16x16x32_bf16 a[212:215], a[84:87], a[40:43], a[212:215]
    ds_read_b64_tr_b16 a[100:101], v15 offset:4096
    v_mfma_f32_16x16x32_bf16 a[220:223], a[84:87], a[44:47], a[220:223]
    v_mfma_f32_16x16x32_bf16 a[228:231], a[84:87], a[48:51], a[228:231]
    v_mfma_f32_16x16x32_bf16 a[236:239], a[84:87], a[52:55], a[236:239]
    v_mfma_f32_16x16x32_bf16 a[244:247], a[84:87], a[56:59], a[244:247]
    ds_read_b64_tr_b16 a[102:103], v15 offset:4352
    v_mfma_f32_16x16x32_bf16 a[252:255], a[84:87], a[60:63], a[252:255]
    ds_read_b64_tr_b16 a[84:85], v15 offset:2048
    v_mfma_f32_16x16x32_bf16 v[128:131], a[88:91], a[32:35], v[128:131]
    ds_read_b64_tr_b16 a[86:87], v15 offset:2304
    v_mfma_f32_16x16x32_bf16 v[144:147], a[88:91], a[36:39], v[144:147]
    v_mfma_f32_16x16x32_bf16 v[160:163], a[88:91], a[40:43], v[160:163]
    v_mfma_f32_16x16x32_bf16 v[176:179], a[88:91], a[44:47], v[176:179]
    v_mfma_f32_16x16x32_bf16 v[192:195], a[88:91], a[48:51], v[192:195]
    v_mfma_f32_16x16x32_bf16 v[208:211], a[88:91], a[52:55], v[208:211]
    v_mfma_f32_16x16x32_bf16 v[224:227], a[88:91], a[56:59], v[224:227]
    v_mfma_f32_16x16x32_bf16 v[240:243], a[88:91], a[60:63], v[240:243]
    ds_read_b64_tr_b16 a[88:89], v13 offset:3072
    v_mfma_f32_16x16x32_bf16 v[132:135], a[92:95], a[32:35], v[132:135]
    ds_read_b64_tr_b16 a[90:91], v13 offset:3328
    v_mfma_f32_16x16x32_bf16 v[148:151], a[92:95], a[36:39], v[148:151]
    v_mfma_f32_16x16x32_bf16 v[164:167], a[92:95], a[40:43], v[164:167]
    v_mfma_f32_16x16x32_bf16 v[180:183], a[92:95], a[44:47], v[180:183]
    v_mfma_f32_16x16x32_bf16 v[196:199], a[92:95], a[48:51], v[196:199]
    v_mfma_f32_16x16x32_bf16 v[212:215], a[92:95], a[52:55], v[212:215]
    v_mfma_f32_16x16x32_bf16 v[228:231], a[92:95], a[56:59], v[228:231]
    v_mfma_f32_16x16x32_bf16 v[244:247], a[92:95], a[60:63], v[244:247]
    ds_read_b64_tr_b16 a[92:93], v15 offset:3072
    v_mfma_f32_16x16x32_bf16 v[136:139], a[104:107], a[32:35], v[136:139]
    ds_read_b64_tr_b16 a[94:95], v15 offset:3328
    v_mfma_f32_16x16x32_bf16 v[152:155], a[104:107], a[36:39], v[152:155]
    v_mfma_f32_16x16x32_bf16 v[168:171], a[104:107], a[40:43], v[168:171]
    v_mfma_f32_16x16x32_bf16 v[184:187], a[104:107], a[44:47], v[184:187]
    v_mfma_f32_16x16x32_bf16 v[200:203], a[104:107], a[48:51], v[200:203]
    v_mfma_f32_16x16x32_bf16 v[216:219], a[104:107], a[52:55], v[216:219]
    v_mfma_f32_16x16x32_bf16 v[232:235], a[104:107], a[56:59], v[232:235]
    v_mfma_f32_16x16x32_bf16 v[248:251], a[104:107], a[60:63], v[248:251]
    v_mfma_f32_16x16x32_bf16 v[140:143], a[108:111], a[32:35], v[140:143]
    v_mfma_f32_16x16x32_bf16 v[156:159], a[108:111], a[36:39], v[156:159]
    v_mfma_f32_16x16x32_bf16 v[172:175], a[108:111], a[40:43], v[172:175]
    v_mfma_f32_16x16x32_bf16 v[188:191], a[108:111], a[44:47], v[188:191]
    v_mfma_f32_16x16x32_bf16 v[204:207], a[108:111], a[48:51], v[204:207]
    v_mfma_f32_16x16x32_bf16 v[220:223], a[108:111], a[52:55], v[220:223]
    v_mfma_f32_16x16x32_bf16 v[236:239], a[108:111], a[56:59], v[236:239]
    v_mfma_f32_16x16x32_bf16 v[252:255], a[108:111], a[60:63], v[252:255]
    s_waitcnt lgkmcnt(0)
    s_barrier
    v_mfma_f32_16x16x32_bf16 a[128:131], a[64:67], a[0:3], a[128:131]
    v_mfma_f32_16x16x32_bf16 a[136:139], a[64:67], a[4:7], a[136:139]
    v_mfma_f32_16x16x32_bf16 a[144:147], a[64:67], a[8:11], a[144:147]
    ds_read_b128 a[32:35], v9 offset:34816
    v_mfma_f32_16x16x32_bf16 a[152:155], a[64:67], a[12:15], a[152:155]
    v_mfma_f32_16x16x32_bf16 a[160:163], a[64:67], a[16:19], a[160:163]
    s_add_u32 s88, s88, s82
    s_add_u32 s89, s88, 262144
    v_mfma_f32_16x16x32_bf16 a[168:171], a[64:67], a[20:23], a[168:171]
    s_mov_b32 s76, s93
    s_lshl_b32 s82, s63, 4
    v_mfma_f32_16x16x32_bf16 a[176:179], a[64:67], a[24:27], a[176:179]
    ds_read_b128 a[36:39], v9 offset:36864
    s_lshl_b32 s83, s60, 2
    s_add_u32 s83, s83, s82
    v_mfma_f32_16x16x32_bf16 a[184:187], a[64:67], a[28:31], a[184:187]
    s_add_u32 s83, s83, s65
    s_lshl_b32 s83, s83, 15
    v_mfma_f32_16x16x32_bf16 v[120:123], a[64:67], a[112:115], v[120:123]
    ds_read_b64_tr_b16 a[64:65], v13 offset:20480
    s_add_u32 s69, s83, 4194304
    s_lshl_b32 s84, s63, 3
    v_mfma_f32_16x16x32_bf16 a[132:135], a[68:71], a[0:3], a[132:135]
    ds_read_b64_tr_b16 a[66:67], v13 offset:20736
    s_add_u32 s84, s84, s66
    s_lshl_b32 s85, s84, 2
    v_mfma_f32_16x16x32_bf16 a[140:143], a[68:71], a[4:7], a[140:143]
    ds_read_b128 a[40:43], v9 offset:38912
    s_add_u32 s85, s85, s60
    s_lshl_b32 s85, s85, 8
    v_mfma_f32_16x16x32_bf16 a[148:151], a[68:71], a[8:11], a[148:151]
    s_add_u32 s77, s85, 39862272
    s_lshl_b32 s84, s84, 18
    v_mfma_f32_16x16x32_bf16 a[156:159], a[68:71], a[12:15], a[156:159]
    s_lshl_b32 s85, s60, 12
    s_add_u32 s84, s84, s85
    v_mfma_f32_16x16x32_bf16 a[164:167], a[68:71], a[16:19], a[164:167]
    s_add_u32 s84, s84, 23068672
    s_xor_b32 s85, s65, 1
    v_mfma_f32_16x16x32_bf16 a[172:175], a[68:71], a[20:23], a[172:175]
    ds_read_b128 a[44:47], v9 offset:40960
    s_lshl_b32 s85, s85, 16
    s_add_u32 s70, s84, s85
    v_mfma_f32_16x16x32_bf16 a[180:183], a[68:71], a[24:27], a[180:183]
    s_add_u32 s70, s70, 16384
    s_lshl_b32 s85, s65, 16
    v_mfma_f32_16x16x32_bf16 a[188:191], a[68:71], a[28:31], a[188:191]
    s_add_u32 s73, s84, s85
    s_add_u32 s73, s73, 16384
    v_mfma_f32_16x16x32_bf16 v[124:127], a[68:71], a[112:115], v[124:127]
    ds_read_b64_tr_b16 a[68:69], v15 offset:20480
    s_xor_b32 s85, s65, 2
    s_lshl_b32 s85, s85, 16
    v_mfma_f32_16x16x32_bf16 v[52:55], a[0:3], a[72:75], v[52:55]
    ds_read_b64_tr_b16 a[70:71], v15 offset:20736
    s_add_u32 s71, s84, s85
    s_add_u32 s71, s71, 32768
    v_mfma_f32_16x16x32_bf16 v[56:59], a[4:7], a[72:75], v[56:59]
    s_lshl_b32 s85, s65, 16
    s_add_u32 s74, s84, s85
    v_mfma_f32_16x16x32_bf16 v[60:63], a[8:11], a[72:75], v[60:63]
    ds_read_b128 a[48:51], v9 offset:43008
    s_add_u32 s74, s74, 32768
    s_xor_b32 s85, s65, 3
    v_mfma_f32_16x16x32_bf16 v[64:67], a[12:15], a[72:75], v[64:67]
    s_lshl_b32 s85, s85, 16
    s_add_u32 s72, s84, s85
    v_mfma_f32_16x16x32_bf16 v[68:71], a[16:19], a[72:75], v[68:71]
    ds_read_b128 a[52:55], v9 offset:45056
    s_add_u32 s72, s72, 49152
    s_lshl_b32 s85, s65, 16
    v_mfma_f32_16x16x32_bf16 v[72:75], a[20:23], a[72:75], v[72:75]
    s_add_u32 s75, s84, s85
    s_add_u32 s75, s75, 49152
    v_mfma_f32_16x16x32_bf16 v[76:79], a[24:27], a[72:75], v[76:79]
    s_lshl_b32 s83, s61, 3
    s_add_u32 s82, s82, s83
    v_mfma_f32_16x16x32_bf16 v[80:83], a[28:31], a[72:75], v[80:83]
    s_lshl_b32 s82, s82, 5
    s_add_u32 s82, s82, s64
    v_mfma_f32_16x16x32_bf16 v[48:51], a[112:115], a[72:75], v[48:51]
    ds_read_b64_tr_b16 a[72:73], v13 offset:21504
    s_lshl_b32 s82, s82, 10
    s_add_u32 s91, s82, 4194304
    v_mfma_f32_16x16x32_bf16 v[88:91], a[0:3], a[76:79], v[88:91]
    ds_read_b64_tr_b16 a[74:75], v13 offset:21760
    v_mov_b32 v42, 1
    v_and_b32 v37, 1, v35
    v_mfma_f32_16x16x32_bf16 v[92:95], a[4:7], a[76:79], v[92:95]
    ds_read_b128 a[56:59], v9 offset:47104
    v_lshl_add_u32 v36, v34, 2, v37
    v_cmp_le_u32 s[4:5], v36, v35
    v_mfma_f32_16x16x32_bf16 v[96:99], a[8:11], a[76:79], v[96:99]
    v_add_u32 v36, 2, v36
    v_cmp_le_u32 s[6:7], v36, v35
    v_mfma_f32_16x16x32_bf16 v[100:103], a[12:15], a[76:79], v[100:103]
    ds_read_b128 a[60:63], v9 offset:49152
    v_mul_u32_u24 v36, 0x0202, v37
    v_lshlrev_b32 v36, 16, v36
    v_mfma_f32_16x16x32_bf16 v[104:107], a[16:19], a[76:79], v[104:107]
    v_add_u32 v36, 0x01000c0c, v36
    v_add_u32 v38, 0x04040000, v36
    v_mfma_f32_16x16x32_bf16 v[108:111], a[20:23], a[76:79], v[108:111]
    v_cndmask_b32 v28, v36, v38, s[4:5]
    v_cndmask_b32 v29, v36, v38, s[6:7]
    v_mfma_f32_16x16x32_bf16 v[112:115], a[24:27], a[76:79], v[112:115]
    v_cmp_eq_u32 vcc, 1, v37
    v_mov_b32 v36, 0x0c0c0100
    v_mfma_f32_16x16x32_bf16 v[116:119], a[28:31], a[76:79], v[116:119]
    ds_read_b128 a[116:119], v11 offset:34816
    v_mov_b32 v38, 0x01000c0c
    v_cndmask_b32 v36, v36, v38, vcc
    v_mfma_f32_16x16x32_bf16 v[84:87], a[112:115], a[76:79], v[84:87]
    ds_read_b64_tr_b16 a[76:77], v15 offset:21504
    v_mov_b32 v38, 0x0c0c0302
    v_mov_b32 v39, 0x03020c0c
    v_mfma_f32_16x16x32_bf16 a[192:195], a[80:83], a[0:3], a[192:195]
    ds_read_b64_tr_b16 a[78:79], v15 offset:21760
    v_cndmask_b32 v38, v38, v39, vcc
    v_mov_b32 v39, 0x0c0c0c0c
    v_mfma_f32_16x16x32_bf16 a[200:203], a[80:83], a[4:7], a[200:203]
    v_cndmask_b32 v30, v36, v39, s[4:5]
    v_cndmask_b32 v31, v38, v39, s[6:7]
    v_mfma_f32_16x16x32_bf16 a[208:211], a[80:83], a[8:11], a[208:211]
    ds_read_b64_tr_b16 a[104:105], v13 offset:24576
    v_cndmask_b32 v32, v39, v36, s[4:5]
    v_cndmask_b32 v33, v39, v38, s[6:7]
    v_mfma_f32_16x16x32_bf16 a[216:219], a[80:83], a[12:15], a[216:219]
    s_or_b32 s82, s63, s61
    s_cmp_eq_u32 s82, 0
    v_mfma_f32_16x16x32_bf16 a[224:227], a[80:83], a[16:19], a[224:227]
    s_cselect_b64 s[4:5], s[4:5], -1
    s_cselect_b64 s[6:7], s[6:7], -1
    v_mfma_f32_16x16x32_bf16 a[232:235], a[80:83], a[20:23], a[232:235]
    s_mov_b32 s14, 0x3e3504f3
    s_mov_b32 s15, 0x3e3504f3
    v_mfma_f32_16x16x32_bf16 a[240:243], a[80:83], a[24:27], a[240:243]
    ds_read_b64_tr_b16 a[106:107], v13 offset:24832
    s_mov_b32 s98, 0x3fb8aa3b
    s_mov_b32 s99, 0x3fb8aa3b
    v_mfma_f32_16x16x32_bf16 a[248:251], a[80:83], a[28:31], a[248:251]
    ds_read_b64_tr_b16 a[80:81], v13 offset:22528
    v_mfma_f32_16x16x32_bf16 a[196:199], a[84:87], a[0:3], a[196:199]
    ds_read_b64_tr_b16 a[82:83], v13 offset:22784
    v_mfma_f32_16x16x32_bf16 a[204:207], a[84:87], a[4:7], a[204:207]
    v_mfma_f32_16x16x32_bf16 a[212:215], a[84:87], a[8:11], a[212:215]
    ds_read_b64_tr_b16 a[108:109], v15 offset:24576
    v_mfma_f32_16x16x32_bf16 a[220:223], a[84:87], a[12:15], a[220:223]
    v_mfma_f32_16x16x32_bf16 a[228:231], a[84:87], a[16:19], a[228:231]
    v_mfma_f32_16x16x32_bf16 a[236:239], a[84:87], a[20:23], a[236:239]
    v_mfma_f32_16x16x32_bf16 a[244:247], a[84:87], a[24:27], a[244:247]
    ds_read_b64_tr_b16 a[110:111], v15 offset:24832
    v_mfma_f32_16x16x32_bf16 a[252:255], a[84:87], a[28:31], a[252:255]
    ds_read_b64_tr_b16 a[84:85], v15 offset:22528
    v_mfma_f32_16x16x32_bf16 v[128:131], a[88:91], a[0:3], v[128:131]
    ds_read_b64_tr_b16 a[86:87], v15 offset:22784
    v_mfma_f32_16x16x32_bf16 v[144:147], a[88:91], a[4:7], v[144:147]
    v_mfma_f32_16x16x32_bf16 v[160:163], a[88:91], a[8:11], v[160:163]
    v_mfma_f32_16x16x32_bf16 v[176:179], a[88:91], a[12:15], v[176:179]
    v_mfma_f32_16x16x32_bf16 v[192:195], a[88:91], a[16:19], v[192:195]
    v_mfma_f32_16x16x32_bf16 v[208:211], a[88:91], a[20:23], v[208:211]
    v_mfma_f32_16x16x32_bf16 v[224:227], a[88:91], a[24:27], v[224:227]
    v_mfma_f32_16x16x32_bf16 v[240:243], a[88:91], a[28:31], v[240:243]
    ds_read_b64_tr_b16 a[88:89], v13 offset:23552
    v_mfma_f32_16x16x32_bf16 v[132:135], a[92:95], a[0:3], v[132:135]
    ds_read_b64_tr_b16 a[90:91], v13 offset:23808
    v_mfma_f32_16x16x32_bf16 v[148:151], a[92:95], a[4:7], v[148:151]
    v_mfma_f32_16x16x32_bf16 v[164:167], a[92:95], a[8:11], v[164:167]
    v_mfma_f32_16x16x32_bf16 v[180:183], a[92:95], a[12:15], v[180:183]
    v_mfma_f32_16x16x32_bf16 v[196:199], a[92:95], a[16:19], v[196:199]
    v_mfma_f32_16x16x32_bf16 v[212:215], a[92:95], a[20:23], v[212:215]
    v_mfma_f32_16x16x32_bf16 v[228:231], a[92:95], a[24:27], v[228:231]
    v_mfma_f32_16x16x32_bf16 v[244:247], a[92:95], a[28:31], v[244:247]
    ds_read_b64_tr_b16 a[92:93], v15 offset:23552
    v_mfma_f32_16x16x32_bf16 v[136:139], a[96:99], a[0:3], v[136:139]
    ds_read_b64_tr_b16 a[94:95], v15 offset:23808
    v_mfma_f32_16x16x32_bf16 v[152:155], a[96:99], a[4:7], v[152:155]
    v_mfma_f32_16x16x32_bf16 v[168:171], a[96:99], a[8:11], v[168:171]
    v_mfma_f32_16x16x32_bf16 v[184:187], a[96:99], a[12:15], v[184:187]
    v_mfma_f32_16x16x32_bf16 v[200:203], a[96:99], a[16:19], v[200:203]
    v_mfma_f32_16x16x32_bf16 v[216:219], a[96:99], a[20:23], v[216:219]
    v_mfma_f32_16x16x32_bf16 v[232:235], a[96:99], a[24:27], v[232:235]
    v_mfma_f32_16x16x32_bf16 v[248:251], a[96:99], a[28:31], v[248:251]
    v_mfma_f32_16x16x32_bf16 v[140:143], a[100:103], a[0:3], v[140:143]
    v_mfma_f32_16x16x32_bf16 v[156:159], a[100:103], a[4:7], v[156:159]
    v_mfma_f32_16x16x32_bf16 v[172:175], a[100:103], a[8:11], v[172:175]
    v_mfma_f32_16x16x32_bf16 v[188:191], a[100:103], a[12:15], v[188:191]
    v_mfma_f32_16x16x32_bf16 v[204:207], a[100:103], a[16:19], v[204:207]
    v_mfma_f32_16x16x32_bf16 v[220:223], a[100:103], a[20:23], v[220:223]
    v_mfma_f32_16x16x32_bf16 v[236:239], a[100:103], a[24:27], v[236:239]
    v_mfma_f32_16x16x32_bf16 v[252:255], a[100:103], a[28:31], v[252:255]
    s_waitcnt lgkmcnt(0)
    s_barrier
    v_mfma_f32_16x16x32_bf16 a[128:131], a[64:67], a[32:35], a[128:131]
    v_mfma_f32_16x16x32_bf16 a[136:139], a[64:67], a[36:39], a[136:139]
    v_mfma_f32_16x16x32_bf16 a[144:147], a[64:67], a[40:43], a[144:147]
    s_mov_b32 s82, 0
    s_add_u32 m0, s3, 0
    v_mfma_f32_16x16x32_bf16 a[152:155], a[64:67], a[44:47], a[152:155]
    buffer_load_dwordx4 v17, s[48:51], s82 offen lds
    v_mfma_f32_16x16x32_bf16 a[160:163], a[64:67], a[48:51], a[160:163]
    v_mfma_f32_16x16x32_bf16 a[168:171], a[64:67], a[52:55], a[168:171]
    v_mfma_f32_16x16x32_bf16 a[176:179], a[64:67], a[56:59], a[176:179]
    v_mfma_f32_16x16x32_bf16 a[184:187], a[64:67], a[60:63], a[184:187]
    buffer_load_dwordx4 v18, s[48:51], s82 offen offset:1024 lds
    v_mfma_f32_16x16x32_bf16 v[120:123], a[64:67], a[116:119], v[120:123]
    v_mfma_f32_16x16x32_bf16 a[132:135], a[68:71], a[32:35], a[132:135]
    v_mfma_f32_16x16x32_bf16 a[140:143], a[68:71], a[36:39], a[140:143]
    v_mfma_f32_16x16x32_bf16 a[148:151], a[68:71], a[40:43], a[148:151]
    s_mov_b32 s83, 229376
    s_add_u32 m0, s3, 8192
    v_mfma_f32_16x16x32_bf16 a[156:159], a[68:71], a[44:47], a[156:159]
    buffer_load_dwordx4 v17, s[48:51], s83 offen lds
    v_mfma_f32_16x16x32_bf16 a[164:167], a[68:71], a[48:51], a[164:167]
    v_mfma_f32_16x16x32_bf16 a[172:175], a[68:71], a[52:55], a[172:175]
    v_mfma_f32_16x16x32_bf16 a[180:183], a[68:71], a[56:59], a[180:183]
    v_mfma_f32_16x16x32_bf16 a[188:191], a[68:71], a[60:63], a[188:191]
    buffer_load_dwordx4 v18, s[48:51], s83 offen offset:1024 lds
    v_mfma_f32_16x16x32_bf16 v[124:127], a[68:71], a[116:119], v[124:127]
    v_mfma_f32_16x16x32_bf16 v[52:55], a[32:35], a[72:75], v[52:55]
    v_mfma_f32_16x16x32_bf16 v[56:59], a[36:39], a[72:75], v[56:59]
    v_mfma_f32_16x16x32_bf16 v[60:63], a[40:43], a[72:75], v[60:63]
    s_mov_b32 s82, 458752
    s_add_u32 m0, s3, 16384
    v_mfma_f32_16x16x32_bf16 v[64:67], a[44:47], a[72:75], v[64:67]
    buffer_load_dwordx4 v17, s[48:51], s82 offen lds
    v_mfma_f32_16x16x32_bf16 v[68:71], a[48:51], a[72:75], v[68:71]
    v_mfma_f32_16x16x32_bf16 v[72:75], a[52:55], a[72:75], v[72:75]
    v_mfma_f32_16x16x32_bf16 v[76:79], a[56:59], a[72:75], v[76:79]
    v_mfma_f32_16x16x32_bf16 v[80:83], a[60:63], a[72:75], v[80:83]
    buffer_load_dwordx4 v18, s[48:51], s82 offen offset:1024 lds
    v_mfma_f32_16x16x32_bf16 v[48:51], a[116:119], a[72:75], v[48:51]
    v_mfma_f32_16x16x32_bf16 v[88:91], a[32:35], a[76:79], v[88:91]
    v_mfma_f32_16x16x32_bf16 v[92:95], a[36:39], a[76:79], v[92:95]
    v_mfma_f32_16x16x32_bf16 v[96:99], a[40:43], a[76:79], v[96:99]
    s_mov_b32 s83, 688128
    s_add_u32 m0, s3, 24576
    v_mfma_f32_16x16x32_bf16 v[100:103], a[44:47], a[76:79], v[100:103]
    buffer_load_dwordx4 v17, s[48:51], s83 offen lds
    v_mfma_f32_16x16x32_bf16 v[104:107], a[48:51], a[76:79], v[104:107]
    v_mfma_f32_16x16x32_bf16 v[108:111], a[52:55], a[76:79], v[108:111]
    v_mfma_f32_16x16x32_bf16 v[112:115], a[56:59], a[76:79], v[112:115]
    v_mfma_f32_16x16x32_bf16 v[116:119], a[60:63], a[76:79], v[116:119]
    buffer_load_dwordx4 v18, s[48:51], s83 offen offset:1024 lds
    v_mfma_f32_16x16x32_bf16 v[84:87], a[116:119], a[76:79], v[84:87]
    v_mfma_f32_16x16x32_bf16 a[192:195], a[80:83], a[32:35], a[192:195]
    v_mfma_f32_16x16x32_bf16 a[200:203], a[80:83], a[36:39], a[200:203]
    v_mfma_f32_16x16x32_bf16 a[208:211], a[80:83], a[40:43], a[208:211]
    s_mov_b32 s82, 917504
    s_add_u32 m0, s3, 32768
    v_mfma_f32_16x16x32_bf16 a[216:219], a[80:83], a[44:47], a[216:219]
    buffer_load_dwordx4 v17, s[48:51], s82 offen lds
    v_mfma_f32_16x16x32_bf16 a[224:227], a[80:83], a[48:51], a[224:227]
    v_mfma_f32_16x16x32_bf16 a[232:235], a[80:83], a[52:55], a[232:235]
    v_mfma_f32_16x16x32_bf16 a[240:243], a[80:83], a[56:59], a[240:243]
    v_mfma_f32_16x16x32_bf16 a[248:251], a[80:83], a[60:63], a[248:251]
    buffer_load_dwordx4 v18, s[48:51], s82 offen offset:1024 lds
    v_mfma_f32_16x16x32_bf16 a[196:199], a[84:87], a[32:35], a[196:199]
    v_mfma_f32_16x16x32_bf16 a[204:207], a[84:87], a[36:39], a[204:207]
    v_mfma_f32_16x16x32_bf16 a[212:215], a[84:87], a[40:43], a[212:215]
    v_mfma_f32_16x16x32_bf16 a[220:223], a[84:87], a[44:47], a[220:223]
    s_mov_b32 s83, 1146880
    s_add_u32 m0, s3, 40960
    v_mfma_f32_16x16x32_bf16 a[228:231], a[84:87], a[48:51], a[228:231]
    buffer_load_dwordx4 v17, s[48:51], s83 offen lds
    v_mfma_f32_16x16x32_bf16 a[236:239], a[84:87], a[52:55], a[236:239]
    v_mfma_f32_16x16x32_bf16 a[244:247], a[84:87], a[56:59], a[244:247]
    v_mfma_f32_16x16x32_bf16 a[252:255], a[84:87], a[60:63], a[252:255]
    v_mfma_f32_16x16x32_bf16 v[128:131], a[88:91], a[32:35], v[128:131]
    buffer_load_dwordx4 v18, s[48:51], s83 offen offset:1024 lds
    v_mfma_f32_16x16x32_bf16 v[144:147], a[88:91], a[36:39], v[144:147]
    v_mfma_f32_16x16x32_bf16 v[160:163], a[88:91], a[40:43], v[160:163]
    v_mfma_f32_16x16x32_bf16 v[176:179], a[88:91], a[44:47], v[176:179]
    v_mfma_f32_16x16x32_bf16 v[192:195], a[88:91], a[48:51], v[192:195]
    s_mov_b32 s82, 1376256
    s_add_u32 m0, s3, 49152
    v_mfma_f32_16x16x32_bf16 v[208:211], a[88:91], a[52:55], v[208:211]
    buffer_load_dwordx4 v17, s[48:51], s82 offen lds
    v_mfma_f32_16x16x32_bf16 v[224:227], a[88:91], a[56:59], v[224:227]
    v_mfma_f32_16x16x32_bf16 v[240:243], a[88:91], a[60:63], v[240:243]
    v_mfma_f32_16x16x32_bf16 v[132:135], a[92:95], a[32:35], v[132:135]
    v_mfma_f32_16x16x32_bf16 v[148:151], a[92:95], a[36:39], v[148:151]
    buffer_load_dwordx4 v18, s[48:51], s82 offen offset:1024 lds
    v_mfma_f32_16x16x32_bf16 v[164:167], a[92:95], a[40:43], v[164:167]
    v_mfma_f32_16x16x32_bf16 v[180:183], a[92:95], a[44:47], v[180:183]
    v_mfma_f32_16x16x32_bf16 v[196:199], a[92:95], a[48:51], v[196:199]
    v_mfma_f32_16x16x32_bf16 v[212:215], a[92:95], a[52:55], v[212:215]
    s_mov_b32 s83, 1605632
    s_add_u32 m0, s3, 57344
    v_mfma_f32_16x16x32_bf16 v[228:231], a[92:95], a[56:59], v[228:231]
    buffer_load_dwordx4 v17, s[48:51], s83 offen lds
    v_mfma_f32_16x16x32_bf16 v[244:247], a[92:95], a[60:63], v[244:247]
    v_mfma_f32_16x16x32_bf16 v[136:139], a[104:107], a[32:35], v[136:139]
    v_mfma_f32_16x16x32_bf16 v[152:155], a[104:107], a[36:39], v[152:155]
    v_mfma_f32_16x16x32_bf16 v[168:171], a[104:107], a[40:43], v[168:171]
    buffer_load_dwordx4 v18, s[48:51], s83 offen offset:1024 lds
    v_mfma_f32_16x16x32_bf16 v[184:187], a[104:107], a[44:47], v[184:187]
    v_mfma_f32_16x16x32_bf16 v[200:203], a[104:107], a[48:51], v[200:203]
    v_mfma_f32_16x16x32_bf16 v[216:219], a[104:107], a[52:55], v[216:219]
    v_mfma_f32_16x16x32_bf16 v[232:235], a[104:107], a[56:59], v[232:235]
    v_mfma_f32_16x16x32_bf16 v[248:251], a[104:107], a[60:63], v[248:251]
    v_mfma_f32_16x16x32_bf16 v[140:143], a[108:111], a[32:35], v[140:143]
    v_mfma_f32_16x16x32_bf16 v[156:159], a[108:111], a[36:39], v[156:159]
    v_mfma_f32_16x16x32_bf16 v[172:175], a[108:111], a[40:43], v[172:175]
    v_mfma_f32_16x16x32_bf16 v[188:191], a[108:111], a[44:47], v[188:191]
    v_mfma_f32_16x16x32_bf16 v[204:207], a[108:111], a[48:51], v[204:207]
    v_mfma_f32_16x16x32_bf16 v[220:223], a[108:111], a[52:55], v[220:223]
    v_mfma_f32_16x16x32_bf16 v[236:239], a[108:111], a[56:59], v[236:239]
    v_mfma_f32_16x16x32_bf16 v[252:255], a[108:111], a[60:63], v[252:255]
    s_branch L_epi
L_g1_1:
    s_mov_b32 m0, s14
    s_mov_b32 s77, 4096
    buffer_load_dwordx4 v1, s[28:31], s77 offen sc1 lds
    s_mov_b32 s77, 19456
    buffer_load_dwordx4 v1, s[28:31], s77 offen offset:1024 sc1 lds
    v_add_u32 v1, 128, v1
    s_mov_b32 m0, s15
    s_mov_b32 s77, 4096
    buffer_load_dwordx4 v1, s[28:31], s77 offen sc1 lds
    s_mov_b32 s77, 19456
    buffer_load_dwordx4 v1, s[28:31], s77 offen offset:1024 sc1 lds
    v_add_u32 v1, 128, v1
    s_waitcnt vmcnt(2)
    s_barrier
    ds_read_b64_tr_b16 a[64:65], v12 offset:0
    ds_read_b64_tr_b16 a[66:67], v12 offset:256
    ds_read_b64_tr_b16 a[68:69], v14 offset:0
    ds_read_b64_tr_b16 a[70:71], v14 offset:256
    ds_read_b64_tr_b16 a[72:73], v12 offset:1024
    ds_read_b64_tr_b16 a[74:75], v12 offset:1280
    ds_read_b64_tr_b16 a[76:77], v14 offset:1024
    ds_read_b64_tr_b16 a[78:79], v14 offset:1280
    ds_read_b64_tr_b16 a[80:81], v12 offset:2048
    ds_read_b64_tr_b16 a[82:83], v12 offset:2304
    ds_read_b64_tr_b16 a[84:85], v14 offset:2048
    ds_read_b64_tr_b16 a[86:87], v14 offset:2304
    ds_read_b64_tr_b16 a[88:89], v12 offset:3072
    ds_read_b64_tr_b16 a[90:91], v12 offset:3328
    ds_read_b64_tr_b16 a[92:93], v14 offset:3072
    ds_read_b64_tr_b16 a[94:95], v14 offset:3328
    ds_read_b64_tr_b16 a[96:97], v12 offset:4096
    ds_read_b64_tr_b16 a[98:99], v12 offset:4352
    ds_read_b64_tr_b16 a[100:101], v14 offset:4096
    ds_read_b64_tr_b16 a[102:103], v14 offset:4352
    ds_read_b128 a[0:3], v8 offset:0
    ds_read_b128 a[4:7], v8 offset:2048
    ds_read_b128 a[8:11], v8 offset:4096
    ds_read_b128 a[12:15], v8 offset:6144
    ds_read_b128 a[16:19], v8 offset:8192
    ds_read_b128 a[20:23], v8 offset:10240
    ds_read_b128 a[24:27], v8 offset:12288
    ds_read_b128 a[28:31], v8 offset:14336
    s_add_u32 m0, s78, 40960
    s_nop 0
    buffer_load_dwordx4 v2, s[32:35], s68 offen offset:0 lds
    buffer_load_dwordx4 v2, s[32:35], s69 offen offset:1024 lds
    buffer_load_dwordx4 v2, s[32:35], s70 offen offset:2048 lds
    v_add_u32 v2, 196608, v2
    buffer_load_dwordx4 v3, s[36:39], s71 offen offset:3072 lds
    s_add_u32 m0, s78, 45056
    s_nop 0
    buffer_load_dwordx4 v3, s[40:43], s72 offen offset:0 lds
    buffer_load_dwordx4 v3, s[36:39], s73 offen offset:1024 lds
    buffer_load_dwordx4 v3, s[40:43], s74 offen offset:2048 lds
    buffer_load_dwordx4 v3, s[36:39], s75 offen offset:3072 lds
    s_add_u32 m0, s78, 49152
    s_nop 0
    buffer_load_dwordx4 v3, s[40:43], s76 offen offset:0 lds
    v_add_u32 v3, 229376, v3
    global_load_lds_dwordx4 v[4:5], off offset:1024
    v_lshl_add_u64 v[4:5], v[4:5], 0, s[80:81]
    s_add_u32 m0, s78, 61440
    s_nop 0
    buffer_load_dwordx4 v2, s[32:35], s68 offen offset:0 lds
    buffer_load_dwordx4 v2, s[32:35], s69 offen offset:1024 lds
    buffer_load_dwordx4 v2, s[32:35], s70 offen offset:2048 lds
    v_add_u32 v2, 196608, v2
    buffer_load_dwordx4 v3, s[36:39], s71 offen offset:3072 lds
    s_add_u32 m0, s78, 65536
    s_nop 0
    buffer_load_dwordx4 v3, s[40:43], s72 offen offset:0 lds
    buffer_load_dwordx4 v3, s[36:39], s73 offen offset:1024 lds
    buffer_load_dwordx4 v3, s[40:43], s74 offen offset:2048 lds
    buffer_load_dwordx4 v3, s[36:39], s75 offen offset:3072 lds
    s_add_u32 m0, s78, 69632
    s_nop 0
    buffer_load_dwordx4 v3, s[40:43], s76 offen offset:0 lds
    v_add_u32 v3, 229376, v3
    global_load_lds_dwordx4 v[4:5], off offset:1024
    v_lshl_add_u64 v[4:5], v[4:5], 0, s[80:81]
    s_mov_b32 s67, 7
    v_mov_b32 v20, 0x7ff00000
.p2align 3
L_loop1:
    s_waitcnt vmcnt(23) lgkmcnt(0)
    s_barrier
    v_mfma_f32_16x16x32_bf16 v[128:131], a[64:67], a[0:3], v[128:131]
    s_add_u32 m0, s78, 0
    buffer_load_dword v7, v6, s[44:47], s4 offen
    v_add_u32_e64 v6, s79, v6
    v_mfma_f32_16x16x32_bf16 v[144:147], a[64:67], a[4:7], v[144:147]
    buffer_load_dwordx4 v2, s[32:35], s68 offen offset:0 lds
    v_mfma_f32_16x16x32_bf16 v[160:163], a[64:67], a[8:11], v[160:163]
    ds_read_b128 a[32:35], v9 offset:0
    v_mfma_f32_16x16x32_bf16 v[176:179], a[64:67], a[12:15], v[176:179]
    v_mfma_f32_16x16x32_bf16 v[192:195], a[64:67], a[16:19], v[192:195]
    v_mfma_f32_16x16x32_bf16 v[208:211], a[64:67], a[20:23], v[208:211]
    v_mfma_f32_16x16x32_bf16 v[224:227], a[64:67], a[24:27], v[224:227]
    ds_read_b128 a[36:39], v9 offset:2048
    v_mfma_f32_16x16x32_bf16 v[240:243], a[64:67], a[28:31], v[240:243]
    ds_read_b64_tr_b16 a[64:65], v12 offset:20480
    v_mfma_f32_16x16x32_bf16 v[132:135], a[68:71], a[0:3], v[132:135]
    ds_read_b64_tr_b16 a[66:67], v12 offset:20736
    v_mfma_f32_16x16x32_bf16 v[148:151], a[68:71], a[4:7], v[148:151]
    buffer_load_dwordx4 v2, s[32:35], s69 offen offset:1024 lds
    v_mfma_f32_16x16x32_bf16 v[164:167], a[68:71], a[8:11], v[164:167]
    ds_read_b128 a[40:43], v9 offset:4096
    v_mfma_f32_16x16x32_bf16 v[180:183], a[68:71], a[12:15], v[180:183]
    v_mfma_f32_16x16x32_bf16 v[196:199], a[68:71], a[16:19], v[196:199]
    v_mfma_f32_16x16x32_bf16 v[212:215], a[68:71], a[20:23], v[212:215]
    buffer_load_dwordx4 v2, s[32:35], s70 offen offset:2048 lds
    v_add_u32 v2, 196608, v2
    v_mfma_f32_16x16x32_bf16 v[228:231], a[68:71], a[24:27], v[228:231]
    ds_read_b128 a[44:47], v9 offset:6144
    v_mfma_f32_16x16x32_bf16 v[244:247], a[68:71], a[28:31], v[244:247]
    ds_read_b64_tr_b16 a[68:69], v14 offset:20480
    v_mfma_f32_16x16x32_bf16 v[136:139], a[72:75], a[0:3], v[136:139]
    ds_read_b64_tr_b16 a[70:71], v14 offset:20736
    v_mfma_f32_16x16x32_bf16 v[152:155], a[72:75], a[4:7], v[152:155]
    v_mfma_f32_16x16x32_bf16 v[168:171], a[72:75], a[8:11], v[168:171]
    ds_read_b128 a[48:51], v9 offset:8192
    v_mfma_f32_16x16x32_bf16 v[184:187], a[72:75], a[12:15], v[184:187]
    buffer_load_dwordx4 v3, s[36:39], s71 offen offset:3072 lds
    v_mfma_f32_16x16x32_bf16 v[200:203], a[72:75], a[16:19], v[200:203]
    v_mfma_f32_16x16x32_bf16 v[216:219], a[72:75], a[20:23], v[216:219]
    v_mfma_f32_16x16x32_bf16 v[232:235], a[72:75], a[24:27], v[232:235]
    ds_read_b128 a[52:55], v9 offset:10240
    v_mfma_f32_16x16x32_bf16 v[248:251], a[72:75], a[28:31], v[248:251]
    ds_read_b64_tr_b16 a[72:73], v12 offset:21504
    v_mfma_f32_16x16x32_bf16 v[140:143], a[76:79], a[0:3], v[140:143]
    ds_read_b64_tr_b16 a[74:75], v12 offset:21760
    s_add_u32 m0, s78, 4096
    v_mfma_f32_16x16x32_bf16 v[156:159], a[76:79], a[4:7], v[156:159]
    buffer_load_dwordx4 v3, s[40:43], s72 offen offset:0 lds
    v_mfma_f32_16x16x32_bf16 v[172:175], a[76:79], a[8:11], v[172:175]
    ds_read_b128 a[56:59], v9 offset:12288
    v_mfma_f32_16x16x32_bf16 v[188:191], a[76:79], a[12:15], v[188:191]
    v_mfma_f32_16x16x32_bf16 v[204:207], a[76:79], a[16:19], v[204:207]
    v_mfma_f32_16x16x32_bf16 v[220:223], a[76:79], a[20:23], v[220:223]
    v_mfma_f32_16x16x32_bf16 v[236:239], a[76:79], a[24:27], v[236:239]
    ds_read_b128 a[60:63], v9 offset:14336
    v_mfma_f32_16x16x32_bf16 v[252:255], a[76:79], a[28:31], v[252:255]
    ds_read_b64_tr_b16 a[76:77], v14 offset:21504
    v_mfma_f32_16x16x32_bf16 a[128:131], a[80:83], a[0:3], a[128:131]
    ds_read_b64_tr_b16 a[78:79], v14 offset:21760
    v_mfma_f32_16x16x32_bf16 a[144:147], a[80:83], a[4:7], a[144:147]
    buffer_load_dwordx4 v3, s[36:39], s73 offen offset:1024 lds
    v_mfma_f32_16x16x32_bf16 a[160:163], a[80:83], a[8:11], a[160:163]
    ds_read_b64_tr_b16 a[104:105], v12 offset:24576
    v_mfma_f32_16x16x32_bf16 a[176:179], a[80:83], a[12:15], a[176:179]
    v_mfma_f32_16x16x32_bf16 a[192:195], a[80:83], a[16:19], a[192:195]
    v_mfma_f32_16x16x32_bf16 a[208:211], a[80:83], a[20:23], a[208:211]
    v_mfma_f32_16x16x32_bf16 a[224:227], a[80:83], a[24:27], a[224:227]
    ds_read_b64_tr_b16 a[106:107], v12 offset:24832
    v_mfma_f32_16x16x32_bf16 a[240:243], a[80:83], a[28:31], a[240:243]
    ds_read_b64_tr_b16 a[80:81], v12 offset:22528
    v_mfma_f32_16x16x32_bf16 a[132:135], a[84:87], a[0:3], a[132:135]
    ds_read_b64_tr_b16 a[82:83], v12 offset:22784
    v_mfma_f32_16x16x32_bf16 a[148:151], a[84:87], a[4:7], a[148:151]
    buffer_load_dwordx4 v3, s[40:43], s74 offen offset:2048 lds
    v_mfma_f32_16x16x32_bf16 a[164:167], a[84:87], a[8:11], a[164:167]
    ds_read_b64_tr_b16 a[108:109], v14 offset:24576
    v_mfma_f32_16x16x32_bf16 a[180:183], a[84:87], a[12:15], a[180:183]
    v_mfma_f32_16x16x32_bf16 a[196:199], a[84:87], a[16:19], a[196:199]
    buffer_load_dwordx4 v3, s[36:39], s75 offen offset:3072 lds
    v_mfma_f32_16x16x32_bf16 a[212:215], a[84:87], a[20:23], a[212:215]
    v_mfma_f32_16x16x32_bf16 a[228:231], a[84:87], a[24:27], a[228:231]
    ds_read_b64_tr_b16 a[110:111], v14 offset:24832
    v_mfma_f32_16x16x32_bf16 a[244:247], a[84:87], a[28:31], a[244:247]
    ds_read_b64_tr_b16 a[84:85], v14 offset:22528
    v_mfma_f32_16x16x32_bf16 a[136:139], a[88:91], a[0:3], a[136:139]
    ds_read_b64_tr_b16 a[86:87], v14 offset:22784
    v_mfma_f32_16x16x32_bf16 a[152:155], a[88:91], a[4:7], a[152:155]
    s_add_u32 m0, s78, 8192
    v_mfma_f32_16x16x32_bf16 a[168:171], a[88:91], a[8:11], a[168:171]
    buffer_load_dwordx4 v3, s[40:43], s76 offen offset:0 lds
    v_add_u32 v3, 229376, v3
    v_mfma_f32_16x16x32_bf16 a[184:187], a[88:91], a[12:15], a[184:187]
    v_mfma_f32_16x16x32_bf16 a[200:203], a[88:91], a[16:19], a[200:203]
    v_mfma_f32_16x16x32_bf16 a[216:219], a[88:91], a[20:23], a[216:219]
    v_mfma_f32_16x16x32_bf16 a[232:235], a[88:91], a[24:27], a[232:235]
    v_mfma_f32_16x16x32_bf16 a[248:251], a[88:91], a[28:31], a[248:251]
    ds_read_b64_tr_b16 a[88:89], v12 offset:23552
    v_mfma_f32_16x16x32_bf16 a[140:143], a[92:95], a[0:3], a[140:143]
    ds_read_b64_tr_b16 a[90:91], v12 offset:23808
    v_mfma_f32_16x16x32_bf16 a[156:159], a[92:95], a[4:7], a[156:159]
    global_load_lds_dwordx4 v[4:5], off offset:1024
    v_lshl_add_u64 v[4:5], v[4:5], 0, s[80:81]
    v_mfma_f32_16x16x32_bf16 a[172:175], a[92:95], a[8:11], a[172:175]
    v_mfma_f32_16x16x32_bf16 a[188:191], a[92:95], a[12:15], a[188:191]
    v_mfma_f32_16x16x32_bf16 a[204:207], a[92:95], a[16:19], a[204:207]
    v_mfma_f32_16x16x32_bf16 a[220:223], a[92:95], a[20:23], a[220:223]
    v_mfma_f32_16x16x32_bf16 a[236:239], a[92:95], a[24:27], a[236:239]
    v_mfma_f32_16x16x32_bf16 a[252:255], a[92:95], a[28:31], a[252:255]
    ds_read_b64_tr_b16 a[92:93], v14 offset:23552
    v_mfma_f32_16x16x32_bf16 v[48:51], a[96:99], a[0:3], v[48:51]
    ds_read_b64_tr_b16 a[94:95], v14 offset:23808
    v_mfma_f32_16x16x32_bf16 v[52:55], a[96:99], a[4:7], v[52:55]
    v_mfma_f32_16x16x32_bf16 v[64:67], a[96:99], a[8:11], v[64:67]
    v_mfma_f32_16x16x32_bf16 v[68:71], a[96:99], a[12:15], v[68:71]
    v_mfma_f32_16x16x32_bf16 v[80:83], a[96:99], a[16:19], v[80:83]
    v_mfma_f32_16x16x32_bf16 v[84:87], a[96:99], a[20:23], v[84:87]
    v_mfma_f32_16x16x32_bf16 v[96:99], a[96:99], a[24:27], v[96:99]
    v_mfma_f32_16x16x32_bf16 v[100:103], a[96:99], a[28:31], v[100:103]
    v_mfma_f32_16x16x32_bf16 v[56:59], a[100:103], a[0:3], v[56:59]
    v_mfma_f32_16x16x32_bf16 v[60:63], a[100:103], a[4:7], v[60:63]
    v_mfma_f32_16x16x32_bf16 v[72:75], a[100:103], a[8:11], v[72:75]
    v_mfma_f32_16x16x32_bf16 v[76:79], a[100:103], a[12:15], v[76:79]
    v_mfma_f32_16x16x32_bf16 v[88:91], a[100:103], a[16:19], v[88:91]
    v_mfma_f32_16x16x32_bf16 v[92:95], a[100:103], a[20:23], v[92:95]
    v_mfma_f32_16x16x32_bf16 v[104:107], a[100:103], a[24:27], v[104:107]
    v_mfma_f32_16x16x32_bf16 v[108:111], a[100:103], a[28:31], v[108:111]
    s_waitcnt vmcnt(21) lgkmcnt(0)
    s_barrier
    v_mfma_f32_16x16x32_bf16 v[128:131], a[64:67], a[32:35], v[128:131]
    s_mov_b32 m0, s14
    s_mov_b32 s77, 4096
    v_mfma_f32_16x16x32_bf16 v[144:147], a[64:67], a[36:39], v[144:147]
    buffer_load_dwordx4 v1, s[28:31], s77 offen sc1 lds
    v_mfma_f32_16x16x32_bf16 v[160:163], a[64:67], a[40:43], v[160:163]
    ds_read_b128 a[0:3], v8 offset:34816
    v_mfma_f32_16x16x32_bf16 v[176:179], a[64:67], a[44:47], v[176:179]
    v_mfma_f32_16x16x32_bf16 v[192:195], a[64:67], a[48:51], v[192:195]
    v_mfma_f32_16x16x32_bf16 v[208:211], a[64:67], a[52:55], v[208:211]
    v_mfma_f32_16x16x32_bf16 v[224:227], a[64:67], a[56:59], v[224:227]
    ds_read_b128 a[4:7], v8 offset:36864
    v_mfma_f32_16x16x32_bf16 v[240:243], a[64:67], a[60:63], v[240:243]
    ds_read_b64_tr_b16 a[64:65], v13 offset:0
    v_mfma_f32_16x16x32_bf16 v[132:135], a[68:71], a[32:35], v[132:135]
    ds_read_b64_tr_b16 a[66:67], v13 offset:256
    s_mov_b32 s77, 19456
    v_mfma_f32_16x16x32_bf16 v[148:151], a[68:71], a[36:39], v[148:151]
    buffer_load_dwordx4 v1, s[28:31], s77 offen offset:1024 sc1 lds
    v_add_u32 v1, 128, v1
    v_mfma_f32_16x16x32_bf16 v[164:167], a[68:71], a[40:43], v[164:167]
    ds_read_b128 a[8:11], v8 offset:38912
    s_add_u32 m0, s78, 20480
    v_mfma_f32_16x16x32_bf16 v[180:183], a[68:71], a[44:47], v[180:183]
    buffer_load_dwordx4 v2, s[32:35], s68 offen offset:0 lds
    v_mfma_f32_16x16x32_bf16 v[196:199], a[68:71], a[48:51], v[196:199]
    v_mfma_f32_16x16x32_bf16 v[212:215], a[68:71], a[52:55], v[212:215]
    v_mfma_f32_16x16x32_bf16 v[228:231], a[68:71], a[56:59], v[228:231]
    ds_read_b128 a[12:15], v8 offset:40960
    v_mfma_f32_16x16x32_bf16 v[244:247], a[68:71], a[60:63], v[244:247]
    ds_read_b64_tr_b16 a[68:69], v15 offset:0
    v_mfma_f32_16x16x32_bf16 v[136:139], a[72:75], a[32:35], v[136:139]
    ds_read_b64_tr_b16 a[70:71], v15 offset:256
    v_mfma_f32_16x16x32_bf16 v[152:155], a[72:75], a[36:39], v[152:155]
    buffer_load_dwordx4 v2, s[32:35], s69 offen offset:1024 lds
    v_mfma_f32_16x16x32_bf16 v[168:171], a[72:75], a[40:43], v[168:171]
    ds_read_b128 a[16:19], v8 offset:43008
    v_mfma_f32_16x16x32_bf16 v[184:187], a[72:75], a[44:47], v[184:187]
    v_mfma_f32_16x16x32_bf16 v[200:203], a[72:75], a[48:51], v[200:203]
    v_mfma_f32_16x16x32_bf16 v[216:219], a[72:75], a[52:55], v[216:219]
    buffer_load_dwordx4 v2, s[32:35], s70 offen offset:2048 lds
    v_add_u32 v2, 196608, v2
    v_mfma_f32_16x16x32_bf16 v[232:235], a[72:75], a[56:59], v[232:235]
    ds_read_b128 a[20:23], v8 offset:45056
    v_mfma_f32_16x16x32_bf16 v[248:251], a[72:75], a[60:63], v[248:251]
    ds_read_b64_tr_b16 a[72:73], v13 offset:1024
    v_mfma_f32_16x16x32_bf16 v[140:143], a[76:79], a[32:35], v[140:143]
    ds_read_b64_tr_b16 a[74:75], v13 offset:1280
    v_mfma_f32_16x16x32_bf16 v[156:159], a[76:79], a[36:39], v[156:159]
    v_mfma_f32_16x16x32_bf16 v[172:175], a[76:79], a[40:43], v[172:175]
    ds_read_b128 a[24:27], v8 offset:47104
    v_mfma_f32_16x16x32_bf16 v[188:191], a[76:79], a[44:47], v[188:191]
    buffer_load_dwordx4 v3, s[36:39], s71 offen offset:3072 lds
    v_mfma_f32_16x16x32_bf16 v[204:207], a[76:79], a[48:51], v[204:207]
    v_mfma_f32_16x16x32_bf16 v[220:223], a[76:79], a[52:55], v[220:223]
    v_mfma_f32_16x16x32_bf16 v[236:239], a[76:79], a[56:59], v[236:239]
    ds_read_b128 a[28:31], v8 offset:49152
    v_mfma_f32_16x16x32_bf16 v[252:255], a[76:79], a[60:63], v[252:255]
    ds_read_b64_tr_b16 a[76:77], v15 offset:1024
    v_mfma_f32_16x16x32_bf16 a[128:131], a[80:83], a[32:35], a[128:131]
    ds_read_b64_tr_b16 a[78:79], v15 offset:1280
    s_add_u32 m0, s78, 24576
    v_mfma_f32_16x16x32_bf16 a[144:147], a[80:83], a[36:39], a[144:147]
    buffer_load_dwordx4 v3, s[40:43], s72 offen offset:0 lds
    v_mfma_f32_16x16x32_bf16 a[160:163], a[80:83], a[40:43], a[160:163]
    ds_read_b64_tr_b16 a[96:97], v13 offset:4096
    v_mfma_f32_16x16x32_bf16 a[176:179], a[80:83], a[44:47], a[176:179]
    v_mfma_f32_16x16x32_bf16 a[192:195], a[80:83], a[48:51], a[192:195]
    v_mfma_f32_16x16x32_bf16 a[208:211], a[80:83], a[52:55], a[208:211]
    buffer_load_dwordx4 v3, s[36:39], s73 offen offset:1024 lds
    v_mfma_f32_16x16x32_bf16 a[224:227], a[80:83], a[56:59], a[224:227]
    ds_read_b64_tr_b16 a[98:99], v13 offset:4352
    v_mfma_f32_16x16x32_bf16 a[240:243], a[80:83], a[60:63], a[240:243]
    ds_read_b64_tr_b16 a[80:81], v13 offset:2048
    v_mfma_f32_16x16x32_bf16 a[132:135], a[84:87], a[32:35], a[132:135]
    ds_read_b64_tr_b16 a[82:83], v13 offset:2304
    v_mfma_f32_16x16x32_bf16 a[148:151], a[84:87], a[36:39], a[148:151]
    v_mfma_f32_16x16x32_bf16 a[164:167], a[84:87], a[40:43], a[164:167]
    ds_read_b64_tr_b16 a[100:101], v15 offset:4096
    v_mfma_f32_16x16x32_bf16 a[180:183], a[84:87], a[44:47], a[180:183]
    buffer_load_dwordx4 v3, s[40:43], s74 offen offset:2048 lds
    v_mfma_f32_16x16x32_bf16 a[196:199], a[84:87], a[48:51], a[196:199]
    v_mfma_f32_16x16x32_bf16 a[212:215], a[84:87], a[52:55], a[212:215]
    v_mfma_f32_16x16x32_bf16 a[228:231], a[84:87], a[56:59], a[228:231]
    ds_read_b64_tr_b16 a[102:103], v15 offset:4352
    v_mfma_f32_16x16x32_bf16 a[244:247], a[84:87], a[60:63], a[244:247]
    ds_read_b64_tr_b16 a[84:85], v15 offset:2048
    v_mfma_f32_16x16x32_bf16 a[136:139], a[88:91], a[32:35], a[136:139]
    ds_read_b64_tr_b16 a[86:87], v15 offset:2304
    v_mfma_f32_16x16x32_bf16 a[152:155], a[88:91], a[36:39], a[152:155]
    buffer_load_dwordx4 v3, s[36:39], s75 offen offset:3072 lds
    v_mfma_f32_16x16x32_bf16 a[168:171], a[88:91], a[40:43], a[168:171]
    v_mfma_f32_16x16x32_bf16 a[184:187], a[88:91], a[44:47], a[184:187]
    s_add_u32 m0, s78, 28672
    v_mfma_f32_16x16x32_bf16 a[200:203], a[88:91], a[48:51], a[200:203]
    buffer_load_dwordx4 v3, s[40:43], s76 offen offset:0 lds
    v_add_u32 v3, 229376, v3
    v_mfma_f32_16x16x32_bf16 a[216:219], a[88:91], a[52:55], a[216:219]
    v_mfma_f32_16x16x32_bf16 a[232:235], a[88:91], a[56:59], a[232:235]
    v_mfma_f32_16x16x32_bf16 a[248:251], a[88:91], a[60:63], a[248:251]
    ds_read_b64_tr_b16 a[88:89], v13 offset:3072
    v_mfma_f32_16x16x32_bf16 a[140:143], a[92:95], a[32:35], a[140:143]
    ds_read_b64_tr_b16 a[90:91], v13 offset:3328
    v_mfma_f32_16x16x32_bf16 a[156:159], a[92:95], a[36:39], a[156:159]
    global_load_lds_dwordx4 v[4:5], off offset:1024
    v_lshl_add_u64 v[4:5], v[4:5], 0, s[80:81]
    v_mfma_f32_16x16x32_bf16 a[172:175], a[92:95], a[40:43], a[172:175]
    v_mfma_f32_16x16x32_bf16 a[188:191], a[92:95], a[44:47], a[188:191]
    v_mfma_f32_16x16x32_bf16 a[204:207], a[92:95], a[48:51], a[204:207]
    v_mfma_f32_16x16x32_bf16 a[220:223], a[92:95], a[52:55], a[220:223]
    v_mfma_f32_16x16x32_bf16 a[236:239], a[92:95], a[56:59], a[236:239]
    v_mfma_f32_16x16x32_bf16 a[252:255], a[92:95], a[60:63], a[252:255]
    ds_read_b64_tr_b16 a[92:93], v15 offset:3072
    v_mfma_f32_16x16x32_bf16 v[48:51], a[104:107], a[32:35], v[48:51]
    ds_read_b64_tr_b16 a[94:95], v15 offset:3328
    v_mfma_f32_16x16x32_bf16 v[52:55], a[104:107], a[36:39], v[52:55]
    v_mfma_f32_16x16x32_bf16 v[64:67], a[104:107], a[40:43], v[64:67]
    v_mfma_f32_16x16x32_bf16 v[68:71], a[104:107], a[44:47], v[68:71]
    v_mfma_f32_16x16x32_bf16 v[80:83], a[104:107], a[48:51], v[80:83]
    v_mfma_f32_16x16x32_bf16 v[84:87], a[104:107], a[52:55], v[84:87]
    v_mfma_f32_16x16x32_bf16 v[96:99], a[104:107], a[56:59], v[96:99]
    v_mfma_f32_16x16x32_bf16 v[100:103], a[104:107], a[60:63], v[100:103]
    v_mfma_f32_16x16x32_bf16 v[56:59], a[108:111], a[32:35], v[56:59]
    v_mfma_f32_16x16x32_bf16 v[60:63], a[108:111], a[36:39], v[60:63]
    v_mfma_f32_16x16x32_bf16 v[72:75], a[108:111], a[40:43], v[72:75]
    v_mfma_f32_16x16x32_bf16 v[76:79], a[108:111], a[44:47], v[76:79]
    v_mfma_f32_16x16x32_bf16 v[88:91], a[108:111], a[48:51], v[88:91]
    v_mfma_f32_16x16x32_bf16 v[92:95], a[108:111], a[52:55], v[92:95]
    v_mfma_f32_16x16x32_bf16 v[104:107], a[108:111], a[56:59], v[104:107]
    v_mfma_f32_16x16x32_bf16 v[108:111], a[108:111], a[60:63], v[108:111]
    s_waitcnt vmcnt(23) lgkmcnt(0)
    s_barrier
    v_mfma_f32_16x16x32_bf16 v[128:131], a[64:67], a[0:3], v[128:131]
    s_add_u32 m0, s78, 40960
    buffer_load_dword v7, v6, s[44:47], s4 offen
    v_add_u32_e64 v6, s79, v6
    v_mfma_f32_16x16x32_bf16 v[144:147], a[64:67], a[4:7], v[144:147]
    buffer_load_dwordx4 v2, s[32:35], s68 offen offset:0 lds
    v_mfma_f32_16x16x32_bf16 v[160:163], a[64:67], a[8:11], v[160:163]
    ds_read_b128 a[32:35], v9 offset:34816
    v_mfma_f32_16x16x32_bf16 v[176:179], a[64:67], a[12:15], v[176:179]
    v_mfma_f32_16x16x32_bf16 v[192:195], a[64:67], a[16:19], v[192:195]
    v_mfma_f32_16x16x32_bf16 v[208:211], a[64:67], a[20:23], v[208:211]
    v_mfma_f32_16x16x32_bf16 v[224:227], a[64:67], a[24:27], v[224:227]
    ds_read_b128 a[36:39], v9 offset:36864
    v_mfma_f32_16x16x32_bf16 v[240:243], a[64:67], a[28:31], v[240:243]
    ds_read_b64_tr_b16 a[64:65], v13 offset:20480
    v_mfma_f32_16x16x32_bf16 v[132:135], a[68:71], a[0:3], v[132:135]
    ds_read_b64_tr_b16 a[66:67], v13 offset:20736
    v_mfma_f32_16x16x32_bf16 v[148:151], a[68:71], a[4:7], v[148:151]
    buffer_load_dwordx4 v2, s[32:35], s69 offen offset:1024 lds
    v_mfma_f32_16x16x32_bf16 v[164:167], a[68:71], a[8:11], v[164:167]
    ds_read_b128 a[40:43], v9 offset:38912
    v_mfma_f32_16x16x32_bf16 v[180:183], a[68:71], a[12:15], v[180:183]
    v_mfma_f32_16x16x32_bf16 v[196:199], a[68:71], a[16:19], v[196:199]
    v_mfma_f32_16x16x32_bf16 v[212:215], a[68:71], a[20:23], v[212:215]
    buffer_load_dwordx4 v2, s[32:35], s70 offen offset:2048 lds
    v_add_u32 v2, 196608, v2
    v_mfma_f32_16x16x32_bf16 v[228:231], a[68:71], a[24:27], v[228:231]
    ds_read_b128 a[44:47], v9 offset:40960
    v_mfma_f32_16x16x32_bf16 v[244:247], a[68:71], a[28:31], v[244:247]
    ds_read_b64_tr_b16 a[68:69], v15 offset:20480
    v_mfma_f32_16x16x32_bf16 v[136:139], a[72:75], a[0:3], v[136:139]
    ds_read_b64_tr_b16 a[70:71], v15 offset:20736
    v_mfma_f32_16x16x32_bf16 v[152:155], a[72:75], a[4:7], v[152:155]
    v_mfma_f32_16x16x32_bf16 v[168:171], a[72:75], a[8:11], v[168:171]
    ds_read_b128 a[48:51], v9 offset:43008
    v_mfma_f32_16x16x32_bf16 v[184:187], a[72:75], a[12:15], v[184:187]
    buffer_load_dwordx4 v3, s[36:39], s71 offen offset:3072 lds
    v_mfma_f32_16x16x32_bf16 v[200:203], a[72:75], a[16:19], v[200:203]
    v_mfma_f32_16x16x32_bf16 v[216:219], a[72:75], a[20:23], v[216:219]
    v_mfma_f32_16x16x32_bf16 v[232:235], a[72:75], a[24:27], v[232:235]
    ds_read_b128 a[52:55], v9 offset:45056
    v_mfma_f32_16x16x32_bf16 v[248:251], a[72:75], a[28:31], v[248:251]
    ds_read_b64_tr_b16 a[72:73], v13 offset:21504
    v_mfma_f32_16x16x32_bf16 v[140:143], a[76:79], a[0:3], v[140:143]
    ds_read_b64_tr_b16 a[74:75], v13 offset:21760
    s_add_u32 m0, s78, 45056
    v_mfma_f32_16x16x32_bf16 v[156:159], a[76:79], a[4:7], v[156:159]
    buffer_load_dwordx4 v3, s[40:43], s72 offen offset:0 lds
    v_mfma_f32_16x16x32_bf16 v[172:175], a[76:79], a[8:11], v[172:175]
    ds_read_b128 a[56:59], v9 offset:47104
    v_mfma_f32_16x16x32_bf16 v[188:191], a[76:79], a[12:15], v[188:191]
    v_mfma_f32_16x16x32_bf16 v[204:207], a[76:79], a[16:19], v[204:207]
    v_mfma_f32_16x16x32_bf16 v[220:223], a[76:79], a[20:23], v[220:223]
    v_mfma_f32_16x16x32_bf16 v[236:239], a[76:79], a[24:27], v[236:239]
    ds_read_b128 a[60:63], v9 offset:49152
    v_mfma_f32_16x16x32_bf16 v[252:255], a[76:79], a[28:31], v[252:255]
    ds_read_b64_tr_b16 a[76:77], v15 offset:21504
    v_mfma_f32_16x16x32_bf16 a[128:131], a[80:83], a[0:3], a[128:131]
    ds_read_b64_tr_b16 a[78:79], v15 offset:21760
    v_mfma_f32_16x16x32_bf16 a[144:147], a[80:83], a[4:7], a[144:147]
    buffer_load_dwordx4 v3, s[36:39], s73 offen offset:1024 lds
    v_mfma_f32_16x16x32_bf16 a[160:163], a[80:83], a[8:11], a[160:163]
    ds_read_b64_tr_b16 a[104:105], v13 offset:24576
    v_mfma_f32_16x16x32_bf16 a[176:179], a[80:83], a[12:15], a[176:179]
    v_mfma_f32_16x16x32_bf16 a[192:195], a[80:83], a[16:19], a[192:195]
    v_mfma_f32_16x16x32_bf16 a[208:211], a[80:83], a[20:23], a[208:211]
    v_mfma_f32_16x16x32_bf16 a[224:227], a[80:83], a[24:27], a[224:227]
    ds_read_b64_tr_b16 a[106:107], v13 offset:24832
    v_mfma_f32_16x16x32_bf16 a[240:243], a[80:83], a[28:31], a[240:243]
    ds_read_b64_tr_b16 a[80:81], v13 offset:22528
    v_mfma_f32_16x16x32_bf16 a[132:135], a[84:87], a[0:3], a[132:135]
    ds_read_b64_tr_b16 a[82:83], v13 offset:22784
    v_mfma_f32_16x16x32_bf16 a[148:151], a[84:87], a[4:7], a[148:151]
    buffer_load_dwordx4 v3, s[40:43], s74 offen offset:2048 lds
    v_mfma_f32_16x16x32_bf16 a[164:167], a[84:87], a[8:11], a[164:167]
    ds_read_b64_tr_b16 a[108:109], v15 offset:24576
    v_mfma_f32_16x16x32_bf16 a[180:183], a[84:87], a[12:15], a[180:183]
    v_mfma_f32_16x16x32_bf16 a[196:199], a[84:87], a[16:19], a[196:199]
    buffer_load_dwordx4 v3, s[36:39], s75 offen offset:3072 lds
    v_mfma_f32_16x16x32_bf16 a[212:215], a[84:87], a[20:23], a[212:215]
    v_mfma_f32_16x16x32_bf16 a[228:231], a[84:87], a[24:27], a[228:231]
    ds_read_b64_tr_b16 a[110:111], v15 offset:24832
    v_mfma_f32_16x16x32_bf16 a[244:247], a[84:87], a[28:31], a[244:247]
    ds_read_b64_tr_b16 a[84:85], v15 offset:22528
    v_mfma_f32_16x16x32_bf16 a[136:139], a[88:91], a[0:3], a[136:139]
    ds_read_b64_tr_b16 a[86:87], v15 offset:22784
    v_mfma_f32_16x16x32_bf16 a[152:155], a[88:91], a[4:7], a[152:155]
    s_add_u32 m0, s78, 49152
    v_mfma_f32_16x16x32_bf16 a[168:171], a[88:91], a[8:11], a[168:171]
    buffer_load_dwordx4 v3, s[40:43], s76 offen offset:0 lds
    v_add_u32 v3, 229376, v3
    v_mfma_f32_16x16x32_bf16 a[184:187], a[88:91], a[12:15], a[184:187]
    v_mfma_f32_16x16x32_bf16 a[200:203], a[88:91], a[16:19], a[200:203]
    v_mfma_f32_16x16x32_bf16 a[216:219], a[88:91], a[20:23], a[216:219]
    v_mfma_f32_16x16x32_bf16 a[232:235], a[88:91], a[24:27], a[232:235]
    v_mfma_f32_16x16x32_bf16 a[248:251], a[88:91], a[28:31], a[248:251]
    ds_read_b64_tr_b16 a[88:89], v13 offset:23552
    v_mfma_f32_16x16x32_bf16 a[140:143], a[92:95], a[0:3], a[140:143]
    ds_read_b64_tr_b16 a[90:91], v13 offset:23808
    v_mfma_f32_16x16x32_bf16 a[156:159], a[92:95], a[4:7], a[156:159]
    global_load_lds_dwordx4 v[4:5], off offset:1024
    v_lshl_add_u64 v[4:5], v[4:5], 0, s[80:81]
    v_mfma_f32_16x16x32_bf16 a[172:175], a[92:95], a[8:11], a[172:175]
    v_mfma_f32_16x16x32_bf16 a[188:191], a[92:95], a[12:15], a[188:191]
    v_mfma_f32_16x16x32_bf16 a[204:207], a[92:95], a[16:19], a[204:207]
    v_mfma_f32_16x16x32_bf16 a[220:223], a[92:95], a[20:23], a[220:223]
    v_mfma_f32_16x16x32_bf16 a[236:239], a[92:95], a[24:27], a[236:239]
    v_mfma_f32_16x16x32_bf16 a[252:255], a[92:95], a[28:31], a[252:255]
    ds_read_b64_tr_b16 a[92:93], v15 offset:23552
    v_mfma_f32_16x16x32_bf16 v[48:51], a[96:99], a[0:3], v[48:51]
    ds_read_b64_tr_b16 a[94:95], v15 offset:23808
    v_mfma_f32_16x16x32_bf16 v[52:55], a[96:99], a[4:7], v[52:55]
    v_mfma_f32_16x16x32_bf16 v[64:67], a[96:99], a[8:11], v[64:67]
    v_mfma_f32_16x16x32_bf16 v[68:71], a[96:99], a[12:15], v[68:71]
    v_mfma_f32_16x16x32_bf16 v[80:83], a[96:99], a[16:19], v[80:83]
    v_mfma_f32_16x16x32_bf16 v[84:87], a[96:99], a[20:23], v[84:87]
    v_mfma_f32_16x16x32_bf16 v[96:99], a[96:99], a[24:27], v[96:99]
    v_mfma_f32_16x16x32_bf16 v[100:103], a[96:99], a[28:31], v[100:103]
    v_mfma_f32_16x16x32_bf16 v[56:59], a[100:103], a[0:3], v[56:59]
    v_mfma_f32_16x16x32_bf16 v[60:63], a[100:103], a[4:7], v[60:63]
    v_mfma_f32_16x16x32_bf16 v[72:75], a[100:103], a[8:11], v[72:75]
    v_mfma_f32_16x16x32_bf16 v[76:79], a[100:103], a[12:15], v[76:79]
    v_mfma_f32_16x16x32_bf16 v[88:91], a[100:103], a[16:19], v[88:91]
    v_mfma_f32_16x16x32_bf16 v[92:95], a[100:103], a[20:23], v[92:95]
    v_mfma_f32_16x16x32_bf16 v[104:107], a[100:103], a[24:27], v[104:107]
    v_mfma_f32_16x16x32_bf16 v[108:111], a[100:103], a[28:31], v[108:111]
    s_waitcnt vmcnt(21) lgkmcnt(0)
    s_barrier
    v_mfma_f32_16x16x32_bf16 v[128:131], a[64:67], a[32:35], v[128:131]
    s_mov_b32 m0, s15
    s_mov_b32 s77, 4096
    v_mfma_f32_16x16x32_bf16 v[144:147], a[64:67], a[36:39], v[144:147]
    buffer_load_dwordx4 v1, s[28:31], s77 offen sc1 lds
    v_mfma_f32_16x16x32_bf16 v[160:163], a[64:67], a[40:43], v[160:163]
    ds_read_b128 a[0:3], v8 offset:0
    v_mfma_f32_16x16x32_bf16 v[176:179], a[64:67], a[44:47], v[176:179]
    v_mfma_f32_16x16x32_bf16 v[192:195], a[64:67], a[48:51], v[192:195]
    v_mfma_f32_16x16x32_bf16 v[208:211], a[64:67], a[52:55], v[208:211]
    v_mfma_f32_16x16x32_bf16 v[224:227], a[64:67], a[56:59], v[224:227]
    ds_read_b128 a[4:7], v8 offset:2048
    v_mfma_f32_16x16x32_bf16 v[240:243], a[64:67], a[60:63], v[240:243]
    ds_read_b64_tr_b16 a[64:65], v12 offset:0
    v_mfma_f32_16x16x32_bf16 v[132:135], a[68:71], a[32:35], v[132:135]
    ds_read_b64_tr_b16 a[66:67], v12 offset:256
    s_mov_b32 s77, 19456
    v_mfma_f32_16x16x32_bf16 v[148:151], a[68:71], a[36:39], v[148:151]
    buffer_load_dwordx4 v1, s[28:31], s77 offen offset:1024 sc1 lds
    v_add_u32 v1, 128, v1
    v_mfma_f32_16x16x32_bf16 v[164:167], a[68:71], a[40:43], v[164:167]
    ds_read_b128 a[8:11], v8 offset:4096
    s_add_u32 m0, s78, 61440
    v_mfma_f32_16x16x32_bf16 v[180:183], a[68:71], a[44:47], v[180:183]
    buffer_load_dwordx4 v2, s[32:35], s68 offen offset:0 lds
    v_mfma_f32_16x16x32_bf16 v[196:199], a[68:71], a[48:51], v[196:199]
    v_mfma_f32_16x16x32_bf16 v[212:215], a[68:71], a[52:55], v[212:215]
    v_mfma_f32_16x16x32_bf16 v[228:231], a[68:71], a[56:59], v[228:231]
    ds_read_b128 a[12:15], v8 offset:6144
    v_mfma_f32_16x16x32_bf16 v[244:247], a[68:71], a[60:63], v[244:247]
    ds_read_b64_tr_b16 a[68:69], v14 offset:0
    v_mfma_f32_16x16x32_bf16 v[136:139], a[72:75], a[32:35], v[136:139]
    ds_read_b64_tr_b16 a[70:71], v14 offset:256
    v_mfma_f32_16x16x32_bf16 v[152:155], a[72:75], a[36:39], v[152:155]
    buffer_load_dwordx4 v2, s[32:35], s69 offen offset:1024 lds
    v_mfma_f32_16x16x32_bf16 v[168:171], a[72:75], a[40:43], v[168:171]
    ds_read_b128 a[16:19], v8 offset:8192
    v_mfma_f32_16x16x32_bf16 v[184:187], a[72:75], a[44:47], v[184:187]
    v_mfma_f32_16x16x32_bf16 v[200:203], a[72:75], a[48:51], v[200:203]
    v_mfma_f32_16x16x32_bf16 v[216:219], a[72:75], a[52:55], v[216:219]
    buffer_load_dwordx4 v2, s[32:35], s70 offen offset:2048 lds
    v_add_u32 v2, 196608, v2
    v_mfma_f32_16x16x32_bf16 v[232:235], a[72:75], a[56:59], v[232:235]
    ds_read_b128 a[20:23], v8 offset:10240
    v_mfma_f32_16x16x32_bf16 v[248:251], a[72:75], a[60:63], v[248:251]
    ds_read_b64_tr_b16 a[72:73], v12 offset:1024
    v_mfma_f32_16x16x32_bf16 v[140:143], a[76:79], a[32:35], v[140:143]
    ds_read_b64_tr_b16 a[74:75], v12 offset:1280
    v_mfma_f32_16x16x32_bf16 v[156:159], a[76:79], a[36:39], v[156:159]
    v_mfma_f32_16x16x32_bf16 v[172:175], a[76:79], a[40:43], v[172:175]
    ds_read_b128 a[24:27], v8 offset:12288
    v_mfma_f32_16x16x32_bf16 v[188:191], a[76:79], a[44:47], v[188:191]
    buffer_load_dwordx4 v3, s[36:39], s71 offen offset:3072 lds
    v_mfma_f32_16x16x32_bf16 v[204:207], a[76:79], a[48:51], v[204:207]
    v_mfma_f32_16x16x32_bf16 v[220:223], a[76:79], a[52:55], v[220:223]
    v_mfma_f32_16x16x32_bf16 v[236:239], a[76:79], a[56:59], v[236:239]
    ds_read_b128 a[28:31], v8 offset:14336
    v_mfma_f32_16x16x32_bf16 v[252:255], a[76:79], a[60:63], v[252:255]
    ds_read_b64_tr_b16 a[76:77], v14 offset:1024
    v_mfma_f32_16x16x32_bf16 a[128:131], a[80:83], a[32:35], a[128:131]
    ds_read_b64_tr_b16 a[78:79], v14 offset:1280
    s_add_u32 m0, s78, 65536
    v_mfma_f32_16x16x32_bf16 a[144:147], a[80:83], a[36:39], a[144:147]
    buffer_load_dwordx4 v3, s[40:43], s72 offen offset:0 lds
    v_mfma_f32_16x16x32_bf16 a[160:163], a[80:83], a[40:43], a[160:163]
    ds_read_b64_tr_b16 a[96:97], v12 offset:4096
    v_mfma_f32_16x16x32_bf16 a[176:179], a[80:83], a[44:47], a[176:179]
    v_mfma_f32_16x16x32_bf16 a[192:195], a[80:83], a[48:51], a[192:195]
    v_mfma_f32_16x16x32_bf16 a[208:211], a[80:83], a[52:55], a[208:211]
    buffer_load_dwordx4 v3, s[36:39], s73 offen offset:1024 lds
    v_mfma_f32_16x16x32_bf16 a[224:227], a[80:83], a[56:59], a[224:227]
    ds_read_b64_tr_b16 a[98:99], v12 offset:4352
    v_mfma_f32_16x16x32_bf16 a[240:243], a[80:83], a[60:63], a[240:243]
    ds_read_b64_tr_b16 a[80:81], v12 offset:2048
    v_mfma_f32_16x16x32_bf16 a[132:135], a[84:87], a[32:35], a[132:135]
    ds_read_b64_tr_b16 a[82:83], v12 offset:2304
    v_mfma_f32_16x16x32_bf16 a[148:151], a[84:87], a[36:39], a[148:151]
    v_mfma_f32_16x16x32_bf16 a[164:167], a[84:87], a[40:43], a[164:167]
    ds_read_b64_tr_b16 a[100:101], v14 offset:4096
    v_mfma_f32_16x16x32_bf16 a[180:183], a[84:87], a[44:47], a[180:183]
    buffer_load_dwordx4 v3, s[40:43], s74 offen offset:2048 lds
    v_mfma_f32_16x16x32_bf16 a[196:199], a[84:87], a[48:51], a[196:199]
    v_mfma_f32_16x16x32_bf16 a[212:215], a[84:87], a[52:55], a[212:215]
    v_mfma_f32_16x16x32_bf16 a[228:231], a[84:87], a[56:59], a[228:231]
    ds_read_b64_tr_b16 a[102:103], v14 offset:4352
    v_mfma_f32_16x16x32_bf16 a[244:247], a[84:87], a[60:63], a[244:247]
    ds_read_b64_tr_b16 a[84:85], v14 offset:2048
    v_mfma_f32_16x16x32_bf16 a[136:139], a[88:91], a[32:35], a[136:139]
    ds_read_b64_tr_b16 a[86:87], v14 offset:2304
    v_mfma_f32_16x16x32_bf16 a[152:155], a[88:91], a[36:39], a[152:155]
    buffer_load_dwordx4 v3, s[36:39], s75 offen offset:3072 lds
    v_mfma_f32_16x16x32_bf16 a[168:171], a[88:91], a[40:43], a[168:171]
    v_mfma_f32_16x16x32_bf16 a[184:187], a[88:91], a[44:47], a[184:187]
    s_add_u32 m0, s78, 69632
    v_mfma_f32_16x16x32_bf16 a[200:203], a[88:91], a[48:51], a[200:203]
    buffer_load_dwordx4 v3, s[40:43], s76 offen offset:0 lds
    v_add_u32 v3, 229376, v3
    v_mfma_f32_16x16x32_bf16 a[216:219], a[88:91], a[52:55], a[216:219]
    v_mfma_f32_16x16x32_bf16 a[232:235], a[88:91], a[56:59], a[232:235]
    v_mfma_f32_16x16x32_bf16 a[248:251], a[88:91], a[60:63], a[248:251]
    ds_read_b64_tr_b16 a[88:89], v12 offset:3072
    v_mfma_f32_16x16x32_bf16 a[140:143], a[92:95], a[32:35], a[140:143]
    ds_read_b64_tr_b16 a[90:91], v12 offset:3328
    v_mfma_f32_16x16x32_bf16 a[156:159], a[92:95], a[36:39], a[156:159]
    global_load_lds_dwordx4 v[4:5], off offset:1024
    v_lshl_add_u64 v[4:5], v[4:5], 0, s[80:81]
    v_mfma_f32_16x16x32_bf16 a[172:175], a[92:95], a[40:43], a[172:175]
    v_mfma_f32_16x16x32_bf16 a[188:191], a[92:95], a[44:47], a[188:191]
    v_mfma_f32_16x16x32_bf16 a[204:207], a[92:95], a[48:51], a[204:207]
    v_mfma_f32_16x16x32_bf16 a[220:223], a[92:95], a[52:55], a[220:223]
    v_mfma_f32_16x16x32_bf16 a[236:239], a[92:95], a[56:59], a[236:239]
    v_mfma_f32_16x16x32_bf16 a[252:255], a[92:95], a[60:63], a[252:255]
    ds_read_b64_tr_b16 a[92:93], v14 offset:3072
    v_mfma_f32_16x16x32_bf16 v[48:51], a[104:107], a[32:35], v[48:51]
    ds_read_b64_tr_b16 a[94:95], v14 offset:3328
    v_mfma_f32_16x16x32_bf16 v[52:55], a[104:107], a[36:39], v[52:55]
    v_mfma_f32_16x16x32_bf16 v[64:67], a[104:107], a[40:43], v[64:67]
    v_mfma_f32_16x16x32_bf16 v[68:71], a[104:107], a[44:47], v[68:71]
    v_mfma_f32_16x16x32_bf16 v[80:83], a[104:107], a[48:51], v[80:83]
    v_mfma_f32_16x16x32_bf16 v[84:87], a[104:107], a[52:55], v[84:87]
    v_mfma_f32_16x16x32_bf16 v[96:99], a[104:107], a[56:59], v[96:99]
    v_mfma_f32_16x16x32_bf16 v[100:103], a[104:107], a[60:63], v[100:103]
    v_mfma_f32_16x16x32_bf16 v[56:59], a[108:111], a[32:35], v[56:59]
    v_mfma_f32_16x16x32_bf16 v[60:63], a[108:111], a[36:39], v[60:63]
    v_mfma_f32_16x16x32_bf16 v[72:75], a[108:111], a[40:43], v[72:75]
    v_mfma_f32_16x16x32_bf16 v[76:79], a[108:111], a[44:47], v[76:79]
    v_mfma_f32_16x16x32_bf16 v[88:91], a[108:111], a[48:51], v[88:91]
    v_mfma_f32_16x16x32_bf16 v[92:95], a[108:111], a[52:55], v[92:95]
    v_mfma_f32_16x16x32_bf16 v[104:107], a[108:111], a[56:59], v[104:107]
    v_mfma_f32_16x16x32_bf16 v[108:111], a[108:111], a[60:63], v[108:111]
    s_sub_u32 s67, s67, 1
    s_cmp_lg_u32 s67, 0
    s_cbranch_scc1 L_loop1
L_tail1:
    s_waitcnt vmcnt(23) lgkmcnt(0)
    s_barrier
    v_mfma_f32_16x16x32_bf16 v[128:131], a[64:67], a[0:3], v[128:131]
    s_getpc_b64 s[86:87]
L_pc1:
    s_sub_u32 s86, s86, L_pc1-L_tail0
    s_subb_u32 s87, s87, 0
    s_lshr_b32 s82, s2, 3
    s_lshl_b32 s82, s82, 2
    s_add_u32 s82, s82, s60
    s_lshl_b32 s82, s82, 10
    v_add_u32 v34, s82, v16
    v_min_u32 v34, L_code_end-L_tail0-4, v34
    global_load_dword v7, v34, s[86:87]
    v_mfma_f32_16x16x32_bf16 v[144:147], a[64:67], a[4:7], v[144:147]
    v_mfma_f32_16x16x32_bf16 v[160:163], a[64:67], a[8:11], v[160:163]
    ds_read_b128 a[32:35], v9 offset:0
    s_and_b32 s82, s2, 7
    s_lshl_b32 s82, s82, 5
    s_lshr_b32 s83, s2, 3
    s_add_u32 s82, s82, s83
    s_lshl_b32 s82, s82, 2
    s_add_u32 s82, s82, s60
    s_mul_i32 s82, s82, 7168
    v_min_u32 v34, 55, v0
    v_lshlrev_b32 v34, 7, v34
    v_add_u32 v34, s82, v34
    global_load_dword v7, v34, s[20:21]
    v_mfma_f32_16x16x32_bf16 v[176:179], a[64:67], a[12:15], v[176:179]
    v_mfma_f32_16x16x32_bf16 v[192:195], a[64:67], a[16:19], v[192:195]
    v_mfma_f32_16x16x32_bf16 v[208:211], a[64:67], a[20:23], v[208:211]
    v_mfma_f32_16x16x32_bf16 v[224:227], a[64:67], a[24:27], v[224:227]
    ds_read_b128 a[36:39], v9 offset:2048
    v_mfma_f32_16x16x32_bf16 v[240:243], a[64:67], a[28:31], v[240:243]
    ds_read_b64_tr_b16 a[64:65], v12 offset:20480
    v_mfma_f32_16x16x32_bf16 v[132:135], a[68:71], a[0:3], v[132:135]
    ds_read_b64_tr_b16 a[66:67], v12 offset:20736
    v_mfma_f32_16x16x32_bf16 v[148:151], a[68:71], a[4:7], v[148:151]
    v_mfma_f32_16x16x32_bf16 v[164:167], a[68:71], a[8:11], v[164:167]
    ds_read_b128 a[40:43], v9 offset:4096
    v_mfma_f32_16x16x32_bf16 v[180:183], a[68:71], a[12:15], v[180:183]
    v_mfma_f32_16x16x32_bf16 v[196:199], a[68:71], a[16:19], v[196:199]
    v_mfma_f32_16x16x32_bf16 v[212:215], a[68:71], a[20:23], v[212:215]
    v_mfma_f32_16x16x32_bf16 v[228:231], a[68:71], a[24:27], v[228:231]
    ds_read_b128 a[44:47], v9 offset:6144
    v_mfma_f32_16x16x32_bf16 v[244:247], a[68:71], a[28:31], v[244:247]
    ds_read_b64_tr_b16 a[68:69], v14 offset:20480
    v_mfma_f32_16x16x32_bf16 v[136:139], a[72:75], a[0:3], v[136:139]
    ds_read_b64_tr_b16 a[70:71], v14 offset:20736
    v_mfma_f32_16x16x32_bf16 v[152:155], a[72:75], a[4:7], v[152:155]
    v_mfma_f32_16x16x32_bf16 v[168:171], a[72:75], a[8:11], v[168:171]
    ds_read_b128 a[48:51], v9 offset:8192
    v_mfma_f32_16x16x32_bf16 v[184:187], a[72:75], a[12:15], v[184:187]
    v_mfma_f32_16x16x32_bf16 v[200:203], a[72:75], a[16:19], v[200:203]
    s_lshl_b32 s82, s2, 2
    s_add_u32 s82, s82, s60
    s_lshl_b32 s82, s82, 11
    v_and_b32 v35, 31, v0
    v_lshlrev_b32 v35, 6, v35
    v_add_u32 v35, s82, v35
    global_load_dword v7, v35, s[12:13]
    v_mfma_f32_16x16x32_bf16 v[216:219], a[72:75], a[20:23], v[216:219]
    v_mfma_f32_16x16x32_bf16 v[232:235], a[72:75], a[24:27], v[232:235]
    ds_read_b128 a[52:55], v9 offset:10240
    v_mfma_f32_16x16x32_bf16 v[248:251], a[72:75], a[28:31], v[248:251]
    ds_read_b64_tr_b16 a[72:73], v12 offset:21504
    v_mfma_f32_16x16x32_bf16 v[140:143], a[76:79], a[0:3], v[140:143]
    ds_read_b64_tr_b16 a[74:75], v12 offset:21760
    v_mfma_f32_16x16x32_bf16 v[156:159], a[76:79], a[4:7], v[156:159]
    v_mfma_f32_16x16x32_bf16 v[172:175], a[76:79], a[8:11], v[172:175]
    ds_read_b128 a[56:59], v9 offset:12288
    v_mfma_f32_16x16x32_bf16 v[188:191], a[76:79], a[12:15], v[188:191]
    v_mfma_f32_16x16x32_bf16 v[204:207], a[76:79], a[16:19], v[204:207]
    v_mfma_f32_16x16x32_bf16 v[220:223], a[76:79], a[20:23], v[220:223]
    v_mfma_f32_16x16x32_bf16 v[236:239], a[76:79], a[24:27], v[236:239]
    ds_read_b128 a[60:63], v9 offset:14336
    v_mfma_f32_16x16x32_bf16 v[252:255], a[76:79], a[28:31], v[252:255]
    ds_read_b64_tr_b16 a[76:77], v14 offset:21504
    v_mfma_f32_16x16x32_bf16 a[128:131], a[80:83], a[0:3], a[128:131]
    ds_read_b64_tr_b16 a[78:79], v14 offset:21760
    v_mfma_f32_16x16x32_bf16 a[144:147], a[80:83], a[4:7], a[144:147]
    v_mfma_f32_16x16x32_bf16 a[160:163], a[80:83], a[8:11], a[160:163]
    ds_read_b64_tr_b16 a[104:105], v12 offset:24576
    v_mfma_f32_16x16x32_bf16 a[176:179], a[80:83], a[12:15], a[176:179]
    v_mfma_f32_16x16x32_bf16 a[192:195], a[80:83], a[16:19], a[192:195]
    v_mfma_f32_16x16x32_bf16 a[208:211], a[80:83], a[20:23], a[208:211]
    v_mfma_f32_16x16x32_bf16 a[224:227], a[80:83], a[24:27], a[224:227]
    ds_read_b64_tr_b16 a[106:107], v12 offset:24832
    v_mfma_f32_16x16x32_bf16 a[240:243], a[80:83], a[28:31], a[240:243]
    ds_read_b64_tr_b16 a[80:81], v12 offset:22528
    v_mfma_f32_16x16x32_bf16 a[132:135], a[84:87], a[0:3], a[132:135]
    ds_read_b64_tr_b16 a[82:83], v12 offset:22784
    v_mfma_f32_16x16x32_bf16 a[148:151], a[84:87], a[4:7], a[148:151]
    v_mfma_f32_16x16x32_bf16 a[164:167], a[84:87], a[8:11], a[164:167]
    ds_read_b64_tr_b16 a[108:109], v14 offset:24576
    v_mfma_f32_16x16x32_bf16 a[180:183], a[84:87], a[12:15], a[180:183]
    v_mfma_f32_16x16x32_bf16 a[196:199], a[84:87], a[16:19], a[196:199]
    v_mfma_f32_16x16x32_bf16 a[212:215], a[84:87], a[20:23], a[212:215]
    v_mfma_f32_16x16x32_bf16 a[228:231], a[84:87], a[24:27], a[228:231]
    ds_read_b64_tr_b16 a[110:111], v14 offset:24832
    v_mfma_f32_16x16x32_bf16 a[244:247], a[84:87], a[28:31], a[244:247]
    ds_read_b64_tr_b16 a[84:85], v14 offset:22528
    v_mfma_f32_16x16x32_bf16 a[136:139], a[88:91], a[0:3], a[136:139]
    ds_read_b64_tr_b16 a[86:87], v14 offset:22784
    v_mfma_f32_16x16x32_bf16 a[152:155], a[88:91], a[4:7], a[152:155]
    v_mfma_f32_16x16x32_bf16 a[168:171], a[88:91], a[8:11], a[168:171]
    v_mfma_f32_16x16x32_bf16 a[184:187], a[88:91], a[12:15], a[184:187]
    v_mfma_f32_16x16x32_bf16 a[200:203], a[88:91], a[16:19], a[200:203]
    v_mfma_f32_16x16x32_bf16 a[216:219], a[88:91], a[20:23], a[216:219]
    v_mfma_f32_16x16x32_bf16 a[232:235], a[88:91], a[24:27], a[232:235]
    v_mfma_f32_16x16x32_bf16 a[248:251], a[88:91], a[28:31], a[248:251]
    ds_read_b64_tr_b16 a[88:89], v12 offset:23552
    v_mfma_f32_16x16x32_bf16 a[140:143], a[92:95], a[0:3], a[140:143]
    ds_read_b64_tr_b16 a[90:91], v12 offset:23808
    v_mfma_f32_16x16x32_bf16 a[156:159], a[92:95], a[4:7], a[156:159]
    v_mfma_f32_16x16x32_bf16 a[172:175], a[92:95], a[8:11], a[172:175]
    v_mfma_f32_16x16x32_bf16 a[188:191], a[92:95], a[12:15], a[188:191]
    v_mfma_f32_16x16x32_bf16 a[204:207], a[92:95], a[16:19], a[204:207]
    v_mfma_f32_16x16x32_bf16 a[220:223], a[92:95], a[20:23], a[220:223]
    v_mfma_f32_16x16x32_bf16 a[236:239], a[92:95], a[24:27], a[236:239]
    v_mfma_f32_16x16x32_bf16 a[252:255], a[92:95], a[28:31], a[252:255]
    ds_read_b64_tr_b16 a[92:93], v14 offset:23552
    v_mfma_f32_16x16x32_bf16 v[48:51], a[96:99], a[0:3], v[48:51]
    ds_read_b64_tr_b16 a[94:95], v14 offset:23808
    v_mfma_f32_16x16x32_bf16 v[52:55], a[96:99], a[4:7], v[52:55]
    v_mfma_f32_16x16x32_bf16 v[64:67], a[96:99], a[8:11], v[64:67]
    v_mfma_f32_16x16x32_bf16 v[68:71], a[96:99], a[12:15], v[68:71]
    v_mfma_f32_16x16x32_bf16 v[80:83], a[96:99], a[16:19], v[80:83]
    v_mfma_f32_16x16x32_bf16 v[84:87], a[96:99], a[20:23], v[84:87]
    v_mfma_f32_16x16x32_bf16 v[96:99], a[96:99], a[24:27], v[96:99]
    v_mfma_f32_16x16x32_bf16 v[100:103], a[96:99], a[28:31], v[100:103]
    v_mfma_f32_16x16x32_bf16 v[56:59], a[100:103], a[0:3], v[56:59]
    v_mfma_f32_16x16x32_bf16 v[60:63], a[100:103], a[4:7], v[60:63]
    v_mfma_f32_16x16x32_bf16 v[72:75], a[100:103], a[8:11], v[72:75]
    v_mfma_f32_16x16x32_bf16 v[76:79], a[100:103], a[12:15], v[76:79]
    v_mfma_f32_16x16x32_bf16 v[88:91], a[100:103], a[16:19], v[88:91]
    v_mfma_f32_16x16x32_bf16 v[92:95], a[100:103], a[20:23], v[92:95]
    v_mfma_f32_16x16x32_bf16 v[104:107], a[100:103], a[24:27], v[104:107]
    v_mfma_f32_16x16x32_bf16 v[108:111], a[100:103], a[28:31], v[108:111]
    s_waitcnt vmcnt(13) lgkmcnt(0)
    s_barrier
    v_mfma_f32_16x16x32_bf16 v[128:131], a[64:67], a[32:35], v[128:131]
    v_mfma_f32_16x16x32_bf16 v[144:147], a[64:67], a[36:39], v[144:147]
    v_mfma_f32_16x16x32_bf16 v[160:163], a[64:67], a[40:43], v[160:163]
    ds_read_b128 a[0:3], v8 offset:34816
    v_mfma_f32_16x16x32_bf16 v[176:179], a[64:67], a[44:47], v[176:179]
    v_mfma_f32_16x16x32_bf16 v[192:195], a[64:67], a[48:51], v[192:195]
    s_mul_i32 s82, s65, 1835008
    v_mfma_f32_16x16x32_bf16 v[208:211], a[64:67], a[52:55], v[208:211]
    s_lshl_b32 s83, s66, 8
    v_mfma_f32_16x16x32_bf16 v[224:227], a[64:67], a[56:59], v[224:227]
    ds_read_b128 a[4:7], v8 offset:36864
    s_add_u32 s82, s82, s83
    v_mfma_f32_16x16x32_bf16 v[240:243], a[64:67], a[60:63], v[240:243]
    ds_read_b64_tr_b16 a[64:65], v13 offset:0
    s_add_u32 s48, s20, s82
    v_mfma_f32_16x16x32_bf16 v[132:135], a[68:71], a[32:35], v[132:135]
    ds_read_b64_tr_b16 a[66:67], v13 offset:256
    s_addc_u32 s49, s21, 0
    v_mfma_f32_16x16x32_bf16 v[148:151], a[68:71], a[36:39], v[148:151]
    s_and_b32 s49, s49, 0xffff
    v_mfma_f32_16x16x32_bf16 v[164:167], a[68:71], a[40:43], v[164:167]
    ds_read_b128 a[8:11], v8 offset:38912
    s_sub_u32 s50, 7340032, s82
    v_mfma_f32_16x16x32_bf16 v[180:183], a[68:71], a[44:47], v[180:183]
    s_mov_b32 s51, 0x20000
    v_mfma_f32_16x16x32_bf16 v[196:199], a[68:71], a[48:51], v[196:199]
    s_add_u32 s52, s12, s83
    v_mfma_f32_16x16x32_bf16 v[212:215], a[68:71], a[52:55], v[212:215]
    s_addc_u32 s53, s13, 0
    v_mfma_f32_16x16x32_bf16 v[228:231], a[68:71], a[56:59], v[228:231]
    ds_read_b128 a[12:15], v8 offset:40960
    s_and_b32 s53, s53, 0xffff
    v_mfma_f32_16x16x32_bf16 v[244:247], a[68:71], a[60:63], v[244:247]
    ds_read_b64_tr_b16 a[68:69], v15 offset:0
    s_sub_u32 s54, 2097152, s83
    v_mfma_f32_16x16x32_bf16 v[136:139], a[72:75], a[32:35], v[136:139]
    ds_read_b64_tr_b16 a[70:71], v15 offset:256
    s_mov_b32 s55, 0x20000
    v_mfma_f32_16x16x32_bf16 v[152:155], a[72:75], a[36:39], v[152:155]
    s_lshl_b32 s3, s60, 11
    v_mfma_f32_16x16x32_bf16 v[168:171], a[72:75], a[40:43], v[168:171]
    ds_read_b128 a[16:19], v8 offset:43008
    v_lshrrev_b32 v34, 4, v0
    v_mfma_f32_16x16x32_bf16 v[184:187], a[72:75], a[44:47], v[184:187]
    v_and_b32 v35, 15, v0
    v_mfma_f32_16x16x32_bf16 v[200:203], a[72:75], a[48:51], v[200:203]
    v_lshlrev_b32 v36, 1, v34
    v_mfma_f32_16x16x32_bf16 v[216:219], a[72:75], a[52:55], v[216:219]
    v_add_u32 v36, 0, v36
    v_mfma_f32_16x16x32_bf16 v[232:235], a[72:75], a[56:59], v[232:235]
    ds_read_b128 a[20:23], v8 offset:45056
    v_xor_b32 v36, v36, v35
    v_mfma_f32_16x16x32_bf16 v[248:251], a[72:75], a[60:63], v[248:251]
    ds_read_b64_tr_b16 a[72:73], v13 offset:1024
    v_lshlrev_b32 v36, 4, v36
    v_mfma_f32_16x16x32_bf16 v[140:143], a[76:79], a[32:35], v[140:143]
    ds_read_b64_tr_b16 a[74:75], v13 offset:1280
    v_lshl_add_u32 v36, v34, 11, v36
    v_mfma_f32_16x16x32_bf16 v[156:159], a[76:79], a[36:39], v[156:159]
    s_lshl_b32 s82, s60, 14
    v_mfma_f32_16x16x32_bf16 v[172:175], a[76:79], a[40:43], v[172:175]
    ds_read_b128 a[24:27], v8 offset:47104
    s_add_u32 s82, s82, 0
    v_mfma_f32_16x16x32_bf16 v[188:191], a[76:79], a[44:47], v[188:191]
    v_add_u32 v17, s82, v36
    v_mfma_f32_16x16x32_bf16 v[204:207], a[76:79], a[48:51], v[204:207]
    s_lshl_b32 s82, s62, 1
    v_mfma_f32_16x16x32_bf16 v[220:223], a[76:79], a[52:55], v[220:223]
    s_add_u32 s82, s82, 0
    v_mfma_f32_16x16x32_bf16 v[236:239], a[76:79], a[56:59], v[236:239]
    ds_read_b128 a[28:31], v8 offset:49152
    s_lshl_b32 s82, s82, 3
    v_mfma_f32_16x16x32_bf16 v[252:255], a[76:79], a[60:63], v[252:255]
    ds_read_b64_tr_b16 a[76:77], v15 offset:1024
    s_lshl_b32 s83, s61, 2
    v_mfma_f32_16x16x32_bf16 a[128:131], a[80:83], a[32:35], a[128:131]
    ds_read_b64_tr_b16 a[78:79], v15 offset:1280
    s_add_u32 s82, s82, s83
    v_mfma_f32_16x16x32_bf16 a[144:147], a[80:83], a[36:39], a[144:147]
    s_mul_i32 s83, s62, 96
    v_mfma_f32_16x16x32_bf16 a[160:163], a[80:83], a[40:43], a[160:163]
    ds_read_b64_tr_b16 a[96:97], v13 offset:4096
    s_add_u32 s82, s82, s83
    v_mfma_f32_16x16x32_bf16 a[176:179], a[80:83], a[44:47], a[176:179]
    s_lshl_b32 s82, s82, 11
    v_mfma_f32_16x16x32_bf16 a[192:195], a[80:83], a[48:51], a[192:195]
    s_sub_u32 s82, s82, 0
    v_mfma_f32_16x16x32_bf16 a[208:211], a[80:83], a[52:55], a[208:211]
    v_add_u32 v19, s82, v36
    v_mfma_f32_16x16x32_bf16 a[224:227], a[80:83], a[56:59], a[224:227]
    ds_read_b64_tr_b16 a[98:99], v13 offset:4352
    v_lshlrev_b32 v36, 1, v34
    v_mfma_f32_16x16x32_bf16 a[240:243], a[80:83], a[60:63], a[240:243]
    ds_read_b64_tr_b16 a[80:81], v13 offset:2048
    v_add_u32 v36, 8, v36
    v_mfma_f32_16x16x32_bf16 a[132:135], a[84:87], a[32:35], a[132:135]
    ds_read_b64_tr_b16 a[82:83], v13 offset:2304
    v_xor_b32 v36, v36, v35
    v_mfma_f32_16x16x32_bf16 a[148:151], a[84:87], a[36:39], a[148:151]
    v_lshlrev_b32 v36, 4, v36
    v_mfma_f32_16x16x32_bf16 a[164:167], a[84:87], a[40:43], a[164:167]
    ds_read_b64_tr_b16 a[100:101], v15 offset:4096
    v_lshl_add_u32 v36, v34, 11, v36
    v_mfma_f32_16x16x32_bf16 a[180:183], a[84:87], a[44:47], a[180:183]
    s_lshl_b32 s82, s60, 14
    v_mfma_f32_16x16x32_bf16 a[196:199], a[84:87], a[48:51], a[196:199]
    s_add_u32 s82, s82, 7168
    v_mfma_f32_16x16x32_bf16 a[212:215], a[84:87], a[52:55], a[212:215]
    v_add_u32 v18, s82, v36
    v_mfma_f32_16x16x32_bf16 a[228:231], a[84:87], a[56:59], a[228:231]
    ds_read_b64_tr_b16 a[102:103], v15 offset:4352
    s_lshl_b32 s82, s62, 1
    v_mfma_f32_16x16x32_bf16 a[244:247], a[84:87], a[60:63], a[244:247]
    ds_read_b64_tr_b16 a[84:85], v15 offset:2048
    s_add_u32 s82, s82, 1
    v_mfma_f32_16x16x32_bf16 a[136:139], a[88:91], a[32:35], a[136:139]
    ds_read_b64_tr_b16 a[86:87], v15 offset:2304
    s_lshl_b32 s82, s82, 3
    v_mfma_f32_16x16x32_bf16 a[152:155], a[88:91], a[36:39], a[152:155]
    s_lshl_b32 s83, s61, 2
    v_mfma_f32_16x16x32_bf16 a[168:171], a[88:91], a[40:43], a[168:171]
    s_add_u32 s82, s82, s83
    v_mfma_f32_16x16x32_bf16 a[184:187], a[88:91], a[44:47], a[184:187]
    s_mul_i32 s83, s62, 96
    v_mfma_f32_16x16x32_bf16 a[200:203], a[88:91], a[48:51], a[200:203]
    s_add_u32 s82, s82, s83
    v_mfma_f32_16x16x32_bf16 a[216:219], a[88:91], a[52:55], a[216:219]
    s_lshl_b32 s82, s82, 11
    v_mfma_f32_16x16x32_bf16 a[232:235], a[88:91], a[56:59], a[232:235]
    s_sub_u32 s82, s82, 1024
    v_mfma_f32_16x16x32_bf16 a[248:251], a[88:91], a[60:63], a[248:251]
    ds_read_b64_tr_b16 a[88:89], v13 offset:3072
    v_add_u32 v20, s82, v36
    v_mfma_f32_16x16x32_bf16 a[140:143], a[92:95], a[32:35], a[140:143]
    ds_read_b64_tr_b16 a[90:91], v13 offset:3328
    s_xor_b32 s82, s65, 0
    v_mfma_f32_16x16x32_bf16 a[156:159], a[92:95], a[36:39], a[156:159]
    s_lshl_b32 s82, s82, 10
    v_mfma_f32_16x16x32_bf16 a[172:175], a[92:95], a[40:43], a[172:175]
    v_add_u32 v21, s82, v16
    v_mfma_f32_16x16x32_bf16 a[188:191], a[92:95], a[44:47], a[188:191]
    s_xor_b32 s82, s65, 1
    v_mfma_f32_16x16x32_bf16 a[204:207], a[92:95], a[48:51], a[204:207]
    s_lshl_b32 s82, s82, 10
    v_mfma_f32_16x16x32_bf16 a[220:223], a[92:95], a[52:55], a[220:223]
    v_add_u32 v22, s82, v16
    v_mfma_f32_16x16x32_bf16 a[236:239], a[92:95], a[56:59], a[236:239]
    s_xor_b32 s82, s65, 2
    v_mfma_f32_16x16x32_bf16 a[252:255], a[92:95], a[60:63], a[252:255]
    ds_read_b64_tr_b16 a[92:93], v15 offset:3072
    s_lshl_b32 s82, s82, 10
    v_mfma_f32_16x16x32_bf16 v[48:51], a[104:107], a[32:35], v[48:51]
    ds_read_b64_tr_b16 a[94:95], v15 offset:3328
    v_add_u32 v23, s82, v16
    v_mfma_f32_16x16x32_bf16 v[52:55], a[104:107], a[36:39], v[52:55]
    s_xor_b32 s82, s65, 3
    v_mfma_f32_16x16x32_bf16 v[64:67], a[104:107], a[40:43], v[64:67]
    s_lshl_b32 s82, s82, 10
    v_mfma_f32_16x16x32_bf16 v[68:71], a[104:107], a[44:47], v[68:71]
    v_add_u32 v24, s82, v16
    v_mfma_f32_16x16x32_bf16 v[80:83], a[104:107], a[48:51], v[80:83]
    s_mov_b32 s94, 0xbdd2d3e8
    v_mfma_f32_16x16x32_bf16 v[84:87], a[104:107], a[52:55], v[84:87]
    v_mfma_f32_16x16x32_bf16 v[96:99], a[104:107], a[56:59], v[96:99]
    v_mfma_f32_16x16x32_bf16 v[100:103], a[104:107], a[60:63], v[100:103]
    v_mfma_f32_16x16x32_bf16 v[56:59], a[108:111], a[32:35], v[56:59]
    v_mfma_f32_16x16x32_bf16 v[60:63], a[108:111], a[36:39], v[60:63]
    v_mfma_f32_16x16x32_bf16 v[72:75], a[108:111], a[40:43], v[72:75]
    v_mfma_f32_16x16x32_bf16 v[76:79], a[108:111], a[44:47], v[76:79]
    v_mfma_f32_16x16x32_bf16 v[88:91], a[108:111], a[48:51], v[88:91]
    v_mfma_f32_16x16x32_bf16 v[92:95], a[108:111], a[52:55], v[92:95]
    v_mfma_f32_16x16x32_bf16 v[104:107], a[108:111], a[56:59], v[104:107]
    v_mfma_f32_16x16x32_bf16 v[108:111], a[108:111], a[60:63], v[108:111]
    s_waitcnt vmcnt(3) lgkmcnt(0)
    s_barrier
    v_mfma_f32_16x16x32_bf16 v[128:131], a[64:67], a[0:3], v[128:131]
    v_mfma_f32_16x16x32_bf16 v[144:147], a[64:67], a[4:7], v[144:147]
    v_mfma_f32_16x16x32_bf16 v[160:163], a[64:67], a[8:11], v[160:163]
    ds_read_b128 a[32:35], v9 offset:34816
    v_mfma_f32_16x16x32_bf16 v[176:179], a[64:67], a[12:15], v[176:179]
    v_mfma_f32_16x16x32_bf16 v[192:195], a[64:67], a[16:19], v[192:195]
    s_mov_b32 s95, 0xbdd2d3e8
    v_mfma_f32_16x16x32_bf16 v[208:211], a[64:67], a[20:23], v[208:211]
    v_mov_b32 v26, 0xc0135761
    v_mfma_f32_16x16x32_bf16 v[224:227], a[64:67], a[24:27], v[224:227]
    ds_read_b128 a[36:39], v9 offset:36864
    v_mov_b32 v27, 0xc0135761
    v_mfma_f32_16x16x32_bf16 v[240:243], a[64:67], a[28:31], v[240:243]
    ds_read_b64_tr_b16 a[64:65], v13 offset:20480
    v_mov_b32 v25, 1
    v_mfma_f32_16x16x32_bf16 v[132:135], a[68:71], a[0:3], v[132:135]
    ds_read_b64_tr_b16 a[66:67], v13 offset:20736
    s_lshl_b32 s82, s60, 12
    v_mfma_f32_16x16x32_bf16 v[148:151], a[68:71], a[4:7], v[148:151]
    s_add_u32 s68, s88, s82
    v_mfma_f32_16x16x32_bf16 v[164:167], a[68:71], a[8:11], v[164:167]
    ds_read_b128 a[40:43], v9 offset:38912
    s_lshl_b32 s82, s61, 13
    v_mfma_f32_16x16x32_bf16 v[180:183], a[68:71], a[12:15], v[180:183]
    s_add_u32 s88, s88, s82
    v_mfma_f32_16x16x32_bf16 v[196:199], a[68:71], a[16:19], v[196:199]
    s_lshr_b32 s82, s66, 1
    v_mfma_f32_16x16x32_bf16 v[212:215], a[68:71], a[20:23], v[212:215]
    s_add_u32 s82, s82, 24
    v_mfma_f32_16x16x32_bf16 v[228:231], a[68:71], a[24:27], v[228:231]
    ds_read_b128 a[44:47], v9 offset:40960
    s_lshl_b32 s82, s82, 14
    v_mfma_f32_16x16x32_bf16 v[244:247], a[68:71], a[28:31], v[244:247]
    ds_read_b64_tr_b16 a[68:69], v15 offset:20480
    s_add_u32 s90, s88, s82
    v_mfma_f32_16x16x32_bf16 v[136:139], a[72:75], a[0:3], v[136:139]
    ds_read_b64_tr_b16 a[70:71], v15 offset:20736
    s_lshl_b32 s82, s66, 14
    v_mfma_f32_16x16x32_bf16 v[152:155], a[72:75], a[4:7], v[152:155]
    s_add_u32 s88, s88, s82
    v_mfma_f32_16x16x32_bf16 v[168:171], a[72:75], a[8:11], v[168:171]
    ds_read_b128 a[48:51], v9 offset:43008
    s_add_u32 s89, s88, 262144
    v_mfma_f32_16x16x32_bf16 v[184:187], a[72:75], a[12:15], v[184:187]
    s_add_u32 s88, s88, 131072
    v_mfma_f32_16x16x32_bf16 v[200:203], a[72:75], a[16:19], v[200:203]
    s_mov_b32 s76, s93
    v_mfma_f32_16x16x32_bf16 v[216:219], a[72:75], a[20:23], v[216:219]
    s_lshl_b32 s82, s63, 4
    v_mfma_f32_16x16x32_bf16 v[232:235], a[72:75], a[24:27], v[232:235]
    ds_read_b128 a[52:55], v9 offset:45056
    s_lshl_b32 s83, s60, 2
    v_mfma_f32_16x16x32_bf16 v[248:251], a[72:75], a[28:31], v[248:251]
    ds_read_b64_tr_b16 a[72:73], v13 offset:21504
    s_add_u32 s83, s83, s82
    v_mfma_f32_16x16x32_bf16 v[140:143], a[76:79], a[0:3], v[140:143]
    ds_read_b64_tr_b16 a[74:75], v13 offset:21760
    s_add_u32 s83, s83, s65
    v_mfma_f32_16x16x32_bf16 v[156:159], a[76:79], a[4:7], v[156:159]
    s_lshl_b32 s83, s83, 15
    v_mfma_f32_16x16x32_bf16 v[172:175], a[76:79], a[8:11], v[172:175]
    ds_read_b128 a[56:59], v9 offset:47104
    s_add_u32 s69, s83, 4194304
    v_mfma_f32_16x16x32_bf16 v[188:191], a[76:79], a[12:15], v[188:191]
    s_lshl_b32 s84, s63, 3
    v_mfma_f32_16x16x32_bf16 v[204:207], a[76:79], a[16:19], v[204:207]
    s_add_u32 s84, s84, s66
    v_mfma_f32_16x16x32_bf16 v[220:223], a[76:79], a[20:23], v[220:223]
    s_lshl_b32 s85, s84, 2
    v_mfma_f32_16x16x32_bf16 v[236:239], a[76:79], a[24:27], v[236:239]
    ds_read_b128 a[60:63], v9 offset:49152
    s_add_u32 s85, s85, s60
    v_mfma_f32_16x16x32_bf16 v[252:255], a[76:79], a[28:31], v[252:255]
    ds_read_b64_tr_b16 a[76:77], v15 offset:21504
    s_lshl_b32 s85, s85, 8
    v_mfma_f32_16x16x32_bf16 a[128:131], a[80:83], a[0:3], a[128:131]
    ds_read_b64_tr_b16 a[78:79], v15 offset:21760
    s_add_u32 s77, s85, 39862272
    v_mfma_f32_16x16x32_bf16 a[144:147], a[80:83], a[4:7], a[144:147]
    s_lshl_b32 s84, s84, 18
    v_mfma_f32_16x16x32_bf16 a[160:163], a[80:83], a[8:11], a[160:163]
    ds_read_b64_tr_b16 a[104:105], v13 offset:24576
    s_lshl_b32 s85, s60, 12
    v_mfma_f32_16x16x32_bf16 a[176:179], a[80:83], a[12:15], a[176:179]
    s_add_u32 s84, s84, s85
    v_mfma_f32_16x16x32_bf16 a[192:195], a[80:83], a[16:19], a[192:195]
    s_add_u32 s84, s84, 23068672
    v_mfma_f32_16x16x32_bf16 a[208:211], a[80:83], a[20:23], a[208:211]
    s_xor_b32 s85, s65, 1
    v_mfma_f32_16x16x32_bf16 a[224:227], a[80:83], a[24:27], a[224:227]
    ds_read_b64_tr_b16 a[106:107], v13 offset:24832
    s_lshl_b32 s85, s85, 16
    v_mfma_f32_16x16x32_bf16 a[240:243], a[80:83], a[28:31], a[240:243]
    ds_read_b64_tr_b16 a[80:81], v13 offset:22528
    s_add_u32 s70, s84, s85
    v_mfma_f32_16x16x32_bf16 a[132:135], a[84:87], a[0:3], a[132:135]
    ds_read_b64_tr_b16 a[82:83], v13 offset:22784
    s_add_u32 s70, s70, 16384
    v_mfma_f32_16x16x32_bf16 a[148:151], a[84:87], a[4:7], a[148:151]
    s_lshl_b32 s85, s65, 16
    v_mfma_f32_16x16x32_bf16 a[164:167], a[84:87], a[8:11], a[164:167]
    ds_read_b64_tr_b16 a[108:109], v15 offset:24576
    s_add_u32 s73, s84, s85
    v_mfma_f32_16x16x32_bf16 a[180:183], a[84:87], a[12:15], a[180:183]
    s_add_u32 s73, s73, 16384
    v_mfma_f32_16x16x32_bf16 a[196:199], a[84:87], a[16:19], a[196:199]
    s_xor_b32 s85, s65, 2
    v_mfma_f32_16x16x32_bf16 a[212:215], a[84:87], a[20:23], a[212:215]
    s_lshl_b32 s85, s85, 16
    v_mfma_f32_16x16x32_bf16 a[228:231], a[84:87], a[24:27], a[228:231]
    ds_read_b64_tr_b16 a[110:111], v15 offset:24832
    s_add_u32 s71, s84, s85
    v_mfma_f32_16x16x32_bf16 a[244:247], a[84:87], a[28:31], a[244:247]
    ds_read_b64_tr_b16 a[84:85], v15 offset:22528
    s_add_u32 s71, s71, 32768
    v_mfma_f32_16x16x32_bf16 a[136:139], a[88:91], a[0:3], a[136:139]
    ds_read_b64_tr_b16 a[86:87], v15 offset:22784
    s_lshl_b32 s85, s65, 16
    v_mfma_f32_16x16x32_bf16 a[152:155], a[88:91], a[4:7], a[152:155]
    s_add_u32 s74, s84, s85
    v_mfma_f32_16x16x32_bf16 a[168:171], a[88:91], a[8:11], a[168:171]
    s_add_u32 s74, s74, 32768
    v_mfma_f32_16x16x32_bf16 a[184:187], a[88:91], a[12:15], a[184:187]
    s_xor_b32 s85, s65, 3
    v_mfma_f32_16x16x32_bf16 a[200:203], a[88:91], a[16:19], a[200:203]
    s_lshl_b32 s85, s85, 16
    v_mfma_f32_16x16x32_bf16 a[216:219], a[88:91], a[20:23], a[216:219]
    s_add_u32 s72, s84, s85
    v_mfma_f32_16x16x32_bf16 a[232:235], a[88:91], a[24:27], a[232:235]
    s_add_u32 s72, s72, 49152
    v_mfma_f32_16x16x32_bf16 a[248:251], a[88:91], a[28:31], a[248:251]
    ds_read_b64_tr_b16 a[88:89], v13 offset:23552
    s_lshl_b32 s85, s65, 16
    v_mfma_f32_16x16x32_bf16 a[140:143], a[92:95], a[0:3], a[140:143]
    ds_read_b64_tr_b16 a[90:91], v13 offset:23808
    s_add_u32 s75, s84, s85
    v_mfma_f32_16x16x32_bf16 a[156:159], a[92:95], a[4:7], a[156:159]
    s_add_u32 s75, s75, 49152
    v_mfma_f32_16x16x32_bf16 a[172:175], a[92:95], a[8:11], a[172:175]
    v_and_b32 v36, 1, v34
    v_mfma_f32_16x16x32_bf16 a[188:191], a[92:95], a[12:15], a[188:191]
    v_lshlrev_b32 v36, 10, v36
    v_mfma_f32_16x16x32_bf16 a[204:207], a[92:95], a[16:19], a[204:207]
    v_lshrrev_b32 v34, 1, v34
    v_mfma_f32_16x16x32_bf16 a[220:223], a[92:95], a[20:23], a[220:223]
    v_lshl_add_u32 v36, v34, 8, v36
    v_mfma_f32_16x16x32_bf16 a[236:239], a[92:95], a[24:27], a[236:239]
    v_lshl_add_u32 v36, v35, 4, v36
    v_mfma_f32_16x16x32_bf16 a[252:255], a[92:95], a[28:31], a[252:255]
    ds_read_b64_tr_b16 a[92:93], v15 offset:23552
    s_and_b32 s82, s66, 1
    v_mfma_f32_16x16x32_bf16 v[48:51], a[96:99], a[0:3], v[48:51]
    ds_read_b64_tr_b16 a[94:95], v15 offset:23808
    s_lshl_b32 s82, s82, 9
    v_mfma_f32_16x16x32_bf16 v[52:55], a[96:99], a[4:7], v[52:55]
    v_add_u32 v28, s82, v36
    v_mfma_f32_16x16x32_bf16 v[64:67], a[96:99], a[8:11], v[64:67]
    v_mov_b32 v29, 0x100
    v_mfma_f32_16x16x32_bf16 v[68:71], a[96:99], a[12:15], v[68:71]
    v_mov_b32 v42, 0x10000
    v_mfma_f32_16x16x32_bf16 v[80:83], a[96:99], a[16:19], v[80:83]
    s_mov_b32 s93, s92
    v_mfma_f32_16x16x32_bf16 v[84:87], a[96:99], a[20:23], v[84:87]
    v_mfma_f32_16x16x32_bf16 v[96:99], a[96:99], a[24:27], v[96:99]
    v_mfma_f32_16x16x32_bf16 v[100:103], a[96:99], a[28:31], v[100:103]
    v_mfma_f32_16x16x32_bf16 v[56:59], a[100:103], a[0:3], v[56:59]
    v_mfma_f32_16x16x32_bf16 v[60:63], a[100:103], a[4:7], v[60:63]
    v_mfma_f32_16x16x32_bf16 v[72:75], a[100:103], a[8:11], v[72:75]
    v_mfma_f32_16x16x32_bf16 v[76:79], a[100:103], a[12:15], v[76:79]
    v_mfma_f32_16x16x32_bf16 v[88:91], a[100:103], a[16:19], v[88:91]
    v_mfma_f32_16x16x32_bf16 v[92:95], a[100:103], a[20:23], v[92:95]
    v_mfma_f32_16x16x32_bf16 v[104:107], a[100:103], a[24:27], v[104:107]
    v_mfma_f32_16x16x32_bf16 v[108:111], a[100:103], a[28:31], v[108:111]
    s_waitcnt lgkmcnt(0)
    s_barrier
    v_mfma_f32_16x16x32_bf16 v[128:131], a[64:67], a[32:35], v[128:131]
    v_mfma_f32_16x16x32_bf16 v[144:147], a[64:67], a[36:39], v[144:147]
    v_mfma_f32_16x16x32_bf16 v[160:163], a[64:67], a[40:43], v[160:163]
    s_mov_b32 s82, 0
    s_add_u32 m0, s3, 0
    v_mfma_f32_16x16x32_bf16 v[176:179], a[64:67], a[44:47], v[176:179]
    buffer_load_dwordx4 v17, s[48:51], s82 offen lds
    v_mfma_f32_16x16x32_bf16 v[192:195], a[64:67], a[48:51], v[192:195]
    v_mfma_f32_16x16x32_bf16 v[208:211], a[64:67], a[52:55], v[208:211]
    v_mfma_f32_16x16x32_bf16 v[224:227], a[64:67], a[56:59], v[224:227]
    v_mfma_f32_16x16x32_bf16 v[240:243], a[64:67], a[60:63], v[240:243]
    buffer_load_dwordx4 v18, s[48:51], s82 offen offset:1024 lds
    v_mfma_f32_16x16x32_bf16 v[132:135], a[68:71], a[32:35], v[132:135]
    v_mfma_f32_16x16x32_bf16 v[148:151], a[68:71], a[36:39], v[148:151]
    v_mfma_f32_16x16x32_bf16 v[164:167], a[68:71], a[40:43], v[164:167]
    v_mfma_f32_16x16x32_bf16 v[180:183], a[68:71], a[44:47], v[180:183]
    s_mov_b32 s83, 229376
    s_add_u32 m0, s3, 8192
    v_mfma_f32_16x16x32_bf16 v[196:199], a[68:71], a[48:51], v[196:199]
    buffer_load_dwordx4 v17, s[48:51], s83 offen lds
    v_mfma_f32_16x16x32_bf16 v[212:215], a[68:71], a[52:55], v[212:215]
    v_mfma_f32_16x16x32_bf16 v[228:231], a[68:71], a[56:59], v[228:231]
    v_mfma_f32_16x16x32_bf16 v[244:247], a[68:71], a[60:63], v[244:247]
    v_mfma_f32_16x16x32_bf16 v[136:139], a[72:75], a[32:35], v[136:139]
    buffer_load_dwordx4 v18, s[48:51], s83 offen offset:1024 lds
    v_mfma_f32_16x16x32_bf16 v[152:155], a[72:75], a[36:39], v[152:155]
    v_mfma_f32_16x16x32_bf16 v[168:171], a[72:75], a[40:43], v[168:171]
    v_mfma_f32_16x16x32_bf16 v[184:187], a[72:75], a[44:47], v[184:187]
    v_mfma_f32_16x16x32_bf16 v[200:203], a[72:75], a[48:51], v[200:203]
    s_mov_b32 s82, 458752
    s_add_u32 m0, s3, 16384
    v_mfma_f32_16x16x32_bf16 v[216:219], a[72:75], a[52:55], v[216:219]
    buffer_load_dwordx4 v17, s[48:51], s82 offen lds
    v_mfma_f32_16x16x32_bf16 v[232:235], a[72:75], a[56:59], v[232:235]
    v_mfma_f32_16x16x32_bf16 v[248:251], a[72:75], a[60:63], v[248:251]
    v_mfma_f32_16x16x32_bf16 v[140:143], a[76:79], a[32:35], v[140:143]
    v_mfma_f32_16x16x32_bf16 v[156:159], a[76:79], a[36:39], v[156:159]
    buffer_load_dwordx4 v18, s[48:51], s82 offen offset:1024 lds
    v_mfma_f32_16x16x32_bf16 v[172:175], a[76:79], a[40:43], v[172:175]
    v_mfma_f32_16x16x32_bf16 v[188:191], a[76:79], a[44:47], v[188:191]
    v_mfma_f32_16x16x32_bf16 v[204:207], a[76:79], a[48:51], v[204:207]
    v_mfma_f32_16x16x32_bf16 v[220:223], a[76:79], a[52:55], v[220:223]
    s_mov_b32 s83, 688128
    s_add_u32 m0, s3, 24576
    v_mfma_f32_16x16x32_bf16 v[236:239], a[76:79], a[56:59], v[236:239]
    buffer_load_dwordx4 v17, s[48:51], s83 offen lds
    v_mfma_f32_16x16x32_bf16 v[252:255], a[76:79], a[60:63], v[252:255]
    v_mfma_f32_16x16x32_bf16 a[128:131], a[80:83], a[32:35], a[128:131]
    v_mfma_f32_16x16x32_bf16 a[144:147], a[80:83], a[36:39], a[144:147]
    v_mfma_f32_16x16x32_bf16 a[160:163], a[80:83], a[40:43], a[160:163]
    buffer_load_dwordx4 v18, s[48:51], s83 offen offset:1024 lds
    v_mfma_f32_16x16x32_bf16 a[176:179], a[80:83], a[44:47], a[176:179]
    v_mfma_f32_16x16x32_bf16 a[192:195], a[80:83], a[48:51], a[192:195]
    v_mfma_f32_16x16x32_bf16 a[208:211], a[80:83], a[52:55], a[208:211]
    v_mfma_f32_16x16x32_bf16 a[224:227], a[80:83], a[56:59], a[224:227]
    s_mov_b32 s82, 917504
    s_add_u32 m0, s3, 32768
    v_mfma_f32_16x16x32_bf16 a[240:243], a[80:83], a[60:63], a[240:243]
    buffer_load_dwordx4 v17, s[48:51], s82 offen lds
    v_mfma_f32_16x16x32_bf16 a[132:135], a[84:87], a[32:35], a[132:135]
    v_mfma_f32_16x16x32_bf16 a[148:151], a[84:87], a[36:39], a[148:151]
    v_mfma_f32_16x16x32_bf16 a[164:167], a[84:87], a[40:43], a[164:167]
    v_mfma_f32_16x16x32_bf16 a[180:183], a[84:87], a[44:47], a[180:183]
    buffer_load_dwordx4 v18, s[48:51], s82 offen offset:1024 lds
    v_mfma_f32_16x16x32_bf16 a[196:199], a[84:87], a[48:51], a[196:199]
    v_mfma_f32_16x16x32_bf16 a[212:215], a[84:87], a[52:55], a[212:215]
    v_mfma_f32_16x16x32_bf16 a[228:231], a[84:87], a[56:59], a[228:231]
    v_mfma_f32_16x16x32_bf16 a[244:247], a[84:87], a[60:63], a[244:247]
    s_mov_b32 s83, 1146880
    s_add_u32 m0, s3, 40960
    v_mfma_f32_16x16x32_bf16 a[136:139], a[88:91], a[32:35], a[136:139]
    buffer_load_dwordx4 v17, s[48:51], s83 offen lds
    v_mfma_f32_16x16x32_bf16 a[152:155], a[88:91], a[36:39], a[152:155]
    v_mfma_f32_16x16x32_bf16 a[168:171], a[88:91], a[40:43], a[168:171]
    v_mfma_f32_16x16x32_bf16 a[184:187], a[88:91], a[44:47], a[184:187]
    v_mfma_f32_16x16x32_bf16 a[200:203], a[88:91], a[48:51], a[200:203]
    buffer_load_dwordx4 v18, s[48:51], s83 offen offset:1024 lds
    v_mfma_f32_16x16x32_bf16 a[216:219], a[88:91], a[52:55], a[216:219]
    v_mfma_f32_16x16x32_bf16 a[232:235], a[88:91], a[56:59], a[232:235]
    v_mfma_f32_16x16x32_bf16 a[248:251], a[88:91], a[60:63], a[248:251]
    v_mfma_f32_16x16x32_bf16 a[140:143], a[92:95], a[32:35], a[140:143]
    s_mov_b32 s82, 1376256
    s_add_u32 m0, s3, 49152
    v_mfma_f32_16x16x32_bf16 a[156:159], a[92:95], a[36:39], a[156:159]
    buffer_load_dwordx4 v17, s[48:51], s82 offen lds
    v_mfma_f32_16x16x32_bf16 a[172:175], a[92:95], a[40:43], a[172:175]
    v_mfma_f32_16x16x32_bf16 a[188:191], a[92:95], a[44:47], a[188:191]
    v_mfma_f32_16x16x32_bf16 a[204:207], a[92:95], a[48:51], a[204:207]
    v_mfma_f32_16x16x32_bf16 a[220:223], a[92:95], a[52:55], a[220:223]
    buffer_load_dwordx4 v18, s[48:51], s82 offen offset:1024 lds
    v_mfma_f32_16x16x32_bf16 a[236:239], a[92:95], a[56:59], a[236:239]
    v_mfma_f32_16x16x32_bf16 a[252:255], a[92:95], a[60:63], a[252:255]
    v_mfma_f32_16x16x32_bf16 v[48:51], a[104:107], a[32:35], v[48:51]
    v_mfma_f32_16x16x32_bf16 v[52:55], a[104:107], a[36:39], v[52:55]
    s_mov_b32 s83, 1605632
    s_add_u32 m0, s3, 57344
    v_mfma_f32_16x16x32_bf16 v[64:67], a[104:107], a[40:43], v[64:67]
    buffer_load_dwordx4 v17, s[48:51], s83 offen lds
    v_mfma_f32_16x16x32_bf16 v[68:71], a[104:107], a[44:47], v[68:71]
    v_mfma_f32_16x16x32_bf16 v[80:83], a[104:107], a[48:51], v[80:83]
    v_mfma_f32_16x16x32_bf16 v[84:87], a[104:107], a[52:55], v[84:87]
    v_mfma_f32_16x16x32_bf16 v[96:99], a[104:107], a[56:59], v[96:99]
    buffer_load_dwordx4 v18, s[48:51], s83 offen offset:1024 lds
    v_mfma_f32_16x16x32_bf16 v[100:103], a[104:107], a[60:63], v[100:103]
    v_mfma_f32_16x16x32_bf16 v[56:59], a[108:111], a[32:35], v[56:59]
    v_mfma_f32_16x16x32_bf16 v[60:63], a[108:111], a[36:39], v[60:63]
    v_mfma_f32_16x16x32_bf16 v[72:75], a[108:111], a[40:43], v[72:75]
    v_mfma_f32_16x16x32_bf16 v[76:79], a[108:111], a[44:47], v[76:79]
    v_mfma_f32_16x16x32_bf16 v[88:91], a[108:111], a[48:51], v[88:91]
    v_mfma_f32_16x16x32_bf16 v[92:95], a[108:111], a[52:55], v[92:95]
    v_mfma_f32_16x16x32_bf16 v[104:107], a[108:111], a[56:59], v[104:107]
    v_mfma_f32_16x16x32_bf16 v[108:111], a[108:111], a[60:63], v[108:111]
L_epi:
    v_pk_mul_f32 v[34:35], v[128:129], v[128:129]
    v_pk_mul_f32 v[36:37], v[130:131], v[130:131]
    v_pk_mul_f32 v[38:39], v[132:133], v[132:133]
    v_pk_mul_f32 v[40:41], v[134:135], v[134:135]
    v_pk_fma_f32 v[34:35], v[34:35], s[94:95], v[26:27]
    v_pk_fma_f32 v[36:37], v[36:37], s[94:95], v[26:27]
    v_pk_fma_f32 v[38:39], v[38:39], s[94:95], v[26:27]
    v_pk_fma_f32 v[40:41], v[40:41], s[94:95], v[26:27]
    v_pk_mul_f32 v[34:35], v[34:35], v[128:129]
    v_pk_mul_f32 v[36:37], v[36:37], v[130:131]
    v_pk_mul_f32 v[38:39], v[38:39], v[132:133]
    v_pk_mul_f32 v[40:41], v[40:41], v[134:135]
    v_exp_f32 v34, v34
    v_exp_f32 v35, v35
    v_exp_f32 v36, v36
    v_exp_f32 v37, v37
    v_exp_f32 v38, v38
    v_exp_f32 v39, v39
    v_exp_f32 v40, v40
    v_exp_f32 v41, v41
    v_pk_mul_f32 v[136:137], v[136:137], v[128:129]
    v_pk_mul_f32 v[138:139], v[138:139], v[130:131]
    v_pk_mul_f32 v[140:141], v[140:141], v[132:133]
    v_pk_mul_f32 v[142:143], v[142:143], v[134:135]
    v_pk_add_f32 v[34:35], v[34:35], 1.0 op_sel_hi:[1,0]
    v_pk_add_f32 v[36:37], v[36:37], 1.0 op_sel_hi:[1,0]
    v_pk_add_f32 v[38:39], v[38:39], 1.0 op_sel_hi:[1,0]
    v_pk_add_f32 v[40:41], v[40:41], 1.0 op_sel_hi:[1,0]
    v_rcp_f32 v34, v34
    v_rcp_f32 v35, v35
    v_rcp_f32 v36, v36
    v_rcp_f32 v37, v37
    v_rcp_f32 v38, v38
    v_rcp_f32 v39, v39
    v_rcp_f32 v40, v40
    v_rcp_f32 v41, v41
    v_pk_mul_f32 v[136:137], v[136:137], v[34:35]
    v_pk_mul_f32 v[138:139], v[138:139], v[36:37]
    v_pk_mul_f32 v[140:141], v[140:141], v[38:39]
    v_pk_mul_f32 v[142:143], v[142:143], v[40:41]
    v_cvt_pk_bf16_f32 v128, v136, v137
    v_cvt_pk_bf16_f32 v129, v138, v139
    v_cvt_pk_bf16_f32 v130, v140, v141
    v_cvt_pk_bf16_f32 v131, v142, v143
    buffer_store_dwordx4 v[128:131], v16, s[56:59], s88 offen offset:0 sc1
    v_pk_mul_f32 v[34:35], v[144:145], v[144:145]
    v_pk_mul_f32 v[36:37], v[146:147], v[146:147]
    v_pk_mul_f32 v[38:39], v[148:149], v[148:149]
    v_pk_mul_f32 v[40:41], v[150:151], v[150:151]
    v_pk_fma_f32 v[34:35], v[34:35], s[94:95], v[26:27]
    v_pk_fma_f32 v[36:37], v[36:37], s[94:95], v[26:27]
    v_pk_fma_f32 v[38:39], v[38:39], s[94:95], v[26:27]
    v_pk_fma_f32 v[40:41], v[40:41], s[94:95], v[26:27]
    v_pk_mul_f32 v[34:35], v[34:35], v[144:145]
    v_pk_mul_f32 v[36:37], v[36:37], v[146:147]
    v_pk_mul_f32 v[38:39], v[38:39], v[148:149]
    v_pk_mul_f32 v[40:41], v[40:41], v[150:151]
    v_exp_f32 v34, v34
    v_exp_f32 v35, v35
    v_exp_f32 v36, v36
    v_exp_f32 v37, v37
    v_exp_f32 v38, v38
    v_exp_f32 v39, v39
    v_exp_f32 v40, v40
    v_exp_f32 v41, v41
    v_pk_mul_f32 v[152:153], v[152:153], v[144:145]
    v_pk_mul_f32 v[154:155], v[154:155], v[146:147]
    v_pk_mul_f32 v[156:157], v[156:157], v[148:149]
    v_pk_mul_f32 v[158:159], v[158:159], v[150:151]
    v_pk_add_f32 v[34:35], v[34:35], 1.0 op_sel_hi:[1,0]
    v_pk_add_f32 v[36:37], v[36:37], 1.0 op_sel_hi:[1,0]
    v_pk_add_f32 v[38:39], v[38:39], 1.0 op_sel_hi:[1,0]
    v_pk_add_f32 v[40:41], v[40:41], 1.0 op_sel_hi:[1,0]
    v_rcp_f32 v34, v34
    v_rcp_f32 v35, v35
    v_rcp_f32 v36, v36
    v_rcp_f32 v37, v37
    v_rcp_f32 v38, v38
    v_rcp_f32 v39, v39
    v_rcp_f32 v40, v40
    v_rcp_f32 v41, v41
    v_pk_mul_f32 v[152:153], v[152:153], v[34:35]
    v_pk_mul_f32 v[154:155], v[154:155], v[36:37]
    v_pk_mul_f32 v[156:157], v[156:157], v[38:39]
    v_pk_mul_f32 v[158:159], v[158:159], v[40:41]
    v_cvt_pk_bf16_f32 v144, v152, v153
    v_cvt_pk_bf16_f32 v145, v154, v155
    v_cvt_pk_bf16_f32 v146, v156, v157
    v_cvt_pk_bf16_f32 v147, v158, v159
    buffer_store_dwordx4 v[144:147], v16, s[56:59], s88 offen offset:1024 sc1
    v_pk_mul_f32 v[34:35], v[160:161], v[160:161]
    v_pk_mul_f32 v[36:37], v[162:163], v[162:163]
    v_pk_mul_f32 v[38:39], v[164:165], v[164:165]
    v_pk_mul_f32 v[40:41], v[166:167], v[166:167]
    v_pk_fma_f32 v[34:35], v[34:35], s[94:95], v[26:27]
    v_pk_fma_f32 v[36:37], v[36:37], s[94:95], v[26:27]
    v_pk_fma_f32 v[38:39], v[38:39], s[94:95], v[26:27]
    v_pk_fma_f32 v[40:41], v[40:41], s[94:95], v[26:27]
    v_pk_mul_f32 v[34:35], v[34:35], v[160:161]
    v_pk_mul_f32 v[36:37], v[36:37], v[162:163]
    v_pk_mul_f32 v[38:39], v[38:39], v[164:165]
    v_pk_mul_f32 v[40:41], v[40:41], v[166:167]
    v_exp_f32 v34, v34
    v_exp_f32 v35, v35
    v_exp_f32 v36, v36
    v_exp_f32 v37, v37
    v_exp_f32 v38, v38
    v_exp_f32 v39, v39
    v_exp_f32 v40, v40
    v_exp_f32 v41, v41
    v_pk_mul_f32 v[168:169], v[168:169], v[160:161]
    v_pk_mul_f32 v[170:171], v[170:171], v[162:163]
    v_pk_mul_f32 v[172:173], v[172:173], v[164:165]
    v_pk_mul_f32 v[174:175], v[174:175], v[166:167]
    v_pk_add_f32 v[34:35], v[34:35], 1.0 op_sel_hi:[1,0]
    v_pk_add_f32 v[36:37], v[36:37], 1.0 op_sel_hi:[1,0]
    v_pk_add_f32 v[38:39], v[38:39], 1.0 op_sel_hi:[1,0]
    v_pk_add_f32 v[40:41], v[40:41], 1.0 op_sel_hi:[1,0]
    v_rcp_f32 v34, v34
    v_rcp_f32 v35, v35
    v_rcp_f32 v36, v36
    v_rcp_f32 v37, v37
    v_rcp_f32 v38, v38
    v_rcp_f32 v39, v39
    v_rcp_f32 v40, v40
    v_rcp_f32 v41, v41
    v_pk_mul_f32 v[168:169], v[168:169], v[34:35]
    v_pk_mul_f32 v[170:171], v[170:171], v[36:37]
    v_pk_mul_f32 v[172:173], v[172:173], v[38:39]
    v_pk_mul_f32 v[174:175], v[174:175], v[40:41]
    v_cvt_pk_bf16_f32 v160, v168, v169
    v_cvt_pk_bf16_f32 v161, v170, v171
    v_cvt_pk_bf16_f32 v162, v172, v173
    v_cvt_pk_bf16_f32 v163, v174, v175
    buffer_store_dwordx4 v[160:163], v16, s[56:59], s88 offen offset:2048 sc1
    v_pk_mul_f32 v[34:35], v[176:177], v[176:177]
    v_pk_mul_f32 v[36:37], v[178:179], v[178:179]
    v_pk_mul_f32 v[38:39], v[180:181], v[180:181]
    v_pk_mul_f32 v[40:41], v[182:183], v[182:183]
    v_pk_fma_f32 v[34:35], v[34:35], s[94:95], v[26:27]
    v_pk_fma_f32 v[36:37], v[36:37], s[94:95], v[26:27]
    v_pk_fma_f32 v[38:39], v[38:39], s[94:95], v[26:27]
    v_pk_fma_f32 v[40:41], v[40:41], s[94:95], v[26:27]
    v_pk_mul_f32 v[34:35], v[34:35], v[176:177]
    v_pk_mul_f32 v[36:37], v[36:37], v[178:179]
    v_pk_mul_f32 v[38:39], v[38:39], v[180:181]
    v_pk_mul_f32 v[40:41], v[40:41], v[182:183]
    v_exp_f32 v34, v34
    v_exp_f32 v35, v35
    v_exp_f32 v36, v36
    v_exp_f32 v37, v37
    v_exp_f32 v38, v38
    v_exp_f32 v39, v39
    v_exp_f32 v40, v40
    v_exp_f32 v41, v41
    v_pk_mul_f32 v[184:185], v[184:185], v[176:177]
    v_pk_mul_f32 v[186:187], v[186:187], v[178:179]
    v_pk_mul_f32 v[188:189], v[188:189], v[180:181]
    v_pk_mul_f32 v[190:191], v[190:191], v[182:183]
    v_pk_add_f32 v[34:35], v[34:35], 1.0 op_sel_hi:[1,0]
    v_pk_add_f32 v[36:37], v[36:37], 1.0 op_sel_hi:[1,0]
    v_pk_add_f32 v[38:39], v[38:39], 1.0 op_sel_hi:[1,0]
    v_pk_add_f32 v[40:41], v[40:41], 1.0 op_sel_hi:[1,0]
    v_rcp_f32 v34, v34
    v_rcp_f32 v35, v35
    v_rcp_f32 v36, v36
    v_rcp_f32 v37, v37
    v_rcp_f32 v38, v38
    v_rcp_f32 v39, v39
    v_rcp_f32 v40, v40
    v_rcp_f32 v41, v41
    v_pk_mul_f32 v[184:185], v[184:185], v[34:35]
    v_pk_mul_f32 v[186:187], v[186:187], v[36:37]
    v_pk_mul_f32 v[188:189], v[188:189], v[38:39]
    v_pk_mul_f32 v[190:191], v[190:191], v[40:41]
    v_cvt_pk_bf16_f32 v176, v184, v185
    v_cvt_pk_bf16_f32 v177, v186, v187
    v_cvt_pk_bf16_f32 v178, v188, v189
    v_cvt_pk_bf16_f32 v179, v190, v191
    buffer_store_dwordx4 v[176:179], v16, s[56:59], s88 offen offset:3072 sc1
    v_pk_mul_f32 v[34:35], v[192:193], v[192:193]
    v_pk_mul_f32 v[36:37], v[194:195], v[194:195]
    v_pk_mul_f32 v[38:39], v[196:197], v[196:197]
    v_pk_mul_f32 v[40:41], v[198:199], v[198:199]
    v_pk_fma_f32 v[34:35], v[34:35], s[94:95], v[26:27]
    v_pk_fma_f32 v[36:37], v[36:37], s[94:95], v[26:27]
    v_pk_fma_f32 v[38:39], v[38:39], s[94:95], v[26:27]
    v_pk_fma_f32 v[40:41], v[40:41], s[94:95], v[26:27]
    v_pk_mul_f32 v[34:35], v[34:35], v[192:193]
    v_pk_mul_f32 v[36:37], v[36:37], v[194:195]
    v_pk_mul_f32 v[38:39], v[38:39], v[196:197]
    v_pk_mul_f32 v[40:41], v[40:41], v[198:199]
    v_exp_f32 v34, v34
    v_exp_f32 v35, v35
    v_exp_f32 v36, v36
    v_exp_f32 v37, v37
    v_exp_f32 v38, v38
    v_exp_f32 v39, v39
    v_exp_f32 v40, v40
    v_exp_f32 v41, v41
    v_pk_mul_f32 v[200:201], v[200:201], v[192:193]
    v_pk_mul_f32 v[202:203], v[202:203], v[194:195]
    v_pk_mul_f32 v[204:205], v[204:205], v[196:197]
    v_pk_mul_f32 v[206:207], v[206:207], v[198:199]
    v_pk_add_f32 v[34:35], v[34:35], 1.0 op_sel_hi:[1,0]
    v_pk_add_f32 v[36:37], v[36:37], 1.0 op_sel_hi:[1,0]
    v_pk_add_f32 v[38:39], v[38:39], 1.0 op_sel_hi:[1,0]
    v_pk_add_f32 v[40:41], v[40:41], 1.0 op_sel_hi:[1,0]
    v_rcp_f32 v34, v34
    v_rcp_f32 v35, v35
    v_rcp_f32 v36, v36
    v_rcp_f32 v37, v37
    v_rcp_f32 v38, v38
    v_rcp_f32 v39, v39
    v_rcp_f32 v40, v40
    v_rcp_f32 v41, v41
    v_pk_mul_f32 v[200:201], v[200:201], v[34:35]
    v_pk_mul_f32 v[202:203], v[202:203], v[36:37]
    v_pk_mul_f32 v[204:205], v[204:205], v[38:39]
    v_pk_mul_f32 v[206:207], v[206:207], v[40:41]
    v_cvt_pk_bf16_f32 v192, v200, v201
    v_cvt_pk_bf16_f32 v193, v202, v203
    v_cvt_pk_bf16_f32 v194, v204, v205
    v_cvt_pk_bf16_f32 v195, v206, v207
    s_add_u32 s88, s88, 4096
    buffer_store_dwordx4 v[192:195], v16, s[56:59], s88 offen offset:0 sc1
    v_pk_mul_f32 v[34:35], v[208:209], v[208:209]
    v_pk_mul_f32 v[36:37], v[210:211], v[210:211]
    v_pk_mul_f32 v[38:39], v[212:213], v[212:213]
    v_pk_mul_f32 v[40:41], v[214:215], v[214:215]
    v_pk_fma_f32 v[34:35], v[34:35], s[94:95], v[26:27]
    v_pk_fma_f32 v[36:37], v[36:37], s[94:95], v[26:27]
    v_pk_fma_f32 v[38:39], v[38:39], s[94:95], v[26:27]
    v_pk_fma_f32 v[40:41], v[40:41], s[94:95], v[26:27]
    v_pk_mul_f32 v[34:35], v[34:35], v[208:209]
    v_pk_mul_f32 v[36:37], v[36:37], v[210:211]
    v_pk_mul_f32 v[38:39], v[38:39], v[212:213]
    v_pk_mul_f32 v[40:41], v[40:41], v[214:215]
    v_exp_f32 v34, v34
    v_exp_f32 v35, v35
    v_exp_f32 v36, v36
    v_exp_f32 v37, v37
    v_exp_f32 v38, v38
    v_exp_f32 v39, v39
    v_exp_f32 v40, v40
    v_exp_f32 v41, v41
    v_pk_mul_f32 v[216:217], v[216:217], v[208:209]
    v_pk_mul_f32 v[218:219], v[218:219], v[210:211]
    v_pk_mul_f32 v[220:221], v[220:221], v[212:213]
    v_pk_mul_f32 v[222:223], v[222:223], v[214:215]
    v_pk_add_f32 v[34:35], v[34:35], 1.0 op_sel_hi:[1,0]
    v_pk_add_f32 v[36:37], v[36:37], 1.0 op_sel_hi:[1,0]
    v_pk_add_f32 v[38:39], v[38:39], 1.0 op_sel_hi:[1,0]
    v_pk_add_f32 v[40:41], v[40:41], 1.0 op_sel_hi:[1,0]
    v_rcp_f32 v34, v34
    v_rcp_f32 v35, v35
    v_rcp_f32 v36, v36
    v_rcp_f32 v37, v37
    v_rcp_f32 v38, v38
    v_rcp_f32 v39, v39
    v_rcp_f32 v40, v40
    v_rcp_f32 v41, v41
    v_pk_mul_f32 v[216:217], v[216:217], v[34:35]
    v_pk_mul_f32 v[218:219], v[218:219], v[36:37]
    v_pk_mul_f32 v[220:221], v[220:221], v[38:39]
    v_pk_mul_f32 v[222:223], v[222:223], v[40:41]
    v_cvt_pk_bf16_f32 v208, v216, v217
    v_cvt_pk_bf16_f32 v209, v218, v219
    v_cvt_pk_bf16_f32 v210, v220, v221
    v_cvt_pk_bf16_f32 v211, v222, v223
    buffer_store_dwordx4 v[208:211], v16, s[56:59], s88 offen offset:1024 sc1
    v_pk_mul_f32 v[34:35], v[224:225], v[224:225]
    v_pk_mul_f32 v[36:37], v[226:227], v[226:227]
    v_pk_mul_f32 v[38:39], v[228:229], v[228:229]
    v_pk_mul_f32 v[40:41], v[230:231], v[230:231]
    v_pk_fma_f32 v[34:35], v[34:35], s[94:95], v[26:27]
    v_pk_fma_f32 v[36:37], v[36:37], s[94:95], v[26:27]
    v_pk_fma_f32 v[38:39], v[38:39], s[94:95], v[26:27]
    v_pk_fma_f32 v[40:41], v[40:41], s[94:95], v[26:27]
    v_pk_mul_f32 v[34:35], v[34:35], v[224:225]
    v_pk_mul_f32 v[36:37], v[36:37], v[226:227]
    v_pk_mul_f32 v[38:39], v[38:39], v[228:229]
    v_pk_mul_f32 v[40:41], v[40:41], v[230:231]
    v_exp_f32 v34, v34
    v_exp_f32 v35, v35
    v_exp_f32 v36, v36
    v_exp_f32 v37, v37
    v_exp_f32 v38, v38
    v_exp_f32 v39, v39
    v_exp_f32 v40, v40
    v_exp_f32 v41, v41
    v_pk_mul_f32 v[232:233], v[232:233], v[224:225]
    v_pk_mul_f32 v[234:235], v[234:235], v[226:227]
    v_pk_mul_f32 v[236:237], v[236:237], v[228:229]
    v_pk_mul_f32 v[238:239], v[238:239], v[230:231]
    v_pk_add_f32 v[34:35], v[34:35], 1.0 op_sel_hi:[1,0]
    v_pk_add_f32 v[36:37], v[36:37], 1.0 op_sel_hi:[1,0]
    v_pk_add_f32 v[38:39], v[38:39], 1.0 op_sel_hi:[1,0]
    v_pk_add_f32 v[40:41], v[40:41], 1.0 op_sel_hi:[1,0]
    v_rcp_f32 v34, v34
    v_rcp_f32 v35, v35
    v_rcp_f32 v36, v36
    v_rcp_f32 v37, v37
    v_rcp_f32 v38, v38
    v_rcp_f32 v39, v39
    v_rcp_f32 v40, v40
    v_rcp_f32 v41, v41
    v_pk_mul_f32 v[232:233], v[232:233], v[34:35]
    v_pk_mul_f32 v[234:235], v[234:235], v[36:37]
    v_pk_mul_f32 v[236:237], v[236:237], v[38:39]
    v_pk_mul_f32 v[238:239], v[238:239], v[40:41]
    v_cvt_pk_bf16_f32 v224, v232, v233
    v_cvt_pk_bf16_f32 v225, v234, v235
    v_cvt_pk_bf16_f32 v226, v236, v237
    v_cvt_pk_bf16_f32 v227, v238, v239
    buffer_store_dwordx4 v[224:227], v16, s[56:59], s88 offen offset:2048 sc1
    v_pk_mul_f32 v[34:35], v[240:241], v[240:241]
    v_pk_mul_f32 v[36:37], v[242:243], v[242:243]
    v_pk_mul_f32 v[38:39], v[244:245], v[244:245]
    v_pk_mul_f32 v[40:41], v[246:247], v[246:247]
    v_pk_fma_f32 v[34:35], v[34:35], s[94:95], v[26:27]
    v_pk_fma_f32 v[36:37], v[36:37], s[94:95], v[26:27]
    v_pk_fma_f32 v[38:39], v[38:39], s[94:95], v[26:27]
    v_pk_fma_f32 v[40:41], v[40:41], s[94:95], v[26:27]
    v_pk_mul_f32 v[34:35], v[34:35], v[240:241]
    v_pk_mul_f32 v[36:37], v[36:37], v[242:243]
    v_pk_mul_f32 v[38:39], v[38:39], v[244:245]
    v_pk_mul_f32 v[40:41], v[40:41], v[246:247]
    v_exp_f32 v34, v34
    v_exp_f32 v35, v35
    v_exp_f32 v36, v36
    v_exp_f32 v37, v37
    v_exp_f32 v38, v38
    v_exp_f32 v39, v39
    v_exp_f32 v40, v40
    v_exp_f32 v41, v41
    v_pk_mul_f32 v[248:249], v[248:249], v[240:241]
    v_pk_mul_f32 v[250:251], v[250:251], v[242:243]
    v_pk_mul_f32 v[252:253], v[252:253], v[244:245]
    v_pk_mul_f32 v[254:255], v[254:255], v[246:247]
    v_pk_add_f32 v[34:35], v[34:35], 1.0 op_sel_hi:[1,0]
    v_pk_add_f32 v[36:37], v[36:37], 1.0 op_sel_hi:[1,0]
    v_pk_add_f32 v[38:39], v[38:39], 1.0 op_sel_hi:[1,0]
    v_pk_add_f32 v[40:41], v[40:41], 1.0 op_sel_hi:[1,0]
    v_rcp_f32 v34, v34
    v_rcp_f32 v35, v35
    v_rcp_f32 v36, v36
    v_rcp_f32 v37, v37
    v_rcp_f32 v38, v38
    v_rcp_f32 v39, v39
    v_rcp_f32 v40, v40
    v_rcp_f32 v41, v41
    v_pk_mul_f32 v[248:249], v[248:249], v[34:35]
    v_pk_mul_f32 v[250:251], v[250:251], v[36:37]
    v_pk_mul_f32 v[252:253], v[252:253], v[38:39]
    v_pk_mul_f32 v[254:255], v[254:255], v[40:41]
    v_cvt_pk_bf16_f32 v240, v248, v249
    v_cvt_pk_bf16_f32 v241, v250, v251
    v_cvt_pk_bf16_f32 v242, v252, v253
    v_cvt_pk_bf16_f32 v243, v254, v255
    buffer_store_dwordx4 v[240:243], v16, s[56:59], s88 offen offset:3072 sc1
    s_cmp_eq_u32 s62, 1
    s_cbranch_scc1 L_epi1
    v_mov_b32 v244, 0xce6e6b28
    v_cvt_pk_bf16_f32 v128, v120, v121
    v_cvt_pk_bf16_f32 v129, v122, v123
    v_cvt_pk_bf16_f32 v130, v124, v125
    v_cvt_pk_bf16_f32 v131, v126, v127
    v_accvgpr_read_b32 v34, a128
    v_accvgpr_read_b32 v35, a129
    v_accvgpr_read_b32 v36, a130
    v_accvgpr_read_b32 v37, a131
    v_accvgpr_read_b32 v38, a132
    v_accvgpr_read_b32 v39, a133
    v_accvgpr_read_b32 v40, a134
    v_accvgpr_read_b32 v41, a135
    v_cvt_pk_bf16_f32 v132, v34, v35
    s_mov_b32 s82, 65536
    s_add_u32 m0, s3, 65536
    s_nop 0
    buffer_load_dwordx4 v17, s[48:51], s82 offen lds
    buffer_load_dwordx4 v18, s[48:51], s82 offen offset:1024 lds
    v_cvt_pk_bf16_f32 v133, v36, v37
    v_cvt_pk_bf16_f32 v134, v38, v39
    v_cvt_pk_bf16_f32 v135, v40, v41
    v_accvgpr_read_b32 v246, a192
    v_accvgpr_read_b32 v247, a193
    v_accvgpr_read_b32 v248, a194
    v_accvgpr_read_b32 v249, a195
    v_accvgpr_read_b32 v250, a196
    v_accvgpr_read_b32 v251, a197
    v_accvgpr_read_b32 v252, a198
    v_accvgpr_read_b32 v253, a199
    v_cvt_pk_bf16_f32 v164, v246, v247
    v_cvt_pk_bf16_f32 v165, v248, v249
    v_cvt_pk_bf16_f32 v166, v250, v251
    v_cvt_pk_bf16_f32 v167, v252, v253
    v_accvgpr_read_b32 v34, a136
    v_accvgpr_read_b32 v35, a137
    v_accvgpr_read_b32 v36, a138
    v_accvgpr_read_b32 v37, a139
    v_accvgpr_read_b32 v38, a140
    v_accvgpr_read_b32 v39, a141
    v_accvgpr_read_b32 v40, a142
    s_mov_b32 s83, 294912
    s_add_u32 m0, s3, 73728
    s_nop 0
    buffer_load_dwordx4 v17, s[48:51], s83 offen lds
    buffer_load_dwordx4 v18, s[48:51], s83 offen offset:1024 lds
    v_accvgpr_read_b32 v41, a143
    v_cvt_pk_bf16_f32 v136, v34, v35
    v_cvt_pk_bf16_f32 v137, v36, v37
    v_cvt_pk_bf16_f32 v138, v38, v39
    v_cvt_pk_bf16_f32 v139, v40, v41
    v_accvgpr_read_b32 v246, a200
    v_accvgpr_read_b32 v247, a201
    v_accvgpr_read_b32 v248, a202
    v_accvgpr_read_b32 v249, a203
    v_accvgpr_read_b32 v250, a204
    v_accvgpr_read_b32 v251, a205
    v_accvgpr_read_b32 v252, a206
    v_accvgpr_read_b32 v253, a207
    v_cvt_pk_bf16_f32 v168, v246, v247
    v_cvt_pk_bf16_f32 v169, v248, v249
    v_cvt_pk_bf16_f32 v170, v250, v251
    v_cvt_pk_bf16_f32 v171, v252, v253
    v_accvgpr_read_b32 v34, a144
    v_accvgpr_read_b32 v35, a145
    v_accvgpr_read_b32 v36, a146
    v_accvgpr_read_b32 v37, a147
    v_accvgpr_read_b32 v38, a148
    s_mov_b32 s82, 524288
    s_add_u32 m0, s3, 81920
    s_nop 0
    buffer_load_dwordx4 v17, s[48:51], s82 offen lds
    buffer_load_dwordx4 v18, s[48:51], s82 offen offset:1024 lds
    v_accvgpr_read_b32 v39, a149
    v_accvgpr_read_b32 v40, a150
    v_accvgpr_read_b32 v41, a151
    v_cvt_pk_bf16_f32 v140, v34, v35
    v_cvt_pk_bf16_f32 v141, v36, v37
    v_cvt_pk_bf16_f32 v142, v38, v39
    v_cvt_pk_bf16_f32 v143, v40, v41
    v_accvgpr_read_b32 v246, a208
    v_accvgpr_read_b32 v247, a209
    v_accvgpr_read_b32 v248, a210
    v_accvgpr_read_b32 v249, a211
    v_accvgpr_read_b32 v250, a212
    v_accvgpr_read_b32 v251, a213
    v_accvgpr_read_b32 v252, a214
    v_accvgpr_read_b32 v253, a215
    v_cvt_pk_bf16_f32 v172, v246, v247
    v_cvt_pk_bf16_f32 v173, v248, v249
    v_cvt_pk_bf16_f32 v174, v250, v251
    v_cvt_pk_bf16_f32 v175, v252, v253
    v_accvgpr_read_b32 v34, a152
    v_accvgpr_read_b32 v35, a153
    v_accvgpr_read_b32 v36, a154
    s_mov_b32 s83, 753664
    s_add_u32 m0, s3, 90112
    s_nop 0
    buffer_load_dwordx4 v17, s[48:51], s83 offen lds
    buffer_load_dwordx4 v18, s[48:51], s83 offen offset:1024 lds
    v_accvgpr_read_b32 v37, a155
    v_accvgpr_read_b32 v38, a156
    v_accvgpr_read_b32 v39, a157
    v_accvgpr_read_b32 v40, a158
    v_accvgpr_read_b32 v41, a159
    v_cvt_pk_bf16_f32 v144, v34, v35
    v_cvt_pk_bf16_f32 v145, v36, v37
    v_cvt_pk_bf16_f32 v146, v38, v39
    v_cvt_pk_bf16_f32 v147, v40, v41
    v_accvgpr_read_b32 v246, a216
    v_accvgpr_read_b32 v247, a217
    v_accvgpr_read_b32 v248, a218
    v_accvgpr_read_b32 v249, a219
    v_accvgpr_read_b32 v250, a220
    v_accvgpr_read_b32 v251, a221
    v_accvgpr_read_b32 v252, a222
    v_accvgpr_read_b32 v253, a223
    v_cvt_pk_bf16_f32 v176, v246, v247
    v_cvt_pk_bf16_f32 v177, v248, v249
    v_cvt_pk_bf16_f32 v178, v250, v251
    v_cvt_pk_bf16_f32 v179, v252, v253
    v_mfma_f32_16x16x32_bf16 v[196:199], v[128:131], v[164:167], 0
    v_mfma_f32_16x16x32_bf16 v[200:203], v[132:135], v[164:167], 0
    v_mfma_f32_16x16x32_bf16 v[204:207], v[132:135], v[168:171], 0
    v_mfma_f32_16x16x32_bf16 v[208:211], v[136:139], v[168:171], 0
    v_mfma_f32_16x16x32_bf16 v[212:215], v[136:139], v[172:175], 0
    v_mfma_f32_16x16x32_bf16 v[216:219], v[140:143], v[172:175], 0
    v_mfma_f32_16x16x32_bf16 v[220:223], v[140:143], v[176:179], 0
    v_mfma_f32_16x16x32_bf16 v[224:227], v[144:147], v[176:179], 0
    s_waitcnt vmcnt(8)
    s_mov_b64 exec, 1
    buffer_atomic_add v25, off, s[56:59], s92 sc1
    s_mov_b64 exec, -1
    v_cvt_pk_bf16_f32 v48, v48, v49
    v_cvt_pk_bf16_f32 v49, v50, v51
    v_cvt_pk_bf16_f32 v84, v84, v85
    v_cvt_pk_bf16_f32 v85, v86, v87
    v_cvt_pk_bf16_f32 v50, v52, v53
    v_cvt_pk_bf16_f32 v51, v54, v55
    v_cvt_pk_bf16_f32 v86, v88, v89
    v_cvt_pk_bf16_f32 v87, v90, v91
    v_cvt_pk_bf16_f32 v52, v56, v57
    v_cvt_pk_bf16_f32 v53, v58, v59
    v_cvt_pk_bf16_f32 v88, v92, v93
    v_cvt_pk_bf16_f32 v89, v94, v95
    v_cvt_pk_bf16_f32 v54, v60, v61
    v_cvt_pk_bf16_f32 v55, v62, v63
    v_cvt_pk_bf16_f32 v90, v96, v97
    v_cvt_pk_bf16_f32 v91, v98, v99
    v_cvt_pk_bf16_f32 v56, v64, v65
    v_cvt_pk_bf16_f32 v57, v66, v67
    v_cvt_pk_bf16_f32 v92, v100, v101
    v_cvt_pk_bf16_f32 v93, v102, v103
    v_cvt_pk_bf16_f32 v58, v68, v69
    v_cvt_pk_bf16_f32 v59, v70, v71
    v_cvt_pk_bf16_f32 v94, v104, v105
    v_cvt_pk_bf16_f32 v95, v106, v107
    v_cvt_pk_bf16_f32 v60, v72, v73
    v_cvt_pk_bf16_f32 v61, v74, v75
    v_cvt_pk_bf16_f32 v96, v108, v109
    v_cvt_pk_bf16_f32 v97, v110, v111
    v_cvt_pk_bf16_f32 v62, v76, v77
    v_cvt_pk_bf16_f32 v63, v78, v79
    v_cvt_pk_bf16_f32 v98, v112, v113
    v_cvt_pk_bf16_f32 v99, v114, v115
    v_cvt_pk_bf16_f32 v64, v80, v81
    v_cvt_pk_bf16_f32 v65, v82, v83
    v_cvt_pk_bf16_f32 v100, v116, v117
    v_cvt_pk_bf16_f32 v101, v118, v119
    v_cvt_pk_bf16_f32 v196, v196, v197
    s_mov_b32 s82, 983040
    s_add_u32 m0, s3, 98304
    s_nop 0
    buffer_load_dwordx4 v17, s[48:51], s82 offen lds
    buffer_load_dwordx4 v18, s[48:51], s82 offen offset:1024 lds
    v_cvt_pk_bf16_f32 v198, v198, v199
    v_cvt_pk_bf16_f32 v200, v200, v201
    v_cvt_pk_bf16_f32 v202, v202, v203
    v_cvt_pk_bf16_f32 v204, v204, v205
    v_cvt_pk_bf16_f32 v206, v206, v207
    v_cvt_pk_bf16_f32 v208, v208, v209
    v_cvt_pk_bf16_f32 v210, v210, v211
    v_cvt_pk_bf16_f32 v212, v212, v213
    v_cvt_pk_bf16_f32 v214, v214, v215
    v_cvt_pk_bf16_f32 v216, v216, v217
    v_cvt_pk_bf16_f32 v218, v218, v219
    v_cvt_pk_bf16_f32 v220, v220, v221
    v_cvt_pk_bf16_f32 v222, v222, v223
    v_cvt_pk_bf16_f32 v224, v224, v225
    v_cvt_pk_bf16_f32 v226, v226, v227
    v_perm_b32 v228, v200, v196, v28
    v_perm_b32 v229, v202, v198, v29
    v_perm_b32 v230, v208, v204, v28
    v_perm_b32 v231, v210, v206, v29
    v_perm_b32 v232, v216, v212, v28
    v_perm_b32 v233, v218, v214, v29
    v_perm_b32 v234, v224, v220, v28
    v_perm_b32 v235, v226, v222, v29
    v_pk_mul_f32 v[228:229], v[228:229], s[14:15]
    v_pk_mul_f32 v[230:231], v[230:231], s[14:15]
    v_pk_mul_f32 v[232:233], v[232:233], s[14:15]
    v_pk_mul_f32 v[234:235], v[234:235], s[14:15]
    v_cvt_pk_bf16_f32 v229, v228, v229
    s_mov_b32 s83, 1212416
    s_add_u32 m0, s3, 106496
    s_nop 0
    buffer_load_dwordx4 v17, s[48:51], s83 offen lds
    buffer_load_dwordx4 v18, s[48:51], s83 offen offset:1024 lds
    v_cvt_pk_bf16_f32 v231, v230, v231
    v_cvt_pk_bf16_f32 v233, v232, v233
    v_cvt_pk_bf16_f32 v235, v234, v235
    v_lshlrev_b32 v228, 16, v229
    v_and_b32 v229, 0xffff0000, v229
    v_lshlrev_b32 v230, 16, v231
    v_and_b32 v231, 0xffff0000, v231
    v_lshlrev_b32 v232, 16, v233
    v_and_b32 v233, 0xffff0000, v233
    v_lshlrev_b32 v234, 16, v235
    v_and_b32 v235, 0xffff0000, v235
    v_cndmask_b32 v228, v244, v228, s[4:5]
    v_cndmask_b32 v229, v244, v229, s[6:7]
    v_max_f32 v236, v228, v229
    v_max_f32 v238, v230, v231
    v_max_f32 v240, v232, v233
    v_max_f32 v242, v234, v235
    v_permlane16_swap_b32 v236, v238
    s_nop 0
    v_permlane16_swap_b32 v240, v242
    v_max_f32 v236, v236, v238
    v_max_f32 v240, v240, v242
    s_nop 1
    v_permlane32_swap_b32 v236, v240
    v_max_f32 v236, v236, v240
    v_mul_f32 v236, 0xbfb8aa3b, v236
    v_mov_b32 v240, v236
    s_nop 1
    v_permlane32_swap_b32 v236, v240
    v_mov_b32 v238, v236
    v_mov_b32 v242, v240
    s_mov_b32 s82, 1441792
    s_add_u32 m0, s3, 114688
    s_nop 0
    buffer_load_dwordx4 v17, s[48:51], s82 offen lds
    buffer_load_dwordx4 v18, s[48:51], s82 offen offset:1024 lds
    v_permlane16_swap_b32 v236, v238
    v_permlane16_swap_b32 v240, v242
    v_pk_fma_f32 v[228:229], v[228:229], s[98:99], v[236:237] op_sel_hi:[1,1,0]
    v_pk_fma_f32 v[230:231], v[230:231], s[98:99], v[238:239] op_sel_hi:[1,1,0]
    v_pk_fma_f32 v[232:233], v[232:233], s[98:99], v[240:241] op_sel_hi:[1,1,0]
    v_pk_fma_f32 v[234:235], v[234:235], s[98:99], v[242:243] op_sel_hi:[1,1,0]
    v_exp_f32 v228, v228
    v_exp_f32 v229, v229
    v_exp_f32 v230, v230
    v_exp_f32 v231, v231
    v_exp_f32 v232, v232
    v_exp_f32 v233, v233
    v_exp_f32 v234, v234
    v_exp_f32 v235, v235
    v_add_f32 v236, v228, v229
    v_add_f32 v238, v230, v231
    v_add_f32 v240, v232, v233
    v_add_f32 v242, v234, v235
    v_permlane16_swap_b32 v236, v238
    s_nop 0
    v_permlane16_swap_b32 v240, v242
    v_add_f32 v236, v236, v238
    v_add_f32 v240, v240, v242
    s_nop 1
    v_permlane32_swap_b32 v236, v240
    v_add_f32 v236, v236, v240
    v_rcp_f32 v236, v236
    s_nop 0
    v_mov_b32 v240, v236
    s_nop 1
    v_permlane32_swap_b32 v236, v240
    v_mov_b32 v238, v236
    s_mov_b32 s83, 1671168
    s_add_u32 m0, s3, 122880
    s_nop 0
    buffer_load_dwordx4 v17, s[48:51], s83 offen lds
    buffer_load_dwordx4 v18, s[48:51], s83 offen offset:1024 lds
    v_mov_b32 v242, v240
    v_permlane16_swap_b32 v236, v238
    s_nop 0
    v_permlane16_swap_b32 v240, v242
    v_pk_mul_f32 v[228:229], v[228:229], v[236:237] op_sel_hi:[1,0]
    v_pk_mul_f32 v[230:231], v[230:231], v[238:239] op_sel_hi:[1,0]
    v_pk_mul_f32 v[232:233], v[232:233], v[240:241] op_sel_hi:[1,0]
    v_pk_mul_f32 v[234:235], v[234:235], v[242:243] op_sel_hi:[1,0]
    v_cvt_pk_bf16_f32 v228, v228, v229
    v_cvt_pk_bf16_f32 v230, v230, v231
    v_cvt_pk_bf16_f32 v232, v232, v233
    v_cvt_pk_bf16_f32 v234, v234, v235
    v_perm_b32 v164, v228, v228, v30
    v_perm_b32 v165, v228, v228, v31
    v_perm_b32 v166, v228, v228, v32
    v_perm_b32 v167, v228, v228, v33
    v_perm_b32 v168, v230, v230, v30
    v_perm_b32 v169, v230, v230, v31
    v_perm_b32 v170, v230, v230, v32
    v_perm_b32 v171, v230, v230, v33
    v_perm_b32 v172, v232, v232, v30
    v_perm_b32 v173, v232, v232, v31
    v_perm_b32 v174, v232, v232, v32
    v_perm_b32 v175, v232, v232, v33
    v_perm_b32 v176, v234, v234, v30
    v_perm_b32 v177, v234, v234, v31
    v_perm_b32 v178, v234, v234, v32
    v_perm_b32 v179, v234, v234, v33
    v_mfma_f32_16x16x32_bf16 v[196:199], v[48:51], v[164:167], 0
    v_mfma_f32_16x16x32_bf16 v[200:203], v[84:87], v[164:167], 0
    v_mfma_f32_16x16x32_bf16 v[204:207], v[50:53], v[168:171], 0
    v_mfma_f32_16x16x32_bf16 v[208:211], v[86:89], v[168:171], 0
    v_mfma_f32_16x16x32_bf16 v[212:215], v[52:55], v[172:175], 0
    v_mfma_f32_16x16x32_bf16 v[216:219], v[88:91], v[172:175], 0
    v_mfma_f32_16x16x32_bf16 v[220:223], v[54:57], v[176:179], 0
    v_mfma_f32_16x16x32_bf16 v[224:227], v[90:93], v[176:179], 0
    v_accvgpr_read_b32 v34, a160
    s_mov_b32 s82, 131072
    s_add_u32 m0, s3, 131072
    s_nop 0
    buffer_load_dwordx4 v17, s[48:51], s82 offen lds
    buffer_load_dwordx4 v18, s[48:51], s82 offen offset:1024 lds
    v_accvgpr_read_b32 v35, a161
    v_accvgpr_read_b32 v36, a162
    v_accvgpr_read_b32 v37, a163
    v_accvgpr_read_b32 v38, a164
    v_accvgpr_read_b32 v39, a165
    v_accvgpr_read_b32 v40, a166
    v_accvgpr_read_b32 v41, a167
    v_cvt_pk_bf16_f32 v148, v34, v35
    v_cvt_pk_bf16_f32 v149, v36, v37
    v_cvt_pk_bf16_f32 v150, v38, v39
    v_cvt_pk_bf16_f32 v151, v40, v41
    v_accvgpr_read_b32 v246, a224
    v_accvgpr_read_b32 v247, a225
    v_accvgpr_read_b32 v248, a226
    v_accvgpr_read_b32 v249, a227
    v_accvgpr_read_b32 v250, a228
    v_accvgpr_read_b32 v251, a229
    v_accvgpr_read_b32 v252, a230
    v_accvgpr_read_b32 v253, a231
    v_cvt_pk_bf16_f32 v180, v246, v247
    v_cvt_pk_bf16_f32 v181, v248, v249
    v_cvt_pk_bf16_f32 v182, v250, v251
    v_cvt_pk_bf16_f32 v183, v252, v253
    v_accvgpr_read_b32 v34, a168
    s_mov_b32 s83, 360448
    s_add_u32 m0, s3, 139264
    s_nop 0
    buffer_load_dwordx4 v17, s[48:51], s83 offen lds
    buffer_load_dwordx4 v18, s[48:51], s83 offen offset:1024 lds
    v_accvgpr_read_b32 v35, a169
    v_accvgpr_read_b32 v36, a170
    v_accvgpr_read_b32 v37, a171
    v_accvgpr_read_b32 v38, a172
    v_accvgpr_read_b32 v39, a173
    v_accvgpr_read_b32 v40, a174
    v_accvgpr_read_b32 v41, a175
    v_cvt_pk_bf16_f32 v152, v34, v35
    v_cvt_pk_bf16_f32 v153, v36, v37
    v_cvt_pk_bf16_f32 v154, v38, v39
    v_cvt_pk_bf16_f32 v155, v40, v41
    v_accvgpr_read_b32 v246, a232
    v_accvgpr_read_b32 v247, a233
    v_accvgpr_read_b32 v248, a234
    v_accvgpr_read_b32 v249, a235
    v_accvgpr_read_b32 v250, a236
    v_accvgpr_read_b32 v251, a237
    v_accvgpr_read_b32 v252, a238
    v_accvgpr_read_b32 v253, a239
    v_cvt_pk_bf16_f32 v184, v246, v247
    v_cvt_pk_bf16_f32 v185, v248, v249
    v_cvt_pk_bf16_f32 v186, v250, v251
    v_cvt_pk_bf16_f32 v187, v252, v253
    v_accvgpr_read_b32 v34, a176
    s_mov_b32 s82, 589824
    s_add_u32 m0, s3, 147456
    s_nop 0
    buffer_load_dwordx4 v17, s[48:51], s82 offen lds
    buffer_load_dwordx4 v18, s[48:51], s82 offen offset:1024 lds
    v_accvgpr_read_b32 v35, a177
    v_accvgpr_read_b32 v36, a178
    v_accvgpr_read_b32 v37, a179
    v_accvgpr_read_b32 v38, a180
    v_accvgpr_read_b32 v39, a181
    v_accvgpr_read_b32 v40, a182
    v_accvgpr_read_b32 v41, a183
    v_cvt_pk_bf16_f32 v156, v34, v35
    v_cvt_pk_bf16_f32 v157, v36, v37
    v_cvt_pk_bf16_f32 v158, v38, v39
    v_cvt_pk_bf16_f32 v159, v40, v41
    v_accvgpr_read_b32 v246, a240
    v_accvgpr_read_b32 v247, a241
    v_accvgpr_read_b32 v248, a242
    v_accvgpr_read_b32 v249, a243
    v_accvgpr_read_b32 v250, a244
    v_accvgpr_read_b32 v251, a245
    v_accvgpr_read_b32 v252, a246
    v_accvgpr_read_b32 v253, a247
    v_cvt_pk_bf16_f32 v188, v246, v247
    v_cvt_pk_bf16_f32 v189, v248, v249
    v_cvt_pk_bf16_f32 v190, v250, v251
    v_cvt_pk_bf16_f32 v191, v252, v253
    v_accvgpr_read_b32 v34, a184
    s_mov_b32 s83, 819200
    s_add_u32 m0, s3, 155648
    s_nop 0
    buffer_load_dwordx4 v17, s[48:51], s83 offen lds
    buffer_load_dwordx4 v18, s[48:51], s83 offen offset:1024 lds
    v_accvgpr_read_b32 v35, a185
    v_accvgpr_read_b32 v36, a186
    v_accvgpr_read_b32 v37, a187
    v_accvgpr_read_b32 v38, a188
    v_accvgpr_read_b32 v39, a189
    v_accvgpr_read_b32 v40, a190
    v_accvgpr_read_b32 v41, a191
    v_cvt_pk_bf16_f32 v160, v34, v35
    v_cvt_pk_bf16_f32 v161, v36, v37
    v_cvt_pk_bf16_f32 v162, v38, v39
    v_cvt_pk_bf16_f32 v163, v40, v41
    v_accvgpr_read_b32 v246, a248
    v_accvgpr_read_b32 v247, a249
    v_accvgpr_read_b32 v248, a250
    v_accvgpr_read_b32 v249, a251
    v_accvgpr_read_b32 v250, a252
    v_accvgpr_read_b32 v251, a253
    v_accvgpr_read_b32 v252, a254
    v_accvgpr_read_b32 v253, a255
    v_cvt_pk_bf16_f32 v192, v246, v247
    v_cvt_pk_bf16_f32 v193, v248, v249
    v_cvt_pk_bf16_f32 v194, v250, v251
    v_cvt_pk_bf16_f32 v195, v252, v253
    v_cvt_pk_bf16_f32 v196, v196, v197
    v_cvt_pk_bf16_f32 v197, v198, v199
    v_cvt_pk_bf16_f32 v198, v200, v201
    v_cvt_pk_bf16_f32 v199, v202, v203
    buffer_store_dwordx4 v[196:199], v16, s[56:59], s91 offen offset:0 sc1
    s_add_u32 s91, s91, 32768
    v_cvt_pk_bf16_f32 v204, v204, v205
    v_cvt_pk_bf16_f32 v205, v206, v207
    v_cvt_pk_bf16_f32 v206, v208, v209
    v_cvt_pk_bf16_f32 v207, v210, v211
    buffer_store_dwordx4 v[204:207], v16, s[56:59], s91 offen offset:0 sc1
    s_add_u32 s91, s91, 32768
    v_cvt_pk_bf16_f32 v212, v212, v213
    v_cvt_pk_bf16_f32 v213, v214, v215
    v_cvt_pk_bf16_f32 v214, v216, v217
    v_cvt_pk_bf16_f32 v215, v218, v219
    buffer_store_dwordx4 v[212:215], v16, s[56:59], s91 offen offset:0 sc1
    s_add_u32 s91, s91, 32768
    v_cvt_pk_bf16_f32 v220, v220, v221
    v_cvt_pk_bf16_f32 v221, v222, v223
    v_cvt_pk_bf16_f32 v222, v224, v225
    v_cvt_pk_bf16_f32 v223, v226, v227
    buffer_store_dwordx4 v[220:223], v16, s[56:59], s91 offen offset:0 sc1
    s_add_u32 s91, s91, 32768
    v_mfma_f32_16x16x32_bf16 v[196:199], v[144:147], v[180:183], 0
    v_mfma_f32_16x16x32_bf16 v[200:203], v[148:151], v[180:183], 0
    v_mfma_f32_16x16x32_bf16 v[204:207], v[148:151], v[184:187], 0
    v_mfma_f32_16x16x32_bf16 v[208:211], v[152:155], v[184:187], 0
    v_mfma_f32_16x16x32_bf16 v[212:215], v[152:155], v[188:191], 0
    v_mfma_f32_16x16x32_bf16 v[216:219], v[156:159], v[188:191], 0
    v_mfma_f32_16x16x32_bf16 v[220:223], v[156:159], v[192:195], 0
    v_mfma_f32_16x16x32_bf16 v[224:227], v[160:163], v[192:195], 0
    s_nop 0
    v_cvt_pk_bf16_f32 v196, v196, v197
    v_cvt_pk_bf16_f32 v198, v198, v199
    v_cvt_pk_bf16_f32 v200, v200, v201
    v_cvt_pk_bf16_f32 v202, v202, v203
    v_cvt_pk_bf16_f32 v204, v204, v205
    v_cvt_pk_bf16_f32 v206, v206, v207
    v_cvt_pk_bf16_f32 v208, v208, v209
    v_cvt_pk_bf16_f32 v210, v210, v211
    v_cvt_pk_bf16_f32 v212, v212, v213
    v_cvt_pk_bf16_f32 v214, v214, v215
    v_cvt_pk_bf16_f32 v216, v216, v217
    v_cvt_pk_bf16_f32 v218, v218, v219
    v_cvt_pk_bf16_f32 v220, v220, v221
    v_cvt_pk_bf16_f32 v222, v222, v223
    v_cvt_pk_bf16_f32 v224, v224, v225
    v_cvt_pk_bf16_f32 v226, v226, v227
    v_perm_b32 v228, v200, v196, v28
    v_perm_b32 v229, v202, v198, v29
    v_perm_b32 v230, v208, v204, v28
    v_perm_b32 v231, v210, v206, v29
    v_perm_b32 v232, v216, v212, v28
    v_perm_b32 v233, v218, v214, v29
    v_perm_b32 v234, v224, v220, v28
    v_perm_b32 v235, v226, v222, v29
    v_pk_mul_f32 v[228:229], v[228:229], s[14:15]
    v_pk_mul_f32 v[230:231], v[230:231], s[14:15]
    v_pk_mul_f32 v[232:233], v[232:233], s[14:15]
    v_pk_mul_f32 v[234:235], v[234:235], s[14:15]
    v_cvt_pk_bf16_f32 v229, v228, v229
    v_cvt_pk_bf16_f32 v231, v230, v231
    v_cvt_pk_bf16_f32 v233, v232, v233
    v_cvt_pk_bf16_f32 v235, v234, v235
    v_lshlrev_b32 v228, 16, v229
    v_and_b32 v229, 0xffff0000, v229
    v_lshlrev_b32 v230, 16, v231
    v_and_b32 v231, 0xffff0000, v231
    v_lshlrev_b32 v232, 16, v233
    v_and_b32 v233, 0xffff0000, v233
    v_lshlrev_b32 v234, 16, v235
    v_and_b32 v235, 0xffff0000, v235
    v_max_f32 v236, v228, v229
    v_max_f32 v238, v230, v231
    v_max_f32 v240, v232, v233
    v_max_f32 v242, v234, v235
    v_permlane16_swap_b32 v236, v238
    s_nop 0
    v_permlane16_swap_b32 v240, v242
    v_max_f32 v236, v236, v238
    v_max_f32 v240, v240, v242
    s_nop 1
    v_permlane32_swap_b32 v236, v240
    v_max_f32 v236, v236, v240
    v_mul_f32 v236, 0xbfb8aa3b, v236
    v_mov_b32 v240, v236
    s_nop 1
    v_permlane32_swap_b32 v236, v240
    v_mov_b32 v238, v236
    v_mov_b32 v242, v240
    s_nop 0
    v_permlane16_swap_b32 v236, v238
    v_permlane16_swap_b32 v240, v242
    v_pk_fma_f32 v[228:229], v[228:229], s[98:99], v[236:237] op_sel_hi:[1,1,0]
    v_pk_fma_f32 v[230:231], v[230:231], s[98:99], v[238:239] op_sel_hi:[1,1,0]
    v_pk_fma_f32 v[232:233], v[232:233], s[98:99], v[240:241] op_sel_hi:[1,1,0]
    v_pk_fma_f32 v[234:235], v[234:235], s[98:99], v[242:243] op_sel_hi:[1,1,0]
    v_exp_f32 v228, v228
    v_exp_f32 v229, v229
    v_exp_f32 v230, v230
    v_exp_f32 v231, v231
    v_exp_f32 v232, v232
    v_exp_f32 v233, v233
    v_exp_f32 v234, v234
    v_exp_f32 v235, v235
    v_add_f32 v236, v228, v229
    v_add_f32 v238, v230, v231
    v_add_f32 v240, v232, v233
    v_add_f32 v242, v234, v235
    v_permlane16_swap_b32 v236, v238
    s_nop 0
    v_permlane16_swap_b32 v240, v242
    v_add_f32 v236, v236, v238
    v_add_f32 v240, v240, v242
    s_nop 1
    v_permlane32_swap_b32 v236, v240
    v_add_f32 v236, v236, v240
    v_rcp_f32 v236, v236
    s_nop 0
    v_mov_b32 v240, v236
    s_nop 1
    v_permlane32_swap_b32 v236, v240
    v_mov_b32 v238, v236
    v_mov_b32 v242, v240
    s_nop 0
    v_permlane16_swap_b32 v236, v238
    v_permlane16_swap_b32 v240, v242
    v_pk_mul_f32 v[228:229], v[228:229], v[236:237] op_sel_hi:[1,0]
    v_pk_mul_f32 v[230:231], v[230:231], v[238:239] op_sel_hi:[1,0]
    v_pk_mul_f32 v[232:233], v[232:233], v[240:241] op_sel_hi:[1,0]
    v_pk_mul_f32 v[234:235], v[234:235], v[242:243] op_sel_hi:[1,0]
    v_cvt_pk_bf16_f32 v228, v228, v229
    v_cvt_pk_bf16_f32 v230, v230, v231
    v_cvt_pk_bf16_f32 v232, v232, v233
    v_cvt_pk_bf16_f32 v234, v234, v235
    v_perm_b32 v180, v228, v228, v30
    v_perm_b32 v181, v228, v228, v31
    v_perm_b32 v182, v228, v228, v32
    v_perm_b32 v183, v228, v228, v33
    v_perm_b32 v184, v230, v230, v30
    v_perm_b32 v185, v230, v230, v31
    v_perm_b32 v186, v230, v230, v32
    v_perm_b32 v187, v230, v230, v33
    v_perm_b32 v188, v232, v232, v30
    v_perm_b32 v189, v232, v232, v31
    v_perm_b32 v190, v232, v232, v32
    v_perm_b32 v191, v232, v232, v33
    v_perm_b32 v192, v234, v234, v30
    v_perm_b32 v193, v234, v234, v31
    v_perm_b32 v194, v234, v234, v32
    v_perm_b32 v195, v234, v234, v33
    v_mfma_f32_16x16x32_bf16 v[196:199], v[56:59], v[180:183], 0
    v_mfma_f32_16x16x32_bf16 v[200:203], v[92:95], v[180:183], 0
    v_mfma_f32_16x16x32_bf16 v[204:207], v[58:61], v[184:187], 0
    v_mfma_f32_16x16x32_bf16 v[208:211], v[94:97], v[184:187], 0
    v_mfma_f32_16x16x32_bf16 v[212:215], v[60:63], v[188:191], 0
    v_mfma_f32_16x16x32_bf16 v[216:219], v[96:99], v[188:191], 0
    v_mfma_f32_16x16x32_bf16 v[220:223], v[62:65], v[192:195], 0
    v_mfma_f32_16x16x32_bf16 v[224:227], v[98:101], v[192:195], 0
    s_nop 0
    v_cvt_pk_bf16_f32 v196, v196, v197
    v_cvt_pk_bf16_f32 v197, v198, v199
    v_cvt_pk_bf16_f32 v198, v200, v201
    v_cvt_pk_bf16_f32 v199, v202, v203
    buffer_store_dwordx4 v[196:199], v16, s[56:59], s91 offen offset:0 sc1
    s_add_u32 s91, s91, 32768
    v_cvt_pk_bf16_f32 v204, v204, v205
    v_cvt_pk_bf16_f32 v205, v206, v207
    v_cvt_pk_bf16_f32 v206, v208, v209
    v_cvt_pk_bf16_f32 v207, v210, v211
    buffer_store_dwordx4 v[204:207], v16, s[56:59], s91 offen offset:0 sc1
    s_add_u32 s91, s91, 32768
    v_cvt_pk_bf16_f32 v212, v212, v213
    v_cvt_pk_bf16_f32 v213, v214, v215
    v_cvt_pk_bf16_f32 v214, v216, v217
    v_cvt_pk_bf16_f32 v215, v218, v219
    buffer_store_dwordx4 v[212:215], v16, s[56:59], s91 offen offset:0 sc1
    s_add_u32 s91, s91, 32768
    v_cvt_pk_bf16_f32 v220, v220, v221
    v_cvt_pk_bf16_f32 v221, v222, v223
    v_cvt_pk_bf16_f32 v222, v224, v225
    v_cvt_pk_bf16_f32 v223, v226, v227
    buffer_store_dwordx4 v[220:223], v16, s[56:59], s91 offen offset:0 sc1
    s_add_u32 s91, s91, 32768
    s_mov_b32 s67, 0
L_spA:
    buffer_load_dword v43, off, s[56:59], s92 sc1
    s_waitcnt vmcnt(0)
    v_readfirstlane_b32 s86, v43
    s_bfe_u32 s86, s86, 0x80000
    s_cmp_eq_u32 s86, 32
    s_cbranch_scc1 L_okA
    s_add_u32 s67, s67, 1
    s_cmp_lt_u32 s67, 0x40000
    s_cbranch_scc1 L_spA
L_okA:
    buffer_load_dwordx4 a[0:3], v21, s[56:59], s68 offen sc1
    buffer_load_dwordx4 a[4:7], v22, s[56:59], s68 offen sc1
    buffer_load_dwordx4 a[8:11], v23, s[56:59], s68 offen sc1
    buffer_load_dwordx4 a[12:15], v24, s[56:59], s68 offen sc1
    s_add_u32 s68, s68, 16384
    buffer_load_dwordx4 a[16:19], v21, s[56:59], s68 offen sc1
    buffer_load_dwordx4 a[20:23], v22, s[56:59], s68 offen sc1
    buffer_load_dwordx4 a[24:27], v23, s[56:59], s68 offen sc1
    buffer_load_dwordx4 a[28:31], v24, s[56:59], s68 offen sc1
    s_add_u32 s68, s68, 16384
    buffer_load_dwordx4 a[32:35], v21, s[56:59], s68 offen sc1
    buffer_load_dwordx4 a[36:39], v22, s[56:59], s68 offen sc1
    buffer_load_dwordx4 a[40:43], v23, s[56:59], s68 offen sc1
    buffer_load_dwordx4 a[44:47], v24, s[56:59], s68 offen sc1
    s_add_u32 s68, s68, 16384
    buffer_load_dwordx4 a[48:51], v21, s[56:59], s68 offen sc1
    buffer_load_dwordx4 a[52:55], v22, s[56:59], s68 offen sc1
    buffer_load_dwordx4 a[56:59], v23, s[56:59], s68 offen sc1
    buffer_load_dwordx4 a[60:63], v24, s[56:59], s68 offen sc1
    s_add_u32 s68, s68, 16384
    buffer_load_dwordx4 a[64:67], v21, s[56:59], s68 offen sc1
    buffer_load_dwordx4 a[68:71], v22, s[56:59], s68 offen sc1
    buffer_load_dwordx4 a[72:75], v23, s[56:59], s68 offen sc1
    buffer_load_dwordx4 a[76:79], v24, s[56:59], s68 offen sc1
    s_add_u32 s68, s68, 16384
    buffer_load_dwordx4 a[80:83], v21, s[56:59], s68 offen sc1
    buffer_load_dwordx4 a[84:87], v22, s[56:59], s68 offen sc1
    buffer_load_dwordx4 a[88:91], v23, s[56:59], s68 offen sc1
    buffer_load_dwordx4 a[92:95], v24, s[56:59], s68 offen sc1
    s_add_u32 s68, s68, 16384
    buffer_load_dwordx4 a[96:99], v21, s[56:59], s68 offen sc1
    buffer_load_dwordx4 a[100:103], v22, s[56:59], s68 offen sc1
    buffer_load_dwordx4 a[104:107], v23, s[56:59], s68 offen sc1
    buffer_load_dwordx4 a[108:111], v24, s[56:59], s68 offen sc1
    s_add_u32 s68, s68, 16384
    buffer_load_dwordx4 a[112:115], v21, s[56:59], s68 offen sc1
    buffer_load_dwordx4 a[116:119], v22, s[56:59], s68 offen sc1
    buffer_load_dwordx4 a[120:123], v23, s[56:59], s68 offen sc1
    buffer_load_dwordx4 a[124:127], v24, s[56:59], s68 offen sc1
    s_add_u32 s68, s68, 16384
    s_barrier
    s_branch L_D
L_epi1:
    v_accvgpr_read_b32 v128, a128
    v_accvgpr_read_b32 v129, a129
    v_accvgpr_read_b32 v130, a130
    v_accvgpr_read_b32 v131, a131
    v_accvgpr_read_b32 v132, a132
    s_mov_b32 s82, 65536
    s_add_u32 m0, s3, 65536
    s_nop 0
    buffer_load_dwordx4 v17, s[48:51], s82 offen lds
    buffer_load_dwordx4 v18, s[48:51], s82 offen offset:1024 lds
    v_accvgpr_read_b32 v133, a133
    v_accvgpr_read_b32 v134, a134
    v_accvgpr_read_b32 v135, a135
    v_accvgpr_read_b32 v136, a136
    v_accvgpr_read_b32 v137, a137
    v_accvgpr_read_b32 v138, a138
    v_accvgpr_read_b32 v139, a139
    v_accvgpr_read_b32 v140, a140
    v_accvgpr_read_b32 v141, a141
    v_accvgpr_read_b32 v142, a142
    v_accvgpr_read_b32 v143, a143
    v_pk_mul_f32 v[34:35], v[128:129], v[128:129]
    v_pk_mul_f32 v[36:37], v[130:131], v[130:131]
    v_pk_mul_f32 v[38:39], v[132:133], v[132:133]
    v_pk_mul_f32 v[40:41], v[134:135], v[134:135]
    v_pk_fma_f32 v[34:35], v[34:35], s[94:95], v[26:27]
    v_pk_fma_f32 v[36:37], v[36:37], s[94:95], v[26:27]
    v_pk_fma_f32 v[38:39], v[38:39], s[94:95], v[26:27]
    v_pk_fma_f32 v[40:41], v[40:41], s[94:95], v[26:27]
    v_pk_mul_f32 v[34:35], v[34:35], v[128:129]
    v_pk_mul_f32 v[36:37], v[36:37], v[130:131]
    v_pk_mul_f32 v[38:39], v[38:39], v[132:133]
    v_pk_mul_f32 v[40:41], v[40:41], v[134:135]
    v_exp_f32 v34, v34
    v_exp_f32 v35, v35
    v_exp_f32 v36, v36
    v_exp_f32 v37, v37
    v_exp_f32 v38, v38
    s_mov_b32 s83, 294912
    s_add_u32 m0, s3, 73728
    s_nop 0
    buffer_load_dwordx4 v17, s[48:51], s83 offen lds
    buffer_load_dwordx4 v18, s[48:51], s83 offen offset:1024 lds
    v_exp_f32 v39, v39
    v_exp_f32 v40, v40
    v_exp_f32 v41, v41
    v_pk_mul_f32 v[136:137], v[136:137], v[128:129]
    v_pk_mul_f32 v[138:139], v[138:139], v[130:131]
    v_pk_mul_f32 v[140:141], v[140:141], v[132:133]
    v_pk_mul_f32 v[142:143], v[142:143], v[134:135]
    v_pk_add_f32 v[34:35], v[34:35], 1.0 op_sel_hi:[1,0]
    v_pk_add_f32 v[36:37], v[36:37], 1.0 op_sel_hi:[1,0]
    v_pk_add_f32 v[38:39], v[38:39], 1.0 op_sel_hi:[1,0]
    v_pk_add_f32 v[40:41], v[40:41], 1.0 op_sel_hi:[1,0]
    v_rcp_f32 v34, v34
    v_rcp_f32 v35, v35
    v_rcp_f32 v36, v36
    v_rcp_f32 v37, v37
    v_rcp_f32 v38, v38
    v_rcp_f32 v39, v39
    v_rcp_f32 v40, v40
    v_rcp_f32 v41, v41
    v_pk_mul_f32 v[136:137], v[136:137], v[34:35]
    v_pk_mul_f32 v[138:139], v[138:139], v[36:37]
    v_pk_mul_f32 v[140:141], v[140:141], v[38:39]
    v_pk_mul_f32 v[142:143], v[142:143], v[40:41]
    v_cvt_pk_bf16_f32 v128, v136, v137
    v_cvt_pk_bf16_f32 v129, v138, v139
    v_cvt_pk_bf16_f32 v130, v140, v141
    v_cvt_pk_bf16_f32 v131, v142, v143
    buffer_store_dwordx4 v[128:131], v16, s[56:59], s89 offen offset:0 sc1
    s_waitcnt vmcnt(5)
    s_mov_b64 exec, 1
    buffer_atomic_add v25, off, s[56:59], s92 sc1
    s_mov_b64 exec, -1
    v_accvgpr_read_b32 v144, a144
    v_accvgpr_read_b32 v145, a145
    v_accvgpr_read_b32 v146, a146
    v_accvgpr_read_b32 v147, a147
    v_accvgpr_read_b32 v148, a148
    s_mov_b32 s82, 524288
    s_add_u32 m0, s3, 81920
    s_nop 0
    buffer_load_dwordx4 v17, s[48:51], s82 offen lds
    buffer_load_dwordx4 v18, s[48:51], s82 offen offset:1024 lds
    v_accvgpr_read_b32 v149, a149
    v_accvgpr_read_b32 v150, a150
    v_accvgpr_read_b32 v151, a151
    v_accvgpr_read_b32 v152, a152
    v_accvgpr_read_b32 v153, a153
    v_accvgpr_read_b32 v154, a154
    v_accvgpr_read_b32 v155, a155
    v_accvgpr_read_b32 v156, a156
    v_accvgpr_read_b32 v157, a157
    v_accvgpr_read_b32 v158, a158
    v_accvgpr_read_b32 v159, a159
    v_pk_mul_f32 v[34:35], v[144:145], v[144:145]
    v_pk_mul_f32 v[36:37], v[146:147], v[146:147]
    v_pk_mul_f32 v[38:39], v[148:149], v[148:149]
    v_pk_mul_f32 v[40:41], v[150:151], v[150:151]
    v_pk_fma_f32 v[34:35], v[34:35], s[94:95], v[26:27]
    v_pk_fma_f32 v[36:37], v[36:37], s[94:95], v[26:27]
    v_pk_fma_f32 v[38:39], v[38:39], s[94:95], v[26:27]
    v_pk_fma_f32 v[40:41], v[40:41], s[94:95], v[26:27]
    v_pk_mul_f32 v[34:35], v[34:35], v[144:145]
    v_pk_mul_f32 v[36:37], v[36:37], v[146:147]
    v_pk_mul_f32 v[38:39], v[38:39], v[148:149]
    v_pk_mul_f32 v[40:41], v[40:41], v[150:151]
    v_exp_f32 v34, v34
    v_exp_f32 v35, v35
    v_exp_f32 v36, v36
    v_exp_f32 v37, v37
    v_exp_f32 v38, v38
    s_mov_b32 s83, 753664
    s_add_u32 m0, s3, 90112
    s_nop 0
    buffer_load_dwordx4 v17, s[48:51], s83 offen lds
    buffer_load_dwordx4 v18, s[48:51], s83 offen offset:1024 lds
    v_exp_f32 v39, v39
    v_exp_f32 v40, v40
    v_exp_f32 v41, v41
    v_pk_mul_f32 v[152:153], v[152:153], v[144:145]
    v_pk_mul_f32 v[154:155], v[154:155], v[146:147]
    v_pk_mul_f32 v[156:157], v[156:157], v[148:149]
    v_pk_mul_f32 v[158:159], v[158:159], v[150:151]
    v_pk_add_f32 v[34:35], v[34:35], 1.0 op_sel_hi:[1,0]
    v_pk_add_f32 v[36:37], v[36:37], 1.0 op_sel_hi:[1,0]
    v_pk_add_f32 v[38:39], v[38:39], 1.0 op_sel_hi:[1,0]
    v_pk_add_f32 v[40:41], v[40:41], 1.0 op_sel_hi:[1,0]
    v_rcp_f32 v34, v34
    v_rcp_f32 v35, v35
    v_rcp_f32 v36, v36
    v_rcp_f32 v37, v37
    v_rcp_f32 v38, v38
    v_rcp_f32 v39, v39
    v_rcp_f32 v40, v40
    v_rcp_f32 v41, v41
    v_pk_mul_f32 v[152:153], v[152:153], v[34:35]
    v_pk_mul_f32 v[154:155], v[154:155], v[36:37]
    v_pk_mul_f32 v[156:157], v[156:157], v[38:39]
    v_pk_mul_f32 v[158:159], v[158:159], v[40:41]
    v_cvt_pk_bf16_f32 v144, v152, v153
    v_cvt_pk_bf16_f32 v145, v154, v155
    v_cvt_pk_bf16_f32 v146, v156, v157
    v_cvt_pk_bf16_f32 v147, v158, v159
    buffer_store_dwordx4 v[144:147], v16, s[56:59], s89 offen offset:1024 sc1
    v_accvgpr_read_b32 v160, a160
    v_accvgpr_read_b32 v161, a161
    v_accvgpr_read_b32 v162, a162
    v_accvgpr_read_b32 v163, a163
    v_accvgpr_read_b32 v164, a164
    s_mov_b32 s82, 983040
    s_add_u32 m0, s3, 98304
    s_nop 0
    buffer_load_dwordx4 v17, s[48:51], s82 offen lds
    buffer_load_dwordx4 v18, s[48:51], s82 offen offset:1024 lds
    v_accvgpr_read_b32 v165, a165
    v_accvgpr_read_b32 v166, a166
    v_accvgpr_read_b32 v167, a167
    v_accvgpr_read_b32 v168, a168
    v_accvgpr_read_b32 v169, a169
    v_accvgpr_read_b32 v170, a170
    v_accvgpr_read_b32 v171, a171
    v_accvgpr_read_b32 v172, a172
    v_accvgpr_read_b32 v173, a173
    v_accvgpr_read_b32 v174, a174
    v_accvgpr_read_b32 v175, a175
    v_pk_mul_f32 v[34:35], v[160:161], v[160:161]
    v_pk_mul_f32 v[36:37], v[162:163], v[162:163]
    v_pk_mul_f32 v[38:39], v[164:165], v[164:165]
    v_pk_mul_f32 v[40:41], v[166:167], v[166:167]
    v_pk_fma_f32 v[34:35], v[34:35], s[94:95], v[26:27]
    v_pk_fma_f32 v[36:37], v[36:37], s[94:95], v[26:27]
    v_pk_fma_f32 v[38:39], v[38:39], s[94:95], v[26:27]
    v_pk_fma_f32 v[40:41], v[40:41], s[94:95], v[26:27]
    v_pk_mul_f32 v[34:35], v[34:35], v[160:161]
    v_pk_mul_f32 v[36:37], v[36:37], v[162:163]
    v_pk_mul_f32 v[38:39], v[38:39], v[164:165]
    v_pk_mul_f32 v[40:41], v[40:41], v[166:167]
    v_exp_f32 v34, v34
    v_exp_f32 v35, v35
    v_exp_f32 v36, v36
    v_exp_f32 v37, v37
    v_exp_f32 v38, v38
    s_mov_b32 s83, 1212416
    s_add_u32 m0, s3, 106496
    s_nop 0
    buffer_load_dwordx4 v17, s[48:51], s83 offen lds
    buffer_load_dwordx4 v18, s[48:51], s83 offen offset:1024 lds
    v_exp_f32 v39, v39
    v_exp_f32 v40, v40
    v_exp_f32 v41, v41
    v_pk_mul_f32 v[168:169], v[168:169], v[160:161]
    v_pk_mul_f32 v[170:171], v[170:171], v[162:163]
    v_pk_mul_f32 v[172:173], v[172:173], v[164:165]
    v_pk_mul_f32 v[174:175], v[174:175], v[166:167]
    v_pk_add_f32 v[34:35], v[34:35], 1.0 op_sel_hi:[1,0]
    v_pk_add_f32 v[36:37], v[36:37], 1.0 op_sel_hi:[1,0]
    v_pk_add_f32 v[38:39], v[38:39], 1.0 op_sel_hi:[1,0]
    v_pk_add_f32 v[40:41], v[40:41], 1.0 op_sel_hi:[1,0]
    v_rcp_f32 v34, v34
    v_rcp_f32 v35, v35
    v_rcp_f32 v36, v36
    v_rcp_f32 v37, v37
    v_rcp_f32 v38, v38
    v_rcp_f32 v39, v39
    v_rcp_f32 v40, v40
    v_rcp_f32 v41, v41
    v_pk_mul_f32 v[168:169], v[168:169], v[34:35]
    v_pk_mul_f32 v[170:171], v[170:171], v[36:37]
    v_pk_mul_f32 v[172:173], v[172:173], v[38:39]
    v_pk_mul_f32 v[174:175], v[174:175], v[40:41]
    v_cvt_pk_bf16_f32 v160, v168, v169
    v_cvt_pk_bf16_f32 v161, v170, v171
    v_cvt_pk_bf16_f32 v162, v172, v173
    v_cvt_pk_bf16_f32 v163, v174, v175
    buffer_store_dwordx4 v[160:163], v16, s[56:59], s89 offen offset:2048 sc1
    v_accvgpr_read_b32 v176, a176
    v_accvgpr_read_b32 v177, a177
    v_accvgpr_read_b32 v178, a178
    v_accvgpr_read_b32 v179, a179
    v_accvgpr_read_b32 v180, a180
    s_mov_b32 s82, 1441792
    s_add_u32 m0, s3, 114688
    s_nop 0
    buffer_load_dwordx4 v17, s[48:51], s82 offen lds
    buffer_load_dwordx4 v18, s[48:51], s82 offen offset:1024 lds
    v_accvgpr_read_b32 v181, a181
    v_accvgpr_read_b32 v182, a182
    v_accvgpr_read_b32 v183, a183
    v_accvgpr_read_b32 v184, a184
    v_accvgpr_read_b32 v185, a185
    v_accvgpr_read_b32 v186, a186
    v_accvgpr_read_b32 v187, a187
    v_accvgpr_read_b32 v188, a188
    v_accvgpr_read_b32 v189, a189
    v_accvgpr_read_b32 v190, a190
    v_accvgpr_read_b32 v191, a191
    v_pk_mul_f32 v[34:35], v[176:177], v[176:177]
    v_pk_mul_f32 v[36:37], v[178:179], v[178:179]
    v_pk_mul_f32 v[38:39], v[180:181], v[180:181]
    v_pk_mul_f32 v[40:41], v[182:183], v[182:183]
    v_pk_fma_f32 v[34:35], v[34:35], s[94:95], v[26:27]
    v_pk_fma_f32 v[36:37], v[36:37], s[94:95], v[26:27]
    v_pk_fma_f32 v[38:39], v[38:39], s[94:95], v[26:27]
    v_pk_fma_f32 v[40:41], v[40:41], s[94:95], v[26:27]
    v_pk_mul_f32 v[34:35], v[34:35], v[176:177]
    v_pk_mul_f32 v[36:37], v[36:37], v[178:179]
    v_pk_mul_f32 v[38:39], v[38:39], v[180:181]
    v_pk_mul_f32 v[40:41], v[40:41], v[182:183]
    v_exp_f32 v34, v34
    v_exp_f32 v35, v35
    v_exp_f32 v36, v36
    v_exp_f32 v37, v37
    v_exp_f32 v38, v38
    s_mov_b32 s83, 1671168
    s_add_u32 m0, s3, 122880
    s_nop 0
    buffer_load_dwordx4 v17, s[48:51], s83 offen lds
    buffer_load_dwordx4 v18, s[48:51], s83 offen offset:1024 lds
    v_exp_f32 v39, v39
    v_exp_f32 v40, v40
    v_exp_f32 v41, v41
    v_pk_mul_f32 v[184:185], v[184:185], v[176:177]
    v_pk_mul_f32 v[186:187], v[186:187], v[178:179]
    v_pk_mul_f32 v[188:189], v[188:189], v[180:181]
    v_pk_mul_f32 v[190:191], v[190:191], v[182:183]
    v_pk_add_f32 v[34:35], v[34:35], 1.0 op_sel_hi:[1,0]
    v_pk_add_f32 v[36:37], v[36:37], 1.0 op_sel_hi:[1,0]
    v_pk_add_f32 v[38:39], v[38:39], 1.0 op_sel_hi:[1,0]
    v_pk_add_f32 v[40:41], v[40:41], 1.0 op_sel_hi:[1,0]
    v_rcp_f32 v34, v34
    v_rcp_f32 v35, v35
    v_rcp_f32 v36, v36
    v_rcp_f32 v37, v37
    v_rcp_f32 v38, v38
    v_rcp_f32 v39, v39
    v_rcp_f32 v40, v40
    v_rcp_f32 v41, v41
    v_pk_mul_f32 v[184:185], v[184:185], v[34:35]
    v_pk_mul_f32 v[186:187], v[186:187], v[36:37]
    v_pk_mul_f32 v[188:189], v[188:189], v[38:39]
    v_pk_mul_f32 v[190:191], v[190:191], v[40:41]
    v_cvt_pk_bf16_f32 v176, v184, v185
    v_cvt_pk_bf16_f32 v177, v186, v187
    v_cvt_pk_bf16_f32 v178, v188, v189
    v_cvt_pk_bf16_f32 v179, v190, v191
    buffer_store_dwordx4 v[176:179], v16, s[56:59], s89 offen offset:3072 sc1
    v_accvgpr_read_b32 v128, a192
    v_accvgpr_read_b32 v129, a193
    v_accvgpr_read_b32 v130, a194
    v_accvgpr_read_b32 v131, a195
    v_accvgpr_read_b32 v132, a196
    s_mov_b32 s82, 131072
    s_add_u32 m0, s3, 131072
    s_nop 0
    buffer_load_dwordx4 v17, s[48:51], s82 offen lds
    buffer_load_dwordx4 v18, s[48:51], s82 offen offset:1024 lds
    v_accvgpr_read_b32 v133, a197
    v_accvgpr_read_b32 v134, a198
    v_accvgpr_read_b32 v135, a199
    v_accvgpr_read_b32 v136, a200
    v_accvgpr_read_b32 v137, a201
    v_accvgpr_read_b32 v138, a202
    v_accvgpr_read_b32 v139, a203
    v_accvgpr_read_b32 v140, a204
    v_accvgpr_read_b32 v141, a205
    v_accvgpr_read_b32 v142, a206
    v_accvgpr_read_b32 v143, a207
    v_pk_mul_f32 v[34:35], v[128:129], v[128:129]
    v_pk_mul_f32 v[36:37], v[130:131], v[130:131]
    v_pk_mul_f32 v[38:39], v[132:133], v[132:133]
    v_pk_mul_f32 v[40:41], v[134:135], v[134:135]
    v_pk_fma_f32 v[34:35], v[34:35], s[94:95], v[26:27]
    v_pk_fma_f32 v[36:37], v[36:37], s[94:95], v[26:27]
    v_pk_fma_f32 v[38:39], v[38:39], s[94:95], v[26:27]
    v_pk_fma_f32 v[40:41], v[40:41], s[94:95], v[26:27]
    v_pk_mul_f32 v[34:35], v[34:35], v[128:129]
    v_pk_mul_f32 v[36:37], v[36:37], v[130:131]
    v_pk_mul_f32 v[38:39], v[38:39], v[132:133]
    v_pk_mul_f32 v[40:41], v[40:41], v[134:135]
    v_exp_f32 v34, v34
    v_exp_f32 v35, v35
    v_exp_f32 v36, v36
    v_exp_f32 v37, v37
    v_exp_f32 v38, v38
    s_mov_b32 s83, 360448
    s_add_u32 m0, s3, 139264
    s_nop 0
    buffer_load_dwordx4 v17, s[48:51], s83 offen lds
    buffer_load_dwordx4 v18, s[48:51], s83 offen offset:1024 lds
    v_exp_f32 v39, v39
    v_exp_f32 v40, v40
    v_exp_f32 v41, v41
    v_pk_mul_f32 v[136:137], v[136:137], v[128:129]
    v_pk_mul_f32 v[138:139], v[138:139], v[130:131]
    v_pk_mul_f32 v[140:141], v[140:141], v[132:133]
    v_pk_mul_f32 v[142:143], v[142:143], v[134:135]
    v_pk_add_f32 v[34:35], v[34:35], 1.0 op_sel_hi:[1,0]
    v_pk_add_f32 v[36:37], v[36:37], 1.0 op_sel_hi:[1,0]
    v_pk_add_f32 v[38:39], v[38:39], 1.0 op_sel_hi:[1,0]
    v_pk_add_f32 v[40:41], v[40:41], 1.0 op_sel_hi:[1,0]
    v_rcp_f32 v34, v34
    v_rcp_f32 v35, v35
    v_rcp_f32 v36, v36
    v_rcp_f32 v37, v37
    v_rcp_f32 v38, v38
    v_rcp_f32 v39, v39
    v_rcp_f32 v40, v40
    v_rcp_f32 v41, v41
    v_pk_mul_f32 v[136:137], v[136:137], v[34:35]
    v_pk_mul_f32 v[138:139], v[138:139], v[36:37]
    v_pk_mul_f32 v[140:141], v[140:141], v[38:39]
    v_pk_mul_f32 v[142:143], v[142:143], v[40:41]
    v_cvt_pk_bf16_f32 v128, v136, v137
    v_cvt_pk_bf16_f32 v129, v138, v139
    v_cvt_pk_bf16_f32 v130, v140, v141
    v_cvt_pk_bf16_f32 v131, v142, v143
    s_add_u32 s89, s89, 4096
    buffer_store_dwordx4 v[128:131], v16, s[56:59], s89 offen offset:0 sc1
    v_accvgpr_read_b32 v144, a208
    v_accvgpr_read_b32 v145, a209
    v_accvgpr_read_b32 v146, a210
    v_accvgpr_read_b32 v147, a211
    v_accvgpr_read_b32 v148, a212
    s_mov_b32 s82, 589824
    s_add_u32 m0, s3, 147456
    s_nop 0
    buffer_load_dwordx4 v17, s[48:51], s82 offen lds
    buffer_load_dwordx4 v18, s[48:51], s82 offen offset:1024 lds
    v_accvgpr_read_b32 v149, a213
    v_accvgpr_read_b32 v150, a214
    v_accvgpr_read_b32 v151, a215
    v_accvgpr_read_b32 v152, a216
    v_accvgpr_read_b32 v153, a217
    v_accvgpr_read_b32 v154, a218
    v_accvgpr_read_b32 v155, a219
    v_accvgpr_read_b32 v156, a220
    v_accvgpr_read_b32 v157, a221
    v_accvgpr_read_b32 v158, a222
    v_accvgpr_read_b32 v159, a223
    v_pk_mul_f32 v[34:35], v[144:145], v[144:145]
    v_pk_mul_f32 v[36:37], v[146:147], v[146:147]
    v_pk_mul_f32 v[38:39], v[148:149], v[148:149]
    v_pk_mul_f32 v[40:41], v[150:151], v[150:151]
    v_pk_fma_f32 v[34:35], v[34:35], s[94:95], v[26:27]
    v_pk_fma_f32 v[36:37], v[36:37], s[94:95], v[26:27]
    v_pk_fma_f32 v[38:39], v[38:39], s[94:95], v[26:27]
    v_pk_fma_f32 v[40:41], v[40:41], s[94:95], v[26:27]
    v_pk_mul_f32 v[34:35], v[34:35], v[144:145]
    v_pk_mul_f32 v[36:37], v[36:37], v[146:147]
    v_pk_mul_f32 v[38:39], v[38:39], v[148:149]
    v_pk_mul_f32 v[40:41], v[40:41], v[150:151]
    v_exp_f32 v34, v34
    v_exp_f32 v35, v35
    v_exp_f32 v36, v36
    v_exp_f32 v37, v37
    v_exp_f32 v38, v38
    s_mov_b32 s83, 819200
    s_add_u32 m0, s3, 155648
    s_nop 0
    buffer_load_dwordx4 v17, s[48:51], s83 offen lds
    buffer_load_dwordx4 v18, s[48:51], s83 offen offset:1024 lds
    v_exp_f32 v39, v39
    v_exp_f32 v40, v40
    v_exp_f32 v41, v41
    v_pk_mul_f32 v[152:153], v[152:153], v[144:145]
    v_pk_mul_f32 v[154:155], v[154:155], v[146:147]
    v_pk_mul_f32 v[156:157], v[156:157], v[148:149]
    v_pk_mul_f32 v[158:159], v[158:159], v[150:151]
    v_pk_add_f32 v[34:35], v[34:35], 1.0 op_sel_hi:[1,0]
    v_pk_add_f32 v[36:37], v[36:37], 1.0 op_sel_hi:[1,0]
    v_pk_add_f32 v[38:39], v[38:39], 1.0 op_sel_hi:[1,0]
    v_pk_add_f32 v[40:41], v[40:41], 1.0 op_sel_hi:[1,0]
    v_rcp_f32 v34, v34
    v_rcp_f32 v35, v35
    v_rcp_f32 v36, v36
    v_rcp_f32 v37, v37
    v_rcp_f32 v38, v38
    v_rcp_f32 v39, v39
    v_rcp_f32 v40, v40
    v_rcp_f32 v41, v41
    v_pk_mul_f32 v[152:153], v[152:153], v[34:35]
    v_pk_mul_f32 v[154:155], v[154:155], v[36:37]
    v_pk_mul_f32 v[156:157], v[156:157], v[38:39]
    v_pk_mul_f32 v[158:159], v[158:159], v[40:41]
    v_cvt_pk_bf16_f32 v144, v152, v153
    v_cvt_pk_bf16_f32 v145, v154, v155
    v_cvt_pk_bf16_f32 v146, v156, v157
    v_cvt_pk_bf16_f32 v147, v158, v159
    buffer_store_dwordx4 v[144:147], v16, s[56:59], s89 offen offset:1024 sc1
    v_accvgpr_read_b32 v160, a224
    v_accvgpr_read_b32 v161, a225
    v_accvgpr_read_b32 v162, a226
    v_accvgpr_read_b32 v163, a227
    v_accvgpr_read_b32 v164, a228
    v_accvgpr_read_b32 v165, a229
    v_accvgpr_read_b32 v166, a230
    v_accvgpr_read_b32 v167, a231
    v_accvgpr_read_b32 v168, a232
    v_accvgpr_read_b32 v169, a233
    v_accvgpr_read_b32 v170, a234
    v_accvgpr_read_b32 v171, a235
    v_accvgpr_read_b32 v172, a236
    v_accvgpr_read_b32 v173, a237
    v_accvgpr_read_b32 v174, a238
    v_accvgpr_read_b32 v175, a239
    v_pk_mul_f32 v[34:35], v[160:161], v[160:161]
    v_pk_mul_f32 v[36:37], v[162:163], v[162:163]
    v_pk_mul_f32 v[38:39], v[164:165], v[164:165]
    v_pk_mul_f32 v[40:41], v[166:167], v[166:167]
    v_pk_fma_f32 v[34:35], v[34:35], s[94:95], v[26:27]
    v_pk_fma_f32 v[36:37], v[36:37], s[94:95], v[26:27]
    v_pk_fma_f32 v[38:39], v[38:39], s[94:95], v[26:27]
    v_pk_fma_f32 v[40:41], v[40:41], s[94:95], v[26:27]
    v_pk_mul_f32 v[34:35], v[34:35], v[160:161]
    v_pk_mul_f32 v[36:37], v[36:37], v[162:163]
    v_pk_mul_f32 v[38:39], v[38:39], v[164:165]
    v_pk_mul_f32 v[40:41], v[40:41], v[166:167]
    v_exp_f32 v34, v34
    v_exp_f32 v35, v35
    v_exp_f32 v36, v36
    v_exp_f32 v37, v37
    v_exp_f32 v38, v38
    v_exp_f32 v39, v39
    v_exp_f32 v40, v40
    v_exp_f32 v41, v41
    v_pk_mul_f32 v[168:169], v[168:169], v[160:161]
    v_pk_mul_f32 v[170:171], v[170:171], v[162:163]
    v_pk_mul_f32 v[172:173], v[172:173], v[164:165]
    v_pk_mul_f32 v[174:175], v[174:175], v[166:167]
    v_pk_add_f32 v[34:35], v[34:35], 1.0 op_sel_hi:[1,0]
    v_pk_add_f32 v[36:37], v[36:37], 1.0 op_sel_hi:[1,0]
    v_pk_add_f32 v[38:39], v[38:39], 1.0 op_sel_hi:[1,0]
    v_pk_add_f32 v[40:41], v[40:41], 1.0 op_sel_hi:[1,0]
    v_rcp_f32 v34, v34
    v_rcp_f32 v35, v35
    v_rcp_f32 v36, v36
    v_rcp_f32 v37, v37
    v_rcp_f32 v38, v38
    v_rcp_f32 v39, v39
    v_rcp_f32 v40, v40
    v_rcp_f32 v41, v41
    v_pk_mul_f32 v[168:169], v[168:169], v[34:35]
    v_pk_mul_f32 v[170:171], v[170:171], v[36:37]
    v_pk_mul_f32 v[172:173], v[172:173], v[38:39]
    v_pk_mul_f32 v[174:175], v[174:175], v[40:41]
    v_cvt_pk_bf16_f32 v160, v168, v169
    v_cvt_pk_bf16_f32 v161, v170, v171
    v_cvt_pk_bf16_f32 v162, v172, v173
    v_cvt_pk_bf16_f32 v163, v174, v175
    buffer_store_dwordx4 v[160:163], v16, s[56:59], s89 offen offset:2048 sc1
    v_accvgpr_read_b32 v176, a240
    v_accvgpr_read_b32 v177, a241
    v_accvgpr_read_b32 v178, a242
    v_accvgpr_read_b32 v179, a243
    v_accvgpr_read_b32 v180, a244
    v_accvgpr_read_b32 v181, a245
    v_accvgpr_read_b32 v182, a246
    v_accvgpr_read_b32 v183, a247
    v_accvgpr_read_b32 v184, a248
    v_accvgpr_read_b32 v185, a249
    v_accvgpr_read_b32 v186, a250
    v_accvgpr_read_b32 v187, a251
    v_accvgpr_read_b32 v188, a252
    v_accvgpr_read_b32 v189, a253
    v_accvgpr_read_b32 v190, a254
    v_accvgpr_read_b32 v191, a255
    v_pk_mul_f32 v[34:35], v[176:177], v[176:177]
    v_pk_mul_f32 v[36:37], v[178:179], v[178:179]
    v_pk_mul_f32 v[38:39], v[180:181], v[180:181]
    v_pk_mul_f32 v[40:41], v[182:183], v[182:183]
    v_pk_fma_f32 v[34:35], v[34:35], s[94:95], v[26:27]
    v_pk_fma_f32 v[36:37], v[36:37], s[94:95], v[26:27]
    v_pk_fma_f32 v[38:39], v[38:39], s[94:95], v[26:27]
    v_pk_fma_f32 v[40:41], v[40:41], s[94:95], v[26:27]
    v_pk_mul_f32 v[34:35], v[34:35], v[176:177]
    v_pk_mul_f32 v[36:37], v[36:37], v[178:179]
    v_pk_mul_f32 v[38:39], v[38:39], v[180:181]
    v_pk_mul_f32 v[40:41], v[40:41], v[182:183]
    v_exp_f32 v34, v34
    v_exp_f32 v35, v35
    v_exp_f32 v36, v36
    v_exp_f32 v37, v37
    v_exp_f32 v38, v38
    v_exp_f32 v39, v39
    v_exp_f32 v40, v40
    v_exp_f32 v41, v41
    v_pk_mul_f32 v[184:185], v[184:185], v[176:177]
    v_pk_mul_f32 v[186:187], v[186:187], v[178:179]
    v_pk_mul_f32 v[188:189], v[188:189], v[180:181]
    v_pk_mul_f32 v[190:191], v[190:191], v[182:183]
    v_pk_add_f32 v[34:35], v[34:35], 1.0 op_sel_hi:[1,0]
    v_pk_add_f32 v[36:37], v[36:37], 1.0 op_sel_hi:[1,0]
    v_pk_add_f32 v[38:39], v[38:39], 1.0 op_sel_hi:[1,0]
    v_pk_add_f32 v[40:41], v[40:41], 1.0 op_sel_hi:[1,0]
    v_rcp_f32 v34, v34
    v_rcp_f32 v35, v35
    v_rcp_f32 v36, v36
    v_rcp_f32 v37, v37
    v_rcp_f32 v38, v38
    v_rcp_f32 v39, v39
    v_rcp_f32 v40, v40
    v_rcp_f32 v41, v41
    v_pk_mul_f32 v[184:185], v[184:185], v[34:35]
    v_pk_mul_f32 v[186:187], v[186:187], v[36:37]
    v_pk_mul_f32 v[188:189], v[188:189], v[38:39]
    v_pk_mul_f32 v[190:191], v[190:191], v[40:41]
    v_cvt_pk_bf16_f32 v176, v184, v185
    v_cvt_pk_bf16_f32 v177, v186, v187
    v_cvt_pk_bf16_f32 v178, v188, v189
    v_cvt_pk_bf16_f32 v179, v190, v191
    buffer_store_dwordx4 v[176:179], v16, s[56:59], s89 offen offset:3072 sc1
    v_pk_mul_f32 v[34:35], v[48:49], v[48:49]
    v_pk_mul_f32 v[36:37], v[50:51], v[50:51]
    v_pk_mul_f32 v[38:39], v[52:53], v[52:53]
    v_pk_mul_f32 v[40:41], v[54:55], v[54:55]
    v_pk_fma_f32 v[34:35], v[34:35], s[94:95], v[26:27]
    v_pk_fma_f32 v[36:37], v[36:37], s[94:95], v[26:27]
    v_pk_fma_f32 v[38:39], v[38:39], s[94:95], v[26:27]
    v_pk_fma_f32 v[40:41], v[40:41], s[94:95], v[26:27]
    v_pk_mul_f32 v[34:35], v[34:35], v[48:49]
    v_pk_mul_f32 v[36:37], v[36:37], v[50:51]
    v_pk_mul_f32 v[38:39], v[38:39], v[52:53]
    v_pk_mul_f32 v[40:41], v[40:41], v[54:55]
    v_exp_f32 v34, v34
    v_exp_f32 v35, v35
    v_exp_f32 v36, v36
    v_exp_f32 v37, v37
    v_exp_f32 v38, v38
    v_exp_f32 v39, v39
    v_exp_f32 v40, v40
    v_exp_f32 v41, v41
    v_pk_mul_f32 v[56:57], v[56:57], v[48:49]
    v_pk_mul_f32 v[58:59], v[58:59], v[50:51]
    v_pk_mul_f32 v[60:61], v[60:61], v[52:53]
    v_pk_mul_f32 v[62:63], v[62:63], v[54:55]
    v_pk_add_f32 v[34:35], v[34:35], 1.0 op_sel_hi:[1,0]
    v_pk_add_f32 v[36:37], v[36:37], 1.0 op_sel_hi:[1,0]
    v_pk_add_f32 v[38:39], v[38:39], 1.0 op_sel_hi:[1,0]
    v_pk_add_f32 v[40:41], v[40:41], 1.0 op_sel_hi:[1,0]
    v_rcp_f32 v34, v34
    v_rcp_f32 v35, v35
    v_rcp_f32 v36, v36
    v_rcp_f32 v37, v37
    v_rcp_f32 v38, v38
    v_rcp_f32 v39, v39
    v_rcp_f32 v40, v40
    v_rcp_f32 v41, v41
    v_pk_mul_f32 v[56:57], v[56:57], v[34:35]
    v_pk_mul_f32 v[58:59], v[58:59], v[36:37]
    v_pk_mul_f32 v[60:61], v[60:61], v[38:39]
    v_pk_mul_f32 v[62:63], v[62:63], v[40:41]
    v_cvt_pk_bf16_f32 v48, v56, v57
    v_cvt_pk_bf16_f32 v49, v58, v59
    v_cvt_pk_bf16_f32 v50, v60, v61
    v_cvt_pk_bf16_f32 v51, v62, v63
    s_nop 0
    v_permlane16_swap_b32 v48, v50
    v_permlane16_swap_b32 v49, v51
    buffer_store_dwordx4 v[48:51], v28, s[56:59], s90 offen offset:0 sc1
    v_pk_mul_f32 v[34:35], v[64:65], v[64:65]
    v_pk_mul_f32 v[36:37], v[66:67], v[66:67]
    v_pk_mul_f32 v[38:39], v[68:69], v[68:69]
    v_pk_mul_f32 v[40:41], v[70:71], v[70:71]
    v_pk_fma_f32 v[34:35], v[34:35], s[94:95], v[26:27]
    v_pk_fma_f32 v[36:37], v[36:37], s[94:95], v[26:27]
    v_pk_fma_f32 v[38:39], v[38:39], s[94:95], v[26:27]
    v_pk_fma_f32 v[40:41], v[40:41], s[94:95], v[26:27]
    v_pk_mul_f32 v[34:35], v[34:35], v[64:65]
    v_pk_mul_f32 v[36:37], v[36:37], v[66:67]
    v_pk_mul_f32 v[38:39], v[38:39], v[68:69]
    v_pk_mul_f32 v[40:41], v[40:41], v[70:71]
    v_exp_f32 v34, v34
    v_exp_f32 v35, v35
    v_exp_f32 v36, v36
    v_exp_f32 v37, v37
    v_exp_f32 v38, v38
    v_exp_f32 v39, v39
    v_exp_f32 v40, v40
    v_exp_f32 v41, v41
    v_pk_mul_f32 v[72:73], v[72:73], v[64:65]
    v_pk_mul_f32 v[74:75], v[74:75], v[66:67]
    v_pk_mul_f32 v[76:77], v[76:77], v[68:69]
    v_pk_mul_f32 v[78:79], v[78:79], v[70:71]
    v_pk_add_f32 v[34:35], v[34:35], 1.0 op_sel_hi:[1,0]
    v_pk_add_f32 v[36:37], v[36:37], 1.0 op_sel_hi:[1,0]
    v_pk_add_f32 v[38:39], v[38:39], 1.0 op_sel_hi:[1,0]
    v_pk_add_f32 v[40:41], v[40:41], 1.0 op_sel_hi:[1,0]
    v_rcp_f32 v34, v34
    v_rcp_f32 v35, v35
    v_rcp_f32 v36, v36
    v_rcp_f32 v37, v37
    v_rcp_f32 v38, v38
    v_rcp_f32 v39, v39
    v_rcp_f32 v40, v40
    v_rcp_f32 v41, v41
    v_pk_mul_f32 v[72:73], v[72:73], v[34:35]
    v_pk_mul_f32 v[74:75], v[74:75], v[36:37]
    v_pk_mul_f32 v[76:77], v[76:77], v[38:39]
    v_pk_mul_f32 v[78:79], v[78:79], v[40:41]
    v_cvt_pk_bf16_f32 v64, v72, v73
    v_cvt_pk_bf16_f32 v65, v74, v75
    v_cvt_pk_bf16_f32 v66, v76, v77
    v_cvt_pk_bf16_f32 v67, v78, v79
    s_nop 0
    v_permlane16_swap_b32 v64, v66
    v_permlane16_swap_b32 v65, v67
    buffer_store_dwordx4 v[64:67], v28, s[56:59], s90 offen offset:2048 sc1
    s_waitcnt vmcnt(2)
    s_mov_b64 exec, 1
    buffer_atomic_add v29, off, s[56:59], s92 sc1
    s_mov_b64 exec, -1
    v_pk_mul_f32 v[34:35], v[80:81], v[80:81]
    v_pk_mul_f32 v[36:37], v[82:83], v[82:83]
    v_pk_mul_f32 v[38:39], v[84:85], v[84:85]
    v_pk_mul_f32 v[40:41], v[86:87], v[86:87]
    v_pk_fma_f32 v[34:35], v[34:35], s[94:95], v[26:27]
    v_pk_fma_f32 v[36:37], v[36:37], s[94:95], v[26:27]
    v_pk_fma_f32 v[38:39], v[38:39], s[94:95], v[26:27]
    v_pk_fma_f32 v[40:41], v[40:41], s[94:95], v[26:27]
    v_pk_mul_f32 v[34:35], v[34:35], v[80:81]
    v_pk_mul_f32 v[36:37], v[36:37], v[82:83]
    v_pk_mul_f32 v[38:39], v[38:39], v[84:85]
    v_pk_mul_f32 v[40:41], v[40:41], v[86:87]
    v_exp_f32 v34, v34
    v_exp_f32 v35, v35
    v_exp_f32 v36, v36
    v_exp_f32 v37, v37
    v_exp_f32 v38, v38
    v_exp_f32 v39, v39
    v_exp_f32 v40, v40
    v_exp_f32 v41, v41
    v_pk_mul_f32 v[88:89], v[88:89], v[80:81]
    v_pk_mul_f32 v[90:91], v[90:91], v[82:83]
    v_pk_mul_f32 v[92:93], v[92:93], v[84:85]
    v_pk_mul_f32 v[94:95], v[94:95], v[86:87]
    v_pk_add_f32 v[34:35], v[34:35], 1.0 op_sel_hi:[1,0]
    v_pk_add_f32 v[36:37], v[36:37], 1.0 op_sel_hi:[1,0]
    v_pk_add_f32 v[38:39], v[38:39], 1.0 op_sel_hi:[1,0]
    v_pk_add_f32 v[40:41], v[40:41], 1.0 op_sel_hi:[1,0]
    v_rcp_f32 v34, v34
    v_rcp_f32 v35, v35
    v_rcp_f32 v36, v36
    v_rcp_f32 v37, v37
    v_rcp_f32 v38, v38
    v_rcp_f32 v39, v39
    v_rcp_f32 v40, v40
    v_rcp_f32 v41, v41
    v_pk_mul_f32 v[88:89], v[88:89], v[34:35]
    v_pk_mul_f32 v[90:91], v[90:91], v[36:37]
    v_pk_mul_f32 v[92:93], v[92:93], v[38:39]
    v_pk_mul_f32 v[94:95], v[94:95], v[40:41]
    v_cvt_pk_bf16_f32 v80, v88, v89
    v_cvt_pk_bf16_f32 v81, v90, v91
    v_cvt_pk_bf16_f32 v82, v92, v93
    v_cvt_pk_bf16_f32 v83, v94, v95
    s_nop 0
    v_permlane16_swap_b32 v80, v82
    v_permlane16_swap_b32 v81, v83
    s_add_u32 s90, s90, 4096
    buffer_store_dwordx4 v[80:83], v28, s[56:59], s90 offen offset:0 sc1
    v_pk_mul_f32 v[34:35], v[96:97], v[96:97]
    v_pk_mul_f32 v[36:37], v[98:99], v[98:99]
    v_pk_mul_f32 v[38:39], v[100:101], v[100:101]
    v_pk_mul_f32 v[40:41], v[102:103], v[102:103]
    v_pk_fma_f32 v[34:35], v[34:35], s[94:95], v[26:27]
    v_pk_fma_f32 v[36:37], v[36:37], s[94:95], v[26:27]
    v_pk_fma_f32 v[38:39], v[38:39], s[94:95], v[26:27]
    v_pk_fma_f32 v[40:41], v[40:41], s[94:95], v[26:27]
    v_pk_mul_f32 v[34:35], v[34:35], v[96:97]
    v_pk_mul_f32 v[36:37], v[36:37], v[98:99]
    v_pk_mul_f32 v[38:39], v[38:39], v[100:101]
    v_pk_mul_f32 v[40:41], v[40:41], v[102:103]
    v_exp_f32 v34, v34
    v_exp_f32 v35, v35
    v_exp_f32 v36, v36
    v_exp_f32 v37, v37
    v_exp_f32 v38, v38
    v_exp_f32 v39, v39
    v_exp_f32 v40, v40
    v_exp_f32 v41, v41
    v_pk_mul_f32 v[104:105], v[104:105], v[96:97]
    v_pk_mul_f32 v[106:107], v[106:107], v[98:99]
    v_pk_mul_f32 v[108:109], v[108:109], v[100:101]
    v_pk_mul_f32 v[110:111], v[110:111], v[102:103]
    v_pk_add_f32 v[34:35], v[34:35], 1.0 op_sel_hi:[1,0]
    v_pk_add_f32 v[36:37], v[36:37], 1.0 op_sel_hi:[1,0]
    v_pk_add_f32 v[38:39], v[38:39], 1.0 op_sel_hi:[1,0]
    v_pk_add_f32 v[40:41], v[40:41], 1.0 op_sel_hi:[1,0]
    v_rcp_f32 v34, v34
    v_rcp_f32 v35, v35
    v_rcp_f32 v36, v36
    v_rcp_f32 v37, v37
    v_rcp_f32 v38, v38
    v_rcp_f32 v39, v39
    v_rcp_f32 v40, v40
    v_rcp_f32 v41, v41
    v_pk_mul_f32 v[104:105], v[104:105], v[34:35]
    v_pk_mul_f32 v[106:107], v[106:107], v[36:37]
    v_pk_mul_f32 v[108:109], v[108:109], v[38:39]
    v_pk_mul_f32 v[110:111], v[110:111], v[40:41]
    v_cvt_pk_bf16_f32 v96, v104, v105
    v_cvt_pk_bf16_f32 v97, v106, v107
    v_cvt_pk_bf16_f32 v98, v108, v109
    v_cvt_pk_bf16_f32 v99, v110, v111
    s_nop 0
    v_permlane16_swap_b32 v96, v98
    v_permlane16_swap_b32 v97, v99
    buffer_store_dwordx4 v[96:99], v28, s[56:59], s90 offen offset:2048 sc1
    s_mov_b32 s67, 0
    s_barrier
    buffer_load_dwordx4 a[0:3], v21, s[56:59], s68 offen sc1
    buffer_load_dwordx4 a[4:7], v22, s[56:59], s68 offen sc1
    buffer_load_dwordx4 a[8:11], v23, s[56:59], s68 offen sc1
    buffer_load_dwordx4 a[12:15], v24, s[56:59], s68 offen sc1
    s_add_u32 s68, s68, 16384
    buffer_load_dwordx4 a[16:19], v21, s[56:59], s68 offen sc1
    buffer_load_dwordx4 a[20:23], v22, s[56:59], s68 offen sc1
    buffer_load_dwordx4 a[24:27], v23, s[56:59], s68 offen sc1
    buffer_load_dwordx4 a[28:31], v24, s[56:59], s68 offen sc1
    s_add_u32 s68, s68, 16384
    buffer_load_dwordx4 a[32:35], v21, s[56:59], s68 offen sc1
    buffer_load_dwordx4 a[36:39], v22, s[56:59], s68 offen sc1
    buffer_load_dwordx4 a[40:43], v23, s[56:59], s68 offen sc1
    buffer_load_dwordx4 a[44:47], v24, s[56:59], s68 offen sc1
    s_add_u32 s68, s68, 16384
    buffer_load_dwordx4 a[48:51], v21, s[56:59], s68 offen sc1
    buffer_load_dwordx4 a[52:55], v22, s[56:59], s68 offen sc1
    buffer_load_dwordx4 a[56:59], v23, s[56:59], s68 offen sc1
    buffer_load_dwordx4 a[60:63], v24, s[56:59], s68 offen sc1
    s_add_u32 s68, s68, 16384
    buffer_load_dwordx4 a[64:67], v21, s[56:59], s68 offen sc1
    buffer_load_dwordx4 a[68:71], v22, s[56:59], s68 offen sc1
    buffer_load_dwordx4 a[72:75], v23, s[56:59], s68 offen sc1
    buffer_load_dwordx4 a[76:79], v24, s[56:59], s68 offen sc1
    s_add_u32 s68, s68, 16384
    buffer_load_dwordx4 a[80:83], v21, s[56:59], s68 offen sc1
    buffer_load_dwordx4 a[84:87], v22, s[56:59], s68 offen sc1
    buffer_load_dwordx4 a[88:91], v23, s[56:59], s68 offen sc1
    buffer_load_dwordx4 a[92:95], v24, s[56:59], s68 offen sc1
    s_add_u32 s68, s68, 16384
    buffer_load_dwordx4 a[96:99], v21, s[56:59], s68 offen sc1
    buffer_load_dwordx4 a[100:103], v22, s[56:59], s68 offen sc1
    buffer_load_dwordx4 a[104:107], v23, s[56:59], s68 offen sc1
    buffer_load_dwordx4 a[108:111], v24, s[56:59], s68 offen sc1
    s_add_u32 s68, s68, 16384
    buffer_load_dwordx4 a[112:115], v21, s[56:59], s68 offen sc1
    buffer_load_dwordx4 a[116:119], v22, s[56:59], s68 offen sc1
    buffer_load_dwordx4 a[120:123], v23, s[56:59], s68 offen sc1
    buffer_load_dwordx4 a[124:127], v24, s[56:59], s68 offen sc1
    s_add_u32 s68, s68, 16384
L_D:
    v_lshrrev_b32 v34, 2, v0
    v_and_b32 v35, 3, v0
    v_lshlrev_b32 v35, 3, v35
    v_lshl_add_u32 v35, v34, 8, v35
    v_and_b32 v34, 7, v34
    v_xor_b32 v36, 0, v34
    v_lshl_add_u32 v8, v36, 5, v35
    v_xor_b32 v36, 1, v34
    v_lshl_add_u32 v9, v36, 5, v35
    v_xor_b32 v36, 2, v34
    v_lshl_add_u32 v10, v36, 5, v35
    v_xor_b32 v36, 3, v34
    v_lshl_add_u32 v11, v36, 5, v35
    v_xor_b32 v36, 4, v34
    v_lshl_add_u32 v12, v36, 5, v35
    v_xor_b32 v36, 5, v34
    v_lshl_add_u32 v13, v36, 5, v35
    v_xor_b32 v36, 6, v34
    v_lshl_add_u32 v14, v36, 5, v35
    v_xor_b32 v36, 7, v34
    v_lshl_add_u32 v15, v36, 5, v35
    ds_read_b64_tr_b16 a[128:129], v8 offset:0
    ds_read_b64_tr_b16 a[130:131], v8 offset:4096
    ds_read_b64_tr_b16 a[132:133], v9 offset:0
    ds_read_b64_tr_b16 a[134:135], v9 offset:4096
    ds_read_b64_tr_b16 a[136:137], v10 offset:0
    ds_read_b64_tr_b16 a[138:139], v10 offset:4096
    ds_read_b64_tr_b16 a[140:141], v11 offset:0
    ds_read_b64_tr_b16 a[142:143], v11 offset:4096
    ds_read_b64_tr_b16 a[144:145], v12 offset:0
    ds_read_b64_tr_b16 a[146:147], v12 offset:4096
    ds_read_b64_tr_b16 a[148:149], v13 offset:0
    ds_read_b64_tr_b16 a[150:151], v13 offset:4096
    ds_read_b64_tr_b16 a[152:153], v14 offset:0
    ds_read_b64_tr_b16 a[154:155], v14 offset:4096
    ds_read_b64_tr_b16 a[156:157], v15 offset:0
    ds_read_b64_tr_b16 a[158:159], v15 offset:4096
    v_add_u32 v48, 0x10000, v8
    v_add_u32 v56, 0x20000, v8
    v_add_u32 v49, 0x10000, v9
    v_add_u32 v57, 0x20000, v9
    v_add_u32 v50, 0x10000, v10
    v_add_u32 v58, 0x20000, v10
    v_add_u32 v51, 0x10000, v11
    v_add_u32 v59, 0x20000, v11
    v_add_u32 v52, 0x10000, v12
    v_add_u32 v60, 0x20000, v12
    v_add_u32 v53, 0x10000, v13
    v_add_u32 v61, 0x20000, v13
    v_add_u32 v54, 0x10000, v14
    v_add_u32 v62, 0x20000, v14
    v_add_u32 v55, 0x10000, v15
    v_add_u32 v63, 0x20000, v15
    s_lshl_b32 s84, s63, 2
    s_add_u32 s84, s84, s60
    s_lshl_b32 s84, s84, 2
    s_add_u32 s84, s84, s65
    s_lshl_b32 s84, s84, 15
    s_lshl_b32 s85, s66, 8
    s_add_u32 s84, s84, s85
    v_and_b32 v34, 15, v0
    v_lshrrev_b32 v35, 4, v0
    v_lshlrev_b32 v36, 11, v34
    v_add_u32 v36, s84, v36
    v_lshl_add_u32 v1, v35, 3, v36
    v_and_b32 v2, 1, v35
    v_lshl_add_u32 v36, v2, 5, v36
    v_lshrrev_b32 v2, 1, v35
    v_lshl_add_u32 v2, v2, 4, v36
    v_lshlrev_b32 v35, 2, v35
    v_sub_u32 v34, v34, v35
    v_mov_b32 v26, 0
    v_mov_b32 v27, 0
    v_mov_b32 v30, 0
    v_mov_b32 v31, 0
    v_mov_b32 v35, 0x3f80
    v_mov_b32 v36, 0x3f800000
    v_cmp_eq_u32 vcc, 0, v34
    s_nop 1
    v_cndmask_b32 v28, v26, v35, vcc
    v_cmp_eq_u32 vcc, 1, v34
    s_nop 1
    v_cndmask_b32 v28, v28, v36, vcc
    v_cmp_eq_u32 vcc, 2, v34
    s_nop 1
    v_cndmask_b32 v29, v26, v35, vcc
    v_cmp_eq_u32 vcc, 3, v34
    s_nop 1
    v_cndmask_b32 v29, v29, v36, vcc
    s_mov_b32 s14, 0xbfb8aa3b
    s_mov_b32 s15, 0xbfb8aa3b
    s_waitcnt vmcnt(31) lgkmcnt(14)
    v_mfma_f32_16x16x32_bf16 v[128:131], a[128:131], a[0:3], 0
    s_waitcnt vmcnt(30)
    v_mfma_f32_16x16x32_bf16 v[160:163], a[128:131], a[4:7], 0
    ds_read_b64_tr_b16 a[160:161], v8 offset:8192
    s_waitcnt vmcnt(29)
    v_mfma_f32_16x16x32_bf16 v[192:195], a[128:131], a[8:11], 0
    ds_read_b64_tr_b16 a[162:163], v8 offset:12288
    s_waitcnt vmcnt(28)
    v_mfma_f32_16x16x32_bf16 v[224:227], a[128:131], a[12:15], 0
    s_waitcnt lgkmcnt(14)
    v_mfma_f32_16x16x32_bf16 v[132:135], a[132:135], a[0:3], 0
    ds_read_b64_tr_b16 a[164:165], v9 offset:8192
    v_mfma_f32_16x16x32_bf16 v[164:167], a[132:135], a[4:7], 0
    ds_read_b64_tr_b16 a[166:167], v9 offset:12288
    v_mfma_f32_16x16x32_bf16 v[196:199], a[132:135], a[8:11], 0
    v_mfma_f32_16x16x32_bf16 v[228:231], a[132:135], a[12:15], 0
    ds_read_b64_tr_b16 a[168:169], v10 offset:8192
    s_waitcnt lgkmcnt(15)
    v_mfma_f32_16x16x32_bf16 v[136:139], a[136:139], a[0:3], 0
    ds_read_b64_tr_b16 a[170:171], v10 offset:12288
    v_mfma_f32_16x16x32_bf16 v[168:171], a[136:139], a[4:7], 0
    v_mfma_f32_16x16x32_bf16 v[200:203], a[136:139], a[8:11], 0
    ds_read_b64_tr_b16 a[172:173], v11 offset:8192
    v_mfma_f32_16x16x32_bf16 v[232:235], a[136:139], a[12:15], 0
    ds_read_b64_tr_b16 a[174:175], v11 offset:12288
    s_waitcnt lgkmcnt(15)
    v_mfma_f32_16x16x32_bf16 v[140:143], a[140:143], a[0:3], 0
    v_mfma_f32_16x16x32_bf16 v[172:175], a[140:143], a[4:7], 0
    ds_read_b64_tr_b16 a[176:177], v12 offset:8192
    v_mfma_f32_16x16x32_bf16 v[204:207], a[140:143], a[8:11], 0
    ds_read_b64_tr_b16 a[178:179], v12 offset:12288
    v_mfma_f32_16x16x32_bf16 v[236:239], a[140:143], a[12:15], 0
    s_waitcnt lgkmcnt(15)
    v_mfma_f32_16x16x32_bf16 v[144:147], a[144:147], a[0:3], 0
    ds_read_b64_tr_b16 a[180:181], v13 offset:8192
    v_mfma_f32_16x16x32_bf16 v[176:179], a[144:147], a[4:7], 0
    ds_read_b64_tr_b16 a[182:183], v13 offset:12288
    v_mfma_f32_16x16x32_bf16 v[208:211], a[144:147], a[8:11], 0
    v_mfma_f32_16x16x32_bf16 v[240:243], a[144:147], a[12:15], 0
    ds_read_b64_tr_b16 a[184:185], v14 offset:8192
    s_waitcnt lgkmcnt(15)
    v_mfma_f32_16x16x32_bf16 v[148:151], a[148:151], a[0:3], 0
    ds_read_b64_tr_b16 a[186:187], v14 offset:12288
    s_mov_b64 exec, 1
    buffer_atomic_add v42, off, s[56:59], s93 sc1
    s_mov_b64 exec, -1
    v_mfma_f32_16x16x32_bf16 v[180:183], a[148:151], a[4:7], 0
    v_mfma_f32_16x16x32_bf16 v[212:215], a[148:151], a[8:11], 0
    ds_read_b64_tr_b16 a[188:189], v15 offset:8192
    v_mfma_f32_16x16x32_bf16 v[244:247], a[148:151], a[12:15], 0
    ds_read_b64_tr_b16 a[190:191], v15 offset:12288
    v_mfma_f32_16x16x32_bf16 v[152:155], a[152:155], a[0:3], 0
    v_mfma_f32_16x16x32_bf16 v[184:187], a[152:155], a[4:7], 0
    v_mfma_f32_16x16x32_bf16 v[216:219], a[152:155], a[8:11], 0
    v_mfma_f32_16x16x32_bf16 v[248:251], a[152:155], a[12:15], 0
    s_waitcnt lgkmcnt(15)
    v_mfma_f32_16x16x32_bf16 v[156:159], a[156:159], a[0:3], 0
    v_mfma_f32_16x16x32_bf16 v[188:191], a[156:159], a[4:7], 0
    v_mfma_f32_16x16x32_bf16 v[220:223], a[156:159], a[8:11], 0
    v_mfma_f32_16x16x32_bf16 v[252:255], a[156:159], a[12:15], 0
    s_waitcnt vmcnt(28) lgkmcnt(14)
    v_mfma_f32_16x16x32_bf16 v[128:131], a[160:163], a[16:19], v[128:131]
    buffer_load_dwordx4 a[0:3], v21, s[56:59], s68 offen sc1
    s_waitcnt vmcnt(28)
    v_mfma_f32_16x16x32_bf16 v[160:163], a[160:163], a[20:23], v[160:163]
    ds_read_b64_tr_b16 a[128:129], v8 offset:16384
    s_waitcnt vmcnt(27)
    v_mfma_f32_16x16x32_bf16 v[192:195], a[160:163], a[24:27], v[192:195]
    ds_read_b64_tr_b16 a[130:131], v8 offset:20480
    buffer_load_dwordx4 a[4:7], v22, s[56:59], s68 offen sc1
    s_waitcnt vmcnt(27)
    v_mfma_f32_16x16x32_bf16 v[224:227], a[160:163], a[28:31], v[224:227]
    s_waitcnt lgkmcnt(14)
    v_mfma_f32_16x16x32_bf16 v[132:135], a[164:167], a[16:19], v[132:135]
    ds_read_b64_tr_b16 a[132:133], v9 offset:16384
    buffer_load_dwordx4 a[8:11], v23, s[56:59], s68 offen sc1
    v_mfma_f32_16x16x32_bf16 v[164:167], a[164:167], a[20:23], v[164:167]
    ds_read_b64_tr_b16 a[134:135], v9 offset:20480
    v_mfma_f32_16x16x32_bf16 v[196:199], a[164:167], a[24:27], v[196:199]
    buffer_load_dwordx4 a[12:15], v24, s[56:59], s68 offen sc1
    v_mfma_f32_16x16x32_bf16 v[228:231], a[164:167], a[28:31], v[228:231]
    ds_read_b64_tr_b16 a[136:137], v10 offset:16384
    s_waitcnt lgkmcnt(15)
    v_mfma_f32_16x16x32_bf16 v[136:139], a[168:171], a[16:19], v[136:139]
    ds_read_b64_tr_b16 a[138:139], v10 offset:20480
    s_add_u32 s68, s68, 16384
    v_mfma_f32_16x16x32_bf16 v[168:171], a[168:171], a[20:23], v[168:171]
    v_mfma_f32_16x16x32_bf16 v[200:203], a[168:171], a[24:27], v[200:203]
    ds_read_b64_tr_b16 a[140:141], v11 offset:16384
    v_mfma_f32_16x16x32_bf16 v[232:235], a[168:171], a[28:31], v[232:235]
    ds_read_b64_tr_b16 a[142:143], v11 offset:20480
    s_waitcnt lgkmcnt(15)
    v_mfma_f32_16x16x32_bf16 v[140:143], a[172:175], a[16:19], v[140:143]
    v_mfma_f32_16x16x32_bf16 v[172:175], a[172:175], a[20:23], v[172:175]
    ds_read_b64_tr_b16 a[144:145], v12 offset:16384
    v_mfma_f32_16x16x32_bf16 v[204:207], a[172:175], a[24:27], v[204:207]
    ds_read_b64_tr_b16 a[146:147], v12 offset:20480
    v_mfma_f32_16x16x32_bf16 v[236:239], a[172:175], a[28:31], v[236:239]
    s_waitcnt lgkmcnt(15)
    v_mfma_f32_16x16x32_bf16 v[144:147], a[176:179], a[16:19], v[144:147]
    ds_read_b64_tr_b16 a[148:149], v13 offset:16384
    v_mfma_f32_16x16x32_bf16 v[176:179], a[176:179], a[20:23], v[176:179]
    ds_read_b64_tr_b16 a[150:151], v13 offset:20480
    v_mfma_f32_16x16x32_bf16 v[208:211], a[176:179], a[24:27], v[208:211]
    v_mfma_f32_16x16x32_bf16 v[240:243], a[176:179], a[28:31], v[240:243]
    ds_read_b64_tr_b16 a[152:153], v14 offset:16384
    s_waitcnt lgkmcnt(15)
    v_mfma_f32_16x16x32_bf16 v[148:151], a[180:183], a[16:19], v[148:151]
    ds_read_b64_tr_b16 a[154:155], v14 offset:20480
    v_mfma_f32_16x16x32_bf16 v[180:183], a[180:183], a[20:23], v[180:183]
    v_mfma_f32_16x16x32_bf16 v[212:215], a[180:183], a[24:27], v[212:215]
    ds_read_b64_tr_b16 a[156:157], v15 offset:16384
    v_mfma_f32_16x16x32_bf16 v[244:247], a[180:183], a[28:31], v[244:247]
    ds_read_b64_tr_b16 a[158:159], v15 offset:20480
    v_mfma_f32_16x16x32_bf16 v[152:155], a[184:187], a[16:19], v[152:155]
    v_mfma_f32_16x16x32_bf16 v[184:187], a[184:187], a[20:23], v[184:187]
    v_mfma_f32_16x16x32_bf16 v[216:219], a[184:187], a[24:27], v[216:219]
    v_mfma_f32_16x16x32_bf16 v[248:251], a[184:187], a[28:31], v[248:251]
    s_waitcnt lgkmcnt(15)
    v_mfma_f32_16x16x32_bf16 v[156:159], a[188:191], a[16:19], v[156:159]
    v_mfma_f32_16x16x32_bf16 v[188:191], a[188:191], a[20:23], v[188:191]
    v_mfma_f32_16x16x32_bf16 v[220:223], a[188:191], a[24:27], v[220:223]
    v_mfma_f32_16x16x32_bf16 v[252:255], a[188:191], a[28:31], v[252:255]
    s_waitcnt vmcnt(28) lgkmcnt(14)
    v_mfma_f32_16x16x32_bf16 v[128:131], a[128:131], a[32:35], v[128:131]
    buffer_load_dwordx4 a[16:19], v21, s[56:59], s68 offen sc1
    s_waitcnt vmcnt(28)
    v_mfma_f32_16x16x32_bf16 v[160:163], a[128:131], a[36:39], v[160:163]
    ds_read_b64_tr_b16 a[160:161], v8 offset:24576
    s_waitcnt vmcnt(27)
    v_mfma_f32_16x16x32_bf16 v[192:195], a[128:131], a[40:43], v[192:195]
    ds_read_b64_tr_b16 a[162:163], v8 offset:28672
    buffer_load_dwordx4 a[20:23], v22, s[56:59], s68 offen sc1
    s_waitcnt vmcnt(27)
    v_mfma_f32_16x16x32_bf16 v[224:227], a[128:131], a[44:47], v[224:227]
    s_waitcnt lgkmcnt(14)
    v_mfma_f32_16x16x32_bf16 v[132:135], a[132:135], a[32:35], v[132:135]
    ds_read_b64_tr_b16 a[164:165], v9 offset:24576
    buffer_load_dwordx4 a[24:27], v23, s[56:59], s68 offen sc1
    v_mfma_f32_16x16x32_bf16 v[164:167], a[132:135], a[36:39], v[164:167]
    ds_read_b64_tr_b16 a[166:167], v9 offset:28672
    v_mfma_f32_16x16x32_bf16 v[196:199], a[132:135], a[40:43], v[196:199]
    buffer_load_dwordx4 a[28:31], v24, s[56:59], s68 offen sc1
    v_mfma_f32_16x16x32_bf16 v[228:231], a[132:135], a[44:47], v[228:231]
    ds_read_b64_tr_b16 a[168:169], v10 offset:24576
    s_waitcnt lgkmcnt(15)
    v_mfma_f32_16x16x32_bf16 v[136:139], a[136:139], a[32:35], v[136:139]
    ds_read_b64_tr_b16 a[170:171], v10 offset:28672
    s_add_u32 s68, s68, 16384
    v_mfma_f32_16x16x32_bf16 v[168:171], a[136:139], a[36:39], v[168:171]
    v_mfma_f32_16x16x32_bf16 v[200:203], a[136:139], a[40:43], v[200:203]
    ds_read_b64_tr_b16 a[172:173], v11 offset:24576
    global_load_dwordx2 v[66:67], v1, s[8:9] offset:0
    v_mfma_f32_16x16x32_bf16 v[232:235], a[136:139], a[44:47], v[232:235]
    ds_read_b64_tr_b16 a[174:175], v11 offset:28672
    s_waitcnt lgkmcnt(15)
    v_mfma_f32_16x16x32_bf16 v[140:143], a[140:143], a[32:35], v[140:143]
    global_load_dwordx2 v[70:71], v1, s[8:9] offset:32
    v_mfma_f32_16x16x32_bf16 v[172:175], a[140:143], a[36:39], v[172:175]
    ds_read_b64_tr_b16 a[176:177], v12 offset:24576
    v_mfma_f32_16x16x32_bf16 v[204:207], a[140:143], a[40:43], v[204:207]
    ds_read_b64_tr_b16 a[178:179], v12 offset:28672
    global_load_dwordx2 v[74:75], v1, s[8:9] offset:64
    v_mfma_f32_16x16x32_bf16 v[236:239], a[140:143], a[44:47], v[236:239]
    s_waitcnt lgkmcnt(15)
    v_mfma_f32_16x16x32_bf16 v[144:147], a[144:147], a[32:35], v[144:147]
    ds_read_b64_tr_b16 a[180:181], v13 offset:24576
    global_load_dwordx2 v[78:79], v1, s[8:9] offset:96
    v_mfma_f32_16x16x32_bf16 v[176:179], a[144:147], a[36:39], v[176:179]
    ds_read_b64_tr_b16 a[182:183], v13 offset:28672
    v_mfma_f32_16x16x32_bf16 v[208:211], a[144:147], a[40:43], v[208:211]
    global_load_dwordx2 v[82:83], v1, s[8:9] offset:128
    v_mfma_f32_16x16x32_bf16 v[240:243], a[144:147], a[44:47], v[240:243]
    ds_read_b64_tr_b16 a[184:185], v14 offset:24576
    s_waitcnt lgkmcnt(15)
    v_mfma_f32_16x16x32_bf16 v[148:151], a[148:151], a[32:35], v[148:151]
    ds_read_b64_tr_b16 a[186:187], v14 offset:28672
    global_load_dwordx2 v[86:87], v1, s[8:9] offset:160
    v_mfma_f32_16x16x32_bf16 v[180:183], a[148:151], a[36:39], v[180:183]
    v_mfma_f32_16x16x32_bf16 v[212:215], a[148:151], a[40:43], v[212:215]
    ds_read_b64_tr_b16 a[188:189], v15 offset:24576
    global_load_dwordx2 v[90:91], v1, s[8:9] offset:192
    v_mfma_f32_16x16x32_bf16 v[244:247], a[148:151], a[44:47], v[244:247]
    ds_read_b64_tr_b16 a[190:191], v15 offset:28672
    v_mfma_f32_16x16x32_bf16 v[152:155], a[152:155], a[32:35], v[152:155]
    global_load_dwordx2 v[94:95], v1, s[8:9] offset:224
    v_mfma_f32_16x16x32_bf16 v[184:187], a[152:155], a[36:39], v[184:187]
    v_mfma_f32_16x16x32_bf16 v[216:219], a[152:155], a[40:43], v[216:219]
    v_mfma_f32_16x16x32_bf16 v[248:251], a[152:155], a[44:47], v[248:251]
    s_waitcnt lgkmcnt(15)
    v_mfma_f32_16x16x32_bf16 v[156:159], a[156:159], a[32:35], v[156:159]
    v_mfma_f32_16x16x32_bf16 v[188:191], a[156:159], a[36:39], v[188:191]
    v_mfma_f32_16x16x32_bf16 v[220:223], a[156:159], a[40:43], v[220:223]
    v_mfma_f32_16x16x32_bf16 v[252:255], a[156:159], a[44:47], v[252:255]
    s_waitcnt vmcnt(36) lgkmcnt(14)
    v_mfma_f32_16x16x32_bf16 v[128:131], a[160:163], a[48:51], v[128:131]
    buffer_load_dwordx4 a[32:35], v21, s[56:59], s68 offen sc1
    s_waitcnt vmcnt(36)
    v_mfma_f32_16x16x32_bf16 v[160:163], a[160:163], a[52:55], v[160:163]
    ds_read_b64_tr_b16 a[128:129], v8 offset:32768
    s_waitcnt vmcnt(35)
    v_mfma_f32_16x16x32_bf16 v[192:195], a[160:163], a[56:59], v[192:195]
    ds_read_b64_tr_b16 a[130:131], v8 offset:36864
    buffer_load_dwordx4 a[36:39], v22, s[56:59], s68 offen sc1
    s_waitcnt vmcnt(35)
    v_mfma_f32_16x16x32_bf16 v[224:227], a[160:163], a[60:63], v[224:227]
    s_waitcnt lgkmcnt(14)
    v_mfma_f32_16x16x32_bf16 v[132:135], a[164:167], a[48:51], v[132:135]
    ds_read_b64_tr_b16 a[132:133], v9 offset:32768
    buffer_load_dwordx4 a[40:43], v23, s[56:59], s68 offen sc1
    v_mfma_f32_16x16x32_bf16 v[164:167], a[164:167], a[52:55], v[164:167]
    ds_read_b64_tr_b16 a[134:135], v9 offset:36864
    v_mfma_f32_16x16x32_bf16 v[196:199], a[164:167], a[56:59], v[196:199]
    buffer_load_dwordx4 a[44:47], v24, s[56:59], s68 offen sc1
    v_mfma_f32_16x16x32_bf16 v[228:231], a[164:167], a[60:63], v[228:231]
    ds_read_b64_tr_b16 a[136:137], v10 offset:32768
    s_waitcnt lgkmcnt(15)
    v_mfma_f32_16x16x32_bf16 v[136:139], a[168:171], a[48:51], v[136:139]
    ds_read_b64_tr_b16 a[138:139], v10 offset:36864
    s_add_u32 s68, s68, 16384
    v_mfma_f32_16x16x32_bf16 v[168:171], a[168:171], a[52:55], v[168:171]
    v_mfma_f32_16x16x32_bf16 v[200:203], a[168:171], a[56:59], v[200:203]
    ds_read_b64_tr_b16 a[140:141], v11 offset:32768
    v_mfma_f32_16x16x32_bf16 v[232:235], a[168:171], a[60:63], v[232:235]
    ds_read_b64_tr_b16 a[142:143], v11 offset:36864
    s_waitcnt lgkmcnt(15)
    v_mfma_f32_16x16x32_bf16 v[140:143], a[172:175], a[48:51], v[140:143]
    v_mfma_f32_16x16x32_bf16 v[172:175], a[172:175], a[52:55], v[172:175]
    ds_read_b64_tr_b16 a[144:145], v12 offset:32768
    v_mfma_f32_16x16x32_bf16 v[204:207], a[172:175], a[56:59], v[204:207]
    ds_read_b64_tr_b16 a[146:147], v12 offset:36864
    v_mfma_f32_16x16x32_bf16 v[236:239], a[172:175], a[60:63], v[236:239]
    s_waitcnt lgkmcnt(15)
    v_mfma_f32_16x16x32_bf16 v[144:147], a[176:179], a[48:51], v[144:147]
    ds_read_b64_tr_b16 a[148:149], v13 offset:32768
    v_mfma_f32_16x16x32_bf16 v[176:179], a[176:179], a[52:55], v[176:179]
    ds_read_b64_tr_b16 a[150:151], v13 offset:36864
    v_mfma_f32_16x16x32_bf16 v[208:211], a[176:179], a[56:59], v[208:211]
    v_mfma_f32_16x16x32_bf16 v[240:243], a[176:179], a[60:63], v[240:243]
    ds_read_b64_tr_b16 a[152:153], v14 offset:32768
    s_waitcnt lgkmcnt(15)
    v_mfma_f32_16x16x32_bf16 v[148:151], a[180:183], a[48:51], v[148:151]
    ds_read_b64_tr_b16 a[154:155], v14 offset:36864
    v_mfma_f32_16x16x32_bf16 v[180:183], a[180:183], a[52:55], v[180:183]
    v_mfma_f32_16x16x32_bf16 v[212:215], a[180:183], a[56:59], v[212:215]
    ds_read_b64_tr_b16 a[156:157], v15 offset:32768
    v_mfma_f32_16x16x32_bf16 v[244:247], a[180:183], a[60:63], v[244:247]
    ds_read_b64_tr_b16 a[158:159], v15 offset:36864
    v_mfma_f32_16x16x32_bf16 v[152:155], a[184:187], a[48:51], v[152:155]
    v_mfma_f32_16x16x32_bf16 v[184:187], a[184:187], a[52:55], v[184:187]
    v_mfma_f32_16x16x32_bf16 v[216:219], a[184:187], a[56:59], v[216:219]
    v_mfma_f32_16x16x32_bf16 v[248:251], a[184:187], a[60:63], v[248:251]
    s_waitcnt lgkmcnt(15)
    v_mfma_f32_16x16x32_bf16 v[156:159], a[188:191], a[48:51], v[156:159]
    buffer_load_dword v43, off, s[56:59], s92 sc1
    v_mfma_f32_16x16x32_bf16 v[188:191], a[188:191], a[52:55], v[188:191]
    v_mfma_f32_16x16x32_bf16 v[220:223], a[188:191], a[56:59], v[220:223]
    v_mfma_f32_16x16x32_bf16 v[252:255], a[188:191], a[60:63], v[252:255]
    s_waitcnt vmcnt(37) lgkmcnt(14)
    v_mfma_f32_16x16x32_bf16 v[128:131], a[128:131], a[64:67], v[128:131]
    buffer_load_dwordx4 a[48:51], v21, s[56:59], s68 offen sc1
    s_waitcnt vmcnt(37)
    v_mfma_f32_16x16x32_bf16 v[160:163], a[128:131], a[68:71], v[160:163]
    ds_read_b64_tr_b16 a[160:161], v8 offset:40960
    s_waitcnt vmcnt(36)
    v_mfma_f32_16x16x32_bf16 v[192:195], a[128:131], a[72:75], v[192:195]
    ds_read_b64_tr_b16 a[162:163], v8 offset:45056
    buffer_load_dwordx4 a[52:55], v22, s[56:59], s68 offen sc1
    s_waitcnt vmcnt(36)
    v_mfma_f32_16x16x32_bf16 v[224:227], a[128:131], a[76:79], v[224:227]
    s_waitcnt lgkmcnt(14)
    v_mfma_f32_16x16x32_bf16 v[132:135], a[132:135], a[64:67], v[132:135]
    ds_read_b64_tr_b16 a[164:165], v9 offset:40960
    buffer_load_dwordx4 a[56:59], v23, s[56:59], s68 offen sc1
    v_mfma_f32_16x16x32_bf16 v[164:167], a[132:135], a[68:71], v[164:167]
    ds_read_b64_tr_b16 a[166:167], v9 offset:45056
    v_mfma_f32_16x16x32_bf16 v[196:199], a[132:135], a[72:75], v[196:199]
    buffer_load_dwordx4 a[60:63], v24, s[56:59], s68 offen sc1
    v_mfma_f32_16x16x32_bf16 v[228:231], a[132:135], a[76:79], v[228:231]
    ds_read_b64_tr_b16 a[168:169], v10 offset:40960
    s_waitcnt lgkmcnt(15)
    v_mfma_f32_16x16x32_bf16 v[136:139], a[136:139], a[64:67], v[136:139]
    ds_read_b64_tr_b16 a[170:171], v10 offset:45056
    s_add_u32 s68, s68, 16384
    v_mfma_f32_16x16x32_bf16 v[168:171], a[136:139], a[68:71], v[168:171]
    v_mfma_f32_16x16x32_bf16 v[200:203], a[136:139], a[72:75], v[200:203]
    ds_read_b64_tr_b16 a[172:173], v11 offset:40960
    v_mfma_f32_16x16x32_bf16 v[232:235], a[136:139], a[76:79], v[232:235]
    ds_read_b64_tr_b16 a[174:175], v11 offset:45056
    s_waitcnt lgkmcnt(15)
    v_mfma_f32_16x16x32_bf16 v[140:143], a[140:143], a[64:67], v[140:143]
    v_mfma_f32_16x16x32_bf16 v[172:175], a[140:143], a[68:71], v[172:175]
    ds_read_b64_tr_b16 a[176:177], v12 offset:40960
    v_mfma_f32_16x16x32_bf16 v[204:207], a[140:143], a[72:75], v[204:207]
    ds_read_b64_tr_b16 a[178:179], v12 offset:45056
    v_mfma_f32_16x16x32_bf16 v[236:239], a[140:143], a[76:79], v[236:239]
    s_waitcnt lgkmcnt(15)
    v_mfma_f32_16x16x32_bf16 v[144:147], a[144:147], a[64:67], v[144:147]
    ds_read_b64_tr_b16 a[180:181], v13 offset:40960
    v_mfma_f32_16x16x32_bf16 v[176:179], a[144:147], a[68:71], v[176:179]
    ds_read_b64_tr_b16 a[182:183], v13 offset:45056
    v_mfma_f32_16x16x32_bf16 v[208:211], a[144:147], a[72:75], v[208:211]
    v_mfma_f32_16x16x32_bf16 v[240:243], a[144:147], a[76:79], v[240:243]
    ds_read_b64_tr_b16 a[184:185], v14 offset:40960
    s_waitcnt lgkmcnt(15)
    v_mfma_f32_16x16x32_bf16 v[148:151], a[148:151], a[64:67], v[148:151]
    ds_read_b64_tr_b16 a[186:187], v14 offset:45056
    v_mfma_f32_16x16x32_bf16 v[180:183], a[148:151], a[68:71], v[180:183]
    v_mfma_f32_16x16x32_bf16 v[212:215], a[148:151], a[72:75], v[212:215]
    ds_read_b64_tr_b16 a[188:189], v15 offset:40960
    v_mfma_f32_16x16x32_bf16 v[244:247], a[148:151], a[76:79], v[244:247]
    ds_read_b64_tr_b16 a[190:191], v15 offset:45056
    v_mfma_f32_16x16x32_bf16 v[152:155], a[152:155], a[64:67], v[152:155]
    v_mfma_f32_16x16x32_bf16 v[184:187], a[152:155], a[68:71], v[184:187]
    v_mfma_f32_16x16x32_bf16 v[216:219], a[152:155], a[72:75], v[216:219]
    v_mfma_f32_16x16x32_bf16 v[248:251], a[152:155], a[76:79], v[248:251]
    s_waitcnt lgkmcnt(15)
    v_mfma_f32_16x16x32_bf16 v[156:159], a[156:159], a[64:67], v[156:159]
    v_mfma_f32_16x16x32_bf16 v[188:191], a[156:159], a[68:71], v[188:191]
    v_mfma_f32_16x16x32_bf16 v[220:223], a[156:159], a[72:75], v[220:223]
    v_mfma_f32_16x16x32_bf16 v[252:255], a[156:159], a[76:79], v[252:255]
    s_waitcnt vmcnt(37) lgkmcnt(14)
    v_mfma_f32_16x16x32_bf16 v[128:131], a[160:163], a[80:83], v[128:131]
    buffer_load_dwordx4 a[64:67], v21, s[56:59], s68 offen sc1
    s_waitcnt vmcnt(37)
    v_mfma_f32_16x16x32_bf16 v[160:163], a[160:163], a[84:87], v[160:163]
    ds_read_b64_tr_b16 a[128:129], v8 offset:49152
    s_waitcnt vmcnt(36)
    v_mfma_f32_16x16x32_bf16 v[192:195], a[160:163], a[88:91], v[192:195]
    ds_read_b64_tr_b16 a[130:131], v8 offset:53248
    buffer_load_dwordx4 a[68:71], v22, s[56:59], s68 offen sc1
    s_waitcnt vmcnt(36)
    v_mfma_f32_16x16x32_bf16 v[224:227], a[160:163], a[92:95], v[224:227]
    s_waitcnt lgkmcnt(14)
    v_mfma_f32_16x16x32_bf16 v[132:135], a[164:167], a[80:83], v[132:135]
    ds_read_b64_tr_b16 a[132:133], v9 offset:49152
    buffer_load_dwordx4 a[72:75], v23, s[56:59], s68 offen sc1
    v_mfma_f32_16x16x32_bf16 v[164:167], a[164:167], a[84:87], v[164:167]
    ds_read_b64_tr_b16 a[134:135], v9 offset:53248
    v_mfma_f32_16x16x32_bf16 v[196:199], a[164:167], a[88:91], v[196:199]
    buffer_load_dwordx4 a[76:79], v24, s[56:59], s68 offen sc1
    v_mfma_f32_16x16x32_bf16 v[228:231], a[164:167], a[92:95], v[228:231]
    ds_read_b64_tr_b16 a[136:137], v10 offset:49152
    s_waitcnt lgkmcnt(15)
    v_mfma_f32_16x16x32_bf16 v[136:139], a[168:171], a[80:83], v[136:139]
    ds_read_b64_tr_b16 a[138:139], v10 offset:53248
    s_add_u32 s68, s68, 16384
    v_mfma_f32_16x16x32_bf16 v[168:171], a[168:171], a[84:87], v[168:171]
    v_mfma_f32_16x16x32_bf16 v[200:203], a[168:171], a[88:91], v[200:203]
    ds_read_b64_tr_b16 a[140:141], v11 offset:49152
    v_mfma_f32_16x16x32_bf16 v[232:235], a[168:171], a[92:95], v[232:235]
    ds_read_b64_tr_b16 a[142:143], v11 offset:53248
    s_waitcnt lgkmcnt(15)
    v_mfma_f32_16x16x32_bf16 v[140:143], a[172:175], a[80:83], v[140:143]
    v_mfma_f32_16x16x32_bf16 v[172:175], a[172:175], a[84:87], v[172:175]
    ds_read_b64_tr_b16 a[144:145], v12 offset:49152
    v_mfma_f32_16x16x32_bf16 v[204:207], a[172:175], a[88:91], v[204:207]
    ds_read_b64_tr_b16 a[146:147], v12 offset:53248
    v_mfma_f32_16x16x32_bf16 v[236:239], a[172:175], a[92:95], v[236:239]
    s_waitcnt lgkmcnt(15)
    v_mfma_f32_16x16x32_bf16 v[144:147], a[176:179], a[80:83], v[144:147]
    ds_read_b64_tr_b16 a[148:149], v13 offset:49152
    v_mfma_f32_16x16x32_bf16 v[176:179], a[176:179], a[84:87], v[176:179]
    ds_read_b64_tr_b16 a[150:151], v13 offset:53248
    v_mfma_f32_16x16x32_bf16 v[208:211], a[176:179], a[88:91], v[208:211]
    v_mfma_f32_16x16x32_bf16 v[240:243], a[176:179], a[92:95], v[240:243]
    ds_read_b64_tr_b16 a[152:153], v14 offset:49152
    s_waitcnt lgkmcnt(15)
    v_mfma_f32_16x16x32_bf16 v[148:151], a[180:183], a[80:83], v[148:151]
    ds_read_b64_tr_b16 a[154:155], v14 offset:53248
    v_mfma_f32_16x16x32_bf16 v[180:183], a[180:183], a[84:87], v[180:183]
    v_mfma_f32_16x16x32_bf16 v[212:215], a[180:183], a[88:91], v[212:215]
    ds_read_b64_tr_b16 a[156:157], v15 offset:49152
    v_mfma_f32_16x16x32_bf16 v[244:247], a[180:183], a[92:95], v[244:247]
    ds_read_b64_tr_b16 a[158:159], v15 offset:53248
    v_mfma_f32_16x16x32_bf16 v[152:155], a[184:187], a[80:83], v[152:155]
    v_mfma_f32_16x16x32_bf16 v[184:187], a[184:187], a[84:87], v[184:187]
    v_mfma_f32_16x16x32_bf16 v[216:219], a[184:187], a[88:91], v[216:219]
    v_mfma_f32_16x16x32_bf16 v[248:251], a[184:187], a[92:95], v[248:251]
    s_waitcnt lgkmcnt(15)
    v_mfma_f32_16x16x32_bf16 v[156:159], a[188:191], a[80:83], v[156:159]
    v_mfma_f32_16x16x32_bf16 v[188:191], a[188:191], a[84:87], v[188:191]
    v_mfma_f32_16x16x32_bf16 v[220:223], a[188:191], a[88:91], v[220:223]
    v_mfma_f32_16x16x32_bf16 v[252:255], a[188:191], a[92:95], v[252:255]
    s_waitcnt vmcnt(37) lgkmcnt(14)
    v_mfma_f32_16x16x32_bf16 v[128:131], a[128:131], a[96:99], v[128:131]
    buffer_load_dwordx4 a[80:83], v21, s[56:59], s68 offen sc1
    s_waitcnt vmcnt(37)
    v_mfma_f32_16x16x32_bf16 v[160:163], a[128:131], a[100:103], v[160:163]
    ds_read_b64_tr_b16 a[160:161], v8 offset:57344
    s_waitcnt vmcnt(36)
    v_mfma_f32_16x16x32_bf16 v[192:195], a[128:131], a[104:107], v[192:195]
    ds_read_b64_tr_b16 a[162:163], v8 offset:61440
    buffer_load_dwordx4 a[84:87], v22, s[56:59], s68 offen sc1
    s_waitcnt vmcnt(36)
    v_mfma_f32_16x16x32_bf16 v[224:227], a[128:131], a[108:111], v[224:227]
    s_waitcnt lgkmcnt(14)
    v_mfma_f32_16x16x32_bf16 v[132:135], a[132:135], a[96:99], v[132:135]
    ds_read_b64_tr_b16 a[164:165], v9 offset:57344
    buffer_load_dwordx4 a[88:91], v23, s[56:59], s68 offen sc1
    v_mfma_f32_16x16x32_bf16 v[164:167], a[132:135], a[100:103], v[164:167]
    ds_read_b64_tr_b16 a[166:167], v9 offset:61440
    v_mfma_f32_16x16x32_bf16 v[196:199], a[132:135], a[104:107], v[196:199]
    buffer_load_dwordx4 a[92:95], v24, s[56:59], s68 offen sc1
    v_mfma_f32_16x16x32_bf16 v[228:231], a[132:135], a[108:111], v[228:231]
    ds_read_b64_tr_b16 a[168:169], v10 offset:57344
    s_waitcnt lgkmcnt(15)
    v_mfma_f32_16x16x32_bf16 v[136:139], a[136:139], a[96:99], v[136:139]
    ds_read_b64_tr_b16 a[170:171], v10 offset:61440
    s_add_u32 s68, s68, 16384
    v_mfma_f32_16x16x32_bf16 v[168:171], a[136:139], a[100:103], v[168:171]
    v_mfma_f32_16x16x32_bf16 v[200:203], a[136:139], a[104:107], v[200:203]
    ds_read_b64_tr_b16 a[172:173], v11 offset:57344
    v_mfma_f32_16x16x32_bf16 v[232:235], a[136:139], a[108:111], v[232:235]
    ds_read_b64_tr_b16 a[174:175], v11 offset:61440
    s_waitcnt lgkmcnt(15)
    v_mfma_f32_16x16x32_bf16 v[140:143], a[140:143], a[96:99], v[140:143]
    v_mfma_f32_16x16x32_bf16 v[172:175], a[140:143], a[100:103], v[172:175]
    ds_read_b64_tr_b16 a[176:177], v12 offset:57344
    v_mfma_f32_16x16x32_bf16 v[204:207], a[140:143], a[104:107], v[204:207]
    ds_read_b64_tr_b16 a[178:179], v12 offset:61440
    v_mfma_f32_16x16x32_bf16 v[236:239], a[140:143], a[108:111], v[236:239]
    s_waitcnt lgkmcnt(15)
    v_mfma_f32_16x16x32_bf16 v[144:147], a[144:147], a[96:99], v[144:147]
    ds_read_b64_tr_b16 a[180:181], v13 offset:57344
    v_mfma_f32_16x16x32_bf16 v[176:179], a[144:147], a[100:103], v[176:179]
    ds_read_b64_tr_b16 a[182:183], v13 offset:61440
    v_mfma_f32_16x16x32_bf16 v[208:211], a[144:147], a[104:107], v[208:211]
    v_mfma_f32_16x16x32_bf16 v[240:243], a[144:147], a[108:111], v[240:243]
    ds_read_b64_tr_b16 a[184:185], v14 offset:57344
    s_waitcnt lgkmcnt(15)
    v_mfma_f32_16x16x32_bf16 v[148:151], a[148:151], a[96:99], v[148:151]
    ds_read_b64_tr_b16 a[186:187], v14 offset:61440
    v_mfma_f32_16x16x32_bf16 v[180:183], a[148:151], a[100:103], v[180:183]
    v_mfma_f32_16x16x32_bf16 v[212:215], a[148:151], a[104:107], v[212:215]
    ds_read_b64_tr_b16 a[188:189], v15 offset:57344
    v_mfma_f32_16x16x32_bf16 v[244:247], a[148:151], a[108:111], v[244:247]
    ds_read_b64_tr_b16 a[190:191], v15 offset:61440
    v_mfma_f32_16x16x32_bf16 v[152:155], a[152:155], a[96:99], v[152:155]
    v_mfma_f32_16x16x32_bf16 v[184:187], a[152:155], a[100:103], v[184:187]
    v_mfma_f32_16x16x32_bf16 v[216:219], a[152:155], a[104:107], v[216:219]
    v_mfma_f32_16x16x32_bf16 v[248:251], a[152:155], a[108:111], v[248:251]
    s_waitcnt lgkmcnt(15)
    v_mfma_f32_16x16x32_bf16 v[156:159], a[156:159], a[96:99], v[156:159]
    v_mfma_f32_16x16x32_bf16 v[188:191], a[156:159], a[100:103], v[188:191]
    v_mfma_f32_16x16x32_bf16 v[220:223], a[156:159], a[104:107], v[220:223]
    v_mfma_f32_16x16x32_bf16 v[252:255], a[156:159], a[108:111], v[252:255]
    s_waitcnt vmcnt(37) lgkmcnt(14)
    v_mfma_f32_16x16x32_bf16 v[128:131], a[160:163], a[112:115], v[128:131]
    buffer_load_dwordx4 a[96:99], v21, s[56:59], s68 offen sc1
    s_waitcnt vmcnt(37)
    v_mfma_f32_16x16x32_bf16 v[160:163], a[160:163], a[116:119], v[160:163]
    ds_read_b64_tr_b16 a[128:129], v48 offset:0
    s_waitcnt vmcnt(36)
    v_mfma_f32_16x16x32_bf16 v[192:195], a[160:163], a[120:123], v[192:195]
    ds_read_b64_tr_b16 a[130:131], v48 offset:4096
    buffer_load_dwordx4 a[100:103], v22, s[56:59], s68 offen sc1
    s_waitcnt vmcnt(36)
    v_mfma_f32_16x16x32_bf16 v[224:227], a[160:163], a[124:127], v[224:227]
    s_waitcnt lgkmcnt(14)
    v_mfma_f32_16x16x32_bf16 v[132:135], a[164:167], a[112:115], v[132:135]
    ds_read_b64_tr_b16 a[132:133], v49 offset:0
    buffer_load_dwordx4 a[104:107], v23, s[56:59], s68 offen sc1
    v_mfma_f32_16x16x32_bf16 v[164:167], a[164:167], a[116:119], v[164:167]
    ds_read_b64_tr_b16 a[134:135], v49 offset:4096
    v_mfma_f32_16x16x32_bf16 v[196:199], a[164:167], a[120:123], v[196:199]
    buffer_load_dwordx4 a[108:111], v24, s[56:59], s68 offen sc1
    v_mfma_f32_16x16x32_bf16 v[228:231], a[164:167], a[124:127], v[228:231]
    ds_read_b64_tr_b16 a[136:137], v50 offset:0
    s_waitcnt lgkmcnt(15)
    v_mfma_f32_16x16x32_bf16 v[136:139], a[168:171], a[112:115], v[136:139]
    ds_read_b64_tr_b16 a[138:139], v50 offset:4096
    s_add_u32 s68, s68, 16384
    v_mfma_f32_16x16x32_bf16 v[168:171], a[168:171], a[116:119], v[168:171]
    v_mfma_f32_16x16x32_bf16 v[200:203], a[168:171], a[120:123], v[200:203]
    ds_read_b64_tr_b16 a[140:141], v51 offset:0
    v_mfma_f32_16x16x32_bf16 v[232:235], a[168:171], a[124:127], v[232:235]
    ds_read_b64_tr_b16 a[142:143], v51 offset:4096
    s_waitcnt lgkmcnt(15)
    v_mfma_f32_16x16x32_bf16 v[140:143], a[172:175], a[112:115], v[140:143]
    v_mfma_f32_16x16x32_bf16 v[172:175], a[172:175], a[116:119], v[172:175]
    ds_read_b64_tr_b16 a[144:145], v52 offset:0
    v_mfma_f32_16x16x32_bf16 v[204:207], a[172:175], a[120:123], v[204:207]
    ds_read_b64_tr_b16 a[146:147], v52 offset:4096
    v_mfma_f32_16x16x32_bf16 v[236:239], a[172:175], a[124:127], v[236:239]
    s_waitcnt lgkmcnt(15)
    v_mfma_f32_16x16x32_bf16 v[144:147], a[176:179], a[112:115], v[144:147]
    ds_read_b64_tr_b16 a[148:149], v53 offset:0
    v_mfma_f32_16x16x32_bf16 v[176:179], a[176:179], a[116:119], v[176:179]
    ds_read_b64_tr_b16 a[150:151], v53 offset:4096
    v_mfma_f32_16x16x32_bf16 v[208:211], a[176:179], a[120:123], v[208:211]
    v_mfma_f32_16x16x32_bf16 v[240:243], a[176:179], a[124:127], v[240:243]
    ds_read_b64_tr_b16 a[152:153], v54 offset:0
    s_waitcnt lgkmcnt(15)
    v_mfma_f32_16x16x32_bf16 v[148:151], a[180:183], a[112:115], v[148:151]
    ds_read_b64_tr_b16 a[154:155], v54 offset:4096
    v_mfma_f32_16x16x32_bf16 v[180:183], a[180:183], a[116:119], v[180:183]
    v_mfma_f32_16x16x32_bf16 v[212:215], a[180:183], a[120:123], v[212:215]
    ds_read_b64_tr_b16 a[156:157], v55 offset:0
    v_mfma_f32_16x16x32_bf16 v[244:247], a[180:183], a[124:127], v[244:247]
    ds_read_b64_tr_b16 a[158:159], v55 offset:4096
    v_mfma_f32_16x16x32_bf16 v[152:155], a[184:187], a[112:115], v[152:155]
    v_mfma_f32_16x16x32_bf16 v[184:187], a[184:187], a[116:119], v[184:187]
    v_mfma_f32_16x16x32_bf16 v[216:219], a[184:187], a[120:123], v[216:219]
    v_mfma_f32_16x16x32_bf16 v[248:251], a[184:187], a[124:127], v[248:251]
    s_waitcnt lgkmcnt(15)
    v_mfma_f32_16x16x32_bf16 v[156:159], a[188:191], a[112:115], v[156:159]
    v_mfma_f32_16x16x32_bf16 v[188:191], a[188:191], a[116:119], v[188:191]
    v_mfma_f32_16x16x32_bf16 v[220:223], a[188:191], a[120:123], v[220:223]
    v_mfma_f32_16x16x32_bf16 v[252:255], a[188:191], a[124:127], v[252:255]
    s_barrier
    s_waitcnt vmcnt(36) lgkmcnt(14)
    v_mfma_f32_16x16x32_bf16 v[128:131], a[128:131], a[0:3], v[128:131]
    buffer_load_dwordx4 a[112:115], v21, s[56:59], s68 offen sc1
    s_waitcnt vmcnt(36)
    v_mfma_f32_16x16x32_bf16 v[160:163], a[128:131], a[4:7], v[160:163]
    ds_read_b64_tr_b16 a[160:161], v48 offset:8192
    s_waitcnt vmcnt(35)
    v_mfma_f32_16x16x32_bf16 v[192:195], a[128:131], a[8:11], v[192:195]
    ds_read_b64_tr_b16 a[162:163], v48 offset:12288
    buffer_load_dwordx4 a[116:119], v22, s[56:59], s68 offen sc1
    s_waitcnt vmcnt(35)
    v_mfma_f32_16x16x32_bf16 v[224:227], a[128:131], a[12:15], v[224:227]
    s_waitcnt lgkmcnt(14)
    v_mfma_f32_16x16x32_bf16 v[132:135], a[132:135], a[0:3], v[132:135]
    ds_read_b64_tr_b16 a[164:165], v49 offset:8192
    buffer_load_dwordx4 a[120:123], v23, s[56:59], s68 offen sc1
    v_mfma_f32_16x16x32_bf16 v[164:167], a[132:135], a[4:7], v[164:167]
    ds_read_b64_tr_b16 a[166:167], v49 offset:12288
    v_mfma_f32_16x16x32_bf16 v[196:199], a[132:135], a[8:11], v[196:199]
    buffer_load_dwordx4 a[124:127], v24, s[56:59], s68 offen sc1
    v_mfma_f32_16x16x32_bf16 v[228:231], a[132:135], a[12:15], v[228:231]
    ds_read_b64_tr_b16 a[168:169], v50 offset:8192
    s_waitcnt lgkmcnt(15)
    v_mfma_f32_16x16x32_bf16 v[136:139], a[136:139], a[0:3], v[136:139]
    ds_read_b64_tr_b16 a[170:171], v50 offset:12288
    s_add_u32 s68, s68, 16384
    v_mfma_f32_16x16x32_bf16 v[168:171], a[136:139], a[4:7], v[168:171]
    v_mfma_f32_16x16x32_bf16 v[200:203], a[136:139], a[8:11], v[200:203]
    ds_read_b64_tr_b16 a[172:173], v51 offset:8192
    v_mfma_f32_16x16x32_bf16 v[232:235], a[136:139], a[12:15], v[232:235]
    ds_read_b64_tr_b16 a[174:175], v51 offset:12288
    s_mov_b32 s82, 1048576
    s_add_u32 m0, s3, 0
    s_waitcnt lgkmcnt(15)
    v_mfma_f32_16x16x32_bf16 v[140:143], a[140:143], a[0:3], v[140:143]
    buffer_load_dwordx4 v17, s[48:51], s82 offen lds
    v_mfma_f32_16x16x32_bf16 v[172:175], a[140:143], a[4:7], v[172:175]
    ds_read_b64_tr_b16 a[176:177], v52 offset:8192
    v_mfma_f32_16x16x32_bf16 v[204:207], a[140:143], a[8:11], v[204:207]
    ds_read_b64_tr_b16 a[178:179], v52 offset:12288
    v_mfma_f32_16x16x32_bf16 v[236:239], a[140:143], a[12:15], v[236:239]
    s_waitcnt lgkmcnt(15)
    v_mfma_f32_16x16x32_bf16 v[144:147], a[144:147], a[0:3], v[144:147]
    ds_read_b64_tr_b16 a[180:181], v53 offset:8192
    buffer_load_dwordx4 v18, s[48:51], s82 offen offset:1024 lds
    v_mfma_f32_16x16x32_bf16 v[176:179], a[144:147], a[4:7], v[176:179]
    ds_read_b64_tr_b16 a[182:183], v53 offset:12288
    v_mfma_f32_16x16x32_bf16 v[208:211], a[144:147], a[8:11], v[208:211]
    v_mfma_f32_16x16x32_bf16 v[240:243], a[144:147], a[12:15], v[240:243]
    ds_read_b64_tr_b16 a[184:185], v54 offset:8192
    s_waitcnt lgkmcnt(15)
    v_mfma_f32_16x16x32_bf16 v[148:151], a[148:151], a[0:3], v[148:151]
    ds_read_b64_tr_b16 a[186:187], v54 offset:12288
    v_mfma_f32_16x16x32_bf16 v[180:183], a[148:151], a[4:7], v[180:183]
    s_mov_b32 s83, 1277952
    s_add_u32 m0, s3, 8192
    v_mfma_f32_16x16x32_bf16 v[212:215], a[148:151], a[8:11], v[212:215]
    ds_read_b64_tr_b16 a[188:189], v55 offset:8192
    buffer_load_dwordx4 v17, s[48:51], s83 offen lds
    v_mfma_f32_16x16x32_bf16 v[244:247], a[148:151], a[12:15], v[244:247]
    ds_read_b64_tr_b16 a[190:191], v55 offset:12288
    v_mfma_f32_16x16x32_bf16 v[152:155], a[152:155], a[0:3], v[152:155]
    v_mfma_f32_16x16x32_bf16 v[184:187], a[152:155], a[4:7], v[184:187]
    v_mfma_f32_16x16x32_bf16 v[216:219], a[152:155], a[8:11], v[216:219]
    buffer_load_dwordx4 v18, s[48:51], s83 offen offset:1024 lds
    v_mfma_f32_16x16x32_bf16 v[248:251], a[152:155], a[12:15], v[248:251]
    s_waitcnt lgkmcnt(15)
    v_mfma_f32_16x16x32_bf16 v[156:159], a[156:159], a[0:3], v[156:159]
    v_mfma_f32_16x16x32_bf16 v[188:191], a[156:159], a[4:7], v[188:191]
    v_mfma_f32_16x16x32_bf16 v[220:223], a[156:159], a[8:11], v[220:223]
    v_mfma_f32_16x16x32_bf16 v[252:255], a[156:159], a[12:15], v[252:255]
    s_waitcnt vmcnt(40) lgkmcnt(14)
    v_mfma_f32_16x16x32_bf16 v[128:131], a[160:163], a[16:19], v[128:131]
    s_waitcnt vmcnt(24)
    v_readfirstlane_b32 s86, v43
    s_bfe_u32 s86, s86, 0x80008
    s_cmp_eq_u32 s86, 16
    s_cbranch_scc0 L_spB
L_okB:
    buffer_load_dwordx4 a[0:3], v21, s[56:59], s68 offen sc1
    v_mfma_f32_16x16x32_bf16 v[160:163], a[160:163], a[20:23], v[160:163]
    ds_read_b64_tr_b16 a[128:129], v48 offset:16384
    v_mfma_f32_16x16x32_bf16 v[192:195], a[160:163], a[24:27], v[192:195]
    ds_read_b64_tr_b16 a[130:131], v48 offset:20480
    buffer_load_dwordx4 a[4:7], v22, s[56:59], s68 offen sc1
    v_mfma_f32_16x16x32_bf16 v[224:227], a[160:163], a[28:31], v[224:227]
    s_waitcnt lgkmcnt(14)
    v_mfma_f32_16x16x32_bf16 v[132:135], a[164:167], a[16:19], v[132:135]
    ds_read_b64_tr_b16 a[132:133], v49 offset:16384
    buffer_load_dwordx4 a[8:11], v23, s[56:59], s68 offen sc1
    v_mfma_f32_16x16x32_bf16 v[164:167], a[164:167], a[20:23], v[164:167]
    ds_read_b64_tr_b16 a[134:135], v49 offset:20480
    v_mfma_f32_16x16x32_bf16 v[196:199], a[164:167], a[24:27], v[196:199]
    buffer_load_dwordx4 a[12:15], v24, s[56:59], s68 offen sc1
    v_mfma_f32_16x16x32_bf16 v[228:231], a[164:167], a[28:31], v[228:231]
    ds_read_b64_tr_b16 a[136:137], v50 offset:16384
    s_waitcnt lgkmcnt(15)
    v_mfma_f32_16x16x32_bf16 v[136:139], a[168:171], a[16:19], v[136:139]
    ds_read_b64_tr_b16 a[138:139], v50 offset:20480
    s_add_u32 s68, s68, 16384
    v_mfma_f32_16x16x32_bf16 v[168:171], a[168:171], a[20:23], v[168:171]
    v_mfma_f32_16x16x32_bf16 v[200:203], a[168:171], a[24:27], v[200:203]
    ds_read_b64_tr_b16 a[140:141], v51 offset:16384
    v_mfma_f32_16x16x32_bf16 v[232:235], a[168:171], a[28:31], v[232:235]
    ds_read_b64_tr_b16 a[142:143], v51 offset:20480
    s_mov_b32 s82, 1507328
    s_add_u32 m0, s3, 16384
    s_waitcnt lgkmcnt(15)
    v_mfma_f32_16x16x32_bf16 v[140:143], a[172:175], a[16:19], v[140:143]
    buffer_load_dwordx4 v17, s[48:51], s82 offen lds
    v_mfma_f32_16x16x32_bf16 v[172:175], a[172:175], a[20:23], v[172:175]
    ds_read_b64_tr_b16 a[144:145], v52 offset:16384
    v_mfma_f32_16x16x32_bf16 v[204:207], a[172:175], a[24:27], v[204:207]
    ds_read_b64_tr_b16 a[146:147], v52 offset:20480
    v_mfma_f32_16x16x32_bf16 v[236:239], a[172:175], a[28:31], v[236:239]
    s_waitcnt lgkmcnt(15)
    v_mfma_f32_16x16x32_bf16 v[144:147], a[176:179], a[16:19], v[144:147]
    ds_read_b64_tr_b16 a[148:149], v53 offset:16384
    buffer_load_dwordx4 v18, s[48:51], s82 offen offset:1024 lds
    v_mfma_f32_16x16x32_bf16 v[176:179], a[176:179], a[20:23], v[176:179]
    ds_read_b64_tr_b16 a[150:151], v53 offset:20480
    v_mfma_f32_16x16x32_bf16 v[208:211], a[176:179], a[24:27], v[208:211]
    v_mfma_f32_16x16x32_bf16 v[240:243], a[176:179], a[28:31], v[240:243]
    ds_read_b64_tr_b16 a[152:153], v54 offset:16384
    s_waitcnt lgkmcnt(15)
    v_mfma_f32_16x16x32_bf16 v[148:151], a[180:183], a[16:19], v[148:151]
    ds_read_b64_tr_b16 a[154:155], v54 offset:20480
    v_mfma_f32_16x16x32_bf16 v[180:183], a[180:183], a[20:23], v[180:183]
    s_mov_b32 s83, 1736704
    s_add_u32 m0, s3, 24576
    v_mfma_f32_16x16x32_bf16 v[212:215], a[180:183], a[24:27], v[212:215]
    ds_read_b64_tr_b16 a[156:157], v55 offset:16384
    buffer_load_dwordx4 v17, s[48:51], s83 offen lds
    v_mfma_f32_16x16x32_bf16 v[244:247], a[180:183], a[28:31], v[244:247]
    ds_read_b64_tr_b16 a[158:159], v55 offset:20480
    v_mfma_f32_16x16x32_bf16 v[152:155], a[184:187], a[16:19], v[152:155]
    v_mfma_f32_16x16x32_bf16 v[184:187], a[184:187], a[20:23], v[184:187]
    v_mfma_f32_16x16x32_bf16 v[216:219], a[184:187], a[24:27], v[216:219]
    buffer_load_dwordx4 v18, s[48:51], s83 offen offset:1024 lds
    v_mfma_f32_16x16x32_bf16 v[248:251], a[184:187], a[28:31], v[248:251]
    s_waitcnt lgkmcnt(15)
    v_mfma_f32_16x16x32_bf16 v[156:159], a[188:191], a[16:19], v[156:159]
    v_mfma_f32_16x16x32_bf16 v[188:191], a[188:191], a[20:23], v[188:191]
    v_mfma_f32_16x16x32_bf16 v[220:223], a[188:191], a[24:27], v[220:223]
    v_mfma_f32_16x16x32_bf16 v[252:255], a[188:191], a[28:31], v[252:255]
    s_waitcnt lgkmcnt(14)
    v_mfma_f32_16x16x32_bf16 v[128:131], a[128:131], a[32:35], v[128:131]
    buffer_load_dwordx4 a[16:19], v21, s[56:59], s68 offen sc1
    v_mfma_f32_16x16x32_bf16 v[160:163], a[128:131], a[36:39], v[160:163]
    ds_read_b64_tr_b16 a[160:161], v48 offset:24576
    v_mfma_f32_16x16x32_bf16 v[192:195], a[128:131], a[40:43], v[192:195]
    ds_read_b64_tr_b16 a[162:163], v48 offset:28672
    buffer_load_dwordx4 a[20:23], v22, s[56:59], s68 offen sc1
    v_mfma_f32_16x16x32_bf16 v[224:227], a[128:131], a[44:47], v[224:227]
    s_waitcnt lgkmcnt(14)
    v_mfma_f32_16x16x32_bf16 v[132:135], a[132:135], a[32:35], v[132:135]
    ds_read_b64_tr_b16 a[164:165], v49 offset:24576
    buffer_load_dwordx4 a[24:27], v23, s[56:59], s68 offen sc1
    v_mfma_f32_16x16x32_bf16 v[164:167], a[132:135], a[36:39], v[164:167]
    ds_read_b64_tr_b16 a[166:167], v49 offset:28672
    v_mfma_f32_16x16x32_bf16 v[196:199], a[132:135], a[40:43], v[196:199]
    buffer_load_dwordx4 a[28:31], v24, s[56:59], s68 offen sc1
    v_mfma_f32_16x16x32_bf16 v[228:231], a[132:135], a[44:47], v[228:231]
    ds_read_b64_tr_b16 a[168:169], v50 offset:24576
    s_waitcnt lgkmcnt(15)
    v_mfma_f32_16x16x32_bf16 v[136:139], a[136:139], a[32:35], v[136:139]
    ds_read_b64_tr_b16 a[170:171], v50 offset:28672
    s_add_u32 s68, s68, 16384
    v_mfma_f32_16x16x32_bf16 v[168:171], a[136:139], a[36:39], v[168:171]
    v_mfma_f32_16x16x32_bf16 v[200:203], a[136:139], a[40:43], v[200:203]
    ds_read_b64_tr_b16 a[172:173], v51 offset:24576
    v_mfma_f32_16x16x32_bf16 v[232:235], a[136:139], a[44:47], v[232:235]
    ds_read_b64_tr_b16 a[174:175], v51 offset:28672
    s_mov_b32 s82, 196608
    s_add_u32 m0, s3, 32768
    s_waitcnt lgkmcnt(15)
    v_mfma_f32_16x16x32_bf16 v[140:143], a[140:143], a[32:35], v[140:143]
    buffer_load_dwordx4 v19, s[48:51], s82 offen lds
    v_mfma_f32_16x16x32_bf16 v[172:175], a[140:143], a[36:39], v[172:175]
    ds_read_b64_tr_b16 a[176:177], v52 offset:24576
    v_mfma_f32_16x16x32_bf16 v[204:207], a[140:143], a[40:43], v[204:207]
    ds_read_b64_tr_b16 a[178:179], v52 offset:28672
    v_mfma_f32_16x16x32_bf16 v[236:239], a[140:143], a[44:47], v[236:239]
    s_waitcnt lgkmcnt(15)
    v_mfma_f32_16x16x32_bf16 v[144:147], a[144:147], a[32:35], v[144:147]
    ds_read_b64_tr_b16 a[180:181], v53 offset:24576
    buffer_load_dwordx4 v20, s[48:51], s82 offen offset:1024 lds
    v_mfma_f32_16x16x32_bf16 v[176:179], a[144:147], a[36:39], v[176:179]
    ds_read_b64_tr_b16 a[182:183], v53 offset:28672
    v_mfma_f32_16x16x32_bf16 v[208:211], a[144:147], a[40:43], v[208:211]
    v_mfma_f32_16x16x32_bf16 v[240:243], a[144:147], a[44:47], v[240:243]
    ds_read_b64_tr_b16 a[184:185], v54 offset:24576
    s_waitcnt lgkmcnt(15)
    v_mfma_f32_16x16x32_bf16 v[148:151], a[148:151], a[32:35], v[148:151]
    ds_read_b64_tr_b16 a[186:187], v54 offset:28672
    v_mfma_f32_16x16x32_bf16 v[180:183], a[148:151], a[36:39], v[180:183]
    s_mov_b32 s83, 655360
    s_add_u32 m0, s3, 40960
    v_mfma_f32_16x16x32_bf16 v[212:215], a[148:151], a[40:43], v[212:215]
    ds_read_b64_tr_b16 a[188:189], v55 offset:24576
    buffer_load_dwordx4 v19, s[48:51], s83 offen lds
    v_mfma_f32_16x16x32_bf16 v[244:247], a[148:151], a[44:47], v[244:247]
    ds_read_b64_tr_b16 a[190:191], v55 offset:28672
    v_mfma_f32_16x16x32_bf16 v[152:155], a[152:155], a[32:35], v[152:155]
    v_mfma_f32_16x16x32_bf16 v[184:187], a[152:155], a[36:39], v[184:187]
    v_mfma_f32_16x16x32_bf16 v[216:219], a[152:155], a[40:43], v[216:219]
    buffer_load_dwordx4 v20, s[48:51], s83 offen offset:1024 lds
    v_mfma_f32_16x16x32_bf16 v[248:251], a[152:155], a[44:47], v[248:251]
    s_waitcnt lgkmcnt(15)
    v_mfma_f32_16x16x32_bf16 v[156:159], a[156:159], a[32:35], v[156:159]
    buffer_load_dword v43, off, s[56:59], s92 sc1
    v_mfma_f32_16x16x32_bf16 v[188:191], a[156:159], a[36:39], v[188:191]
    v_mfma_f32_16x16x32_bf16 v[220:223], a[156:159], a[40:43], v[220:223]
    v_mfma_f32_16x16x32_bf16 v[252:255], a[156:159], a[44:47], v[252:255]
    s_waitcnt vmcnt(40) lgkmcnt(14)
    v_mfma_f32_16x16x32_bf16 v[128:131], a[160:163], a[48:51], v[128:131]
    buffer_load_dwordx4 a[32:35], v21, s[56:59], s68 offen sc1
    s_waitcnt vmcnt(40)
    v_mfma_f32_16x16x32_bf16 v[160:163], a[160:163], a[52:55], v[160:163]
    ds_read_b64_tr_b16 a[128:129], v48 offset:32768
    s_waitcnt vmcnt(39)
    v_mfma_f32_16x16x32_bf16 v[192:195], a[160:163], a[56:59], v[192:195]
    ds_read_b64_tr_b16 a[130:131], v48 offset:36864
    buffer_load_dwordx4 a[36:39], v22, s[56:59], s68 offen sc1
    s_waitcnt vmcnt(39)
    v_mfma_f32_16x16x32_bf16 v[224:227], a[160:163], a[60:63], v[224:227]
    s_waitcnt lgkmcnt(14)
    v_mfma_f32_16x16x32_bf16 v[132:135], a[164:167], a[48:51], v[132:135]
    ds_read_b64_tr_b16 a[132:133], v49 offset:32768
    buffer_load_dwordx4 a[40:43], v23, s[56:59], s68 offen sc1
    v_mfma_f32_16x16x32_bf16 v[164:167], a[164:167], a[52:55], v[164:167]
    ds_read_b64_tr_b16 a[134:135], v49 offset:36864
    v_mfma_f32_16x16x32_bf16 v[196:199], a[164:167], a[56:59], v[196:199]
    buffer_load_dwordx4 a[44:47], v24, s[56:59], s68 offen sc1
    v_mfma_f32_16x16x32_bf16 v[228:231], a[164:167], a[60:63], v[228:231]
    ds_read_b64_tr_b16 a[136:137], v50 offset:32768
    s_waitcnt lgkmcnt(15)
    v_mfma_f32_16x16x32_bf16 v[136:139], a[168:171], a[48:51], v[136:139]
    ds_read_b64_tr_b16 a[138:139], v50 offset:36864
    s_add_u32 s68, s68, 16384
    v_mfma_f32_16x16x32_bf16 v[168:171], a[168:171], a[52:55], v[168:171]
    v_mfma_f32_16x16x32_bf16 v[200:203], a[168:171], a[56:59], v[200:203]
    ds_read_b64_tr_b16 a[140:141], v51 offset:32768
    v_mfma_f32_16x16x32_bf16 v[232:235], a[168:171], a[60:63], v[232:235]
    ds_read_b64_tr_b16 a[142:143], v51 offset:36864
    s_mov_b32 s82, 1114112
    s_add_u32 m0, s3, 49152
    s_waitcnt lgkmcnt(15)
    v_mfma_f32_16x16x32_bf16 v[140:143], a[172:175], a[48:51], v[140:143]
    buffer_load_dwordx4 v19, s[48:51], s82 offen lds
    v_mfma_f32_16x16x32_bf16 v[172:175], a[172:175], a[52:55], v[172:175]
    ds_read_b64_tr_b16 a[144:145], v52 offset:32768
    v_mfma_f32_16x16x32_bf16 v[204:207], a[172:175], a[56:59], v[204:207]
    ds_read_b64_tr_b16 a[146:147], v52 offset:36864
    v_mfma_f32_16x16x32_bf16 v[236:239], a[172:175], a[60:63], v[236:239]
    s_waitcnt lgkmcnt(15)
    v_mfma_f32_16x16x32_bf16 v[144:147], a[176:179], a[48:51], v[144:147]
    ds_read_b64_tr_b16 a[148:149], v53 offset:32768
    buffer_load_dwordx4 v20, s[48:51], s82 offen offset:1024 lds
    v_mfma_f32_16x16x32_bf16 v[176:179], a[176:179], a[52:55], v[176:179]
    ds_read_b64_tr_b16 a[150:151], v53 offset:36864
    v_mfma_f32_16x16x32_bf16 v[208:211], a[176:179], a[56:59], v[208:211]
    v_mfma_f32_16x16x32_bf16 v[240:243], a[176:179], a[60:63], v[240:243]
    ds_read_b64_tr_b16 a[152:153], v54 offset:32768
    s_waitcnt lgkmcnt(15)
    v_mfma_f32_16x16x32_bf16 v[148:151], a[180:183], a[48:51], v[148:151]
    ds_read_b64_tr_b16 a[154:155], v54 offset:36864
    v_mfma_f32_16x16x32_bf16 v[180:183], a[180:183], a[52:55], v[180:183]
    s_mov_b32 s83, 1572864
    s_add_u32 m0, s3, 57344
    v_mfma_f32_16x16x32_bf16 v[212:215], a[180:183], a[56:59], v[212:215]
    ds_read_b64_tr_b16 a[156:157], v55 offset:32768
    buffer_load_dwordx4 v19, s[48:51], s83 offen lds
    v_mfma_f32_16x16x32_bf16 v[244:247], a[180:183], a[60:63], v[244:247]
    ds_read_b64_tr_b16 a[158:159], v55 offset:36864
    v_mfma_f32_16x16x32_bf16 v[152:155], a[184:187], a[48:51], v[152:155]
    v_mfma_f32_16x16x32_bf16 v[184:187], a[184:187], a[52:55], v[184:187]
    v_mfma_f32_16x16x32_bf16 v[216:219], a[184:187], a[56:59], v[216:219]
    buffer_load_dwordx4 v20, s[48:51], s83 offen offset:1024 lds
    v_mfma_f32_16x16x32_bf16 v[248:251], a[184:187], a[60:63], v[248:251]
    s_waitcnt lgkmcnt(15)
    v_mfma_f32_16x16x32_bf16 v[156:159], a[188:191], a[48:51], v[156:159]
    v_mfma_f32_16x16x32_bf16 v[188:191], a[188:191], a[52:55], v[188:191]
    v_mfma_f32_16x16x32_bf16 v[220:223], a[188:191], a[56:59], v[220:223]
    v_mfma_f32_16x16x32_bf16 v[252:255], a[188:191], a[60:63], v[252:255]
    s_waitcnt vmcnt(44) lgkmcnt(14)
    v_mfma_f32_16x16x32_bf16 v[128:131], a[128:131], a[64:67], v[128:131]
    buffer_load_dwordx4 a[48:51], v21, s[56:59], s68 offen sc1
    s_waitcnt vmcnt(44)
    v_mfma_f32_16x16x32_bf16 v[160:163], a[128:131], a[68:71], v[160:163]
    ds_read_b64_tr_b16 a[160:161], v48 offset:40960
    s_waitcnt vmcnt(43)
    v_mfma_f32_16x16x32_bf16 v[192:195], a[128:131], a[72:75], v[192:195]
    ds_read_b64_tr_b16 a[162:163], v48 offset:45056
    buffer_load_dwordx4 a[52:55], v22, s[56:59], s68 offen sc1
    s_waitcnt vmcnt(43)
    v_mfma_f32_16x16x32_bf16 v[224:227], a[128:131], a[76:79], v[224:227]
    s_waitcnt lgkmcnt(14)
    v_mfma_f32_16x16x32_bf16 v[132:135], a[132:135], a[64:67], v[132:135]
    ds_read_b64_tr_b16 a[164:165], v49 offset:40960
    buffer_load_dwordx4 a[56:59], v23, s[56:59], s68 offen sc1
    v_mfma_f32_16x16x32_bf16 v[164:167], a[132:135], a[68:71], v[164:167]
    ds_read_b64_tr_b16 a[166:167], v49 offset:45056
    v_mfma_f32_16x16x32_bf16 v[196:199], a[132:135], a[72:75], v[196:199]
    buffer_load_dwordx4 a[60:63], v24, s[56:59], s68 offen sc1
    v_mfma_f32_16x16x32_bf16 v[228:231], a[132:135], a[76:79], v[228:231]
    ds_read_b64_tr_b16 a[168:169], v50 offset:40960
    s_waitcnt lgkmcnt(15)
    v_mfma_f32_16x16x32_bf16 v[136:139], a[136:139], a[64:67], v[136:139]
    ds_read_b64_tr_b16 a[170:171], v50 offset:45056
    s_add_u32 s68, s68, 16384
    v_mfma_f32_16x16x32_bf16 v[168:171], a[136:139], a[68:71], v[168:171]
    v_mfma_f32_16x16x32_bf16 v[200:203], a[136:139], a[72:75], v[200:203]
    ds_read_b64_tr_b16 a[172:173], v51 offset:40960
    v_lshlrev_b32 v64, 16, v66
    v_mfma_f32_16x16x32_bf16 v[232:235], a[136:139], a[76:79], v[232:235]
    ds_read_b64_tr_b16 a[174:175], v51 offset:45056
    v_and_b32 v65, 0xffff0000, v66
    s_waitcnt lgkmcnt(15)
    v_mfma_f32_16x16x32_bf16 v[140:143], a[140:143], a[64:67], v[140:143]
    v_lshlrev_b32 v66, 16, v67
    v_mfma_f32_16x16x32_bf16 v[172:175], a[140:143], a[68:71], v[172:175]
    ds_read_b64_tr_b16 a[176:177], v52 offset:40960
    v_and_b32 v67, 0xffff0000, v67
    v_mfma_f32_16x16x32_bf16 v[204:207], a[140:143], a[72:75], v[204:207]
    ds_read_b64_tr_b16 a[178:179], v52 offset:45056
    v_lshlrev_b32 v68, 16, v70
    v_mfma_f32_16x16x32_bf16 v[236:239], a[140:143], a[76:79], v[236:239]
    v_and_b32 v69, 0xffff0000, v70
    s_waitcnt lgkmcnt(15)
    v_mfma_f32_16x16x32_bf16 v[144:147], a[144:147], a[64:67], v[144:147]
    ds_read_b64_tr_b16 a[180:181], v53 offset:40960
    v_lshlrev_b32 v70, 16, v71
    v_mfma_f32_16x16x32_bf16 v[176:179], a[144:147], a[68:71], v[176:179]
    ds_read_b64_tr_b16 a[182:183], v53 offset:45056
    v_and_b32 v71, 0xffff0000, v71
    v_mfma_f32_16x16x32_bf16 v[208:211], a[144:147], a[72:75], v[208:211]
    v_lshlrev_b32 v72, 16, v74
    v_mfma_f32_16x16x32_bf16 v[240:243], a[144:147], a[76:79], v[240:243]
    ds_read_b64_tr_b16 a[184:185], v54 offset:40960
    v_and_b32 v73, 0xffff0000, v74
    s_waitcnt lgkmcnt(15)
    v_mfma_f32_16x16x32_bf16 v[148:151], a[148:151], a[64:67], v[148:151]
    ds_read_b64_tr_b16 a[186:187], v54 offset:45056
    v_lshlrev_b32 v74, 16, v75
    v_mfma_f32_16x16x32_bf16 v[180:183], a[148:151], a[68:71], v[180:183]
    v_and_b32 v75, 0xffff0000, v75
    v_mfma_f32_16x16x32_bf16 v[212:215], a[148:151], a[72:75], v[212:215]
    ds_read_b64_tr_b16 a[188:189], v55 offset:40960
    v_lshlrev_b32 v76, 16, v78
    v_mfma_f32_16x16x32_bf16 v[244:247], a[148:151], a[76:79], v[244:247]
    ds_read_b64_tr_b16 a[190:191], v55 offset:45056
    v_and_b32 v77, 0xffff0000, v78
    v_mfma_f32_16x16x32_bf16 v[152:155], a[152:155], a[64:67], v[152:155]
    v_lshlrev_b32 v78, 16, v79
    v_mfma_f32_16x16x32_bf16 v[184:187], a[152:155], a[68:71], v[184:187]
    v_and_b32 v79, 0xffff0000, v79
    v_mfma_f32_16x16x32_bf16 v[216:219], a[152:155], a[72:75], v[216:219]
    v_mfma_f32_16x16x32_bf16 v[248:251], a[152:155], a[76:79], v[248:251]
    s_waitcnt lgkmcnt(15)
    v_mfma_f32_16x16x32_bf16 v[156:159], a[156:159], a[64:67], v[156:159]
    v_mfma_f32_16x16x32_bf16 v[188:191], a[156:159], a[68:71], v[188:191]
    v_mfma_f32_16x16x32_bf16 v[220:223], a[156:159], a[72:75], v[220:223]
    v_mfma_f32_16x16x32_bf16 v[252:255], a[156:159], a[76:79], v[252:255]
    s_waitcnt vmcnt(44) lgkmcnt(14)
    v_mfma_f32_16x16x32_bf16 v[128:131], a[160:163], a[80:83], v[128:131]
    buffer_load_dwordx4 a[64:67], v21, s[56:59], s68 offen sc1
    s_waitcnt vmcnt(44)
    v_mfma_f32_16x16x32_bf16 v[160:163], a[160:163], a[84:87], v[160:163]
    ds_read_b64_tr_b16 a[128:129], v48 offset:49152
    s_waitcnt vmcnt(43)
    v_mfma_f32_16x16x32_bf16 v[192:195], a[160:163], a[88:91], v[192:195]
    ds_read_b64_tr_b16 a[130:131], v48 offset:53248
    buffer_load_dwordx4 a[68:71], v22, s[56:59], s68 offen sc1
    s_waitcnt vmcnt(43)
    v_mfma_f32_16x16x32_bf16 v[224:227], a[160:163], a[92:95], v[224:227]
    s_waitcnt lgkmcnt(14)
    v_mfma_f32_16x16x32_bf16 v[132:135], a[164:167], a[80:83], v[132:135]
    ds_read_b64_tr_b16 a[132:133], v49 offset:49152
    buffer_load_dwordx4 a[72:75], v23, s[56:59], s68 offen sc1
    v_mfma_f32_16x16x32_bf16 v[164:167], a[164:167], a[84:87], v[164:167]
    ds_read_b64_tr_b16 a[134:135], v49 offset:53248
    v_mfma_f32_16x16x32_bf16 v[196:199], a[164:167], a[88:91], v[196:199]
    buffer_load_dwordx4 a[76:79], v24, s[56:59], s68 offen sc1
    v_mfma_f32_16x16x32_bf16 v[228:231], a[164:167], a[92:95], v[228:231]
    ds_read_b64_tr_b16 a[136:137], v50 offset:49152
    s_waitcnt lgkmcnt(15)
    v_mfma_f32_16x16x32_bf16 v[136:139], a[168:171], a[80:83], v[136:139]
    ds_read_b64_tr_b16 a[138:139], v50 offset:53248
    s_add_u32 s68, s68, 16384
    v_mfma_f32_16x16x32_bf16 v[168:171], a[168:171], a[84:87], v[168:171]
    v_mfma_f32_16x16x32_bf16 v[200:203], a[168:171], a[88:91], v[200:203]
    ds_read_b64_tr_b16 a[140:141], v51 offset:49152
    v_lshlrev_b32 v80, 16, v82
    v_mfma_f32_16x16x32_bf16 v[232:235], a[168:171], a[92:95], v[232:235]
    ds_read_b64_tr_b16 a[142:143], v51 offset:53248
    v_and_b32 v81, 0xffff0000, v82
    s_waitcnt lgkmcnt(15)
    v_mfma_f32_16x16x32_bf16 v[140:143], a[172:175], a[80:83], v[140:143]
    v_lshlrev_b32 v82, 16, v83
    v_mfma_f32_16x16x32_bf16 v[172:175], a[172:175], a[84:87], v[172:175]
    ds_read_b64_tr_b16 a[144:145], v52 offset:49152
    v_and_b32 v83, 0xffff0000, v83
    v_mfma_f32_16x16x32_bf16 v[204:207], a[172:175], a[88:91], v[204:207]
    ds_read_b64_tr_b16 a[146:147], v52 offset:53248
    v_lshlrev_b32 v84, 16, v86
    v_mfma_f32_16x16x32_bf16 v[236:239], a[172:175], a[92:95], v[236:239]
    v_and_b32 v85, 0xffff0000, v86
    s_waitcnt lgkmcnt(15)
    v_mfma_f32_16x16x32_bf16 v[144:147], a[176:179], a[80:83], v[144:147]
    ds_read_b64_tr_b16 a[148:149], v53 offset:49152
    v_lshlrev_b32 v86, 16, v87
    v_mfma_f32_16x16x32_bf16 v[176:179], a[176:179], a[84:87], v[176:179]
    ds_read_b64_tr_b16 a[150:151], v53 offset:53248
    v_and_b32 v87, 0xffff0000, v87
    v_mfma_f32_16x16x32_bf16 v[208:211], a[176:179], a[88:91], v[208:211]
    v_lshlrev_b32 v88, 16, v90
    v_mfma_f32_16x16x32_bf16 v[240:243], a[176:179], a[92:95], v[240:243]
    ds_read_b64_tr_b16 a[152:153], v54 offset:49152
    v_and_b32 v89, 0xffff0000, v90
    s_waitcnt lgkmcnt(15)
    v_mfma_f32_16x16x32_bf16 v[148:151], a[180:183], a[80:83], v[148:151]
    ds_read_b64_tr_b16 a[154:155], v54 offset:53248
    v_lshlrev_b32 v90, 16, v91
    v_mfma_f32_16x16x32_bf16 v[180:183], a[180:183], a[84:87], v[180:183]
    v_and_b32 v91, 0xffff0000, v91
    v_mfma_f32_16x16x32_bf16 v[212:215], a[180:183], a[88:91], v[212:215]
    ds_read_b64_tr_b16 a[156:157], v55 offset:49152
    v_lshlrev_b32 v92, 16, v94
    v_mfma_f32_16x16x32_bf16 v[244:247], a[180:183], a[92:95], v[244:247]
    ds_read_b64_tr_b16 a[158:159], v55 offset:53248
    v_and_b32 v93, 0xffff0000, v94
    v_mfma_f32_16x16x32_bf16 v[152:155], a[184:187], a[80:83], v[152:155]
    v_lshlrev_b32 v94, 16, v95
    v_mfma_f32_16x16x32_bf16 v[184:187], a[184:187], a[84:87], v[184:187]
    v_and_b32 v95, 0xffff0000, v95
    v_mfma_f32_16x16x32_bf16 v[216:219], a[184:187], a[88:91], v[216:219]
    v_mfma_f32_16x16x32_bf16 v[248:251], a[184:187], a[92:95], v[248:251]
    s_waitcnt lgkmcnt(15)
    v_mfma_f32_16x16x32_bf16 v[156:159], a[188:191], a[80:83], v[156:159]
    buffer_load_dword v44, off, s[56:59], s76 sc1
    v_mfma_f32_16x16x32_bf16 v[188:191], a[188:191], a[84:87], v[188:191]
    v_mfma_f32_16x16x32_bf16 v[220:223], a[188:191], a[88:91], v[220:223]
    v_mfma_f32_16x16x32_bf16 v[252:255], a[188:191], a[92:95], v[252:255]
    s_waitcnt vmcnt(45) lgkmcnt(14)
    v_mfma_f32_16x16x32_bf16 v[128:131], a[128:131], a[96:99], v[128:131]
    buffer_load_dwordx4 a[80:83], v21, s[56:59], s68 offen sc1
    s_waitcnt vmcnt(45)
    v_mfma_f32_16x16x32_bf16 v[160:163], a[128:131], a[100:103], v[160:163]
    ds_read_b64_tr_b16 a[160:161], v48 offset:57344
    s_waitcnt vmcnt(44)
    v_mfma_f32_16x16x32_bf16 v[192:195], a[128:131], a[104:107], v[192:195]
    ds_read_b64_tr_b16 a[162:163], v48 offset:61440
    buffer_load_dwordx4 a[84:87], v22, s[56:59], s68 offen sc1
    s_waitcnt vmcnt(44)
    v_mfma_f32_16x16x32_bf16 v[224:227], a[128:131], a[108:111], v[224:227]
    s_waitcnt lgkmcnt(14)
    v_mfma_f32_16x16x32_bf16 v[132:135], a[132:135], a[96:99], v[132:135]
    ds_read_b64_tr_b16 a[164:165], v49 offset:57344
    buffer_load_dwordx4 a[88:91], v23, s[56:59], s68 offen sc1
    v_mfma_f32_16x16x32_bf16 v[164:167], a[132:135], a[100:103], v[164:167]
    ds_read_b64_tr_b16 a[166:167], v49 offset:61440
    v_mfma_f32_16x16x32_bf16 v[196:199], a[132:135], a[104:107], v[196:199]
    buffer_load_dwordx4 a[92:95], v24, s[56:59], s68 offen sc1
    v_mfma_f32_16x16x32_bf16 v[228:231], a[132:135], a[108:111], v[228:231]
    ds_read_b64_tr_b16 a[168:169], v50 offset:57344
    s_waitcnt lgkmcnt(15)
    v_mfma_f32_16x16x32_bf16 v[136:139], a[136:139], a[96:99], v[136:139]
    ds_read_b64_tr_b16 a[170:171], v50 offset:61440
    s_add_u32 s68, s68, 16384
    v_mfma_f32_16x16x32_bf16 v[168:171], a[136:139], a[100:103], v[168:171]
    v_mfma_f32_16x16x32_bf16 v[200:203], a[136:139], a[104:107], v[200:203]
    ds_read_b64_tr_b16 a[172:173], v51 offset:57344
    v_mfma_f32_16x16x32_bf16 v[232:235], a[136:139], a[108:111], v[232:235]
    ds_read_b64_tr_b16 a[174:175], v51 offset:61440
    s_waitcnt lgkmcnt(15)
    v_mfma_f32_16x16x32_bf16 v[140:143], a[140:143], a[96:99], v[140:143]
    v_mfma_f32_16x16x32_bf16 v[172:175], a[140:143], a[100:103], v[172:175]
    ds_read_b64_tr_b16 a[176:177], v52 offset:57344
    v_mfma_f32_16x16x32_bf16 v[204:207], a[140:143], a[104:107], v[204:207]
    ds_read_b64_tr_b16 a[178:179], v52 offset:61440
    v_mfma_f32_16x16x32_bf16 v[236:239], a[140:143], a[108:111], v[236:239]
    s_waitcnt lgkmcnt(15)
    v_mfma_f32_16x16x32_bf16 v[144:147], a[144:147], a[96:99], v[144:147]
    ds_read_b64_tr_b16 a[180:181], v53 offset:57344
    v_mfma_f32_16x16x32_bf16 v[176:179], a[144:147], a[100:103], v[176:179]
    ds_read_b64_tr_b16 a[182:183], v53 offset:61440
    v_mfma_f32_16x16x32_bf16 v[208:211], a[144:147], a[104:107], v[208:211]
    v_mfma_f32_16x16x32_bf16 v[240:243], a[144:147], a[108:111], v[240:243]
    ds_read_b64_tr_b16 a[184:185], v54 offset:57344
    s_waitcnt lgkmcnt(15)
    v_mfma_f32_16x16x32_bf16 v[148:151], a[148:151], a[96:99], v[148:151]
    ds_read_b64_tr_b16 a[186:187], v54 offset:61440
    v_mfma_f32_16x16x32_bf16 v[180:183], a[148:151], a[100:103], v[180:183]
    v_mfma_f32_16x16x32_bf16 v[212:215], a[148:151], a[104:107], v[212:215]
    ds_read_b64_tr_b16 a[188:189], v55 offset:57344
    v_mfma_f32_16x16x32_bf16 v[244:247], a[148:151], a[108:111], v[244:247]
    ds_read_b64_tr_b16 a[190:191], v55 offset:61440
    v_mfma_f32_16x16x32_bf16 v[152:155], a[152:155], a[96:99], v[152:155]
    v_mfma_f32_16x16x32_bf16 v[184:187], a[152:155], a[100:103], v[184:187]
    v_mfma_f32_16x16x32_bf16 v[216:219], a[152:155], a[104:107], v[216:219]
    v_mfma_f32_16x16x32_bf16 v[248:251], a[152:155], a[108:111], v[248:251]
    s_waitcnt lgkmcnt(15)
    v_mfma_f32_16x16x32_bf16 v[156:159], a[156:159], a[96:99], v[156:159]
    v_mfma_f32_16x16x32_bf16 v[188:191], a[156:159], a[100:103], v[188:191]
    v_mfma_f32_16x16x32_bf16 v[220:223], a[156:159], a[104:107], v[220:223]
    v_mfma_f32_16x16x32_bf16 v[252:255], a[156:159], a[108:111], v[252:255]
    s_waitcnt vmcnt(45) lgkmcnt(14)
    v_mfma_f32_16x16x32_bf16 v[128:131], a[160:163], a[112:115], v[128:131]
    buffer_load_dwordx4 a[96:99], v21, s[56:59], s68 offen sc1
    s_waitcnt vmcnt(45)
    v_mfma_f32_16x16x32_bf16 v[160:163], a[160:163], a[116:119], v[160:163]
    ds_read_b64_tr_b16 a[128:129], v56 offset:0
    s_waitcnt vmcnt(44)
    v_mfma_f32_16x16x32_bf16 v[192:195], a[160:163], a[120:123], v[192:195]
    ds_read_b64_tr_b16 a[130:131], v56 offset:4096
    buffer_load_dwordx4 a[100:103], v22, s[56:59], s68 offen sc1
    s_waitcnt vmcnt(44)
    v_mfma_f32_16x16x32_bf16 v[224:227], a[160:163], a[124:127], v[224:227]
    s_waitcnt lgkmcnt(14)
    v_mfma_f32_16x16x32_bf16 v[132:135], a[164:167], a[112:115], v[132:135]
    ds_read_b64_tr_b16 a[132:133], v57 offset:0
    buffer_load_dwordx4 a[104:107], v23, s[56:59], s68 offen sc1
    v_mfma_f32_16x16x32_bf16 v[164:167], a[164:167], a[116:119], v[164:167]
    ds_read_b64_tr_b16 a[134:135], v57 offset:4096
    v_mfma_f32_16x16x32_bf16 v[196:199], a[164:167], a[120:123], v[196:199]
    buffer_load_dwordx4 a[108:111], v24, s[56:59], s68 offen sc1
    v_mfma_f32_16x16x32_bf16 v[228:231], a[164:167], a[124:127], v[228:231]
    ds_read_b64_tr_b16 a[136:137], v58 offset:0
    s_waitcnt lgkmcnt(15)
    v_mfma_f32_16x16x32_bf16 v[136:139], a[168:171], a[112:115], v[136:139]
    ds_read_b64_tr_b16 a[138:139], v58 offset:4096
    s_add_u32 s68, s68, 16384
    v_mfma_f32_16x16x32_bf16 v[168:171], a[168:171], a[116:119], v[168:171]
    v_mfma_f32_16x16x32_bf16 v[200:203], a[168:171], a[120:123], v[200:203]
    ds_read_b64_tr_b16 a[140:141], v59 offset:0
    v_mfma_f32_16x16x32_bf16 v[232:235], a[168:171], a[124:127], v[232:235]
    ds_read_b64_tr_b16 a[142:143], v59 offset:4096
    s_waitcnt lgkmcnt(15)
    v_mfma_f32_16x16x32_bf16 v[140:143], a[172:175], a[112:115], v[140:143]
    v_mfma_f32_16x16x32_bf16 v[172:175], a[172:175], a[116:119], v[172:175]
    ds_read_b64_tr_b16 a[144:145], v60 offset:0
    v_mfma_f32_16x16x32_bf16 v[204:207], a[172:175], a[120:123], v[204:207]
    ds_read_b64_tr_b16 a[146:147], v60 offset:4096
    v_mfma_f32_16x16x32_bf16 v[236:239], a[172:175], a[124:127], v[236:239]
    s_waitcnt lgkmcnt(15)
    v_mfma_f32_16x16x32_bf16 v[144:147], a[176:179], a[112:115], v[144:147]
    ds_read_b64_tr_b16 a[148:149], v61 offset:0
    v_mfma_f32_16x16x32_bf16 v[176:179], a[176:179], a[116:119], v[176:179]
    ds_read_b64_tr_b16 a[150:151], v61 offset:4096
    v_mfma_f32_16x16x32_bf16 v[208:211], a[176:179], a[120:123], v[208:211]
    v_mfma_f32_16x16x32_bf16 v[240:243], a[176:179], a[124:127], v[240:243]
    ds_read_b64_tr_b16 a[152:153], v62 offset:0
    s_waitcnt lgkmcnt(15)
    v_mfma_f32_16x16x32_bf16 v[148:151], a[180:183], a[112:115], v[148:151]
    ds_read_b64_tr_b16 a[154:155], v62 offset:4096
    v_mfma_f32_16x16x32_bf16 v[180:183], a[180:183], a[116:119], v[180:183]
    v_mfma_f32_16x16x32_bf16 v[212:215], a[180:183], a[120:123], v[212:215]
    ds_read_b64_tr_b16 a[156:157], v63 offset:0
    v_mfma_f32_16x16x32_bf16 v[244:247], a[180:183], a[124:127], v[244:247]
    ds_read_b64_tr_b16 a[158:159], v63 offset:4096
    v_mfma_f32_16x16x32_bf16 v[152:155], a[184:187], a[112:115], v[152:155]
    v_mfma_f32_16x16x32_bf16 v[184:187], a[184:187], a[116:119], v[184:187]
    v_mfma_f32_16x16x32_bf16 v[216:219], a[184:187], a[120:123], v[216:219]
    v_mfma_f32_16x16x32_bf16 v[248:251], a[184:187], a[124:127], v[248:251]
    s_waitcnt lgkmcnt(15)
    v_mfma_f32_16x16x32_bf16 v[156:159], a[188:191], a[112:115], v[156:159]
    v_mfma_f32_16x16x32_bf16 v[188:191], a[188:191], a[116:119], v[188:191]
    v_mfma_f32_16x16x32_bf16 v[220:223], a[188:191], a[120:123], v[220:223]
    v_mfma_f32_16x16x32_bf16 v[252:255], a[188:191], a[124:127], v[252:255]
    s_waitcnt vmcnt(17)
    s_barrier
    s_waitcnt lgkmcnt(14)
    v_mfma_f32_16x16x32_bf16 v[128:131], a[128:131], a[0:3], v[128:131]
    buffer_load_dwordx4 a[112:115], v21, s[56:59], s68 offen sc1
    v_mfma_f32_16x16x32_bf16 v[160:163], a[128:131], a[4:7], v[160:163]
    ds_read_b64_tr_b16 a[160:161], v56 offset:8192
    v_mfma_f32_16x16x32_bf16 v[192:195], a[128:131], a[8:11], v[192:195]
    ds_read_b64_tr_b16 a[162:163], v56 offset:12288
    buffer_load_dwordx4 a[116:119], v22, s[56:59], s68 offen sc1
    v_mfma_f32_16x16x32_bf16 v[224:227], a[128:131], a[12:15], v[224:227]
    s_waitcnt lgkmcnt(14)
    v_mfma_f32_16x16x32_bf16 v[132:135], a[132:135], a[0:3], v[132:135]
    ds_read_b64_tr_b16 a[164:165], v57 offset:8192
    buffer_load_dwordx4 a[120:123], v23, s[56:59], s68 offen sc1
    v_mfma_f32_16x16x32_bf16 v[164:167], a[132:135], a[4:7], v[164:167]
    ds_read_b64_tr_b16 a[166:167], v57 offset:12288
    v_mfma_f32_16x16x32_bf16 v[196:199], a[132:135], a[8:11], v[196:199]
    buffer_load_dwordx4 a[124:127], v24, s[56:59], s68 offen sc1
    v_mfma_f32_16x16x32_bf16 v[228:231], a[132:135], a[12:15], v[228:231]
    ds_read_b64_tr_b16 a[168:169], v58 offset:8192
    s_waitcnt lgkmcnt(15)
    v_mfma_f32_16x16x32_bf16 v[136:139], a[136:139], a[0:3], v[136:139]
    ds_read_b64_tr_b16 a[170:171], v58 offset:12288
    s_add_u32 s68, s68, 16384
    v_mfma_f32_16x16x32_bf16 v[168:171], a[136:139], a[4:7], v[168:171]
    v_mfma_f32_16x16x32_bf16 v[200:203], a[136:139], a[8:11], v[200:203]
    ds_read_b64_tr_b16 a[172:173], v59 offset:8192
    v_mfma_f32_16x16x32_bf16 v[232:235], a[136:139], a[12:15], v[232:235]
    ds_read_b64_tr_b16 a[174:175], v59 offset:12288
    s_mov_b32 s82, 0
    s_add_u32 m0, s3, 65536
    s_waitcnt lgkmcnt(15)
    v_mfma_f32_16x16x32_bf16 v[140:143], a[140:143], a[0:3], v[140:143]
    buffer_load_dwordx4 v17, s[52:55], s82 offen lds
    v_mfma_f32_16x16x32_bf16 v[172:175], a[140:143], a[4:7], v[172:175]
    ds_read_b64_tr_b16 a[176:177], v60 offset:8192
    v_mfma_f32_16x16x32_bf16 v[204:207], a[140:143], a[8:11], v[204:207]
    ds_read_b64_tr_b16 a[178:179], v60 offset:12288
    v_mfma_f32_16x16x32_bf16 v[236:239], a[140:143], a[12:15], v[236:239]
    s_waitcnt lgkmcnt(15)
    v_mfma_f32_16x16x32_bf16 v[144:147], a[144:147], a[0:3], v[144:147]
    ds_read_b64_tr_b16 a[180:181], v61 offset:8192
    buffer_load_dwordx4 v18, s[52:55], s82 offen offset:1024 lds
    v_mfma_f32_16x16x32_bf16 v[176:179], a[144:147], a[4:7], v[176:179]
    ds_read_b64_tr_b16 a[182:183], v61 offset:12288
    v_mfma_f32_16x16x32_bf16 v[208:211], a[144:147], a[8:11], v[208:211]
    v_mfma_f32_16x16x32_bf16 v[240:243], a[144:147], a[12:15], v[240:243]
    ds_read_b64_tr_b16 a[184:185], v62 offset:8192
    s_waitcnt lgkmcnt(15)
    v_mfma_f32_16x16x32_bf16 v[148:151], a[148:151], a[0:3], v[148:151]
    ds_read_b64_tr_b16 a[186:187], v62 offset:12288
    v_mfma_f32_16x16x32_bf16 v[180:183], a[148:151], a[4:7], v[180:183]
    s_mov_b32 s83, 65536
    s_add_u32 m0, s3, 73728
    v_mfma_f32_16x16x32_bf16 v[212:215], a[148:151], a[8:11], v[212:215]
    ds_read_b64_tr_b16 a[188:189], v63 offset:8192
    buffer_load_dwordx4 v17, s[52:55], s83 offen lds
    v_mfma_f32_16x16x32_bf16 v[244:247], a[148:151], a[12:15], v[244:247]
    ds_read_b64_tr_b16 a[190:191], v63 offset:12288
    v_mfma_f32_16x16x32_bf16 v[152:155], a[152:155], a[0:3], v[152:155]
    v_mfma_f32_16x16x32_bf16 v[184:187], a[152:155], a[4:7], v[184:187]
    v_mfma_f32_16x16x32_bf16 v[216:219], a[152:155], a[8:11], v[216:219]
    buffer_load_dwordx4 v18, s[52:55], s83 offen offset:1024 lds
    v_mfma_f32_16x16x32_bf16 v[248:251], a[152:155], a[12:15], v[248:251]
    s_waitcnt lgkmcnt(15)
    v_mfma_f32_16x16x32_bf16 v[156:159], a[156:159], a[0:3], v[156:159]
    v_mfma_f32_16x16x32_bf16 v[188:191], a[156:159], a[4:7], v[188:191]
    v_mfma_f32_16x16x32_bf16 v[220:223], a[156:159], a[8:11], v[220:223]
    v_mfma_f32_16x16x32_bf16 v[252:255], a[156:159], a[12:15], v[252:255]
    s_waitcnt lgkmcnt(14)
    v_mfma_f32_16x16x32_bf16 v[128:131], a[160:163], a[16:19], v[128:131]
    v_readfirstlane_b32 s86, v43
    s_bfe_u32 s86, s86, 0x80010
    s_cmp_eq_u32 s86, 16
    s_cbranch_scc0 L_spC
L_okC:
    buffer_load_dwordx4 a[0:3], v21, s[56:59], s68 offen sc1
    v_mfma_f32_16x16x32_bf16 v[160:163], a[160:163], a[20:23], v[160:163]
    ds_read_b64_tr_b16 a[128:129], v56 offset:16384
    v_mfma_f32_16x16x32_bf16 v[192:195], a[160:163], a[24:27], v[192:195]
    ds_read_b64_tr_b16 a[130:131], v56 offset:20480
    buffer_load_dwordx4 a[4:7], v22, s[56:59], s68 offen sc1
    v_mfma_f32_16x16x32_bf16 v[224:227], a[160:163], a[28:31], v[224:227]
    s_waitcnt lgkmcnt(14)
    v_mfma_f32_16x16x32_bf16 v[132:135], a[164:167], a[16:19], v[132:135]
    ds_read_b64_tr_b16 a[132:133], v57 offset:16384
    buffer_load_dwordx4 a[8:11], v23, s[56:59], s68 offen sc1
    v_mfma_f32_16x16x32_bf16 v[164:167], a[164:167], a[20:23], v[164:167]
    ds_read_b64_tr_b16 a[134:135], v57 offset:20480
    v_mfma_f32_16x16x32_bf16 v[196:199], a[164:167], a[24:27], v[196:199]
    buffer_load_dwordx4 a[12:15], v24, s[56:59], s68 offen sc1
    v_mfma_f32_16x16x32_bf16 v[228:231], a[164:167], a[28:31], v[228:231]
    ds_read_b64_tr_b16 a[136:137], v58 offset:16384
    s_waitcnt lgkmcnt(15)
    v_mfma_f32_16x16x32_bf16 v[136:139], a[168:171], a[16:19], v[136:139]
    ds_read_b64_tr_b16 a[138:139], v58 offset:20480
    s_add_u32 s68, s68, 16384
    v_mfma_f32_16x16x32_bf16 v[168:171], a[168:171], a[20:23], v[168:171]
    v_mfma_f32_16x16x32_bf16 v[200:203], a[168:171], a[24:27], v[200:203]
    ds_read_b64_tr_b16 a[140:141], v59 offset:16384
    v_mfma_f32_16x16x32_bf16 v[232:235], a[168:171], a[28:31], v[232:235]
    ds_read_b64_tr_b16 a[142:143], v59 offset:20480
    s_mov_b32 s82, 131072
    s_add_u32 m0, s3, 81920
    s_waitcnt lgkmcnt(15)
    v_mfma_f32_16x16x32_bf16 v[140:143], a[172:175], a[16:19], v[140:143]
    buffer_load_dwordx4 v17, s[52:55], s82 offen lds
    v_mfma_f32_16x16x32_bf16 v[172:175], a[172:175], a[20:23], v[172:175]
    ds_read_b64_tr_b16 a[144:145], v60 offset:16384
    v_mfma_f32_16x16x32_bf16 v[204:207], a[172:175], a[24:27], v[204:207]
    ds_read_b64_tr_b16 a[146:147], v60 offset:20480
    v_mfma_f32_16x16x32_bf16 v[236:239], a[172:175], a[28:31], v[236:239]
    s_waitcnt lgkmcnt(15)
    v_mfma_f32_16x16x32_bf16 v[144:147], a[176:179], a[16:19], v[144:147]
    ds_read_b64_tr_b16 a[148:149], v61 offset:16384
    buffer_load_dwordx4 v18, s[52:55], s82 offen offset:1024 lds
    v_mfma_f32_16x16x32_bf16 v[176:179], a[176:179], a[20:23], v[176:179]
    ds_read_b64_tr_b16 a[150:151], v61 offset:20480
    v_mfma_f32_16x16x32_bf16 v[208:211], a[176:179], a[24:27], v[208:211]
    v_mfma_f32_16x16x32_bf16 v[240:243], a[176:179], a[28:31], v[240:243]
    ds_read_b64_tr_b16 a[152:153], v62 offset:16384
    s_waitcnt lgkmcnt(15)
    v_mfma_f32_16x16x32_bf16 v[148:151], a[180:183], a[16:19], v[148:151]
    ds_read_b64_tr_b16 a[154:155], v62 offset:20480
    v_mfma_f32_16x16x32_bf16 v[180:183], a[180:183], a[20:23], v[180:183]
    s_mov_b32 s83, 196608
    s_add_u32 m0, s3, 90112
    v_mfma_f32_16x16x32_bf16 v[212:215], a[180:183], a[24:27], v[212:215]
    ds_read_b64_tr_b16 a[156:157], v63 offset:16384
    buffer_load_dwordx4 v17, s[52:55], s83 offen lds
    v_mfma_f32_16x16x32_bf16 v[244:247], a[180:183], a[28:31], v[244:247]
    ds_read_b64_tr_b16 a[158:159], v63 offset:20480
    v_mfma_f32_16x16x32_bf16 v[152:155], a[184:187], a[16:19], v[152:155]
    v_mfma_f32_16x16x32_bf16 v[184:187], a[184:187], a[20:23], v[184:187]
    v_mfma_f32_16x16x32_bf16 v[216:219], a[184:187], a[24:27], v[216:219]
    buffer_load_dwordx4 v18, s[52:55], s83 offen offset:1024 lds
    v_mfma_f32_16x16x32_bf16 v[248:251], a[184:187], a[28:31], v[248:251]
    s_waitcnt lgkmcnt(15)
    v_mfma_f32_16x16x32_bf16 v[156:159], a[188:191], a[16:19], v[156:159]
    v_mfma_f32_16x16x32_bf16 v[188:191], a[188:191], a[20:23], v[188:191]
    v_mfma_f32_16x16x32_bf16 v[220:223], a[188:191], a[24:27], v[220:223]
    v_mfma_f32_16x16x32_bf16 v[252:255], a[188:191], a[28:31], v[252:255]
    s_waitcnt lgkmcnt(14)
    v_mfma_f32_16x16x32_bf16 v[128:131], a[128:131], a[32:35], v[128:131]
    buffer_load_dwordx4 a[16:19], v21, s[56:59], s68 offen sc1
    v_mfma_f32_16x16x32_bf16 v[160:163], a[128:131], a[36:39], v[160:163]
    ds_read_b64_tr_b16 a[160:161], v56 offset:24576
    v_mfma_f32_16x16x32_bf16 v[192:195], a[128:131], a[40:43], v[192:195]
    ds_read_b64_tr_b16 a[162:163], v56 offset:28672
    buffer_load_dwordx4 a[20:23], v22, s[56:59], s68 offen sc1
    v_mfma_f32_16x16x32_bf16 v[224:227], a[128:131], a[44:47], v[224:227]
    s_waitcnt lgkmcnt(14)
    v_mfma_f32_16x16x32_bf16 v[132:135], a[132:135], a[32:35], v[132:135]
    ds_read_b64_tr_b16 a[164:165], v57 offset:24576
    buffer_load_dwordx4 a[24:27], v23, s[56:59], s68 offen sc1
    v_mfma_f32_16x16x32_bf16 v[164:167], a[132:135], a[36:39], v[164:167]
    ds_read_b64_tr_b16 a[166:167], v57 offset:28672
    v_mfma_f32_16x16x32_bf16 v[196:199], a[132:135], a[40:43], v[196:199]
    buffer_load_dwordx4 a[28:31], v24, s[56:59], s68 offen sc1
    v_mfma_f32_16x16x32_bf16 v[228:231], a[132:135], a[44:47], v[228:231]
    ds_read_b64_tr_b16 a[168:169], v58 offset:24576
    s_waitcnt lgkmcnt(15)
    v_mfma_f32_16x16x32_bf16 v[136:139], a[136:139], a[32:35], v[136:139]
    ds_read_b64_tr_b16 a[170:171], v58 offset:28672
    s_add_u32 s68, s68, 16384
    v_mfma_f32_16x16x32_bf16 v[168:171], a[136:139], a[36:39], v[168:171]
    v_mfma_f32_16x16x32_bf16 v[200:203], a[136:139], a[40:43], v[200:203]
    ds_read_b64_tr_b16 a[172:173], v59 offset:24576
    v_mfma_f32_16x16x32_bf16 v[232:235], a[136:139], a[44:47], v[232:235]
    ds_read_b64_tr_b16 a[174:175], v59 offset:28672
    s_mov_b32 s82, 262144
    s_add_u32 m0, s3, 98304
    s_waitcnt lgkmcnt(15)
    v_mfma_f32_16x16x32_bf16 v[140:143], a[140:143], a[32:35], v[140:143]
    buffer_load_dwordx4 v17, s[52:55], s82 offen lds
    v_mfma_f32_16x16x32_bf16 v[172:175], a[140:143], a[36:39], v[172:175]
    ds_read_b64_tr_b16 a[176:177], v60 offset:24576
    v_mfma_f32_16x16x32_bf16 v[204:207], a[140:143], a[40:43], v[204:207]
    ds_read_b64_tr_b16 a[178:179], v60 offset:28672
    v_mfma_f32_16x16x32_bf16 v[236:239], a[140:143], a[44:47], v[236:239]
    s_waitcnt lgkmcnt(15)
    v_mfma_f32_16x16x32_bf16 v[144:147], a[144:147], a[32:35], v[144:147]
    ds_read_b64_tr_b16 a[180:181], v61 offset:24576
    buffer_load_dwordx4 v18, s[52:55], s82 offen offset:1024 lds
    v_mfma_f32_16x16x32_bf16 v[176:179], a[144:147], a[36:39], v[176:179]
    ds_read_b64_tr_b16 a[182:183], v61 offset:28672
    v_mfma_f32_16x16x32_bf16 v[208:211], a[144:147], a[40:43], v[208:211]
    v_mfma_f32_16x16x32_bf16 v[240:243], a[144:147], a[44:47], v[240:243]
    ds_read_b64_tr_b16 a[184:185], v62 offset:24576
    s_waitcnt lgkmcnt(15)
    v_mfma_f32_16x16x32_bf16 v[148:151], a[148:151], a[32:35], v[148:151]
    ds_read_b64_tr_b16 a[186:187], v62 offset:28672
    v_mfma_f32_16x16x32_bf16 v[180:183], a[148:151], a[36:39], v[180:183]
    s_mov_b32 s83, 327680
    s_add_u32 m0, s3, 106496
    v_mfma_f32_16x16x32_bf16 v[212:215], a[148:151], a[40:43], v[212:215]
    ds_read_b64_tr_b16 a[188:189], v63 offset:24576
    buffer_load_dwordx4 v17, s[52:55], s83 offen lds
    v_mfma_f32_16x16x32_bf16 v[244:247], a[148:151], a[44:47], v[244:247]
    ds_read_b64_tr_b16 a[190:191], v63 offset:28672
    v_mfma_f32_16x16x32_bf16 v[152:155], a[152:155], a[32:35], v[152:155]
    v_mfma_f32_16x16x32_bf16 v[184:187], a[152:155], a[36:39], v[184:187]
    v_mfma_f32_16x16x32_bf16 v[216:219], a[152:155], a[40:43], v[216:219]
    buffer_load_dwordx4 v18, s[52:55], s83 offen offset:1024 lds
    v_mfma_f32_16x16x32_bf16 v[248:251], a[152:155], a[44:47], v[248:251]
    s_waitcnt lgkmcnt(15)
    v_mfma_f32_16x16x32_bf16 v[156:159], a[156:159], a[32:35], v[156:159]
    v_mfma_f32_16x16x32_bf16 v[188:191], a[156:159], a[36:39], v[188:191]
    v_mfma_f32_16x16x32_bf16 v[220:223], a[156:159], a[40:43], v[220:223]
    v_mfma_f32_16x16x32_bf16 v[252:255], a[156:159], a[44:47], v[252:255]
    s_waitcnt vmcnt(40) lgkmcnt(14)
    v_mfma_f32_16x16x32_bf16 v[128:131], a[160:163], a[48:51], v[128:131]
    buffer_load_dwordx4 a[32:35], v21, s[56:59], s68 offen sc1
    s_waitcnt vmcnt(40)
    v_mfma_f32_16x16x32_bf16 v[160:163], a[160:163], a[52:55], v[160:163]
    ds_read_b64_tr_b16 a[128:129], v8 offset:0
    s_waitcnt vmcnt(39)
    v_mfma_f32_16x16x32_bf16 v[192:195], a[160:163], a[56:59], v[192:195]
    ds_read_b64_tr_b16 a[130:131], v8 offset:4096
    buffer_load_dwordx4 a[36:39], v22, s[56:59], s68 offen sc1
    s_waitcnt vmcnt(39)
    v_mfma_f32_16x16x32_bf16 v[224:227], a[160:163], a[60:63], v[224:227]
    s_waitcnt lgkmcnt(14)
    v_mfma_f32_16x16x32_bf16 v[132:135], a[164:167], a[48:51], v[132:135]
    ds_read_b64_tr_b16 a[132:133], v9 offset:0
    buffer_load_dwordx4 a[40:43], v23, s[56:59], s68 offen sc1
    v_mfma_f32_16x16x32_bf16 v[164:167], a[164:167], a[52:55], v[164:167]
    ds_read_b64_tr_b16 a[134:135], v9 offset:4096
    v_mfma_f32_16x16x32_bf16 v[196:199], a[164:167], a[56:59], v[196:199]
    buffer_load_dwordx4 a[44:47], v24, s[56:59], s68 offen sc1
    v_mfma_f32_16x16x32_bf16 v[228:231], a[164:167], a[60:63], v[228:231]
    ds_read_b64_tr_b16 a[136:137], v10 offset:0
    s_waitcnt lgkmcnt(15)
    v_mfma_f32_16x16x32_bf16 v[136:139], a[168:171], a[48:51], v[136:139]
    ds_read_b64_tr_b16 a[138:139], v10 offset:4096
    s_add_u32 s68, s68, 16384
    v_mfma_f32_16x16x32_bf16 v[168:171], a[168:171], a[52:55], v[168:171]
    v_mfma_f32_16x16x32_bf16 v[200:203], a[168:171], a[56:59], v[200:203]
    ds_read_b64_tr_b16 a[140:141], v11 offset:0
    v_mfma_f32_16x16x32_bf16 v[232:235], a[168:171], a[60:63], v[232:235]
    ds_read_b64_tr_b16 a[142:143], v11 offset:4096
    s_mov_b32 s82, 393216
    s_add_u32 m0, s3, 114688
    s_waitcnt lgkmcnt(15)
    v_mfma_f32_16x16x32_bf16 v[140:143], a[172:175], a[48:51], v[140:143]
    buffer_load_dwordx4 v17, s[52:55], s82 offen lds
    v_mfma_f32_16x16x32_bf16 v[172:175], a[172:175], a[52:55], v[172:175]
    ds_read_b64_tr_b16 a[144:145], v12 offset:0
    v_mfma_f32_16x16x32_bf16 v[204:207], a[172:175], a[56:59], v[204:207]
    ds_read_b64_tr_b16 a[146:147], v12 offset:4096
    v_mfma_f32_16x16x32_bf16 v[236:239], a[172:175], a[60:63], v[236:239]
    s_waitcnt lgkmcnt(15)
    v_mfma_f32_16x16x32_bf16 v[144:147], a[176:179], a[48:51], v[144:147]
    ds_read_b64_tr_b16 a[148:149], v13 offset:0
    buffer_load_dwordx4 v18, s[52:55], s82 offen offset:1024 lds
    v_mfma_f32_16x16x32_bf16 v[176:179], a[176:179], a[52:55], v[176:179]
    ds_read_b64_tr_b16 a[150:151], v13 offset:4096
    v_mfma_f32_16x16x32_bf16 v[208:211], a[176:179], a[56:59], v[208:211]
    v_mfma_f32_16x16x32_bf16 v[240:243], a[176:179], a[60:63], v[240:243]
    ds_read_b64_tr_b16 a[152:153], v14 offset:0
    s_waitcnt lgkmcnt(15)
    v_mfma_f32_16x16x32_bf16 v[148:151], a[180:183], a[48:51], v[148:151]
    ds_read_b64_tr_b16 a[154:155], v14 offset:4096
    v_mfma_f32_16x16x32_bf16 v[180:183], a[180:183], a[52:55], v[180:183]
    s_mov_b32 s83, 458752
    s_add_u32 m0, s3, 122880
    v_mfma_f32_16x16x32_bf16 v[212:215], a[180:183], a[56:59], v[212:215]
    ds_read_b64_tr_b16 a[156:157], v15 offset:0
    buffer_load_dwordx4 v17, s[52:55], s83 offen lds
    v_mfma_f32_16x16x32_bf16 v[244:247], a[180:183], a[60:63], v[244:247]
    ds_read_b64_tr_b16 a[158:159], v15 offset:4096
    v_mfma_f32_16x16x32_bf16 v[152:155], a[184:187], a[48:51], v[152:155]
    v_mfma_f32_16x16x32_bf16 v[184:187], a[184:187], a[52:55], v[184:187]
    v_mfma_f32_16x16x32_bf16 v[216:219], a[184:187], a[56:59], v[216:219]
    buffer_load_dwordx4 v18, s[52:55], s83 offen offset:1024 lds
    v_mfma_f32_16x16x32_bf16 v[248:251], a[184:187], a[60:63], v[248:251]
    s_waitcnt lgkmcnt(15)
    v_mfma_f32_16x16x32_bf16 v[156:159], a[188:191], a[48:51], v[156:159]
    v_mfma_f32_16x16x32_bf16 v[188:191], a[188:191], a[52:55], v[188:191]
    v_mfma_f32_16x16x32_bf16 v[220:223], a[188:191], a[56:59], v[220:223]
    v_mfma_f32_16x16x32_bf16 v[252:255], a[188:191], a[60:63], v[252:255]
    s_waitcnt vmcnt(44) lgkmcnt(14)
    v_mfma_f32_16x16x32_bf16 v[128:131], a[128:131], a[64:67], v[128:131]
    buffer_load_dwordx4 a[48:51], v21, s[56:59], s68 offen sc1
    s_waitcnt vmcnt(44)
    v_mfma_f32_16x16x32_bf16 v[160:163], a[128:131], a[68:71], v[160:163]
    ds_read_b64_tr_b16 a[160:161], v8 offset:8192
    s_waitcnt vmcnt(43)
    v_mfma_f32_16x16x32_bf16 v[192:195], a[128:131], a[72:75], v[192:195]
    ds_read_b64_tr_b16 a[162:163], v8 offset:12288
    buffer_load_dwordx4 a[52:55], v22, s[56:59], s68 offen sc1
    s_waitcnt vmcnt(43)
    v_mfma_f32_16x16x32_bf16 v[224:227], a[128:131], a[76:79], v[224:227]
    s_waitcnt lgkmcnt(14)
    v_mfma_f32_16x16x32_bf16 v[132:135], a[132:135], a[64:67], v[132:135]
    ds_read_b64_tr_b16 a[164:165], v9 offset:8192
    buffer_load_dwordx4 a[56:59], v23, s[56:59], s68 offen sc1
    v_mfma_f32_16x16x32_bf16 v[164:167], a[132:135], a[68:71], v[164:167]
    ds_read_b64_tr_b16 a[166:167], v9 offset:12288
    v_mfma_f32_16x16x32_bf16 v[196:199], a[132:135], a[72:75], v[196:199]
    buffer_load_dwordx4 a[60:63], v24, s[56:59], s68 offen sc1
    v_mfma_f32_16x16x32_bf16 v[228:231], a[132:135], a[76:79], v[228:231]
    ds_read_b64_tr_b16 a[168:169], v10 offset:8192
    s_waitcnt lgkmcnt(15)
    v_mfma_f32_16x16x32_bf16 v[136:139], a[136:139], a[64:67], v[136:139]
    ds_read_b64_tr_b16 a[170:171], v10 offset:12288
    s_add_u32 s68, s68, 16384
    v_mfma_f32_16x16x32_bf16 v[168:171], a[136:139], a[68:71], v[168:171]
    v_mfma_f32_16x16x32_bf16 v[200:203], a[136:139], a[72:75], v[200:203]
    ds_read_b64_tr_b16 a[172:173], v11 offset:8192
    v_mfma_f32_16x16x32_bf16 v[232:235], a[136:139], a[76:79], v[232:235]
    ds_read_b64_tr_b16 a[174:175], v11 offset:12288
    s_waitcnt lgkmcnt(15)
    v_mfma_f32_16x16x32_bf16 v[140:143], a[140:143], a[64:67], v[140:143]
    v_mfma_f32_16x16x32_bf16 v[172:175], a[140:143], a[68:71], v[172:175]
    ds_read_b64_tr_b16 a[176:177], v12 offset:8192
    v_mfma_f32_16x16x32_bf16 v[204:207], a[140:143], a[72:75], v[204:207]
    ds_read_b64_tr_b16 a[178:179], v12 offset:12288
    v_mfma_f32_16x16x32_bf16 v[236:239], a[140:143], a[76:79], v[236:239]
    s_waitcnt lgkmcnt(15)
    v_mfma_f32_16x16x32_bf16 v[144:147], a[144:147], a[64:67], v[144:147]
    ds_read_b64_tr_b16 a[180:181], v13 offset:8192
    v_mfma_f32_16x16x32_bf16 v[176:179], a[144:147], a[68:71], v[176:179]
    ds_read_b64_tr_b16 a[182:183], v13 offset:12288
    v_mfma_f32_16x16x32_bf16 v[208:211], a[144:147], a[72:75], v[208:211]
    v_mfma_f32_16x16x32_bf16 v[240:243], a[144:147], a[76:79], v[240:243]
    ds_read_b64_tr_b16 a[184:185], v14 offset:8192
    s_waitcnt lgkmcnt(15)
    v_mfma_f32_16x16x32_bf16 v[148:151], a[148:151], a[64:67], v[148:151]
    ds_read_b64_tr_b16 a[186:187], v14 offset:12288
    v_mfma_f32_16x16x32_bf16 v[180:183], a[148:151], a[68:71], v[180:183]
    v_mfma_f32_16x16x32_bf16 v[212:215], a[148:151], a[72:75], v[212:215]
    ds_read_b64_tr_b16 a[188:189], v15 offset:8192
    v_mfma_f32_16x16x32_bf16 v[244:247], a[148:151], a[76:79], v[244:247]
    ds_read_b64_tr_b16 a[190:191], v15 offset:12288
    v_mfma_f32_16x16x32_bf16 v[152:155], a[152:155], a[64:67], v[152:155]
    v_mfma_f32_16x16x32_bf16 v[184:187], a[152:155], a[68:71], v[184:187]
    v_mfma_f32_16x16x32_bf16 v[216:219], a[152:155], a[72:75], v[216:219]
    v_mfma_f32_16x16x32_bf16 v[248:251], a[152:155], a[76:79], v[248:251]
    s_waitcnt lgkmcnt(15)
    v_mfma_f32_16x16x32_bf16 v[156:159], a[156:159], a[64:67], v[156:159]
    v_mfma_f32_16x16x32_bf16 v[188:191], a[156:159], a[68:71], v[188:191]
    v_mfma_f32_16x16x32_bf16 v[220:223], a[156:159], a[72:75], v[220:223]
    v_mfma_f32_16x16x32_bf16 v[252:255], a[156:159], a[76:79], v[252:255]
    s_waitcnt vmcnt(43) lgkmcnt(14)
    v_mfma_f32_16x16x32_bf16 v[128:131], a[160:163], a[80:83], v[128:131]
    v_readfirstlane_b32 s86, v44
    s_cmp_eq_u32 s86, 64
    s_cbranch_scc0 L_spO
L_okO:
    buffer_load_dwordx4 a[64:67], v16, s[56:59], s69 offen offset:0 sc1
    s_waitcnt vmcnt(43)
    v_mfma_f32_16x16x32_bf16 v[160:163], a[160:163], a[84:87], v[160:163]
    ds_read_b64_tr_b16 a[128:129], v8 offset:16384
    s_waitcnt vmcnt(42)
    v_mfma_f32_16x16x32_bf16 v[192:195], a[160:163], a[88:91], v[192:195]
    ds_read_b64_tr_b16 a[130:131], v8 offset:20480
    buffer_load_dwordx4 a[68:71], v16, s[56:59], s69 offen offset:1024 sc1
    s_waitcnt vmcnt(42)
    v_mfma_f32_16x16x32_bf16 v[224:227], a[160:163], a[92:95], v[224:227]
    s_waitcnt lgkmcnt(14)
    v_mfma_f32_16x16x32_bf16 v[132:135], a[164:167], a[80:83], v[132:135]
    ds_read_b64_tr_b16 a[132:133], v9 offset:16384
    buffer_load_dwordx4 a[72:75], v16, s[56:59], s69 offen offset:2048 sc1
    v_mfma_f32_16x16x32_bf16 v[164:167], a[164:167], a[84:87], v[164:167]
    ds_read_b64_tr_b16 a[134:135], v9 offset:20480
    v_mfma_f32_16x16x32_bf16 v[196:199], a[164:167], a[88:91], v[196:199]
    buffer_load_dwordx4 a[76:79], v16, s[56:59], s69 offen offset:3072 sc1
    v_mfma_f32_16x16x32_bf16 v[228:231], a[164:167], a[92:95], v[228:231]
    ds_read_b64_tr_b16 a[136:137], v10 offset:16384
    s_waitcnt lgkmcnt(15)
    v_mfma_f32_16x16x32_bf16 v[136:139], a[168:171], a[80:83], v[136:139]
    ds_read_b64_tr_b16 a[138:139], v10 offset:20480
    s_add_u32 s69, s69, 4096
    v_mfma_f32_16x16x32_bf16 v[168:171], a[168:171], a[84:87], v[168:171]
    v_mfma_f32_16x16x32_bf16 v[200:203], a[168:171], a[88:91], v[200:203]
    ds_read_b64_tr_b16 a[140:141], v11 offset:16384
    v_mfma_f32_16x16x32_bf16 v[232:235], a[168:171], a[92:95], v[232:235]
    ds_read_b64_tr_b16 a[142:143], v11 offset:20480
    s_waitcnt lgkmcnt(15)
    v_mfma_f32_16x16x32_bf16 v[140:143], a[172:175], a[80:83], v[140:143]
    v_mfma_f32_16x16x32_bf16 v[172:175], a[172:175], a[84:87], v[172:175]
    ds_read_b64_tr_b16 a[144:145], v12 offset:16384
    v_mfma_f32_16x16x32_bf16 v[204:207], a[172:175], a[88:91], v[204:207]
    ds_read_b64_tr_b16 a[146:147], v12 offset:20480
    v_mfma_f32_16x16x32_bf16 v[236:239], a[172:175], a[92:95], v[236:239]
    s_waitcnt lgkmcnt(15)
    v_mfma_f32_16x16x32_bf16 v[144:147], a[176:179], a[80:83], v[144:147]
    ds_read_b64_tr_b16 a[148:149], v13 offset:16384
    v_mfma_f32_16x16x32_bf16 v[176:179], a[176:179], a[84:87], v[176:179]
    ds_read_b64_tr_b16 a[150:151], v13 offset:20480
    v_mfma_f32_16x16x32_bf16 v[208:211], a[176:179], a[88:91], v[208:211]
    v_mfma_f32_16x16x32_bf16 v[240:243], a[176:179], a[92:95], v[240:243]
    ds_read_b64_tr_b16 a[152:153], v14 offset:16384
    s_waitcnt lgkmcnt(15)
    v_mfma_f32_16x16x32_bf16 v[148:151], a[180:183], a[80:83], v[148:151]
    ds_read_b64_tr_b16 a[154:155], v14 offset:20480
    v_mfma_f32_16x16x32_bf16 v[180:183], a[180:183], a[84:87], v[180:183]
    v_mfma_f32_16x16x32_bf16 v[212:215], a[180:183], a[88:91], v[212:215]
    ds_read_b64_tr_b16 a[156:157], v15 offset:16384
    v_mfma_f32_16x16x32_bf16 v[244:247], a[180:183], a[92:95], v[244:247]
    ds_read_b64_tr_b16 a[158:159], v15 offset:20480
    v_mfma_f32_16x16x32_bf16 v[152:155], a[184:187], a[80:83], v[152:155]
    v_mfma_f32_16x16x32_bf16 v[184:187], a[184:187], a[84:87], v[184:187]
    v_mfma_f32_16x16x32_bf16 v[216:219], a[184:187], a[88:91], v[216:219]
    v_mfma_f32_16x16x32_bf16 v[248:251], a[184:187], a[92:95], v[248:251]
    s_waitcnt lgkmcnt(15)
    v_mfma_f32_16x16x32_bf16 v[156:159], a[188:191], a[80:83], v[156:159]
    v_mfma_f32_16x16x32_bf16 v[188:191], a[188:191], a[84:87], v[188:191]
    v_mfma_f32_16x16x32_bf16 v[220:223], a[188:191], a[88:91], v[220:223]
    v_mfma_f32_16x16x32_bf16 v[252:255], a[188:191], a[92:95], v[252:255]
    s_waitcnt vmcnt(43) lgkmcnt(14)
    v_mfma_f32_16x16x32_bf16 v[128:131], a[128:131], a[96:99], v[128:131]
    buffer_load_dwordx4 a[80:83], v16, s[56:59], s69 offen offset:0 sc1
    s_waitcnt vmcnt(43)
    v_mfma_f32_16x16x32_bf16 v[160:163], a[128:131], a[100:103], v[160:163]
    ds_read_b64_tr_b16 a[160:161], v8 offset:24576
    s_waitcnt vmcnt(42)
    v_mfma_f32_16x16x32_bf16 v[192:195], a[128:131], a[104:107], v[192:195]
    ds_read_b64_tr_b16 a[162:163], v8 offset:28672
    buffer_load_dwordx4 a[84:87], v16, s[56:59], s69 offen offset:1024 sc1
    s_waitcnt vmcnt(42)
    v_mfma_f32_16x16x32_bf16 v[224:227], a[128:131], a[108:111], v[224:227]
    s_waitcnt lgkmcnt(14)
    v_mfma_f32_16x16x32_bf16 v[132:135], a[132:135], a[96:99], v[132:135]
    ds_read_b64_tr_b16 a[164:165], v9 offset:24576
    buffer_load_dwordx4 a[88:91], v16, s[56:59], s69 offen offset:2048 sc1
    v_mfma_f32_16x16x32_bf16 v[164:167], a[132:135], a[100:103], v[164:167]
    ds_read_b64_tr_b16 a[166:167], v9 offset:28672
    v_mfma_f32_16x16x32_bf16 v[196:199], a[132:135], a[104:107], v[196:199]
    buffer_load_dwordx4 a[92:95], v16, s[56:59], s69 offen offset:3072 sc1
    v_mfma_f32_16x16x32_bf16 v[228:231], a[132:135], a[108:111], v[228:231]
    ds_read_b64_tr_b16 a[168:169], v10 offset:24576
    s_waitcnt lgkmcnt(15)
    v_mfma_f32_16x16x32_bf16 v[136:139], a[136:139], a[96:99], v[136:139]
    ds_read_b64_tr_b16 a[170:171], v10 offset:28672
    s_add_u32 s69, s69, 4096
    v_mfma_f32_16x16x32_bf16 v[168:171], a[136:139], a[100:103], v[168:171]
    v_mfma_f32_16x16x32_bf16 v[200:203], a[136:139], a[104:107], v[200:203]
    ds_read_b64_tr_b16 a[172:173], v11 offset:24576
    v_mfma_f32_16x16x32_bf16 v[232:235], a[136:139], a[108:111], v[232:235]
    ds_read_b64_tr_b16 a[174:175], v11 offset:28672
    s_waitcnt lgkmcnt(15)
    v_mfma_f32_16x16x32_bf16 v[140:143], a[140:143], a[96:99], v[140:143]
    v_mfma_f32_16x16x32_bf16 v[172:175], a[140:143], a[100:103], v[172:175]
    ds_read_b64_tr_b16 a[176:177], v12 offset:24576
    v_mfma_f32_16x16x32_bf16 v[204:207], a[140:143], a[104:107], v[204:207]
    ds_read_b64_tr_b16 a[178:179], v12 offset:28672
    v_mfma_f32_16x16x32_bf16 v[236:239], a[140:143], a[108:111], v[236:239]
    s_waitcnt lgkmcnt(15)
    v_mfma_f32_16x16x32_bf16 v[144:147], a[144:147], a[96:99], v[144:147]
    ds_read_b64_tr_b16 a[180:181], v13 offset:24576
    v_mfma_f32_16x16x32_bf16 v[176:179], a[144:147], a[100:103], v[176:179]
    ds_read_b64_tr_b16 a[182:183], v13 offset:28672
    v_mfma_f32_16x16x32_bf16 v[208:211], a[144:147], a[104:107], v[208:211]
    v_mfma_f32_16x16x32_bf16 v[240:243], a[144:147], a[108:111], v[240:243]
    ds_read_b64_tr_b16 a[184:185], v14 offset:24576
    s_waitcnt lgkmcnt(15)
    v_mfma_f32_16x16x32_bf16 v[148:151], a[148:151], a[96:99], v[148:151]
    ds_read_b64_tr_b16 a[186:187], v14 offset:28672
    v_mfma_f32_16x16x32_bf16 v[180:183], a[148:151], a[100:103], v[180:183]
    v_mfma_f32_16x16x32_bf16 v[212:215], a[148:151], a[104:107], v[212:215]
    ds_read_b64_tr_b16 a[188:189], v15 offset:24576
    v_mfma_f32_16x16x32_bf16 v[244:247], a[148:151], a[108:111], v[244:247]
    ds_read_b64_tr_b16 a[190:191], v15 offset:28672
    v_mfma_f32_16x16x32_bf16 v[152:155], a[152:155], a[96:99], v[152:155]
    v_mfma_f32_16x16x32_bf16 v[184:187], a[152:155], a[100:103], v[184:187]
    v_mfma_f32_16x16x32_bf16 v[216:219], a[152:155], a[104:107], v[216:219]
    v_mfma_f32_16x16x32_bf16 v[248:251], a[152:155], a[108:111], v[248:251]
    s_waitcnt lgkmcnt(15)
    v_mfma_f32_16x16x32_bf16 v[156:159], a[156:159], a[96:99], v[156:159]
    v_mfma_f32_16x16x32_bf16 v[188:191], a[156:159], a[100:103], v[188:191]
    v_mfma_f32_16x16x32_bf16 v[220:223], a[156:159], a[104:107], v[220:223]
    v_mfma_f32_16x16x32_bf16 v[252:255], a[156:159], a[108:111], v[252:255]
    s_waitcnt vmcnt(43) lgkmcnt(14)
    v_mfma_f32_16x16x32_bf16 v[128:131], a[160:163], a[112:115], v[128:131]
    buffer_load_dwordx4 a[96:99], v16, s[56:59], s69 offen offset:0 sc1
    s_waitcnt vmcnt(43)
    v_mfma_f32_16x16x32_bf16 v[160:163], a[160:163], a[116:119], v[160:163]
    ds_read_b64_tr_b16 a[128:129], v8 offset:32768
    s_waitcnt vmcnt(42)
    v_mfma_f32_16x16x32_bf16 v[192:195], a[160:163], a[120:123], v[192:195]
    ds_read_b64_tr_b16 a[130:131], v8 offset:36864
    buffer_load_dwordx4 a[100:103], v16, s[56:59], s69 offen offset:1024 sc1
    s_waitcnt vmcnt(42)
    v_mfma_f32_16x16x32_bf16 v[224:227], a[160:163], a[124:127], v[224:227]
    s_waitcnt lgkmcnt(14)
    v_mfma_f32_16x16x32_bf16 v[132:135], a[164:167], a[112:115], v[132:135]
    ds_read_b64_tr_b16 a[132:133], v9 offset:32768
    buffer_load_dwordx4 a[104:107], v16, s[56:59], s69 offen offset:2048 sc1
    v_mfma_f32_16x16x32_bf16 v[164:167], a[164:167], a[116:119], v[164:167]
    ds_read_b64_tr_b16 a[134:135], v9 offset:36864
    v_mfma_f32_16x16x32_bf16 v[196:199], a[164:167], a[120:123], v[196:199]
    buffer_load_dwordx4 a[108:111], v16, s[56:59], s69 offen offset:3072 sc1
    v_mfma_f32_16x16x32_bf16 v[228:231], a[164:167], a[124:127], v[228:231]
    ds_read_b64_tr_b16 a[136:137], v10 offset:32768
    s_waitcnt lgkmcnt(15)
    v_mfma_f32_16x16x32_bf16 v[136:139], a[168:171], a[112:115], v[136:139]
    ds_read_b64_tr_b16 a[138:139], v10 offset:36864
    s_add_u32 s69, s69, 4096
    v_mfma_f32_16x16x32_bf16 v[168:171], a[168:171], a[116:119], v[168:171]
    v_mfma_f32_16x16x32_bf16 v[200:203], a[168:171], a[120:123], v[200:203]
    ds_read_b64_tr_b16 a[140:141], v11 offset:32768
    v_mfma_f32_16x16x32_bf16 v[232:235], a[168:171], a[124:127], v[232:235]
    ds_read_b64_tr_b16 a[142:143], v11 offset:36864
    s_waitcnt lgkmcnt(15)
    v_mfma_f32_16x16x32_bf16 v[140:143], a[172:175], a[112:115], v[140:143]
    v_mfma_f32_16x16x32_bf16 v[172:175], a[172:175], a[116:119], v[172:175]
    ds_read_b64_tr_b16 a[144:145], v12 offset:32768
    v_mfma_f32_16x16x32_bf16 v[204:207], a[172:175], a[120:123], v[204:207]
    ds_read_b64_tr_b16 a[146:147], v12 offset:36864
    v_mfma_f32_16x16x32_bf16 v[236:239], a[172:175], a[124:127], v[236:239]
    s_waitcnt lgkmcnt(15)
    v_mfma_f32_16x16x32_bf16 v[144:147], a[176:179], a[112:115], v[144:147]
    ds_read_b64_tr_b16 a[148:149], v13 offset:32768
    v_mfma_f32_16x16x32_bf16 v[176:179], a[176:179], a[116:119], v[176:179]
    ds_read_b64_tr_b16 a[150:151], v13 offset:36864
    v_mfma_f32_16x16x32_bf16 v[208:211], a[176:179], a[120:123], v[208:211]
    v_mfma_f32_16x16x32_bf16 v[240:243], a[176:179], a[124:127], v[240:243]
    ds_read_b64_tr_b16 a[152:153], v14 offset:32768
    s_waitcnt lgkmcnt(15)
    v_mfma_f32_16x16x32_bf16 v[148:151], a[180:183], a[112:115], v[148:151]
    ds_read_b64_tr_b16 a[154:155], v14 offset:36864
    v_mfma_f32_16x16x32_bf16 v[180:183], a[180:183], a[116:119], v[180:183]
    v_mfma_f32_16x16x32_bf16 v[212:215], a[180:183], a[120:123], v[212:215]
    ds_read_b64_tr_b16 a[156:157], v15 offset:32768
    v_mfma_f32_16x16x32_bf16 v[244:247], a[180:183], a[124:127], v[244:247]
    ds_read_b64_tr_b16 a[158:159], v15 offset:36864
    v_mfma_f32_16x16x32_bf16 v[152:155], a[184:187], a[112:115], v[152:155]
    v_mfma_f32_16x16x32_bf16 v[184:187], a[184:187], a[116:119], v[184:187]
    v_mfma_f32_16x16x32_bf16 v[216:219], a[184:187], a[120:123], v[216:219]
    v_mfma_f32_16x16x32_bf16 v[248:251], a[184:187], a[124:127], v[248:251]
    s_waitcnt lgkmcnt(15)
    v_mfma_f32_16x16x32_bf16 v[156:159], a[188:191], a[112:115], v[156:159]
    v_mfma_f32_16x16x32_bf16 v[188:191], a[188:191], a[116:119], v[188:191]
    v_mfma_f32_16x16x32_bf16 v[220:223], a[188:191], a[120:123], v[220:223]
    v_mfma_f32_16x16x32_bf16 v[252:255], a[188:191], a[124:127], v[252:255]
    s_waitcnt vmcnt(16)
    s_barrier
    s_waitcnt lgkmcnt(14)
    v_mfma_f32_16x16x32_bf16 v[128:131], a[128:131], a[0:3], v[128:131]
    buffer_load_dwordx4 a[112:115], v16, s[56:59], s69 offen offset:0 sc1
    v_mfma_f32_16x16x32_bf16 v[160:163], a[128:131], a[4:7], v[160:163]
    ds_read_b64_tr_b16 a[160:161], v8 offset:40960
    v_mfma_f32_16x16x32_bf16 v[192:195], a[128:131], a[8:11], v[192:195]
    ds_read_b64_tr_b16 a[162:163], v8 offset:45056
    buffer_load_dwordx4 a[116:119], v16, s[56:59], s69 offen offset:1024 sc1
    v_mfma_f32_16x16x32_bf16 v[224:227], a[128:131], a[12:15], v[224:227]
    s_waitcnt lgkmcnt(14)
    v_mfma_f32_16x16x32_bf16 v[132:135], a[132:135], a[0:3], v[132:135]
    ds_read_b64_tr_b16 a[164:165], v9 offset:40960
    buffer_load_dwordx4 a[120:123], v16, s[56:59], s69 offen offset:2048 sc1
    v_mfma_f32_16x16x32_bf16 v[164:167], a[132:135], a[4:7], v[164:167]
    ds_read_b64_tr_b16 a[166:167], v9 offset:45056
    v_mfma_f32_16x16x32_bf16 v[196:199], a[132:135], a[8:11], v[196:199]
    buffer_load_dwordx4 a[124:127], v16, s[56:59], s69 offen offset:3072 sc1
    v_mfma_f32_16x16x32_bf16 v[228:231], a[132:135], a[12:15], v[228:231]
    ds_read_b64_tr_b16 a[168:169], v10 offset:40960
    s_waitcnt lgkmcnt(15)
    v_mfma_f32_16x16x32_bf16 v[136:139], a[136:139], a[0:3], v[136:139]
    ds_read_b64_tr_b16 a[170:171], v10 offset:45056
    s_add_u32 s69, s69, 4096
    v_mfma_f32_16x16x32_bf16 v[168:171], a[136:139], a[4:7], v[168:171]
    v_mfma_f32_16x16x32_bf16 v[200:203], a[136:139], a[8:11], v[200:203]
    ds_read_b64_tr_b16 a[172:173], v11 offset:40960
    v_mfma_f32_16x16x32_bf16 v[232:235], a[136:139], a[12:15], v[232:235]
    ds_read_b64_tr_b16 a[174:175], v11 offset:45056
    s_mov_b32 s82, 524288
    s_add_u32 m0, s3, 131072
    s_waitcnt lgkmcnt(15)
    v_mfma_f32_16x16x32_bf16 v[140:143], a[140:143], a[0:3], v[140:143]
    buffer_load_dwordx4 v17, s[52:55], s82 offen lds
    v_mfma_f32_16x16x32_bf16 v[172:175], a[140:143], a[4:7], v[172:175]
    ds_read_b64_tr_b16 a[176:177], v12 offset:40960
    v_mfma_f32_16x16x32_bf16 v[204:207], a[140:143], a[8:11], v[204:207]
    ds_read_b64_tr_b16 a[178:179], v12 offset:45056
    v_mfma_f32_16x16x32_bf16 v[236:239], a[140:143], a[12:15], v[236:239]
    s_waitcnt lgkmcnt(15)
    v_mfma_f32_16x16x32_bf16 v[144:147], a[144:147], a[0:3], v[144:147]
    ds_read_b64_tr_b16 a[180:181], v13 offset:40960
    buffer_load_dwordx4 v18, s[52:55], s82 offen offset:1024 lds
    v_mfma_f32_16x16x32_bf16 v[176:179], a[144:147], a[4:7], v[176:179]
    ds_read_b64_tr_b16 a[182:183], v13 offset:45056
    v_mfma_f32_16x16x32_bf16 v[208:211], a[144:147], a[8:11], v[208:211]
    v_mfma_f32_16x16x32_bf16 v[240:243], a[144:147], a[12:15], v[240:243]
    ds_read_b64_tr_b16 a[184:185], v14 offset:40960
    s_waitcnt lgkmcnt(15)
    v_mfma_f32_16x16x32_bf16 v[148:151], a[148:151], a[0:3], v[148:151]
    ds_read_b64_tr_b16 a[186:187], v14 offset:45056
    v_mfma_f32_16x16x32_bf16 v[180:183], a[148:151], a[4:7], v[180:183]
    s_mov_b32 s83, 589824
    s_add_u32 m0, s3, 139264
    v_mfma_f32_16x16x32_bf16 v[212:215], a[148:151], a[8:11], v[212:215]
    ds_read_b64_tr_b16 a[188:189], v15 offset:40960
    buffer_load_dwordx4 v17, s[52:55], s83 offen lds
    v_mfma_f32_16x16x32_bf16 v[244:247], a[148:151], a[12:15], v[244:247]
    ds_read_b64_tr_b16 a[190:191], v15 offset:45056
    v_mfma_f32_16x16x32_bf16 v[152:155], a[152:155], a[0:3], v[152:155]
    v_mfma_f32_16x16x32_bf16 v[184:187], a[152:155], a[4:7], v[184:187]
    v_mfma_f32_16x16x32_bf16 v[216:219], a[152:155], a[8:11], v[216:219]
    buffer_load_dwordx4 v18, s[52:55], s83 offen offset:1024 lds
    v_mfma_f32_16x16x32_bf16 v[248:251], a[152:155], a[12:15], v[248:251]
    s_waitcnt lgkmcnt(15)
    v_mfma_f32_16x16x32_bf16 v[156:159], a[156:159], a[0:3], v[156:159]
    v_mfma_f32_16x16x32_bf16 v[188:191], a[156:159], a[4:7], v[188:191]
    v_mfma_f32_16x16x32_bf16 v[220:223], a[156:159], a[8:11], v[220:223]
    v_mfma_f32_16x16x32_bf16 v[252:255], a[156:159], a[12:15], v[252:255]
    s_waitcnt lgkmcnt(14)
    v_mfma_f32_16x16x32_bf16 v[128:131], a[160:163], a[16:19], v[128:131]
    buffer_load_dwordx4 a[0:3], v16, s[56:59], s69 offen offset:0 sc1
    v_mfma_f32_16x16x32_bf16 v[160:163], a[160:163], a[20:23], v[160:163]
    ds_read_b64_tr_b16 a[128:129], v8 offset:49152
    v_mfma_f32_16x16x32_bf16 v[192:195], a[160:163], a[24:27], v[192:195]
    ds_read_b64_tr_b16 a[130:131], v8 offset:53248
    buffer_load_dwordx4 a[4:7], v16, s[56:59], s69 offen offset:1024 sc1
    v_mfma_f32_16x16x32_bf16 v[224:227], a[160:163], a[28:31], v[224:227]
    s_waitcnt lgkmcnt(14)
    v_mfma_f32_16x16x32_bf16 v[132:135], a[164:167], a[16:19], v[132:135]
    ds_read_b64_tr_b16 a[132:133], v9 offset:49152
    buffer_load_dwordx4 a[8:11], v16, s[56:59], s69 offen offset:2048 sc1
    v_mfma_f32_16x16x32_bf16 v[164:167], a[164:167], a[20:23], v[164:167]
    ds_read_b64_tr_b16 a[134:135], v9 offset:53248
    v_mfma_f32_16x16x32_bf16 v[196:199], a[164:167], a[24:27], v[196:199]
    buffer_load_dwordx4 a[12:15], v16, s[56:59], s69 offen offset:3072 sc1
    v_mfma_f32_16x16x32_bf16 v[228:231], a[164:167], a[28:31], v[228:231]
    ds_read_b64_tr_b16 a[136:137], v10 offset:49152
    s_waitcnt lgkmcnt(15)
    v_mfma_f32_16x16x32_bf16 v[136:139], a[168:171], a[16:19], v[136:139]
    ds_read_b64_tr_b16 a[138:139], v10 offset:53248
    s_add_u32 s69, s69, 4096
    v_mfma_f32_16x16x32_bf16 v[168:171], a[168:171], a[20:23], v[168:171]
    v_mfma_f32_16x16x32_bf16 v[200:203], a[168:171], a[24:27], v[200:203]
    ds_read_b64_tr_b16 a[140:141], v11 offset:49152
    v_mfma_f32_16x16x32_bf16 v[232:235], a[168:171], a[28:31], v[232:235]
    ds_read_b64_tr_b16 a[142:143], v11 offset:53248
    s_mov_b32 s82, 655360
    s_add_u32 m0, s3, 147456
    s_waitcnt lgkmcnt(15)
    v_mfma_f32_16x16x32_bf16 v[140:143], a[172:175], a[16:19], v[140:143]
    buffer_load_dwordx4 v17, s[52:55], s82 offen lds
    v_mfma_f32_16x16x32_bf16 v[172:175], a[172:175], a[20:23], v[172:175]
    ds_read_b64_tr_b16 a[144:145], v12 offset:49152
    v_mfma_f32_16x16x32_bf16 v[204:207], a[172:175], a[24:27], v[204:207]
    ds_read_b64_tr_b16 a[146:147], v12 offset:53248
    v_mfma_f32_16x16x32_bf16 v[236:239], a[172:175], a[28:31], v[236:239]
    s_waitcnt lgkmcnt(15)
    v_mfma_f32_16x16x32_bf16 v[144:147], a[176:179], a[16:19], v[144:147]
    ds_read_b64_tr_b16 a[148:149], v13 offset:49152
    buffer_load_dwordx4 v18, s[52:55], s82 offen offset:1024 lds
    v_mfma_f32_16x16x32_bf16 v[176:179], a[176:179], a[20:23], v[176:179]
    ds_read_b64_tr_b16 a[150:151], v13 offset:53248
    v_mfma_f32_16x16x32_bf16 v[208:211], a[176:179], a[24:27], v[208:211]
    v_mfma_f32_16x16x32_bf16 v[240:243], a[176:179], a[28:31], v[240:243]
    ds_read_b64_tr_b16 a[152:153], v14 offset:49152
    s_waitcnt lgkmcnt(15)
    v_mfma_f32_16x16x32_bf16 v[148:151], a[180:183], a[16:19], v[148:151]
    ds_read_b64_tr_b16 a[154:155], v14 offset:53248
    v_mfma_f32_16x16x32_bf16 v[180:183], a[180:183], a[20:23], v[180:183]
    s_mov_b32 s83, 720896
    s_add_u32 m0, s3, 155648
    v_mfma_f32_16x16x32_bf16 v[212:215], a[180:183], a[24:27], v[212:215]
    ds_read_b64_tr_b16 a[156:157], v15 offset:49152
    buffer_load_dwordx4 v17, s[52:55], s83 offen lds
    v_mfma_f32_16x16x32_bf16 v[244:247], a[180:183], a[28:31], v[244:247]
    ds_read_b64_tr_b16 a[158:159], v15 offset:53248
    v_mfma_f32_16x16x32_bf16 v[152:155], a[184:187], a[16:19], v[152:155]
    v_mfma_f32_16x16x32_bf16 v[184:187], a[184:187], a[20:23], v[184:187]
    v_mfma_f32_16x16x32_bf16 v[216:219], a[184:187], a[24:27], v[216:219]
    buffer_load_dwordx4 v18, s[52:55], s83 offen offset:1024 lds
    v_mfma_f32_16x16x32_bf16 v[248:251], a[184:187], a[28:31], v[248:251]
    s_waitcnt lgkmcnt(15)
    v_mfma_f32_16x16x32_bf16 v[156:159], a[188:191], a[16:19], v[156:159]
    v_mfma_f32_16x16x32_bf16 v[188:191], a[188:191], a[20:23], v[188:191]
    v_mfma_f32_16x16x32_bf16 v[220:223], a[188:191], a[24:27], v[220:223]
    v_mfma_f32_16x16x32_bf16 v[252:255], a[188:191], a[28:31], v[252:255]
    s_waitcnt lgkmcnt(14)
    v_mfma_f32_16x16x32_bf16 v[128:131], a[128:131], a[32:35], v[128:131]
    buffer_load_dwordx4 a[16:19], v16, s[56:59], s69 offen offset:0 sc1
    v_mfma_f32_16x16x32_bf16 v[160:163], a[128:131], a[36:39], v[160:163]
    ds_read_b64_tr_b16 a[160:161], v8 offset:57344
    v_mfma_f32_16x16x32_bf16 v[192:195], a[128:131], a[40:43], v[192:195]
    ds_read_b64_tr_b16 a[162:163], v8 offset:61440
    buffer_load_dwordx4 a[20:23], v16, s[56:59], s69 offen offset:1024 sc1
    v_mfma_f32_16x16x32_bf16 v[224:227], a[128:131], a[44:47], v[224:227]
    s_waitcnt lgkmcnt(14)
    v_mfma_f32_16x16x32_bf16 v[132:135], a[132:135], a[32:35], v[132:135]
    ds_read_b64_tr_b16 a[164:165], v9 offset:57344
    buffer_load_dwordx4 a[24:27], v16, s[56:59], s69 offen offset:2048 sc1
    v_mfma_f32_16x16x32_bf16 v[164:167], a[132:135], a[36:39], v[164:167]
    ds_read_b64_tr_b16 a[166:167], v9 offset:61440
    v_mfma_f32_16x16x32_bf16 v[196:199], a[132:135], a[40:43], v[196:199]
    buffer_load_dwordx4 a[28:31], v16, s[56:59], s69 offen offset:3072 sc1
    v_mfma_f32_16x16x32_bf16 v[228:231], a[132:135], a[44:47], v[228:231]
    ds_read_b64_tr_b16 a[168:169], v10 offset:57344
    s_waitcnt lgkmcnt(15)
    v_mfma_f32_16x16x32_bf16 v[136:139], a[136:139], a[32:35], v[136:139]
    ds_read_b64_tr_b16 a[170:171], v10 offset:61440
    s_add_u32 s69, s69, 4096
    v_mfma_f32_16x16x32_bf16 v[168:171], a[136:139], a[36:39], v[168:171]
    v_mfma_f32_16x16x32_bf16 v[200:203], a[136:139], a[40:43], v[200:203]
    ds_read_b64_tr_b16 a[172:173], v11 offset:57344
    v_mfma_f32_16x16x32_bf16 v[232:235], a[136:139], a[44:47], v[232:235]
    ds_read_b64_tr_b16 a[174:175], v11 offset:61440
    s_mov_b32 s82, 786432
    s_add_u32 m0, s3, 0
    s_waitcnt lgkmcnt(15)
    v_mfma_f32_16x16x32_bf16 v[140:143], a[140:143], a[32:35], v[140:143]
    buffer_load_dwordx4 v17, s[52:55], s82 offen lds
    v_mfma_f32_16x16x32_bf16 v[172:175], a[140:143], a[36:39], v[172:175]
    ds_read_b64_tr_b16 a[176:177], v12 offset:57344
    v_mfma_f32_16x16x32_bf16 v[204:207], a[140:143], a[40:43], v[204:207]
    ds_read_b64_tr_b16 a[178:179], v12 offset:61440
    v_mfma_f32_16x16x32_bf16 v[236:239], a[140:143], a[44:47], v[236:239]
    s_waitcnt lgkmcnt(15)
    v_mfma_f32_16x16x32_bf16 v[144:147], a[144:147], a[32:35], v[144:147]
    ds_read_b64_tr_b16 a[180:181], v13 offset:57344
    buffer_load_dwordx4 v18, s[52:55], s82 offen offset:1024 lds
    v_mfma_f32_16x16x32_bf16 v[176:179], a[144:147], a[36:39], v[176:179]
    ds_read_b64_tr_b16 a[182:183], v13 offset:61440
    v_mfma_f32_16x16x32_bf16 v[208:211], a[144:147], a[40:43], v[208:211]
    v_mfma_f32_16x16x32_bf16 v[240:243], a[144:147], a[44:47], v[240:243]
    ds_read_b64_tr_b16 a[184:185], v14 offset:57344
    s_waitcnt lgkmcnt(15)
    v_mfma_f32_16x16x32_bf16 v[148:151], a[148:151], a[32:35], v[148:151]
    ds_read_b64_tr_b16 a[186:187], v14 offset:61440
    v_mfma_f32_16x16x32_bf16 v[180:183], a[148:151], a[36:39], v[180:183]
    s_mov_b32 s83, 851968
    s_add_u32 m0, s3, 8192
    v_mfma_f32_16x16x32_bf16 v[212:215], a[148:151], a[40:43], v[212:215]
    ds_read_b64_tr_b16 a[188:189], v15 offset:57344
    buffer_load_dwordx4 v17, s[52:55], s83 offen lds
    v_mfma_f32_16x16x32_bf16 v[244:247], a[148:151], a[44:47], v[244:247]
    ds_read_b64_tr_b16 a[190:191], v15 offset:61440
    v_mfma_f32_16x16x32_bf16 v[152:155], a[152:155], a[32:35], v[152:155]
    v_mfma_f32_16x16x32_bf16 v[184:187], a[152:155], a[36:39], v[184:187]
    v_mfma_f32_16x16x32_bf16 v[216:219], a[152:155], a[40:43], v[216:219]
    buffer_load_dwordx4 v18, s[52:55], s83 offen offset:1024 lds
    v_mfma_f32_16x16x32_bf16 v[248:251], a[152:155], a[44:47], v[248:251]
    s_waitcnt lgkmcnt(15)
    v_mfma_f32_16x16x32_bf16 v[156:159], a[156:159], a[32:35], v[156:159]
    v_mfma_f32_16x16x32_bf16 v[188:191], a[156:159], a[36:39], v[188:191]
    v_mfma_f32_16x16x32_bf16 v[220:223], a[156:159], a[40:43], v[220:223]
    v_mfma_f32_16x16x32_bf16 v[252:255], a[156:159], a[44:47], v[252:255]
    s_waitcnt vmcnt(38) lgkmcnt(14)
    v_mfma_f32_16x16x32_bf16 v[160:163], a[160:163], a[52:55], v[160:163]
    buffer_load_dwordx4 a[32:35], v16, s[56:59], s69 offen offset:0 sc1
    s_waitcnt lgkmcnt(12)
    v_mfma_f32_16x16x32_bf16 v[164:167], a[164:167], a[52:55], v[164:167]
    ds_read_b64_tr_b16 a[128:129], v48 offset:0
    s_waitcnt lgkmcnt(11)
    v_mfma_f32_16x16x32_bf16 v[168:171], a[168:171], a[52:55], v[168:171]
    ds_read_b64_tr_b16 a[130:131], v48 offset:4096
    buffer_load_dwordx4 a[36:39], v16, s[56:59], s69 offen offset:1024 sc1
    s_waitcnt lgkmcnt(10)
    v_mfma_f32_16x16x32_bf16 v[172:175], a[172:175], a[52:55], v[172:175]
    ds_read_b64_tr_b16 a[132:133], v49 offset:0
    s_waitcnt lgkmcnt(9)
    v_mfma_f32_16x16x32_bf16 v[176:179], a[176:179], a[52:55], v[176:179]
    ds_read_b64_tr_b16 a[134:135], v49 offset:4096
    buffer_load_dwordx4 a[40:43], v16, s[56:59], s69 offen offset:2048 sc1
    s_waitcnt lgkmcnt(8)
    v_mfma_f32_16x16x32_bf16 v[180:183], a[180:183], a[52:55], v[180:183]
    ds_read_b64_tr_b16 a[136:137], v50 offset:0
    s_waitcnt lgkmcnt(7)
    v_mfma_f32_16x16x32_bf16 v[184:187], a[184:187], a[52:55], v[184:187]
    ds_read_b64_tr_b16 a[138:139], v50 offset:4096
    buffer_load_dwordx4 a[44:47], v16, s[56:59], s69 offen offset:3072 sc1
    s_waitcnt lgkmcnt(6)
    v_mfma_f32_16x16x32_bf16 v[188:191], a[188:191], a[52:55], v[188:191]
    ds_read_b64_tr_b16 a[140:141], v51 offset:0
    s_waitcnt vmcnt(41)
    v_mfma_f32_16x16x32_bf16 v[192:195], a[160:163], a[56:59], v[192:195]
    ds_read_b64_tr_b16 a[142:143], v51 offset:4096
    s_add_u32 s69, s69, 4096
    v_mfma_f32_16x16x32_bf16 v[196:199], a[164:167], a[56:59], v[196:199]
    ds_read_b64_tr_b16 a[144:145], v52 offset:0
    v_mfma_f32_16x16x32_bf16 v[200:203], a[168:171], a[56:59], v[200:203]
    ds_read_b64_tr_b16 a[146:147], v52 offset:4096
    v_mfma_f32_16x16x32_bf16 v[204:207], a[172:175], a[56:59], v[204:207]
    ds_read_b64_tr_b16 a[148:149], v53 offset:0
    s_mov_b32 s82, 917504
    s_add_u32 m0, s3, 16384
    v_mfma_f32_16x16x32_bf16 v[208:211], a[176:179], a[56:59], v[208:211]
    ds_read_b64_tr_b16 a[150:151], v53 offset:4096
    buffer_load_dwordx4 v17, s[52:55], s82 offen lds
    v_cvt_pk_bf16_f32 v160, v160, v161
    v_cvt_pk_bf16_f32 v161, v162, v163
    v_mfma_f32_16x16x32_bf16 v[212:215], a[180:183], a[56:59], v[212:215]
    ds_read_b64_tr_b16 a[152:153], v54 offset:0
    v_cvt_pk_bf16_f32 v162, v164, v165
    v_cvt_pk_bf16_f32 v163, v166, v167
    v_mfma_f32_16x16x32_bf16 v[216:219], a[184:187], a[56:59], v[216:219]
    ds_read_b64_tr_b16 a[154:155], v54 offset:4096
    buffer_store_dwordx4 v[160:163], v16, s[56:59], s70 offen offset:0 sc1
    v_cvt_pk_bf16_f32 v168, v168, v169
    v_mfma_f32_16x16x32_bf16 v[220:223], a[188:191], a[56:59], v[220:223]
    v_cvt_pk_bf16_f32 v169, v170, v171
    v_cvt_pk_bf16_f32 v170, v172, v173
    s_waitcnt vmcnt(42)
    v_mfma_f32_16x16x32_bf16 v[224:227], a[160:163], a[60:63], v[224:227]
    buffer_load_dwordx4 v18, s[52:55], s82 offen offset:1024 lds
    v_cvt_pk_bf16_f32 v171, v174, v175
    buffer_store_dwordx4 v[168:171], v16, s[56:59], s70 offen offset:1024 sc1
    v_mfma_f32_16x16x32_bf16 v[228:231], a[164:167], a[60:63], v[228:231]
    v_cvt_pk_bf16_f32 v176, v176, v177
    v_cvt_pk_bf16_f32 v177, v178, v179
    v_mfma_f32_16x16x32_bf16 v[232:235], a[168:171], a[60:63], v[232:235]
    v_cvt_pk_bf16_f32 v178, v180, v181
    v_cvt_pk_bf16_f32 v179, v182, v183
    v_mfma_f32_16x16x32_bf16 v[236:239], a[172:175], a[60:63], v[236:239]
    buffer_store_dwordx4 v[176:179], v16, s[56:59], s70 offen offset:2048 sc1
    v_cvt_pk_bf16_f32 v184, v184, v185
    v_mfma_f32_16x16x32_bf16 v[240:243], a[176:179], a[60:63], v[240:243]
    v_cvt_pk_bf16_f32 v185, v186, v187
    v_cvt_pk_bf16_f32 v186, v188, v189
    v_mfma_f32_16x16x32_bf16 v[244:247], a[180:183], a[60:63], v[244:247]
    s_mov_b32 s83, 983040
    s_add_u32 m0, s3, 24576
    v_cvt_pk_bf16_f32 v187, v190, v191
    buffer_store_dwordx4 v[184:187], v16, s[56:59], s70 offen offset:3072 sc1
    v_mfma_f32_16x16x32_bf16 v[248:251], a[184:187], a[60:63], v[248:251]
    buffer_load_dwordx4 v17, s[52:55], s83 offen lds
    v_cvt_pk_bf16_f32 v192, v192, v193
    v_cvt_pk_bf16_f32 v193, v194, v195
    v_mfma_f32_16x16x32_bf16 v[252:255], a[188:191], a[60:63], v[252:255]
    v_cvt_pk_bf16_f32 v194, v196, v197
    v_cvt_pk_bf16_f32 v195, v198, v199
    v_mfma_f32_16x16x32_bf16 v[128:131], a[160:163], a[48:51], v[128:131]
    buffer_store_dwordx4 v[192:195], v16, s[56:59], s71 offen offset:0 sc1
    v_cvt_pk_bf16_f32 v200, v200, v201
    v_mfma_f32_16x16x32_bf16 v[132:135], a[164:167], a[48:51], v[132:135]
    v_cvt_pk_bf16_f32 v201, v202, v203
    v_cvt_pk_bf16_f32 v202, v204, v205
    v_mfma_f32_16x16x32_bf16 v[136:139], a[168:171], a[48:51], v[136:139]
    buffer_load_dwordx4 v18, s[52:55], s83 offen offset:1024 lds
    v_cvt_pk_bf16_f32 v203, v206, v207
    buffer_store_dwordx4 v[200:203], v16, s[56:59], s71 offen offset:1024 sc1
    v_mfma_f32_16x16x32_bf16 v[140:143], a[172:175], a[48:51], v[140:143]
    v_cvt_pk_bf16_f32 v208, v208, v209
    v_cvt_pk_bf16_f32 v209, v210, v211
    v_mfma_f32_16x16x32_bf16 v[144:147], a[176:179], a[48:51], v[144:147]
    v_cvt_pk_bf16_f32 v210, v212, v213
    v_cvt_pk_bf16_f32 v211, v214, v215
    v_mfma_f32_16x16x32_bf16 v[148:151], a[180:183], a[48:51], v[148:151]
    buffer_store_dwordx4 v[208:211], v16, s[56:59], s71 offen offset:2048 sc1
    v_cvt_pk_bf16_f32 v216, v216, v217
    v_mfma_f32_16x16x32_bf16 v[152:155], a[184:187], a[48:51], v[152:155]
    v_cvt_pk_bf16_f32 v217, v218, v219
    v_cvt_pk_bf16_f32 v218, v220, v221
    v_mfma_f32_16x16x32_bf16 v[156:159], a[188:191], a[48:51], v[156:159]
    v_cvt_pk_bf16_f32 v219, v222, v223
    buffer_store_dwordx4 v[216:219], v16, s[56:59], s71 offen offset:3072 sc1
    s_barrier
    buffer_load_dwordx4 a[48:51], v16, s[56:59], s69 offen offset:0 sc1
    buffer_load_dwordx4 a[52:55], v16, s[56:59], s69 offen offset:1024 sc1
    buffer_load_dwordx4 a[56:59], v16, s[56:59], s69 offen offset:2048 sc1
    buffer_load_dwordx4 a[60:63], v16, s[56:59], s69 offen offset:3072 sc1
    s_add_u32 s69, s69, 4096
    s_waitcnt vmcnt(55) lgkmcnt(12)
    v_mfma_f32_16x16x32_bf16 v[96:99], a[128:131], a[64:67], 0
    ds_read_b64_tr_b16 a[156:157], v55 offset:0
    ds_read_b64_tr_b16 a[158:159], v55 offset:4096
    v_cvt_pk_bf16_f32 v224, v224, v225
    v_cvt_pk_bf16_f32 v225, v226, v227
    s_waitcnt lgkmcnt(12)
    v_mfma_f32_16x16x32_bf16 v[100:103], a[132:135], a[64:67], 0
    ds_read_b64_tr_b16 a[160:161], v48 offset:8192
    ds_read_b64_tr_b16 a[162:163], v48 offset:12288
    v_cvt_pk_bf16_f32 v226, v228, v229
    v_cvt_pk_bf16_f32 v227, v230, v231
    s_waitcnt lgkmcnt(12)
    v_mfma_f32_16x16x32_bf16 v[104:107], a[136:139], a[64:67], 0
    ds_read_b64_tr_b16 a[164:165], v49 offset:8192
    ds_read_b64_tr_b16 a[166:167], v49 offset:12288
    buffer_store_dwordx4 v[224:227], v16, s[56:59], s72 offen offset:0 sc1
    v_cvt_pk_bf16_f32 v232, v232, v233
    s_waitcnt lgkmcnt(12)
    v_mfma_f32_16x16x32_bf16 v[108:111], a[140:143], a[64:67], 0
    ds_read_b64_tr_b16 a[168:169], v50 offset:8192
    ds_read_b64_tr_b16 a[170:171], v50 offset:12288
    v_cvt_pk_bf16_f32 v233, v234, v235
    v_cvt_pk_bf16_f32 v234, v236, v237
    s_waitcnt lgkmcnt(12)
    v_mfma_f32_16x16x32_bf16 v[112:115], a[144:147], a[64:67], 0
    ds_read_b64_tr_b16 a[172:173], v51 offset:8192
    ds_read_b64_tr_b16 a[174:175], v51 offset:12288
    v_cvt_pk_bf16_f32 v235, v238, v239
    buffer_store_dwordx4 v[232:235], v16, s[56:59], s72 offen offset:1024 sc1
    s_waitcnt lgkmcnt(12)
    v_mfma_f32_16x16x32_bf16 v[116:119], a[148:151], a[64:67], 0
    ds_read_b64_tr_b16 a[176:177], v52 offset:8192
    ds_read_b64_tr_b16 a[178:179], v52 offset:12288
    v_cvt_pk_bf16_f32 v240, v240, v241
    v_cvt_pk_bf16_f32 v241, v242, v243
    s_waitcnt lgkmcnt(12)
    v_mfma_f32_16x16x32_bf16 v[120:123], a[152:155], a[64:67], 0
    ds_read_b64_tr_b16 a[180:181], v53 offset:8192
    ds_read_b64_tr_b16 a[182:183], v53 offset:12288
    v_cvt_pk_bf16_f32 v242, v244, v245
    v_cvt_pk_bf16_f32 v243, v246, v247
    s_waitcnt lgkmcnt(12)
    v_mfma_f32_16x16x32_bf16 v[124:127], a[156:159], a[64:67], 0
    ds_read_b64_tr_b16 a[184:185], v54 offset:8192
    ds_read_b64_tr_b16 a[186:187], v54 offset:12288
    buffer_store_dwordx4 v[240:243], v16, s[56:59], s72 offen offset:2048 sc1
    v_cvt_pk_bf16_f32 v248, v248, v249
    s_waitcnt vmcnt(57) lgkmcnt(12)
    v_mfma_f32_16x16x32_bf16 v[96:99], a[160:163], a[68:71], v[96:99]
    ds_read_b64_tr_b16 a[188:189], v55 offset:8192
    ds_read_b64_tr_b16 a[190:191], v55 offset:12288
    v_cvt_pk_bf16_f32 v249, v250, v251
    v_cvt_pk_bf16_f32 v250, v252, v253
    s_waitcnt lgkmcnt(12)
    v_mfma_f32_16x16x32_bf16 v[100:103], a[164:167], a[68:71], v[100:103]
    ds_read_b64_tr_b16 a[128:129], v48 offset:16384
    ds_read_b64_tr_b16 a[130:131], v48 offset:20480
    v_cvt_pk_bf16_f32 v251, v254, v255
    buffer_store_dwordx4 v[248:251], v16, s[56:59], s72 offen offset:3072 sc1
    s_waitcnt lgkmcnt(12)
    v_mfma_f32_16x16x32_bf16 v[104:107], a[168:171], a[68:71], v[104:107]
    ds_read_b64_tr_b16 a[132:133], v49 offset:16384
    ds_read_b64_tr_b16 a[134:135], v49 offset:20480
    s_mov_b32 s82, 1048576
    s_add_u32 m0, s3, 32768
    s_nop 0
    buffer_load_dwordx4 v17, s[52:55], s82 offen lds
    s_waitcnt lgkmcnt(12)
    v_mfma_f32_16x16x32_bf16 v[108:111], a[172:175], a[68:71], v[108:111]
    ds_read_b64_tr_b16 a[136:137], v50 offset:16384
    ds_read_b64_tr_b16 a[138:139], v50 offset:20480
    s_waitcnt lgkmcnt(12)
    v_mfma_f32_16x16x32_bf16 v[112:115], a[176:179], a[68:71], v[112:115]
    ds_read_b64_tr_b16 a[140:141], v51 offset:16384
    ds_read_b64_tr_b16 a[142:143], v51 offset:20480
    s_waitcnt lgkmcnt(12)
    v_mfma_f32_16x16x32_bf16 v[116:119], a[180:183], a[68:71], v[116:119]
    ds_read_b64_tr_b16 a[144:145], v52 offset:16384
    ds_read_b64_tr_b16 a[146:147], v52 offset:20480
    buffer_load_dwordx4 v18, s[52:55], s82 offen offset:1024 lds
    s_waitcnt lgkmcnt(12)
    v_mfma_f32_16x16x32_bf16 v[120:123], a[184:187], a[68:71], v[120:123]
    ds_read_b64_tr_b16 a[148:149], v53 offset:16384
    ds_read_b64_tr_b16 a[150:151], v53 offset:20480
    s_waitcnt lgkmcnt(12)
    v_mfma_f32_16x16x32_bf16 v[124:127], a[188:191], a[68:71], v[124:127]
    ds_read_b64_tr_b16 a[152:153], v54 offset:16384
    ds_read_b64_tr_b16 a[154:155], v54 offset:20480
    s_waitcnt vmcnt(59) lgkmcnt(12)
    v_mfma_f32_16x16x32_bf16 v[96:99], a[128:131], a[72:75], v[96:99]
    ds_read_b64_tr_b16 a[156:157], v55 offset:16384
    ds_read_b64_tr_b16 a[158:159], v55 offset:20480
    s_mov_b32 s83, 1114112
    s_add_u32 m0, s3, 40960
    s_nop 0
    buffer_load_dwordx4 v17, s[52:55], s83 offen lds
    s_waitcnt lgkmcnt(12)
    v_mfma_f32_16x16x32_bf16 v[100:103], a[132:135], a[72:75], v[100:103]
    ds_read_b64_tr_b16 a[160:161], v48 offset:24576
    ds_read_b64_tr_b16 a[162:163], v48 offset:28672
    s_waitcnt lgkmcnt(12)
    v_mfma_f32_16x16x32_bf16 v[104:107], a[136:139], a[72:75], v[104:107]
    ds_read_b64_tr_b16 a[164:165], v49 offset:24576
    ds_read_b64_tr_b16 a[166:167], v49 offset:28672
    s_waitcnt lgkmcnt(12)
    v_mfma_f32_16x16x32_bf16 v[108:111], a[140:143], a[72:75], v[108:111]
    ds_read_b64_tr_b16 a[168:169], v50 offset:24576
    ds_read_b64_tr_b16 a[170:171], v50 offset:28672
    buffer_load_dwordx4 v18, s[52:55], s83 offen offset:1024 lds
    s_waitcnt lgkmcnt(12)
    v_mfma_f32_16x16x32_bf16 v[112:115], a[144:147], a[72:75], v[112:115]
    ds_read_b64_tr_b16 a[172:173], v51 offset:24576
    ds_read_b64_tr_b16 a[174:175], v51 offset:28672
    s_waitcnt lgkmcnt(12)
    v_mfma_f32_16x16x32_bf16 v[116:119], a[148:151], a[72:75], v[116:119]
    ds_read_b64_tr_b16 a[176:177], v52 offset:24576
    ds_read_b64_tr_b16 a[178:179], v52 offset:28672
    s_waitcnt lgkmcnt(12)
    v_mfma_f32_16x16x32_bf16 v[120:123], a[152:155], a[72:75], v[120:123]
    ds_read_b64_tr_b16 a[180:181], v53 offset:24576
    ds_read_b64_tr_b16 a[182:183], v53 offset:28672
    s_mov_b32 s82, 1179648
    s_add_u32 m0, s3, 49152
    s_nop 0
    buffer_load_dwordx4 v17, s[52:55], s82 offen lds
    s_waitcnt lgkmcnt(12)
    v_mfma_f32_16x16x32_bf16 v[124:127], a[156:159], a[72:75], v[124:127]
    ds_read_b64_tr_b16 a[184:185], v54 offset:24576
    ds_read_b64_tr_b16 a[186:187], v54 offset:28672
    s_waitcnt vmcnt(61) lgkmcnt(12)
    v_mfma_f32_16x16x32_bf16 v[96:99], a[160:163], a[76:79], v[96:99]
    ds_read_b64_tr_b16 a[188:189], v55 offset:24576
    ds_read_b64_tr_b16 a[190:191], v55 offset:28672
    s_waitcnt lgkmcnt(12)
    v_mfma_f32_16x16x32_bf16 v[100:103], a[164:167], a[76:79], v[100:103]
    ds_read_b64_tr_b16 a[128:129], v48 offset:32768
    ds_read_b64_tr_b16 a[130:131], v48 offset:36864
    buffer_load_dwordx4 v18, s[52:55], s82 offen offset:1024 lds
    s_waitcnt lgkmcnt(12)
    v_mfma_f32_16x16x32_bf16 v[104:107], a[168:171], a[76:79], v[104:107]
    ds_read_b64_tr_b16 a[132:133], v49 offset:32768
    ds_read_b64_tr_b16 a[134:135], v49 offset:36864
    s_waitcnt lgkmcnt(12)
    v_mfma_f32_16x16x32_bf16 v[108:111], a[172:175], a[76:79], v[108:111]
    ds_read_b64_tr_b16 a[136:137], v50 offset:32768
    ds_read_b64_tr_b16 a[138:139], v50 offset:36864
    s_waitcnt lgkmcnt(12)
    v_mfma_f32_16x16x32_bf16 v[112:115], a[176:179], a[76:79], v[112:115]
    ds_read_b64_tr_b16 a[140:141], v51 offset:32768
    ds_read_b64_tr_b16 a[142:143], v51 offset:36864
    s_mov_b32 s83, 1245184
    s_add_u32 m0, s3, 57344
    s_nop 0
    buffer_load_dwordx4 v17, s[52:55], s83 offen lds
    s_waitcnt lgkmcnt(12)
    v_mfma_f32_16x16x32_bf16 v[116:119], a[180:183], a[76:79], v[116:119]
    ds_read_b64_tr_b16 a[144:145], v52 offset:32768
    ds_read_b64_tr_b16 a[146:147], v52 offset:36864
    s_waitcnt lgkmcnt(12)
    v_mfma_f32_16x16x32_bf16 v[120:123], a[184:187], a[76:79], v[120:123]
    ds_read_b64_tr_b16 a[148:149], v53 offset:32768
    ds_read_b64_tr_b16 a[150:151], v53 offset:36864
    s_waitcnt lgkmcnt(12)
    v_mfma_f32_16x16x32_bf16 v[124:127], a[188:191], a[76:79], v[124:127]
    ds_read_b64_tr_b16 a[152:153], v54 offset:32768
    ds_read_b64_tr_b16 a[154:155], v54 offset:36864
    buffer_load_dwordx4 v18, s[52:55], s83 offen offset:1024 lds
    s_waitcnt vmcnt(63) lgkmcnt(12)
    v_mfma_f32_16x16x32_bf16 v[96:99], a[128:131], a[80:83], v[96:99]
    ds_read_b64_tr_b16 a[156:157], v55 offset:32768
    ds_read_b64_tr_b16 a[158:159], v55 offset:36864
    s_waitcnt lgkmcnt(12)
    v_mfma_f32_16x16x32_bf16 v[100:103], a[132:135], a[80:83], v[100:103]
    ds_read_b64_tr_b16 a[160:161], v48 offset:40960
    ds_read_b64_tr_b16 a[162:163], v48 offset:45056
    s_waitcnt lgkmcnt(12)
    v_mfma_f32_16x16x32_bf16 v[104:107], a[136:139], a[80:83], v[104:107]
    ds_read_b64_tr_b16 a[164:165], v49 offset:40960
    ds_read_b64_tr_b16 a[166:167], v49 offset:45056
    s_waitcnt lgkmcnt(12)
    v_mfma_f32_16x16x32_bf16 v[108:111], a[140:143], a[80:83], v[108:111]
    ds_read_b64_tr_b16 a[168:169], v50 offset:40960
    ds_read_b64_tr_b16 a[170:171], v50 offset:45056
    s_waitcnt lgkmcnt(12)
    v_mfma_f32_16x16x32_bf16 v[112:115], a[144:147], a[80:83], v[112:115]
    ds_read_b64_tr_b16 a[172:173], v51 offset:40960
    ds_read_b64_tr_b16 a[174:175], v51 offset:45056
    s_waitcnt lgkmcnt(12)
    v_mfma_f32_16x16x32_bf16 v[116:119], a[148:151], a[80:83], v[116:119]
    ds_read_b64_tr_b16 a[176:177], v52 offset:40960
    ds_read_b64_tr_b16 a[178:179], v52 offset:45056
    s_waitcnt lgkmcnt(12)
    v_mfma_f32_16x16x32_bf16 v[120:123], a[152:155], a[80:83], v[120:123]
    ds_read_b64_tr_b16 a[180:181], v53 offset:40960
    ds_read_b64_tr_b16 a[182:183], v53 offset:45056
    s_waitcnt lgkmcnt(12)
    v_mfma_f32_16x16x32_bf16 v[124:127], a[156:159], a[80:83], v[124:127]
    ds_read_b64_tr_b16 a[184:185], v54 offset:40960
    ds_read_b64_tr_b16 a[186:187], v54 offset:45056
    s_waitcnt vmcnt(62) lgkmcnt(12)
    v_mfma_f32_16x16x32_bf16 v[96:99], a[160:163], a[84:87], v[96:99]
    ds_read_b64_tr_b16 a[188:189], v55 offset:40960
    ds_read_b64_tr_b16 a[190:191], v55 offset:45056
    s_waitcnt lgkmcnt(12)
    v_mfma_f32_16x16x32_bf16 v[100:103], a[164:167], a[84:87], v[100:103]
    ds_read_b64_tr_b16 a[128:129], v48 offset:49152
    ds_read_b64_tr_b16 a[130:131], v48 offset:53248
    s_waitcnt lgkmcnt(12)
    v_mfma_f32_16x16x32_bf16 v[104:107], a[168:171], a[84:87], v[104:107]
    ds_read_b64_tr_b16 a[132:133], v49 offset:49152
    ds_read_b64_tr_b16 a[134:135], v49 offset:53248
    s_waitcnt lgkmcnt(12)
    v_mfma_f32_16x16x32_bf16 v[108:111], a[172:175], a[84:87], v[108:111]
    ds_read_b64_tr_b16 a[136:137], v50 offset:49152
    ds_read_b64_tr_b16 a[138:139], v50 offset:53248
    s_waitcnt lgkmcnt(12)
    v_mfma_f32_16x16x32_bf16 v[112:115], a[176:179], a[84:87], v[112:115]
    ds_read_b64_tr_b16 a[140:141], v51 offset:49152
    ds_read_b64_tr_b16 a[142:143], v51 offset:53248
    s_waitcnt lgkmcnt(12)
    v_mfma_f32_16x16x32_bf16 v[116:119], a[180:183], a[84:87], v[116:119]
    ds_read_b64_tr_b16 a[144:145], v52 offset:49152
    ds_read_b64_tr_b16 a[146:147], v52 offset:53248
    s_waitcnt lgkmcnt(12)
    v_mfma_f32_16x16x32_bf16 v[120:123], a[184:187], a[84:87], v[120:123]
    ds_read_b64_tr_b16 a[148:149], v53 offset:49152
    ds_read_b64_tr_b16 a[150:151], v53 offset:53248
    s_waitcnt lgkmcnt(12)
    v_mfma_f32_16x16x32_bf16 v[124:127], a[188:191], a[84:87], v[124:127]
    ds_read_b64_tr_b16 a[152:153], v54 offset:49152
    ds_read_b64_tr_b16 a[154:155], v54 offset:53248
    s_waitcnt vmcnt(19)
    s_barrier
    s_waitcnt lgkmcnt(12)
    v_mfma_f32_16x16x32_bf16 v[96:99], a[128:131], a[88:91], v[96:99]
    ds_read_b64_tr_b16 a[156:157], v55 offset:49152
    ds_read_b64_tr_b16 a[158:159], v55 offset:53248
    s_mov_b32 s82, 1310720
    s_add_u32 m0, s3, 65536
    s_nop 0
    buffer_load_dwordx4 v17, s[52:55], s82 offen lds
    s_waitcnt lgkmcnt(12)
    v_mfma_f32_16x16x32_bf16 v[100:103], a[132:135], a[88:91], v[100:103]
    ds_read_b64_tr_b16 a[160:161], v48 offset:57344
    ds_read_b64_tr_b16 a[162:163], v48 offset:61440
    s_waitcnt lgkmcnt(12)
    v_mfma_f32_16x16x32_bf16 v[104:107], a[136:139], a[88:91], v[104:107]
    ds_read_b64_tr_b16 a[164:165], v49 offset:57344
    ds_read_b64_tr_b16 a[166:167], v49 offset:61440
    s_waitcnt lgkmcnt(12)
    v_mfma_f32_16x16x32_bf16 v[108:111], a[140:143], a[88:91], v[108:111]
    ds_read_b64_tr_b16 a[168:169], v50 offset:57344
    ds_read_b64_tr_b16 a[170:171], v50 offset:61440
    buffer_load_dwordx4 v18, s[52:55], s82 offen offset:1024 lds
    s_waitcnt lgkmcnt(12)
    v_mfma_f32_16x16x32_bf16 v[112:115], a[144:147], a[88:91], v[112:115]
    ds_read_b64_tr_b16 a[172:173], v51 offset:57344
    ds_read_b64_tr_b16 a[174:175], v51 offset:61440
    s_waitcnt lgkmcnt(12)
    v_mfma_f32_16x16x32_bf16 v[116:119], a[148:151], a[88:91], v[116:119]
    ds_read_b64_tr_b16 a[176:177], v52 offset:57344
    ds_read_b64_tr_b16 a[178:179], v52 offset:61440
    s_waitcnt lgkmcnt(12)
    v_mfma_f32_16x16x32_bf16 v[120:123], a[152:155], a[88:91], v[120:123]
    ds_read_b64_tr_b16 a[180:181], v53 offset:57344
    ds_read_b64_tr_b16 a[182:183], v53 offset:61440
    s_mov_b32 s83, 1376256
    s_add_u32 m0, s3, 73728
    s_nop 0
    buffer_load_dwordx4 v17, s[52:55], s83 offen lds
    s_waitcnt lgkmcnt(12)
    v_mfma_f32_16x16x32_bf16 v[124:127], a[156:159], a[88:91], v[124:127]
    ds_read_b64_tr_b16 a[184:185], v54 offset:57344
    ds_read_b64_tr_b16 a[186:187], v54 offset:61440
    s_waitcnt lgkmcnt(12)
    v_mfma_f32_16x16x32_bf16 v[96:99], a[160:163], a[92:95], v[96:99]
    ds_read_b64_tr_b16 a[188:189], v55 offset:57344
    ds_read_b64_tr_b16 a[190:191], v55 offset:61440
    s_waitcnt vmcnt(11)
    s_mov_b64 exec, 1
    buffer_atomic_add v25, off, s[56:59], s77 sc1
    s_mov_b64 exec, -1
    s_waitcnt lgkmcnt(12)
    v_mfma_f32_16x16x32_bf16 v[100:103], a[164:167], a[92:95], v[100:103]
    ds_read_b64_tr_b16 a[128:129], v56 offset:0
    ds_read_b64_tr_b16 a[130:131], v56 offset:4096
    buffer_load_dwordx4 v18, s[52:55], s83 offen offset:1024 lds
    s_waitcnt lgkmcnt(12)
    v_mfma_f32_16x16x32_bf16 v[104:107], a[168:171], a[92:95], v[104:107]
    ds_read_b64_tr_b16 a[132:133], v57 offset:0
    ds_read_b64_tr_b16 a[134:135], v57 offset:4096
    s_waitcnt lgkmcnt(12)
    v_mfma_f32_16x16x32_bf16 v[108:111], a[172:175], a[92:95], v[108:111]
    ds_read_b64_tr_b16 a[136:137], v58 offset:0
    ds_read_b64_tr_b16 a[138:139], v58 offset:4096
    s_waitcnt lgkmcnt(12)
    v_mfma_f32_16x16x32_bf16 v[112:115], a[176:179], a[92:95], v[112:115]
    ds_read_b64_tr_b16 a[140:141], v59 offset:0
    ds_read_b64_tr_b16 a[142:143], v59 offset:4096
    s_mov_b32 s82, 1441792
    s_add_u32 m0, s3, 81920
    s_nop 0
    buffer_load_dwordx4 v17, s[52:55], s82 offen lds
    s_waitcnt lgkmcnt(12)
    v_mfma_f32_16x16x32_bf16 v[116:119], a[180:183], a[92:95], v[116:119]
    ds_read_b64_tr_b16 a[144:145], v60 offset:0
    ds_read_b64_tr_b16 a[146:147], v60 offset:4096
    s_waitcnt lgkmcnt(12)
    v_mfma_f32_16x16x32_bf16 v[120:123], a[184:187], a[92:95], v[120:123]
    ds_read_b64_tr_b16 a[148:149], v61 offset:0
    ds_read_b64_tr_b16 a[150:151], v61 offset:4096
    s_waitcnt lgkmcnt(12)
    v_mfma_f32_16x16x32_bf16 v[124:127], a[188:191], a[92:95], v[124:127]
    ds_read_b64_tr_b16 a[152:153], v62 offset:0
    ds_read_b64_tr_b16 a[154:155], v62 offset:4096
    buffer_load_dwordx4 v18, s[52:55], s82 offen offset:1024 lds
    s_waitcnt lgkmcnt(12)
    v_mfma_f32_16x16x32_bf16 v[96:99], a[128:131], a[96:99], v[96:99]
    ds_read_b64_tr_b16 a[156:157], v63 offset:0
    ds_read_b64_tr_b16 a[158:159], v63 offset:4096
    s_waitcnt lgkmcnt(12)
    v_mfma_f32_16x16x32_bf16 v[100:103], a[132:135], a[96:99], v[100:103]
    ds_read_b64_tr_b16 a[160:161], v56 offset:8192
    ds_read_b64_tr_b16 a[162:163], v56 offset:12288
    s_waitcnt lgkmcnt(12)
    v_mfma_f32_16x16x32_bf16 v[104:107], a[136:139], a[96:99], v[104:107]
    ds_read_b64_tr_b16 a[164:165], v57 offset:8192
    ds_read_b64_tr_b16 a[166:167], v57 offset:12288
    s_mov_b32 s83, 1507328
    s_add_u32 m0, s3, 90112
    s_nop 0
    buffer_load_dwordx4 v17, s[52:55], s83 offen lds
    s_waitcnt lgkmcnt(12)
    v_mfma_f32_16x16x32_bf16 v[108:111], a[140:143], a[96:99], v[108:111]
    ds_read_b64_tr_b16 a[168:169], v58 offset:8192
    ds_read_b64_tr_b16 a[170:171], v58 offset:12288
    s_waitcnt lgkmcnt(12)
    v_mfma_f32_16x16x32_bf16 v[112:115], a[144:147], a[96:99], v[112:115]
    ds_read_b64_tr_b16 a[172:173], v59 offset:8192
    ds_read_b64_tr_b16 a[174:175], v59 offset:12288
    s_waitcnt lgkmcnt(12)
    v_mfma_f32_16x16x32_bf16 v[116:119], a[148:151], a[96:99], v[116:119]
    ds_read_b64_tr_b16 a[176:177], v60 offset:8192
    ds_read_b64_tr_b16 a[178:179], v60 offset:12288
    buffer_load_dwordx4 v18, s[52:55], s83 offen offset:1024 lds
    s_waitcnt lgkmcnt(12)
    v_mfma_f32_16x16x32_bf16 v[120:123], a[152:155], a[96:99], v[120:123]
    ds_read_b64_tr_b16 a[180:181], v61 offset:8192
    ds_read_b64_tr_b16 a[182:183], v61 offset:12288
    s_waitcnt lgkmcnt(12)
    v_mfma_f32_16x16x32_bf16 v[124:127], a[156:159], a[96:99], v[124:127]
    ds_read_b64_tr_b16 a[184:185], v62 offset:8192
    ds_read_b64_tr_b16 a[186:187], v62 offset:12288
    s_waitcnt lgkmcnt(12)
    v_mfma_f32_16x16x32_bf16 v[96:99], a[160:163], a[100:103], v[96:99]
    ds_read_b64_tr_b16 a[188:189], v63 offset:8192
    ds_read_b64_tr_b16 a[190:191], v63 offset:12288
    s_mov_b32 s82, 1572864
    s_add_u32 m0, s3, 98304
    s_nop 0
    buffer_load_dwordx4 v17, s[52:55], s82 offen lds
    s_waitcnt lgkmcnt(12)
    v_mfma_f32_16x16x32_bf16 v[100:103], a[164:167], a[100:103], v[100:103]
    ds_read_b64_tr_b16 a[128:129], v56 offset:16384
    ds_read_b64_tr_b16 a[130:131], v56 offset:20480
    s_waitcnt lgkmcnt(12)
    v_mfma_f32_16x16x32_bf16 v[104:107], a[168:171], a[100:103], v[104:107]
    ds_read_b64_tr_b16 a[132:133], v57 offset:16384
    ds_read_b64_tr_b16 a[134:135], v57 offset:20480
    s_waitcnt lgkmcnt(12)
    v_mfma_f32_16x16x32_bf16 v[108:111], a[172:175], a[100:103], v[108:111]
    ds_read_b64_tr_b16 a[136:137], v58 offset:16384
    ds_read_b64_tr_b16 a[138:139], v58 offset:20480
    buffer_load_dwordx4 v18, s[52:55], s82 offen offset:1024 lds
    s_waitcnt lgkmcnt(12)
    v_mfma_f32_16x16x32_bf16 v[112:115], a[176:179], a[100:103], v[112:115]
    ds_read_b64_tr_b16 a[140:141], v59 offset:16384
    ds_read_b64_tr_b16 a[142:143], v59 offset:20480
    s_waitcnt lgkmcnt(12)
    v_mfma_f32_16x16x32_bf16 v[116:119], a[180:183], a[100:103], v[116:119]
    ds_read_b64_tr_b16 a[144:145], v60 offset:16384
    ds_read_b64_tr_b16 a[146:147], v60 offset:20480
    s_waitcnt lgkmcnt(12)
    v_mfma_f32_16x16x32_bf16 v[120:123], a[184:187], a[100:103], v[120:123]
    ds_read_b64_tr_b16 a[148:149], v61 offset:16384
    ds_read_b64_tr_b16 a[150:151], v61 offset:20480
    s_mov_b32 s83, 1638400
    s_add_u32 m0, s3, 106496
    s_nop 0
    buffer_load_dwordx4 v17, s[52:55], s83 offen lds
    s_waitcnt lgkmcnt(12)
    v_mfma_f32_16x16x32_bf16 v[124:127], a[188:191], a[100:103], v[124:127]
    ds_read_b64_tr_b16 a[152:153], v62 offset:16384
    ds_read_b64_tr_b16 a[154:155], v62 offset:20480
    s_waitcnt lgkmcnt(12)
    v_mfma_f32_16x16x32_bf16 v[96:99], a[128:131], a[104:107], v[96:99]
    ds_read_b64_tr_b16 a[156:157], v63 offset:16384
    ds_read_b64_tr_b16 a[158:159], v63 offset:20480
    s_waitcnt lgkmcnt(12)
    v_mfma_f32_16x16x32_bf16 v[100:103], a[132:135], a[104:107], v[100:103]
    ds_read_b64_tr_b16 a[160:161], v56 offset:24576
    ds_read_b64_tr_b16 a[162:163], v56 offset:28672
    buffer_load_dwordx4 v18, s[52:55], s83 offen offset:1024 lds
    s_waitcnt lgkmcnt(12)
    v_mfma_f32_16x16x32_bf16 v[104:107], a[136:139], a[104:107], v[104:107]
    ds_read_b64_tr_b16 a[164:165], v57 offset:24576
    ds_read_b64_tr_b16 a[166:167], v57 offset:28672
    s_waitcnt lgkmcnt(12)
    v_mfma_f32_16x16x32_bf16 v[108:111], a[140:143], a[104:107], v[108:111]
    ds_read_b64_tr_b16 a[168:169], v58 offset:24576
    ds_read_b64_tr_b16 a[170:171], v58 offset:28672
    s_waitcnt lgkmcnt(12)
    v_mfma_f32_16x16x32_bf16 v[112:115], a[144:147], a[104:107], v[112:115]
    ds_read_b64_tr_b16 a[172:173], v59 offset:24576
    ds_read_b64_tr_b16 a[174:175], v59 offset:28672
    s_waitcnt lgkmcnt(12)
    v_mfma_f32_16x16x32_bf16 v[116:119], a[148:151], a[104:107], v[116:119]
    ds_read_b64_tr_b16 a[176:177], v60 offset:24576
    ds_read_b64_tr_b16 a[178:179], v60 offset:28672
    s_waitcnt lgkmcnt(12)
    v_mfma_f32_16x16x32_bf16 v[120:123], a[152:155], a[104:107], v[120:123]
    ds_read_b64_tr_b16 a[180:181], v61 offset:24576
    ds_read_b64_tr_b16 a[182:183], v61 offset:28672
    s_waitcnt lgkmcnt(12)
    v_mfma_f32_16x16x32_bf16 v[124:127], a[156:159], a[104:107], v[124:127]
    ds_read_b64_tr_b16 a[184:185], v62 offset:24576
    ds_read_b64_tr_b16 a[186:187], v62 offset:28672
    s_waitcnt lgkmcnt(12)
    v_mfma_f32_16x16x32_bf16 v[96:99], a[160:163], a[108:111], v[96:99]
    ds_read_b64_tr_b16 a[188:189], v63 offset:24576
    ds_read_b64_tr_b16 a[190:191], v63 offset:28672
    s_waitcnt lgkmcnt(12)
    v_mfma_f32_16x16x32_bf16 v[100:103], a[164:167], a[108:111], v[100:103]
    ds_read_b64_tr_b16 a[128:129], v8 offset:0
    ds_read_b64_tr_b16 a[130:131], v8 offset:4096
    s_waitcnt lgkmcnt(12)
    v_mfma_f32_16x16x32_bf16 v[104:107], a[168:171], a[108:111], v[104:107]
    ds_read_b64_tr_b16 a[132:133], v9 offset:0
    ds_read_b64_tr_b16 a[134:135], v9 offset:4096
    s_waitcnt lgkmcnt(12)
    v_mfma_f32_16x16x32_bf16 v[108:111], a[172:175], a[108:111], v[108:111]
    ds_read_b64_tr_b16 a[136:137], v10 offset:0
    ds_read_b64_tr_b16 a[138:139], v10 offset:4096
    s_waitcnt lgkmcnt(12)
    v_mfma_f32_16x16x32_bf16 v[112:115], a[176:179], a[108:111], v[112:115]
    ds_read_b64_tr_b16 a[140:141], v11 offset:0
    ds_read_b64_tr_b16 a[142:143], v11 offset:4096
    s_waitcnt lgkmcnt(12)
    v_mfma_f32_16x16x32_bf16 v[116:119], a[180:183], a[108:111], v[116:119]
    ds_read_b64_tr_b16 a[144:145], v12 offset:0
    ds_read_b64_tr_b16 a[146:147], v12 offset:4096
    s_waitcnt lgkmcnt(12)
    v_mfma_f32_16x16x32_bf16 v[120:123], a[184:187], a[108:111], v[120:123]
    ds_read_b64_tr_b16 a[148:149], v13 offset:0
    ds_read_b64_tr_b16 a[150:151], v13 offset:4096
    s_waitcnt lgkmcnt(12)
    v_mfma_f32_16x16x32_bf16 v[124:127], a[188:191], a[108:111], v[124:127]
    ds_read_b64_tr_b16 a[152:153], v14 offset:0
    ds_read_b64_tr_b16 a[154:155], v14 offset:4096
    s_waitcnt lgkmcnt(12)
    v_mfma_f32_16x16x32_bf16 v[96:99], a[128:131], a[112:115], v[96:99]
    ds_read_b64_tr_b16 a[156:157], v15 offset:0
    ds_read_b64_tr_b16 a[158:159], v15 offset:4096
    s_waitcnt lgkmcnt(12)
    v_mfma_f32_16x16x32_bf16 v[100:103], a[132:135], a[112:115], v[100:103]
    ds_read_b64_tr_b16 a[160:161], v8 offset:8192
    ds_read_b64_tr_b16 a[162:163], v8 offset:12288
    s_waitcnt lgkmcnt(12)
    v_mfma_f32_16x16x32_bf16 v[104:107], a[136:139], a[112:115], v[104:107]
    ds_read_b64_tr_b16 a[164:165], v9 offset:8192
    ds_read_b64_tr_b16 a[166:167], v9 offset:12288
    s_waitcnt lgkmcnt(12)
    v_mfma_f32_16x16x32_bf16 v[108:111], a[140:143], a[112:115], v[108:111]
    ds_read_b64_tr_b16 a[168:169], v10 offset:8192
    ds_read_b64_tr_b16 a[170:171], v10 offset:12288
    s_waitcnt lgkmcnt(12)
    v_mfma_f32_16x16x32_bf16 v[112:115], a[144:147], a[112:115], v[112:115]
    ds_read_b64_tr_b16 a[172:173], v11 offset:8192
    ds_read_b64_tr_b16 a[174:175], v11 offset:12288
    s_waitcnt lgkmcnt(12)
    v_mfma_f32_16x16x32_bf16 v[116:119], a[148:151], a[112:115], v[116:119]
    ds_read_b64_tr_b16 a[176:177], v12 offset:8192
    ds_read_b64_tr_b16 a[178:179], v12 offset:12288
    s_waitcnt lgkmcnt(12)
    v_mfma_f32_16x16x32_bf16 v[120:123], a[152:155], a[112:115], v[120:123]
    ds_read_b64_tr_b16 a[180:181], v13 offset:8192
    ds_read_b64_tr_b16 a[182:183], v13 offset:12288
    s_waitcnt lgkmcnt(12)
    v_mfma_f32_16x16x32_bf16 v[124:127], a[156:159], a[112:115], v[124:127]
    ds_read_b64_tr_b16 a[184:185], v14 offset:8192
    ds_read_b64_tr_b16 a[186:187], v14 offset:12288
    s_waitcnt lgkmcnt(12)
    v_mfma_f32_16x16x32_bf16 v[96:99], a[160:163], a[116:119], v[96:99]
    ds_read_b64_tr_b16 a[188:189], v15 offset:8192
    ds_read_b64_tr_b16 a[190:191], v15 offset:12288
    s_waitcnt lgkmcnt(12)
    v_mfma_f32_16x16x32_bf16 v[100:103], a[164:167], a[116:119], v[100:103]
    ds_read_b64_tr_b16 a[128:129], v8 offset:16384
    ds_read_b64_tr_b16 a[130:131], v8 offset:20480
    s_waitcnt lgkmcnt(12)
    v_mfma_f32_16x16x32_bf16 v[104:107], a[168:171], a[116:119], v[104:107]
    ds_read_b64_tr_b16 a[132:133], v9 offset:16384
    ds_read_b64_tr_b16 a[134:135], v9 offset:20480
    s_waitcnt lgkmcnt(12)
    v_mfma_f32_16x16x32_bf16 v[108:111], a[172:175], a[116:119], v[108:111]
    ds_read_b64_tr_b16 a[136:137], v10 offset:16384
    ds_read_b64_tr_b16 a[138:139], v10 offset:20480
    s_waitcnt lgkmcnt(12)
    v_mfma_f32_16x16x32_bf16 v[112:115], a[176:179], a[116:119], v[112:115]
    ds_read_b64_tr_b16 a[140:141], v11 offset:16384
    ds_read_b64_tr_b16 a[142:143], v11 offset:20480
    s_waitcnt lgkmcnt(12)
    v_mfma_f32_16x16x32_bf16 v[116:119], a[180:183], a[116:119], v[116:119]
    ds_read_b64_tr_b16 a[144:145], v12 offset:16384
    ds_read_b64_tr_b16 a[146:147], v12 offset:20480
    s_waitcnt lgkmcnt(12)
    v_mfma_f32_16x16x32_bf16 v[120:123], a[184:187], a[116:119], v[120:123]
    ds_read_b64_tr_b16 a[148:149], v13 offset:16384
    ds_read_b64_tr_b16 a[150:151], v13 offset:20480
    s_waitcnt lgkmcnt(12)
    v_mfma_f32_16x16x32_bf16 v[124:127], a[188:191], a[116:119], v[124:127]
    ds_read_b64_tr_b16 a[152:153], v14 offset:16384
    ds_read_b64_tr_b16 a[154:155], v14 offset:20480
    s_waitcnt vmcnt(13)
    s_barrier
    s_waitcnt lgkmcnt(12)
    v_mfma_f32_16x16x32_bf16 v[96:99], a[128:131], a[120:123], v[96:99]
    ds_read_b64_tr_b16 a[156:157], v15 offset:16384
    ds_read_b64_tr_b16 a[158:159], v15 offset:20480
    s_mov_b32 s82, 1703936
    s_add_u32 m0, s3, 114688
    s_nop 0
    buffer_load_dwordx4 v17, s[52:55], s82 offen lds
    s_waitcnt lgkmcnt(12)
    v_mfma_f32_16x16x32_bf16 v[100:103], a[132:135], a[120:123], v[100:103]
    ds_read_b64_tr_b16 a[160:161], v8 offset:24576
    ds_read_b64_tr_b16 a[162:163], v8 offset:28672
    s_waitcnt lgkmcnt(12)
    v_mfma_f32_16x16x32_bf16 v[104:107], a[136:139], a[120:123], v[104:107]
    ds_read_b64_tr_b16 a[164:165], v9 offset:24576
    ds_read_b64_tr_b16 a[166:167], v9 offset:28672
    s_waitcnt lgkmcnt(12)
    v_mfma_f32_16x16x32_bf16 v[108:111], a[140:143], a[120:123], v[108:111]
    ds_read_b64_tr_b16 a[168:169], v10 offset:24576
    ds_read_b64_tr_b16 a[170:171], v10 offset:28672
    buffer_load_dwordx4 v18, s[52:55], s82 offen offset:1024 lds
    s_waitcnt lgkmcnt(12)
    v_mfma_f32_16x16x32_bf16 v[112:115], a[144:147], a[120:123], v[112:115]
    ds_read_b64_tr_b16 a[172:173], v11 offset:24576
    ds_read_b64_tr_b16 a[174:175], v11 offset:28672
    s_waitcnt lgkmcnt(12)
    v_mfma_f32_16x16x32_bf16 v[116:119], a[148:151], a[120:123], v[116:119]
    ds_read_b64_tr_b16 a[176:177], v12 offset:24576
    ds_read_b64_tr_b16 a[178:179], v12 offset:28672
    s_waitcnt lgkmcnt(12)
    v_mfma_f32_16x16x32_bf16 v[120:123], a[152:155], a[120:123], v[120:123]
    ds_read_b64_tr_b16 a[180:181], v13 offset:24576
    ds_read_b64_tr_b16 a[182:183], v13 offset:28672
    s_mov_b32 s83, 1769472
    s_add_u32 m0, s3, 122880
    s_nop 0
    buffer_load_dwordx4 v17, s[52:55], s83 offen lds
    s_waitcnt lgkmcnt(12)
    v_mfma_f32_16x16x32_bf16 v[124:127], a[156:159], a[120:123], v[124:127]
    ds_read_b64_tr_b16 a[184:185], v14 offset:24576
    ds_read_b64_tr_b16 a[186:187], v14 offset:28672
    s_waitcnt lgkmcnt(12)
    v_mfma_f32_16x16x32_bf16 v[96:99], a[160:163], a[124:127], v[96:99]
    ds_read_b64_tr_b16 a[188:189], v15 offset:24576
    ds_read_b64_tr_b16 a[190:191], v15 offset:28672
    buffer_load_dword v43, off, s[56:59], s77 sc1
    s_waitcnt lgkmcnt(12)
    v_mfma_f32_16x16x32_bf16 v[100:103], a[164:167], a[124:127], v[100:103]
    ds_read_b64_tr_b16 a[128:129], v8 offset:32768
    ds_read_b64_tr_b16 a[130:131], v8 offset:36864
    buffer_load_dwordx4 v18, s[52:55], s83 offen offset:1024 lds
    s_waitcnt lgkmcnt(12)
    v_mfma_f32_16x16x32_bf16 v[104:107], a[168:171], a[124:127], v[104:107]
    ds_read_b64_tr_b16 a[132:133], v9 offset:32768
    ds_read_b64_tr_b16 a[134:135], v9 offset:36864
    s_waitcnt lgkmcnt(12)
    v_mfma_f32_16x16x32_bf16 v[108:111], a[172:175], a[124:127], v[108:111]
    ds_read_b64_tr_b16 a[136:137], v10 offset:32768
    ds_read_b64_tr_b16 a[138:139], v10 offset:36864
    s_waitcnt lgkmcnt(12)
    v_mfma_f32_16x16x32_bf16 v[112:115], a[176:179], a[124:127], v[112:115]
    ds_read_b64_tr_b16 a[140:141], v11 offset:32768
    ds_read_b64_tr_b16 a[142:143], v11 offset:36864
    s_mov_b32 s82, 1835008
    s_add_u32 m0, s3, 131072
    s_nop 0
    buffer_load_dwordx4 v17, s[52:55], s82 offen lds
    s_waitcnt lgkmcnt(12)
    v_mfma_f32_16x16x32_bf16 v[116:119], a[180:183], a[124:127], v[116:119]
    ds_read_b64_tr_b16 a[144:145], v12 offset:32768
    ds_read_b64_tr_b16 a[146:147], v12 offset:36864
    s_waitcnt lgkmcnt(12)
    v_mfma_f32_16x16x32_bf16 v[120:123], a[184:187], a[124:127], v[120:123]
    ds_read_b64_tr_b16 a[148:149], v13 offset:32768
    ds_read_b64_tr_b16 a[150:151], v13 offset:36864
    s_waitcnt lgkmcnt(12)
    v_mfma_f32_16x16x32_bf16 v[124:127], a[188:191], a[124:127], v[124:127]
    ds_read_b64_tr_b16 a[152:153], v14 offset:32768
    ds_read_b64_tr_b16 a[154:155], v14 offset:36864
    buffer_load_dwordx4 v18, s[52:55], s82 offen offset:1024 lds
    s_waitcnt lgkmcnt(12)
    v_mfma_f32_16x16x32_bf16 v[96:99], a[128:131], a[0:3], v[96:99]
    ds_read_b64_tr_b16 a[156:157], v15 offset:32768
    ds_read_b64_tr_b16 a[158:159], v15 offset:36864
    s_waitcnt lgkmcnt(12)
    v_mfma_f32_16x16x32_bf16 v[100:103], a[132:135], a[0:3], v[100:103]
    ds_read_b64_tr_b16 a[160:161], v8 offset:40960
    ds_read_b64_tr_b16 a[162:163], v8 offset:45056
    s_waitcnt lgkmcnt(12)
    v_mfma_f32_16x16x32_bf16 v[104:107], a[136:139], a[0:3], v[104:107]
    ds_read_b64_tr_b16 a[164:165], v9 offset:40960
    ds_read_b64_tr_b16 a[166:167], v9 offset:45056
    s_mov_b32 s83, 1900544
    s_add_u32 m0, s3, 139264
    s_nop 0
    buffer_load_dwordx4 v17, s[52:55], s83 offen lds
    s_waitcnt lgkmcnt(12)
    v_mfma_f32_16x16x32_bf16 v[108:111], a[140:143], a[0:3], v[108:111]
    ds_read_b64_tr_b16 a[168:169], v10 offset:40960
    ds_read_b64_tr_b16 a[170:171], v10 offset:45056
    s_waitcnt lgkmcnt(12)
    v_mfma_f32_16x16x32_bf16 v[112:115], a[144:147], a[0:3], v[112:115]
    ds_read_b64_tr_b16 a[172:173], v11 offset:40960
    ds_read_b64_tr_b16 a[174:175], v11 offset:45056
    s_waitcnt lgkmcnt(12)
    v_mfma_f32_16x16x32_bf16 v[116:119], a[148:151], a[0:3], v[116:119]
    ds_read_b64_tr_b16 a[176:177], v12 offset:40960
    ds_read_b64_tr_b16 a[178:179], v12 offset:45056
    buffer_load_dwordx4 v18, s[52:55], s83 offen offset:1024 lds
    s_waitcnt lgkmcnt(12)
    v_mfma_f32_16x16x32_bf16 v[120:123], a[152:155], a[0:3], v[120:123]
    ds_read_b64_tr_b16 a[180:181], v13 offset:40960
    ds_read_b64_tr_b16 a[182:183], v13 offset:45056
    s_waitcnt lgkmcnt(12)
    v_mfma_f32_16x16x32_bf16 v[124:127], a[156:159], a[0:3], v[124:127]
    ds_read_b64_tr_b16 a[184:185], v14 offset:40960
    ds_read_b64_tr_b16 a[186:187], v14 offset:45056
    s_waitcnt lgkmcnt(12)
    v_mfma_f32_16x16x32_bf16 v[96:99], a[160:163], a[4:7], v[96:99]
    ds_read_b64_tr_b16 a[188:189], v15 offset:40960
    ds_read_b64_tr_b16 a[190:191], v15 offset:45056
    s_mov_b32 s82, 1966080
    s_add_u32 m0, s3, 147456
    s_nop 0
    buffer_load_dwordx4 v17, s[52:55], s82 offen lds
    s_waitcnt lgkmcnt(12)
    v_mfma_f32_16x16x32_bf16 v[100:103], a[164:167], a[4:7], v[100:103]
    ds_read_b64_tr_b16 a[128:129], v8 offset:49152
    ds_read_b64_tr_b16 a[130:131], v8 offset:53248
    s_waitcnt lgkmcnt(12)
    v_mfma_f32_16x16x32_bf16 v[104:107], a[168:171], a[4:7], v[104:107]
    ds_read_b64_tr_b16 a[132:133], v9 offset:49152
    ds_read_b64_tr_b16 a[134:135], v9 offset:53248
    s_waitcnt lgkmcnt(12)
    v_mfma_f32_16x16x32_bf16 v[108:111], a[172:175], a[4:7], v[108:111]
    ds_read_b64_tr_b16 a[136:137], v10 offset:49152
    ds_read_b64_tr_b16 a[138:139], v10 offset:53248
    buffer_load_dwordx4 v18, s[52:55], s82 offen offset:1024 lds
    s_waitcnt lgkmcnt(12)
    v_mfma_f32_16x16x32_bf16 v[112:115], a[176:179], a[4:7], v[112:115]
    ds_read_b64_tr_b16 a[140:141], v11 offset:49152
    ds_read_b64_tr_b16 a[142:143], v11 offset:53248
    s_waitcnt lgkmcnt(12)
    v_mfma_f32_16x16x32_bf16 v[116:119], a[180:183], a[4:7], v[116:119]
    ds_read_b64_tr_b16 a[144:145], v12 offset:49152
    ds_read_b64_tr_b16 a[146:147], v12 offset:53248
    s_waitcnt lgkmcnt(12)
    v_mfma_f32_16x16x32_bf16 v[120:123], a[184:187], a[4:7], v[120:123]
    ds_read_b64_tr_b16 a[148:149], v13 offset:49152
    ds_read_b64_tr_b16 a[150:151], v13 offset:53248
    s_mov_b32 s83, 2031616
    s_add_u32 m0, s3, 155648
    s_nop 0
    buffer_load_dwordx4 v17, s[52:55], s83 offen lds
    s_waitcnt lgkmcnt(12)
    v_mfma_f32_16x16x32_bf16 v[124:127], a[188:191], a[4:7], v[124:127]
    ds_read_b64_tr_b16 a[152:153], v14 offset:49152
    ds_read_b64_tr_b16 a[154:155], v14 offset:53248
    s_waitcnt vmcnt(12)
    s_barrier
    s_waitcnt lgkmcnt(12)
    v_mfma_f32_16x16x32_bf16 v[96:99], a[128:131], a[8:11], v[96:99]
    ds_read_b64_tr_b16 a[156:157], v15 offset:49152
    ds_read_b64_tr_b16 a[158:159], v15 offset:53248
    s_waitcnt lgkmcnt(12)
    v_mfma_f32_16x16x32_bf16 v[100:103], a[132:135], a[8:11], v[100:103]
    ds_read_b64_tr_b16 a[160:161], v8 offset:57344
    ds_read_b64_tr_b16 a[162:163], v8 offset:61440
    buffer_load_dwordx4 v18, s[52:55], s83 offen offset:1024 lds
    s_waitcnt lgkmcnt(12)
    v_mfma_f32_16x16x32_bf16 v[104:107], a[136:139], a[8:11], v[104:107]
    ds_read_b64_tr_b16 a[164:165], v9 offset:57344
    ds_read_b64_tr_b16 a[166:167], v9 offset:61440
    s_waitcnt lgkmcnt(12)
    v_mfma_f32_16x16x32_bf16 v[108:111], a[140:143], a[8:11], v[108:111]
    ds_read_b64_tr_b16 a[168:169], v10 offset:57344
    ds_read_b64_tr_b16 a[170:171], v10 offset:61440
    s_waitcnt lgkmcnt(12)
    v_mfma_f32_16x16x32_bf16 v[112:115], a[144:147], a[8:11], v[112:115]
    ds_read_b64_tr_b16 a[172:173], v11 offset:57344
    ds_read_b64_tr_b16 a[174:175], v11 offset:61440
    s_waitcnt lgkmcnt(12)
    v_mfma_f32_16x16x32_bf16 v[116:119], a[148:151], a[8:11], v[116:119]
    ds_read_b64_tr_b16 a[176:177], v12 offset:57344
    ds_read_b64_tr_b16 a[178:179], v12 offset:61440
    s_waitcnt lgkmcnt(12)
    v_mfma_f32_16x16x32_bf16 v[120:123], a[152:155], a[8:11], v[120:123]
    ds_read_b64_tr_b16 a[180:181], v13 offset:57344
    ds_read_b64_tr_b16 a[182:183], v13 offset:61440
    s_waitcnt lgkmcnt(12)
    v_mfma_f32_16x16x32_bf16 v[124:127], a[156:159], a[8:11], v[124:127]
    ds_read_b64_tr_b16 a[184:185], v14 offset:57344
    ds_read_b64_tr_b16 a[186:187], v14 offset:61440
    s_waitcnt lgkmcnt(12)
    v_mfma_f32_16x16x32_bf16 v[96:99], a[160:163], a[12:15], v[96:99]
    ds_read_b64_tr_b16 a[188:189], v15 offset:57344
    ds_read_b64_tr_b16 a[190:191], v15 offset:61440
    s_waitcnt lgkmcnt(12)
    v_mfma_f32_16x16x32_bf16 v[100:103], a[164:167], a[12:15], v[100:103]
    ds_read_b64_tr_b16 a[128:129], v48 offset:0
    ds_read_b64_tr_b16 a[130:131], v48 offset:4096
    s_waitcnt lgkmcnt(12)
    v_mfma_f32_16x16x32_bf16 v[104:107], a[168:171], a[12:15], v[104:107]
    ds_read_b64_tr_b16 a[132:133], v49 offset:0
    ds_read_b64_tr_b16 a[134:135], v49 offset:4096
    s_waitcnt lgkmcnt(12)
    v_mfma_f32_16x16x32_bf16 v[108:111], a[172:175], a[12:15], v[108:111]
    ds_read_b64_tr_b16 a[136:137], v50 offset:0
    ds_read_b64_tr_b16 a[138:139], v50 offset:4096
    s_waitcnt lgkmcnt(12)
    v_mfma_f32_16x16x32_bf16 v[112:115], a[176:179], a[12:15], v[112:115]
    ds_read_b64_tr_b16 a[140:141], v51 offset:0
    ds_read_b64_tr_b16 a[142:143], v51 offset:4096
    s_waitcnt lgkmcnt(12)
    v_mfma_f32_16x16x32_bf16 v[116:119], a[180:183], a[12:15], v[116:119]
    ds_read_b64_tr_b16 a[144:145], v52 offset:0
    ds_read_b64_tr_b16 a[146:147], v52 offset:4096
    s_waitcnt lgkmcnt(12)
    v_mfma_f32_16x16x32_bf16 v[120:123], a[184:187], a[12:15], v[120:123]
    ds_read_b64_tr_b16 a[148:149], v53 offset:0
    ds_read_b64_tr_b16 a[150:151], v53 offset:4096
    s_waitcnt lgkmcnt(12)
    v_mfma_f32_16x16x32_bf16 v[124:127], a[188:191], a[12:15], v[124:127]
    ds_read_b64_tr_b16 a[152:153], v54 offset:0
    ds_read_b64_tr_b16 a[154:155], v54 offset:4096
    s_waitcnt lgkmcnt(12)
    v_mfma_f32_16x16x32_bf16 v[96:99], a[128:131], a[16:19], v[96:99]
    ds_read_b64_tr_b16 a[156:157], v55 offset:0
    ds_read_b64_tr_b16 a[158:159], v55 offset:4096
    s_waitcnt vmcnt(9)
    v_readfirstlane_b32 s86, v43
    s_cmp_eq_u32 s86, 4
    s_cbranch_scc0 L_spP
L_okP:
    buffer_load_dwordx4 v[164:167], v16, s[56:59], s73 offen offset:0 sc1
    s_waitcnt lgkmcnt(12)
    v_mfma_f32_16x16x32_bf16 v[100:103], a[132:135], a[16:19], v[100:103]
    ds_read_b64_tr_b16 a[160:161], v48 offset:8192
    ds_read_b64_tr_b16 a[162:163], v48 offset:12288
    buffer_load_dwordx4 v[172:175], v16, s[56:59], s73 offen offset:1024 sc1
    s_waitcnt lgkmcnt(12)
    v_mfma_f32_16x16x32_bf16 v[104:107], a[136:139], a[16:19], v[104:107]
    ds_read_b64_tr_b16 a[164:165], v49 offset:8192
    ds_read_b64_tr_b16 a[166:167], v49 offset:12288
    buffer_load_dwordx4 v[180:183], v16, s[56:59], s73 offen offset:2048 sc1
    s_waitcnt lgkmcnt(12)
    v_mfma_f32_16x16x32_bf16 v[108:111], a[140:143], a[16:19], v[108:111]
    ds_read_b64_tr_b16 a[168:169], v50 offset:8192
    ds_read_b64_tr_b16 a[170:171], v50 offset:12288
    buffer_load_dwordx4 v[188:191], v16, s[56:59], s73 offen offset:3072 sc1
    s_waitcnt lgkmcnt(12)
    v_mfma_f32_16x16x32_bf16 v[112:115], a[144:147], a[16:19], v[112:115]
    ds_read_b64_tr_b16 a[172:173], v51 offset:8192
    ds_read_b64_tr_b16 a[174:175], v51 offset:12288
    buffer_load_dwordx4 v[196:199], v16, s[56:59], s74 offen offset:0 sc1
    s_waitcnt lgkmcnt(12)
    v_mfma_f32_16x16x32_bf16 v[116:119], a[148:151], a[16:19], v[116:119]
    ds_read_b64_tr_b16 a[176:177], v52 offset:8192
    ds_read_b64_tr_b16 a[178:179], v52 offset:12288
    buffer_load_dwordx4 v[204:207], v16, s[56:59], s74 offen offset:1024 sc1
    s_waitcnt lgkmcnt(12)
    v_mfma_f32_16x16x32_bf16 v[120:123], a[152:155], a[16:19], v[120:123]
    ds_read_b64_tr_b16 a[180:181], v53 offset:8192
    ds_read_b64_tr_b16 a[182:183], v53 offset:12288
    buffer_load_dwordx4 v[212:215], v16, s[56:59], s74 offen offset:2048 sc1
    s_waitcnt lgkmcnt(12)
    v_mfma_f32_16x16x32_bf16 v[124:127], a[156:159], a[16:19], v[124:127]
    ds_read_b64_tr_b16 a[184:185], v54 offset:8192
    ds_read_b64_tr_b16 a[186:187], v54 offset:12288
    buffer_load_dwordx4 v[220:223], v16, s[56:59], s74 offen offset:3072 sc1
    s_waitcnt lgkmcnt(12)
    v_mfma_f32_16x16x32_bf16 v[96:99], a[160:163], a[20:23], v[96:99]
    ds_read_b64_tr_b16 a[188:189], v55 offset:8192
    ds_read_b64_tr_b16 a[190:191], v55 offset:12288
    buffer_load_dwordx4 v[228:231], v16, s[56:59], s75 offen offset:0 sc1
    s_waitcnt lgkmcnt(12)
    v_mfma_f32_16x16x32_bf16 v[100:103], a[164:167], a[20:23], v[100:103]
    ds_read_b64_tr_b16 a[128:129], v48 offset:16384
    ds_read_b64_tr_b16 a[130:131], v48 offset:20480
    buffer_load_dwordx4 v[236:239], v16, s[56:59], s75 offen offset:1024 sc1
    s_waitcnt lgkmcnt(12)
    v_mfma_f32_16x16x32_bf16 v[104:107], a[168:171], a[20:23], v[104:107]
    ds_read_b64_tr_b16 a[132:133], v49 offset:16384
    ds_read_b64_tr_b16 a[134:135], v49 offset:20480
    buffer_load_dwordx4 v[244:247], v16, s[56:59], s75 offen offset:2048 sc1
    s_waitcnt lgkmcnt(12)
    v_mfma_f32_16x16x32_bf16 v[108:111], a[172:175], a[20:23], v[108:111]
    ds_read_b64_tr_b16 a[136:137], v50 offset:16384
    ds_read_b64_tr_b16 a[138:139], v50 offset:20480
    buffer_load_dwordx4 v[252:255], v16, s[56:59], s75 offen offset:3072 sc1
    s_waitcnt lgkmcnt(12)
    v_mfma_f32_16x16x32_bf16 v[112:115], a[176:179], a[20:23], v[112:115]
    ds_read_b64_tr_b16 a[140:141], v51 offset:16384
    ds_read_b64_tr_b16 a[142:143], v51 offset:20480
    s_waitcnt lgkmcnt(12)
    v_mfma_f32_16x16x32_bf16 v[116:119], a[180:183], a[20:23], v[116:119]
    ds_read_b64_tr_b16 a[144:145], v52 offset:16384
    ds_read_b64_tr_b16 a[146:147], v52 offset:20480
    s_waitcnt lgkmcnt(12)
    v_mfma_f32_16x16x32_bf16 v[120:123], a[184:187], a[20:23], v[120:123]
    ds_read_b64_tr_b16 a[148:149], v53 offset:16384
    ds_read_b64_tr_b16 a[150:151], v53 offset:20480
    s_waitcnt lgkmcnt(12)
    v_mfma_f32_16x16x32_bf16 v[124:127], a[188:191], a[20:23], v[124:127]
    ds_read_b64_tr_b16 a[152:153], v54 offset:16384
    ds_read_b64_tr_b16 a[154:155], v54 offset:20480
    s_waitcnt lgkmcnt(12)
    v_mfma_f32_16x16x32_bf16 v[96:99], a[128:131], a[24:27], v[96:99]
    ds_read_b64_tr_b16 a[156:157], v55 offset:16384
    ds_read_b64_tr_b16 a[158:159], v55 offset:20480
    s_waitcnt lgkmcnt(12)
    v_mfma_f32_16x16x32_bf16 v[100:103], a[132:135], a[24:27], v[100:103]
    ds_read_b64_tr_b16 a[160:161], v48 offset:24576
    ds_read_b64_tr_b16 a[162:163], v48 offset:28672
    s_waitcnt lgkmcnt(12)
    v_mfma_f32_16x16x32_bf16 v[104:107], a[136:139], a[24:27], v[104:107]
    ds_read_b64_tr_b16 a[164:165], v49 offset:24576
    ds_read_b64_tr_b16 a[166:167], v49 offset:28672
    s_waitcnt lgkmcnt(12)
    v_mfma_f32_16x16x32_bf16 v[108:111], a[140:143], a[24:27], v[108:111]
    ds_read_b64_tr_b16 a[168:169], v50 offset:24576
    ds_read_b64_tr_b16 a[170:171], v50 offset:28672
    s_waitcnt lgkmcnt(12)
    v_mfma_f32_16x16x32_bf16 v[112:115], a[144:147], a[24:27], v[112:115]
    ds_read_b64_tr_b16 a[172:173], v51 offset:24576
    ds_read_b64_tr_b16 a[174:175], v51 offset:28672
    s_waitcnt lgkmcnt(12)
    v_mfma_f32_16x16x32_bf16 v[116:119], a[148:151], a[24:27], v[116:119]
    ds_read_b64_tr_b16 a[176:177], v52 offset:24576
    ds_read_b64_tr_b16 a[178:179], v52 offset:28672
    s_waitcnt lgkmcnt(12)
    v_mfma_f32_16x16x32_bf16 v[120:123], a[152:155], a[24:27], v[120:123]
    ds_read_b64_tr_b16 a[180:181], v53 offset:24576
    ds_read_b64_tr_b16 a[182:183], v53 offset:28672
    s_waitcnt lgkmcnt(12)
    v_mfma_f32_16x16x32_bf16 v[124:127], a[156:159], a[24:27], v[124:127]
    ds_read_b64_tr_b16 a[184:185], v54 offset:24576
    ds_read_b64_tr_b16 a[186:187], v54 offset:28672
    s_waitcnt lgkmcnt(12)
    v_mfma_f32_16x16x32_bf16 v[96:99], a[160:163], a[28:31], v[96:99]
    ds_read_b64_tr_b16 a[188:189], v55 offset:24576
    ds_read_b64_tr_b16 a[190:191], v55 offset:28672
    s_waitcnt lgkmcnt(12)
    v_mfma_f32_16x16x32_bf16 v[100:103], a[164:167], a[28:31], v[100:103]
    ds_read_b64_tr_b16 a[128:129], v48 offset:32768
    ds_read_b64_tr_b16 a[130:131], v48 offset:36864
    s_waitcnt lgkmcnt(12)
    v_mfma_f32_16x16x32_bf16 v[104:107], a[168:171], a[28:31], v[104:107]
    ds_read_b64_tr_b16 a[132:133], v49 offset:32768
    ds_read_b64_tr_b16 a[134:135], v49 offset:36864
    s_waitcnt lgkmcnt(12)
    v_mfma_f32_16x16x32_bf16 v[108:111], a[172:175], a[28:31], v[108:111]
    ds_read_b64_tr_b16 a[136:137], v50 offset:32768
    ds_read_b64_tr_b16 a[138:139], v50 offset:36864
    s_waitcnt lgkmcnt(12)
    v_mfma_f32_16x16x32_bf16 v[112:115], a[176:179], a[28:31], v[112:115]
    ds_read_b64_tr_b16 a[140:141], v51 offset:32768
    ds_read_b64_tr_b16 a[142:143], v51 offset:36864
    s_waitcnt lgkmcnt(12)
    v_mfma_f32_16x16x32_bf16 v[116:119], a[180:183], a[28:31], v[116:119]
    ds_read_b64_tr_b16 a[144:145], v52 offset:32768
    ds_read_b64_tr_b16 a[146:147], v52 offset:36864
    s_waitcnt lgkmcnt(12)
    v_mfma_f32_16x16x32_bf16 v[120:123], a[184:187], a[28:31], v[120:123]
    ds_read_b64_tr_b16 a[148:149], v53 offset:32768
    ds_read_b64_tr_b16 a[150:151], v53 offset:36864
    s_waitcnt lgkmcnt(12)
    v_mfma_f32_16x16x32_bf16 v[124:127], a[188:191], a[28:31], v[124:127]
    ds_read_b64_tr_b16 a[152:153], v54 offset:32768
    ds_read_b64_tr_b16 a[154:155], v54 offset:36864
    s_waitcnt vmcnt(12)
    s_barrier
    s_waitcnt lgkmcnt(12)
    v_mfma_f32_16x16x32_bf16 v[96:99], a[128:131], a[32:35], v[96:99]
    ds_read_b64_tr_b16 a[156:157], v55 offset:32768
    ds_read_b64_tr_b16 a[158:159], v55 offset:36864
    s_waitcnt lgkmcnt(12)
    v_mfma_f32_16x16x32_bf16 v[100:103], a[132:135], a[32:35], v[100:103]
    ds_read_b64_tr_b16 a[160:161], v48 offset:40960
    ds_read_b64_tr_b16 a[162:163], v48 offset:45056
    s_waitcnt lgkmcnt(12)
    v_mfma_f32_16x16x32_bf16 v[104:107], a[136:139], a[32:35], v[104:107]
    ds_read_b64_tr_b16 a[164:165], v49 offset:40960
    ds_read_b64_tr_b16 a[166:167], v49 offset:45056
    s_waitcnt lgkmcnt(12)
    v_mfma_f32_16x16x32_bf16 v[108:111], a[140:143], a[32:35], v[108:111]
    ds_read_b64_tr_b16 a[168:169], v50 offset:40960
    ds_read_b64_tr_b16 a[170:171], v50 offset:45056
    s_waitcnt lgkmcnt(12)
    v_mfma_f32_16x16x32_bf16 v[112:115], a[144:147], a[32:35], v[112:115]
    ds_read_b64_tr_b16 a[172:173], v51 offset:40960
    ds_read_b64_tr_b16 a[174:175], v51 offset:45056
    s_waitcnt lgkmcnt(12)
    v_mfma_f32_16x16x32_bf16 v[116:119], a[148:151], a[32:35], v[116:119]
    ds_read_b64_tr_b16 a[176:177], v52 offset:40960
    ds_read_b64_tr_b16 a[178:179], v52 offset:45056
    s_waitcnt lgkmcnt(12)
    v_mfma_f32_16x16x32_bf16 v[120:123], a[152:155], a[32:35], v[120:123]
    ds_read_b64_tr_b16 a[180:181], v53 offset:40960
    ds_read_b64_tr_b16 a[182:183], v53 offset:45056
    s_waitcnt lgkmcnt(12)
    v_mfma_f32_16x16x32_bf16 v[124:127], a[156:159], a[32:35], v[124:127]
    ds_read_b64_tr_b16 a[184:185], v54 offset:40960
    ds_read_b64_tr_b16 a[186:187], v54 offset:45056
    s_waitcnt lgkmcnt(12)
    v_mfma_f32_16x16x32_bf16 v[96:99], a[160:163], a[36:39], v[96:99]
    ds_read_b64_tr_b16 a[188:189], v55 offset:40960
    ds_read_b64_tr_b16 a[190:191], v55 offset:45056
    s_waitcnt lgkmcnt(12)
    v_mfma_f32_16x16x32_bf16 v[100:103], a[164:167], a[36:39], v[100:103]
    ds_read_b64_tr_b16 a[128:129], v48 offset:49152
    ds_read_b64_tr_b16 a[130:131], v48 offset:53248
    s_waitcnt lgkmcnt(12)
    v_mfma_f32_16x16x32_bf16 v[104:107], a[168:171], a[36:39], v[104:107]
    ds_read_b64_tr_b16 a[132:133], v49 offset:49152
    ds_read_b64_tr_b16 a[134:135], v49 offset:53248
    s_waitcnt lgkmcnt(12)
    v_mfma_f32_16x16x32_bf16 v[108:111], a[172:175], a[36:39], v[108:111]
    ds_read_b64_tr_b16 a[136:137], v50 offset:49152
    ds_read_b64_tr_b16 a[138:139], v50 offset:53248
    s_waitcnt lgkmcnt(12)
    v_mfma_f32_16x16x32_bf16 v[112:115], a[176:179], a[36:39], v[112:115]
    ds_read_b64_tr_b16 a[140:141], v51 offset:49152
    ds_read_b64_tr_b16 a[142:143], v51 offset:53248
    s_waitcnt lgkmcnt(12)
    v_mfma_f32_16x16x32_bf16 v[116:119], a[180:183], a[36:39], v[116:119]
    ds_read_b64_tr_b16 a[144:145], v52 offset:49152
    ds_read_b64_tr_b16 a[146:147], v52 offset:53248
    s_waitcnt lgkmcnt(12)
    v_mfma_f32_16x16x32_bf16 v[120:123], a[184:187], a[36:39], v[120:123]
    ds_read_b64_tr_b16 a[148:149], v53 offset:49152
    ds_read_b64_tr_b16 a[150:151], v53 offset:53248
    s_waitcnt lgkmcnt(12)
    v_mfma_f32_16x16x32_bf16 v[124:127], a[188:191], a[36:39], v[124:127]
    ds_read_b64_tr_b16 a[152:153], v54 offset:49152
    ds_read_b64_tr_b16 a[154:155], v54 offset:53248
    s_waitcnt lgkmcnt(12)
    v_mfma_f32_16x16x32_bf16 v[96:99], a[128:131], a[40:43], v[96:99]
    ds_read_b64_tr_b16 a[156:157], v55 offset:49152
    ds_read_b64_tr_b16 a[158:159], v55 offset:53248
    s_waitcnt lgkmcnt(12)
    v_mfma_f32_16x16x32_bf16 v[100:103], a[132:135], a[40:43], v[100:103]
    ds_read_b64_tr_b16 a[160:161], v48 offset:57344
    ds_read_b64_tr_b16 a[162:163], v48 offset:61440
    s_waitcnt lgkmcnt(12)
    v_mfma_f32_16x16x32_bf16 v[104:107], a[136:139], a[40:43], v[104:107]
    ds_read_b64_tr_b16 a[164:165], v49 offset:57344
    ds_read_b64_tr_b16 a[166:167], v49 offset:61440
    s_waitcnt lgkmcnt(12)
    v_mfma_f32_16x16x32_bf16 v[108:111], a[140:143], a[40:43], v[108:111]
    ds_read_b64_tr_b16 a[168:169], v50 offset:57344
    ds_read_b64_tr_b16 a[170:171], v50 offset:61440
    s_waitcnt lgkmcnt(12)
    v_mfma_f32_16x16x32_bf16 v[112:115], a[144:147], a[40:43], v[112:115]
    ds_read_b64_tr_b16 a[172:173], v51 offset:57344
    ds_read_b64_tr_b16 a[174:175], v51 offset:61440
    s_waitcnt lgkmcnt(12)
    v_mfma_f32_16x16x32_bf16 v[116:119], a[148:151], a[40:43], v[116:119]
    ds_read_b64_tr_b16 a[176:177], v52 offset:57344
    ds_read_b64_tr_b16 a[178:179], v52 offset:61440
    s_waitcnt lgkmcnt(12)
    v_mfma_f32_16x16x32_bf16 v[120:123], a[152:155], a[40:43], v[120:123]
    ds_read_b64_tr_b16 a[180:181], v53 offset:57344
    ds_read_b64_tr_b16 a[182:183], v53 offset:61440
    s_waitcnt lgkmcnt(12)
    v_mfma_f32_16x16x32_bf16 v[124:127], a[156:159], a[40:43], v[124:127]
    ds_read_b64_tr_b16 a[184:185], v54 offset:57344
    ds_read_b64_tr_b16 a[186:187], v54 offset:61440
    s_waitcnt lgkmcnt(12)
    v_mfma_f32_16x16x32_bf16 v[96:99], a[160:163], a[44:47], v[96:99]
    ds_read_b64_tr_b16 a[188:189], v55 offset:57344
    ds_read_b64_tr_b16 a[190:191], v55 offset:61440
    s_waitcnt lgkmcnt(12)
    v_mfma_f32_16x16x32_bf16 v[100:103], a[164:167], a[44:47], v[100:103]
    ds_read_b64_tr_b16 a[128:129], v56 offset:0
    ds_read_b64_tr_b16 a[130:131], v56 offset:4096
    s_waitcnt lgkmcnt(12)
    v_mfma_f32_16x16x32_bf16 v[104:107], a[168:171], a[44:47], v[104:107]
    ds_read_b64_tr_b16 a[132:133], v57 offset:0
    ds_read_b64_tr_b16 a[134:135], v57 offset:4096
    s_waitcnt lgkmcnt(12)
    v_mfma_f32_16x16x32_bf16 v[108:111], a[172:175], a[44:47], v[108:111]
    ds_read_b64_tr_b16 a[136:137], v58 offset:0
    ds_read_b64_tr_b16 a[138:139], v58 offset:4096
    s_waitcnt lgkmcnt(12)
    v_mfma_f32_16x16x32_bf16 v[112:115], a[176:179], a[44:47], v[112:115]
    ds_read_b64_tr_b16 a[140:141], v59 offset:0
    ds_read_b64_tr_b16 a[142:143], v59 offset:4096
    s_waitcnt lgkmcnt(12)
    v_mfma_f32_16x16x32_bf16 v[116:119], a[180:183], a[44:47], v[116:119]
    ds_read_b64_tr_b16 a[144:145], v60 offset:0
    ds_read_b64_tr_b16 a[146:147], v60 offset:4096
    s_waitcnt lgkmcnt(12)
    v_mfma_f32_16x16x32_bf16 v[120:123], a[184:187], a[44:47], v[120:123]
    ds_read_b64_tr_b16 a[148:149], v61 offset:0
    ds_read_b64_tr_b16 a[150:151], v61 offset:4096
    s_waitcnt lgkmcnt(12)
    v_mfma_f32_16x16x32_bf16 v[124:127], a[188:191], a[44:47], v[124:127]
    ds_read_b64_tr_b16 a[152:153], v62 offset:0
    ds_read_b64_tr_b16 a[154:155], v62 offset:4096
    s_waitcnt lgkmcnt(12)
    v_mfma_f32_16x16x32_bf16 v[96:99], a[128:131], a[48:51], v[96:99]
    ds_read_b64_tr_b16 a[156:157], v63 offset:0
    ds_read_b64_tr_b16 a[158:159], v63 offset:4096
    s_waitcnt lgkmcnt(12)
    v_mfma_f32_16x16x32_bf16 v[100:103], a[132:135], a[48:51], v[100:103]
    ds_read_b64_tr_b16 a[160:161], v56 offset:8192
    ds_read_b64_tr_b16 a[162:163], v56 offset:12288
    s_waitcnt lgkmcnt(12)
    v_mfma_f32_16x16x32_bf16 v[104:107], a[136:139], a[48:51], v[104:107]
    ds_read_b64_tr_b16 a[164:165], v57 offset:8192
    ds_read_b64_tr_b16 a[166:167], v57 offset:12288
    s_waitcnt lgkmcnt(12)
    v_mfma_f32_16x16x32_bf16 v[108:111], a[140:143], a[48:51], v[108:111]
    ds_read_b64_tr_b16 a[168:169], v58 offset:8192
    ds_read_b64_tr_b16 a[170:171], v58 offset:12288
    s_waitcnt lgkmcnt(12)
    v_mfma_f32_16x16x32_bf16 v[112:115], a[144:147], a[48:51], v[112:115]
    ds_read_b64_tr_b16 a[172:173], v59 offset:8192
    ds_read_b64_tr_b16 a[174:175], v59 offset:12288
    s_waitcnt lgkmcnt(12)
    v_mfma_f32_16x16x32_bf16 v[116:119], a[148:151], a[48:51], v[116:119]
    ds_read_b64_tr_b16 a[176:177], v60 offset:8192
    ds_read_b64_tr_b16 a[178:179], v60 offset:12288
    s_waitcnt lgkmcnt(12)
    v_mfma_f32_16x16x32_bf16 v[120:123], a[152:155], a[48:51], v[120:123]
    ds_read_b64_tr_b16 a[180:181], v61 offset:8192
    ds_read_b64_tr_b16 a[182:183], v61 offset:12288
    s_waitcnt lgkmcnt(12)
    v_mfma_f32_16x16x32_bf16 v[124:127], a[156:159], a[48:51], v[124:127]
    ds_read_b64_tr_b16 a[184:185], v62 offset:8192
    ds_read_b64_tr_b16 a[186:187], v62 offset:12288
    s_waitcnt lgkmcnt(12)
    v_mfma_f32_16x16x32_bf16 v[96:99], a[160:163], a[52:55], v[96:99]
    ds_read_b64_tr_b16 a[188:189], v63 offset:8192
    ds_read_b64_tr_b16 a[190:191], v63 offset:12288
    s_waitcnt lgkmcnt(12)
    v_mfma_f32_16x16x32_bf16 v[100:103], a[164:167], a[52:55], v[100:103]
    ds_read_b64_tr_b16 a[128:129], v56 offset:16384
    ds_read_b64_tr_b16 a[130:131], v56 offset:20480
    s_waitcnt lgkmcnt(12)
    v_mfma_f32_16x16x32_bf16 v[104:107], a[168:171], a[52:55], v[104:107]
    ds_read_b64_tr_b16 a[132:133], v57 offset:16384
    ds_read_b64_tr_b16 a[134:135], v57 offset:20480
    s_waitcnt lgkmcnt(12)
    v_mfma_f32_16x16x32_bf16 v[108:111], a[172:175], a[52:55], v[108:111]
    ds_read_b64_tr_b16 a[136:137], v58 offset:16384
    ds_read_b64_tr_b16 a[138:139], v58 offset:20480
    s_waitcnt lgkmcnt(12)
    v_mfma_f32_16x16x32_bf16 v[112:115], a[176:179], a[52:55], v[112:115]
    ds_read_b64_tr_b16 a[140:141], v59 offset:16384
    ds_read_b64_tr_b16 a[142:143], v59 offset:20480
    s_waitcnt lgkmcnt(12)
    v_mfma_f32_16x16x32_bf16 v[116:119], a[180:183], a[52:55], v[116:119]
    ds_read_b64_tr_b16 a[144:145], v60 offset:16384
    ds_read_b64_tr_b16 a[146:147], v60 offset:20480
    s_waitcnt lgkmcnt(12)
    v_mfma_f32_16x16x32_bf16 v[120:123], a[184:187], a[52:55], v[120:123]
    ds_read_b64_tr_b16 a[148:149], v61 offset:16384
    ds_read_b64_tr_b16 a[150:151], v61 offset:20480
    s_waitcnt lgkmcnt(12)
    v_mfma_f32_16x16x32_bf16 v[124:127], a[188:191], a[52:55], v[124:127]
    ds_read_b64_tr_b16 a[152:153], v62 offset:16384
    ds_read_b64_tr_b16 a[154:155], v62 offset:20480
    s_waitcnt lgkmcnt(12)
    v_mfma_f32_16x16x32_bf16 v[96:99], a[128:131], a[56:59], v[96:99]
    ds_read_b64_tr_b16 a[156:157], v63 offset:16384
    ds_read_b64_tr_b16 a[158:159], v63 offset:20480
    s_waitcnt lgkmcnt(12)
    v_mfma_f32_16x16x32_bf16 v[100:103], a[132:135], a[56:59], v[100:103]
    ds_read_b64_tr_b16 a[160:161], v56 offset:24576
    ds_read_b64_tr_b16 a[162:163], v56 offset:28672
    s_waitcnt lgkmcnt(12)
    v_mfma_f32_16x16x32_bf16 v[104:107], a[136:139], a[56:59], v[104:107]
    ds_read_b64_tr_b16 a[164:165], v57 offset:24576
    ds_read_b64_tr_b16 a[166:167], v57 offset:28672
    s_waitcnt lgkmcnt(12)
    v_mfma_f32_16x16x32_bf16 v[108:111], a[140:143], a[56:59], v[108:111]
    ds_read_b64_tr_b16 a[168:169], v58 offset:24576
    ds_read_b64_tr_b16 a[170:171], v58 offset:28672
    s_waitcnt lgkmcnt(12)
    v_mfma_f32_16x16x32_bf16 v[112:115], a[144:147], a[56:59], v[112:115]
    ds_read_b64_tr_b16 a[172:173], v59 offset:24576
    ds_read_b64_tr_b16 a[174:175], v59 offset:28672
    s_waitcnt lgkmcnt(12)
    v_mfma_f32_16x16x32_bf16 v[116:119], a[148:151], a[56:59], v[116:119]
    ds_read_b64_tr_b16 a[176:177], v60 offset:24576
    ds_read_b64_tr_b16 a[178:179], v60 offset:28672
    s_waitcnt lgkmcnt(12)
    v_mfma_f32_16x16x32_bf16 v[120:123], a[152:155], a[56:59], v[120:123]
    ds_read_b64_tr_b16 a[180:181], v61 offset:24576
    ds_read_b64_tr_b16 a[182:183], v61 offset:28672
    s_waitcnt lgkmcnt(12)
    v_mfma_f32_16x16x32_bf16 v[124:127], a[156:159], a[56:59], v[124:127]
    ds_read_b64_tr_b16 a[184:185], v62 offset:24576
    ds_read_b64_tr_b16 a[186:187], v62 offset:28672
    s_waitcnt lgkmcnt(12)
    v_mfma_f32_16x16x32_bf16 v[96:99], a[160:163], a[60:63], v[96:99]
    ds_read_b64_tr_b16 a[188:189], v63 offset:24576
    ds_read_b64_tr_b16 a[190:191], v63 offset:28672
    s_waitcnt lgkmcnt(12)
    v_mfma_f32_16x16x32_bf16 v[100:103], a[164:167], a[60:63], v[100:103]
    s_waitcnt lgkmcnt(10)
    v_mfma_f32_16x16x32_bf16 v[104:107], a[168:171], a[60:63], v[104:107]
    s_waitcnt lgkmcnt(8)
    v_mfma_f32_16x16x32_bf16 v[108:111], a[172:175], a[60:63], v[108:111]
    s_waitcnt lgkmcnt(6)
    v_mfma_f32_16x16x32_bf16 v[112:115], a[176:179], a[60:63], v[112:115]
    s_waitcnt lgkmcnt(4)
    v_mfma_f32_16x16x32_bf16 v[116:119], a[180:183], a[60:63], v[116:119]
    s_waitcnt lgkmcnt(2)
    v_mfma_f32_16x16x32_bf16 v[120:123], a[184:187], a[60:63], v[120:123]
    s_waitcnt lgkmcnt(0)
    v_mfma_f32_16x16x32_bf16 v[124:127], a[188:191], a[60:63], v[124:127]
    s_waitcnt vmcnt(11)
    v_mfma_f32_16x16x32_bf16 v[128:131], v[28:31], v[164:167], v[128:131]
    v_mfma_f32_16x16x32_bf16 v[132:135], v[26:29], v[164:167], v[132:135]
    s_waitcnt vmcnt(10)
    v_mfma_f32_16x16x32_bf16 v[136:139], v[28:31], v[172:175], v[136:139]
    v_mfma_f32_16x16x32_bf16 v[140:143], v[26:29], v[172:175], v[140:143]
    s_waitcnt vmcnt(9)
    v_mfma_f32_16x16x32_bf16 v[144:147], v[28:31], v[180:183], v[144:147]
    v_mfma_f32_16x16x32_bf16 v[148:151], v[26:29], v[180:183], v[148:151]
    s_waitcnt vmcnt(8)
    v_mfma_f32_16x16x32_bf16 v[152:155], v[28:31], v[188:191], v[152:155]
    v_mfma_f32_16x16x32_bf16 v[156:159], v[26:29], v[188:191], v[156:159]
    s_waitcnt vmcnt(7)
    v_mfma_f32_16x16x32_bf16 v[128:131], v[28:31], v[196:199], v[128:131]
    v_mfma_f32_16x16x32_bf16 v[132:135], v[26:29], v[196:199], v[132:135]
    s_waitcnt vmcnt(6)
    v_mfma_f32_16x16x32_bf16 v[136:139], v[28:31], v[204:207], v[136:139]
    v_mfma_f32_16x16x32_bf16 v[140:143], v[26:29], v[204:207], v[140:143]
    s_waitcnt vmcnt(5)
    v_mfma_f32_16x16x32_bf16 v[144:147], v[28:31], v[212:215], v[144:147]
    v_mfma_f32_16x16x32_bf16 v[148:151], v[26:29], v[212:215], v[148:151]
    s_waitcnt vmcnt(4)
    v_mfma_f32_16x16x32_bf16 v[152:155], v[28:31], v[220:223], v[152:155]
    v_mfma_f32_16x16x32_bf16 v[156:159], v[26:29], v[220:223], v[156:159]
    s_waitcnt vmcnt(3)
    v_mfma_f32_16x16x32_bf16 v[128:131], v[28:31], v[228:231], v[128:131]
    v_mfma_f32_16x16x32_bf16 v[132:135], v[26:29], v[228:231], v[132:135]
    s_waitcnt vmcnt(2)
    v_mfma_f32_16x16x32_bf16 v[136:139], v[28:31], v[236:239], v[136:139]
    v_mfma_f32_16x16x32_bf16 v[140:143], v[26:29], v[236:239], v[140:143]
    s_waitcnt vmcnt(1)
    v_mfma_f32_16x16x32_bf16 v[144:147], v[28:31], v[244:247], v[144:147]
    v_mfma_f32_16x16x32_bf16 v[148:151], v[26:29], v[244:247], v[148:151]
    s_waitcnt vmcnt(0)
    v_mfma_f32_16x16x32_bf16 v[152:155], v[28:31], v[252:255], v[152:155]
    v_mfma_f32_16x16x32_bf16 v[156:159], v[26:29], v[252:255], v[156:159]
    v_pk_mul_f32 v[34:35], v[128:129], s[14:15]
    v_pk_mul_f32 v[36:37], v[130:131], s[14:15]
    v_pk_mul_f32 v[38:39], v[132:133], s[14:15]
    v_pk_mul_f32 v[40:41], v[134:135], s[14:15]
    v_exp_f32 v34, v34
    v_exp_f32 v35, v35
    v_exp_f32 v36, v36
    v_exp_f32 v37, v37
    v_exp_f32 v38, v38
    v_exp_f32 v39, v39
    v_exp_f32 v40, v40
    v_exp_f32 v41, v41
    v_pk_mul_f32 v[96:97], v[96:97], v[128:129]
    v_pk_mul_f32 v[98:99], v[98:99], v[130:131]
    v_pk_mul_f32 v[100:101], v[100:101], v[132:133]
    v_pk_mul_f32 v[102:103], v[102:103], v[134:135]
    v_pk_add_f32 v[34:35], v[34:35], 1.0 op_sel_hi:[1,0]
    v_pk_add_f32 v[36:37], v[36:37], 1.0 op_sel_hi:[1,0]
    v_pk_add_f32 v[38:39], v[38:39], 1.0 op_sel_hi:[1,0]
    v_pk_add_f32 v[40:41], v[40:41], 1.0 op_sel_hi:[1,0]
    v_rcp_f32 v34, v34
    v_rcp_f32 v35, v35
    v_rcp_f32 v36, v36
    v_rcp_f32 v37, v37
    v_rcp_f32 v38, v38
    v_rcp_f32 v39, v39
    v_rcp_f32 v40, v40
    v_rcp_f32 v41, v41
    v_pk_fma_f32 v[96:97], v[96:97], v[34:35], v[64:65]
    v_pk_fma_f32 v[98:99], v[98:99], v[36:37], v[66:67]
    v_pk_fma_f32 v[100:101], v[100:101], v[38:39], v[68:69]
    v_pk_fma_f32 v[102:103], v[102:103], v[40:41], v[70:71]
    v_cvt_pk_bf16_f32 v96, v96, v97
    v_cvt_pk_bf16_f32 v97, v98, v99
    v_cvt_pk_bf16_f32 v98, v100, v101
    v_cvt_pk_bf16_f32 v99, v102, v103
    s_nop 0
    v_permlane16_swap_b32 v96, v98
    v_permlane16_swap_b32 v97, v99
    global_store_dwordx4 v2, v[96:99], s[22:23] offset:0 sc1
    v_pk_mul_f32 v[34:35], v[136:137], s[14:15]
    v_pk_mul_f32 v[36:37], v[138:139], s[14:15]
    v_pk_mul_f32 v[38:39], v[140:141], s[14:15]
    v_pk_mul_f32 v[40:41], v[142:143], s[14:15]
    v_exp_f32 v34, v34
    v_exp_f32 v35, v35
    v_exp_f32 v36, v36
    v_exp_f32 v37, v37
    v_exp_f32 v38, v38
    v_exp_f32 v39, v39
    v_exp_f32 v40, v40
    v_exp_f32 v41, v41
    v_pk_mul_f32 v[104:105], v[104:105], v[136:137]
    v_pk_mul_f32 v[106:107], v[106:107], v[138:139]
    v_pk_mul_f32 v[108:109], v[108:109], v[140:141]
    v_pk_mul_f32 v[110:111], v[110:111], v[142:143]
    v_pk_add_f32 v[34:35], v[34:35], 1.0 op_sel_hi:[1,0]
    v_pk_add_f32 v[36:37], v[36:37], 1.0 op_sel_hi:[1,0]
    v_pk_add_f32 v[38:39], v[38:39], 1.0 op_sel_hi:[1,0]
    v_pk_add_f32 v[40:41], v[40:41], 1.0 op_sel_hi:[1,0]
    v_rcp_f32 v34, v34
    v_rcp_f32 v35, v35
    v_rcp_f32 v36, v36
    v_rcp_f32 v37, v37
    v_rcp_f32 v38, v38
    v_rcp_f32 v39, v39
    v_rcp_f32 v40, v40
    v_rcp_f32 v41, v41
    v_pk_fma_f32 v[104:105], v[104:105], v[34:35], v[72:73]
    v_pk_fma_f32 v[106:107], v[106:107], v[36:37], v[74:75]
    v_pk_fma_f32 v[108:109], v[108:109], v[38:39], v[76:77]
    v_pk_fma_f32 v[110:111], v[110:111], v[40:41], v[78:79]
    v_cvt_pk_bf16_f32 v104, v104, v105
    v_cvt_pk_bf16_f32 v105, v106, v107
    v_cvt_pk_bf16_f32 v106, v108, v109
    v_cvt_pk_bf16_f32 v107, v110, v111
    s_nop 0
    v_permlane16_swap_b32 v104, v106
    v_permlane16_swap_b32 v105, v107
    global_store_dwordx4 v2, v[104:107], s[22:23] offset:64 sc1
    v_pk_mul_f32 v[34:35], v[144:145], s[14:15]
    v_pk_mul_f32 v[36:37], v[146:147], s[14:15]
    v_pk_mul_f32 v[38:39], v[148:149], s[14:15]
    v_pk_mul_f32 v[40:41], v[150:151], s[14:15]
    v_exp_f32 v34, v34
    v_exp_f32 v35, v35
    v_exp_f32 v36, v36
    v_exp_f32 v37, v37
    v_exp_f32 v38, v38
    v_exp_f32 v39, v39
    v_exp_f32 v40, v40
    v_exp_f32 v41, v41
    v_pk_mul_f32 v[112:113], v[112:113], v[144:145]
    v_pk_mul_f32 v[114:115], v[114:115], v[146:147]
    v_pk_mul_f32 v[116:117], v[116:117], v[148:149]
    v_pk_mul_f32 v[118:119], v[118:119], v[150:151]
    v_pk_add_f32 v[34:35], v[34:35], 1.0 op_sel_hi:[1,0]
    v_pk_add_f32 v[36:37], v[36:37], 1.0 op_sel_hi:[1,0]
    v_pk_add_f32 v[38:39], v[38:39], 1.0 op_sel_hi:[1,0]
    v_pk_add_f32 v[40:41], v[40:41], 1.0 op_sel_hi:[1,0]
    v_rcp_f32 v34, v34
    v_rcp_f32 v35, v35
    v_rcp_f32 v36, v36
    v_rcp_f32 v37, v37
    v_rcp_f32 v38, v38
    v_rcp_f32 v39, v39
    v_rcp_f32 v40, v40
    v_rcp_f32 v41, v41
    v_pk_fma_f32 v[112:113], v[112:113], v[34:35], v[80:81]
    v_pk_fma_f32 v[114:115], v[114:115], v[36:37], v[82:83]
    v_pk_fma_f32 v[116:117], v[116:117], v[38:39], v[84:85]
    v_pk_fma_f32 v[118:119], v[118:119], v[40:41], v[86:87]
    v_cvt_pk_bf16_f32 v112, v112, v113
    v_cvt_pk_bf16_f32 v113, v114, v115
    v_cvt_pk_bf16_f32 v114, v116, v117
    v_cvt_pk_bf16_f32 v115, v118, v119
    s_nop 0
    v_permlane16_swap_b32 v112, v114
    v_permlane16_swap_b32 v113, v115
    global_store_dwordx4 v2, v[112:115], s[22:23] offset:128 sc1
    v_pk_mul_f32 v[34:35], v[152:153], s[14:15]
    v_pk_mul_f32 v[36:37], v[154:155], s[14:15]
    v_pk_mul_f32 v[38:39], v[156:157], s[14:15]
    v_pk_mul_f32 v[40:41], v[158:159], s[14:15]
    v_exp_f32 v34, v34
    v_exp_f32 v35, v35
    v_exp_f32 v36, v36
    v_exp_f32 v37, v37
    v_exp_f32 v38, v38
    v_exp_f32 v39, v39
    v_exp_f32 v40, v40
    v_exp_f32 v41, v41
    v_pk_mul_f32 v[120:121], v[120:121], v[152:153]
    v_pk_mul_f32 v[122:123], v[122:123], v[154:155]
    v_pk_mul_f32 v[124:125], v[124:125], v[156:157]
    v_pk_mul_f32 v[126:127], v[126:127], v[158:159]
    v_pk_add_f32 v[34:35], v[34:35], 1.0 op_sel_hi:[1,0]
    v_pk_add_f32 v[36:37], v[36:37], 1.0 op_sel_hi:[1,0]
    v_pk_add_f32 v[38:39], v[38:39], 1.0 op_sel_hi:[1,0]
    v_pk_add_f32 v[40:41], v[40:41], 1.0 op_sel_hi:[1,0]
    v_rcp_f32 v34, v34
    v_rcp_f32 v35, v35
    v_rcp_f32 v36, v36
    v_rcp_f32 v37, v37
    v_rcp_f32 v38, v38
    v_rcp_f32 v39, v39
    v_rcp_f32 v40, v40
    v_rcp_f32 v41, v41
    v_pk_fma_f32 v[120:121], v[120:121], v[34:35], v[88:89]
    v_pk_fma_f32 v[122:123], v[122:123], v[36:37], v[90:91]
    v_pk_fma_f32 v[124:125], v[124:125], v[38:39], v[92:93]
    v_pk_fma_f32 v[126:127], v[126:127], v[40:41], v[94:95]
    v_cvt_pk_bf16_f32 v120, v120, v121
    v_cvt_pk_bf16_f32 v121, v122, v123
    v_cvt_pk_bf16_f32 v122, v124, v125
    v_cvt_pk_bf16_f32 v123, v126, v127
    s_nop 0
    v_permlane16_swap_b32 v120, v122
    v_permlane16_swap_b32 v121, v123
    global_store_dwordx4 v2, v[120:123], s[22:23] offset:192 sc1
L_end:
    s_endpgm
L_spB:
    buffer_load_dword v43, off, s[56:59], s92 sc1
    s_waitcnt vmcnt(0)
    v_readfirstlane_b32 s86, v43
    s_bfe_u32 s86, s86, 0x80008
    s_cmp_eq_u32 s86, 16
    s_cbranch_scc1 L_okB
    s_add_u32 s67, s67, 1
    s_cmp_lt_u32 s67, 0x40000
    s_cbranch_scc1 L_spB
    s_branch L_okB
L_spC:
    buffer_load_dword v43, off, s[56:59], s92 sc1
    s_waitcnt vmcnt(0)
    v_readfirstlane_b32 s86, v43
    s_bfe_u32 s86, s86, 0x80010
    s_cmp_eq_u32 s86, 16
    s_cbranch_scc1 L_okC
    s_add_u32 s67, s67, 1
    s_cmp_lt_u32 s67, 0x40000
    s_cbranch_scc1 L_spC
    s_branch L_okC
L_spO:
    buffer_load_dword v43, off, s[56:59], s76 sc1
    s_waitcnt vmcnt(0)
    v_readfirstlane_b32 s86, v43
    s_cmp_eq_u32 s86, 64
    s_cbranch_scc1 L_okO
    s_add_u32 s67, s67, 1
    s_cmp_lt_u32 s67, 0x40000
    s_cbranch_scc1 L_spO
    s_branch L_okO
L_spP:
    buffer_load_dword v43, off, s[56:59], s77 sc1
    s_waitcnt vmcnt(0)
    v_readfirstlane_b32 s86, v43
    s_cmp_eq_u32 s86, 4
    s_cbranch_scc1 L_okP
    s_add_u32 s67, s67, 1
    s_cmp_lt_u32 s67, 0x40000
    s_cbranch_scc1 L_spP
    s_branch L_okP
L_code_end:
.section .rodata,"a"
.p2align 6
.amdhsa_kernel recurrent_scan__sliding_local_dilated__glu_gated_geglu__prompt_kernel
  .amdhsa_next_free_vgpr 512
  .amdhsa_next_free_sgpr 102
  .amdhsa_accum_offset 256
  .amdhsa_group_segment_fixed_size 0
  .amdhsa_kernarg_size 80
  .amdhsa_user_sgpr_count 2
  .amdhsa_user_sgpr_kernarg_segment_ptr 1
  .amdhsa_system_sgpr_workgroup_id_x 1
.end_amdhsa_kernel
```

```asm
; @launch grid=(256,1,1) block=(256,1,1) lds=163840
.amdgcn_target "amdgcn-amd-amdhsa--gfx950"
.text
.p2align 8
.globl recurrent_scan__sliding_local_dilated__glu_gated_geglu__prompt_kernel
.type recurrent_scan__sliding_local_dilated__glu_gated_geglu__prompt_kernel,@function
recurrent_scan__sliding_local_dilated__glu_gated_geglu__prompt_kernel:
    s_cmp_ge_u32 s2, 256
    s_cbranch_scc1 L_end
    s_load_dwordx16 s[8:23], s[0:1], 0
    s_load_dwordx4 s[24:27], s[0:1], 64
    v_lshrrev_b32 v1, 6, v0
    v_and_b32 v0, 63, v0
    v_readfirstlane_b32 s60, v1
    s_getpc_b64 s[86:87]
L_pc:
    s_lshr_b32 s82, s2, 3
    s_lshl_b32 s82, s82, 2
    s_add_u32 s82, s82, s60
    s_lshl_b32 s82, s82, 10
    v_lshl_add_u32 v2, v0, 4, s82
    v_min_u32 v2, L_code_end-L_pc-4, v2
    global_load_dword v7, v2, s[86:87]
    s_and_b32 s82, s2, 7
    s_lshr_b32 s83, s2, 3
    s_lshr_b32 s65, s82, 1
    s_and_b32 s63, s82, 1
    s_lshl_b32 s63, s63, 2
    s_and_b32 s84, s83, 3
    s_add_u32 s63, s63, s84
    s_lshr_b32 s66, s83, 2
    s_lshl_b32 s64, s65, 3
    s_add_u32 s64, s64, s66
    s_lshr_b32 s61, s60, 1
    s_and_b32 s62, s60, 1
    v_lshlrev_b32 v16, 4, v0
    s_lshl_b32 s84, s64, 2
    s_add_u32 s84, s84, s60
    s_lshl_b32 s85, s63, 7
    s_add_u32 s84, s84, s85
    s_lshl_b32 s85, s84, 12
    v_add_u32 v36, s85, v16
    s_lshl_b32 s84, s84, 2
    s_add_u32 s84, s84, 39845888
    v_mov_b32 v37, s84
    s_waitcnt lgkmcnt(0)
    global_load_dwordx4 v[48:51], v36, s[8:9] offset:0 nt
    global_load_dwordx4 v[52:55], v36, s[8:9] offset:1024 nt
    global_load_dwordx4 v[56:59], v36, s[8:9] offset:2048 nt
    global_load_dwordx4 v[60:63], v36, s[8:9] offset:3072 nt
    s_lshl_b32 s84, s63, 9
    s_lshl_b32 s85, s61, 8
    s_add_u32 s85, s85, s84
    s_sub_u32 s84, s84, 32
    s_max_i32 s84, s84, 0
    s_cmp_eq_u32 s62, 0
    s_cselect_b32 s85, s85, s84
    s_cselect_b32 s84, 63, 7
    s_add_u32 s85, s85, 39845888
    v_and_b32 v38, s84, v0
    v_lshlrev_b32 v38, 2, v38
    v_add_u32 v38, s85, v38
    global_load_dword v39, v38, s[26:27] sc1
    global_load_dword v40, v37, s[26:27] sc1
    v_lshlrev_b32 v2, 6, v0
    v_sub_u32 v2, v2, v16
    v_add_u32 v2, v2, v36
    s_sub_u32 s84, s63, s62
    s_max_i32 s84, s84, 0
    s_lshl_b32 s84, s84, 5
    v_mov_b32 v41, s84
    s_mov_b32 s56, s26
    s_and_b32 s57, s27, 0xffff
    s_mov_b32 s58, 0x10000000
    s_mov_b32 s59, 0x20000
    s_lshl_b32 s84, s63, 2
    s_add_u32 s84, s84, s65
    s_lshl_b32 s92, s84, 8
    s_add_u32 s92, s92, 39849984
    s_mul_i32 s88, s84, 458752
    s_add_u32 s88, s88, 8388608
    s_lshl_b32 s93, s63, 8
    s_add_u32 s93, s93, 39858176
    s_cmp_lg_u32 s60, 3
    s_cbranch_scc1 L_nozero
    s_lshl_b32 s84, s63, 3
    s_add_u32 s84, s84, s66
    s_lshl_b32 s84, s84, 2
    s_add_u32 s84, s84, s65
    s_lshl_b32 s84, s84, 8
    s_add_u32 s84, s84, 39862272
    v_mov_b32 v2, s84
    v_writelane_b32 v2, s92, 1
    v_writelane_b32 v2, s93, 2
    s_cmp_eq_u32 s66, 0
    s_cselect_b32 s84, 3, 1
    s_cmp_eq_u32 s64, 0
    s_cselect_b32 s84, 7, s84
    v_mov_b32 v3, 0
    s_mov_b32 exec_hi, 0
    s_mov_b32 exec_lo, s84
    global_store_dword v2, v3, s[26:27] sc1
    s_mov_b64 exec, -1
L_nozero:
    v_lshrrev_b32 v20, 2, v0
    v_and_b32 v21, 3, v0
    v_lshrrev_b32 v22, 4, v0
    v_and_b32 v23, 15, v0
    v_lshrrev_b32 v24, 3, v20
    v_lshlrev_b32 v24, 1, v24
    v_xor_b32 v24, v21, v24
    v_mul_u32_u24 v2, 6144, v20
    v_lshl_add_u32 v2, v24, 4, v2
    v_mul_u32_u24 v25, 7168, v20
    v_lshl_add_u32 v3, v24, 4, v25
    s_mul_i32 s84, s61, 98304
    s_lshl_b32 s85, s64, 6
    s_add_u32 s84, s84, s85
    s_add_u32 s32, s10, s84
    s_addc_u32 s33, s11, 0
    s_sub_u32 s32, s32, 4096
    s_subb_u32 s33, s33, 0
    s_and_b32 s33, s33, 0xffff
    s_sub_u32 s34, 6295552, s84
    s_mov_b32 s35, 0x20000
    s_mul_i32 s84, s61, 114688
    s_mul_i32 s85, s64, 224
    s_add_u32 s84, s84, s85
    s_add_u32 s36, s16, s84
    s_addc_u32 s37, s17, 0
    s_sub_u32 s36, s36, 4096
    s_subb_u32 s37, s37, 0
    s_and_b32 s37, s37, 0xffff
    s_sub_u32 s38, 7344128, s84
    s_mov_b32 s39, 0x20000
    s_add_u32 s40, s18, s84
    s_addc_u32 s41, s19, 0
    s_sub_u32 s40, s40, 4096
    s_subb_u32 s41, s41, 0
    s_and_b32 s41, s41, 0xffff
    s_sub_u32 s42, 7344128, s84
    s_mov_b32 s43, 0x20000
    v_cmp_lt_u32 vcc, 1, v24
    v_and_b32 v24, 1, v24
    v_lshl_add_u32 v24, v24, 4, v25
    v_add_u32 v24, 3264, v24
    v_mov_b32 v25, 0
    s_add_u32 s82, s16, s84
    s_addc_u32 s83, s17, 0
    s_sub_u32 s82, s82, 4096
    s_subb_u32 s83, s83, 0
    v_lshl_add_u64 v[4:5], v[24:25], 0, s[82:83]
    s_add_u32 s82, s18, s84
    s_addc_u32 s83, s19, 0
    s_sub_u32 s82, s82, 4096
    s_subb_u32 s83, s83, 0
    v_lshl_add_u64 v[24:25], v[24:25], 0, s[82:83]
    v_cndmask_b32 v4, v4, v24, vcc
    v_cndmask_b32 v5, v5, v25, vcc
    s_mov_b32 s80, 229376
    s_mov_b32 s81, 0
    s_cmp_eq_u32 s62, 1
    s_cbranch_scc1 L_init1
    s_lshl_b32 s78, s61, 14
    s_mov_b32 s68, 4096
    s_mov_b32 s69, 19456
    s_mov_b32 s70, 34816
    s_mov_b32 s71, 50176
    s_mov_b32 s72, 69632
    s_mov_b32 s73, 84992
    s_mov_b32 s74, 100352
    s_mov_b32 s75, 115712
    s_lshl_b32 s84, s63, 1
    s_add_u32 s84, s84, s61
    s_lshl_b32 s84, s84, 18
    s_branch L_init2
L_init1:
    s_mul_i32 s78, s61, 10240
    s_add_u32 s78, s78, 69632
    s_mov_b32 s68, 6144
    s_mov_b32 s69, 7168
    s_mov_b32 s70, 2048
    s_mov_b32 s71, 1024
    s_mov_b32 s72, 4096
    s_mov_b32 s73, 3136
    s_mov_b32 s74, 2112
    s_mov_b32 s75, 1152
    s_mov_b32 s76, 4224
    s_mov_b32 s14, 151552
    s_cmp_eq_u32 s61, 0
    s_cselect_b32 s15, 67584, s14
    s_cselect_b32 s14, 32768, s14
    s_lshl_b32 s84, s63, 19
    s_sub_u32 s84, s84, 32768
    s_max_i32 s84, s84, 0
L_init2:
    s_add_u32 s28, s26, s84
    s_addc_u32 s29, s27, 0
    s_sub_u32 s28, s28, 4096
    s_subb_u32 s29, s29, 0
    s_and_b32 s29, s29, 0xffff
    s_sub_u32 s30, 4198400, s84
    s_mov_b32 s31, 0x20000
    v_lshrrev_b32 v24, 3, v0
    v_and_b32 v25, 6, v24
    v_and_b32 v1, 7, v0
    v_xor_b32 v25, v25, v1
    v_lshlrev_b32 v25, 4, v25
    v_lshl_add_u32 v1, v24, 11, v25
    s_cmp_eq_u32 s63, 0
    s_cselect_b32 s84, 1, 3
    s_and_b32 s85, s60, s84
    s_cmp_eq_u32 s85, s84
    s_cselect_b32 s85, 0x40000000, 0
    s_cselect_b32 s87, 1, 0
    v_add_u32 v1, s85, v1
    s_lshr_b32 s83, s2, 3
    v_lshrrev_b32 v24, 3, v0
    v_and_b32 v25, 7, v0
    s_lshr_b32 s84, s63, 2
    s_lshl_b32 s84, s84, 4
    s_lshr_b32 s85, s83, 1
    s_add_u32 s84, s84, s85
    s_and_b32 s83, s83, 1
    s_cmp_eq_u32 s60, 0
    s_cbranch_scc1 L_pf0
    s_cmp_eq_u32 s60, 1
    s_cselect_b32 s44, s16, s18
    s_cselect_b32 s45, s17, s19
    s_cmp_eq_u32 s60, 3
    s_cselect_b32 s46, 0, 7340032
    s_mov_b32 s79, 229376
    s_mul_i32 s84, s84, 7168
    s_lshl_b32 s85, s65, 1
    s_add_u32 s85, s85, s83
    s_mul_i32 s85, s85, 896
    s_add_u32 s84, s84, s85
    v_cmp_gt_u32 vcc, 7, v25
    v_lshlrev_b32 v25, 7, v25
    s_branch L_pfd
L_pf0:
    s_mov_b32 s44, s10
    s_mov_b32 s45, s11
    s_mov_b32 s46, 6291456
    s_mov_b32 s79, 196608
    s_mul_i32 s84, s84, 6144
    s_lshl_b32 s85, s65, 1
    s_add_u32 s85, s85, s83
    s_lshl_b32 s85, s85, 8
    s_add_u32 s84, s84, s85
    v_cmp_gt_u32 vcc, 6, v25
    v_and_b32 v6, 1, v25
    v_lshrrev_b32 v25, 1, v25
    v_lshlrev_b32 v25, 11, v25
    v_lshl_add_u32 v25, v6, 7, v25
L_pfd:
    v_add_u32 v25, s84, v25
    v_mov_b32 v6, 0x40000000
    v_cndmask_b32 v25, v6, v25, vcc
    v_mul_lo_u32 v42, v24, s79
    v_add_u32 v42, v42, v25
    s_lshr_b32 s84, s79, 1
    s_sub_u32 s85, 0, s84
    s_cmp_lt_u32 s63, 4
    s_cselect_b32 s84, s84, s85
    s_mul_i32 s85, s79, 6
    s_sub_u32 s84, s84, s85
    v_add_u32 v25, s84, v42
    v_cmp_gt_u32 vcc, 4, v24
    s_nop 1
    v_cndmask_b32 v6, v6, v25, vcc
    v_cmp_gt_u32 vcc, 2, v24
    s_nop 1
    v_cndmask_b32 v6, v6, v42, vcc
    s_mul_i32 s84, s79, 8
    v_add_u32 v6, s84, v6
    s_lshl_b32 s86, s79, 3
    s_mul_i32 s79, s79, 2
    s_lshr_b32 s84, s2, 3
    s_and_b32 s84, s84, 0
    s_cmp_eq_u32 s84, 0
    s_cselect_b32 s4, 0, 0x40000000
    s_lshl_b32 s84, s63, 4
    s_add_u32 s84, s84, s65
    s_lshl_b32 s84, s84, 15
    s_lshl_b32 s85, s66, 8
    s_add_u32 s84, s84, s85
    s_add_u32 s48, s8, s84
    s_addc_u32 s49, s9, 0
    s_mov_b32 s50, 424192
    s_mov_b32 s52, 131072
    v_lshrrev_b32 v33, 1, v0
    v_and_b32 v24, 1, v0
    v_lshlrev_b32 v24, 7, v24
    v_lshl_add_u32 v33, v33, 11, v24
    v_subrev_u32 v33, 524288, v33
    v_mov_b32 v24, 0x40000000
    v_cmp_gt_u32 vcc, 32, v0
    s_nop 1
    v_cndmask_b32 v33, v24, v33, vcc
    s_cmp_lg_u32 s60, 3
    s_cbranch_scc1 L_pf3d
    s_lshl_b32 s84, s2, 13
    s_add_u32 s48, s12, s84
    s_addc_u32 s49, s13, 0
    s_mov_b32 s50, 8192
    s_mov_b32 s52, 2048
    v_lshlrev_b32 v25, 7, v0
    v_subrev_u32 v33, 16384, v25
    v_cmp_gt_u32 vcc, 16, v0
    s_nop 1
    v_cndmask_b32 v33, v24, v33, vcc
    s_and_b32 s84, s2, 7
    s_lshl_b32 s84, s84, 5
    s_lshr_b32 s85, s2, 3
    s_add_u32 s84, s84, s85
    s_mul_i32 s84, s84, 28672
    s_add_u32 s44, s20, s84
    s_addc_u32 s45, s21, 0
    s_mov_b32 s46, 14336
    s_mov_b32 s79, 7168
    v_subrev_u32 v6, 86016, v25
    v_mov_b32 v42, 0x40000000
    v_cmp_gt_u32 vcc, 56, v0
    s_nop 1
    v_cndmask_b32 v6, v42, v6, vcc
L_pf3d:
    s_and_b32 s49, s49, 0xffff
    s_mov_b32 s51, 0x20000
    s_and_b32 s45, s45, 0xffff
    s_mov_b32 s47, 0x20000
    v_and_b32 v24, 6, v23
    v_xor_b32 v24, v24, v22
    v_lshlrev_b32 v24, 4, v24
    v_lshl_add_u32 v24, v23, 7, v24
    v_xor_b32 v25, 64, v24
    s_lshl_b32 s84, s61, 14
    v_add_u32 v8, s84, v24
    v_add_u32 v9, s84, v25
    s_mul_i32 s84, s61, -18432
    s_add_u32 s84, s84, 32768
    v_add_u32 v10, s84, v24
    v_add_u32 v11, s84, v25
    v_lshrrev_b32 v24, 5, v0
    v_mul_u32_u24 v24, 10240, v24
    v_and_b32 v26, 1, v22
    v_bfe_u32 v25, v0, 2, 2
    v_lshl_add_u32 v25, v26, 3, v25
    v_lshl_add_u32 v24, v25, 6, v24
    v_and_b32 v25, 1, v0
    v_lshl_add_u32 v24, v25, 3, v24
    v_bfe_u32 v27, v0, 1, 1
    v_lshlrev_b32 v26, 1, v26
    s_mul_i32 s84, s62, 5120
    s_add_u32 s84, s84, 69632
    v_add_u32 v24, s84, v24
    v_add_u32 v25, 0, v27
    v_xor_b32 v25, v25, v26
    v_lshl_add_u32 v12, v25, 4, v24
    v_add_u32 v13, 40960, v12
    v_add_u32 v25, 2, v27
    v_xor_b32 v25, v25, v26
    v_lshl_add_u32 v14, v25, 4, v24
    v_add_u32 v15, 40960, v14
    v_mov_b32 v28, 0
    v_mov_b32 v29, 0
    v_mov_b32 v30, 0
    v_mov_b32 v31, 0
    s_cmp_eq_u32 s62, 1
    s_cbranch_scc1 L_early1
    s_mov_b64 exec, 0xffffffff
    buffer_load_dword v7, v42, s[44:47], 0 offen
    s_mov_b64 exec, -1
    v_mfma_f32_32x32x16_bf16 a[128:143], v[28:31], v[28:31], 0
    v_mfma_f32_32x32x16_bf16 a[144:159], v[28:31], v[28:31], 0
    v_mfma_f32_32x32x16_bf16 a[160:175], v[28:31], v[28:31], 0
    v_mfma_f32_32x32x16_bf16 a[176:191], v[28:31], v[28:31], 0
    v_mfma_f32_32x32x16_bf16 a[192:207], v[28:31], v[28:31], 0
    v_mfma_f32_32x32x16_bf16 a[208:223], v[28:31], v[28:31], 0
    v_mfma_f32_32x32x16_bf16 a[224:239], v[28:31], v[28:31], 0
    v_mfma_f32_32x32x16_bf16 a[240:255], v[28:31], v[28:31], 0
    v_mfma_f32_32x32x16_bf16 v[128:143], v[28:31], v[28:31], 0
    v_mfma_f32_32x32x16_bf16 v[144:159], v[28:31], v[28:31], 0
    v_mfma_f32_32x32x16_bf16 v[160:175], v[28:31], v[28:31], 0
    v_mfma_f32_32x32x16_bf16 v[176:191], v[28:31], v[28:31], 0
    v_mfma_f32_32x32x16_bf16 v[192:207], v[28:31], v[28:31], 0
    v_mfma_f32_32x32x16_bf16 v[208:223], v[28:31], v[28:31], 0
    v_mfma_f32_32x32x16_bf16 v[224:239], v[28:31], v[28:31], 0
    v_mfma_f32_32x32x16_bf16 v[240:255], v[28:31], v[28:31], 0
    s_waitcnt vmcnt(3)
    s_branch L_ln
L_early1:
    s_mov_b64 exec, 0xffffffff
    buffer_load_dword v7, v42, s[44:47], 0 offen
    s_mov_b64 exec, -1
    v_mfma_f32_32x32x16_bf16 a[128:143], v[28:31], v[28:31], 0
    v_mfma_f32_32x32x16_bf16 a[144:159], v[28:31], v[28:31], 0
    v_mfma_f32_32x32x16_bf16 a[160:175], v[28:31], v[28:31], 0
    v_mfma_f32_32x32x16_bf16 a[176:191], v[28:31], v[28:31], 0
    v_mfma_f32_32x32x16_bf16 a[192:207], v[28:31], v[28:31], 0
    v_mfma_f32_32x32x16_bf16 a[208:223], v[28:31], v[28:31], 0
    v_mfma_f32_32x32x16_bf16 a[224:239], v[28:31], v[28:31], 0
    v_mfma_f32_32x32x16_bf16 a[240:255], v[28:31], v[28:31], 0
    v_mfma_f32_32x32x16_bf16 v[128:143], v[28:31], v[28:31], 0
    v_mfma_f32_32x32x16_bf16 v[144:159], v[28:31], v[28:31], 0
    v_mfma_f32_32x32x16_bf16 v[160:175], v[28:31], v[28:31], 0
    v_mfma_f32_32x32x16_bf16 v[176:191], v[28:31], v[28:31], 0
    v_mfma_f32_32x32x16_bf16 v[192:207], v[28:31], v[28:31], 0
    v_mfma_f32_32x32x16_bf16 v[208:223], v[28:31], v[28:31], 0
    v_mfma_f32_32x32x16_bf16 v[224:239], v[28:31], v[28:31], 0
    v_mfma_f32_32x32x16_bf16 v[240:255], v[28:31], v[28:31], 0
    s_waitcnt vmcnt(3)
L_ln:
    v_lshlrev_b32 v64, 16, v48
    v_and_b32 v65, 0xffff0000, v48
    v_lshlrev_b32 v66, 16, v49
    v_and_b32 v67, 0xffff0000, v49
    v_lshlrev_b32 v68, 16, v50
    v_and_b32 v69, 0xffff0000, v50
    v_lshlrev_b32 v70, 16, v51
    v_and_b32 v71, 0xffff0000, v51
    v_lshlrev_b32 v72, 16, v52
    v_and_b32 v73, 0xffff0000, v52
    v_lshlrev_b32 v74, 16, v53
    v_and_b32 v75, 0xffff0000, v53
    v_lshlrev_b32 v76, 16, v54
    v_and_b32 v77, 0xffff0000, v54
    v_lshlrev_b32 v78, 16, v55
    v_and_b32 v79, 0xffff0000, v55
    v_lshlrev_b32 v80, 16, v56
    v_and_b32 v81, 0xffff0000, v56
    v_lshlrev_b32 v82, 16, v57
    v_and_b32 v83, 0xffff0000, v57
    v_lshlrev_b32 v84, 16, v58
    v_and_b32 v85, 0xffff0000, v58
    v_lshlrev_b32 v86, 16, v59
    v_and_b32 v87, 0xffff0000, v59
    v_lshlrev_b32 v88, 16, v60
    v_and_b32 v89, 0xffff0000, v60
    v_lshlrev_b32 v90, 16, v61
    v_and_b32 v91, 0xffff0000, v61
    v_lshlrev_b32 v92, 16, v62
    v_and_b32 v93, 0xffff0000, v62
    v_lshlrev_b32 v94, 16, v63
    v_and_b32 v95, 0xffff0000, v63
    v_pk_add_f32 v[96:97], v[64:65], v[66:67]
    v_pk_add_f32 v[98:99], v[80:81], v[82:83]
    v_pk_add_f32 v[96:97], v[96:97], v[68:69]
    v_pk_add_f32 v[98:99], v[98:99], v[84:85]
    v_pk_add_f32 v[96:97], v[96:97], v[70:71]
    v_pk_add_f32 v[98:99], v[98:99], v[86:87]
    v_pk_add_f32 v[96:97], v[96:97], v[72:73]
    v_pk_add_f32 v[98:99], v[98:99], v[88:89]
    v_pk_add_f32 v[96:97], v[96:97], v[74:75]
    v_pk_add_f32 v[98:99], v[98:99], v[90:91]
    v_pk_add_f32 v[96:97], v[96:97], v[76:77]
    v_pk_add_f32 v[98:99], v[98:99], v[92:93]
    v_pk_add_f32 v[96:97], v[96:97], v[78:79]
    v_pk_add_f32 v[98:99], v[98:99], v[94:95]
    v_add_f32 v102, v96, v97
    v_add_f32 v103, v98, v99
    s_nop 1
    v_permlane32_swap_b32 v102, v103
    v_add_f32 v102, v102, v103
    v_mov_b32 v100, v102
    s_nop 1
    v_permlane16_swap_b32 v102, v100
    v_add_f32 v102, v102, v100
    s_nop 1
    v_add_f32_dpp v102, v102, v102 quad_perm:[1,0,3,2] row_mask:0xf bank_mask:0xf
    s_nop 1
    v_add_f32_dpp v102, v102, v102 quad_perm:[2,3,0,1] row_mask:0xf bank_mask:0xf
    s_nop 1
    v_add_f32_dpp v102, v102, v102 row_half_mirror row_mask:0xf bank_mask:0xf
    s_nop 1
    v_add_f32_dpp v102, v102, v102 row_mirror row_mask:0xf bank_mask:0xf
    v_mul_f32 v102, 0xba800000, v102
    v_cvt_pk_bf16_f32 v106, v102, v102
    v_lshlrev_b32 v106, 16, v106
    v_mov_b32 v103, v102
    s_nop 1
    v_permlane32_swap_b32 v102, v103
    v_mov_b32 v107, v106
    s_nop 1
    v_permlane32_swap_b32 v106, v107
    v_pk_add_f32 v[108:109], v[64:65], v[102:103] op_sel_hi:[1,0]
    v_pk_add_f32 v[110:111], v[80:81], v[102:103] op_sel:[0,1] op_sel_hi:[1,1]
    v_pk_mul_f32 v[96:97], v[108:109], v[108:109]
    v_pk_mul_f32 v[98:99], v[110:111], v[110:111]
    v_pk_add_f32 v[108:109], v[66:67], v[102:103] op_sel_hi:[1,0]
    v_pk_add_f32 v[110:111], v[82:83], v[102:103] op_sel:[0,1] op_sel_hi:[1,1]
    v_pk_fma_f32 v[96:97], v[108:109], v[108:109], v[96:97]
    v_pk_fma_f32 v[98:99], v[110:111], v[110:111], v[98:99]
    v_pk_add_f32 v[108:109], v[68:69], v[102:103] op_sel_hi:[1,0]
    v_pk_add_f32 v[110:111], v[84:85], v[102:103] op_sel:[0,1] op_sel_hi:[1,1]
    v_pk_fma_f32 v[96:97], v[108:109], v[108:109], v[96:97]
    v_pk_fma_f32 v[98:99], v[110:111], v[110:111], v[98:99]
    v_pk_add_f32 v[108:109], v[70:71], v[102:103] op_sel_hi:[1,0]
    v_pk_add_f32 v[110:111], v[86:87], v[102:103] op_sel:[0,1] op_sel_hi:[1,1]
    v_pk_fma_f32 v[96:97], v[108:109], v[108:109], v[96:97]
    v_pk_fma_f32 v[98:99], v[110:111], v[110:111], v[98:99]
    v_pk_add_f32 v[108:109], v[72:73], v[102:103] op_sel_hi:[1,0]
    v_pk_add_f32 v[110:111], v[88:89], v[102:103] op_sel:[0,1] op_sel_hi:[1,1]
    v_pk_fma_f32 v[96:97], v[108:109], v[108:109], v[96:97]
    v_pk_fma_f32 v[98:99], v[110:111], v[110:111], v[98:99]
    v_pk_add_f32 v[108:109], v[74:75], v[102:103] op_sel_hi:[1,0]
    v_pk_add_f32 v[110:111], v[90:91], v[102:103] op_sel:[0,1] op_sel_hi:[1,1]
    v_pk_fma_f32 v[96:97], v[108:109], v[108:109], v[96:97]
    v_pk_fma_f32 v[98:99], v[110:111], v[110:111], v[98:99]
    v_pk_add_f32 v[108:109], v[76:77], v[102:103] op_sel_hi:[1,0]
    v_pk_add_f32 v[110:111], v[92:93], v[102:103] op_sel:[0,1] op_sel_hi:[1,1]
    v_pk_fma_f32 v[96:97], v[108:109], v[108:109], v[96:97]
    v_pk_fma_f32 v[98:99], v[110:111], v[110:111], v[98:99]
    v_pk_add_f32 v[108:109], v[78:79], v[102:103] op_sel_hi:[1,0]
    v_pk_add_f32 v[110:111], v[94:95], v[102:103] op_sel:[0,1] op_sel_hi:[1,1]
    v_pk_fma_f32 v[96:97], v[108:109], v[108:109], v[96:97]
    v_pk_fma_f32 v[98:99], v[110:111], v[110:111], v[98:99]
    v_add_f32 v104, v96, v97
    v_add_f32 v105, v98, v99
    s_nop 1
    v_permlane32_swap_b32 v104, v105
    v_add_f32 v104, v104, v105
    v_mov_b32 v100, v104
    s_nop 1
    v_permlane16_swap_b32 v104, v100
    v_add_f32 v104, v104, v100
    s_nop 1
    v_add_f32_dpp v104, v104, v104 quad_perm:[1,0,3,2] row_mask:0xf bank_mask:0xf
    s_nop 1
    v_add_f32_dpp v104, v104, v104 quad_perm:[2,3,0,1] row_mask:0xf bank_mask:0xf
    s_nop 1
    v_add_f32_dpp v104, v104, v104 row_half_mirror row_mask:0xf bank_mask:0xf
    s_nop 1
    v_add_f32_dpp v104, v104, v104 row_mirror row_mask:0xf bank_mask:0xf
    v_mul_f32 v104, 0x3a800000, v104
    v_cvt_pk_bf16_f32 v104, v104, v104
    v_lshlrev_b32 v104, 16, v104
    v_add_f32 v104, 0x3727c5ac, v104
    v_cvt_pk_bf16_f32 v104, v104, v104
    v_lshlrev_b32 v104, 16, v104
    v_sqrt_f32 v104, v104
    s_nop 0
    v_cvt_pk_bf16_f32 v104, v104, v104
    v_lshlrev_b32 v104, 16, v104
    v_rcp_f32 v100, v104
    s_nop 0
    v_fma_f32 v104, -v104, v100, 1.0
    v_fma_f32 v104, v104, v100, v100
    v_mov_b32 v105, v104
    s_nop 1
    v_permlane32_swap_b32 v104, v105
    v_pk_add_f32 v[64:65], v[64:65], v[106:107] op_sel_hi:[1,0]
    v_pk_add_f32 v[66:67], v[66:67], v[106:107] op_sel_hi:[1,0]
    v_pk_add_f32 v[68:69], v[68:69], v[106:107] op_sel_hi:[1,0]
    v_pk_add_f32 v[70:71], v[70:71], v[106:107] op_sel_hi:[1,0]
    v_cvt_pk_bf16_f32 v65, v64, v65
    v_cvt_pk_bf16_f32 v67, v66, v67
    v_cvt_pk_bf16_f32 v69, v68, v69
    v_cvt_pk_bf16_f32 v71, v70, v71
    v_lshlrev_b32 v64, 16, v65
    v_and_b32 v65, 0xffff0000, v65
    v_lshlrev_b32 v66, 16, v67
    v_and_b32 v67, 0xffff0000, v67
    v_lshlrev_b32 v68, 16, v69
    v_and_b32 v69, 0xffff0000, v69
    v_lshlrev_b32 v70, 16, v71
    v_and_b32 v71, 0xffff0000, v71
    v_pk_mul_f32 v[64:65], v[64:65], v[104:105] op_sel_hi:[1,0]
    v_pk_mul_f32 v[66:67], v[66:67], v[104:105] op_sel_hi:[1,0]
    v_pk_mul_f32 v[68:69], v[68:69], v[104:105] op_sel_hi:[1,0]
    v_pk_mul_f32 v[70:71], v[70:71], v[104:105] op_sel_hi:[1,0]
    v_cvt_pk_bf16_f32 v48, v64, v65
    v_cvt_pk_bf16_f32 v49, v66, v67
    v_cvt_pk_bf16_f32 v50, v68, v69
    v_cvt_pk_bf16_f32 v51, v70, v71
    global_store_dwordx4 v36, v[48:51], s[26:27] offset:0 sc1
    v_pk_add_f32 v[72:73], v[72:73], v[106:107] op_sel_hi:[1,0]
    v_pk_add_f32 v[74:75], v[74:75], v[106:107] op_sel_hi:[1,0]
    v_pk_add_f32 v[76:77], v[76:77], v[106:107] op_sel_hi:[1,0]
    v_pk_add_f32 v[78:79], v[78:79], v[106:107] op_sel_hi:[1,0]
    v_cvt_pk_bf16_f32 v73, v72, v73
    v_cvt_pk_bf16_f32 v75, v74, v75
    v_cvt_pk_bf16_f32 v77, v76, v77
    v_cvt_pk_bf16_f32 v79, v78, v79
    v_lshlrev_b32 v72, 16, v73
    v_and_b32 v73, 0xffff0000, v73
    v_lshlrev_b32 v74, 16, v75
    v_and_b32 v75, 0xffff0000, v75
    v_lshlrev_b32 v76, 16, v77
    v_and_b32 v77, 0xffff0000, v77
    v_lshlrev_b32 v78, 16, v79
    v_and_b32 v79, 0xffff0000, v79
    v_pk_mul_f32 v[72:73], v[72:73], v[104:105] op_sel_hi:[1,0]
    v_pk_mul_f32 v[74:75], v[74:75], v[104:105] op_sel_hi:[1,0]
    v_pk_mul_f32 v[76:77], v[76:77], v[104:105] op_sel_hi:[1,0]
    v_pk_mul_f32 v[78:79], v[78:79], v[104:105] op_sel_hi:[1,0]
    v_cvt_pk_bf16_f32 v52, v72, v73
    v_cvt_pk_bf16_f32 v53, v74, v75
    v_cvt_pk_bf16_f32 v54, v76, v77
    v_cvt_pk_bf16_f32 v55, v78, v79
    global_store_dwordx4 v36, v[52:55], s[26:27] offset:1024 sc1
    v_pk_add_f32 v[80:81], v[80:81], v[106:107] op_sel:[0,1] op_sel_hi:[1,1]
    v_pk_add_f32 v[82:83], v[82:83], v[106:107] op_sel:[0,1] op_sel_hi:[1,1]
    v_pk_add_f32 v[84:85], v[84:85], v[106:107] op_sel:[0,1] op_sel_hi:[1,1]
    v_pk_add_f32 v[86:87], v[86:87], v[106:107] op_sel:[0,1] op_sel_hi:[1,1]
    v_cvt_pk_bf16_f32 v81, v80, v81
    v_cvt_pk_bf16_f32 v83, v82, v83
    v_cvt_pk_bf16_f32 v85, v84, v85
    v_cvt_pk_bf16_f32 v87, v86, v87
    v_lshlrev_b32 v80, 16, v81
    v_and_b32 v81, 0xffff0000, v81
    v_lshlrev_b32 v82, 16, v83
    v_and_b32 v83, 0xffff0000, v83
    v_lshlrev_b32 v84, 16, v85
    v_and_b32 v85, 0xffff0000, v85
    v_lshlrev_b32 v86, 16, v87
    v_and_b32 v87, 0xffff0000, v87
    v_pk_mul_f32 v[80:81], v[80:81], v[104:105] op_sel:[0,1] op_sel_hi:[1,1]
    v_pk_mul_f32 v[82:83], v[82:83], v[104:105] op_sel:[0,1] op_sel_hi:[1,1]
    v_pk_mul_f32 v[84:85], v[84:85], v[104:105] op_sel:[0,1] op_sel_hi:[1,1]
    v_pk_mul_f32 v[86:87], v[86:87], v[104:105] op_sel:[0,1] op_sel_hi:[1,1]
    v_cvt_pk_bf16_f32 v56, v80, v81
    v_cvt_pk_bf16_f32 v57, v82, v83
    v_cvt_pk_bf16_f32 v58, v84, v85
    v_cvt_pk_bf16_f32 v59, v86, v87
    global_store_dwordx4 v36, v[56:59], s[26:27] offset:2048 sc1
    v_pk_add_f32 v[88:89], v[88:89], v[106:107] op_sel:[0,1] op_sel_hi:[1,1]
    v_pk_add_f32 v[90:91], v[90:91], v[106:107] op_sel:[0,1] op_sel_hi:[1,1]
    v_pk_add_f32 v[92:93], v[92:93], v[106:107] op_sel:[0,1] op_sel_hi:[1,1]
    v_pk_add_f32 v[94:95], v[94:95], v[106:107] op_sel:[0,1] op_sel_hi:[1,1]
    v_cvt_pk_bf16_f32 v89, v88, v89
    v_cvt_pk_bf16_f32 v91, v90, v91
    v_cvt_pk_bf16_f32 v93, v92, v93
    v_cvt_pk_bf16_f32 v95, v94, v95
    v_lshlrev_b32 v88, 16, v89
    v_and_b32 v89, 0xffff0000, v89
    v_lshlrev_b32 v90, 16, v91
    v_and_b32 v91, 0xffff0000, v91
    v_lshlrev_b32 v92, 16, v93
    v_and_b32 v93, 0xffff0000, v93
    v_lshlrev_b32 v94, 16, v95
    v_and_b32 v95, 0xffff0000, v95
    v_pk_mul_f32 v[88:89], v[88:89], v[104:105] op_sel:[0,1] op_sel_hi:[1,1]
    v_pk_mul_f32 v[90:91], v[90:91], v[104:105] op_sel:[0,1] op_sel_hi:[1,1]
    v_pk_mul_f32 v[92:93], v[92:93], v[104:105] op_sel:[0,1] op_sel_hi:[1,1]
    v_pk_mul_f32 v[94:95], v[94:95], v[104:105] op_sel:[0,1] op_sel_hi:[1,1]
    v_cvt_pk_bf16_f32 v60, v88, v89
    v_cvt_pk_bf16_f32 v61, v90, v91
    v_cvt_pk_bf16_f32 v62, v92, v93
    v_cvt_pk_bf16_f32 v63, v94, v95
    global_store_dwordx4 v36, v[60:63], s[26:27] offset:3072 sc1
    s_waitcnt vmcnt(5)
    v_add_u32 v40, 1, v40
    s_waitcnt vmcnt(0)
    s_mov_b64 exec, 1
    global_store_dword v37, v40, s[26:27] sc1
    s_mov_b64 exec, -1
    buffer_load_dword v7, v42, s[44:47], 0 offen
    v_add_u32_e64 v42, s86, v42
    s_barrier
    v_mfma_f32_32x32x16_bf16 v[48:63], v[28:31], v[28:31], 0
    v_mfma_f32_32x32x16_bf16 v[64:79], v[28:31], v[28:31], 0
    v_mfma_f32_32x32x16_bf16 v[80:95], v[28:31], v[28:31], 0
    v_mfma_f32_32x32x16_bf16 v[96:111], v[28:31], v[28:31], 0
    v_mfma_f32_32x32x16_bf16 v[112:127], v[28:31], v[28:31], 0
    s_mov_b32 s67, 0
    s_cmp_lg_u32 s60, 3
    s_cbranch_scc1 L_noarr
    s_lshl_b32 s84, s63, 5
    v_mov_b32 v20, s84
    v_mov_b32 v21, 1
    s_mov_b64 exec, 1
    global_atomic_add v20, v21, s[24:25] sc1
    s_mov_b64 exec, -1
L_noarr:
    s_cmp_eq_u32 s62, 0
    s_cbranch_scc1 L_now
    s_add_u32 m0, s78, 0
    s_nop 0
    buffer_load_dwordx4 v2, s[32:35], s68 offen offset:0 lds
    buffer_load_dwordx4 v2, s[32:35], s69 offen offset:1024 lds
    buffer_load_dwordx4 v2, s[32:35], s70 offen offset:2048 lds
    v_add_u32 v2, 196608, v2
    buffer_load_dwordx4 v3, s[36:39], s71 offen offset:3072 lds
    s_add_u32 m0, s78, 4096
    s_nop 0
    buffer_load_dwordx4 v3, s[40:43], s72 offen offset:0 lds
    buffer_load_dwordx4 v3, s[36:39], s73 offen offset:1024 lds
    buffer_load_dwordx4 v3, s[40:43], s74 offen offset:2048 lds
    buffer_load_dwordx4 v3, s[36:39], s75 offen offset:3072 lds
    s_add_u32 m0, s78, 8192
    s_nop 0
    buffer_load_dwordx4 v3, s[40:43], s76 offen offset:0 lds
    v_add_u32 v3, 229376, v3
    global_load_lds_dwordx4 v[4:5], off offset:1024
    v_lshl_add_u64 v[4:5], v[4:5], 0, s[80:81]
    s_add_u32 m0, s78, 20480
    s_nop 0
    buffer_load_dwordx4 v2, s[32:35], s68 offen offset:0 lds
    buffer_load_dwordx4 v2, s[32:35], s69 offen offset:1024 lds
    buffer_load_dwordx4 v2, s[32:35], s70 offen offset:2048 lds
    v_add_u32 v2, 196608, v2
    buffer_load_dwordx4 v3, s[36:39], s71 offen offset:3072 lds
    s_add_u32 m0, s78, 24576
    s_nop 0
    buffer_load_dwordx4 v3, s[40:43], s72 offen offset:0 lds
    buffer_load_dwordx4 v3, s[36:39], s73 offen offset:1024 lds
    buffer_load_dwordx4 v3, s[40:43], s74 offen offset:2048 lds
    buffer_load_dwordx4 v3, s[36:39], s75 offen offset:3072 lds
    s_add_u32 m0, s78, 28672
    s_nop 0
    buffer_load_dwordx4 v3, s[40:43], s76 offen offset:0 lds
    v_add_u32 v3, 229376, v3
    global_load_lds_dwordx4 v[4:5], off offset:1024
    v_lshl_add_u64 v[4:5], v[4:5], 0, s[80:81]
L_now:
    s_cmp_eq_u32 s60, 3
    s_cbranch_scc1 L_stub0
L_stubret:
    s_cmp_eq_u32 s87, 1
    s_cbranch_scc1 L_lnok
L_lnpoll:
    global_load_dword v20, v38, s[26:27] sc1
    s_waitcnt vmcnt(0)
    v_cmp_ne_u32 vcc, v20, v39
    s_cmp_eq_u64 vcc, -1
    s_cbranch_scc1 L_lnok
    s_add_u32 s67, s67, 1
    s_and_b32 s84, s67, 3
    s_cbranch_scc1 L_lnpoll
    global_load_dword v20, v41, s[24:25] sc1
    s_waitcnt vmcnt(0)
    v_readfirstlane_b32 s84, v20
    s_cmp_ge_u32 s84, 32
    s_cbranch_scc1 L_lnok
    s_cmp_lt_u32 s67, 0x40000
    s_cbranch_scc1 L_lnpoll
L_lnok:
    s_cmp_eq_u32 s62, 1
    s_cbranch_scc1 L_g1_1
    s_branch L_g1_0
.p2align 12
L_stub0:
    s_branch L_stub1
L_g1_0:
    v_add_u32 v2, 131072, v1
    s_add_u32 m0, s78, 0
    s_nop 0
    buffer_load_dwordx4 v1, s[28:31], s68 offen offset:0 sc1 lds
    buffer_load_dwordx4 v1, s[28:31], s69 offen offset:1024 sc1 lds
    buffer_load_dwordx4 v1, s[28:31], s70 offen offset:2048 sc1 lds
    buffer_load_dwordx4 v1, s[28:31], s71 offen offset:3072 sc1 lds
    s_add_u32 m0, s78, 4096
    s_nop 0
    buffer_load_dwordx4 v1, s[28:31], s72 offen offset:0 sc1 lds
    buffer_load_dwordx4 v1, s[28:31], s73 offen offset:1024 sc1 lds
    buffer_load_dwordx4 v1, s[28:31], s74 offen offset:2048 sc1 lds
    buffer_load_dwordx4 v1, s[28:31], s75 offen offset:3072 sc1 lds
    v_add_u32 v1, 128, v1
    s_add_u32 m0, s78, 8192
    s_nop 0
    buffer_load_dwordx4 v2, s[28:31], s68 offen offset:0 sc1 lds
    buffer_load_dwordx4 v2, s[28:31], s69 offen offset:1024 sc1 lds
    buffer_load_dwordx4 v2, s[28:31], s70 offen offset:2048 sc1 lds
    buffer_load_dwordx4 v2, s[28:31], s71 offen offset:3072 sc1 lds
    s_add_u32 m0, s78, 12288
    s_nop 0
    buffer_load_dwordx4 v2, s[28:31], s72 offen offset:0 sc1 lds
    buffer_load_dwordx4 v2, s[28:31], s73 offen offset:1024 sc1 lds
    buffer_load_dwordx4 v2, s[28:31], s74 offen offset:2048 sc1 lds
    buffer_load_dwordx4 v2, s[28:31], s75 offen offset:3072 sc1 lds
    v_add_u32 v2, 128, v2
    s_add_u32 m0, s78, 34816
    s_nop 0
    buffer_load_dwordx4 v1, s[28:31], s68 offen offset:0 sc1 lds
    buffer_load_dwordx4 v1, s[28:31], s69 offen offset:1024 sc1 lds
    buffer_load_dwordx4 v1, s[28:31], s70 offen offset:2048 sc1 lds
    buffer_load_dwordx4 v1, s[28:31], s71 offen offset:3072 sc1 lds
    s_add_u32 m0, s78, 38912
    s_nop 0
    buffer_load_dwordx4 v1, s[28:31], s72 offen offset:0 sc1 lds
    buffer_load_dwordx4 v1, s[28:31], s73 offen offset:1024 sc1 lds
    buffer_load_dwordx4 v1, s[28:31], s74 offen offset:2048 sc1 lds
    buffer_load_dwordx4 v1, s[28:31], s75 offen offset:3072 sc1 lds
    v_add_u32 v1, 128, v1
    s_add_u32 m0, s78, 43008
    s_nop 0
    buffer_load_dwordx4 v2, s[28:31], s68 offen offset:0 sc1 lds
    buffer_load_dwordx4 v2, s[28:31], s69 offen offset:1024 sc1 lds
    buffer_load_dwordx4 v2, s[28:31], s70 offen offset:2048 sc1 lds
    buffer_load_dwordx4 v2, s[28:31], s71 offen offset:3072 sc1 lds
    s_add_u32 m0, s78, 47104
    s_nop 0
    buffer_load_dwordx4 v2, s[28:31], s72 offen offset:0 sc1 lds
    buffer_load_dwordx4 v2, s[28:31], s73 offen offset:1024 sc1 lds
    buffer_load_dwordx4 v2, s[28:31], s74 offen offset:2048 sc1 lds
    buffer_load_dwordx4 v2, s[28:31], s75 offen offset:3072 sc1 lds
    v_add_u32 v2, 128, v2
    s_waitcnt vmcnt(16)
    s_barrier
    ds_read_b64_tr_b16 a[64:65], v12 offset:0
    ds_read_b64_tr_b16 a[66:67], v12 offset:256
    ds_read_b64_tr_b16 a[68:69], v14 offset:0
    ds_read_b64_tr_b16 a[70:71], v14 offset:256
    ds_read_b64_tr_b16 a[72:73], v12 offset:1024
    ds_read_b64_tr_b16 a[74:75], v12 offset:1280
    ds_read_b64_tr_b16 a[76:77], v14 offset:1024
    ds_read_b64_tr_b16 a[78:79], v14 offset:1280
    ds_read_b64_tr_b16 a[80:81], v12 offset:2048
    ds_read_b64_tr_b16 a[82:83], v12 offset:2304
    ds_read_b64_tr_b16 a[84:85], v14 offset:2048
    ds_read_b64_tr_b16 a[86:87], v14 offset:2304
    ds_read_b64_tr_b16 a[88:89], v12 offset:3072
    ds_read_b64_tr_b16 a[90:91], v12 offset:3328
    ds_read_b64_tr_b16 a[92:93], v14 offset:3072
    ds_read_b64_tr_b16 a[94:95], v14 offset:3328
    ds_read_b64_tr_b16 a[96:97], v12 offset:4096
    ds_read_b64_tr_b16 a[98:99], v12 offset:4352
    ds_read_b64_tr_b16 a[100:101], v14 offset:4096
    ds_read_b64_tr_b16 a[102:103], v14 offset:4352
    ds_read_b128 a[0:3], v8 offset:0
    ds_read_b128 a[4:7], v8 offset:2048
    ds_read_b128 a[8:11], v8 offset:4096
    ds_read_b128 a[12:15], v8 offset:6144
    ds_read_b128 a[16:19], v8 offset:8192
    ds_read_b128 a[20:23], v8 offset:10240
    ds_read_b128 a[24:27], v8 offset:12288
    ds_read_b128 a[28:31], v8 offset:14336
    ds_read_b128 a[112:115], v10 offset:0
    s_mov_b32 s67, 7
    v_mov_b32 v20, 0x7ff00000
.p2align 3
L_loop0:
    s_waitcnt lgkmcnt(0)
    s_barrier
    v_mfma_f32_16x16x32_bf16 a[128:131], a[64:67], a[0:3], a[128:131]
    buffer_load_dword v7, v6, s[44:47], s4 offen
    v_add_u32_e64 v6, s79, v6
    v_mfma_f32_16x16x32_bf16 a[136:139], a[64:67], a[4:7], a[136:139]
    v_mfma_f32_16x16x32_bf16 a[144:147], a[64:67], a[8:11], a[144:147]
    ds_read_b128 a[32:35], v9 offset:0
    v_mfma_f32_16x16x32_bf16 a[152:155], a[64:67], a[12:15], a[152:155]
    v_mfma_f32_16x16x32_bf16 a[160:163], a[64:67], a[16:19], a[160:163]
    v_mfma_f32_16x16x32_bf16 a[168:171], a[64:67], a[20:23], a[168:171]
    v_mfma_f32_16x16x32_bf16 a[176:179], a[64:67], a[24:27], a[176:179]
    ds_read_b128 a[36:39], v9 offset:2048
    v_mfma_f32_16x16x32_bf16 a[184:187], a[64:67], a[28:31], a[184:187]
    v_mfma_f32_16x16x32_bf16 v[120:123], a[64:67], a[112:115], v[120:123]
    ds_read_b64_tr_b16 a[64:65], v12 offset:20480
    v_mfma_f32_16x16x32_bf16 a[132:135], a[68:71], a[0:3], a[132:135]
    ds_read_b64_tr_b16 a[66:67], v12 offset:20736
    v_mfma_f32_16x16x32_bf16 a[140:143], a[68:71], a[4:7], a[140:143]
    ds_read_b128 a[40:43], v9 offset:4096
    v_mfma_f32_16x16x32_bf16 a[148:151], a[68:71], a[8:11], a[148:151]
    v_mfma_f32_16x16x32_bf16 a[156:159], a[68:71], a[12:15], a[156:159]
    v_mfma_f32_16x16x32_bf16 a[164:167], a[68:71], a[16:19], a[164:167]
    v_mfma_f32_16x16x32_bf16 a[172:175], a[68:71], a[20:23], a[172:175]
    ds_read_b128 a[44:47], v9 offset:6144
    v_mfma_f32_16x16x32_bf16 a[180:183], a[68:71], a[24:27], a[180:183]
    v_mfma_f32_16x16x32_bf16 a[188:191], a[68:71], a[28:31], a[188:191]
    v_mfma_f32_16x16x32_bf16 v[124:127], a[68:71], a[112:115], v[124:127]
    ds_read_b64_tr_b16 a[68:69], v14 offset:20480
    v_mfma_f32_16x16x32_bf16 v[52:55], a[0:3], a[72:75], v[52:55]
    ds_read_b64_tr_b16 a[70:71], v14 offset:20736
    v_mfma_f32_16x16x32_bf16 v[56:59], a[4:7], a[72:75], v[56:59]
    v_mfma_f32_16x16x32_bf16 v[60:63], a[8:11], a[72:75], v[60:63]
    ds_read_b128 a[48:51], v9 offset:8192
    v_mfma_f32_16x16x32_bf16 v[64:67], a[12:15], a[72:75], v[64:67]
    v_mfma_f32_16x16x32_bf16 v[68:71], a[16:19], a[72:75], v[68:71]
    ds_read_b128 a[52:55], v9 offset:10240
    v_mfma_f32_16x16x32_bf16 v[72:75], a[20:23], a[72:75], v[72:75]
    v_mfma_f32_16x16x32_bf16 v[76:79], a[24:27], a[72:75], v[76:79]
    v_mfma_f32_16x16x32_bf16 v[80:83], a[28:31], a[72:75], v[80:83]
    v_mfma_f32_16x16x32_bf16 v[48:51], a[112:115], a[72:75], v[48:51]
    ds_read_b64_tr_b16 a[72:73], v12 offset:21504
    v_mfma_f32_16x16x32_bf16 v[88:91], a[0:3], a[76:79], v[88:91]
    ds_read_b64_tr_b16 a[74:75], v12 offset:21760
    v_mfma_f32_16x16x32_bf16 v[92:95], a[4:7], a[76:79], v[92:95]
    ds_read_b128 a[56:59], v9 offset:12288
    v_mfma_f32_16x16x32_bf16 v[96:99], a[8:11], a[76:79], v[96:99]
    v_mfma_f32_16x16x32_bf16 v[100:103], a[12:15], a[76:79], v[100:103]
    ds_read_b128 a[60:63], v9 offset:14336
    v_mfma_f32_16x16x32_bf16 v[104:107], a[16:19], a[76:79], v[104:107]
    v_mfma_f32_16x16x32_bf16 v[108:111], a[20:23], a[76:79], v[108:111]
    v_mfma_f32_16x16x32_bf16 v[112:115], a[24:27], a[76:79], v[112:115]
    v_mfma_f32_16x16x32_bf16 v[116:119], a[28:31], a[76:79], v[116:119]
    ds_read_b128 a[116:119], v11 offset:0
    v_mfma_f32_16x16x32_bf16 v[84:87], a[112:115], a[76:79], v[84:87]
    ds_read_b64_tr_b16 a[76:77], v14 offset:21504
    v_mfma_f32_16x16x32_bf16 a[192:195], a[80:83], a[0:3], a[192:195]
    ds_read_b64_tr_b16 a[78:79], v14 offset:21760
    v_mfma_f32_16x16x32_bf16 a[200:203], a[80:83], a[4:7], a[200:203]
    v_mfma_f32_16x16x32_bf16 a[208:211], a[80:83], a[8:11], a[208:211]
    ds_read_b64_tr_b16 a[104:105], v12 offset:24576
    v_mfma_f32_16x16x32_bf16 a[216:219], a[80:83], a[12:15], a[216:219]
    v_mfma_f32_16x16x32_bf16 a[224:227], a[80:83], a[16:19], a[224:227]
    v_mfma_f32_16x16x32_bf16 a[232:235], a[80:83], a[20:23], a[232:235]
    v_mfma_f32_16x16x32_bf16 a[240:243], a[80:83], a[24:27], a[240:243]
    ds_read_b64_tr_b16 a[106:107], v12 offset:24832
    v_mfma_f32_16x16x32_bf16 a[248:251], a[80:83], a[28:31], a[248:251]
    ds_read_b64_tr_b16 a[80:81], v12 offset:22528
    v_mfma_f32_16x16x32_bf16 a[196:199], a[84:87], a[0:3], a[196:199]
    ds_read_b64_tr_b16 a[82:83], v12 offset:22784
    v_mfma_f32_16x16x32_bf16 a[204:207], a[84:87], a[4:7], a[204:207]
    v_mfma_f32_16x16x32_bf16 a[212:215], a[84:87], a[8:11], a[212:215]
    ds_read_b64_tr_b16 a[108:109], v14 offset:24576
    v_mfma_f32_16x16x32_bf16 a[220:223], a[84:87], a[12:15], a[220:223]
    v_mfma_f32_16x16x32_bf16 a[228:231], a[84:87], a[16:19], a[228:231]
    v_mfma_f32_16x16x32_bf16 a[236:239], a[84:87], a[20:23], a[236:239]
    v_mfma_f32_16x16x32_bf16 a[244:247], a[84:87], a[24:27], a[244:247]
    ds_read_b64_tr_b16 a[110:111], v14 offset:24832
    v_mfma_f32_16x16x32_bf16 a[252:255], a[84:87], a[28:31], a[252:255]
    ds_read_b64_tr_b16 a[84:85], v14 offset:22528
    v_mfma_f32_16x16x32_bf16 v[128:131], a[88:91], a[0:3], v[128:131]
    ds_read_b64_tr_b16 a[86:87], v14 offset:22784
    v_mfma_f32_16x16x32_bf16 v[144:147], a[88:91], a[4:7], v[144:147]
    v_mfma_f32_16x16x32_bf16 v[160:163], a[88:91], a[8:11], v[160:163]
    v_mfma_f32_16x16x32_bf16 v[176:179], a[88:91], a[12:15], v[176:179]
    v_mfma_f32_16x16x32_bf16 v[192:195], a[88:91], a[16:19], v[192:195]
    v_mfma_f32_16x16x32_bf16 v[208:211], a[88:91], a[20:23], v[208:211]
    v_mfma_f32_16x16x32_bf16 v[224:227], a[88:91], a[24:27], v[224:227]
    v_mfma_f32_16x16x32_bf16 v[240:243], a[88:91], a[28:31], v[240:243]
    ds_read_b64_tr_b16 a[88:89], v12 offset:23552
    v_mfma_f32_16x16x32_bf16 v[132:135], a[92:95], a[0:3], v[132:135]
    ds_read_b64_tr_b16 a[90:91], v12 offset:23808
    v_mfma_f32_16x16x32_bf16 v[148:151], a[92:95], a[4:7], v[148:151]
    v_mfma_f32_16x16x32_bf16 v[164:167], a[92:95], a[8:11], v[164:167]
    v_mfma_f32_16x16x32_bf16 v[180:183], a[92:95], a[12:15], v[180:183]
    v_mfma_f32_16x16x32_bf16 v[196:199], a[92:95], a[16:19], v[196:199]
    v_mfma_f32_16x16x32_bf16 v[212:215], a[92:95], a[20:23], v[212:215]
    v_mfma_f32_16x16x32_bf16 v[228:231], a[92:95], a[24:27], v[228:231]
    v_mfma_f32_16x16x32_bf16 v[244:247], a[92:95], a[28:31], v[244:247]
    ds_read_b64_tr_b16 a[92:93], v14 offset:23552
    v_mfma_f32_16x16x32_bf16 v[136:139], a[96:99], a[0:3], v[136:139]
    ds_read_b64_tr_b16 a[94:95], v14 offset:23808
    v_mfma_f32_16x16x32_bf16 v[152:155], a[96:99], a[4:7], v[152:155]
    v_mfma_f32_16x16x32_bf16 v[168:171], a[96:99], a[8:11], v[168:171]
    v_mfma_f32_16x16x32_bf16 v[184:187], a[96:99], a[12:15], v[184:187]
    v_mfma_f32_16x16x32_bf16 v[200:203], a[96:99], a[16:19], v[200:203]
    v_mfma_f32_16x16x32_bf16 v[216:219], a[96:99], a[20:23], v[216:219]
    v_mfma_f32_16x16x32_bf16 v[232:235], a[96:99], a[24:27], v[232:235]
    v_mfma_f32_16x16x32_bf16 v[248:251], a[96:99], a[28:31], v[248:251]
    v_mfma_f32_16x16x32_bf16 v[140:143], a[100:103], a[0:3], v[140:143]
    v_mfma_f32_16x16x32_bf16 v[156:159], a[100:103], a[4:7], v[156:159]
    v_mfma_f32_16x16x32_bf16 v[172:175], a[100:103], a[8:11], v[172:175]
    v_mfma_f32_16x16x32_bf16 v[188:191], a[100:103], a[12:15], v[188:191]
    v_mfma_f32_16x16x32_bf16 v[204:207], a[100:103], a[16:19], v[204:207]
    v_mfma_f32_16x16x32_bf16 v[220:223], a[100:103], a[20:23], v[220:223]
    v_mfma_f32_16x16x32_bf16 v[236:239], a[100:103], a[24:27], v[236:239]
    v_mfma_f32_16x16x32_bf16 v[252:255], a[100:103], a[28:31], v[252:255]
    s_waitcnt vmcnt(1) lgkmcnt(0)
    s_barrier
    v_mfma_f32_16x16x32_bf16 a[128:131], a[64:67], a[32:35], a[128:131]
    s_add_u32 m0, s78, 0
    v_mfma_f32_16x16x32_bf16 a[136:139], a[64:67], a[36:39], a[136:139]
    buffer_load_dwordx4 v1, s[28:31], s68 offen offset:0 sc1 lds
    v_mfma_f32_16x16x32_bf16 a[144:147], a[64:67], a[40:43], a[144:147]
    ds_read_b128 a[0:3], v8 offset:34816
    v_mfma_f32_16x16x32_bf16 a[152:155], a[64:67], a[44:47], a[152:155]
    v_mfma_f32_16x16x32_bf16 a[160:163], a[64:67], a[48:51], a[160:163]
    buffer_load_dwordx4 v1, s[28:31], s69 offen offset:1024 sc1 lds
    v_mfma_f32_16x16x32_bf16 a[168:171], a[64:67], a[52:55], a[168:171]
    v_mfma_f32_16x16x32_bf16 a[176:179], a[64:67], a[56:59], a[176:179]
    ds_read_b128 a[4:7], v8 offset:36864
    v_mfma_f32_16x16x32_bf16 a[184:187], a[64:67], a[60:63], a[184:187]
    v_mfma_f32_16x16x32_bf16 v[120:123], a[64:67], a[116:119], v[120:123]
    ds_read_b64_tr_b16 a[64:65], v13 offset:0
    v_mfma_f32_16x16x32_bf16 a[132:135], a[68:71], a[32:35], a[132:135]
    ds_read_b64_tr_b16 a[66:67], v13 offset:256
    v_mfma_f32_16x16x32_bf16 a[140:143], a[68:71], a[36:39], a[140:143]
    ds_read_b128 a[8:11], v8 offset:38912
    v_mfma_f32_16x16x32_bf16 a[148:151], a[68:71], a[40:43], a[148:151]
    buffer_load_dwordx4 v1, s[28:31], s70 offen offset:2048 sc1 lds
    v_mfma_f32_16x16x32_bf16 a[156:159], a[68:71], a[44:47], a[156:159]
    buffer_load_dwordx4 v1, s[28:31], s71 offen offset:3072 sc1 lds
    v_mfma_f32_16x16x32_bf16 a[164:167], a[68:71], a[48:51], a[164:167]
    v_mfma_f32_16x16x32_bf16 a[172:175], a[68:71], a[52:55], a[172:175]
    ds_read_b128 a[12:15], v8 offset:40960
    v_mfma_f32_16x16x32_bf16 a[180:183], a[68:71], a[56:59], a[180:183]
    s_add_u32 m0, s78, 4096
    v_mfma_f32_16x16x32_bf16 a[188:191], a[68:71], a[60:63], a[188:191]
    buffer_load_dwordx4 v1, s[28:31], s72 offen offset:0 sc1 lds
    v_mfma_f32_16x16x32_bf16 v[124:127], a[68:71], a[116:119], v[124:127]
    ds_read_b64_tr_b16 a[68:69], v15 offset:0
    v_mfma_f32_16x16x32_bf16 v[52:55], a[32:35], a[72:75], v[52:55]
    ds_read_b64_tr_b16 a[70:71], v15 offset:256
    v_mfma_f32_16x16x32_bf16 v[56:59], a[36:39], a[72:75], v[56:59]
    v_mfma_f32_16x16x32_bf16 v[60:63], a[40:43], a[72:75], v[60:63]
    ds_read_b128 a[16:19], v8 offset:43008
    v_mfma_f32_16x16x32_bf16 v[64:67], a[44:47], a[72:75], v[64:67]
    buffer_load_dwordx4 v1, s[28:31], s73 offen offset:1024 sc1 lds
    v_mfma_f32_16x16x32_bf16 v[68:71], a[48:51], a[72:75], v[68:71]
    ds_read_b128 a[20:23], v8 offset:45056
    v_mfma_f32_16x16x32_bf16 v[72:75], a[52:55], a[72:75], v[72:75]
    v_mfma_f32_16x16x32_bf16 v[76:79], a[56:59], a[72:75], v[76:79]
    buffer_load_dwordx4 v1, s[28:31], s74 offen offset:2048 sc1 lds
    v_mfma_f32_16x16x32_bf16 v[80:83], a[60:63], a[72:75], v[80:83]
    v_mfma_f32_16x16x32_bf16 v[48:51], a[116:119], a[72:75], v[48:51]
    ds_read_b64_tr_b16 a[72:73], v13 offset:1024
    v_mfma_f32_16x16x32_bf16 v[88:91], a[32:35], a[76:79], v[88:91]
    ds_read_b64_tr_b16 a[74:75], v13 offset:1280
    v_mfma_f32_16x16x32_bf16 v[92:95], a[36:39], a[76:79], v[92:95]
    ds_read_b128 a[24:27], v8 offset:47104
    v_mfma_f32_16x16x32_bf16 v[96:99], a[40:43], a[76:79], v[96:99]
    buffer_load_dwordx4 v1, s[28:31], s75 offen offset:3072 sc1 lds
    v_add_u32 v1, 128, v1
    v_mfma_f32_16x16x32_bf16 v[100:103], a[44:47], a[76:79], v[100:103]
    ds_read_b128 a[28:31], v8 offset:49152
    v_mfma_f32_16x16x32_bf16 v[104:107], a[48:51], a[76:79], v[104:107]
    s_add_u32 m0, s78, 8192
    v_mfma_f32_16x16x32_bf16 v[108:111], a[52:55], a[76:79], v[108:111]
    buffer_load_dwordx4 v2, s[28:31], s68 offen offset:0 sc1 lds
    v_mfma_f32_16x16x32_bf16 v[112:115], a[56:59], a[76:79], v[112:115]
    v_mfma_f32_16x16x32_bf16 v[116:119], a[60:63], a[76:79], v[116:119]
    ds_read_b128 a[112:115], v10 offset:34816
    v_mfma_f32_16x16x32_bf16 v[84:87], a[116:119], a[76:79], v[84:87]
    ds_read_b64_tr_b16 a[76:77], v15 offset:1024
    v_mfma_f32_16x16x32_bf16 a[192:195], a[80:83], a[32:35], a[192:195]
    ds_read_b64_tr_b16 a[78:79], v15 offset:1280
    v_mfma_f32_16x16x32_bf16 a[200:203], a[80:83], a[36:39], a[200:203]
    buffer_load_dwordx4 v2, s[28:31], s69 offen offset:1024 sc1 lds
    v_mfma_f32_16x16x32_bf16 a[208:211], a[80:83], a[40:43], a[208:211]
    ds_read_b64_tr_b16 a[96:97], v13 offset:4096
    v_mfma_f32_16x16x32_bf16 a[216:219], a[80:83], a[44:47], a[216:219]
    buffer_load_dwordx4 v2, s[28:31], s70 offen offset:2048 sc1 lds
    v_mfma_f32_16x16x32_bf16 a[224:227], a[80:83], a[48:51], a[224:227]
    v_mfma_f32_16x16x32_bf16 a[232:235], a[80:83], a[52:55], a[232:235]
    v_mfma_f32_16x16x32_bf16 a[240:243], a[80:83], a[56:59], a[240:243]
    ds_read_b64_tr_b16 a[98:99], v13 offset:4352
    v_mfma_f32_16x16x32_bf16 a[248:251], a[80:83], a[60:63], a[248:251]
    ds_read_b64_tr_b16 a[80:81], v13 offset:2048
    v_mfma_f32_16x16x32_bf16 a[196:199], a[84:87], a[32:35], a[196:199]
    ds_read_b64_tr_b16 a[82:83], v13 offset:2304
    v_mfma_f32_16x16x32_bf16 a[204:207], a[84:87], a[36:39], a[204:207]
    buffer_load_dwordx4 v2, s[28:31], s71 offen offset:3072 sc1 lds
    v_mfma_f32_16x16x32_bf16 a[212:215], a[84:87], a[40:43], a[212:215]
    ds_read_b64_tr_b16 a[100:101], v15 offset:4096
    s_add_u32 m0, s78, 12288
    v_mfma_f32_16x16x32_bf16 a[220:223], a[84:87], a[44:47], a[220:223]
    buffer_load_dwordx4 v2, s[28:31], s72 offen offset:0 sc1 lds
    v_mfma_f32_16x16x32_bf16 a[228:231], a[84:87], a[48:51], a[228:231]
    v_mfma_f32_16x16x32_bf16 a[236:239], a[84:87], a[52:55], a[236:239]
    v_mfma_f32_16x16x32_bf16 a[244:247], a[84:87], a[56:59], a[244:247]
    ds_read_b64_tr_b16 a[102:103], v15 offset:4352
    v_mfma_f32_16x16x32_bf16 a[252:255], a[84:87], a[60:63], a[252:255]
    ds_read_b64_tr_b16 a[84:85], v15 offset:2048
    v_mfma_f32_16x16x32_bf16 v[128:131], a[88:91], a[32:35], v[128:131]
    ds_read_b64_tr_b16 a[86:87], v15 offset:2304
    v_mfma_f32_16x16x32_bf16 v[144:147], a[88:91], a[36:39], v[144:147]
    buffer_load_dwordx4 v2, s[28:31], s73 offen offset:1024 sc1 lds
    v_mfma_f32_16x16x32_bf16 v[160:163], a[88:91], a[40:43], v[160:163]
    v_mfma_f32_16x16x32_bf16 v[176:179], a[88:91], a[44:47], v[176:179]
    buffer_load_dwordx4 v2, s[28:31], s74 offen offset:2048 sc1 lds
    v_mfma_f32_16x16x32_bf16 v[192:195], a[88:91], a[48:51], v[192:195]
    v_mfma_f32_16x16x32_bf16 v[208:211], a[88:91], a[52:55], v[208:211]
    v_mfma_f32_16x16x32_bf16 v[224:227], a[88:91], a[56:59], v[224:227]
    v_mfma_f32_16x16x32_bf16 v[240:243], a[88:91], a[60:63], v[240:243]
    ds_read_b64_tr_b16 a[88:89], v13 offset:3072
    v_mfma_f32_16x16x32_bf16 v[132:135], a[92:95], a[32:35], v[132:135]
    ds_read_b64_tr_b16 a[90:91], v13 offset:3328
    v_mfma_f32_16x16x32_bf16 v[148:151], a[92:95], a[36:39], v[148:151]
    buffer_load_dwordx4 v2, s[28:31], s75 offen offset:3072 sc1 lds
    v_add_u32 v2, 128, v2
    v_mfma_f32_16x16x32_bf16 v[164:167], a[92:95], a[40:43], v[164:167]
    v_mfma_f32_16x16x32_bf16 v[180:183], a[92:95], a[44:47], v[180:183]
    v_mfma_f32_16x16x32_bf16 v[196:199], a[92:95], a[48:51], v[196:199]
    v_mfma_f32_16x16x32_bf16 v[212:215], a[92:95], a[52:55], v[212:215]
    v_mfma_f32_16x16x32_bf16 v[228:231], a[92:95], a[56:59], v[228:231]
    v_mfma_f32_16x16x32_bf16 v[244:247], a[92:95], a[60:63], v[244:247]
    ds_read_b64_tr_b16 a[92:93], v15 offset:3072
    v_mfma_f32_16x16x32_bf16 v[136:139], a[104:107], a[32:35], v[136:139]
    ds_read_b64_tr_b16 a[94:95], v15 offset:3328
    v_mfma_f32_16x16x32_bf16 v[152:155], a[104:107], a[36:39], v[152:155]
    v_mfma_f32_16x16x32_bf16 v[168:171], a[104:107], a[40:43], v[168:171]
    v_mfma_f32_16x16x32_bf16 v[184:187], a[104:107], a[44:47], v[184:187]
    v_mfma_f32_16x16x32_bf16 v[200:203], a[104:107], a[48:51], v[200:203]
    v_mfma_f32_16x16x32_bf16 v[216:219], a[104:107], a[52:55], v[216:219]
    v_mfma_f32_16x16x32_bf16 v[232:235], a[104:107], a[56:59], v[232:235]
    v_mfma_f32_16x16x32_bf16 v[248:251], a[104:107], a[60:63], v[248:251]
    v_mfma_f32_16x16x32_bf16 v[140:143], a[108:111], a[32:35], v[140:143]
    v_mfma_f32_16x16x32_bf16 v[156:159], a[108:111], a[36:39], v[156:159]
    v_mfma_f32_16x16x32_bf16 v[172:175], a[108:111], a[40:43], v[172:175]
    v_mfma_f32_16x16x32_bf16 v[188:191], a[108:111], a[44:47], v[188:191]
    v_mfma_f32_16x16x32_bf16 v[204:207], a[108:111], a[48:51], v[204:207]
    v_mfma_f32_16x16x32_bf16 v[220:223], a[108:111], a[52:55], v[220:223]
    v_mfma_f32_16x16x32_bf16 v[236:239], a[108:111], a[56:59], v[236:239]
    v_mfma_f32_16x16x32_bf16 v[252:255], a[108:111], a[60:63], v[252:255]
    s_waitcnt lgkmcnt(0)
    s_barrier
    v_mfma_f32_16x16x32_bf16 a[128:131], a[64:67], a[0:3], a[128:131]
    buffer_load_dword v7, v6, s[44:47], s4 offen
    v_add_u32_e64 v6, s79, v6
    v_mfma_f32_16x16x32_bf16 a[136:139], a[64:67], a[4:7], a[136:139]
    v_mfma_f32_16x16x32_bf16 a[144:147], a[64:67], a[8:11], a[144:147]
    ds_read_b128 a[32:35], v9 offset:34816
    v_mfma_f32_16x16x32_bf16 a[152:155], a[64:67], a[12:15], a[152:155]
    v_mfma_f32_16x16x32_bf16 a[160:163], a[64:67], a[16:19], a[160:163]
    v_mfma_f32_16x16x32_bf16 a[168:171], a[64:67], a[20:23], a[168:171]
    v_mfma_f32_16x16x32_bf16 a[176:179], a[64:67], a[24:27], a[176:179]
    ds_read_b128 a[36:39], v9 offset:36864
    v_mfma_f32_16x16x32_bf16 a[184:187], a[64:67], a[28:31], a[184:187]
    v_mfma_f32_16x16x32_bf16 v[120:123], a[64:67], a[112:115], v[120:123]
    ds_read_b64_tr_b16 a[64:65], v13 offset:20480
    v_mfma_f32_16x16x32_bf16 a[132:135], a[68:71], a[0:3], a[132:135]
    ds_read_b64_tr_b16 a[66:67], v13 offset:20736
    v_mfma_f32_16x16x32_bf16 a[140:143], a[68:71], a[4:7], a[140:143]
    ds_read_b128 a[40:43], v9 offset:38912
    v_mfma_f32_16x16x32_bf16 a[148:151], a[68:71], a[8:11], a[148:151]
    v_mfma_f32_16x16x32_bf16 a[156:159], a[68:71], a[12:15], a[156:159]
    v_mfma_f32_16x16x32_bf16 a[164:167], a[68:71], a[16:19], a[164:167]
    v_mfma_f32_16x16x32_bf16 a[172:175], a[68:71], a[20:23], a[172:175]
    ds_read_b128 a[44:47], v9 offset:40960
    v_mfma_f32_16x16x32_bf16 a[180:183], a[68:71], a[24:27], a[180:183]
    v_mfma_f32_16x16x32_bf16 a[188:191], a[68:71], a[28:31], a[188:191]
    v_mfma_f32_16x16x32_bf16 v[124:127], a[68:71], a[112:115], v[124:127]
    ds_read_b64_tr_b16 a[68:69], v15 offset:20480
    v_mfma_f32_16x16x32_bf16 v[52:55], a[0:3], a[72:75], v[52:55]
    ds_read_b64_tr_b16 a[70:71], v15 offset:20736
    v_mfma_f32_16x16x32_bf16 v[56:59], a[4:7], a[72:75], v[56:59]
    v_mfma_f32_16x16x32_bf16 v[60:63], a[8:11], a[72:75], v[60:63]
    ds_read_b128 a[48:51], v9 offset:43008
    v_mfma_f32_16x16x32_bf16 v[64:67], a[12:15], a[72:75], v[64:67]
    v_mfma_f32_16x16x32_bf16 v[68:71], a[16:19], a[72:75], v[68:71]
    ds_read_b128 a[52:55], v9 offset:45056
    v_mfma_f32_16x16x32_bf16 v[72:75], a[20:23], a[72:75], v[72:75]
    v_mfma_f32_16x16x32_bf16 v[76:79], a[24:27], a[72:75], v[76:79]
    v_mfma_f32_16x16x32_bf16 v[80:83], a[28:31], a[72:75], v[80:83]
    v_mfma_f32_16x16x32_bf16 v[48:51], a[112:115], a[72:75], v[48:51]
    ds_read_b64_tr_b16 a[72:73], v13 offset:21504
    v_mfma_f32_16x16x32_bf16 v[88:91], a[0:3], a[76:79], v[88:91]
    ds_read_b64_tr_b16 a[74:75], v13 offset:21760
    v_mfma_f32_16x16x32_bf16 v[92:95], a[4:7], a[76:79], v[92:95]
    ds_read_b128 a[56:59], v9 offset:47104
    v_mfma_f32_16x16x32_bf16 v[96:99], a[8:11], a[76:79], v[96:99]
    v_mfma_f32_16x16x32_bf16 v[100:103], a[12:15], a[76:79], v[100:103]
    ds_read_b128 a[60:63], v9 offset:49152
    v_mfma_f32_16x16x32_bf16 v[104:107], a[16:19], a[76:79], v[104:107]
    v_mfma_f32_16x16x32_bf16 v[108:111], a[20:23], a[76:79], v[108:111]
    v_mfma_f32_16x16x32_bf16 v[112:115], a[24:27], a[76:79], v[112:115]
    v_mfma_f32_16x16x32_bf16 v[116:119], a[28:31], a[76:79], v[116:119]
    ds_read_b128 a[116:119], v11 offset:34816
    v_mfma_f32_16x16x32_bf16 v[84:87], a[112:115], a[76:79], v[84:87]
    ds_read_b64_tr_b16 a[76:77], v15 offset:21504
    v_mfma_f32_16x16x32_bf16 a[192:195], a[80:83], a[0:3], a[192:195]
    ds_read_b64_tr_b16 a[78:79], v15 offset:21760
    v_mfma_f32_16x16x32_bf16 a[200:203], a[80:83], a[4:7], a[200:203]
    v_mfma_f32_16x16x32_bf16 a[208:211], a[80:83], a[8:11], a[208:211]
    ds_read_b64_tr_b16 a[104:105], v13 offset:24576
    v_mfma_f32_16x16x32_bf16 a[216:219], a[80:83], a[12:15], a[216:219]
    v_mfma_f32_16x16x32_bf16 a[224:227], a[80:83], a[16:19], a[224:227]
    v_mfma_f32_16x16x32_bf16 a[232:235], a[80:83], a[20:23], a[232:235]
    v_mfma_f32_16x16x32_bf16 a[240:243], a[80:83], a[24:27], a[240:243]
    ds_read_b64_tr_b16 a[106:107], v13 offset:24832
    v_mfma_f32_16x16x32_bf16 a[248:251], a[80:83], a[28:31], a[248:251]
    ds_read_b64_tr_b16 a[80:81], v13 offset:22528
    v_mfma_f32_16x16x32_bf16 a[196:199], a[84:87], a[0:3], a[196:199]
    ds_read_b64_tr_b16 a[82:83], v13 offset:22784
    v_mfma_f32_16x16x32_bf16 a[204:207], a[84:87], a[4:7], a[204:207]
    v_mfma_f32_16x16x32_bf16 a[212:215], a[84:87], a[8:11], a[212:215]
    ds_read_b64_tr_b16 a[108:109], v15 offset:24576
    v_mfma_f32_16x16x32_bf16 a[220:223], a[84:87], a[12:15], a[220:223]
    v_mfma_f32_16x16x32_bf16 a[228:231], a[84:87], a[16:19], a[228:231]
    v_mfma_f32_16x16x32_bf16 a[236:239], a[84:87], a[20:23], a[236:239]
    v_mfma_f32_16x16x32_bf16 a[244:247], a[84:87], a[24:27], a[244:247]
    ds_read_b64_tr_b16 a[110:111], v15 offset:24832
    v_mfma_f32_16x16x32_bf16 a[252:255], a[84:87], a[28:31], a[252:255]
    ds_read_b64_tr_b16 a[84:85], v15 offset:22528
    v_mfma_f32_16x16x32_bf16 v[128:131], a[88:91], a[0:3], v[128:131]
    ds_read_b64_tr_b16 a[86:87], v15 offset:22784
    v_mfma_f32_16x16x32_bf16 v[144:147], a[88:91], a[4:7], v[144:147]
    v_mfma_f32_16x16x32_bf16 v[160:163], a[88:91], a[8:11], v[160:163]
    v_mfma_f32_16x16x32_bf16 v[176:179], a[88:91], a[12:15], v[176:179]
    v_mfma_f32_16x16x32_bf16 v[192:195], a[88:91], a[16:19], v[192:195]
    v_mfma_f32_16x16x32_bf16 v[208:211], a[88:91], a[20:23], v[208:211]
    v_mfma_f32_16x16x32_bf16 v[224:227], a[88:91], a[24:27], v[224:227]
    v_mfma_f32_16x16x32_bf16 v[240:243], a[88:91], a[28:31], v[240:243]
    ds_read_b64_tr_b16 a[88:89], v13 offset:23552
    v_mfma_f32_16x16x32_bf16 v[132:135], a[92:95], a[0:3], v[132:135]
    ds_read_b64_tr_b16 a[90:91], v13 offset:23808
    v_mfma_f32_16x16x32_bf16 v[148:151], a[92:95], a[4:7], v[148:151]
    v_mfma_f32_16x16x32_bf16 v[164:167], a[92:95], a[8:11], v[164:167]
    v_mfma_f32_16x16x32_bf16 v[180:183], a[92:95], a[12:15], v[180:183]
    v_mfma_f32_16x16x32_bf16 v[196:199], a[92:95], a[16:19], v[196:199]
    v_mfma_f32_16x16x32_bf16 v[212:215], a[92:95], a[20:23], v[212:215]
    v_mfma_f32_16x16x32_bf16 v[228:231], a[92:95], a[24:27], v[228:231]
    v_mfma_f32_16x16x32_bf16 v[244:247], a[92:95], a[28:31], v[244:247]
    ds_read_b64_tr_b16 a[92:93], v15 offset:23552
    v_mfma_f32_16x16x32_bf16 v[136:139], a[96:99], a[0:3], v[136:139]
    ds_read_b64_tr_b16 a[94:95], v15 offset:23808
    v_mfma_f32_16x16x32_bf16 v[152:155], a[96:99], a[4:7], v[152:155]
    v_mfma_f32_16x16x32_bf16 v[168:171], a[96:99], a[8:11], v[168:171]
    v_mfma_f32_16x16x32_bf16 v[184:187], a[96:99], a[12:15], v[184:187]
    v_mfma_f32_16x16x32_bf16 v[200:203], a[96:99], a[16:19], v[200:203]
    v_mfma_f32_16x16x32_bf16 v[216:219], a[96:99], a[20:23], v[216:219]
    v_mfma_f32_16x16x32_bf16 v[232:235], a[96:99], a[24:27], v[232:235]
    v_mfma_f32_16x16x32_bf16 v[248:251], a[96:99], a[28:31], v[248:251]
    v_mfma_f32_16x16x32_bf16 v[140:143], a[100:103], a[0:3], v[140:143]
    v_mfma_f32_16x16x32_bf16 v[156:159], a[100:103], a[4:7], v[156:159]
    v_mfma_f32_16x16x32_bf16 v[172:175], a[100:103], a[8:11], v[172:175]
    v_mfma_f32_16x16x32_bf16 v[188:191], a[100:103], a[12:15], v[188:191]
    v_mfma_f32_16x16x32_bf16 v[204:207], a[100:103], a[16:19], v[204:207]
    v_mfma_f32_16x16x32_bf16 v[220:223], a[100:103], a[20:23], v[220:223]
    v_mfma_f32_16x16x32_bf16 v[236:239], a[100:103], a[24:27], v[236:239]
    v_mfma_f32_16x16x32_bf16 v[252:255], a[100:103], a[28:31], v[252:255]
    s_waitcnt vmcnt(1) lgkmcnt(0)
    s_barrier
    v_mfma_f32_16x16x32_bf16 a[128:131], a[64:67], a[32:35], a[128:131]
    s_add_u32 m0, s78, 34816
    v_mfma_f32_16x16x32_bf16 a[136:139], a[64:67], a[36:39], a[136:139]
    buffer_load_dwordx4 v1, s[28:31], s68 offen offset:0 sc1 lds
    v_mfma_f32_16x16x32_bf16 a[144:147], a[64:67], a[40:43], a[144:147]
    ds_read_b128 a[0:3], v8 offset:0
    v_mfma_f32_16x16x32_bf16 a[152:155], a[64:67], a[44:47], a[152:155]
    v_mfma_f32_16x16x32_bf16 a[160:163], a[64:67], a[48:51], a[160:163]
    buffer_load_dwordx4 v1, s[28:31], s69 offen offset:1024 sc1 lds
    v_mfma_f32_16x16x32_bf16 a[168:171], a[64:67], a[52:55], a[168:171]
    v_mfma_f32_16x16x32_bf16 a[176:179], a[64:67], a[56:59], a[176:179]
    ds_read_b128 a[4:7], v8 offset:2048
    v_mfma_f32_16x16x32_bf16 a[184:187], a[64:67], a[60:63], a[184:187]
    v_mfma_f32_16x16x32_bf16 v[120:123], a[64:67], a[116:119], v[120:123]
    ds_read_b64_tr_b16 a[64:65], v12 offset:0
    v_mfma_f32_16x16x32_bf16 a[132:135], a[68:71], a[32:35], a[132:135]
    ds_read_b64_tr_b16 a[66:67], v12 offset:256
    v_mfma_f32_16x16x32_bf16 a[140:143], a[68:71], a[36:39], a[140:143]
    ds_read_b128 a[8:11], v8 offset:4096
    v_mfma_f32_16x16x32_bf16 a[148:151], a[68:71], a[40:43], a[148:151]
    buffer_load_dwordx4 v1, s[28:31], s70 offen offset:2048 sc1 lds
    v_mfma_f32_16x16x32_bf16 a[156:159], a[68:71], a[44:47], a[156:159]
    buffer_load_dwordx4 v1, s[28:31], s71 offen offset:3072 sc1 lds
    v_mfma_f32_16x16x32_bf16 a[164:167], a[68:71], a[48:51], a[164:167]
    v_mfma_f32_16x16x32_bf16 a[172:175], a[68:71], a[52:55], a[172:175]
    ds_read_b128 a[12:15], v8 offset:6144
    v_mfma_f32_16x16x32_bf16 a[180:183], a[68:71], a[56:59], a[180:183]
    s_add_u32 m0, s78, 38912
    v_mfma_f32_16x16x32_bf16 a[188:191], a[68:71], a[60:63], a[188:191]
    buffer_load_dwordx4 v1, s[28:31], s72 offen offset:0 sc1 lds
    v_mfma_f32_16x16x32_bf16 v[124:127], a[68:71], a[116:119], v[124:127]
    ds_read_b64_tr_b16 a[68:69], v14 offset:0
    v_mfma_f32_16x16x32_bf16 v[52:55], a[32:35], a[72:75], v[52:55]
    ds_read_b64_tr_b16 a[70:71], v14 offset:256
    v_mfma_f32_16x16x32_bf16 v[56:59], a[36:39], a[72:75], v[56:59]
    v_mfma_f32_16x16x32_bf16 v[60:63], a[40:43], a[72:75], v[60:63]
    ds_read_b128 a[16:19], v8 offset:8192
    v_mfma_f32_16x16x32_bf16 v[64:67], a[44:47], a[72:75], v[64:67]
    buffer_load_dwordx4 v1, s[28:31], s73 offen offset:1024 sc1 lds
    v_mfma_f32_16x16x32_bf16 v[68:71], a[48:51], a[72:75], v[68:71]
    ds_read_b128 a[20:23], v8 offset:10240
    v_mfma_f32_16x16x32_bf16 v[72:75], a[52:55], a[72:75], v[72:75]
    v_mfma_f32_16x16x32_bf16 v[76:79], a[56:59], a[72:75], v[76:79]
    buffer_load_dwordx4 v1, s[28:31], s74 offen offset:2048 sc1 lds
    v_mfma_f32_16x16x32_bf16 v[80:83], a[60:63], a[72:75], v[80:83]
    v_mfma_f32_16x16x32_bf16 v[48:51], a[116:119], a[72:75], v[48:51]
    ds_read_b64_tr_b16 a[72:73], v12 offset:1024
    v_mfma_f32_16x16x32_bf16 v[88:91], a[32:35], a[76:79], v[88:91]
    ds_read_b64_tr_b16 a[74:75], v12 offset:1280
    v_mfma_f32_16x16x32_bf16 v[92:95], a[36:39], a[76:79], v[92:95]
    ds_read_b128 a[24:27], v8 offset:12288
    v_mfma_f32_16x16x32_bf16 v[96:99], a[40:43], a[76:79], v[96:99]
    buffer_load_dwordx4 v1, s[28:31], s75 offen offset:3072 sc1 lds
    v_add_u32 v1, 128, v1
    v_mfma_f32_16x16x32_bf16 v[100:103], a[44:47], a[76:79], v[100:103]
    ds_read_b128 a[28:31], v8 offset:14336
    v_mfma_f32_16x16x32_bf16 v[104:107], a[48:51], a[76:79], v[104:107]
    s_add_u32 m0, s78, 43008
    v_mfma_f32_16x16x32_bf16 v[108:111], a[52:55], a[76:79], v[108:111]
    buffer_load_dwordx4 v2, s[28:31], s68 offen offset:0 sc1 lds
    v_mfma_f32_16x16x32_bf16 v[112:115], a[56:59], a[76:79], v[112:115]
    v_mfma_f32_16x16x32_bf16 v[116:119], a[60:63], a[76:79], v[116:119]
    ds_read_b128 a[112:115], v10 offset:0
    v_mfma_f32_16x16x32_bf16 v[84:87], a[116:119], a[76:79], v[84:87]
    ds_read_b64_tr_b16 a[76:77], v14 offset:1024
    v_mfma_f32_16x16x32_bf16 a[192:195], a[80:83], a[32:35], a[192:195]
    ds_read_b64_tr_b16 a[78:79], v14 offset:1280
    v_mfma_f32_16x16x32_bf16 a[200:203], a[80:83], a[36:39], a[200:203]
    buffer_load_dwordx4 v2, s[28:31], s69 offen offset:1024 sc1 lds
    v_mfma_f32_16x16x32_bf16 a[208:211], a[80:83], a[40:43], a[208:211]
    ds_read_b64_tr_b16 a[96:97], v12 offset:4096
    v_mfma_f32_16x16x32_bf16 a[216:219], a[80:83], a[44:47], a[216:219]
    buffer_load_dwordx4 v2, s[28:31], s70 offen offset:2048 sc1 lds
    v_mfma_f32_16x16x32_bf16 a[224:227], a[80:83], a[48:51], a[224:227]
    v_mfma_f32_16x16x32_bf16 a[232:235], a[80:83], a[52:55], a[232:235]
    v_mfma_f32_16x16x32_bf16 a[240:243], a[80:83], a[56:59], a[240:243]
    ds_read_b64_tr_b16 a[98:99], v12 offset:4352
    v_mfma_f32_16x16x32_bf16 a[248:251], a[80:83], a[60:63], a[248:251]
    ds_read_b64_tr_b16 a[80:81], v12 offset:2048
    v_mfma_f32_16x16x32_bf16 a[196:199], a[84:87], a[32:35], a[196:199]
    ds_read_b64_tr_b16 a[82:83], v12 offset:2304
    v_mfma_f32_16x16x32_bf16 a[204:207], a[84:87], a[36:39], a[204:207]
    buffer_load_dwordx4 v2, s[28:31], s71 offen offset:3072 sc1 lds
    v_mfma_f32_16x16x32_bf16 a[212:215], a[84:87], a[40:43], a[212:215]
    ds_read_b64_tr_b16 a[100:101], v14 offset:4096
    s_add_u32 m0, s78, 47104
    v_mfma_f32_16x16x32_bf16 a[220:223], a[84:87], a[44:47], a[220:223]
    buffer_load_dwordx4 v2, s[28:31], s72 offen offset:0 sc1 lds
    v_mfma_f32_16x16x32_bf16 a[228:231], a[84:87], a[48:51], a[228:231]
    v_mfma_f32_16x16x32_bf16 a[236:239], a[84:87], a[52:55], a[236:239]
    v_mfma_f32_16x16x32_bf16 a[244:247], a[84:87], a[56:59], a[244:247]
    ds_read_b64_tr_b16 a[102:103], v14 offset:4352
    v_mfma_f32_16x16x32_bf16 a[252:255], a[84:87], a[60:63], a[252:255]
    ds_read_b64_tr_b16 a[84:85], v14 offset:2048
    v_mfma_f32_16x16x32_bf16 v[128:131], a[88:91], a[32:35], v[128:131]
    ds_read_b64_tr_b16 a[86:87], v14 offset:2304
    v_mfma_f32_16x16x32_bf16 v[144:147], a[88:91], a[36:39], v[144:147]
    buffer_load_dwordx4 v2, s[28:31], s73 offen offset:1024 sc1 lds
    v_mfma_f32_16x16x32_bf16 v[160:163], a[88:91], a[40:43], v[160:163]
    v_mfma_f32_16x16x32_bf16 v[176:179], a[88:91], a[44:47], v[176:179]
    buffer_load_dwordx4 v2, s[28:31], s74 offen offset:2048 sc1 lds
    v_mfma_f32_16x16x32_bf16 v[192:195], a[88:91], a[48:51], v[192:195]
    v_mfma_f32_16x16x32_bf16 v[208:211], a[88:91], a[52:55], v[208:211]
    v_mfma_f32_16x16x32_bf16 v[224:227], a[88:91], a[56:59], v[224:227]
    v_mfma_f32_16x16x32_bf16 v[240:243], a[88:91], a[60:63], v[240:243]
    ds_read_b64_tr_b16 a[88:89], v12 offset:3072
    v_mfma_f32_16x16x32_bf16 v[132:135], a[92:95], a[32:35], v[132:135]
    ds_read_b64_tr_b16 a[90:91], v12 offset:3328
    v_mfma_f32_16x16x32_bf16 v[148:151], a[92:95], a[36:39], v[148:151]
    buffer_load_dwordx4 v2, s[28:31], s75 offen offset:3072 sc1 lds
    v_add_u32 v2, 128, v2
    v_mfma_f32_16x16x32_bf16 v[164:167], a[92:95], a[40:43], v[164:167]
    v_mfma_f32_16x16x32_bf16 v[180:183], a[92:95], a[44:47], v[180:183]
    v_mfma_f32_16x16x32_bf16 v[196:199], a[92:95], a[48:51], v[196:199]
    v_mfma_f32_16x16x32_bf16 v[212:215], a[92:95], a[52:55], v[212:215]
    v_mfma_f32_16x16x32_bf16 v[228:231], a[92:95], a[56:59], v[228:231]
    v_mfma_f32_16x16x32_bf16 v[244:247], a[92:95], a[60:63], v[244:247]
    ds_read_b64_tr_b16 a[92:93], v14 offset:3072
    v_mfma_f32_16x16x32_bf16 v[136:139], a[104:107], a[32:35], v[136:139]
    ds_read_b64_tr_b16 a[94:95], v14 offset:3328
    v_mfma_f32_16x16x32_bf16 v[152:155], a[104:107], a[36:39], v[152:155]
    v_mfma_f32_16x16x32_bf16 v[168:171], a[104:107], a[40:43], v[168:171]
    v_mfma_f32_16x16x32_bf16 v[184:187], a[104:107], a[44:47], v[184:187]
    v_mfma_f32_16x16x32_bf16 v[200:203], a[104:107], a[48:51], v[200:203]
    v_mfma_f32_16x16x32_bf16 v[216:219], a[104:107], a[52:55], v[216:219]
    v_mfma_f32_16x16x32_bf16 v[232:235], a[104:107], a[56:59], v[232:235]
    v_mfma_f32_16x16x32_bf16 v[248:251], a[104:107], a[60:63], v[248:251]
    v_mfma_f32_16x16x32_bf16 v[140:143], a[108:111], a[32:35], v[140:143]
    v_mfma_f32_16x16x32_bf16 v[156:159], a[108:111], a[36:39], v[156:159]
    v_mfma_f32_16x16x32_bf16 v[172:175], a[108:111], a[40:43], v[172:175]
    v_mfma_f32_16x16x32_bf16 v[188:191], a[108:111], a[44:47], v[188:191]
    v_mfma_f32_16x16x32_bf16 v[204:207], a[108:111], a[48:51], v[204:207]
    v_mfma_f32_16x16x32_bf16 v[220:223], a[108:111], a[52:55], v[220:223]
    v_mfma_f32_16x16x32_bf16 v[236:239], a[108:111], a[56:59], v[236:239]
    v_mfma_f32_16x16x32_bf16 v[252:255], a[108:111], a[60:63], v[252:255]
    s_sub_u32 s67, s67, 1
    s_cmp_lg_u32 s67, 0
    s_cbranch_scc1 L_loop0
L_tail0:
    s_waitcnt lgkmcnt(0)
    s_barrier
    v_mfma_f32_16x16x32_bf16 a[128:131], a[64:67], a[0:3], a[128:131]
    s_getpc_b64 s[86:87]
L_pc0:
    s_sub_u32 s86, s86, L_pc0-L_tail0
    s_subb_u32 s87, s87, 0
    s_lshr_b32 s82, s2, 3
    s_lshl_b32 s82, s82, 2
    s_add_u32 s82, s82, s60
    s_lshl_b32 s82, s82, 10
    v_add_u32 v34, s82, v16
    v_min_u32 v34, L_code_end-L_tail0-4, v34
    global_load_dword v7, v34, s[86:87]
    v_mfma_f32_16x16x32_bf16 a[136:139], a[64:67], a[4:7], a[136:139]
    v_mfma_f32_16x16x32_bf16 a[144:147], a[64:67], a[8:11], a[144:147]
    ds_read_b128 a[32:35], v9 offset:0
    s_and_b32 s82, s2, 7
    s_lshl_b32 s82, s82, 5
    s_lshr_b32 s83, s2, 3
    s_add_u32 s82, s82, s83
    s_mul_i32 s82, s82, 28672
    s_mul_i32 s83, s60, 28
    s_add_u32 s83, s83, 112
    v_min_u32 v34, 27, v0
    v_add_u32 v34, s83, v34
    v_min_u32 v34, 223, v34
    v_lshlrev_b32 v34, 7, v34
    v_add_u32 v34, s82, v34
    global_load_dword v7, v34, s[20:21]
    v_mfma_f32_16x16x32_bf16 a[152:155], a[64:67], a[12:15], a[152:155]
    v_mfma_f32_16x16x32_bf16 a[160:163], a[64:67], a[16:19], a[160:163]
    v_mfma_f32_16x16x32_bf16 a[168:171], a[64:67], a[20:23], a[168:171]
    v_mfma_f32_16x16x32_bf16 a[176:179], a[64:67], a[24:27], a[176:179]
    ds_read_b128 a[36:39], v9 offset:2048
    v_mfma_f32_16x16x32_bf16 a[184:187], a[64:67], a[28:31], a[184:187]
    v_mfma_f32_16x16x32_bf16 v[120:123], a[64:67], a[112:115], v[120:123]
    ds_read_b64_tr_b16 a[64:65], v12 offset:20480
    v_mfma_f32_16x16x32_bf16 a[132:135], a[68:71], a[0:3], a[132:135]
    ds_read_b64_tr_b16 a[66:67], v12 offset:20736
    v_mfma_f32_16x16x32_bf16 a[140:143], a[68:71], a[4:7], a[140:143]
    ds_read_b128 a[40:43], v9 offset:4096
    v_mfma_f32_16x16x32_bf16 a[148:151], a[68:71], a[8:11], a[148:151]
    v_mfma_f32_16x16x32_bf16 a[156:159], a[68:71], a[12:15], a[156:159]
    v_mfma_f32_16x16x32_bf16 a[164:167], a[68:71], a[16:19], a[164:167]
    v_mfma_f32_16x16x32_bf16 a[172:175], a[68:71], a[20:23], a[172:175]
    ds_read_b128 a[44:47], v9 offset:6144
    v_mfma_f32_16x16x32_bf16 a[180:183], a[68:71], a[24:27], a[180:183]
    v_mfma_f32_16x16x32_bf16 a[188:191], a[68:71], a[28:31], a[188:191]
    v_mfma_f32_16x16x32_bf16 v[124:127], a[68:71], a[112:115], v[124:127]
    ds_read_b64_tr_b16 a[68:69], v14 offset:20480
    v_mfma_f32_16x16x32_bf16 v[52:55], a[0:3], a[72:75], v[52:55]
    ds_read_b64_tr_b16 a[70:71], v14 offset:20736
    v_mfma_f32_16x16x32_bf16 v[56:59], a[4:7], a[72:75], v[56:59]
    v_mfma_f32_16x16x32_bf16 v[60:63], a[8:11], a[72:75], v[60:63]
    ds_read_b128 a[48:51], v9 offset:8192
    v_mfma_f32_16x16x32_bf16 v[64:67], a[12:15], a[72:75], v[64:67]
    v_mfma_f32_16x16x32_bf16 v[68:71], a[16:19], a[72:75], v[68:71]
    ds_read_b128 a[52:55], v9 offset:10240
    v_mfma_f32_16x16x32_bf16 v[72:75], a[20:23], a[72:75], v[72:75]
    v_mfma_f32_16x16x32_bf16 v[76:79], a[24:27], a[72:75], v[76:79]
    v_mfma_f32_16x16x32_bf16 v[80:83], a[28:31], a[72:75], v[80:83]
    v_mfma_f32_16x16x32_bf16 v[48:51], a[112:115], a[72:75], v[48:51]
    ds_read_b64_tr_b16 a[72:73], v12 offset:21504
    v_mfma_f32_16x16x32_bf16 v[88:91], a[0:3], a[76:79], v[88:91]
    ds_read_b64_tr_b16 a[74:75], v12 offset:21760
    v_mfma_f32_16x16x32_bf16 v[92:95], a[4:7], a[76:79], v[92:95]
    ds_read_b128 a[56:59], v9 offset:12288
    v_mfma_f32_16x16x32_bf16 v[96:99], a[8:11], a[76:79], v[96:99]
    v_mfma_f32_16x16x32_bf16 v[100:103], a[12:15], a[76:79], v[100:103]
    ds_read_b128 a[60:63], v9 offset:14336
    v_mfma_f32_16x16x32_bf16 v[104:107], a[16:19], a[76:79], v[104:107]
    v_mfma_f32_16x16x32_bf16 v[108:111], a[20:23], a[76:79], v[108:111]
    v_mfma_f32_16x16x32_bf16 v[112:115], a[24:27], a[76:79], v[112:115]
    v_mfma_f32_16x16x32_bf16 v[116:119], a[28:31], a[76:79], v[116:119]
    ds_read_b128 a[116:119], v11 offset:0
    v_mfma_f32_16x16x32_bf16 v[84:87], a[112:115], a[76:79], v[84:87]
    ds_read_b64_tr_b16 a[76:77], v14 offset:21504
    v_mfma_f32_16x16x32_bf16 a[192:195], a[80:83], a[0:3], a[192:195]
    ds_read_b64_tr_b16 a[78:79], v14 offset:21760
    v_mfma_f32_16x16x32_bf16 a[200:203], a[80:83], a[4:7], a[200:203]
    v_mfma_f32_16x16x32_bf16 a[208:211], a[80:83], a[8:11], a[208:211]
    ds_read_b64_tr_b16 a[104:105], v12 offset:24576
    v_mfma_f32_16x16x32_bf16 a[216:219], a[80:83], a[12:15], a[216:219]
    v_mfma_f32_16x16x32_bf16 a[224:227], a[80:83], a[16:19], a[224:227]
    v_mfma_f32_16x16x32_bf16 a[232:235], a[80:83], a[20:23], a[232:235]
    v_mfma_f32_16x16x32_bf16 a[240:243], a[80:83], a[24:27], a[240:243]
    ds_read_b64_tr_b16 a[106:107], v12 offset:24832
    v_mfma_f32_16x16x32_bf16 a[248:251], a[80:83], a[28:31], a[248:251]
    ds_read_b64_tr_b16 a[80:81], v12 offset:22528
    v_mfma_f32_16x16x32_bf16 a[196:199], a[84:87], a[0:3], a[196:199]
    ds_read_b64_tr_b16 a[82:83], v12 offset:22784
    v_mfma_f32_16x16x32_bf16 a[204:207], a[84:87], a[4:7], a[204:207]
    v_mfma_f32_16x16x32_bf16 a[212:215], a[84:87], a[8:11], a[212:215]
    ds_read_b64_tr_b16 a[108:109], v14 offset:24576
    v_mfma_f32_16x16x32_bf16 a[220:223], a[84:87], a[12:15], a[220:223]
    v_mfma_f32_16x16x32_bf16 a[228:231], a[84:87], a[16:19], a[228:231]
    v_mfma_f32_16x16x32_bf16 a[236:239], a[84:87], a[20:23], a[236:239]
    v_mfma_f32_16x16x32_bf16 a[244:247], a[84:87], a[24:27], a[244:247]
    ds_read_b64_tr_b16 a[110:111], v14 offset:24832
    v_mfma_f32_16x16x32_bf16 a[252:255], a[84:87], a[28:31], a[252:255]
    ds_read_b64_tr_b16 a[84:85], v14 offset:22528
    v_mfma_f32_16x16x32_bf16 v[128:131], a[88:91], a[0:3], v[128:131]
    ds_read_b64_tr_b16 a[86:87], v14 offset:22784
    v_mfma_f32_16x16x32_bf16 v[144:147], a[88:91], a[4:7], v[144:147]
    v_mfma_f32_16x16x32_bf16 v[160:163], a[88:91], a[8:11], v[160:163]
    v_mfma_f32_16x16x32_bf16 v[176:179], a[88:91], a[12:15], v[176:179]
    v_mfma_f32_16x16x32_bf16 v[192:195], a[88:91], a[16:19], v[192:195]
    v_mfma_f32_16x16x32_bf16 v[208:211], a[88:91], a[20:23], v[208:211]
    v_mfma_f32_16x16x32_bf16 v[224:227], a[88:91], a[24:27], v[224:227]
    v_mfma_f32_16x16x32_bf16 v[240:243], a[88:91], a[28:31], v[240:243]
    ds_read_b64_tr_b16 a[88:89], v12 offset:23552
    v_mfma_f32_16x16x32_bf16 v[132:135], a[92:95], a[0:3], v[132:135]
    ds_read_b64_tr_b16 a[90:91], v12 offset:23808
    v_mfma_f32_16x16x32_bf16 v[148:151], a[92:95], a[4:7], v[148:151]
    v_mfma_f32_16x16x32_bf16 v[164:167], a[92:95], a[8:11], v[164:167]
    v_mfma_f32_16x16x32_bf16 v[180:183], a[92:95], a[12:15], v[180:183]
    v_mfma_f32_16x16x32_bf16 v[196:199], a[92:95], a[16:19], v[196:199]
    v_mfma_f32_16x16x32_bf16 v[212:215], a[92:95], a[20:23], v[212:215]
    v_mfma_f32_16x16x32_bf16 v[228:231], a[92:95], a[24:27], v[228:231]
    v_mfma_f32_16x16x32_bf16 v[244:247], a[92:95], a[28:31], v[244:247]
    ds_read_b64_tr_b16 a[92:93], v14 offset:23552
    v_mfma_f32_16x16x32_bf16 v[136:139], a[96:99], a[0:3], v[136:139]
    ds_read_b64_tr_b16 a[94:95], v14 offset:23808
    v_mfma_f32_16x16x32_bf16 v[152:155], a[96:99], a[4:7], v[152:155]
    v_mfma_f32_16x16x32_bf16 v[168:171], a[96:99], a[8:11], v[168:171]
    v_mfma_f32_16x16x32_bf16 v[184:187], a[96:99], a[12:15], v[184:187]
    v_mfma_f32_16x16x32_bf16 v[200:203], a[96:99], a[16:19], v[200:203]
    v_mfma_f32_16x16x32_bf16 v[216:219], a[96:99], a[20:23], v[216:219]
    v_mfma_f32_16x16x32_bf16 v[232:235], a[96:99], a[24:27], v[232:235]
    v_mfma_f32_16x16x32_bf16 v[248:251], a[96:99], a[28:31], v[248:251]
    v_mfma_f32_16x16x32_bf16 v[140:143], a[100:103], a[0:3], v[140:143]
    v_mfma_f32_16x16x32_bf16 v[156:159], a[100:103], a[4:7], v[156:159]
    v_mfma_f32_16x16x32_bf16 v[172:175], a[100:103], a[8:11], v[172:175]
    v_mfma_f32_16x16x32_bf16 v[188:191], a[100:103], a[12:15], v[188:191]
    v_mfma_f32_16x16x32_bf16 v[204:207], a[100:103], a[16:19], v[204:207]
    v_mfma_f32_16x16x32_bf16 v[220:223], a[100:103], a[20:23], v[220:223]
    v_mfma_f32_16x16x32_bf16 v[236:239], a[100:103], a[24:27], v[236:239]
    v_mfma_f32_16x16x32_bf16 v[252:255], a[100:103], a[28:31], v[252:255]
    s_waitcnt vmcnt(2) lgkmcnt(0)
    s_barrier
    v_mfma_f32_16x16x32_bf16 a[128:131], a[64:67], a[32:35], a[128:131]
    v_mfma_f32_16x16x32_bf16 a[136:139], a[64:67], a[36:39], a[136:139]
    v_mfma_f32_16x16x32_bf16 a[144:147], a[64:67], a[40:43], a[144:147]
    ds_read_b128 a[0:3], v8 offset:34816
    v_mfma_f32_16x16x32_bf16 a[152:155], a[64:67], a[44:47], a[152:155]
    v_mfma_f32_16x16x32_bf16 a[160:163], a[64:67], a[48:51], a[160:163]
    s_mul_i32 s82, s65, 1835008
    s_lshl_b32 s83, s66, 8
    v_mfma_f32_16x16x32_bf16 a[168:171], a[64:67], a[52:55], a[168:171]
    s_add_u32 s82, s82, s83
    s_add_u32 s48, s20, s82
    v_mfma_f32_16x16x32_bf16 a[176:179], a[64:67], a[56:59], a[176:179]
    ds_read_b128 a[4:7], v8 offset:36864
    s_addc_u32 s49, s21, 0
    s_and_b32 s49, s49, 0xffff
    v_mfma_f32_16x16x32_bf16 a[184:187], a[64:67], a[60:63], a[184:187]
    s_sub_u32 s50, 7340032, s82
    s_mov_b32 s51, 0x20000
    v_mfma_f32_16x16x32_bf16 v[120:123], a[64:67], a[116:119], v[120:123]
    ds_read_b64_tr_b16 a[64:65], v13 offset:0
    s_add_u32 s52, s12, s83
    s_addc_u32 s53, s13, 0
    v_mfma_f32_16x16x32_bf16 a[132:135], a[68:71], a[32:35], a[132:135]
    ds_read_b64_tr_b16 a[66:67], v13 offset:256
    s_and_b32 s53, s53, 0xffff
    s_sub_u32 s54, 2097152, s83
    v_mfma_f32_16x16x32_bf16 a[140:143], a[68:71], a[36:39], a[140:143]
    ds_read_b128 a[8:11], v8 offset:38912
    s_mov_b32 s55, 0x20000
    s_lshl_b32 s3, s60, 11
    v_mfma_f32_16x16x32_bf16 a[148:151], a[68:71], a[40:43], a[148:151]
    v_lshrrev_b32 v34, 4, v0
    v_and_b32 v35, 15, v0
    v_mfma_f32_16x16x32_bf16 a[156:159], a[68:71], a[44:47], a[156:159]
    v_lshlrev_b32 v36, 1, v34
    v_add_u32 v36, 0, v36
    v_mfma_f32_16x16x32_bf16 a[164:167], a[68:71], a[48:51], a[164:167]
    v_xor_b32 v36, v36, v35
    v_lshlrev_b32 v36, 4, v36
    v_mfma_f32_16x16x32_bf16 a[172:175], a[68:71], a[52:55], a[172:175]
    ds_read_b128 a[12:15], v8 offset:40960
    v_lshl_add_u32 v36, v34, 11, v36
    s_lshl_b32 s82, s60, 14
    v_mfma_f32_16x16x32_bf16 a[180:183], a[68:71], a[56:59], a[180:183]
    s_add_u32 s82, s82, 0
    v_add_u32 v17, s82, v36
    v_mfma_f32_16x16x32_bf16 a[188:191], a[68:71], a[60:63], a[188:191]
    s_lshl_b32 s82, s62, 1
    s_add_u32 s82, s82, 0
    v_mfma_f32_16x16x32_bf16 v[124:127], a[68:71], a[116:119], v[124:127]
    ds_read_b64_tr_b16 a[68:69], v15 offset:0
    s_lshl_b32 s82, s82, 3
    s_lshl_b32 s83, s61, 2
    v_mfma_f32_16x16x32_bf16 v[52:55], a[32:35], a[72:75], v[52:55]
    ds_read_b64_tr_b16 a[70:71], v15 offset:256
    s_add_u32 s82, s82, s83
    s_mul_i32 s83, s62, 96
    v_mfma_f32_16x16x32_bf16 v[56:59], a[36:39], a[72:75], v[56:59]
    s_add_u32 s82, s82, s83
    s_lshl_b32 s82, s82, 11
    v_mfma_f32_16x16x32_bf16 v[60:63], a[40:43], a[72:75], v[60:63]
    ds_read_b128 a[16:19], v8 offset:43008
    s_sub_u32 s82, s82, 0
    v_add_u32 v19, s82, v36
    v_mfma_f32_16x16x32_bf16 v[64:67], a[44:47], a[72:75], v[64:67]
    v_lshlrev_b32 v36, 1, v34
    v_add_u32 v36, 8, v36
    v_mfma_f32_16x16x32_bf16 v[68:71], a[48:51], a[72:75], v[68:71]
    ds_read_b128 a[20:23], v8 offset:45056
    v_xor_b32 v36, v36, v35
    v_lshlrev_b32 v36, 4, v36
    v_mfma_f32_16x16x32_bf16 v[72:75], a[52:55], a[72:75], v[72:75]
    v_lshl_add_u32 v36, v34, 11, v36
    s_lshl_b32 s82, s60, 14
    v_mfma_f32_16x16x32_bf16 v[76:79], a[56:59], a[72:75], v[76:79]
    s_add_u32 s82, s82, 7168
    v_add_u32 v18, s82, v36
    v_mfma_f32_16x16x32_bf16 v[80:83], a[60:63], a[72:75], v[80:83]
    s_lshl_b32 s82, s62, 1
    s_add_u32 s82, s82, 1
    v_mfma_f32_16x16x32_bf16 v[48:51], a[116:119], a[72:75], v[48:51]
    ds_read_b64_tr_b16 a[72:73], v13 offset:1024
    s_lshl_b32 s82, s82, 3
    s_lshl_b32 s83, s61, 2
    v_mfma_f32_16x16x32_bf16 v[88:91], a[32:35], a[76:79], v[88:91]
    ds_read_b64_tr_b16 a[74:75], v13 offset:1280
    s_add_u32 s82, s82, s83
    s_mul_i32 s83, s62, 96
    v_mfma_f32_16x16x32_bf16 v[92:95], a[36:39], a[76:79], v[92:95]
    ds_read_b128 a[24:27], v8 offset:47104
    s_add_u32 s82, s82, s83
    s_lshl_b32 s82, s82, 11
    v_mfma_f32_16x16x32_bf16 v[96:99], a[40:43], a[76:79], v[96:99]
    s_sub_u32 s82, s82, 1024
    v_add_u32 v20, s82, v36
    v_mfma_f32_16x16x32_bf16 v[100:103], a[44:47], a[76:79], v[100:103]
    ds_read_b128 a[28:31], v8 offset:49152
    s_xor_b32 s82, s65, 0
    s_lshl_b32 s82, s82, 10
    v_mfma_f32_16x16x32_bf16 v[104:107], a[48:51], a[76:79], v[104:107]
    v_add_u32 v21, s82, v16
    s_xor_b32 s82, s65, 1
    v_mfma_f32_16x16x32_bf16 v[108:111], a[52:55], a[76:79], v[108:111]
    s_lshl_b32 s82, s82, 10
    v_add_u32 v22, s82, v16
    v_mfma_f32_16x16x32_bf16 v[112:115], a[56:59], a[76:79], v[112:115]
    s_xor_b32 s82, s65, 2
    s_lshl_b32 s82, s82, 10
    v_mfma_f32_16x16x32_bf16 v[116:119], a[60:63], a[76:79], v[116:119]
    ds_read_b128 a[112:115], v10 offset:34816
    v_add_u32 v23, s82, v16
    s_xor_b32 s82, s65, 3
    v_mfma_f32_16x16x32_bf16 v[84:87], a[116:119], a[76:79], v[84:87]
    ds_read_b64_tr_b16 a[76:77], v15 offset:1024
    s_lshl_b32 s82, s82, 10
    v_add_u32 v24, s82, v16
    v_mfma_f32_16x16x32_bf16 a[192:195], a[80:83], a[32:35], a[192:195]
    ds_read_b64_tr_b16 a[78:79], v15 offset:1280
    s_mov_b32 s94, 0xbdd2d3e8
    s_mov_b32 s95, 0xbdd2d3e8
    v_mfma_f32_16x16x32_bf16 a[200:203], a[80:83], a[36:39], a[200:203]
    v_mov_b32 v26, 0xc0135761
    v_mov_b32 v27, 0xc0135761
    v_mfma_f32_16x16x32_bf16 a[208:211], a[80:83], a[40:43], a[208:211]
    ds_read_b64_tr_b16 a[96:97], v13 offset:4096
    v_mov_b32 v25, 1
    s_lshl_b32 s82, s60, 12
    v_mfma_f32_16x16x32_bf16 a[216:219], a[80:83], a[44:47], a[216:219]
    s_add_u32 s68, s88, s82
    s_lshl_b32 s82, s61, 13
    v_mfma_f32_16x16x32_bf16 a[224:227], a[80:83], a[48:51], a[224:227]
    s_add_u32 s88, s88, s82
    s_lshr_b32 s82, s66, 1
    v_mfma_f32_16x16x32_bf16 a[232:235], a[80:83], a[52:55], a[232:235]
    s_add_u32 s82, s82, 24
    s_lshl_b32 s82, s82, 14
    v_mfma_f32_16x16x32_bf16 a[240:243], a[80:83], a[56:59], a[240:243]
    ds_read_b64_tr_b16 a[98:99], v13 offset:4352
    s_add_u32 s90, s88, s82
    s_lshl_b32 s82, s66, 14
    v_mfma_f32_16x16x32_bf16 a[248:251], a[80:83], a[60:63], a[248:251]
    ds_read_b64_tr_b16 a[80:81], v13 offset:2048
    v_mfma_f32_16x16x32_bf16 a[196:199], a[84:87], a[32:35], a[196:199]
    ds_read_b64_tr_b16 a[82:83], v13 offset:2304
    v_mfma_f32_16x16x32_bf16 a[204:207], a[84:87], a[36:39], a[204:207]
    v_mfma_f32_16x16x32_bf16 a[212:215], a[84:87], a[40:43], a[212:215]
    ds_read_b64_tr_b16 a[100:101], v15 offset:4096
    v_mfma_f32_16x16x32_bf16 a[220:223], a[84:87], a[44:47], a[220:223]
    v_mfma_f32_16x16x32_bf16 a[228:231], a[84:87], a[48:51], a[228:231]
    v_mfma_f32_16x16x32_bf16 a[236:239], a[84:87], a[52:55], a[236:239]
    v_mfma_f32_16x16x32_bf16 a[244:247], a[84:87], a[56:59], a[244:247]
    ds_read_b64_tr_b16 a[102:103], v15 offset:4352
    v_mfma_f32_16x16x32_bf16 a[252:255], a[84:87], a[60:63], a[252:255]
    ds_read_b64_tr_b16 a[84:85], v15 offset:2048
    v_mfma_f32_16x16x32_bf16 v[128:131], a[88:91], a[32:35], v[128:131]
    ds_read_b64_tr_b16 a[86:87], v15 offset:2304
    v_mfma_f32_16x16x32_bf16 v[144:147], a[88:91], a[36:39], v[144:147]
    v_mfma_f32_16x16x32_bf16 v[160:163], a[88:91], a[40:43], v[160:163]
    v_mfma_f32_16x16x32_bf16 v[176:179], a[88:91], a[44:47], v[176:179]
    v_mfma_f32_16x16x32_bf16 v[192:195], a[88:91], a[48:51], v[192:195]
    v_mfma_f32_16x16x32_bf16 v[208:211], a[88:91], a[52:55], v[208:211]
    v_mfma_f32_16x16x32_bf16 v[224:227], a[88:91], a[56:59], v[224:227]
    v_mfma_f32_16x16x32_bf16 v[240:243], a[88:91], a[60:63], v[240:243]
    ds_read_b64_tr_b16 a[88:89], v13 offset:3072
    v_mfma_f32_16x16x32_bf16 v[132:135], a[92:95], a[32:35], v[132:135]
    ds_read_b64_tr_b16 a[90:91], v13 offset:3328
    v_mfma_f32_16x16x32_bf16 v[148:151], a[92:95], a[36:39], v[148:151]
    v_mfma_f32_16x16x32_bf16 v[164:167], a[92:95], a[40:43], v[164:167]
    v_mfma_f32_16x16x32_bf16 v[180:183], a[92:95], a[44:47], v[180:183]
    v_mfma_f32_16x16x32_bf16 v[196:199], a[92:95], a[48:51], v[196:199]
    v_mfma_f32_16x16x32_bf16 v[212:215], a[92:95], a[52:55], v[212:215]
    v_mfma_f32_16x16x32_bf16 v[228:231], a[92:95], a[56:59], v[228:231]
    v_mfma_f32_16x16x32_bf16 v[244:247], a[92:95], a[60:63], v[244:247]
    ds_read_b64_tr_b16 a[92:93], v15 offset:3072
    v_mfma_f32_16x16x32_bf16 v[136:139], a[104:107], a[32:35], v[136:139]
    ds_read_b64_tr_b16 a[94:95], v15 offset:3328
    v_mfma_f32_16x16x32_bf16 v[152:155], a[104:107], a[36:39], v[152:155]
    v_mfma_f32_16x16x32_bf16 v[168:171], a[104:107], a[40:43], v[168:171]
    v_mfma_f32_16x16x32_bf16 v[184:187], a[104:107], a[44:47], v[184:187]
    v_mfma_f32_16x16x32_bf16 v[200:203], a[104:107], a[48:51], v[200:203]
    v_mfma_f32_16x16x32_bf16 v[216:219], a[104:107], a[52:55], v[216:219]
    v_mfma_f32_16x16x32_bf16 v[232:235], a[104:107], a[56:59], v[232:235]
    v_mfma_f32_16x16x32_bf16 v[248:251], a[104:107], a[60:63], v[248:251]
    v_mfma_f32_16x16x32_bf16 v[140:143], a[108:111], a[32:35], v[140:143]
    v_mfma_f32_16x16x32_bf16 v[156:159], a[108:111], a[36:39], v[156:159]
    v_mfma_f32_16x16x32_bf16 v[172:175], a[108:111], a[40:43], v[172:175]
    v_mfma_f32_16x16x32_bf16 v[188:191], a[108:111], a[44:47], v[188:191]
    v_mfma_f32_16x16x32_bf16 v[204:207], a[108:111], a[48:51], v[204:207]
    v_mfma_f32_16x16x32_bf16 v[220:223], a[108:111], a[52:55], v[220:223]
    v_mfma_f32_16x16x32_bf16 v[236:239], a[108:111], a[56:59], v[236:239]
    v_mfma_f32_16x16x32_bf16 v[252:255], a[108:111], a[60:63], v[252:255]
    s_waitcnt lgkmcnt(0)
    s_barrier
    v_mfma_f32_16x16x32_bf16 a[128:131], a[64:67], a[0:3], a[128:131]
    v_mfma_f32_16x16x32_bf16 a[136:139], a[64:67], a[4:7], a[136:139]
    v_mfma_f32_16x16x32_bf16 a[144:147], a[64:67], a[8:11], a[144:147]
    ds_read_b128 a[32:35], v9 offset:34816
    v_mfma_f32_16x16x32_bf16 a[152:155], a[64:67], a[12:15], a[152:155]
    v_mfma_f32_16x16x32_bf16 a[160:163], a[64:67], a[16:19], a[160:163]
    s_add_u32 s88, s88, s82
    s_add_u32 s89, s88, 262144
    v_mfma_f32_16x16x32_bf16 a[168:171], a[64:67], a[20:23], a[168:171]
    s_mov_b32 s76, s93
    s_lshl_b32 s82, s63, 4
    v_mfma_f32_16x16x32_bf16 a[176:179], a[64:67], a[24:27], a[176:179]
    ds_read_b128 a[36:39], v9 offset:36864
    s_lshl_b32 s83, s60, 2
    s_add_u32 s83, s83, s82
    v_mfma_f32_16x16x32_bf16 a[184:187], a[64:67], a[28:31], a[184:187]
    s_add_u32 s83, s83, s65
    s_lshl_b32 s83, s83, 15
    v_mfma_f32_16x16x32_bf16 v[120:123], a[64:67], a[112:115], v[120:123]
    ds_read_b64_tr_b16 a[64:65], v13 offset:20480
    s_add_u32 s69, s83, 4194304
    s_lshl_b32 s84, s63, 3
    v_mfma_f32_16x16x32_bf16 a[132:135], a[68:71], a[0:3], a[132:135]
    ds_read_b64_tr_b16 a[66:67], v13 offset:20736
    s_add_u32 s84, s84, s66
    s_lshl_b32 s85, s84, 2
    v_mfma_f32_16x16x32_bf16 a[140:143], a[68:71], a[4:7], a[140:143]
    ds_read_b128 a[40:43], v9 offset:38912
    s_add_u32 s85, s85, s60
    s_lshl_b32 s85, s85, 8
    v_mfma_f32_16x16x32_bf16 a[148:151], a[68:71], a[8:11], a[148:151]
    s_add_u32 s77, s85, 39862272
    s_lshl_b32 s84, s84, 18
    v_mfma_f32_16x16x32_bf16 a[156:159], a[68:71], a[12:15], a[156:159]
    s_lshl_b32 s85, s60, 12
    s_add_u32 s84, s84, s85
    v_mfma_f32_16x16x32_bf16 a[164:167], a[68:71], a[16:19], a[164:167]
    s_add_u32 s84, s84, 23068672
    s_xor_b32 s85, s65, 1
    v_mfma_f32_16x16x32_bf16 a[172:175], a[68:71], a[20:23], a[172:175]
    ds_read_b128 a[44:47], v9 offset:40960
    s_lshl_b32 s85, s85, 16
    s_add_u32 s70, s84, s85
    v_mfma_f32_16x16x32_bf16 a[180:183], a[68:71], a[24:27], a[180:183]
    s_add_u32 s70, s70, 16384
    s_lshl_b32 s85, s65, 16
    v_mfma_f32_16x16x32_bf16 a[188:191], a[68:71], a[28:31], a[188:191]
    s_add_u32 s73, s84, s85
    s_add_u32 s73, s73, 16384
    v_mfma_f32_16x16x32_bf16 v[124:127], a[68:71], a[112:115], v[124:127]
    ds_read_b64_tr_b16 a[68:69], v15 offset:20480
    s_xor_b32 s85, s65, 2
    s_lshl_b32 s85, s85, 16
    v_mfma_f32_16x16x32_bf16 v[52:55], a[0:3], a[72:75], v[52:55]
    ds_read_b64_tr_b16 a[70:71], v15 offset:20736
    s_add_u32 s71, s84, s85
    s_add_u32 s71, s71, 32768
    v_mfma_f32_16x16x32_bf16 v[56:59], a[4:7], a[72:75], v[56:59]
    s_lshl_b32 s85, s65, 16
    s_add_u32 s74, s84, s85
    v_mfma_f32_16x16x32_bf16 v[60:63], a[8:11], a[72:75], v[60:63]
    ds_read_b128 a[48:51], v9 offset:43008
    s_add_u32 s74, s74, 32768
    s_xor_b32 s85, s65, 3
    v_mfma_f32_16x16x32_bf16 v[64:67], a[12:15], a[72:75], v[64:67]
    s_lshl_b32 s85, s85, 16
    s_add_u32 s72, s84, s85
    v_mfma_f32_16x16x32_bf16 v[68:71], a[16:19], a[72:75], v[68:71]
    ds_read_b128 a[52:55], v9 offset:45056
    s_add_u32 s72, s72, 49152
    s_lshl_b32 s85, s65, 16
    v_mfma_f32_16x16x32_bf16 v[72:75], a[20:23], a[72:75], v[72:75]
    s_add_u32 s75, s84, s85
    s_add_u32 s75, s75, 49152
    v_mfma_f32_16x16x32_bf16 v[76:79], a[24:27], a[72:75], v[76:79]
    s_lshl_b32 s83, s61, 3
    s_add_u32 s82, s82, s83
    v_mfma_f32_16x16x32_bf16 v[80:83], a[28:31], a[72:75], v[80:83]
    s_lshl_b32 s82, s82, 5
    s_add_u32 s82, s82, s64
    v_mfma_f32_16x16x32_bf16 v[48:51], a[112:115], a[72:75], v[48:51]
    ds_read_b64_tr_b16 a[72:73], v13 offset:21504
    s_lshl_b32 s82, s82, 10
    s_add_u32 s91, s82, 4194304
    v_mfma_f32_16x16x32_bf16 v[88:91], a[0:3], a[76:79], v[88:91]
    ds_read_b64_tr_b16 a[74:75], v13 offset:21760
    v_mov_b32 v42, 1
    v_and_b32 v37, 1, v35
    v_mfma_f32_16x16x32_bf16 v[92:95], a[4:7], a[76:79], v[92:95]
    ds_read_b128 a[56:59], v9 offset:47104
    v_lshl_add_u32 v36, v34, 2, v37
    v_cmp_le_u32 s[4:5], v36, v35
    v_mfma_f32_16x16x32_bf16 v[96:99], a[8:11], a[76:79], v[96:99]
    v_add_u32 v36, 2, v36
    v_cmp_le_u32 s[6:7], v36, v35
    v_mfma_f32_16x16x32_bf16 v[100:103], a[12:15], a[76:79], v[100:103]
    ds_read_b128 a[60:63], v9 offset:49152
    v_mul_u32_u24 v36, 0x0202, v37
    v_lshlrev_b32 v36, 16, v36
    v_mfma_f32_16x16x32_bf16 v[104:107], a[16:19], a[76:79], v[104:107]
    v_add_u32 v36, 0x01000c0c, v36
    v_add_u32 v38, 0x04040000, v36
    v_mfma_f32_16x16x32_bf16 v[108:111], a[20:23], a[76:79], v[108:111]
    v_cndmask_b32 v28, v36, v38, s[4:5]
    v_cndmask_b32 v29, v36, v38, s[6:7]
    v_mfma_f32_16x16x32_bf16 v[112:115], a[24:27], a[76:79], v[112:115]
    v_cmp_eq_u32 vcc, 1, v37
    v_mov_b32 v36, 0x0c0c0100
    v_mfma_f32_16x16x32_bf16 v[116:119], a[28:31], a[76:79], v[116:119]
    ds_read_b128 a[116:119], v11 offset:34816
    v_mov_b32 v38, 0x01000c0c
    v_cndmask_b32 v36, v36, v38, vcc
    v_mfma_f32_16x16x32_bf16 v[84:87], a[112:115], a[76:79], v[84:87]
    ds_read_b64_tr_b16 a[76:77], v15 offset:21504
    v_mov_b32 v38, 0x0c0c0302
    v_mov_b32 v39, 0x03020c0c
    v_mfma_f32_16x16x32_bf16 a[192:195], a[80:83], a[0:3], a[192:195]
    ds_read_b64_tr_b16 a[78:79], v15 offset:21760
    v_cndmask_b32 v38, v38, v39, vcc
    v_mov_b32 v39, 0x0c0c0c0c
    v_mfma_f32_16x16x32_bf16 a[200:203], a[80:83], a[4:7], a[200:203]
    v_cndmask_b32 v30, v36, v39, s[4:5]
    v_cndmask_b32 v31, v38, v39, s[6:7]
    v_mfma_f32_16x16x32_bf16 a[208:211], a[80:83], a[8:11], a[208:211]
    ds_read_b64_tr_b16 a[104:105], v13 offset:24576
    v_cndmask_b32 v32, v39, v36, s[4:5]
    v_cndmask_b32 v33, v39, v38, s[6:7]
    v_mfma_f32_16x16x32_bf16 a[216:219], a[80:83], a[12:15], a[216:219]
    s_or_b32 s82, s63, s61
    s_cmp_eq_u32 s82, 0
    v_mfma_f32_16x16x32_bf16 a[224:227], a[80:83], a[16:19], a[224:227]
    s_cselect_b64 s[4:5], s[4:5], -1
    s_cselect_b64 s[6:7], s[6:7], -1
    v_mfma_f32_16x16x32_bf16 a[232:235], a[80:83], a[20:23], a[232:235]
    s_mov_b32 s14, 0x3e3504f3
    s_mov_b32 s15, 0x3e3504f3
    v_mfma_f32_16x16x32_bf16 a[240:243], a[80:83], a[24:27], a[240:243]
    ds_read_b64_tr_b16 a[106:107], v13 offset:24832
    s_mov_b32 s98, 0x3fb8aa3b
    s_mov_b32 s99, 0x3fb8aa3b
    v_mfma_f32_16x16x32_bf16 a[248:251], a[80:83], a[28:31], a[248:251]
    ds_read_b64_tr_b16 a[80:81], v13 offset:22528
    v_mfma_f32_16x16x32_bf16 a[196:199], a[84:87], a[0:3], a[196:199]
    ds_read_b64_tr_b16 a[82:83], v13 offset:22784
    v_mfma_f32_16x16x32_bf16 a[204:207], a[84:87], a[4:7], a[204:207]
    v_mfma_f32_16x16x32_bf16 a[212:215], a[84:87], a[8:11], a[212:215]
    ds_read_b64_tr_b16 a[108:109], v15 offset:24576
    v_mfma_f32_16x16x32_bf16 a[220:223], a[84:87], a[12:15], a[220:223]
    v_mfma_f32_16x16x32_bf16 a[228:231], a[84:87], a[16:19], a[228:231]
    v_mfma_f32_16x16x32_bf16 a[236:239], a[84:87], a[20:23], a[236:239]
    v_mfma_f32_16x16x32_bf16 a[244:247], a[84:87], a[24:27], a[244:247]
    ds_read_b64_tr_b16 a[110:111], v15 offset:24832
    v_mfma_f32_16x16x32_bf16 a[252:255], a[84:87], a[28:31], a[252:255]
    ds_read_b64_tr_b16 a[84:85], v15 offset:22528
    v_mfma_f32_16x16x32_bf16 v[128:131], a[88:91], a[0:3], v[128:131]
    ds_read_b64_tr_b16 a[86:87], v15 offset:22784
    v_mfma_f32_16x16x32_bf16 v[144:147], a[88:91], a[4:7], v[144:147]
    v_mfma_f32_16x16x32_bf16 v[160:163], a[88:91], a[8:11], v[160:163]
    v_mfma_f32_16x16x32_bf16 v[176:179], a[88:91], a[12:15], v[176:179]
    v_mfma_f32_16x16x32_bf16 v[192:195], a[88:91], a[16:19], v[192:195]
    v_mfma_f32_16x16x32_bf16 v[208:211], a[88:91], a[20:23], v[208:211]
    v_mfma_f32_16x16x32_bf16 v[224:227], a[88:91], a[24:27], v[224:227]
    v_mfma_f32_16x16x32_bf16 v[240:243], a[88:91], a[28:31], v[240:243]
    ds_read_b64_tr_b16 a[88:89], v13 offset:23552
    v_mfma_f32_16x16x32_bf16 v[132:135], a[92:95], a[0:3], v[132:135]
    ds_read_b64_tr_b16 a[90:91], v13 offset:23808
    v_mfma_f32_16x16x32_bf16 v[148:151], a[92:95], a[4:7], v[148:151]
    v_mfma_f32_16x16x32_bf16 v[164:167], a[92:95], a[8:11], v[164:167]
    v_mfma_f32_16x16x32_bf16 v[180:183], a[92:95], a[12:15], v[180:183]
    v_mfma_f32_16x16x32_bf16 v[196:199], a[92:95], a[16:19], v[196:199]
    s_branch L_over1
L_stub1:
    s_branch L_stub2
L_over1:
    v_mfma_f32_16x16x32_bf16 v[212:215], a[92:95], a[20:23], v[212:215]
    v_mfma_f32_16x16x32_bf16 v[228:231], a[92:95], a[24:27], v[228:231]
    v_mfma_f32_16x16x32_bf16 v[244:247], a[92:95], a[28:31], v[244:247]
    ds_read_b64_tr_b16 a[92:93], v15 offset:23552
    v_mfma_f32_16x16x32_bf16 v[136:139], a[96:99], a[0:3], v[136:139]
    ds_read_b64_tr_b16 a[94:95], v15 offset:23808
    v_mfma_f32_16x16x32_bf16 v[152:155], a[96:99], a[4:7], v[152:155]
    v_mfma_f32_16x16x32_bf16 v[168:171], a[96:99], a[8:11], v[168:171]
    v_mfma_f32_16x16x32_bf16 v[184:187], a[96:99], a[12:15], v[184:187]
    v_mfma_f32_16x16x32_bf16 v[200:203], a[96:99], a[16:19], v[200:203]
    v_mfma_f32_16x16x32_bf16 v[216:219], a[96:99], a[20:23], v[216:219]
    v_mfma_f32_16x16x32_bf16 v[232:235], a[96:99], a[24:27], v[232:235]
    v_mfma_f32_16x16x32_bf16 v[248:251], a[96:99], a[28:31], v[248:251]
    v_mfma_f32_16x16x32_bf16 v[140:143], a[100:103], a[0:3], v[140:143]
    v_mfma_f32_16x16x32_bf16 v[156:159], a[100:103], a[4:7], v[156:159]
    v_mfma_f32_16x16x32_bf16 v[172:175], a[100:103], a[8:11], v[172:175]
    v_mfma_f32_16x16x32_bf16 v[188:191], a[100:103], a[12:15], v[188:191]
    v_mfma_f32_16x16x32_bf16 v[204:207], a[100:103], a[16:19], v[204:207]
    v_mfma_f32_16x16x32_bf16 v[220:223], a[100:103], a[20:23], v[220:223]
    v_mfma_f32_16x16x32_bf16 v[236:239], a[100:103], a[24:27], v[236:239]
    v_mfma_f32_16x16x32_bf16 v[252:255], a[100:103], a[28:31], v[252:255]
    s_waitcnt lgkmcnt(0)
    s_barrier
    v_mfma_f32_16x16x32_bf16 a[128:131], a[64:67], a[32:35], a[128:131]
    v_mfma_f32_16x16x32_bf16 a[136:139], a[64:67], a[36:39], a[136:139]
    v_mfma_f32_16x16x32_bf16 a[144:147], a[64:67], a[40:43], a[144:147]
    s_mov_b32 s82, 0
    s_add_u32 m0, s3, 0
    v_mfma_f32_16x16x32_bf16 a[152:155], a[64:67], a[44:47], a[152:155]
    buffer_load_dwordx4 v17, s[48:51], s82 offen lds
    v_mfma_f32_16x16x32_bf16 a[160:163], a[64:67], a[48:51], a[160:163]
    v_mfma_f32_16x16x32_bf16 a[168:171], a[64:67], a[52:55], a[168:171]
    v_mfma_f32_16x16x32_bf16 a[176:179], a[64:67], a[56:59], a[176:179]
    v_mfma_f32_16x16x32_bf16 a[184:187], a[64:67], a[60:63], a[184:187]
    buffer_load_dwordx4 v18, s[48:51], s82 offen offset:1024 lds
    v_mfma_f32_16x16x32_bf16 v[120:123], a[64:67], a[116:119], v[120:123]
    v_mfma_f32_16x16x32_bf16 a[132:135], a[68:71], a[32:35], a[132:135]
    v_mfma_f32_16x16x32_bf16 a[140:143], a[68:71], a[36:39], a[140:143]
    v_mfma_f32_16x16x32_bf16 a[148:151], a[68:71], a[40:43], a[148:151]
    s_mov_b32 s83, 229376
    s_add_u32 m0, s3, 8192
    v_mfma_f32_16x16x32_bf16 a[156:159], a[68:71], a[44:47], a[156:159]
    buffer_load_dwordx4 v17, s[48:51], s83 offen lds
    v_mfma_f32_16x16x32_bf16 a[164:167], a[68:71], a[48:51], a[164:167]
    v_mfma_f32_16x16x32_bf16 a[172:175], a[68:71], a[52:55], a[172:175]
    v_mfma_f32_16x16x32_bf16 a[180:183], a[68:71], a[56:59], a[180:183]
    v_mfma_f32_16x16x32_bf16 a[188:191], a[68:71], a[60:63], a[188:191]
    buffer_load_dwordx4 v18, s[48:51], s83 offen offset:1024 lds
    v_mfma_f32_16x16x32_bf16 v[124:127], a[68:71], a[116:119], v[124:127]
    v_mfma_f32_16x16x32_bf16 v[52:55], a[32:35], a[72:75], v[52:55]
    v_mfma_f32_16x16x32_bf16 v[56:59], a[36:39], a[72:75], v[56:59]
    v_mfma_f32_16x16x32_bf16 v[60:63], a[40:43], a[72:75], v[60:63]
    s_mov_b32 s82, 458752
    s_add_u32 m0, s3, 16384
    v_mfma_f32_16x16x32_bf16 v[64:67], a[44:47], a[72:75], v[64:67]
    buffer_load_dwordx4 v17, s[48:51], s82 offen lds
    v_mfma_f32_16x16x32_bf16 v[68:71], a[48:51], a[72:75], v[68:71]
    v_mfma_f32_16x16x32_bf16 v[72:75], a[52:55], a[72:75], v[72:75]
    v_mfma_f32_16x16x32_bf16 v[76:79], a[56:59], a[72:75], v[76:79]
    v_mfma_f32_16x16x32_bf16 v[80:83], a[60:63], a[72:75], v[80:83]
    buffer_load_dwordx4 v18, s[48:51], s82 offen offset:1024 lds
    v_mfma_f32_16x16x32_bf16 v[48:51], a[116:119], a[72:75], v[48:51]
    v_mfma_f32_16x16x32_bf16 v[88:91], a[32:35], a[76:79], v[88:91]
    v_mfma_f32_16x16x32_bf16 v[92:95], a[36:39], a[76:79], v[92:95]
    v_mfma_f32_16x16x32_bf16 v[96:99], a[40:43], a[76:79], v[96:99]
    s_mov_b32 s83, 688128
    s_add_u32 m0, s3, 24576
    v_mfma_f32_16x16x32_bf16 v[100:103], a[44:47], a[76:79], v[100:103]
    buffer_load_dwordx4 v17, s[48:51], s83 offen lds
    v_mfma_f32_16x16x32_bf16 v[104:107], a[48:51], a[76:79], v[104:107]
    v_mfma_f32_16x16x32_bf16 v[108:111], a[52:55], a[76:79], v[108:111]
    v_mfma_f32_16x16x32_bf16 v[112:115], a[56:59], a[76:79], v[112:115]
    v_mfma_f32_16x16x32_bf16 v[116:119], a[60:63], a[76:79], v[116:119]
    buffer_load_dwordx4 v18, s[48:51], s83 offen offset:1024 lds
    v_mfma_f32_16x16x32_bf16 v[84:87], a[116:119], a[76:79], v[84:87]
    v_mfma_f32_16x16x32_bf16 a[192:195], a[80:83], a[32:35], a[192:195]
    v_mfma_f32_16x16x32_bf16 a[200:203], a[80:83], a[36:39], a[200:203]
    v_mfma_f32_16x16x32_bf16 a[208:211], a[80:83], a[40:43], a[208:211]
    s_mov_b32 s82, 917504
    s_add_u32 m0, s3, 32768
    v_mfma_f32_16x16x32_bf16 a[216:219], a[80:83], a[44:47], a[216:219]
    buffer_load_dwordx4 v17, s[48:51], s82 offen lds
    v_mfma_f32_16x16x32_bf16 a[224:227], a[80:83], a[48:51], a[224:227]
    v_mfma_f32_16x16x32_bf16 a[232:235], a[80:83], a[52:55], a[232:235]
    v_mfma_f32_16x16x32_bf16 a[240:243], a[80:83], a[56:59], a[240:243]
    v_mfma_f32_16x16x32_bf16 a[248:251], a[80:83], a[60:63], a[248:251]
    buffer_load_dwordx4 v18, s[48:51], s82 offen offset:1024 lds
    v_mfma_f32_16x16x32_bf16 a[196:199], a[84:87], a[32:35], a[196:199]
    v_mfma_f32_16x16x32_bf16 a[204:207], a[84:87], a[36:39], a[204:207]
    v_mfma_f32_16x16x32_bf16 a[212:215], a[84:87], a[40:43], a[212:215]
    v_mfma_f32_16x16x32_bf16 a[220:223], a[84:87], a[44:47], a[220:223]
    s_mov_b32 s83, 1146880
    s_add_u32 m0, s3, 40960
    v_mfma_f32_16x16x32_bf16 a[228:231], a[84:87], a[48:51], a[228:231]
    buffer_load_dwordx4 v17, s[48:51], s83 offen lds
    v_mfma_f32_16x16x32_bf16 a[236:239], a[84:87], a[52:55], a[236:239]
    v_mfma_f32_16x16x32_bf16 a[244:247], a[84:87], a[56:59], a[244:247]
    v_mfma_f32_16x16x32_bf16 a[252:255], a[84:87], a[60:63], a[252:255]
    v_mfma_f32_16x16x32_bf16 v[128:131], a[88:91], a[32:35], v[128:131]
    buffer_load_dwordx4 v18, s[48:51], s83 offen offset:1024 lds
    v_mfma_f32_16x16x32_bf16 v[144:147], a[88:91], a[36:39], v[144:147]
    v_mfma_f32_16x16x32_bf16 v[160:163], a[88:91], a[40:43], v[160:163]
    v_mfma_f32_16x16x32_bf16 v[176:179], a[88:91], a[44:47], v[176:179]
    v_mfma_f32_16x16x32_bf16 v[192:195], a[88:91], a[48:51], v[192:195]
    s_mov_b32 s82, 1376256
    s_add_u32 m0, s3, 49152
    v_mfma_f32_16x16x32_bf16 v[208:211], a[88:91], a[52:55], v[208:211]
    buffer_load_dwordx4 v17, s[48:51], s82 offen lds
    v_mfma_f32_16x16x32_bf16 v[224:227], a[88:91], a[56:59], v[224:227]
    v_mfma_f32_16x16x32_bf16 v[240:243], a[88:91], a[60:63], v[240:243]
    v_mfma_f32_16x16x32_bf16 v[132:135], a[92:95], a[32:35], v[132:135]
    v_mfma_f32_16x16x32_bf16 v[148:151], a[92:95], a[36:39], v[148:151]
    buffer_load_dwordx4 v18, s[48:51], s82 offen offset:1024 lds
    v_mfma_f32_16x16x32_bf16 v[164:167], a[92:95], a[40:43], v[164:167]
    v_mfma_f32_16x16x32_bf16 v[180:183], a[92:95], a[44:47], v[180:183]
    v_mfma_f32_16x16x32_bf16 v[196:199], a[92:95], a[48:51], v[196:199]
    v_mfma_f32_16x16x32_bf16 v[212:215], a[92:95], a[52:55], v[212:215]
    s_mov_b32 s83, 1605632
    s_add_u32 m0, s3, 57344
    v_mfma_f32_16x16x32_bf16 v[228:231], a[92:95], a[56:59], v[228:231]
    buffer_load_dwordx4 v17, s[48:51], s83 offen lds
    v_mfma_f32_16x16x32_bf16 v[244:247], a[92:95], a[60:63], v[244:247]
    v_mfma_f32_16x16x32_bf16 v[136:139], a[104:107], a[32:35], v[136:139]
    v_mfma_f32_16x16x32_bf16 v[152:155], a[104:107], a[36:39], v[152:155]
    v_mfma_f32_16x16x32_bf16 v[168:171], a[104:107], a[40:43], v[168:171]
    buffer_load_dwordx4 v18, s[48:51], s83 offen offset:1024 lds
    v_mfma_f32_16x16x32_bf16 v[184:187], a[104:107], a[44:47], v[184:187]
    v_mfma_f32_16x16x32_bf16 v[200:203], a[104:107], a[48:51], v[200:203]
    v_mfma_f32_16x16x32_bf16 v[216:219], a[104:107], a[52:55], v[216:219]
    v_mfma_f32_16x16x32_bf16 v[232:235], a[104:107], a[56:59], v[232:235]
    v_mfma_f32_16x16x32_bf16 v[248:251], a[104:107], a[60:63], v[248:251]
    v_mfma_f32_16x16x32_bf16 v[140:143], a[108:111], a[32:35], v[140:143]
    v_mfma_f32_16x16x32_bf16 v[156:159], a[108:111], a[36:39], v[156:159]
    v_mfma_f32_16x16x32_bf16 v[172:175], a[108:111], a[40:43], v[172:175]
    v_mfma_f32_16x16x32_bf16 v[188:191], a[108:111], a[44:47], v[188:191]
    v_mfma_f32_16x16x32_bf16 v[204:207], a[108:111], a[48:51], v[204:207]
    v_mfma_f32_16x16x32_bf16 v[220:223], a[108:111], a[52:55], v[220:223]
    v_mfma_f32_16x16x32_bf16 v[236:239], a[108:111], a[56:59], v[236:239]
    v_mfma_f32_16x16x32_bf16 v[252:255], a[108:111], a[60:63], v[252:255]
    s_branch L_epi
L_stub2:
    s_branch L_stub3
L_g1_1:
    s_mov_b32 m0, s14
    s_mov_b32 s77, 4096
    buffer_load_dwordx4 v1, s[28:31], s77 offen sc1 lds
    s_mov_b32 s77, 19456
    buffer_load_dwordx4 v1, s[28:31], s77 offen offset:1024 sc1 lds
    v_add_u32 v1, 128, v1
    s_mov_b32 m0, s15
    s_mov_b32 s77, 4096
    buffer_load_dwordx4 v1, s[28:31], s77 offen sc1 lds
    s_mov_b32 s77, 19456
    buffer_load_dwordx4 v1, s[28:31], s77 offen offset:1024 sc1 lds
    v_add_u32 v1, 128, v1
    s_waitcnt vmcnt(2)
    s_barrier
    ds_read_b64_tr_b16 a[64:65], v12 offset:0
    ds_read_b64_tr_b16 a[66:67], v12 offset:256
    ds_read_b64_tr_b16 a[68:69], v14 offset:0
    ds_read_b64_tr_b16 a[70:71], v14 offset:256
    ds_read_b64_tr_b16 a[72:73], v12 offset:1024
    ds_read_b64_tr_b16 a[74:75], v12 offset:1280
    ds_read_b64_tr_b16 a[76:77], v14 offset:1024
    ds_read_b64_tr_b16 a[78:79], v14 offset:1280
    ds_read_b64_tr_b16 a[80:81], v12 offset:2048
    ds_read_b64_tr_b16 a[82:83], v12 offset:2304
    ds_read_b64_tr_b16 a[84:85], v14 offset:2048
    ds_read_b64_tr_b16 a[86:87], v14 offset:2304
    ds_read_b64_tr_b16 a[88:89], v12 offset:3072
    ds_read_b64_tr_b16 a[90:91], v12 offset:3328
    ds_read_b64_tr_b16 a[92:93], v14 offset:3072
    ds_read_b64_tr_b16 a[94:95], v14 offset:3328
    ds_read_b64_tr_b16 a[96:97], v12 offset:4096
    ds_read_b64_tr_b16 a[98:99], v12 offset:4352
    ds_read_b64_tr_b16 a[100:101], v14 offset:4096
    ds_read_b64_tr_b16 a[102:103], v14 offset:4352
    ds_read_b128 a[0:3], v8 offset:0
    ds_read_b128 a[4:7], v8 offset:2048
    ds_read_b128 a[8:11], v8 offset:4096
    ds_read_b128 a[12:15], v8 offset:6144
    ds_read_b128 a[16:19], v8 offset:8192
    ds_read_b128 a[20:23], v8 offset:10240
    ds_read_b128 a[24:27], v8 offset:12288
    ds_read_b128 a[28:31], v8 offset:14336
    s_add_u32 m0, s78, 40960
    s_nop 0
    buffer_load_dwordx4 v2, s[32:35], s68 offen offset:0 lds
    buffer_load_dwordx4 v2, s[32:35], s69 offen offset:1024 lds
    buffer_load_dwordx4 v2, s[32:35], s70 offen offset:2048 lds
    v_add_u32 v2, 196608, v2
    buffer_load_dwordx4 v3, s[36:39], s71 offen offset:3072 lds
    s_add_u32 m0, s78, 45056
    s_nop 0
    buffer_load_dwordx4 v3, s[40:43], s72 offen offset:0 lds
    buffer_load_dwordx4 v3, s[36:39], s73 offen offset:1024 lds
    buffer_load_dwordx4 v3, s[40:43], s74 offen offset:2048 lds
    buffer_load_dwordx4 v3, s[36:39], s75 offen offset:3072 lds
    s_add_u32 m0, s78, 49152
    s_nop 0
    buffer_load_dwordx4 v3, s[40:43], s76 offen offset:0 lds
    v_add_u32 v3, 229376, v3
    global_load_lds_dwordx4 v[4:5], off offset:1024
    v_lshl_add_u64 v[4:5], v[4:5], 0, s[80:81]
    s_add_u32 m0, s78, 61440
    s_nop 0
    buffer_load_dwordx4 v2, s[32:35], s68 offen offset:0 lds
    buffer_load_dwordx4 v2, s[32:35], s69 offen offset:1024 lds
    buffer_load_dwordx4 v2, s[32:35], s70 offen offset:2048 lds
    v_add_u32 v2, 196608, v2
    buffer_load_dwordx4 v3, s[36:39], s71 offen offset:3072 lds
    s_add_u32 m0, s78, 65536
    s_nop 0
    buffer_load_dwordx4 v3, s[40:43], s72 offen offset:0 lds
    buffer_load_dwordx4 v3, s[36:39], s73 offen offset:1024 lds
    buffer_load_dwordx4 v3, s[40:43], s74 offen offset:2048 lds
    buffer_load_dwordx4 v3, s[36:39], s75 offen offset:3072 lds
    s_add_u32 m0, s78, 69632
    s_nop 0
    buffer_load_dwordx4 v3, s[40:43], s76 offen offset:0 lds
    v_add_u32 v3, 229376, v3
    global_load_lds_dwordx4 v[4:5], off offset:1024
    v_lshl_add_u64 v[4:5], v[4:5], 0, s[80:81]
    s_mov_b32 s67, 7
    v_mov_b32 v20, 0x7ff00000
.p2align 3
L_loop1:
    s_waitcnt vmcnt(24) lgkmcnt(0)
    s_barrier
    v_mfma_f32_16x16x32_bf16 v[128:131], a[64:67], a[0:3], v[128:131]
    s_add_u32 m0, s78, 0
    buffer_load_dword v7, v6, s[44:47], s4 offen
    v_add_u32_e64 v6, s79, v6
    v_mfma_f32_16x16x32_bf16 v[144:147], a[64:67], a[4:7], v[144:147]
    buffer_load_dwordx4 v2, s[32:35], s68 offen offset:0 lds
    buffer_load_dword v7, v33, s[48:51], 0 offen
    v_add_u32_e64 v33, s52, v33
    v_mfma_f32_16x16x32_bf16 v[160:163], a[64:67], a[8:11], v[160:163]
    ds_read_b128 a[32:35], v9 offset:0
    v_mfma_f32_16x16x32_bf16 v[176:179], a[64:67], a[12:15], v[176:179]
    v_mfma_f32_16x16x32_bf16 v[192:195], a[64:67], a[16:19], v[192:195]
    v_mfma_f32_16x16x32_bf16 v[208:211], a[64:67], a[20:23], v[208:211]
    v_mfma_f32_16x16x32_bf16 v[224:227], a[64:67], a[24:27], v[224:227]
    ds_read_b128 a[36:39], v9 offset:2048
    v_mfma_f32_16x16x32_bf16 v[240:243], a[64:67], a[28:31], v[240:243]
    ds_read_b64_tr_b16 a[64:65], v12 offset:20480
    v_mfma_f32_16x16x32_bf16 v[132:135], a[68:71], a[0:3], v[132:135]
    ds_read_b64_tr_b16 a[66:67], v12 offset:20736
    v_mfma_f32_16x16x32_bf16 v[148:151], a[68:71], a[4:7], v[148:151]
    buffer_load_dwordx4 v2, s[32:35], s69 offen offset:1024 lds
    v_mfma_f32_16x16x32_bf16 v[164:167], a[68:71], a[8:11], v[164:167]
    ds_read_b128 a[40:43], v9 offset:4096
    v_mfma_f32_16x16x32_bf16 v[180:183], a[68:71], a[12:15], v[180:183]
    v_mfma_f32_16x16x32_bf16 v[196:199], a[68:71], a[16:19], v[196:199]
    v_mfma_f32_16x16x32_bf16 v[212:215], a[68:71], a[20:23], v[212:215]
    buffer_load_dwordx4 v2, s[32:35], s70 offen offset:2048 lds
    v_add_u32 v2, 196608, v2
    v_mfma_f32_16x16x32_bf16 v[228:231], a[68:71], a[24:27], v[228:231]
    ds_read_b128 a[44:47], v9 offset:6144
    v_mfma_f32_16x16x32_bf16 v[244:247], a[68:71], a[28:31], v[244:247]
    ds_read_b64_tr_b16 a[68:69], v14 offset:20480
    v_mfma_f32_16x16x32_bf16 v[136:139], a[72:75], a[0:3], v[136:139]
    ds_read_b64_tr_b16 a[70:71], v14 offset:20736
    v_mfma_f32_16x16x32_bf16 v[152:155], a[72:75], a[4:7], v[152:155]
    v_mfma_f32_16x16x32_bf16 v[168:171], a[72:75], a[8:11], v[168:171]
    ds_read_b128 a[48:51], v9 offset:8192
    v_mfma_f32_16x16x32_bf16 v[184:187], a[72:75], a[12:15], v[184:187]
    buffer_load_dwordx4 v3, s[36:39], s71 offen offset:3072 lds
    v_mfma_f32_16x16x32_bf16 v[200:203], a[72:75], a[16:19], v[200:203]
    v_mfma_f32_16x16x32_bf16 v[216:219], a[72:75], a[20:23], v[216:219]
    v_mfma_f32_16x16x32_bf16 v[232:235], a[72:75], a[24:27], v[232:235]
    ds_read_b128 a[52:55], v9 offset:10240
    v_mfma_f32_16x16x32_bf16 v[248:251], a[72:75], a[28:31], v[248:251]
    ds_read_b64_tr_b16 a[72:73], v12 offset:21504
    v_mfma_f32_16x16x32_bf16 v[140:143], a[76:79], a[0:3], v[140:143]
    ds_read_b64_tr_b16 a[74:75], v12 offset:21760
    s_add_u32 m0, s78, 4096
    v_mfma_f32_16x16x32_bf16 v[156:159], a[76:79], a[4:7], v[156:159]
    buffer_load_dwordx4 v3, s[40:43], s72 offen offset:0 lds
    v_mfma_f32_16x16x32_bf16 v[172:175], a[76:79], a[8:11], v[172:175]
    ds_read_b128 a[56:59], v9 offset:12288
    v_mfma_f32_16x16x32_bf16 v[188:191], a[76:79], a[12:15], v[188:191]
    v_mfma_f32_16x16x32_bf16 v[204:207], a[76:79], a[16:19], v[204:207]
    v_mfma_f32_16x16x32_bf16 v[220:223], a[76:79], a[20:23], v[220:223]
    v_mfma_f32_16x16x32_bf16 v[236:239], a[76:79], a[24:27], v[236:239]
    ds_read_b128 a[60:63], v9 offset:14336
    v_mfma_f32_16x16x32_bf16 v[252:255], a[76:79], a[28:31], v[252:255]
    ds_read_b64_tr_b16 a[76:77], v14 offset:21504
    v_mfma_f32_16x16x32_bf16 a[128:131], a[80:83], a[0:3], a[128:131]
    ds_read_b64_tr_b16 a[78:79], v14 offset:21760
    v_mfma_f32_16x16x32_bf16 a[144:147], a[80:83], a[4:7], a[144:147]
    buffer_load_dwordx4 v3, s[36:39], s73 offen offset:1024 lds
    v_mfma_f32_16x16x32_bf16 a[160:163], a[80:83], a[8:11], a[160:163]
    ds_read_b64_tr_b16 a[104:105], v12 offset:24576
    v_mfma_f32_16x16x32_bf16 a[176:179], a[80:83], a[12:15], a[176:179]
    v_mfma_f32_16x16x32_bf16 a[192:195], a[80:83], a[16:19], a[192:195]
    v_mfma_f32_16x16x32_bf16 a[208:211], a[80:83], a[20:23], a[208:211]
    v_mfma_f32_16x16x32_bf16 a[224:227], a[80:83], a[24:27], a[224:227]
    ds_read_b64_tr_b16 a[106:107], v12 offset:24832
    v_mfma_f32_16x16x32_bf16 a[240:243], a[80:83], a[28:31], a[240:243]
    ds_read_b64_tr_b16 a[80:81], v12 offset:22528
    v_mfma_f32_16x16x32_bf16 a[132:135], a[84:87], a[0:3], a[132:135]
    ds_read_b64_tr_b16 a[82:83], v12 offset:22784
    v_mfma_f32_16x16x32_bf16 a[148:151], a[84:87], a[4:7], a[148:151]
    buffer_load_dwordx4 v3, s[40:43], s74 offen offset:2048 lds
    v_mfma_f32_16x16x32_bf16 a[164:167], a[84:87], a[8:11], a[164:167]
    ds_read_b64_tr_b16 a[108:109], v14 offset:24576
    v_mfma_f32_16x16x32_bf16 a[180:183], a[84:87], a[12:15], a[180:183]
    v_mfma_f32_16x16x32_bf16 a[196:199], a[84:87], a[16:19], a[196:199]
    buffer_load_dwordx4 v3, s[36:39], s75 offen offset:3072 lds
    v_mfma_f32_16x16x32_bf16 a[212:215], a[84:87], a[20:23], a[212:215]
    v_mfma_f32_16x16x32_bf16 a[228:231], a[84:87], a[24:27], a[228:231]
    ds_read_b64_tr_b16 a[110:111], v14 offset:24832
    v_mfma_f32_16x16x32_bf16 a[244:247], a[84:87], a[28:31], a[244:247]
    ds_read_b64_tr_b16 a[84:85], v14 offset:22528
    v_mfma_f32_16x16x32_bf16 a[136:139], a[88:91], a[0:3], a[136:139]
    ds_read_b64_tr_b16 a[86:87], v14 offset:22784
    v_mfma_f32_16x16x32_bf16 a[152:155], a[88:91], a[4:7], a[152:155]
    s_add_u32 m0, s78, 8192
    v_mfma_f32_16x16x32_bf16 a[168:171], a[88:91], a[8:11], a[168:171]
    buffer_load_dwordx4 v3, s[40:43], s76 offen offset:0 lds
    v_add_u32 v3, 229376, v3
    v_mfma_f32_16x16x32_bf16 a[184:187], a[88:91], a[12:15], a[184:187]
    v_mfma_f32_16x16x32_bf16 a[200:203], a[88:91], a[16:19], a[200:203]
    v_mfma_f32_16x16x32_bf16 a[216:219], a[88:91], a[20:23], a[216:219]
    v_mfma_f32_16x16x32_bf16 a[232:235], a[88:91], a[24:27], a[232:235]
    v_mfma_f32_16x16x32_bf16 a[248:251], a[88:91], a[28:31], a[248:251]
    ds_read_b64_tr_b16 a[88:89], v12 offset:23552
    v_mfma_f32_16x16x32_bf16 a[140:143], a[92:95], a[0:3], a[140:143]
    ds_read_b64_tr_b16 a[90:91], v12 offset:23808
    v_mfma_f32_16x16x32_bf16 a[156:159], a[92:95], a[4:7], a[156:159]
    global_load_lds_dwordx4 v[4:5], off offset:1024
    v_lshl_add_u64 v[4:5], v[4:5], 0, s[80:81]
    v_mfma_f32_16x16x32_bf16 a[172:175], a[92:95], a[8:11], a[172:175]
    v_mfma_f32_16x16x32_bf16 a[188:191], a[92:95], a[12:15], a[188:191]
    v_mfma_f32_16x16x32_bf16 a[204:207], a[92:95], a[16:19], a[204:207]
    v_mfma_f32_16x16x32_bf16 a[220:223], a[92:95], a[20:23], a[220:223]
    v_mfma_f32_16x16x32_bf16 a[236:239], a[92:95], a[24:27], a[236:239]
    v_mfma_f32_16x16x32_bf16 a[252:255], a[92:95], a[28:31], a[252:255]
    ds_read_b64_tr_b16 a[92:93], v14 offset:23552
    v_mfma_f32_16x16x32_bf16 v[48:51], a[96:99], a[0:3], v[48:51]
    ds_read_b64_tr_b16 a[94:95], v14 offset:23808
    v_mfma_f32_16x16x32_bf16 v[52:55], a[96:99], a[4:7], v[52:55]
    v_mfma_f32_16x16x32_bf16 v[64:67], a[96:99], a[8:11], v[64:67]
    v_mfma_f32_16x16x32_bf16 v[68:71], a[96:99], a[12:15], v[68:71]
    v_mfma_f32_16x16x32_bf16 v[80:83], a[96:99], a[16:19], v[80:83]
    v_mfma_f32_16x16x32_bf16 v[84:87], a[96:99], a[20:23], v[84:87]
    v_mfma_f32_16x16x32_bf16 v[96:99], a[96:99], a[24:27], v[96:99]
    v_mfma_f32_16x16x32_bf16 v[100:103], a[96:99], a[28:31], v[100:103]
    v_mfma_f32_16x16x32_bf16 v[56:59], a[100:103], a[0:3], v[56:59]
    v_mfma_f32_16x16x32_bf16 v[60:63], a[100:103], a[4:7], v[60:63]
    v_mfma_f32_16x16x32_bf16 v[72:75], a[100:103], a[8:11], v[72:75]
    v_mfma_f32_16x16x32_bf16 v[76:79], a[100:103], a[12:15], v[76:79]
    v_mfma_f32_16x16x32_bf16 v[88:91], a[100:103], a[16:19], v[88:91]
    v_mfma_f32_16x16x32_bf16 v[92:95], a[100:103], a[20:23], v[92:95]
    v_mfma_f32_16x16x32_bf16 v[104:107], a[100:103], a[24:27], v[104:107]
    v_mfma_f32_16x16x32_bf16 v[108:111], a[100:103], a[28:31], v[108:111]
    s_waitcnt vmcnt(22) lgkmcnt(0)
    s_barrier
    v_mfma_f32_16x16x32_bf16 v[128:131], a[64:67], a[32:35], v[128:131]
    s_mov_b32 m0, s14
    s_mov_b32 s77, 4096
    v_mfma_f32_16x16x32_bf16 v[144:147], a[64:67], a[36:39], v[144:147]
    buffer_load_dwordx4 v1, s[28:31], s77 offen sc1 lds
    v_mfma_f32_16x16x32_bf16 v[160:163], a[64:67], a[40:43], v[160:163]
    ds_read_b128 a[0:3], v8 offset:34816
    v_mfma_f32_16x16x32_bf16 v[176:179], a[64:67], a[44:47], v[176:179]
    v_mfma_f32_16x16x32_bf16 v[192:195], a[64:67], a[48:51], v[192:195]
    v_mfma_f32_16x16x32_bf16 v[208:211], a[64:67], a[52:55], v[208:211]
    v_mfma_f32_16x16x32_bf16 v[224:227], a[64:67], a[56:59], v[224:227]
    ds_read_b128 a[4:7], v8 offset:36864
    v_mfma_f32_16x16x32_bf16 v[240:243], a[64:67], a[60:63], v[240:243]
    ds_read_b64_tr_b16 a[64:65], v13 offset:0
    v_mfma_f32_16x16x32_bf16 v[132:135], a[68:71], a[32:35], v[132:135]
    ds_read_b64_tr_b16 a[66:67], v13 offset:256
    s_mov_b32 s77, 19456
    v_mfma_f32_16x16x32_bf16 v[148:151], a[68:71], a[36:39], v[148:151]
    buffer_load_dwordx4 v1, s[28:31], s77 offen offset:1024 sc1 lds
    v_add_u32 v1, 128, v1
    v_mfma_f32_16x16x32_bf16 v[164:167], a[68:71], a[40:43], v[164:167]
    ds_read_b128 a[8:11], v8 offset:38912
    s_add_u32 m0, s78, 20480
    v_mfma_f32_16x16x32_bf16 v[180:183], a[68:71], a[44:47], v[180:183]
    buffer_load_dwordx4 v2, s[32:35], s68 offen offset:0 lds
    v_mfma_f32_16x16x32_bf16 v[196:199], a[68:71], a[48:51], v[196:199]
    v_mfma_f32_16x16x32_bf16 v[212:215], a[68:71], a[52:55], v[212:215]
    v_mfma_f32_16x16x32_bf16 v[228:231], a[68:71], a[56:59], v[228:231]
    ds_read_b128 a[12:15], v8 offset:40960
    v_mfma_f32_16x16x32_bf16 v[244:247], a[68:71], a[60:63], v[244:247]
    ds_read_b64_tr_b16 a[68:69], v15 offset:0
    v_mfma_f32_16x16x32_bf16 v[136:139], a[72:75], a[32:35], v[136:139]
    ds_read_b64_tr_b16 a[70:71], v15 offset:256
    v_mfma_f32_16x16x32_bf16 v[152:155], a[72:75], a[36:39], v[152:155]
    buffer_load_dwordx4 v2, s[32:35], s69 offen offset:1024 lds
    v_mfma_f32_16x16x32_bf16 v[168:171], a[72:75], a[40:43], v[168:171]
    ds_read_b128 a[16:19], v8 offset:43008
    v_mfma_f32_16x16x32_bf16 v[184:187], a[72:75], a[44:47], v[184:187]
    v_mfma_f32_16x16x32_bf16 v[200:203], a[72:75], a[48:51], v[200:203]
    v_mfma_f32_16x16x32_bf16 v[216:219], a[72:75], a[52:55], v[216:219]
    buffer_load_dwordx4 v2, s[32:35], s70 offen offset:2048 lds
    v_add_u32 v2, 196608, v2
    v_mfma_f32_16x16x32_bf16 v[232:235], a[72:75], a[56:59], v[232:235]
    ds_read_b128 a[20:23], v8 offset:45056
    v_mfma_f32_16x16x32_bf16 v[248:251], a[72:75], a[60:63], v[248:251]
    ds_read_b64_tr_b16 a[72:73], v13 offset:1024
    v_mfma_f32_16x16x32_bf16 v[140:143], a[76:79], a[32:35], v[140:143]
    ds_read_b64_tr_b16 a[74:75], v13 offset:1280
    v_mfma_f32_16x16x32_bf16 v[156:159], a[76:79], a[36:39], v[156:159]
    v_mfma_f32_16x16x32_bf16 v[172:175], a[76:79], a[40:43], v[172:175]
    ds_read_b128 a[24:27], v8 offset:47104
    v_mfma_f32_16x16x32_bf16 v[188:191], a[76:79], a[44:47], v[188:191]
    buffer_load_dwordx4 v3, s[36:39], s71 offen offset:3072 lds
    v_mfma_f32_16x16x32_bf16 v[204:207], a[76:79], a[48:51], v[204:207]
    v_mfma_f32_16x16x32_bf16 v[220:223], a[76:79], a[52:55], v[220:223]
    v_mfma_f32_16x16x32_bf16 v[236:239], a[76:79], a[56:59], v[236:239]
    ds_read_b128 a[28:31], v8 offset:49152
    v_mfma_f32_16x16x32_bf16 v[252:255], a[76:79], a[60:63], v[252:255]
    ds_read_b64_tr_b16 a[76:77], v15 offset:1024
    v_mfma_f32_16x16x32_bf16 a[128:131], a[80:83], a[32:35], a[128:131]
    ds_read_b64_tr_b16 a[78:79], v15 offset:1280
    s_add_u32 m0, s78, 24576
    v_mfma_f32_16x16x32_bf16 a[144:147], a[80:83], a[36:39], a[144:147]
    buffer_load_dwordx4 v3, s[40:43], s72 offen offset:0 lds
    v_mfma_f32_16x16x32_bf16 a[160:163], a[80:83], a[40:43], a[160:163]
    ds_read_b64_tr_b16 a[96:97], v13 offset:4096
    v_mfma_f32_16x16x32_bf16 a[176:179], a[80:83], a[44:47], a[176:179]
    v_mfma_f32_16x16x32_bf16 a[192:195], a[80:83], a[48:51], a[192:195]
    v_mfma_f32_16x16x32_bf16 a[208:211], a[80:83], a[52:55], a[208:211]
    buffer_load_dwordx4 v3, s[36:39], s73 offen offset:1024 lds
    v_mfma_f32_16x16x32_bf16 a[224:227], a[80:83], a[56:59], a[224:227]
    ds_read_b64_tr_b16 a[98:99], v13 offset:4352
    v_mfma_f32_16x16x32_bf16 a[240:243], a[80:83], a[60:63], a[240:243]
    ds_read_b64_tr_b16 a[80:81], v13 offset:2048
    v_mfma_f32_16x16x32_bf16 a[132:135], a[84:87], a[32:35], a[132:135]
    ds_read_b64_tr_b16 a[82:83], v13 offset:2304
    v_mfma_f32_16x16x32_bf16 a[148:151], a[84:87], a[36:39], a[148:151]
    v_mfma_f32_16x16x32_bf16 a[164:167], a[84:87], a[40:43], a[164:167]
    ds_read_b64_tr_b16 a[100:101], v15 offset:4096
    v_mfma_f32_16x16x32_bf16 a[180:183], a[84:87], a[44:47], a[180:183]
    buffer_load_dwordx4 v3, s[40:43], s74 offen offset:2048 lds
    v_mfma_f32_16x16x32_bf16 a[196:199], a[84:87], a[48:51], a[196:199]
    v_mfma_f32_16x16x32_bf16 a[212:215], a[84:87], a[52:55], a[212:215]
    v_mfma_f32_16x16x32_bf16 a[228:231], a[84:87], a[56:59], a[228:231]
    ds_read_b64_tr_b16 a[102:103], v15 offset:4352
    v_mfma_f32_16x16x32_bf16 a[244:247], a[84:87], a[60:63], a[244:247]
    ds_read_b64_tr_b16 a[84:85], v15 offset:2048
    v_mfma_f32_16x16x32_bf16 a[136:139], a[88:91], a[32:35], a[136:139]
    ds_read_b64_tr_b16 a[86:87], v15 offset:2304
    v_mfma_f32_16x16x32_bf16 a[152:155], a[88:91], a[36:39], a[152:155]
    buffer_load_dwordx4 v3, s[36:39], s75 offen offset:3072 lds
    v_mfma_f32_16x16x32_bf16 a[168:171], a[88:91], a[40:43], a[168:171]
    v_mfma_f32_16x16x32_bf16 a[184:187], a[88:91], a[44:47], a[184:187]
    s_add_u32 m0, s78, 28672
    v_mfma_f32_16x16x32_bf16 a[200:203], a[88:91], a[48:51], a[200:203]
    buffer_load_dwordx4 v3, s[40:43], s76 offen offset:0 lds
    v_add_u32 v3, 229376, v3
    v_mfma_f32_16x16x32_bf16 a[216:219], a[88:91], a[52:55], a[216:219]
    v_mfma_f32_16x16x32_bf16 a[232:235], a[88:91], a[56:59], a[232:235]
    v_mfma_f32_16x16x32_bf16 a[248:251], a[88:91], a[60:63], a[248:251]
    ds_read_b64_tr_b16 a[88:89], v13 offset:3072
    v_mfma_f32_16x16x32_bf16 a[140:143], a[92:95], a[32:35], a[140:143]
    ds_read_b64_tr_b16 a[90:91], v13 offset:3328
    v_mfma_f32_16x16x32_bf16 a[156:159], a[92:95], a[36:39], a[156:159]
    global_load_lds_dwordx4 v[4:5], off offset:1024
    v_lshl_add_u64 v[4:5], v[4:5], 0, s[80:81]
    v_mfma_f32_16x16x32_bf16 a[172:175], a[92:95], a[40:43], a[172:175]
    v_mfma_f32_16x16x32_bf16 a[188:191], a[92:95], a[44:47], a[188:191]
    v_mfma_f32_16x16x32_bf16 a[204:207], a[92:95], a[48:51], a[204:207]
    v_mfma_f32_16x16x32_bf16 a[220:223], a[92:95], a[52:55], a[220:223]
    v_mfma_f32_16x16x32_bf16 a[236:239], a[92:95], a[56:59], a[236:239]
    v_mfma_f32_16x16x32_bf16 a[252:255], a[92:95], a[60:63], a[252:255]
    ds_read_b64_tr_b16 a[92:93], v15 offset:3072
    v_mfma_f32_16x16x32_bf16 v[48:51], a[104:107], a[32:35], v[48:51]
    ds_read_b64_tr_b16 a[94:95], v15 offset:3328
    v_mfma_f32_16x16x32_bf16 v[52:55], a[104:107], a[36:39], v[52:55]
    v_mfma_f32_16x16x32_bf16 v[64:67], a[104:107], a[40:43], v[64:67]
    v_mfma_f32_16x16x32_bf16 v[68:71], a[104:107], a[44:47], v[68:71]
    v_mfma_f32_16x16x32_bf16 v[80:83], a[104:107], a[48:51], v[80:83]
    v_mfma_f32_16x16x32_bf16 v[84:87], a[104:107], a[52:55], v[84:87]
    v_mfma_f32_16x16x32_bf16 v[96:99], a[104:107], a[56:59], v[96:99]
    v_mfma_f32_16x16x32_bf16 v[100:103], a[104:107], a[60:63], v[100:103]
    v_mfma_f32_16x16x32_bf16 v[56:59], a[108:111], a[32:35], v[56:59]
    v_mfma_f32_16x16x32_bf16 v[60:63], a[108:111], a[36:39], v[60:63]
    v_mfma_f32_16x16x32_bf16 v[72:75], a[108:111], a[40:43], v[72:75]
    v_mfma_f32_16x16x32_bf16 v[76:79], a[108:111], a[44:47], v[76:79]
    v_mfma_f32_16x16x32_bf16 v[88:91], a[108:111], a[48:51], v[88:91]
    v_mfma_f32_16x16x32_bf16 v[92:95], a[108:111], a[52:55], v[92:95]
    v_mfma_f32_16x16x32_bf16 v[104:107], a[108:111], a[56:59], v[104:107]
    v_mfma_f32_16x16x32_bf16 v[108:111], a[108:111], a[60:63], v[108:111]
    s_waitcnt vmcnt(24) lgkmcnt(0)
    s_barrier
    v_mfma_f32_16x16x32_bf16 v[128:131], a[64:67], a[0:3], v[128:131]
    s_add_u32 m0, s78, 40960
    buffer_load_dword v7, v6, s[44:47], s4 offen
    v_add_u32_e64 v6, s79, v6
    v_mfma_f32_16x16x32_bf16 v[144:147], a[64:67], a[4:7], v[144:147]
    buffer_load_dwordx4 v2, s[32:35], s68 offen offset:0 lds
    buffer_load_dword v7, v33, s[48:51], 0 offen
    v_add_u32_e64 v33, s52, v33
    v_mfma_f32_16x16x32_bf16 v[160:163], a[64:67], a[8:11], v[160:163]
    ds_read_b128 a[32:35], v9 offset:34816
    v_mfma_f32_16x16x32_bf16 v[176:179], a[64:67], a[12:15], v[176:179]
    v_mfma_f32_16x16x32_bf16 v[192:195], a[64:67], a[16:19], v[192:195]
    v_mfma_f32_16x16x32_bf16 v[208:211], a[64:67], a[20:23], v[208:211]
    v_mfma_f32_16x16x32_bf16 v[224:227], a[64:67], a[24:27], v[224:227]
    ds_read_b128 a[36:39], v9 offset:36864
    v_mfma_f32_16x16x32_bf16 v[240:243], a[64:67], a[28:31], v[240:243]
    ds_read_b64_tr_b16 a[64:65], v13 offset:20480
    v_mfma_f32_16x16x32_bf16 v[132:135], a[68:71], a[0:3], v[132:135]
    ds_read_b64_tr_b16 a[66:67], v13 offset:20736
    v_mfma_f32_16x16x32_bf16 v[148:151], a[68:71], a[4:7], v[148:151]
    buffer_load_dwordx4 v2, s[32:35], s69 offen offset:1024 lds
    v_mfma_f32_16x16x32_bf16 v[164:167], a[68:71], a[8:11], v[164:167]
    ds_read_b128 a[40:43], v9 offset:38912
    v_mfma_f32_16x16x32_bf16 v[180:183], a[68:71], a[12:15], v[180:183]
    v_mfma_f32_16x16x32_bf16 v[196:199], a[68:71], a[16:19], v[196:199]
    v_mfma_f32_16x16x32_bf16 v[212:215], a[68:71], a[20:23], v[212:215]
    buffer_load_dwordx4 v2, s[32:35], s70 offen offset:2048 lds
    v_add_u32 v2, 196608, v2
    v_mfma_f32_16x16x32_bf16 v[228:231], a[68:71], a[24:27], v[228:231]
    ds_read_b128 a[44:47], v9 offset:40960
    v_mfma_f32_16x16x32_bf16 v[244:247], a[68:71], a[28:31], v[244:247]
    ds_read_b64_tr_b16 a[68:69], v15 offset:20480
    v_mfma_f32_16x16x32_bf16 v[136:139], a[72:75], a[0:3], v[136:139]
    ds_read_b64_tr_b16 a[70:71], v15 offset:20736
    v_mfma_f32_16x16x32_bf16 v[152:155], a[72:75], a[4:7], v[152:155]
    v_mfma_f32_16x16x32_bf16 v[168:171], a[72:75], a[8:11], v[168:171]
    ds_read_b128 a[48:51], v9 offset:43008
    v_mfma_f32_16x16x32_bf16 v[184:187], a[72:75], a[12:15], v[184:187]
    buffer_load_dwordx4 v3, s[36:39], s71 offen offset:3072 lds
    v_mfma_f32_16x16x32_bf16 v[200:203], a[72:75], a[16:19], v[200:203]
    v_mfma_f32_16x16x32_bf16 v[216:219], a[72:75], a[20:23], v[216:219]
    v_mfma_f32_16x16x32_bf16 v[232:235], a[72:75], a[24:27], v[232:235]
    ds_read_b128 a[52:55], v9 offset:45056
    v_mfma_f32_16x16x32_bf16 v[248:251], a[72:75], a[28:31], v[248:251]
    ds_read_b64_tr_b16 a[72:73], v13 offset:21504
    v_mfma_f32_16x16x32_bf16 v[140:143], a[76:79], a[0:3], v[140:143]
    ds_read_b64_tr_b16 a[74:75], v13 offset:21760
    s_add_u32 m0, s78, 45056
    v_mfma_f32_16x16x32_bf16 v[156:159], a[76:79], a[4:7], v[156:159]
    buffer_load_dwordx4 v3, s[40:43], s72 offen offset:0 lds
    v_mfma_f32_16x16x32_bf16 v[172:175], a[76:79], a[8:11], v[172:175]
    ds_read_b128 a[56:59], v9 offset:47104
    v_mfma_f32_16x16x32_bf16 v[188:191], a[76:79], a[12:15], v[188:191]
    v_mfma_f32_16x16x32_bf16 v[204:207], a[76:79], a[16:19], v[204:207]
    v_mfma_f32_16x16x32_bf16 v[220:223], a[76:79], a[20:23], v[220:223]
    v_mfma_f32_16x16x32_bf16 v[236:239], a[76:79], a[24:27], v[236:239]
    ds_read_b128 a[60:63], v9 offset:49152
    v_mfma_f32_16x16x32_bf16 v[252:255], a[76:79], a[28:31], v[252:255]
    ds_read_b64_tr_b16 a[76:77], v15 offset:21504
    v_mfma_f32_16x16x32_bf16 a[128:131], a[80:83], a[0:3], a[128:131]
    ds_read_b64_tr_b16 a[78:79], v15 offset:21760
    v_mfma_f32_16x16x32_bf16 a[144:147], a[80:83], a[4:7], a[144:147]
    buffer_load_dwordx4 v3, s[36:39], s73 offen offset:1024 lds
    v_mfma_f32_16x16x32_bf16 a[160:163], a[80:83], a[8:11], a[160:163]
    ds_read_b64_tr_b16 a[104:105], v13 offset:24576
    v_mfma_f32_16x16x32_bf16 a[176:179], a[80:83], a[12:15], a[176:179]
    v_mfma_f32_16x16x32_bf16 a[192:195], a[80:83], a[16:19], a[192:195]
    v_mfma_f32_16x16x32_bf16 a[208:211], a[80:83], a[20:23], a[208:211]
    v_mfma_f32_16x16x32_bf16 a[224:227], a[80:83], a[24:27], a[224:227]
    ds_read_b64_tr_b16 a[106:107], v13 offset:24832
    v_mfma_f32_16x16x32_bf16 a[240:243], a[80:83], a[28:31], a[240:243]
    ds_read_b64_tr_b16 a[80:81], v13 offset:22528
    v_mfma_f32_16x16x32_bf16 a[132:135], a[84:87], a[0:3], a[132:135]
    ds_read_b64_tr_b16 a[82:83], v13 offset:22784
    v_mfma_f32_16x16x32_bf16 a[148:151], a[84:87], a[4:7], a[148:151]
    buffer_load_dwordx4 v3, s[40:43], s74 offen offset:2048 lds
    v_mfma_f32_16x16x32_bf16 a[164:167], a[84:87], a[8:11], a[164:167]
    ds_read_b64_tr_b16 a[108:109], v15 offset:24576
    v_mfma_f32_16x16x32_bf16 a[180:183], a[84:87], a[12:15], a[180:183]
    v_mfma_f32_16x16x32_bf16 a[196:199], a[84:87], a[16:19], a[196:199]
    buffer_load_dwordx4 v3, s[36:39], s75 offen offset:3072 lds
    v_mfma_f32_16x16x32_bf16 a[212:215], a[84:87], a[20:23], a[212:215]
    v_mfma_f32_16x16x32_bf16 a[228:231], a[84:87], a[24:27], a[228:231]
    ds_read_b64_tr_b16 a[110:111], v15 offset:24832
    v_mfma_f32_16x16x32_bf16 a[244:247], a[84:87], a[28:31], a[244:247]
    ds_read_b64_tr_b16 a[84:85], v15 offset:22528
    v_mfma_f32_16x16x32_bf16 a[136:139], a[88:91], a[0:3], a[136:139]
    ds_read_b64_tr_b16 a[86:87], v15 offset:22784
    v_mfma_f32_16x16x32_bf16 a[152:155], a[88:91], a[4:7], a[152:155]
    s_add_u32 m0, s78, 49152
    v_mfma_f32_16x16x32_bf16 a[168:171], a[88:91], a[8:11], a[168:171]
    buffer_load_dwordx4 v3, s[40:43], s76 offen offset:0 lds
    v_add_u32 v3, 229376, v3
    v_mfma_f32_16x16x32_bf16 a[184:187], a[88:91], a[12:15], a[184:187]
    v_mfma_f32_16x16x32_bf16 a[200:203], a[88:91], a[16:19], a[200:203]
    v_mfma_f32_16x16x32_bf16 a[216:219], a[88:91], a[20:23], a[216:219]
    v_mfma_f32_16x16x32_bf16 a[232:235], a[88:91], a[24:27], a[232:235]
    v_mfma_f32_16x16x32_bf16 a[248:251], a[88:91], a[28:31], a[248:251]
    ds_read_b64_tr_b16 a[88:89], v13 offset:23552
    v_mfma_f32_16x16x32_bf16 a[140:143], a[92:95], a[0:3], a[140:143]
    ds_read_b64_tr_b16 a[90:91], v13 offset:23808
    v_mfma_f32_16x16x32_bf16 a[156:159], a[92:95], a[4:7], a[156:159]
    global_load_lds_dwordx4 v[4:5], off offset:1024
    v_lshl_add_u64 v[4:5], v[4:5], 0, s[80:81]
    v_mfma_f32_16x16x32_bf16 a[172:175], a[92:95], a[8:11], a[172:175]
    v_mfma_f32_16x16x32_bf16 a[188:191], a[92:95], a[12:15], a[188:191]
    v_mfma_f32_16x16x32_bf16 a[204:207], a[92:95], a[16:19], a[204:207]
    v_mfma_f32_16x16x32_bf16 a[220:223], a[92:95], a[20:23], a[220:223]
    v_mfma_f32_16x16x32_bf16 a[236:239], a[92:95], a[24:27], a[236:239]
    v_mfma_f32_16x16x32_bf16 a[252:255], a[92:95], a[28:31], a[252:255]
    ds_read_b64_tr_b16 a[92:93], v15 offset:23552
    v_mfma_f32_16x16x32_bf16 v[48:51], a[96:99], a[0:3], v[48:51]
    ds_read_b64_tr_b16 a[94:95], v15 offset:23808
    v_mfma_f32_16x16x32_bf16 v[52:55], a[96:99], a[4:7], v[52:55]
    v_mfma_f32_16x16x32_bf16 v[64:67], a[96:99], a[8:11], v[64:67]
    v_mfma_f32_16x16x32_bf16 v[68:71], a[96:99], a[12:15], v[68:71]
    v_mfma_f32_16x16x32_bf16 v[80:83], a[96:99], a[16:19], v[80:83]
    v_mfma_f32_16x16x32_bf16 v[84:87], a[96:99], a[20:23], v[84:87]
    v_mfma_f32_16x16x32_bf16 v[96:99], a[96:99], a[24:27], v[96:99]
    v_mfma_f32_16x16x32_bf16 v[100:103], a[96:99], a[28:31], v[100:103]
    v_mfma_f32_16x16x32_bf16 v[56:59], a[100:103], a[0:3], v[56:59]
    v_mfma_f32_16x16x32_bf16 v[60:63], a[100:103], a[4:7], v[60:63]
    v_mfma_f32_16x16x32_bf16 v[72:75], a[100:103], a[8:11], v[72:75]
    v_mfma_f32_16x16x32_bf16 v[76:79], a[100:103], a[12:15], v[76:79]
    v_mfma_f32_16x16x32_bf16 v[88:91], a[100:103], a[16:19], v[88:91]
    v_mfma_f32_16x16x32_bf16 v[92:95], a[100:103], a[20:23], v[92:95]
    v_mfma_f32_16x16x32_bf16 v[104:107], a[100:103], a[24:27], v[104:107]
    v_mfma_f32_16x16x32_bf16 v[108:111], a[100:103], a[28:31], v[108:111]
    s_waitcnt vmcnt(22) lgkmcnt(0)
    s_barrier
    v_mfma_f32_16x16x32_bf16 v[128:131], a[64:67], a[32:35], v[128:131]
    s_mov_b32 m0, s15
    s_mov_b32 s77, 4096
    v_mfma_f32_16x16x32_bf16 v[144:147], a[64:67], a[36:39], v[144:147]
    buffer_load_dwordx4 v1, s[28:31], s77 offen sc1 lds
    v_mfma_f32_16x16x32_bf16 v[160:163], a[64:67], a[40:43], v[160:163]
    ds_read_b128 a[0:3], v8 offset:0
    v_mfma_f32_16x16x32_bf16 v[176:179], a[64:67], a[44:47], v[176:179]
    v_mfma_f32_16x16x32_bf16 v[192:195], a[64:67], a[48:51], v[192:195]
    v_mfma_f32_16x16x32_bf16 v[208:211], a[64:67], a[52:55], v[208:211]
    v_mfma_f32_16x16x32_bf16 v[224:227], a[64:67], a[56:59], v[224:227]
    ds_read_b128 a[4:7], v8 offset:2048
    v_mfma_f32_16x16x32_bf16 v[240:243], a[64:67], a[60:63], v[240:243]
    ds_read_b64_tr_b16 a[64:65], v12 offset:0
    v_mfma_f32_16x16x32_bf16 v[132:135], a[68:71], a[32:35], v[132:135]
    ds_read_b64_tr_b16 a[66:67], v12 offset:256
    s_mov_b32 s77, 19456
    v_mfma_f32_16x16x32_bf16 v[148:151], a[68:71], a[36:39], v[148:151]
    buffer_load_dwordx4 v1, s[28:31], s77 offen offset:1024 sc1 lds
    v_add_u32 v1, 128, v1
    v_mfma_f32_16x16x32_bf16 v[164:167], a[68:71], a[40:43], v[164:167]
    ds_read_b128 a[8:11], v8 offset:4096
    s_add_u32 m0, s78, 61440
    v_mfma_f32_16x16x32_bf16 v[180:183], a[68:71], a[44:47], v[180:183]
    buffer_load_dwordx4 v2, s[32:35], s68 offen offset:0 lds
    v_mfma_f32_16x16x32_bf16 v[196:199], a[68:71], a[48:51], v[196:199]
    v_mfma_f32_16x16x32_bf16 v[212:215], a[68:71], a[52:55], v[212:215]
    v_mfma_f32_16x16x32_bf16 v[228:231], a[68:71], a[56:59], v[228:231]
    ds_read_b128 a[12:15], v8 offset:6144
    v_mfma_f32_16x16x32_bf16 v[244:247], a[68:71], a[60:63], v[244:247]
    ds_read_b64_tr_b16 a[68:69], v14 offset:0
    v_mfma_f32_16x16x32_bf16 v[136:139], a[72:75], a[32:35], v[136:139]
    ds_read_b64_tr_b16 a[70:71], v14 offset:256
    v_mfma_f32_16x16x32_bf16 v[152:155], a[72:75], a[36:39], v[152:155]
    buffer_load_dwordx4 v2, s[32:35], s69 offen offset:1024 lds
    v_mfma_f32_16x16x32_bf16 v[168:171], a[72:75], a[40:43], v[168:171]
    ds_read_b128 a[16:19], v8 offset:8192
    v_mfma_f32_16x16x32_bf16 v[184:187], a[72:75], a[44:47], v[184:187]
    v_mfma_f32_16x16x32_bf16 v[200:203], a[72:75], a[48:51], v[200:203]
    v_mfma_f32_16x16x32_bf16 v[216:219], a[72:75], a[52:55], v[216:219]
    buffer_load_dwordx4 v2, s[32:35], s70 offen offset:2048 lds
    v_add_u32 v2, 196608, v2
    v_mfma_f32_16x16x32_bf16 v[232:235], a[72:75], a[56:59], v[232:235]
    ds_read_b128 a[20:23], v8 offset:10240
    v_mfma_f32_16x16x32_bf16 v[248:251], a[72:75], a[60:63], v[248:251]
    ds_read_b64_tr_b16 a[72:73], v12 offset:1024
    v_mfma_f32_16x16x32_bf16 v[140:143], a[76:79], a[32:35], v[140:143]
    ds_read_b64_tr_b16 a[74:75], v12 offset:1280
    v_mfma_f32_16x16x32_bf16 v[156:159], a[76:79], a[36:39], v[156:159]
    v_mfma_f32_16x16x32_bf16 v[172:175], a[76:79], a[40:43], v[172:175]
    ds_read_b128 a[24:27], v8 offset:12288
    v_mfma_f32_16x16x32_bf16 v[188:191], a[76:79], a[44:47], v[188:191]
    buffer_load_dwordx4 v3, s[36:39], s71 offen offset:3072 lds
    v_mfma_f32_16x16x32_bf16 v[204:207], a[76:79], a[48:51], v[204:207]
    v_mfma_f32_16x16x32_bf16 v[220:223], a[76:79], a[52:55], v[220:223]
    v_mfma_f32_16x16x32_bf16 v[236:239], a[76:79], a[56:59], v[236:239]
    ds_read_b128 a[28:31], v8 offset:14336
    v_mfma_f32_16x16x32_bf16 v[252:255], a[76:79], a[60:63], v[252:255]
    ds_read_b64_tr_b16 a[76:77], v14 offset:1024
    v_mfma_f32_16x16x32_bf16 a[128:131], a[80:83], a[32:35], a[128:131]
    ds_read_b64_tr_b16 a[78:79], v14 offset:1280
    s_add_u32 m0, s78, 65536
    v_mfma_f32_16x16x32_bf16 a[144:147], a[80:83], a[36:39], a[144:147]
    buffer_load_dwordx4 v3, s[40:43], s72 offen offset:0 lds
    v_mfma_f32_16x16x32_bf16 a[160:163], a[80:83], a[40:43], a[160:163]
    ds_read_b64_tr_b16 a[96:97], v12 offset:4096
    v_mfma_f32_16x16x32_bf16 a[176:179], a[80:83], a[44:47], a[176:179]
    v_mfma_f32_16x16x32_bf16 a[192:195], a[80:83], a[48:51], a[192:195]
    v_mfma_f32_16x16x32_bf16 a[208:211], a[80:83], a[52:55], a[208:211]
    buffer_load_dwordx4 v3, s[36:39], s73 offen offset:1024 lds
    v_mfma_f32_16x16x32_bf16 a[224:227], a[80:83], a[56:59], a[224:227]
    ds_read_b64_tr_b16 a[98:99], v12 offset:4352
    v_mfma_f32_16x16x32_bf16 a[240:243], a[80:83], a[60:63], a[240:243]
    ds_read_b64_tr_b16 a[80:81], v12 offset:2048
    v_mfma_f32_16x16x32_bf16 a[132:135], a[84:87], a[32:35], a[132:135]
    ds_read_b64_tr_b16 a[82:83], v12 offset:2304
    v_mfma_f32_16x16x32_bf16 a[148:151], a[84:87], a[36:39], a[148:151]
    v_mfma_f32_16x16x32_bf16 a[164:167], a[84:87], a[40:43], a[164:167]
    ds_read_b64_tr_b16 a[100:101], v14 offset:4096
    v_mfma_f32_16x16x32_bf16 a[180:183], a[84:87], a[44:47], a[180:183]
    buffer_load_dwordx4 v3, s[40:43], s74 offen offset:2048 lds
    v_mfma_f32_16x16x32_bf16 a[196:199], a[84:87], a[48:51], a[196:199]
    v_mfma_f32_16x16x32_bf16 a[212:215], a[84:87], a[52:55], a[212:215]
    v_mfma_f32_16x16x32_bf16 a[228:231], a[84:87], a[56:59], a[228:231]
    ds_read_b64_tr_b16 a[102:103], v14 offset:4352
    v_mfma_f32_16x16x32_bf16 a[244:247], a[84:87], a[60:63], a[244:247]
    ds_read_b64_tr_b16 a[84:85], v14 offset:2048
    v_mfma_f32_16x16x32_bf16 a[136:139], a[88:91], a[32:35], a[136:139]
    ds_read_b64_tr_b16 a[86:87], v14 offset:2304
    v_mfma_f32_16x16x32_bf16 a[152:155], a[88:91], a[36:39], a[152:155]
    buffer_load_dwordx4 v3, s[36:39], s75 offen offset:3072 lds
    v_mfma_f32_16x16x32_bf16 a[168:171], a[88:91], a[40:43], a[168:171]
    v_mfma_f32_16x16x32_bf16 a[184:187], a[88:91], a[44:47], a[184:187]
    s_add_u32 m0, s78, 69632
    v_mfma_f32_16x16x32_bf16 a[200:203], a[88:91], a[48:51], a[200:203]
    buffer_load_dwordx4 v3, s[40:43], s76 offen offset:0 lds
    v_add_u32 v3, 229376, v3
    v_mfma_f32_16x16x32_bf16 a[216:219], a[88:91], a[52:55], a[216:219]
    v_mfma_f32_16x16x32_bf16 a[232:235], a[88:91], a[56:59], a[232:235]
    v_mfma_f32_16x16x32_bf16 a[248:251], a[88:91], a[60:63], a[248:251]
    ds_read_b64_tr_b16 a[88:89], v12 offset:3072
    v_mfma_f32_16x16x32_bf16 a[140:143], a[92:95], a[32:35], a[140:143]
    ds_read_b64_tr_b16 a[90:91], v12 offset:3328
    v_mfma_f32_16x16x32_bf16 a[156:159], a[92:95], a[36:39], a[156:159]
    global_load_lds_dwordx4 v[4:5], off offset:1024
    v_lshl_add_u64 v[4:5], v[4:5], 0, s[80:81]
    v_mfma_f32_16x16x32_bf16 a[172:175], a[92:95], a[40:43], a[172:175]
    v_mfma_f32_16x16x32_bf16 a[188:191], a[92:95], a[44:47], a[188:191]
    v_mfma_f32_16x16x32_bf16 a[204:207], a[92:95], a[48:51], a[204:207]
    v_mfma_f32_16x16x32_bf16 a[220:223], a[92:95], a[52:55], a[220:223]
    v_mfma_f32_16x16x32_bf16 a[236:239], a[92:95], a[56:59], a[236:239]
    v_mfma_f32_16x16x32_bf16 a[252:255], a[92:95], a[60:63], a[252:255]
    ds_read_b64_tr_b16 a[92:93], v14 offset:3072
    v_mfma_f32_16x16x32_bf16 v[48:51], a[104:107], a[32:35], v[48:51]
    ds_read_b64_tr_b16 a[94:95], v14 offset:3328
    v_mfma_f32_16x16x32_bf16 v[52:55], a[104:107], a[36:39], v[52:55]
    v_mfma_f32_16x16x32_bf16 v[64:67], a[104:107], a[40:43], v[64:67]
    v_mfma_f32_16x16x32_bf16 v[68:71], a[104:107], a[44:47], v[68:71]
    v_mfma_f32_16x16x32_bf16 v[80:83], a[104:107], a[48:51], v[80:83]
    v_mfma_f32_16x16x32_bf16 v[84:87], a[104:107], a[52:55], v[84:87]
    v_mfma_f32_16x16x32_bf16 v[96:99], a[104:107], a[56:59], v[96:99]
    v_mfma_f32_16x16x32_bf16 v[100:103], a[104:107], a[60:63], v[100:103]
    v_mfma_f32_16x16x32_bf16 v[56:59], a[108:111], a[32:35], v[56:59]
    v_mfma_f32_16x16x32_bf16 v[60:63], a[108:111], a[36:39], v[60:63]
    v_mfma_f32_16x16x32_bf16 v[72:75], a[108:111], a[40:43], v[72:75]
    v_mfma_f32_16x16x32_bf16 v[76:79], a[108:111], a[44:47], v[76:79]
    v_mfma_f32_16x16x32_bf16 v[88:91], a[108:111], a[48:51], v[88:91]
    v_mfma_f32_16x16x32_bf16 v[92:95], a[108:111], a[52:55], v[92:95]
    v_mfma_f32_16x16x32_bf16 v[104:107], a[108:111], a[56:59], v[104:107]
    v_mfma_f32_16x16x32_bf16 v[108:111], a[108:111], a[60:63], v[108:111]
    s_sub_u32 s67, s67, 1
    s_cmp_lg_u32 s67, 0
    s_cbranch_scc1 L_loop1
L_tail1:
    s_waitcnt vmcnt(24) lgkmcnt(0)
    s_barrier
    v_mfma_f32_16x16x32_bf16 v[128:131], a[64:67], a[0:3], v[128:131]
    s_getpc_b64 s[86:87]
L_pc1:
    s_sub_u32 s86, s86, L_pc1-L_tail0
    s_subb_u32 s87, s87, 0
    s_lshr_b32 s82, s2, 3
    s_lshl_b32 s82, s82, 2
    s_add_u32 s82, s82, s60
    s_lshl_b32 s82, s82, 10
    v_add_u32 v34, s82, v16
    v_min_u32 v34, L_code_end-L_tail0-4, v34
    global_load_dword v7, v34, s[86:87]
    v_mfma_f32_16x16x32_bf16 v[144:147], a[64:67], a[4:7], v[144:147]
    v_mfma_f32_16x16x32_bf16 v[160:163], a[64:67], a[8:11], v[160:163]
    ds_read_b128 a[32:35], v9 offset:0
    s_and_b32 s82, s2, 7
    s_lshl_b32 s82, s82, 5
    s_lshr_b32 s83, s2, 3
    s_add_u32 s82, s82, s83
    s_mul_i32 s82, s82, 28672
    s_mul_i32 s83, s60, 28
    s_add_u32 s83, s83, 112
    v_min_u32 v34, 27, v0
    v_add_u32 v34, s83, v34
    v_min_u32 v34, 223, v34
    v_lshlrev_b32 v34, 7, v34
    v_add_u32 v34, s82, v34
    global_load_dword v7, v34, s[20:21]
    v_mfma_f32_16x16x32_bf16 v[176:179], a[64:67], a[12:15], v[176:179]
    v_mfma_f32_16x16x32_bf16 v[192:195], a[64:67], a[16:19], v[192:195]
    v_mfma_f32_16x16x32_bf16 v[208:211], a[64:67], a[20:23], v[208:211]
    v_mfma_f32_16x16x32_bf16 v[224:227], a[64:67], a[24:27], v[224:227]
    ds_read_b128 a[36:39], v9 offset:2048
    v_mfma_f32_16x16x32_bf16 v[240:243], a[64:67], a[28:31], v[240:243]
    ds_read_b64_tr_b16 a[64:65], v12 offset:20480
    v_mfma_f32_16x16x32_bf16 v[132:135], a[68:71], a[0:3], v[132:135]
    ds_read_b64_tr_b16 a[66:67], v12 offset:20736
    v_mfma_f32_16x16x32_bf16 v[148:151], a[68:71], a[4:7], v[148:151]
    v_mfma_f32_16x16x32_bf16 v[164:167], a[68:71], a[8:11], v[164:167]
    ds_read_b128 a[40:43], v9 offset:4096
    v_mfma_f32_16x16x32_bf16 v[180:183], a[68:71], a[12:15], v[180:183]
    v_mfma_f32_16x16x32_bf16 v[196:199], a[68:71], a[16:19], v[196:199]
    v_mfma_f32_16x16x32_bf16 v[212:215], a[68:71], a[20:23], v[212:215]
    v_mfma_f32_16x16x32_bf16 v[228:231], a[68:71], a[24:27], v[228:231]
    ds_read_b128 a[44:47], v9 offset:6144
    v_mfma_f32_16x16x32_bf16 v[244:247], a[68:71], a[28:31], v[244:247]
    ds_read_b64_tr_b16 a[68:69], v14 offset:20480
    v_mfma_f32_16x16x32_bf16 v[136:139], a[72:75], a[0:3], v[136:139]
    ds_read_b64_tr_b16 a[70:71], v14 offset:20736
    v_mfma_f32_16x16x32_bf16 v[152:155], a[72:75], a[4:7], v[152:155]
    v_mfma_f32_16x16x32_bf16 v[168:171], a[72:75], a[8:11], v[168:171]
    ds_read_b128 a[48:51], v9 offset:8192
    v_mfma_f32_16x16x32_bf16 v[184:187], a[72:75], a[12:15], v[184:187]
    v_mfma_f32_16x16x32_bf16 v[200:203], a[72:75], a[16:19], v[200:203]
    v_mfma_f32_16x16x32_bf16 v[216:219], a[72:75], a[20:23], v[216:219]
    v_mfma_f32_16x16x32_bf16 v[232:235], a[72:75], a[24:27], v[232:235]
    ds_read_b128 a[52:55], v9 offset:10240
    v_mfma_f32_16x16x32_bf16 v[248:251], a[72:75], a[28:31], v[248:251]
    ds_read_b64_tr_b16 a[72:73], v12 offset:21504
    v_mfma_f32_16x16x32_bf16 v[140:143], a[76:79], a[0:3], v[140:143]
    ds_read_b64_tr_b16 a[74:75], v12 offset:21760
    v_mfma_f32_16x16x32_bf16 v[156:159], a[76:79], a[4:7], v[156:159]
    v_mfma_f32_16x16x32_bf16 v[172:175], a[76:79], a[8:11], v[172:175]
    ds_read_b128 a[56:59], v9 offset:12288
    v_mfma_f32_16x16x32_bf16 v[188:191], a[76:79], a[12:15], v[188:191]
    v_mfma_f32_16x16x32_bf16 v[204:207], a[76:79], a[16:19], v[204:207]
    v_mfma_f32_16x16x32_bf16 v[220:223], a[76:79], a[20:23], v[220:223]
    v_mfma_f32_16x16x32_bf16 v[236:239], a[76:79], a[24:27], v[236:239]
    ds_read_b128 a[60:63], v9 offset:14336
    v_mfma_f32_16x16x32_bf16 v[252:255], a[76:79], a[28:31], v[252:255]
    ds_read_b64_tr_b16 a[76:77], v14 offset:21504
    v_mfma_f32_16x16x32_bf16 a[128:131], a[80:83], a[0:3], a[128:131]
    ds_read_b64_tr_b16 a[78:79], v14 offset:21760
    v_mfma_f32_16x16x32_bf16 a[144:147], a[80:83], a[4:7], a[144:147]
    v_mfma_f32_16x16x32_bf16 a[160:163], a[80:83], a[8:11], a[160:163]
    ds_read_b64_tr_b16 a[104:105], v12 offset:24576
    v_mfma_f32_16x16x32_bf16 a[176:179], a[80:83], a[12:15], a[176:179]
    v_mfma_f32_16x16x32_bf16 a[192:195], a[80:83], a[16:19], a[192:195]
    v_mfma_f32_16x16x32_bf16 a[208:211], a[80:83], a[20:23], a[208:211]
    v_mfma_f32_16x16x32_bf16 a[224:227], a[80:83], a[24:27], a[224:227]
    ds_read_b64_tr_b16 a[106:107], v12 offset:24832
    v_mfma_f32_16x16x32_bf16 a[240:243], a[80:83], a[28:31], a[240:243]
    ds_read_b64_tr_b16 a[80:81], v12 offset:22528
    v_mfma_f32_16x16x32_bf16 a[132:135], a[84:87], a[0:3], a[132:135]
    ds_read_b64_tr_b16 a[82:83], v12 offset:22784
    v_mfma_f32_16x16x32_bf16 a[148:151], a[84:87], a[4:7], a[148:151]
    v_mfma_f32_16x16x32_bf16 a[164:167], a[84:87], a[8:11], a[164:167]
    ds_read_b64_tr_b16 a[108:109], v14 offset:24576
    v_mfma_f32_16x16x32_bf16 a[180:183], a[84:87], a[12:15], a[180:183]
    v_mfma_f32_16x16x32_bf16 a[196:199], a[84:87], a[16:19], a[196:199]
    v_mfma_f32_16x16x32_bf16 a[212:215], a[84:87], a[20:23], a[212:215]
    v_mfma_f32_16x16x32_bf16 a[228:231], a[84:87], a[24:27], a[228:231]
    ds_read_b64_tr_b16 a[110:111], v14 offset:24832
    v_mfma_f32_16x16x32_bf16 a[244:247], a[84:87], a[28:31], a[244:247]
    ds_read_b64_tr_b16 a[84:85], v14 offset:22528
    v_mfma_f32_16x16x32_bf16 a[136:139], a[88:91], a[0:3], a[136:139]
    ds_read_b64_tr_b16 a[86:87], v14 offset:22784
    v_mfma_f32_16x16x32_bf16 a[152:155], a[88:91], a[4:7], a[152:155]
    v_mfma_f32_16x16x32_bf16 a[168:171], a[88:91], a[8:11], a[168:171]
    v_mfma_f32_16x16x32_bf16 a[184:187], a[88:91], a[12:15], a[184:187]
    v_mfma_f32_16x16x32_bf16 a[200:203], a[88:91], a[16:19], a[200:203]
    v_mfma_f32_16x16x32_bf16 a[216:219], a[88:91], a[20:23], a[216:219]
    v_mfma_f32_16x16x32_bf16 a[232:235], a[88:91], a[24:27], a[232:235]
    v_mfma_f32_16x16x32_bf16 a[248:251], a[88:91], a[28:31], a[248:251]
    ds_read_b64_tr_b16 a[88:89], v12 offset:23552
    v_mfma_f32_16x16x32_bf16 a[140:143], a[92:95], a[0:3], a[140:143]
    ds_read_b64_tr_b16 a[90:91], v12 offset:23808
    v_mfma_f32_16x16x32_bf16 a[156:159], a[92:95], a[4:7], a[156:159]
    v_mfma_f32_16x16x32_bf16 a[172:175], a[92:95], a[8:11], a[172:175]
    v_mfma_f32_16x16x32_bf16 a[188:191], a[92:95], a[12:15], a[188:191]
    v_mfma_f32_16x16x32_bf16 a[204:207], a[92:95], a[16:19], a[204:207]
    v_mfma_f32_16x16x32_bf16 a[220:223], a[92:95], a[20:23], a[220:223]
    v_mfma_f32_16x16x32_bf16 a[236:239], a[92:95], a[24:27], a[236:239]
    v_mfma_f32_16x16x32_bf16 a[252:255], a[92:95], a[28:31], a[252:255]
    ds_read_b64_tr_b16 a[92:93], v14 offset:23552
    v_mfma_f32_16x16x32_bf16 v[48:51], a[96:99], a[0:3], v[48:51]
    ds_read_b64_tr_b16 a[94:95], v14 offset:23808
    v_mfma_f32_16x16x32_bf16 v[52:55], a[96:99], a[4:7], v[52:55]
    v_mfma_f32_16x16x32_bf16 v[64:67], a[96:99], a[8:11], v[64:67]
    v_mfma_f32_16x16x32_bf16 v[68:71], a[96:99], a[12:15], v[68:71]
    v_mfma_f32_16x16x32_bf16 v[80:83], a[96:99], a[16:19], v[80:83]
    v_mfma_f32_16x16x32_bf16 v[84:87], a[96:99], a[20:23], v[84:87]
    v_mfma_f32_16x16x32_bf16 v[96:99], a[96:99], a[24:27], v[96:99]
    v_mfma_f32_16x16x32_bf16 v[100:103], a[96:99], a[28:31], v[100:103]
    v_mfma_f32_16x16x32_bf16 v[56:59], a[100:103], a[0:3], v[56:59]
    v_mfma_f32_16x16x32_bf16 v[60:63], a[100:103], a[4:7], v[60:63]
    v_mfma_f32_16x16x32_bf16 v[72:75], a[100:103], a[8:11], v[72:75]
    v_mfma_f32_16x16x32_bf16 v[76:79], a[100:103], a[12:15], v[76:79]
    v_mfma_f32_16x16x32_bf16 v[88:91], a[100:103], a[16:19], v[88:91]
    v_mfma_f32_16x16x32_bf16 v[92:95], a[100:103], a[20:23], v[92:95]
    v_mfma_f32_16x16x32_bf16 v[104:107], a[100:103], a[24:27], v[104:107]
    v_mfma_f32_16x16x32_bf16 v[108:111], a[100:103], a[28:31], v[108:111]
    s_waitcnt vmcnt(12) lgkmcnt(0)
    s_barrier
    v_mfma_f32_16x16x32_bf16 v[128:131], a[64:67], a[32:35], v[128:131]
    v_mfma_f32_16x16x32_bf16 v[144:147], a[64:67], a[36:39], v[144:147]
    v_mfma_f32_16x16x32_bf16 v[160:163], a[64:67], a[40:43], v[160:163]
    ds_read_b128 a[0:3], v8 offset:34816
    v_mfma_f32_16x16x32_bf16 v[176:179], a[64:67], a[44:47], v[176:179]
    v_mfma_f32_16x16x32_bf16 v[192:195], a[64:67], a[48:51], v[192:195]
    s_mul_i32 s82, s65, 1835008
    v_mfma_f32_16x16x32_bf16 v[208:211], a[64:67], a[52:55], v[208:211]
    s_lshl_b32 s83, s66, 8
    v_mfma_f32_16x16x32_bf16 v[224:227], a[64:67], a[56:59], v[224:227]
    ds_read_b128 a[4:7], v8 offset:36864
    s_add_u32 s82, s82, s83
    v_mfma_f32_16x16x32_bf16 v[240:243], a[64:67], a[60:63], v[240:243]
    ds_read_b64_tr_b16 a[64:65], v13 offset:0
    s_add_u32 s48, s20, s82
    v_mfma_f32_16x16x32_bf16 v[132:135], a[68:71], a[32:35], v[132:135]
    ds_read_b64_tr_b16 a[66:67], v13 offset:256
    s_addc_u32 s49, s21, 0
    v_mfma_f32_16x16x32_bf16 v[148:151], a[68:71], a[36:39], v[148:151]
    s_and_b32 s49, s49, 0xffff
    v_mfma_f32_16x16x32_bf16 v[164:167], a[68:71], a[40:43], v[164:167]
    ds_read_b128 a[8:11], v8 offset:38912
    s_sub_u32 s50, 7340032, s82
    v_mfma_f32_16x16x32_bf16 v[180:183], a[68:71], a[44:47], v[180:183]
    s_mov_b32 s51, 0x20000
    v_mfma_f32_16x16x32_bf16 v[196:199], a[68:71], a[48:51], v[196:199]
    s_add_u32 s52, s12, s83
    v_mfma_f32_16x16x32_bf16 v[212:215], a[68:71], a[52:55], v[212:215]
    s_addc_u32 s53, s13, 0
    v_mfma_f32_16x16x32_bf16 v[228:231], a[68:71], a[56:59], v[228:231]
    ds_read_b128 a[12:15], v8 offset:40960
    s_and_b32 s53, s53, 0xffff
    v_mfma_f32_16x16x32_bf16 v[244:247], a[68:71], a[60:63], v[244:247]
    ds_read_b64_tr_b16 a[68:69], v15 offset:0
    s_sub_u32 s54, 2097152, s83
    v_mfma_f32_16x16x32_bf16 v[136:139], a[72:75], a[32:35], v[136:139]
    ds_read_b64_tr_b16 a[70:71], v15 offset:256
    s_mov_b32 s55, 0x20000
    v_mfma_f32_16x16x32_bf16 v[152:155], a[72:75], a[36:39], v[152:155]
    s_lshl_b32 s3, s60, 11
    v_mfma_f32_16x16x32_bf16 v[168:171], a[72:75], a[40:43], v[168:171]
    ds_read_b128 a[16:19], v8 offset:43008
    v_lshrrev_b32 v34, 4, v0
    v_mfma_f32_16x16x32_bf16 v[184:187], a[72:75], a[44:47], v[184:187]
    v_and_b32 v35, 15, v0
    v_mfma_f32_16x16x32_bf16 v[200:203], a[72:75], a[48:51], v[200:203]
    v_lshlrev_b32 v36, 1, v34
    v_mfma_f32_16x16x32_bf16 v[216:219], a[72:75], a[52:55], v[216:219]
    v_add_u32 v36, 0, v36
    v_mfma_f32_16x16x32_bf16 v[232:235], a[72:75], a[56:59], v[232:235]
    ds_read_b128 a[20:23], v8 offset:45056
    v_xor_b32 v36, v36, v35
    v_mfma_f32_16x16x32_bf16 v[248:251], a[72:75], a[60:63], v[248:251]
    ds_read_b64_tr_b16 a[72:73], v13 offset:1024
    v_lshlrev_b32 v36, 4, v36
    v_mfma_f32_16x16x32_bf16 v[140:143], a[76:79], a[32:35], v[140:143]
    ds_read_b64_tr_b16 a[74:75], v13 offset:1280
    v_lshl_add_u32 v36, v34, 11, v36
    v_mfma_f32_16x16x32_bf16 v[156:159], a[76:79], a[36:39], v[156:159]
    s_lshl_b32 s82, s60, 14
    v_mfma_f32_16x16x32_bf16 v[172:175], a[76:79], a[40:43], v[172:175]
    ds_read_b128 a[24:27], v8 offset:47104
    s_add_u32 s82, s82, 0
    v_mfma_f32_16x16x32_bf16 v[188:191], a[76:79], a[44:47], v[188:191]
    v_add_u32 v17, s82, v36
    v_mfma_f32_16x16x32_bf16 v[204:207], a[76:79], a[48:51], v[204:207]
    s_lshl_b32 s82, s62, 1
    v_mfma_f32_16x16x32_bf16 v[220:223], a[76:79], a[52:55], v[220:223]
    s_add_u32 s82, s82, 0
    v_mfma_f32_16x16x32_bf16 v[236:239], a[76:79], a[56:59], v[236:239]
    ds_read_b128 a[28:31], v8 offset:49152
    s_lshl_b32 s82, s82, 3
    v_mfma_f32_16x16x32_bf16 v[252:255], a[76:79], a[60:63], v[252:255]
    ds_read_b64_tr_b16 a[76:77], v15 offset:1024
    s_lshl_b32 s83, s61, 2
    v_mfma_f32_16x16x32_bf16 a[128:131], a[80:83], a[32:35], a[128:131]
    ds_read_b64_tr_b16 a[78:79], v15 offset:1280
    s_add_u32 s82, s82, s83
    v_mfma_f32_16x16x32_bf16 a[144:147], a[80:83], a[36:39], a[144:147]
    s_mul_i32 s83, s62, 96
    v_mfma_f32_16x16x32_bf16 a[160:163], a[80:83], a[40:43], a[160:163]
    ds_read_b64_tr_b16 a[96:97], v13 offset:4096
    s_add_u32 s82, s82, s83
    v_mfma_f32_16x16x32_bf16 a[176:179], a[80:83], a[44:47], a[176:179]
    s_lshl_b32 s82, s82, 11
    v_mfma_f32_16x16x32_bf16 a[192:195], a[80:83], a[48:51], a[192:195]
    s_sub_u32 s82, s82, 0
    v_mfma_f32_16x16x32_bf16 a[208:211], a[80:83], a[52:55], a[208:211]
    v_add_u32 v19, s82, v36
    v_mfma_f32_16x16x32_bf16 a[224:227], a[80:83], a[56:59], a[224:227]
    ds_read_b64_tr_b16 a[98:99], v13 offset:4352
    v_lshlrev_b32 v36, 1, v34
    v_mfma_f32_16x16x32_bf16 a[240:243], a[80:83], a[60:63], a[240:243]
    ds_read_b64_tr_b16 a[80:81], v13 offset:2048
    v_add_u32 v36, 8, v36
    v_mfma_f32_16x16x32_bf16 a[132:135], a[84:87], a[32:35], a[132:135]
    ds_read_b64_tr_b16 a[82:83], v13 offset:2304
    v_xor_b32 v36, v36, v35
    v_mfma_f32_16x16x32_bf16 a[148:151], a[84:87], a[36:39], a[148:151]
    v_lshlrev_b32 v36, 4, v36
    v_mfma_f32_16x16x32_bf16 a[164:167], a[84:87], a[40:43], a[164:167]
    ds_read_b64_tr_b16 a[100:101], v15 offset:4096
    v_lshl_add_u32 v36, v34, 11, v36
    v_mfma_f32_16x16x32_bf16 a[180:183], a[84:87], a[44:47], a[180:183]
    s_lshl_b32 s82, s60, 14
    v_mfma_f32_16x16x32_bf16 a[196:199], a[84:87], a[48:51], a[196:199]
    s_add_u32 s82, s82, 7168
    v_mfma_f32_16x16x32_bf16 a[212:215], a[84:87], a[52:55], a[212:215]
    v_add_u32 v18, s82, v36
    v_mfma_f32_16x16x32_bf16 a[228:231], a[84:87], a[56:59], a[228:231]
    ds_read_b64_tr_b16 a[102:103], v15 offset:4352
    s_lshl_b32 s82, s62, 1
    v_mfma_f32_16x16x32_bf16 a[244:247], a[84:87], a[60:63], a[244:247]
    ds_read_b64_tr_b16 a[84:85], v15 offset:2048
    s_add_u32 s82, s82, 1
    v_mfma_f32_16x16x32_bf16 a[136:139], a[88:91], a[32:35], a[136:139]
    ds_read_b64_tr_b16 a[86:87], v15 offset:2304
    s_lshl_b32 s82, s82, 3
    v_mfma_f32_16x16x32_bf16 a[152:155], a[88:91], a[36:39], a[152:155]
    s_lshl_b32 s83, s61, 2
    v_mfma_f32_16x16x32_bf16 a[168:171], a[88:91], a[40:43], a[168:171]
    s_add_u32 s82, s82, s83
    v_mfma_f32_16x16x32_bf16 a[184:187], a[88:91], a[44:47], a[184:187]
    s_mul_i32 s83, s62, 96
    v_mfma_f32_16x16x32_bf16 a[200:203], a[88:91], a[48:51], a[200:203]
    s_add_u32 s82, s82, s83
    v_mfma_f32_16x16x32_bf16 a[216:219], a[88:91], a[52:55], a[216:219]
    s_lshl_b32 s82, s82, 11
    v_mfma_f32_16x16x32_bf16 a[232:235], a[88:91], a[56:59], a[232:235]
    s_sub_u32 s82, s82, 1024
    v_mfma_f32_16x16x32_bf16 a[248:251], a[88:91], a[60:63], a[248:251]
    ds_read_b64_tr_b16 a[88:89], v13 offset:3072
    v_add_u32 v20, s82, v36
    v_mfma_f32_16x16x32_bf16 a[140:143], a[92:95], a[32:35], a[140:143]
    ds_read_b64_tr_b16 a[90:91], v13 offset:3328
    s_xor_b32 s82, s65, 0
    v_mfma_f32_16x16x32_bf16 a[156:159], a[92:95], a[36:39], a[156:159]
    s_lshl_b32 s82, s82, 10
    v_mfma_f32_16x16x32_bf16 a[172:175], a[92:95], a[40:43], a[172:175]
    v_add_u32 v21, s82, v16
    v_mfma_f32_16x16x32_bf16 a[188:191], a[92:95], a[44:47], a[188:191]
    s_xor_b32 s82, s65, 1
    v_mfma_f32_16x16x32_bf16 a[204:207], a[92:95], a[48:51], a[204:207]
    s_lshl_b32 s82, s82, 10
    v_mfma_f32_16x16x32_bf16 a[220:223], a[92:95], a[52:55], a[220:223]
    v_add_u32 v22, s82, v16
    v_mfma_f32_16x16x32_bf16 a[236:239], a[92:95], a[56:59], a[236:239]
    s_xor_b32 s82, s65, 2
    v_mfma_f32_16x16x32_bf16 a[252:255], a[92:95], a[60:63], a[252:255]
    ds_read_b64_tr_b16 a[92:93], v15 offset:3072
    s_lshl_b32 s82, s82, 10
    v_mfma_f32_16x16x32_bf16 v[48:51], a[104:107], a[32:35], v[48:51]
    ds_read_b64_tr_b16 a[94:95], v15 offset:3328
    v_add_u32 v23, s82, v16
    v_mfma_f32_16x16x32_bf16 v[52:55], a[104:107], a[36:39], v[52:55]
    s_xor_b32 s82, s65, 3
    v_mfma_f32_16x16x32_bf16 v[64:67], a[104:107], a[40:43], v[64:67]
    s_lshl_b32 s82, s82, 10
    v_mfma_f32_16x16x32_bf16 v[68:71], a[104:107], a[44:47], v[68:71]
    v_add_u32 v24, s82, v16
    v_mfma_f32_16x16x32_bf16 v[80:83], a[104:107], a[48:51], v[80:83]
    s_mov_b32 s94, 0xbdd2d3e8
    v_mfma_f32_16x16x32_bf16 v[84:87], a[104:107], a[52:55], v[84:87]
    v_mfma_f32_16x16x32_bf16 v[96:99], a[104:107], a[56:59], v[96:99]
    v_mfma_f32_16x16x32_bf16 v[100:103], a[104:107], a[60:63], v[100:103]
    v_mfma_f32_16x16x32_bf16 v[56:59], a[108:111], a[32:35], v[56:59]
    v_mfma_f32_16x16x32_bf16 v[60:63], a[108:111], a[36:39], v[60:63]
    v_mfma_f32_16x16x32_bf16 v[72:75], a[108:111], a[40:43], v[72:75]
    v_mfma_f32_16x16x32_bf16 v[76:79], a[108:111], a[44:47], v[76:79]
    v_mfma_f32_16x16x32_bf16 v[88:91], a[108:111], a[48:51], v[88:91]
    v_mfma_f32_16x16x32_bf16 v[92:95], a[108:111], a[52:55], v[92:95]
    v_mfma_f32_16x16x32_bf16 v[104:107], a[108:111], a[56:59], v[104:107]
    v_mfma_f32_16x16x32_bf16 v[108:111], a[108:111], a[60:63], v[108:111]
    s_waitcnt vmcnt(2) lgkmcnt(0)
    s_barrier
    v_mfma_f32_16x16x32_bf16 v[128:131], a[64:67], a[0:3], v[128:131]
    v_mfma_f32_16x16x32_bf16 v[144:147], a[64:67], a[4:7], v[144:147]
    v_mfma_f32_16x16x32_bf16 v[160:163], a[64:67], a[8:11], v[160:163]
    ds_read_b128 a[32:35], v9 offset:34816
    v_mfma_f32_16x16x32_bf16 v[176:179], a[64:67], a[12:15], v[176:179]
    v_mfma_f32_16x16x32_bf16 v[192:195], a[64:67], a[16:19], v[192:195]
    s_mov_b32 s95, 0xbdd2d3e8
    v_mfma_f32_16x16x32_bf16 v[208:211], a[64:67], a[20:23], v[208:211]
    v_mov_b32 v26, 0xc0135761
    v_mfma_f32_16x16x32_bf16 v[224:227], a[64:67], a[24:27], v[224:227]
    ds_read_b128 a[36:39], v9 offset:36864
    v_mov_b32 v27, 0xc0135761
    v_mfma_f32_16x16x32_bf16 v[240:243], a[64:67], a[28:31], v[240:243]
    ds_read_b64_tr_b16 a[64:65], v13 offset:20480
    v_mov_b32 v25, 1
    s_branch L_over3
L_stub3:
    s_branch L_stub4
L_over3:
    v_mfma_f32_16x16x32_bf16 v[132:135], a[68:71], a[0:3], v[132:135]
    ds_read_b64_tr_b16 a[66:67], v13 offset:20736
    s_lshl_b32 s82, s60, 12
    v_mfma_f32_16x16x32_bf16 v[148:151], a[68:71], a[4:7], v[148:151]
    s_add_u32 s68, s88, s82
    v_mfma_f32_16x16x32_bf16 v[164:167], a[68:71], a[8:11], v[164:167]
    ds_read_b128 a[40:43], v9 offset:38912
    s_lshl_b32 s82, s61, 13
    v_mfma_f32_16x16x32_bf16 v[180:183], a[68:71], a[12:15], v[180:183]
    s_add_u32 s88, s88, s82
    v_mfma_f32_16x16x32_bf16 v[196:199], a[68:71], a[16:19], v[196:199]
    s_lshr_b32 s82, s66, 1
    v_mfma_f32_16x16x32_bf16 v[212:215], a[68:71], a[20:23], v[212:215]
    s_add_u32 s82, s82, 24
    v_mfma_f32_16x16x32_bf16 v[228:231], a[68:71], a[24:27], v[228:231]
    ds_read_b128 a[44:47], v9 offset:40960
    s_lshl_b32 s82, s82, 14
    v_mfma_f32_16x16x32_bf16 v[244:247], a[68:71], a[28:31], v[244:247]
    ds_read_b64_tr_b16 a[68:69], v15 offset:20480
    s_add_u32 s90, s88, s82
    v_mfma_f32_16x16x32_bf16 v[136:139], a[72:75], a[0:3], v[136:139]
    ds_read_b64_tr_b16 a[70:71], v15 offset:20736
    s_lshl_b32 s82, s66, 14
    v_mfma_f32_16x16x32_bf16 v[152:155], a[72:75], a[4:7], v[152:155]
    s_add_u32 s88, s88, s82
    v_mfma_f32_16x16x32_bf16 v[168:171], a[72:75], a[8:11], v[168:171]
    ds_read_b128 a[48:51], v9 offset:43008
    s_add_u32 s89, s88, 262144
    v_mfma_f32_16x16x32_bf16 v[184:187], a[72:75], a[12:15], v[184:187]
    s_add_u32 s88, s88, 131072
    v_mfma_f32_16x16x32_bf16 v[200:203], a[72:75], a[16:19], v[200:203]
    s_mov_b32 s76, s93
    v_mfma_f32_16x16x32_bf16 v[216:219], a[72:75], a[20:23], v[216:219]
    s_lshl_b32 s82, s63, 4
    v_mfma_f32_16x16x32_bf16 v[232:235], a[72:75], a[24:27], v[232:235]
    ds_read_b128 a[52:55], v9 offset:45056
    s_lshl_b32 s83, s60, 2
    v_mfma_f32_16x16x32_bf16 v[248:251], a[72:75], a[28:31], v[248:251]
    ds_read_b64_tr_b16 a[72:73], v13 offset:21504
    s_add_u32 s83, s83, s82
    v_mfma_f32_16x16x32_bf16 v[140:143], a[76:79], a[0:3], v[140:143]
    ds_read_b64_tr_b16 a[74:75], v13 offset:21760
    s_add_u32 s83, s83, s65
    v_mfma_f32_16x16x32_bf16 v[156:159], a[76:79], a[4:7], v[156:159]
    s_lshl_b32 s83, s83, 15
    v_mfma_f32_16x16x32_bf16 v[172:175], a[76:79], a[8:11], v[172:175]
    ds_read_b128 a[56:59], v9 offset:47104
    s_add_u32 s69, s83, 4194304
    v_mfma_f32_16x16x32_bf16 v[188:191], a[76:79], a[12:15], v[188:191]
    s_lshl_b32 s84, s63, 3
    v_mfma_f32_16x16x32_bf16 v[204:207], a[76:79], a[16:19], v[204:207]
    s_add_u32 s84, s84, s66
    v_mfma_f32_16x16x32_bf16 v[220:223], a[76:79], a[20:23], v[220:223]
    s_lshl_b32 s85, s84, 2
    v_mfma_f32_16x16x32_bf16 v[236:239], a[76:79], a[24:27], v[236:239]
    ds_read_b128 a[60:63], v9 offset:49152
    s_add_u32 s85, s85, s60
    v_mfma_f32_16x16x32_bf16 v[252:255], a[76:79], a[28:31], v[252:255]
    ds_read_b64_tr_b16 a[76:77], v15 offset:21504
    s_lshl_b32 s85, s85, 8
    v_mfma_f32_16x16x32_bf16 a[128:131], a[80:83], a[0:3], a[128:131]
    ds_read_b64_tr_b16 a[78:79], v15 offset:21760
    s_add_u32 s77, s85, 39862272
    v_mfma_f32_16x16x32_bf16 a[144:147], a[80:83], a[4:7], a[144:147]
    s_lshl_b32 s84, s84, 18
    v_mfma_f32_16x16x32_bf16 a[160:163], a[80:83], a[8:11], a[160:163]
    ds_read_b64_tr_b16 a[104:105], v13 offset:24576
    s_lshl_b32 s85, s60, 12
    v_mfma_f32_16x16x32_bf16 a[176:179], a[80:83], a[12:15], a[176:179]
    s_add_u32 s84, s84, s85
    v_mfma_f32_16x16x32_bf16 a[192:195], a[80:83], a[16:19], a[192:195]
    s_add_u32 s84, s84, 23068672
    v_mfma_f32_16x16x32_bf16 a[208:211], a[80:83], a[20:23], a[208:211]
    s_xor_b32 s85, s65, 1
    v_mfma_f32_16x16x32_bf16 a[224:227], a[80:83], a[24:27], a[224:227]
    ds_read_b64_tr_b16 a[106:107], v13 offset:24832
    s_lshl_b32 s85, s85, 16
    v_mfma_f32_16x16x32_bf16 a[240:243], a[80:83], a[28:31], a[240:243]
    ds_read_b64_tr_b16 a[80:81], v13 offset:22528
    s_add_u32 s70, s84, s85
    v_mfma_f32_16x16x32_bf16 a[132:135], a[84:87], a[0:3], a[132:135]
    ds_read_b64_tr_b16 a[82:83], v13 offset:22784
    s_add_u32 s70, s70, 16384
    v_mfma_f32_16x16x32_bf16 a[148:151], a[84:87], a[4:7], a[148:151]
    s_lshl_b32 s85, s65, 16
    v_mfma_f32_16x16x32_bf16 a[164:167], a[84:87], a[8:11], a[164:167]
    ds_read_b64_tr_b16 a[108:109], v15 offset:24576
    s_add_u32 s73, s84, s85
    v_mfma_f32_16x16x32_bf16 a[180:183], a[84:87], a[12:15], a[180:183]
    s_add_u32 s73, s73, 16384
    v_mfma_f32_16x16x32_bf16 a[196:199], a[84:87], a[16:19], a[196:199]
    s_xor_b32 s85, s65, 2
    v_mfma_f32_16x16x32_bf16 a[212:215], a[84:87], a[20:23], a[212:215]
    s_lshl_b32 s85, s85, 16
    v_mfma_f32_16x16x32_bf16 a[228:231], a[84:87], a[24:27], a[228:231]
    ds_read_b64_tr_b16 a[110:111], v15 offset:24832
    s_add_u32 s71, s84, s85
    v_mfma_f32_16x16x32_bf16 a[244:247], a[84:87], a[28:31], a[244:247]
    ds_read_b64_tr_b16 a[84:85], v15 offset:22528
    s_add_u32 s71, s71, 32768
    v_mfma_f32_16x16x32_bf16 a[136:139], a[88:91], a[0:3], a[136:139]
    ds_read_b64_tr_b16 a[86:87], v15 offset:22784
    s_lshl_b32 s85, s65, 16
    v_mfma_f32_16x16x32_bf16 a[152:155], a[88:91], a[4:7], a[152:155]
    s_add_u32 s74, s84, s85
    v_mfma_f32_16x16x32_bf16 a[168:171], a[88:91], a[8:11], a[168:171]
    s_add_u32 s74, s74, 32768
    v_mfma_f32_16x16x32_bf16 a[184:187], a[88:91], a[12:15], a[184:187]
    s_xor_b32 s85, s65, 3
    v_mfma_f32_16x16x32_bf16 a[200:203], a[88:91], a[16:19], a[200:203]
    s_lshl_b32 s85, s85, 16
    v_mfma_f32_16x16x32_bf16 a[216:219], a[88:91], a[20:23], a[216:219]
    s_add_u32 s72, s84, s85
    v_mfma_f32_16x16x32_bf16 a[232:235], a[88:91], a[24:27], a[232:235]
    s_add_u32 s72, s72, 49152
    v_mfma_f32_16x16x32_bf16 a[248:251], a[88:91], a[28:31], a[248:251]
    ds_read_b64_tr_b16 a[88:89], v13 offset:23552
    s_lshl_b32 s85, s65, 16
    v_mfma_f32_16x16x32_bf16 a[140:143], a[92:95], a[0:3], a[140:143]
    ds_read_b64_tr_b16 a[90:91], v13 offset:23808
    s_add_u32 s75, s84, s85
    v_mfma_f32_16x16x32_bf16 a[156:159], a[92:95], a[4:7], a[156:159]
    s_add_u32 s75, s75, 49152
    v_mfma_f32_16x16x32_bf16 a[172:175], a[92:95], a[8:11], a[172:175]
    v_and_b32 v36, 1, v34
    v_mfma_f32_16x16x32_bf16 a[188:191], a[92:95], a[12:15], a[188:191]
    v_lshlrev_b32 v36, 10, v36
    v_mfma_f32_16x16x32_bf16 a[204:207], a[92:95], a[16:19], a[204:207]
    v_lshrrev_b32 v34, 1, v34
    v_mfma_f32_16x16x32_bf16 a[220:223], a[92:95], a[20:23], a[220:223]
    v_lshl_add_u32 v36, v34, 8, v36
    v_mfma_f32_16x16x32_bf16 a[236:239], a[92:95], a[24:27], a[236:239]
    v_lshl_add_u32 v36, v35, 4, v36
    v_mfma_f32_16x16x32_bf16 a[252:255], a[92:95], a[28:31], a[252:255]
    ds_read_b64_tr_b16 a[92:93], v15 offset:23552
    s_and_b32 s82, s66, 1
    v_mfma_f32_16x16x32_bf16 v[48:51], a[96:99], a[0:3], v[48:51]
    ds_read_b64_tr_b16 a[94:95], v15 offset:23808
    s_lshl_b32 s82, s82, 9
    v_mfma_f32_16x16x32_bf16 v[52:55], a[96:99], a[4:7], v[52:55]
    v_add_u32 v28, s82, v36
    v_mfma_f32_16x16x32_bf16 v[64:67], a[96:99], a[8:11], v[64:67]
    v_mov_b32 v29, 0x100
    v_mfma_f32_16x16x32_bf16 v[68:71], a[96:99], a[12:15], v[68:71]
    v_mov_b32 v42, 0x10000
    v_mfma_f32_16x16x32_bf16 v[80:83], a[96:99], a[16:19], v[80:83]
    s_mov_b32 s93, s92
    v_mfma_f32_16x16x32_bf16 v[84:87], a[96:99], a[20:23], v[84:87]
    v_mfma_f32_16x16x32_bf16 v[96:99], a[96:99], a[24:27], v[96:99]
    v_mfma_f32_16x16x32_bf16 v[100:103], a[96:99], a[28:31], v[100:103]
    v_mfma_f32_16x16x32_bf16 v[56:59], a[100:103], a[0:3], v[56:59]
    v_mfma_f32_16x16x32_bf16 v[60:63], a[100:103], a[4:7], v[60:63]
    v_mfma_f32_16x16x32_bf16 v[72:75], a[100:103], a[8:11], v[72:75]
    v_mfma_f32_16x16x32_bf16 v[76:79], a[100:103], a[12:15], v[76:79]
    v_mfma_f32_16x16x32_bf16 v[88:91], a[100:103], a[16:19], v[88:91]
    v_mfma_f32_16x16x32_bf16 v[92:95], a[100:103], a[20:23], v[92:95]
    v_mfma_f32_16x16x32_bf16 v[104:107], a[100:103], a[24:27], v[104:107]
    v_mfma_f32_16x16x32_bf16 v[108:111], a[100:103], a[28:31], v[108:111]
    s_waitcnt lgkmcnt(0)
    s_barrier
    v_mfma_f32_16x16x32_bf16 v[128:131], a[64:67], a[32:35], v[128:131]
    v_mfma_f32_16x16x32_bf16 v[144:147], a[64:67], a[36:39], v[144:147]
    v_mfma_f32_16x16x32_bf16 v[160:163], a[64:67], a[40:43], v[160:163]
    s_mov_b32 s82, 0
    s_add_u32 m0, s3, 0
    v_mfma_f32_16x16x32_bf16 v[176:179], a[64:67], a[44:47], v[176:179]
    buffer_load_dwordx4 v17, s[48:51], s82 offen lds
    v_mfma_f32_16x16x32_bf16 v[192:195], a[64:67], a[48:51], v[192:195]
    v_mfma_f32_16x16x32_bf16 v[208:211], a[64:67], a[52:55], v[208:211]
    v_mfma_f32_16x16x32_bf16 v[224:227], a[64:67], a[56:59], v[224:227]
    v_mfma_f32_16x16x32_bf16 v[240:243], a[64:67], a[60:63], v[240:243]
    buffer_load_dwordx4 v18, s[48:51], s82 offen offset:1024 lds
    v_mfma_f32_16x16x32_bf16 v[132:135], a[68:71], a[32:35], v[132:135]
    v_mfma_f32_16x16x32_bf16 v[148:151], a[68:71], a[36:39], v[148:151]
    v_mfma_f32_16x16x32_bf16 v[164:167], a[68:71], a[40:43], v[164:167]
    v_mfma_f32_16x16x32_bf16 v[180:183], a[68:71], a[44:47], v[180:183]
    s_mov_b32 s83, 229376
    s_add_u32 m0, s3, 8192
    v_mfma_f32_16x16x32_bf16 v[196:199], a[68:71], a[48:51], v[196:199]
    buffer_load_dwordx4 v17, s[48:51], s83 offen lds
    v_mfma_f32_16x16x32_bf16 v[212:215], a[68:71], a[52:55], v[212:215]
    v_mfma_f32_16x16x32_bf16 v[228:231], a[68:71], a[56:59], v[228:231]
    v_mfma_f32_16x16x32_bf16 v[244:247], a[68:71], a[60:63], v[244:247]
    v_mfma_f32_16x16x32_bf16 v[136:139], a[72:75], a[32:35], v[136:139]
    buffer_load_dwordx4 v18, s[48:51], s83 offen offset:1024 lds
    v_mfma_f32_16x16x32_bf16 v[152:155], a[72:75], a[36:39], v[152:155]
    v_mfma_f32_16x16x32_bf16 v[168:171], a[72:75], a[40:43], v[168:171]
    v_mfma_f32_16x16x32_bf16 v[184:187], a[72:75], a[44:47], v[184:187]
    v_mfma_f32_16x16x32_bf16 v[200:203], a[72:75], a[48:51], v[200:203]
    s_mov_b32 s82, 458752
    s_add_u32 m0, s3, 16384
    v_mfma_f32_16x16x32_bf16 v[216:219], a[72:75], a[52:55], v[216:219]
    buffer_load_dwordx4 v17, s[48:51], s82 offen lds
    v_mfma_f32_16x16x32_bf16 v[232:235], a[72:75], a[56:59], v[232:235]
    v_mfma_f32_16x16x32_bf16 v[248:251], a[72:75], a[60:63], v[248:251]
    v_mfma_f32_16x16x32_bf16 v[140:143], a[76:79], a[32:35], v[140:143]
    v_mfma_f32_16x16x32_bf16 v[156:159], a[76:79], a[36:39], v[156:159]
    buffer_load_dwordx4 v18, s[48:51], s82 offen offset:1024 lds
    v_mfma_f32_16x16x32_bf16 v[172:175], a[76:79], a[40:43], v[172:175]
    v_mfma_f32_16x16x32_bf16 v[188:191], a[76:79], a[44:47], v[188:191]
    v_mfma_f32_16x16x32_bf16 v[204:207], a[76:79], a[48:51], v[204:207]
    v_mfma_f32_16x16x32_bf16 v[220:223], a[76:79], a[52:55], v[220:223]
    s_mov_b32 s83, 688128
    s_add_u32 m0, s3, 24576
    v_mfma_f32_16x16x32_bf16 v[236:239], a[76:79], a[56:59], v[236:239]
    buffer_load_dwordx4 v17, s[48:51], s83 offen lds
    v_mfma_f32_16x16x32_bf16 v[252:255], a[76:79], a[60:63], v[252:255]
    v_mfma_f32_16x16x32_bf16 a[128:131], a[80:83], a[32:35], a[128:131]
    v_mfma_f32_16x16x32_bf16 a[144:147], a[80:83], a[36:39], a[144:147]
    v_mfma_f32_16x16x32_bf16 a[160:163], a[80:83], a[40:43], a[160:163]
    buffer_load_dwordx4 v18, s[48:51], s83 offen offset:1024 lds
    v_mfma_f32_16x16x32_bf16 a[176:179], a[80:83], a[44:47], a[176:179]
    v_mfma_f32_16x16x32_bf16 a[192:195], a[80:83], a[48:51], a[192:195]
    v_mfma_f32_16x16x32_bf16 a[208:211], a[80:83], a[52:55], a[208:211]
    v_mfma_f32_16x16x32_bf16 a[224:227], a[80:83], a[56:59], a[224:227]
    s_mov_b32 s82, 917504
    s_add_u32 m0, s3, 32768
    v_mfma_f32_16x16x32_bf16 a[240:243], a[80:83], a[60:63], a[240:243]
    buffer_load_dwordx4 v17, s[48:51], s82 offen lds
    v_mfma_f32_16x16x32_bf16 a[132:135], a[84:87], a[32:35], a[132:135]
    v_mfma_f32_16x16x32_bf16 a[148:151], a[84:87], a[36:39], a[148:151]
    v_mfma_f32_16x16x32_bf16 a[164:167], a[84:87], a[40:43], a[164:167]
    v_mfma_f32_16x16x32_bf16 a[180:183], a[84:87], a[44:47], a[180:183]
    buffer_load_dwordx4 v18, s[48:51], s82 offen offset:1024 lds
    v_mfma_f32_16x16x32_bf16 a[196:199], a[84:87], a[48:51], a[196:199]
    v_mfma_f32_16x16x32_bf16 a[212:215], a[84:87], a[52:55], a[212:215]
    v_mfma_f32_16x16x32_bf16 a[228:231], a[84:87], a[56:59], a[228:231]
    v_mfma_f32_16x16x32_bf16 a[244:247], a[84:87], a[60:63], a[244:247]
    s_mov_b32 s83, 1146880
    s_add_u32 m0, s3, 40960
    v_mfma_f32_16x16x32_bf16 a[136:139], a[88:91], a[32:35], a[136:139]
    buffer_load_dwordx4 v17, s[48:51], s83 offen lds
    v_mfma_f32_16x16x32_bf16 a[152:155], a[88:91], a[36:39], a[152:155]
    v_mfma_f32_16x16x32_bf16 a[168:171], a[88:91], a[40:43], a[168:171]
    v_mfma_f32_16x16x32_bf16 a[184:187], a[88:91], a[44:47], a[184:187]
    v_mfma_f32_16x16x32_bf16 a[200:203], a[88:91], a[48:51], a[200:203]
    buffer_load_dwordx4 v18, s[48:51], s83 offen offset:1024 lds
    v_mfma_f32_16x16x32_bf16 a[216:219], a[88:91], a[52:55], a[216:219]
    v_mfma_f32_16x16x32_bf16 a[232:235], a[88:91], a[56:59], a[232:235]
    v_mfma_f32_16x16x32_bf16 a[248:251], a[88:91], a[60:63], a[248:251]
    v_mfma_f32_16x16x32_bf16 a[140:143], a[92:95], a[32:35], a[140:143]
    s_mov_b32 s82, 1376256
    s_add_u32 m0, s3, 49152
    v_mfma_f32_16x16x32_bf16 a[156:159], a[92:95], a[36:39], a[156:159]
    buffer_load_dwordx4 v17, s[48:51], s82 offen lds
    v_mfma_f32_16x16x32_bf16 a[172:175], a[92:95], a[40:43], a[172:175]
    v_mfma_f32_16x16x32_bf16 a[188:191], a[92:95], a[44:47], a[188:191]
    v_mfma_f32_16x16x32_bf16 a[204:207], a[92:95], a[48:51], a[204:207]
    v_mfma_f32_16x16x32_bf16 a[220:223], a[92:95], a[52:55], a[220:223]
    buffer_load_dwordx4 v18, s[48:51], s82 offen offset:1024 lds
    v_mfma_f32_16x16x32_bf16 a[236:239], a[92:95], a[56:59], a[236:239]
    v_mfma_f32_16x16x32_bf16 a[252:255], a[92:95], a[60:63], a[252:255]
    v_mfma_f32_16x16x32_bf16 v[48:51], a[104:107], a[32:35], v[48:51]
    v_mfma_f32_16x16x32_bf16 v[52:55], a[104:107], a[36:39], v[52:55]
    s_mov_b32 s83, 1605632
    s_add_u32 m0, s3, 57344
    v_mfma_f32_16x16x32_bf16 v[64:67], a[104:107], a[40:43], v[64:67]
    buffer_load_dwordx4 v17, s[48:51], s83 offen lds
    v_mfma_f32_16x16x32_bf16 v[68:71], a[104:107], a[44:47], v[68:71]
    v_mfma_f32_16x16x32_bf16 v[80:83], a[104:107], a[48:51], v[80:83]
    v_mfma_f32_16x16x32_bf16 v[84:87], a[104:107], a[52:55], v[84:87]
    v_mfma_f32_16x16x32_bf16 v[96:99], a[104:107], a[56:59], v[96:99]
    buffer_load_dwordx4 v18, s[48:51], s83 offen offset:1024 lds
    v_mfma_f32_16x16x32_bf16 v[100:103], a[104:107], a[60:63], v[100:103]
    v_mfma_f32_16x16x32_bf16 v[56:59], a[108:111], a[32:35], v[56:59]
    v_mfma_f32_16x16x32_bf16 v[60:63], a[108:111], a[36:39], v[60:63]
    v_mfma_f32_16x16x32_bf16 v[72:75], a[108:111], a[40:43], v[72:75]
    v_mfma_f32_16x16x32_bf16 v[76:79], a[108:111], a[44:47], v[76:79]
    v_mfma_f32_16x16x32_bf16 v[88:91], a[108:111], a[48:51], v[88:91]
    v_mfma_f32_16x16x32_bf16 v[92:95], a[108:111], a[52:55], v[92:95]
    v_mfma_f32_16x16x32_bf16 v[104:107], a[108:111], a[56:59], v[104:107]
    v_mfma_f32_16x16x32_bf16 v[108:111], a[108:111], a[60:63], v[108:111]
L_epi:
    v_pk_mul_f32 v[34:35], v[128:129], v[128:129]
    v_pk_mul_f32 v[36:37], v[130:131], v[130:131]
    v_pk_mul_f32 v[38:39], v[132:133], v[132:133]
    v_pk_mul_f32 v[40:41], v[134:135], v[134:135]
    v_pk_fma_f32 v[34:35], v[34:35], s[94:95], v[26:27]
    v_pk_fma_f32 v[36:37], v[36:37], s[94:95], v[26:27]
    v_pk_fma_f32 v[38:39], v[38:39], s[94:95], v[26:27]
    v_pk_fma_f32 v[40:41], v[40:41], s[94:95], v[26:27]
    v_pk_mul_f32 v[34:35], v[34:35], v[128:129]
    v_pk_mul_f32 v[36:37], v[36:37], v[130:131]
    v_pk_mul_f32 v[38:39], v[38:39], v[132:133]
    v_pk_mul_f32 v[40:41], v[40:41], v[134:135]
    v_exp_f32 v34, v34
    v_exp_f32 v35, v35
    v_exp_f32 v36, v36
    v_exp_f32 v37, v37
    v_exp_f32 v38, v38
    v_exp_f32 v39, v39
    v_exp_f32 v40, v40
    v_exp_f32 v41, v41
    v_pk_mul_f32 v[136:137], v[136:137], v[128:129]
    v_pk_mul_f32 v[138:139], v[138:139], v[130:131]
    v_pk_mul_f32 v[140:141], v[140:141], v[132:133]
    v_pk_mul_f32 v[142:143], v[142:143], v[134:135]
    v_pk_add_f32 v[34:35], v[34:35], 1.0 op_sel_hi:[1,0]
    v_pk_add_f32 v[36:37], v[36:37], 1.0 op_sel_hi:[1,0]
    v_pk_add_f32 v[38:39], v[38:39], 1.0 op_sel_hi:[1,0]
    v_pk_add_f32 v[40:41], v[40:41], 1.0 op_sel_hi:[1,0]
    v_rcp_f32 v34, v34
    v_rcp_f32 v35, v35
    v_rcp_f32 v36, v36
    v_rcp_f32 v37, v37
    v_rcp_f32 v38, v38
    v_rcp_f32 v39, v39
    v_rcp_f32 v40, v40
    v_rcp_f32 v41, v41
    v_pk_mul_f32 v[136:137], v[136:137], v[34:35]
    v_pk_mul_f32 v[138:139], v[138:139], v[36:37]
    v_pk_mul_f32 v[140:141], v[140:141], v[38:39]
    v_pk_mul_f32 v[142:143], v[142:143], v[40:41]
    v_cvt_pk_bf16_f32 v128, v136, v137
    v_cvt_pk_bf16_f32 v129, v138, v139
    v_cvt_pk_bf16_f32 v130, v140, v141
    v_cvt_pk_bf16_f32 v131, v142, v143
    buffer_store_dwordx4 v[128:131], v16, s[56:59], s88 offen offset:0 sc1
    v_pk_mul_f32 v[34:35], v[144:145], v[144:145]
    v_pk_mul_f32 v[36:37], v[146:147], v[146:147]
    v_pk_mul_f32 v[38:39], v[148:149], v[148:149]
    v_pk_mul_f32 v[40:41], v[150:151], v[150:151]
    v_pk_fma_f32 v[34:35], v[34:35], s[94:95], v[26:27]
    v_pk_fma_f32 v[36:37], v[36:37], s[94:95], v[26:27]
    v_pk_fma_f32 v[38:39], v[38:39], s[94:95], v[26:27]
    v_pk_fma_f32 v[40:41], v[40:41], s[94:95], v[26:27]
    v_pk_mul_f32 v[34:35], v[34:35], v[144:145]
    v_pk_mul_f32 v[36:37], v[36:37], v[146:147]
    v_pk_mul_f32 v[38:39], v[38:39], v[148:149]
    v_pk_mul_f32 v[40:41], v[40:41], v[150:151]
    v_exp_f32 v34, v34
    v_exp_f32 v35, v35
    v_exp_f32 v36, v36
    v_exp_f32 v37, v37
    v_exp_f32 v38, v38
    v_exp_f32 v39, v39
    v_exp_f32 v40, v40
    v_exp_f32 v41, v41
    v_pk_mul_f32 v[152:153], v[152:153], v[144:145]
    v_pk_mul_f32 v[154:155], v[154:155], v[146:147]
    v_pk_mul_f32 v[156:157], v[156:157], v[148:149]
    v_pk_mul_f32 v[158:159], v[158:159], v[150:151]
    v_pk_add_f32 v[34:35], v[34:35], 1.0 op_sel_hi:[1,0]
    v_pk_add_f32 v[36:37], v[36:37], 1.0 op_sel_hi:[1,0]
    v_pk_add_f32 v[38:39], v[38:39], 1.0 op_sel_hi:[1,0]
    v_pk_add_f32 v[40:41], v[40:41], 1.0 op_sel_hi:[1,0]
    v_rcp_f32 v34, v34
    v_rcp_f32 v35, v35
    v_rcp_f32 v36, v36
    v_rcp_f32 v37, v37
    v_rcp_f32 v38, v38
    v_rcp_f32 v39, v39
    v_rcp_f32 v40, v40
    v_rcp_f32 v41, v41
    v_pk_mul_f32 v[152:153], v[152:153], v[34:35]
    v_pk_mul_f32 v[154:155], v[154:155], v[36:37]
    v_pk_mul_f32 v[156:157], v[156:157], v[38:39]
    v_pk_mul_f32 v[158:159], v[158:159], v[40:41]
    v_cvt_pk_bf16_f32 v144, v152, v153
    v_cvt_pk_bf16_f32 v145, v154, v155
    v_cvt_pk_bf16_f32 v146, v156, v157
    v_cvt_pk_bf16_f32 v147, v158, v159
    buffer_store_dwordx4 v[144:147], v16, s[56:59], s88 offen offset:1024 sc1
    v_pk_mul_f32 v[34:35], v[160:161], v[160:161]
    v_pk_mul_f32 v[36:37], v[162:163], v[162:163]
    v_pk_mul_f32 v[38:39], v[164:165], v[164:165]
    v_pk_mul_f32 v[40:41], v[166:167], v[166:167]
    v_pk_fma_f32 v[34:35], v[34:35], s[94:95], v[26:27]
    v_pk_fma_f32 v[36:37], v[36:37], s[94:95], v[26:27]
    v_pk_fma_f32 v[38:39], v[38:39], s[94:95], v[26:27]
    v_pk_fma_f32 v[40:41], v[40:41], s[94:95], v[26:27]
    v_pk_mul_f32 v[34:35], v[34:35], v[160:161]
    v_pk_mul_f32 v[36:37], v[36:37], v[162:163]
    v_pk_mul_f32 v[38:39], v[38:39], v[164:165]
    v_pk_mul_f32 v[40:41], v[40:41], v[166:167]
    v_exp_f32 v34, v34
    v_exp_f32 v35, v35
    v_exp_f32 v36, v36
    v_exp_f32 v37, v37
    v_exp_f32 v38, v38
    v_exp_f32 v39, v39
    v_exp_f32 v40, v40
    v_exp_f32 v41, v41
    v_pk_mul_f32 v[168:169], v[168:169], v[160:161]
    v_pk_mul_f32 v[170:171], v[170:171], v[162:163]
    v_pk_mul_f32 v[172:173], v[172:173], v[164:165]
    v_pk_mul_f32 v[174:175], v[174:175], v[166:167]
    v_pk_add_f32 v[34:35], v[34:35], 1.0 op_sel_hi:[1,0]
    v_pk_add_f32 v[36:37], v[36:37], 1.0 op_sel_hi:[1,0]
    v_pk_add_f32 v[38:39], v[38:39], 1.0 op_sel_hi:[1,0]
    v_pk_add_f32 v[40:41], v[40:41], 1.0 op_sel_hi:[1,0]
    v_rcp_f32 v34, v34
    v_rcp_f32 v35, v35
    v_rcp_f32 v36, v36
    v_rcp_f32 v37, v37
    v_rcp_f32 v38, v38
    v_rcp_f32 v39, v39
    v_rcp_f32 v40, v40
    v_rcp_f32 v41, v41
    v_pk_mul_f32 v[168:169], v[168:169], v[34:35]
    v_pk_mul_f32 v[170:171], v[170:171], v[36:37]
    v_pk_mul_f32 v[172:173], v[172:173], v[38:39]
    v_pk_mul_f32 v[174:175], v[174:175], v[40:41]
    v_cvt_pk_bf16_f32 v160, v168, v169
    v_cvt_pk_bf16_f32 v161, v170, v171
    v_cvt_pk_bf16_f32 v162, v172, v173
    v_cvt_pk_bf16_f32 v163, v174, v175
    buffer_store_dwordx4 v[160:163], v16, s[56:59], s88 offen offset:2048 sc1
    v_pk_mul_f32 v[34:35], v[176:177], v[176:177]
    v_pk_mul_f32 v[36:37], v[178:179], v[178:179]
    v_pk_mul_f32 v[38:39], v[180:181], v[180:181]
    v_pk_mul_f32 v[40:41], v[182:183], v[182:183]
    v_pk_fma_f32 v[34:35], v[34:35], s[94:95], v[26:27]
    v_pk_fma_f32 v[36:37], v[36:37], s[94:95], v[26:27]
    v_pk_fma_f32 v[38:39], v[38:39], s[94:95], v[26:27]
    v_pk_fma_f32 v[40:41], v[40:41], s[94:95], v[26:27]
    v_pk_mul_f32 v[34:35], v[34:35], v[176:177]
    v_pk_mul_f32 v[36:37], v[36:37], v[178:179]
    v_pk_mul_f32 v[38:39], v[38:39], v[180:181]
    v_pk_mul_f32 v[40:41], v[40:41], v[182:183]
    v_exp_f32 v34, v34
    v_exp_f32 v35, v35
    v_exp_f32 v36, v36
    v_exp_f32 v37, v37
    v_exp_f32 v38, v38
    v_exp_f32 v39, v39
    v_exp_f32 v40, v40
    v_exp_f32 v41, v41
    v_pk_mul_f32 v[184:185], v[184:185], v[176:177]
    v_pk_mul_f32 v[186:187], v[186:187], v[178:179]
    v_pk_mul_f32 v[188:189], v[188:189], v[180:181]
    v_pk_mul_f32 v[190:191], v[190:191], v[182:183]
    v_pk_add_f32 v[34:35], v[34:35], 1.0 op_sel_hi:[1,0]
    v_pk_add_f32 v[36:37], v[36:37], 1.0 op_sel_hi:[1,0]
    v_pk_add_f32 v[38:39], v[38:39], 1.0 op_sel_hi:[1,0]
    v_pk_add_f32 v[40:41], v[40:41], 1.0 op_sel_hi:[1,0]
    v_rcp_f32 v34, v34
    v_rcp_f32 v35, v35
    v_rcp_f32 v36, v36
    v_rcp_f32 v37, v37
    v_rcp_f32 v38, v38
    v_rcp_f32 v39, v39
    v_rcp_f32 v40, v40
    v_rcp_f32 v41, v41
    v_pk_mul_f32 v[184:185], v[184:185], v[34:35]
    v_pk_mul_f32 v[186:187], v[186:187], v[36:37]
    v_pk_mul_f32 v[188:189], v[188:189], v[38:39]
    v_pk_mul_f32 v[190:191], v[190:191], v[40:41]
    v_cvt_pk_bf16_f32 v176, v184, v185
    v_cvt_pk_bf16_f32 v177, v186, v187
    v_cvt_pk_bf16_f32 v178, v188, v189
    v_cvt_pk_bf16_f32 v179, v190, v191
    buffer_store_dwordx4 v[176:179], v16, s[56:59], s88 offen offset:3072 sc1
    v_pk_mul_f32 v[34:35], v[192:193], v[192:193]
    v_pk_mul_f32 v[36:37], v[194:195], v[194:195]
    v_pk_mul_f32 v[38:39], v[196:197], v[196:197]
    v_pk_mul_f32 v[40:41], v[198:199], v[198:199]
    v_pk_fma_f32 v[34:35], v[34:35], s[94:95], v[26:27]
    v_pk_fma_f32 v[36:37], v[36:37], s[94:95], v[26:27]
    v_pk_fma_f32 v[38:39], v[38:39], s[94:95], v[26:27]
    v_pk_fma_f32 v[40:41], v[40:41], s[94:95], v[26:27]
    v_pk_mul_f32 v[34:35], v[34:35], v[192:193]
    v_pk_mul_f32 v[36:37], v[36:37], v[194:195]
    v_pk_mul_f32 v[38:39], v[38:39], v[196:197]
    v_pk_mul_f32 v[40:41], v[40:41], v[198:199]
    v_exp_f32 v34, v34
    v_exp_f32 v35, v35
    v_exp_f32 v36, v36
    v_exp_f32 v37, v37
    v_exp_f32 v38, v38
    v_exp_f32 v39, v39
    v_exp_f32 v40, v40
    v_exp_f32 v41, v41
    v_pk_mul_f32 v[200:201], v[200:201], v[192:193]
    v_pk_mul_f32 v[202:203], v[202:203], v[194:195]
    v_pk_mul_f32 v[204:205], v[204:205], v[196:197]
    v_pk_mul_f32 v[206:207], v[206:207], v[198:199]
    v_pk_add_f32 v[34:35], v[34:35], 1.0 op_sel_hi:[1,0]
    v_pk_add_f32 v[36:37], v[36:37], 1.0 op_sel_hi:[1,0]
    v_pk_add_f32 v[38:39], v[38:39], 1.0 op_sel_hi:[1,0]
    v_pk_add_f32 v[40:41], v[40:41], 1.0 op_sel_hi:[1,0]
    v_rcp_f32 v34, v34
    v_rcp_f32 v35, v35
    v_rcp_f32 v36, v36
    v_rcp_f32 v37, v37
    v_rcp_f32 v38, v38
    v_rcp_f32 v39, v39
    v_rcp_f32 v40, v40
    v_rcp_f32 v41, v41
    v_pk_mul_f32 v[200:201], v[200:201], v[34:35]
    v_pk_mul_f32 v[202:203], v[202:203], v[36:37]
    v_pk_mul_f32 v[204:205], v[204:205], v[38:39]
    v_pk_mul_f32 v[206:207], v[206:207], v[40:41]
    v_cvt_pk_bf16_f32 v192, v200, v201
    v_cvt_pk_bf16_f32 v193, v202, v203
    v_cvt_pk_bf16_f32 v194, v204, v205
    v_cvt_pk_bf16_f32 v195, v206, v207
    s_add_u32 s88, s88, 4096
    buffer_store_dwordx4 v[192:195], v16, s[56:59], s88 offen offset:0 sc1
    v_pk_mul_f32 v[34:35], v[208:209], v[208:209]
    v_pk_mul_f32 v[36:37], v[210:211], v[210:211]
    v_pk_mul_f32 v[38:39], v[212:213], v[212:213]
    v_pk_mul_f32 v[40:41], v[214:215], v[214:215]
    v_pk_fma_f32 v[34:35], v[34:35], s[94:95], v[26:27]
    v_pk_fma_f32 v[36:37], v[36:37], s[94:95], v[26:27]
    v_pk_fma_f32 v[38:39], v[38:39], s[94:95], v[26:27]
    v_pk_fma_f32 v[40:41], v[40:41], s[94:95], v[26:27]
    v_pk_mul_f32 v[34:35], v[34:35], v[208:209]
    v_pk_mul_f32 v[36:37], v[36:37], v[210:211]
    v_pk_mul_f32 v[38:39], v[38:39], v[212:213]
    v_pk_mul_f32 v[40:41], v[40:41], v[214:215]
    v_exp_f32 v34, v34
    v_exp_f32 v35, v35
    v_exp_f32 v36, v36
    v_exp_f32 v37, v37
    v_exp_f32 v38, v38
    v_exp_f32 v39, v39
    v_exp_f32 v40, v40
    v_exp_f32 v41, v41
    v_pk_mul_f32 v[216:217], v[216:217], v[208:209]
    v_pk_mul_f32 v[218:219], v[218:219], v[210:211]
    v_pk_mul_f32 v[220:221], v[220:221], v[212:213]
    v_pk_mul_f32 v[222:223], v[222:223], v[214:215]
    v_pk_add_f32 v[34:35], v[34:35], 1.0 op_sel_hi:[1,0]
    v_pk_add_f32 v[36:37], v[36:37], 1.0 op_sel_hi:[1,0]
    v_pk_add_f32 v[38:39], v[38:39], 1.0 op_sel_hi:[1,0]
    v_pk_add_f32 v[40:41], v[40:41], 1.0 op_sel_hi:[1,0]
    v_rcp_f32 v34, v34
    v_rcp_f32 v35, v35
    v_rcp_f32 v36, v36
    v_rcp_f32 v37, v37
    v_rcp_f32 v38, v38
    v_rcp_f32 v39, v39
    v_rcp_f32 v40, v40
    v_rcp_f32 v41, v41
    v_pk_mul_f32 v[216:217], v[216:217], v[34:35]
    v_pk_mul_f32 v[218:219], v[218:219], v[36:37]
    v_pk_mul_f32 v[220:221], v[220:221], v[38:39]
    v_pk_mul_f32 v[222:223], v[222:223], v[40:41]
    v_cvt_pk_bf16_f32 v208, v216, v217
    v_cvt_pk_bf16_f32 v209, v218, v219
    v_cvt_pk_bf16_f32 v210, v220, v221
    v_cvt_pk_bf16_f32 v211, v222, v223
    buffer_store_dwordx4 v[208:211], v16, s[56:59], s88 offen offset:1024 sc1
    v_pk_mul_f32 v[34:35], v[224:225], v[224:225]
    v_pk_mul_f32 v[36:37], v[226:227], v[226:227]
    v_pk_mul_f32 v[38:39], v[228:229], v[228:229]
    v_pk_mul_f32 v[40:41], v[230:231], v[230:231]
    v_pk_fma_f32 v[34:35], v[34:35], s[94:95], v[26:27]
    v_pk_fma_f32 v[36:37], v[36:37], s[94:95], v[26:27]
    v_pk_fma_f32 v[38:39], v[38:39], s[94:95], v[26:27]
    v_pk_fma_f32 v[40:41], v[40:41], s[94:95], v[26:27]
    v_pk_mul_f32 v[34:35], v[34:35], v[224:225]
    v_pk_mul_f32 v[36:37], v[36:37], v[226:227]
    v_pk_mul_f32 v[38:39], v[38:39], v[228:229]
    v_pk_mul_f32 v[40:41], v[40:41], v[230:231]
    v_exp_f32 v34, v34
    v_exp_f32 v35, v35
    v_exp_f32 v36, v36
    v_exp_f32 v37, v37
    v_exp_f32 v38, v38
    v_exp_f32 v39, v39
    v_exp_f32 v40, v40
    v_exp_f32 v41, v41
    v_pk_mul_f32 v[232:233], v[232:233], v[224:225]
    v_pk_mul_f32 v[234:235], v[234:235], v[226:227]
    v_pk_mul_f32 v[236:237], v[236:237], v[228:229]
    v_pk_mul_f32 v[238:239], v[238:239], v[230:231]
    v_pk_add_f32 v[34:35], v[34:35], 1.0 op_sel_hi:[1,0]
    v_pk_add_f32 v[36:37], v[36:37], 1.0 op_sel_hi:[1,0]
    v_pk_add_f32 v[38:39], v[38:39], 1.0 op_sel_hi:[1,0]
    v_pk_add_f32 v[40:41], v[40:41], 1.0 op_sel_hi:[1,0]
    v_rcp_f32 v34, v34
    v_rcp_f32 v35, v35
    v_rcp_f32 v36, v36
    v_rcp_f32 v37, v37
    v_rcp_f32 v38, v38
    v_rcp_f32 v39, v39
    v_rcp_f32 v40, v40
    v_rcp_f32 v41, v41
    v_pk_mul_f32 v[232:233], v[232:233], v[34:35]
    v_pk_mul_f32 v[234:235], v[234:235], v[36:37]
    v_pk_mul_f32 v[236:237], v[236:237], v[38:39]
    v_pk_mul_f32 v[238:239], v[238:239], v[40:41]
    v_cvt_pk_bf16_f32 v224, v232, v233
    v_cvt_pk_bf16_f32 v225, v234, v235
    v_cvt_pk_bf16_f32 v226, v236, v237
    v_cvt_pk_bf16_f32 v227, v238, v239
    buffer_store_dwordx4 v[224:227], v16, s[56:59], s88 offen offset:2048 sc1
    v_pk_mul_f32 v[34:35], v[240:241], v[240:241]
    v_pk_mul_f32 v[36:37], v[242:243], v[242:243]
    v_pk_mul_f32 v[38:39], v[244:245], v[244:245]
    v_pk_mul_f32 v[40:41], v[246:247], v[246:247]
    s_branch L_over4
L_stub4:
    s_branch L_stub5
L_over4:
    v_pk_fma_f32 v[34:35], v[34:35], s[94:95], v[26:27]
    v_pk_fma_f32 v[36:37], v[36:37], s[94:95], v[26:27]
    v_pk_fma_f32 v[38:39], v[38:39], s[94:95], v[26:27]
    v_pk_fma_f32 v[40:41], v[40:41], s[94:95], v[26:27]
    v_pk_mul_f32 v[34:35], v[34:35], v[240:241]
    v_pk_mul_f32 v[36:37], v[36:37], v[242:243]
    v_pk_mul_f32 v[38:39], v[38:39], v[244:245]
    v_pk_mul_f32 v[40:41], v[40:41], v[246:247]
    v_exp_f32 v34, v34
    v_exp_f32 v35, v35
    v_exp_f32 v36, v36
    v_exp_f32 v37, v37
    v_exp_f32 v38, v38
    v_exp_f32 v39, v39
    v_exp_f32 v40, v40
    v_exp_f32 v41, v41
    v_pk_mul_f32 v[248:249], v[248:249], v[240:241]
    v_pk_mul_f32 v[250:251], v[250:251], v[242:243]
    v_pk_mul_f32 v[252:253], v[252:253], v[244:245]
    v_pk_mul_f32 v[254:255], v[254:255], v[246:247]
    v_pk_add_f32 v[34:35], v[34:35], 1.0 op_sel_hi:[1,0]
    v_pk_add_f32 v[36:37], v[36:37], 1.0 op_sel_hi:[1,0]
    v_pk_add_f32 v[38:39], v[38:39], 1.0 op_sel_hi:[1,0]
    v_pk_add_f32 v[40:41], v[40:41], 1.0 op_sel_hi:[1,0]
    v_rcp_f32 v34, v34
    v_rcp_f32 v35, v35
    v_rcp_f32 v36, v36
    v_rcp_f32 v37, v37
    v_rcp_f32 v38, v38
    v_rcp_f32 v39, v39
    v_rcp_f32 v40, v40
    v_rcp_f32 v41, v41
    v_pk_mul_f32 v[248:249], v[248:249], v[34:35]
    v_pk_mul_f32 v[250:251], v[250:251], v[36:37]
    v_pk_mul_f32 v[252:253], v[252:253], v[38:39]
    v_pk_mul_f32 v[254:255], v[254:255], v[40:41]
    v_cvt_pk_bf16_f32 v240, v248, v249
    v_cvt_pk_bf16_f32 v241, v250, v251
    v_cvt_pk_bf16_f32 v242, v252, v253
    v_cvt_pk_bf16_f32 v243, v254, v255
    buffer_store_dwordx4 v[240:243], v16, s[56:59], s88 offen offset:3072 sc1
    s_cmp_eq_u32 s62, 1
    s_cbranch_scc1 L_epi1
    v_mov_b32 v244, 0xce6e6b28
    v_cvt_pk_bf16_f32 v128, v120, v121
    v_cvt_pk_bf16_f32 v129, v122, v123
    v_cvt_pk_bf16_f32 v130, v124, v125
    v_cvt_pk_bf16_f32 v131, v126, v127
    v_accvgpr_read_b32 v34, a128
    v_accvgpr_read_b32 v35, a129
    v_accvgpr_read_b32 v36, a130
    v_accvgpr_read_b32 v37, a131
    v_accvgpr_read_b32 v38, a132
    v_accvgpr_read_b32 v39, a133
    v_accvgpr_read_b32 v40, a134
    v_accvgpr_read_b32 v41, a135
    v_cvt_pk_bf16_f32 v132, v34, v35
    s_mov_b32 s82, 65536
    s_add_u32 m0, s3, 65536
    s_nop 0
    buffer_load_dwordx4 v17, s[48:51], s82 offen lds
    buffer_load_dwordx4 v18, s[48:51], s82 offen offset:1024 lds
    v_cvt_pk_bf16_f32 v133, v36, v37
    v_cvt_pk_bf16_f32 v134, v38, v39
    v_cvt_pk_bf16_f32 v135, v40, v41
    v_accvgpr_read_b32 v246, a192
    v_accvgpr_read_b32 v247, a193
    v_accvgpr_read_b32 v248, a194
    v_accvgpr_read_b32 v249, a195
    v_accvgpr_read_b32 v250, a196
    v_accvgpr_read_b32 v251, a197
    v_accvgpr_read_b32 v252, a198
    v_accvgpr_read_b32 v253, a199
    v_cvt_pk_bf16_f32 v164, v246, v247
    v_cvt_pk_bf16_f32 v165, v248, v249
    v_cvt_pk_bf16_f32 v166, v250, v251
    v_cvt_pk_bf16_f32 v167, v252, v253
    v_accvgpr_read_b32 v34, a136
    v_accvgpr_read_b32 v35, a137
    v_accvgpr_read_b32 v36, a138
    v_accvgpr_read_b32 v37, a139
    v_accvgpr_read_b32 v38, a140
    v_accvgpr_read_b32 v39, a141
    v_accvgpr_read_b32 v40, a142
    s_mov_b32 s83, 294912
    s_add_u32 m0, s3, 73728
    s_nop 0
    buffer_load_dwordx4 v17, s[48:51], s83 offen lds
    buffer_load_dwordx4 v18, s[48:51], s83 offen offset:1024 lds
    v_accvgpr_read_b32 v41, a143
    v_cvt_pk_bf16_f32 v136, v34, v35
    v_cvt_pk_bf16_f32 v137, v36, v37
    v_cvt_pk_bf16_f32 v138, v38, v39
    v_cvt_pk_bf16_f32 v139, v40, v41
    v_accvgpr_read_b32 v246, a200
    v_accvgpr_read_b32 v247, a201
    v_accvgpr_read_b32 v248, a202
    v_accvgpr_read_b32 v249, a203
    v_accvgpr_read_b32 v250, a204
    v_accvgpr_read_b32 v251, a205
    v_accvgpr_read_b32 v252, a206
    v_accvgpr_read_b32 v253, a207
    v_cvt_pk_bf16_f32 v168, v246, v247
    v_cvt_pk_bf16_f32 v169, v248, v249
    v_cvt_pk_bf16_f32 v170, v250, v251
    v_cvt_pk_bf16_f32 v171, v252, v253
    v_accvgpr_read_b32 v34, a144
    v_accvgpr_read_b32 v35, a145
    v_accvgpr_read_b32 v36, a146
    v_accvgpr_read_b32 v37, a147
    v_accvgpr_read_b32 v38, a148
    s_mov_b32 s82, 524288
    s_add_u32 m0, s3, 81920
    s_nop 0
    buffer_load_dwordx4 v17, s[48:51], s82 offen lds
    buffer_load_dwordx4 v18, s[48:51], s82 offen offset:1024 lds
    v_accvgpr_read_b32 v39, a149
    v_accvgpr_read_b32 v40, a150
    v_accvgpr_read_b32 v41, a151
    v_cvt_pk_bf16_f32 v140, v34, v35
    v_cvt_pk_bf16_f32 v141, v36, v37
    v_cvt_pk_bf16_f32 v142, v38, v39
    v_cvt_pk_bf16_f32 v143, v40, v41
    v_accvgpr_read_b32 v246, a208
    v_accvgpr_read_b32 v247, a209
    v_accvgpr_read_b32 v248, a210
    v_accvgpr_read_b32 v249, a211
    v_accvgpr_read_b32 v250, a212
    v_accvgpr_read_b32 v251, a213
    v_accvgpr_read_b32 v252, a214
    v_accvgpr_read_b32 v253, a215
    v_cvt_pk_bf16_f32 v172, v246, v247
    v_cvt_pk_bf16_f32 v173, v248, v249
    v_cvt_pk_bf16_f32 v174, v250, v251
    v_cvt_pk_bf16_f32 v175, v252, v253
    v_accvgpr_read_b32 v34, a152
    v_accvgpr_read_b32 v35, a153
    v_accvgpr_read_b32 v36, a154
    s_mov_b32 s83, 753664
    s_add_u32 m0, s3, 90112
    s_nop 0
    buffer_load_dwordx4 v17, s[48:51], s83 offen lds
    buffer_load_dwordx4 v18, s[48:51], s83 offen offset:1024 lds
    v_accvgpr_read_b32 v37, a155
    v_accvgpr_read_b32 v38, a156
    v_accvgpr_read_b32 v39, a157
    v_accvgpr_read_b32 v40, a158
    v_accvgpr_read_b32 v41, a159
    v_cvt_pk_bf16_f32 v144, v34, v35
    v_cvt_pk_bf16_f32 v145, v36, v37
    v_cvt_pk_bf16_f32 v146, v38, v39
    v_cvt_pk_bf16_f32 v147, v40, v41
    v_accvgpr_read_b32 v246, a216
    v_accvgpr_read_b32 v247, a217
    v_accvgpr_read_b32 v248, a218
    v_accvgpr_read_b32 v249, a219
    v_accvgpr_read_b32 v250, a220
    v_accvgpr_read_b32 v251, a221
    v_accvgpr_read_b32 v252, a222
    v_accvgpr_read_b32 v253, a223
    v_cvt_pk_bf16_f32 v176, v246, v247
    v_cvt_pk_bf16_f32 v177, v248, v249
    v_cvt_pk_bf16_f32 v178, v250, v251
    v_cvt_pk_bf16_f32 v179, v252, v253
    v_mfma_f32_16x16x32_bf16 v[196:199], v[128:131], v[164:167], 0
    v_mfma_f32_16x16x32_bf16 v[200:203], v[132:135], v[164:167], 0
    v_mfma_f32_16x16x32_bf16 v[204:207], v[132:135], v[168:171], 0
    v_mfma_f32_16x16x32_bf16 v[208:211], v[136:139], v[168:171], 0
    v_mfma_f32_16x16x32_bf16 v[212:215], v[136:139], v[172:175], 0
    v_mfma_f32_16x16x32_bf16 v[216:219], v[140:143], v[172:175], 0
    v_mfma_f32_16x16x32_bf16 v[220:223], v[140:143], v[176:179], 0
    v_mfma_f32_16x16x32_bf16 v[224:227], v[144:147], v[176:179], 0
    s_waitcnt vmcnt(8)
    s_mov_b64 exec, 1
    buffer_atomic_add v25, off, s[56:59], s92 sc1
    s_mov_b64 exec, -1
    v_cvt_pk_bf16_f32 v48, v48, v49
    v_cvt_pk_bf16_f32 v49, v50, v51
    v_cvt_pk_bf16_f32 v84, v84, v85
    v_cvt_pk_bf16_f32 v85, v86, v87
    v_cvt_pk_bf16_f32 v50, v52, v53
    v_cvt_pk_bf16_f32 v51, v54, v55
    v_cvt_pk_bf16_f32 v86, v88, v89
    v_cvt_pk_bf16_f32 v87, v90, v91
    v_cvt_pk_bf16_f32 v52, v56, v57
    v_cvt_pk_bf16_f32 v53, v58, v59
    v_cvt_pk_bf16_f32 v88, v92, v93
    v_cvt_pk_bf16_f32 v89, v94, v95
    v_cvt_pk_bf16_f32 v54, v60, v61
    v_cvt_pk_bf16_f32 v55, v62, v63
    v_cvt_pk_bf16_f32 v90, v96, v97
    v_cvt_pk_bf16_f32 v91, v98, v99
    v_cvt_pk_bf16_f32 v56, v64, v65
    v_cvt_pk_bf16_f32 v57, v66, v67
    v_cvt_pk_bf16_f32 v92, v100, v101
    v_cvt_pk_bf16_f32 v93, v102, v103
    v_cvt_pk_bf16_f32 v58, v68, v69
    v_cvt_pk_bf16_f32 v59, v70, v71
    v_cvt_pk_bf16_f32 v94, v104, v105
    v_cvt_pk_bf16_f32 v95, v106, v107
    v_cvt_pk_bf16_f32 v60, v72, v73
    v_cvt_pk_bf16_f32 v61, v74, v75
    v_cvt_pk_bf16_f32 v96, v108, v109
    v_cvt_pk_bf16_f32 v97, v110, v111
    v_cvt_pk_bf16_f32 v62, v76, v77
    v_cvt_pk_bf16_f32 v63, v78, v79
    v_cvt_pk_bf16_f32 v98, v112, v113
    v_cvt_pk_bf16_f32 v99, v114, v115
    v_cvt_pk_bf16_f32 v64, v80, v81
    v_cvt_pk_bf16_f32 v65, v82, v83
    v_cvt_pk_bf16_f32 v100, v116, v117
    v_cvt_pk_bf16_f32 v101, v118, v119
    v_cvt_pk_bf16_f32 v196, v196, v197
    s_mov_b32 s82, 983040
    s_add_u32 m0, s3, 98304
    s_nop 0
    buffer_load_dwordx4 v17, s[48:51], s82 offen lds
    buffer_load_dwordx4 v18, s[48:51], s82 offen offset:1024 lds
    v_cvt_pk_bf16_f32 v198, v198, v199
    v_cvt_pk_bf16_f32 v200, v200, v201
    v_cvt_pk_bf16_f32 v202, v202, v203
    v_cvt_pk_bf16_f32 v204, v204, v205
    v_cvt_pk_bf16_f32 v206, v206, v207
    v_cvt_pk_bf16_f32 v208, v208, v209
    v_cvt_pk_bf16_f32 v210, v210, v211
    v_cvt_pk_bf16_f32 v212, v212, v213
    v_cvt_pk_bf16_f32 v214, v214, v215
    v_cvt_pk_bf16_f32 v216, v216, v217
    v_cvt_pk_bf16_f32 v218, v218, v219
    v_cvt_pk_bf16_f32 v220, v220, v221
    v_cvt_pk_bf16_f32 v222, v222, v223
    v_cvt_pk_bf16_f32 v224, v224, v225
    v_cvt_pk_bf16_f32 v226, v226, v227
    v_perm_b32 v228, v200, v196, v28
    v_perm_b32 v229, v202, v198, v29
    v_perm_b32 v230, v208, v204, v28
    v_perm_b32 v231, v210, v206, v29
    v_perm_b32 v232, v216, v212, v28
    v_perm_b32 v233, v218, v214, v29
    v_perm_b32 v234, v224, v220, v28
    v_perm_b32 v235, v226, v222, v29
    v_pk_mul_f32 v[228:229], v[228:229], s[14:15]
    v_pk_mul_f32 v[230:231], v[230:231], s[14:15]
    v_pk_mul_f32 v[232:233], v[232:233], s[14:15]
    v_pk_mul_f32 v[234:235], v[234:235], s[14:15]
    v_cvt_pk_bf16_f32 v229, v228, v229
    s_mov_b32 s83, 1212416
    s_add_u32 m0, s3, 106496
    s_nop 0
    buffer_load_dwordx4 v17, s[48:51], s83 offen lds
    buffer_load_dwordx4 v18, s[48:51], s83 offen offset:1024 lds
    v_cvt_pk_bf16_f32 v231, v230, v231
    v_cvt_pk_bf16_f32 v233, v232, v233
    v_cvt_pk_bf16_f32 v235, v234, v235
    v_lshlrev_b32 v228, 16, v229
    v_and_b32 v229, 0xffff0000, v229
    v_lshlrev_b32 v230, 16, v231
    v_and_b32 v231, 0xffff0000, v231
    v_lshlrev_b32 v232, 16, v233
    v_and_b32 v233, 0xffff0000, v233
    v_lshlrev_b32 v234, 16, v235
    v_and_b32 v235, 0xffff0000, v235
    v_cndmask_b32 v228, v244, v228, s[4:5]
    v_cndmask_b32 v229, v244, v229, s[6:7]
    v_max_f32 v236, v228, v229
    v_max_f32 v238, v230, v231
    v_max_f32 v240, v232, v233
    v_max_f32 v242, v234, v235
    v_permlane16_swap_b32 v236, v238
    s_nop 0
    v_permlane16_swap_b32 v240, v242
    v_max_f32 v236, v236, v238
    v_max_f32 v240, v240, v242
    s_nop 1
    v_permlane32_swap_b32 v236, v240
    v_max_f32 v236, v236, v240
    v_mul_f32 v236, 0xbfb8aa3b, v236
    v_mov_b32 v240, v236
    s_nop 1
    v_permlane32_swap_b32 v236, v240
    v_mov_b32 v238, v236
    v_mov_b32 v242, v240
    s_mov_b32 s82, 1441792
    s_add_u32 m0, s3, 114688
    s_nop 0
    buffer_load_dwordx4 v17, s[48:51], s82 offen lds
    buffer_load_dwordx4 v18, s[48:51], s82 offen offset:1024 lds
    v_permlane16_swap_b32 v236, v238
    v_permlane16_swap_b32 v240, v242
    v_pk_fma_f32 v[228:229], v[228:229], s[98:99], v[236:237] op_sel_hi:[1,1,0]
    v_pk_fma_f32 v[230:231], v[230:231], s[98:99], v[238:239] op_sel_hi:[1,1,0]
    v_pk_fma_f32 v[232:233], v[232:233], s[98:99], v[240:241] op_sel_hi:[1,1,0]
    v_pk_fma_f32 v[234:235], v[234:235], s[98:99], v[242:243] op_sel_hi:[1,1,0]
    v_exp_f32 v228, v228
    v_exp_f32 v229, v229
    v_exp_f32 v230, v230
    v_exp_f32 v231, v231
    v_exp_f32 v232, v232
    v_exp_f32 v233, v233
    v_exp_f32 v234, v234
    v_exp_f32 v235, v235
    v_add_f32 v236, v228, v229
    v_add_f32 v238, v230, v231
    v_add_f32 v240, v232, v233
    v_add_f32 v242, v234, v235
    v_permlane16_swap_b32 v236, v238
    s_nop 0
    v_permlane16_swap_b32 v240, v242
    v_add_f32 v236, v236, v238
    v_add_f32 v240, v240, v242
    s_nop 1
    v_permlane32_swap_b32 v236, v240
    v_add_f32 v236, v236, v240
    v_rcp_f32 v236, v236
    s_nop 0
    v_mov_b32 v240, v236
    s_nop 1
    v_permlane32_swap_b32 v236, v240
    v_mov_b32 v238, v236
    s_mov_b32 s83, 1671168
    s_add_u32 m0, s3, 122880
    s_nop 0
    buffer_load_dwordx4 v17, s[48:51], s83 offen lds
    buffer_load_dwordx4 v18, s[48:51], s83 offen offset:1024 lds
    v_mov_b32 v242, v240
    v_permlane16_swap_b32 v236, v238
    s_nop 0
    v_permlane16_swap_b32 v240, v242
    v_pk_mul_f32 v[228:229], v[228:229], v[236:237] op_sel_hi:[1,0]
    v_pk_mul_f32 v[230:231], v[230:231], v[238:239] op_sel_hi:[1,0]
    v_pk_mul_f32 v[232:233], v[232:233], v[240:241] op_sel_hi:[1,0]
    v_pk_mul_f32 v[234:235], v[234:235], v[242:243] op_sel_hi:[1,0]
    v_cvt_pk_bf16_f32 v228, v228, v229
    v_cvt_pk_bf16_f32 v230, v230, v231
    v_cvt_pk_bf16_f32 v232, v232, v233
    v_cvt_pk_bf16_f32 v234, v234, v235
    v_perm_b32 v164, v228, v228, v30
    v_perm_b32 v165, v228, v228, v31
    v_perm_b32 v166, v228, v228, v32
    v_perm_b32 v167, v228, v228, v33
    v_perm_b32 v168, v230, v230, v30
    v_perm_b32 v169, v230, v230, v31
    v_perm_b32 v170, v230, v230, v32
    v_perm_b32 v171, v230, v230, v33
    v_perm_b32 v172, v232, v232, v30
    v_perm_b32 v173, v232, v232, v31
    v_perm_b32 v174, v232, v232, v32
    v_perm_b32 v175, v232, v232, v33
    v_perm_b32 v176, v234, v234, v30
    v_perm_b32 v177, v234, v234, v31
    v_perm_b32 v178, v234, v234, v32
    v_perm_b32 v179, v234, v234, v33
    v_mfma_f32_16x16x32_bf16 v[196:199], v[48:51], v[164:167], 0
    v_mfma_f32_16x16x32_bf16 v[200:203], v[84:87], v[164:167], 0
    v_mfma_f32_16x16x32_bf16 v[204:207], v[50:53], v[168:171], 0
    v_mfma_f32_16x16x32_bf16 v[208:211], v[86:89], v[168:171], 0
    v_mfma_f32_16x16x32_bf16 v[212:215], v[52:55], v[172:175], 0
    v_mfma_f32_16x16x32_bf16 v[216:219], v[88:91], v[172:175], 0
    v_mfma_f32_16x16x32_bf16 v[220:223], v[54:57], v[176:179], 0
    v_mfma_f32_16x16x32_bf16 v[224:227], v[90:93], v[176:179], 0
    v_accvgpr_read_b32 v34, a160
    s_mov_b32 s82, 131072
    s_add_u32 m0, s3, 131072
    s_nop 0
    buffer_load_dwordx4 v17, s[48:51], s82 offen lds
    buffer_load_dwordx4 v18, s[48:51], s82 offen offset:1024 lds
    v_accvgpr_read_b32 v35, a161
    v_accvgpr_read_b32 v36, a162
    v_accvgpr_read_b32 v37, a163
    v_accvgpr_read_b32 v38, a164
    v_accvgpr_read_b32 v39, a165
    v_accvgpr_read_b32 v40, a166
    v_accvgpr_read_b32 v41, a167
    v_cvt_pk_bf16_f32 v148, v34, v35
    v_cvt_pk_bf16_f32 v149, v36, v37
    v_cvt_pk_bf16_f32 v150, v38, v39
    v_cvt_pk_bf16_f32 v151, v40, v41
    v_accvgpr_read_b32 v246, a224
    v_accvgpr_read_b32 v247, a225
    v_accvgpr_read_b32 v248, a226
    v_accvgpr_read_b32 v249, a227
    v_accvgpr_read_b32 v250, a228
    v_accvgpr_read_b32 v251, a229
    v_accvgpr_read_b32 v252, a230
    v_accvgpr_read_b32 v253, a231
    v_cvt_pk_bf16_f32 v180, v246, v247
    v_cvt_pk_bf16_f32 v181, v248, v249
    v_cvt_pk_bf16_f32 v182, v250, v251
    v_cvt_pk_bf16_f32 v183, v252, v253
    v_accvgpr_read_b32 v34, a168
    s_mov_b32 s83, 360448
    s_add_u32 m0, s3, 139264
    s_nop 0
    buffer_load_dwordx4 v17, s[48:51], s83 offen lds
    buffer_load_dwordx4 v18, s[48:51], s83 offen offset:1024 lds
    v_accvgpr_read_b32 v35, a169
    v_accvgpr_read_b32 v36, a170
    v_accvgpr_read_b32 v37, a171
    v_accvgpr_read_b32 v38, a172
    v_accvgpr_read_b32 v39, a173
    v_accvgpr_read_b32 v40, a174
    v_accvgpr_read_b32 v41, a175
    v_cvt_pk_bf16_f32 v152, v34, v35
    v_cvt_pk_bf16_f32 v153, v36, v37
    v_cvt_pk_bf16_f32 v154, v38, v39
    v_cvt_pk_bf16_f32 v155, v40, v41
    v_accvgpr_read_b32 v246, a232
    v_accvgpr_read_b32 v247, a233
    v_accvgpr_read_b32 v248, a234
    v_accvgpr_read_b32 v249, a235
    v_accvgpr_read_b32 v250, a236
    v_accvgpr_read_b32 v251, a237
    v_accvgpr_read_b32 v252, a238
    v_accvgpr_read_b32 v253, a239
    v_cvt_pk_bf16_f32 v184, v246, v247
    v_cvt_pk_bf16_f32 v185, v248, v249
    v_cvt_pk_bf16_f32 v186, v250, v251
    v_cvt_pk_bf16_f32 v187, v252, v253
    v_accvgpr_read_b32 v34, a176
    s_mov_b32 s82, 589824
    s_add_u32 m0, s3, 147456
    s_nop 0
    buffer_load_dwordx4 v17, s[48:51], s82 offen lds
    buffer_load_dwordx4 v18, s[48:51], s82 offen offset:1024 lds
    v_accvgpr_read_b32 v35, a177
    v_accvgpr_read_b32 v36, a178
    v_accvgpr_read_b32 v37, a179
    v_accvgpr_read_b32 v38, a180
    v_accvgpr_read_b32 v39, a181
    v_accvgpr_read_b32 v40, a182
    v_accvgpr_read_b32 v41, a183
    v_cvt_pk_bf16_f32 v156, v34, v35
    v_cvt_pk_bf16_f32 v157, v36, v37
    v_cvt_pk_bf16_f32 v158, v38, v39
    v_cvt_pk_bf16_f32 v159, v40, v41
    v_accvgpr_read_b32 v246, a240
    v_accvgpr_read_b32 v247, a241
    v_accvgpr_read_b32 v248, a242
    v_accvgpr_read_b32 v249, a243
    v_accvgpr_read_b32 v250, a244
    v_accvgpr_read_b32 v251, a245
    v_accvgpr_read_b32 v252, a246
    v_accvgpr_read_b32 v253, a247
    v_cvt_pk_bf16_f32 v188, v246, v247
    v_cvt_pk_bf16_f32 v189, v248, v249
    v_cvt_pk_bf16_f32 v190, v250, v251
    v_cvt_pk_bf16_f32 v191, v252, v253
    v_accvgpr_read_b32 v34, a184
    s_mov_b32 s83, 819200
    s_add_u32 m0, s3, 155648
    s_nop 0
    buffer_load_dwordx4 v17, s[48:51], s83 offen lds
    buffer_load_dwordx4 v18, s[48:51], s83 offen offset:1024 lds
    v_accvgpr_read_b32 v35, a185
    v_accvgpr_read_b32 v36, a186
    v_accvgpr_read_b32 v37, a187
    v_accvgpr_read_b32 v38, a188
    v_accvgpr_read_b32 v39, a189
    v_accvgpr_read_b32 v40, a190
    v_accvgpr_read_b32 v41, a191
    v_cvt_pk_bf16_f32 v160, v34, v35
    v_cvt_pk_bf16_f32 v161, v36, v37
    v_cvt_pk_bf16_f32 v162, v38, v39
    v_cvt_pk_bf16_f32 v163, v40, v41
    v_accvgpr_read_b32 v246, a248
    v_accvgpr_read_b32 v247, a249
    v_accvgpr_read_b32 v248, a250
    v_accvgpr_read_b32 v249, a251
    v_accvgpr_read_b32 v250, a252
    v_accvgpr_read_b32 v251, a253
    v_accvgpr_read_b32 v252, a254
    v_accvgpr_read_b32 v253, a255
    v_cvt_pk_bf16_f32 v192, v246, v247
    v_cvt_pk_bf16_f32 v193, v248, v249
    v_cvt_pk_bf16_f32 v194, v250, v251
    v_cvt_pk_bf16_f32 v195, v252, v253
    v_cvt_pk_bf16_f32 v196, v196, v197
    v_cvt_pk_bf16_f32 v197, v198, v199
    v_cvt_pk_bf16_f32 v198, v200, v201
    v_cvt_pk_bf16_f32 v199, v202, v203
    buffer_store_dwordx4 v[196:199], v16, s[56:59], s91 offen offset:0 sc1
    s_add_u32 s91, s91, 32768
    v_cvt_pk_bf16_f32 v204, v204, v205
    v_cvt_pk_bf16_f32 v205, v206, v207
    v_cvt_pk_bf16_f32 v206, v208, v209
    v_cvt_pk_bf16_f32 v207, v210, v211
    buffer_store_dwordx4 v[204:207], v16, s[56:59], s91 offen offset:0 sc1
    s_add_u32 s91, s91, 32768
    v_cvt_pk_bf16_f32 v212, v212, v213
    v_cvt_pk_bf16_f32 v213, v214, v215
    v_cvt_pk_bf16_f32 v214, v216, v217
    v_cvt_pk_bf16_f32 v215, v218, v219
    buffer_store_dwordx4 v[212:215], v16, s[56:59], s91 offen offset:0 sc1
    s_add_u32 s91, s91, 32768
    v_cvt_pk_bf16_f32 v220, v220, v221
    v_cvt_pk_bf16_f32 v221, v222, v223
    v_cvt_pk_bf16_f32 v222, v224, v225
    v_cvt_pk_bf16_f32 v223, v226, v227
    buffer_store_dwordx4 v[220:223], v16, s[56:59], s91 offen offset:0 sc1
    s_add_u32 s91, s91, 32768
    s_mov_b32 s67, 0
    v_mfma_f32_16x16x32_bf16 v[196:199], v[144:147], v[180:183], 0
    v_mfma_f32_16x16x32_bf16 v[200:203], v[148:151], v[180:183], 0
    v_mfma_f32_16x16x32_bf16 v[204:207], v[148:151], v[184:187], 0
    v_mfma_f32_16x16x32_bf16 v[208:211], v[152:155], v[184:187], 0
    v_mfma_f32_16x16x32_bf16 v[212:215], v[152:155], v[188:191], 0
    v_mfma_f32_16x16x32_bf16 v[216:219], v[156:159], v[188:191], 0
    v_mfma_f32_16x16x32_bf16 v[220:223], v[156:159], v[192:195], 0
    v_mfma_f32_16x16x32_bf16 v[224:227], v[160:163], v[192:195], 0
    s_nop 0
    v_cvt_pk_bf16_f32 v196, v196, v197
    v_cvt_pk_bf16_f32 v198, v198, v199
    v_cvt_pk_bf16_f32 v200, v200, v201
    v_cvt_pk_bf16_f32 v202, v202, v203
    v_cvt_pk_bf16_f32 v204, v204, v205
    v_cvt_pk_bf16_f32 v206, v206, v207
    v_cvt_pk_bf16_f32 v208, v208, v209
    v_cvt_pk_bf16_f32 v210, v210, v211
    v_cvt_pk_bf16_f32 v212, v212, v213
    v_cvt_pk_bf16_f32 v214, v214, v215
    v_cvt_pk_bf16_f32 v216, v216, v217
    v_cvt_pk_bf16_f32 v218, v218, v219
    v_cvt_pk_bf16_f32 v220, v220, v221
    v_cvt_pk_bf16_f32 v222, v222, v223
    v_cvt_pk_bf16_f32 v224, v224, v225
    v_cvt_pk_bf16_f32 v226, v226, v227
    v_perm_b32 v228, v200, v196, v28
    v_perm_b32 v229, v202, v198, v29
    v_perm_b32 v230, v208, v204, v28
    v_perm_b32 v231, v210, v206, v29
    v_perm_b32 v232, v216, v212, v28
    v_perm_b32 v233, v218, v214, v29
    v_perm_b32 v234, v224, v220, v28
    v_perm_b32 v235, v226, v222, v29
    v_pk_mul_f32 v[228:229], v[228:229], s[14:15]
    v_pk_mul_f32 v[230:231], v[230:231], s[14:15]
    v_pk_mul_f32 v[232:233], v[232:233], s[14:15]
    v_pk_mul_f32 v[234:235], v[234:235], s[14:15]
    v_cvt_pk_bf16_f32 v229, v228, v229
    v_cvt_pk_bf16_f32 v231, v230, v231
    v_cvt_pk_bf16_f32 v233, v232, v233
    v_cvt_pk_bf16_f32 v235, v234, v235
    v_lshlrev_b32 v228, 16, v229
    v_and_b32 v229, 0xffff0000, v229
    v_lshlrev_b32 v230, 16, v231
    v_and_b32 v231, 0xffff0000, v231
    v_lshlrev_b32 v232, 16, v233
    v_and_b32 v233, 0xffff0000, v233
    v_lshlrev_b32 v234, 16, v235
    v_and_b32 v235, 0xffff0000, v235
    buffer_load_dword v43, off, s[56:59], s92 sc1
    v_max_f32 v236, v228, v229
    v_max_f32 v238, v230, v231
    v_max_f32 v240, v232, v233
    v_max_f32 v242, v234, v235
    v_permlane16_swap_b32 v236, v238
    s_nop 0
    v_permlane16_swap_b32 v240, v242
    v_max_f32 v236, v236, v238
    v_max_f32 v240, v240, v242
    s_nop 1
    v_permlane32_swap_b32 v236, v240
    v_max_f32 v236, v236, v240
    s_branch L_over5
L_stub5:
    s_branch L_stub6
L_over5:
    v_mul_f32 v236, 0xbfb8aa3b, v236
    v_mov_b32 v240, v236
    s_nop 1
    v_permlane32_swap_b32 v236, v240
    v_mov_b32 v238, v236
    v_mov_b32 v242, v240
    s_nop 0
    v_permlane16_swap_b32 v236, v238
    v_permlane16_swap_b32 v240, v242
    v_pk_fma_f32 v[228:229], v[228:229], s[98:99], v[236:237] op_sel_hi:[1,1,0]
    v_pk_fma_f32 v[230:231], v[230:231], s[98:99], v[238:239] op_sel_hi:[1,1,0]
    v_pk_fma_f32 v[232:233], v[232:233], s[98:99], v[240:241] op_sel_hi:[1,1,0]
    v_pk_fma_f32 v[234:235], v[234:235], s[98:99], v[242:243] op_sel_hi:[1,1,0]
    v_exp_f32 v228, v228
    v_exp_f32 v229, v229
    v_exp_f32 v230, v230
    v_exp_f32 v231, v231
    v_exp_f32 v232, v232
    v_exp_f32 v233, v233
    v_exp_f32 v234, v234
    v_exp_f32 v235, v235
    v_add_f32 v236, v228, v229
    v_add_f32 v238, v230, v231
    v_add_f32 v240, v232, v233
    v_add_f32 v242, v234, v235
    v_permlane16_swap_b32 v236, v238
    s_nop 0
    v_permlane16_swap_b32 v240, v242
    v_add_f32 v236, v236, v238
    v_add_f32 v240, v240, v242
    s_nop 1
    v_permlane32_swap_b32 v236, v240
    v_add_f32 v236, v236, v240
    v_rcp_f32 v236, v236
    s_nop 0
    v_mov_b32 v240, v236
    s_nop 1
    v_permlane32_swap_b32 v236, v240
    v_mov_b32 v238, v236
    v_mov_b32 v242, v240
    s_nop 0
    v_permlane16_swap_b32 v236, v238
    v_permlane16_swap_b32 v240, v242
    v_pk_mul_f32 v[228:229], v[228:229], v[236:237] op_sel_hi:[1,0]
    v_pk_mul_f32 v[230:231], v[230:231], v[238:239] op_sel_hi:[1,0]
    v_pk_mul_f32 v[232:233], v[232:233], v[240:241] op_sel_hi:[1,0]
    v_pk_mul_f32 v[234:235], v[234:235], v[242:243] op_sel_hi:[1,0]
    v_cvt_pk_bf16_f32 v228, v228, v229
    v_cvt_pk_bf16_f32 v230, v230, v231
    v_cvt_pk_bf16_f32 v232, v232, v233
    v_cvt_pk_bf16_f32 v234, v234, v235
    v_perm_b32 v180, v228, v228, v30
    v_perm_b32 v181, v228, v228, v31
    v_perm_b32 v182, v228, v228, v32
    v_perm_b32 v183, v228, v228, v33
    v_perm_b32 v184, v230, v230, v30
    v_perm_b32 v185, v230, v230, v31
    v_perm_b32 v186, v230, v230, v32
    v_perm_b32 v187, v230, v230, v33
    v_perm_b32 v188, v232, v232, v30
    v_perm_b32 v189, v232, v232, v31
    v_perm_b32 v190, v232, v232, v32
    v_perm_b32 v191, v232, v232, v33
    v_perm_b32 v192, v234, v234, v30
    v_perm_b32 v193, v234, v234, v31
    v_perm_b32 v194, v234, v234, v32
    v_perm_b32 v195, v234, v234, v33
    v_mfma_f32_16x16x32_bf16 v[196:199], v[56:59], v[180:183], 0
    v_mfma_f32_16x16x32_bf16 v[200:203], v[92:95], v[180:183], 0
    v_mfma_f32_16x16x32_bf16 v[204:207], v[58:61], v[184:187], 0
    v_mfma_f32_16x16x32_bf16 v[208:211], v[94:97], v[184:187], 0
    v_mfma_f32_16x16x32_bf16 v[212:215], v[60:63], v[188:191], 0
    v_mfma_f32_16x16x32_bf16 v[216:219], v[96:99], v[188:191], 0
    v_mfma_f32_16x16x32_bf16 v[220:223], v[62:65], v[192:195], 0
    v_mfma_f32_16x16x32_bf16 v[224:227], v[98:101], v[192:195], 0
    s_nop 0
    v_cvt_pk_bf16_f32 v196, v196, v197
    v_cvt_pk_bf16_f32 v197, v198, v199
    v_cvt_pk_bf16_f32 v198, v200, v201
    v_cvt_pk_bf16_f32 v199, v202, v203
    buffer_store_dwordx4 v[196:199], v16, s[56:59], s91 offen offset:0 sc1
    s_add_u32 s91, s91, 32768
    v_cvt_pk_bf16_f32 v204, v204, v205
    v_cvt_pk_bf16_f32 v205, v206, v207
    v_cvt_pk_bf16_f32 v206, v208, v209
    v_cvt_pk_bf16_f32 v207, v210, v211
    buffer_store_dwordx4 v[204:207], v16, s[56:59], s91 offen offset:0 sc1
    s_add_u32 s91, s91, 32768
    v_cvt_pk_bf16_f32 v212, v212, v213
    v_cvt_pk_bf16_f32 v213, v214, v215
    v_cvt_pk_bf16_f32 v214, v216, v217
    v_cvt_pk_bf16_f32 v215, v218, v219
    buffer_store_dwordx4 v[212:215], v16, s[56:59], s91 offen offset:0 sc1
    s_add_u32 s91, s91, 32768
    v_cvt_pk_bf16_f32 v220, v220, v221
    v_cvt_pk_bf16_f32 v221, v222, v223
    v_cvt_pk_bf16_f32 v222, v224, v225
    v_cvt_pk_bf16_f32 v223, v226, v227
    buffer_store_dwordx4 v[220:223], v16, s[56:59], s91 offen offset:0 sc1
    s_add_u32 s91, s91, 32768
    s_waitcnt vmcnt(4)
    v_readfirstlane_b32 s86, v43
    s_bfe_u32 s86, s86, 0x80000
    s_cmp_eq_u32 s86, 32
    s_cbranch_scc0 L_spA0
L_okA0:
    buffer_load_dwordx4 a[0:3], v21, s[56:59], s68 offen sc1
    buffer_load_dwordx4 a[4:7], v22, s[56:59], s68 offen sc1
    buffer_load_dwordx4 a[8:11], v23, s[56:59], s68 offen sc1
    buffer_load_dwordx4 a[12:15], v24, s[56:59], s68 offen sc1
    s_add_u32 s68, s68, 16384
    buffer_load_dwordx4 a[16:19], v21, s[56:59], s68 offen sc1
    buffer_load_dwordx4 a[20:23], v22, s[56:59], s68 offen sc1
    buffer_load_dwordx4 a[24:27], v23, s[56:59], s68 offen sc1
    buffer_load_dwordx4 a[28:31], v24, s[56:59], s68 offen sc1
    s_add_u32 s68, s68, 16384
    buffer_load_dwordx4 a[32:35], v21, s[56:59], s68 offen sc1
    buffer_load_dwordx4 a[36:39], v22, s[56:59], s68 offen sc1
    buffer_load_dwordx4 a[40:43], v23, s[56:59], s68 offen sc1
    buffer_load_dwordx4 a[44:47], v24, s[56:59], s68 offen sc1
    s_add_u32 s68, s68, 16384
    buffer_load_dwordx4 a[48:51], v21, s[56:59], s68 offen sc1
    buffer_load_dwordx4 a[52:55], v22, s[56:59], s68 offen sc1
    buffer_load_dwordx4 a[56:59], v23, s[56:59], s68 offen sc1
    buffer_load_dwordx4 a[60:63], v24, s[56:59], s68 offen sc1
    s_add_u32 s68, s68, 16384
    buffer_load_dwordx4 a[64:67], v21, s[56:59], s68 offen sc1
    buffer_load_dwordx4 a[68:71], v22, s[56:59], s68 offen sc1
    buffer_load_dwordx4 a[72:75], v23, s[56:59], s68 offen sc1
    buffer_load_dwordx4 a[76:79], v24, s[56:59], s68 offen sc1
    s_add_u32 s68, s68, 16384
    buffer_load_dwordx4 a[80:83], v21, s[56:59], s68 offen sc1
    buffer_load_dwordx4 a[84:87], v22, s[56:59], s68 offen sc1
    buffer_load_dwordx4 a[88:91], v23, s[56:59], s68 offen sc1
    buffer_load_dwordx4 a[92:95], v24, s[56:59], s68 offen sc1
    s_add_u32 s68, s68, 16384
    buffer_load_dwordx4 a[96:99], v21, s[56:59], s68 offen sc1
    buffer_load_dwordx4 a[100:103], v22, s[56:59], s68 offen sc1
    buffer_load_dwordx4 a[104:107], v23, s[56:59], s68 offen sc1
    buffer_load_dwordx4 a[108:111], v24, s[56:59], s68 offen sc1
    s_add_u32 s68, s68, 16384
    buffer_load_dwordx4 a[112:115], v21, s[56:59], s68 offen sc1
    buffer_load_dwordx4 a[116:119], v22, s[56:59], s68 offen sc1
    buffer_load_dwordx4 a[120:123], v23, s[56:59], s68 offen sc1
    buffer_load_dwordx4 a[124:127], v24, s[56:59], s68 offen sc1
    s_add_u32 s68, s68, 16384
    s_barrier
    s_branch L_D
L_stub6:
    s_branch L_stub7
L_epi1:
    s_mov_b32 s67, 0
    v_accvgpr_read_b32 v128, a128
    v_accvgpr_read_b32 v129, a129
    v_accvgpr_read_b32 v130, a130
    v_accvgpr_read_b32 v131, a131
    v_accvgpr_read_b32 v132, a132
    s_mov_b32 s82, 65536
    s_add_u32 m0, s3, 65536
    s_nop 0
    buffer_load_dwordx4 v17, s[48:51], s82 offen lds
    buffer_load_dwordx4 v18, s[48:51], s82 offen offset:1024 lds
    v_accvgpr_read_b32 v133, a133
    v_accvgpr_read_b32 v134, a134
    v_accvgpr_read_b32 v135, a135
    v_accvgpr_read_b32 v136, a136
    v_accvgpr_read_b32 v137, a137
    v_accvgpr_read_b32 v138, a138
    v_accvgpr_read_b32 v139, a139
    v_accvgpr_read_b32 v140, a140
    v_accvgpr_read_b32 v141, a141
    v_accvgpr_read_b32 v142, a142
    v_accvgpr_read_b32 v143, a143
    v_pk_mul_f32 v[34:35], v[128:129], v[128:129]
    v_pk_mul_f32 v[36:37], v[130:131], v[130:131]
    v_pk_mul_f32 v[38:39], v[132:133], v[132:133]
    v_pk_mul_f32 v[40:41], v[134:135], v[134:135]
    v_pk_fma_f32 v[34:35], v[34:35], s[94:95], v[26:27]
    v_pk_fma_f32 v[36:37], v[36:37], s[94:95], v[26:27]
    v_pk_fma_f32 v[38:39], v[38:39], s[94:95], v[26:27]
    v_pk_fma_f32 v[40:41], v[40:41], s[94:95], v[26:27]
    v_pk_mul_f32 v[34:35], v[34:35], v[128:129]
    v_pk_mul_f32 v[36:37], v[36:37], v[130:131]
    v_pk_mul_f32 v[38:39], v[38:39], v[132:133]
    v_pk_mul_f32 v[40:41], v[40:41], v[134:135]
    v_exp_f32 v34, v34
    v_exp_f32 v35, v35
    v_exp_f32 v36, v36
    v_exp_f32 v37, v37
    v_exp_f32 v38, v38
    s_mov_b32 s83, 294912
    s_add_u32 m0, s3, 73728
    s_nop 0
    buffer_load_dwordx4 v17, s[48:51], s83 offen lds
    buffer_load_dwordx4 v18, s[48:51], s83 offen offset:1024 lds
    v_exp_f32 v39, v39
    v_exp_f32 v40, v40
    v_exp_f32 v41, v41
    v_pk_mul_f32 v[136:137], v[136:137], v[128:129]
    v_pk_mul_f32 v[138:139], v[138:139], v[130:131]
    v_pk_mul_f32 v[140:141], v[140:141], v[132:133]
    v_pk_mul_f32 v[142:143], v[142:143], v[134:135]
    v_pk_add_f32 v[34:35], v[34:35], 1.0 op_sel_hi:[1,0]
    v_pk_add_f32 v[36:37], v[36:37], 1.0 op_sel_hi:[1,0]
    v_pk_add_f32 v[38:39], v[38:39], 1.0 op_sel_hi:[1,0]
    v_pk_add_f32 v[40:41], v[40:41], 1.0 op_sel_hi:[1,0]
    v_rcp_f32 v34, v34
    v_rcp_f32 v35, v35
    v_rcp_f32 v36, v36
    v_rcp_f32 v37, v37
    v_rcp_f32 v38, v38
    v_rcp_f32 v39, v39
    v_rcp_f32 v40, v40
    v_rcp_f32 v41, v41
    v_pk_mul_f32 v[136:137], v[136:137], v[34:35]
    v_pk_mul_f32 v[138:139], v[138:139], v[36:37]
    v_pk_mul_f32 v[140:141], v[140:141], v[38:39]
    v_pk_mul_f32 v[142:143], v[142:143], v[40:41]
    v_cvt_pk_bf16_f32 v128, v136, v137
    v_cvt_pk_bf16_f32 v129, v138, v139
    v_cvt_pk_bf16_f32 v130, v140, v141
    v_cvt_pk_bf16_f32 v131, v142, v143
    buffer_store_dwordx4 v[128:131], v16, s[56:59], s89 offen offset:0 sc1
    s_waitcnt vmcnt(5)
    s_mov_b64 exec, 1
    buffer_atomic_add v25, off, s[56:59], s92 sc1
    s_mov_b64 exec, -1
    v_accvgpr_read_b32 v144, a144
    v_accvgpr_read_b32 v145, a145
    v_accvgpr_read_b32 v146, a146
    v_accvgpr_read_b32 v147, a147
    v_accvgpr_read_b32 v148, a148
    s_mov_b32 s82, 524288
    s_add_u32 m0, s3, 81920
    s_nop 0
    buffer_load_dwordx4 v17, s[48:51], s82 offen lds
    buffer_load_dwordx4 v18, s[48:51], s82 offen offset:1024 lds
    v_accvgpr_read_b32 v149, a149
    v_accvgpr_read_b32 v150, a150
    v_accvgpr_read_b32 v151, a151
    v_accvgpr_read_b32 v152, a152
    v_accvgpr_read_b32 v153, a153
    v_accvgpr_read_b32 v154, a154
    v_accvgpr_read_b32 v155, a155
    v_accvgpr_read_b32 v156, a156
    v_accvgpr_read_b32 v157, a157
    v_accvgpr_read_b32 v158, a158
    v_accvgpr_read_b32 v159, a159
    v_pk_mul_f32 v[34:35], v[144:145], v[144:145]
    v_pk_mul_f32 v[36:37], v[146:147], v[146:147]
    v_pk_mul_f32 v[38:39], v[148:149], v[148:149]
    v_pk_mul_f32 v[40:41], v[150:151], v[150:151]
    v_pk_fma_f32 v[34:35], v[34:35], s[94:95], v[26:27]
    v_pk_fma_f32 v[36:37], v[36:37], s[94:95], v[26:27]
    v_pk_fma_f32 v[38:39], v[38:39], s[94:95], v[26:27]
    v_pk_fma_f32 v[40:41], v[40:41], s[94:95], v[26:27]
    v_pk_mul_f32 v[34:35], v[34:35], v[144:145]
    v_pk_mul_f32 v[36:37], v[36:37], v[146:147]
    v_pk_mul_f32 v[38:39], v[38:39], v[148:149]
    v_pk_mul_f32 v[40:41], v[40:41], v[150:151]
    v_exp_f32 v34, v34
    v_exp_f32 v35, v35
    v_exp_f32 v36, v36
    v_exp_f32 v37, v37
    v_exp_f32 v38, v38
    s_mov_b32 s83, 753664
    s_add_u32 m0, s3, 90112
    s_nop 0
    buffer_load_dwordx4 v17, s[48:51], s83 offen lds
    buffer_load_dwordx4 v18, s[48:51], s83 offen offset:1024 lds
    v_exp_f32 v39, v39
    v_exp_f32 v40, v40
    v_exp_f32 v41, v41
    v_pk_mul_f32 v[152:153], v[152:153], v[144:145]
    v_pk_mul_f32 v[154:155], v[154:155], v[146:147]
    v_pk_mul_f32 v[156:157], v[156:157], v[148:149]
    v_pk_mul_f32 v[158:159], v[158:159], v[150:151]
    v_pk_add_f32 v[34:35], v[34:35], 1.0 op_sel_hi:[1,0]
    v_pk_add_f32 v[36:37], v[36:37], 1.0 op_sel_hi:[1,0]
    v_pk_add_f32 v[38:39], v[38:39], 1.0 op_sel_hi:[1,0]
    v_pk_add_f32 v[40:41], v[40:41], 1.0 op_sel_hi:[1,0]
    v_rcp_f32 v34, v34
    v_rcp_f32 v35, v35
    v_rcp_f32 v36, v36
    v_rcp_f32 v37, v37
    v_rcp_f32 v38, v38
    v_rcp_f32 v39, v39
    v_rcp_f32 v40, v40
    v_rcp_f32 v41, v41
    v_pk_mul_f32 v[152:153], v[152:153], v[34:35]
    v_pk_mul_f32 v[154:155], v[154:155], v[36:37]
    v_pk_mul_f32 v[156:157], v[156:157], v[38:39]
    v_pk_mul_f32 v[158:159], v[158:159], v[40:41]
    v_cvt_pk_bf16_f32 v144, v152, v153
    v_cvt_pk_bf16_f32 v145, v154, v155
    v_cvt_pk_bf16_f32 v146, v156, v157
    v_cvt_pk_bf16_f32 v147, v158, v159
    buffer_store_dwordx4 v[144:147], v16, s[56:59], s89 offen offset:1024 sc1
    v_accvgpr_read_b32 v160, a160
    v_accvgpr_read_b32 v161, a161
    v_accvgpr_read_b32 v162, a162
    v_accvgpr_read_b32 v163, a163
    v_accvgpr_read_b32 v164, a164
    s_mov_b32 s82, 983040
    s_add_u32 m0, s3, 98304
    s_nop 0
    buffer_load_dwordx4 v17, s[48:51], s82 offen lds
    buffer_load_dwordx4 v18, s[48:51], s82 offen offset:1024 lds
    v_accvgpr_read_b32 v165, a165
    v_accvgpr_read_b32 v166, a166
    v_accvgpr_read_b32 v167, a167
    v_accvgpr_read_b32 v168, a168
    v_accvgpr_read_b32 v169, a169
    v_accvgpr_read_b32 v170, a170
    v_accvgpr_read_b32 v171, a171
    v_accvgpr_read_b32 v172, a172
    v_accvgpr_read_b32 v173, a173
    v_accvgpr_read_b32 v174, a174
    v_accvgpr_read_b32 v175, a175
    v_pk_mul_f32 v[34:35], v[160:161], v[160:161]
    v_pk_mul_f32 v[36:37], v[162:163], v[162:163]
    v_pk_mul_f32 v[38:39], v[164:165], v[164:165]
    v_pk_mul_f32 v[40:41], v[166:167], v[166:167]
    v_pk_fma_f32 v[34:35], v[34:35], s[94:95], v[26:27]
    v_pk_fma_f32 v[36:37], v[36:37], s[94:95], v[26:27]
    v_pk_fma_f32 v[38:39], v[38:39], s[94:95], v[26:27]
    v_pk_fma_f32 v[40:41], v[40:41], s[94:95], v[26:27]
    v_pk_mul_f32 v[34:35], v[34:35], v[160:161]
    v_pk_mul_f32 v[36:37], v[36:37], v[162:163]
    v_pk_mul_f32 v[38:39], v[38:39], v[164:165]
    v_pk_mul_f32 v[40:41], v[40:41], v[166:167]
    v_exp_f32 v34, v34
    v_exp_f32 v35, v35
    v_exp_f32 v36, v36
    v_exp_f32 v37, v37
    v_exp_f32 v38, v38
    s_mov_b32 s83, 1212416
    s_add_u32 m0, s3, 106496
    s_nop 0
    buffer_load_dwordx4 v17, s[48:51], s83 offen lds
    buffer_load_dwordx4 v18, s[48:51], s83 offen offset:1024 lds
    v_exp_f32 v39, v39
    v_exp_f32 v40, v40
    v_exp_f32 v41, v41
    v_pk_mul_f32 v[168:169], v[168:169], v[160:161]
    v_pk_mul_f32 v[170:171], v[170:171], v[162:163]
    v_pk_mul_f32 v[172:173], v[172:173], v[164:165]
    v_pk_mul_f32 v[174:175], v[174:175], v[166:167]
    v_pk_add_f32 v[34:35], v[34:35], 1.0 op_sel_hi:[1,0]
    v_pk_add_f32 v[36:37], v[36:37], 1.0 op_sel_hi:[1,0]
    v_pk_add_f32 v[38:39], v[38:39], 1.0 op_sel_hi:[1,0]
    v_pk_add_f32 v[40:41], v[40:41], 1.0 op_sel_hi:[1,0]
    v_rcp_f32 v34, v34
    v_rcp_f32 v35, v35
    v_rcp_f32 v36, v36
    v_rcp_f32 v37, v37
    v_rcp_f32 v38, v38
    v_rcp_f32 v39, v39
    v_rcp_f32 v40, v40
    v_rcp_f32 v41, v41
    v_pk_mul_f32 v[168:169], v[168:169], v[34:35]
    v_pk_mul_f32 v[170:171], v[170:171], v[36:37]
    v_pk_mul_f32 v[172:173], v[172:173], v[38:39]
    v_pk_mul_f32 v[174:175], v[174:175], v[40:41]
    v_cvt_pk_bf16_f32 v160, v168, v169
    v_cvt_pk_bf16_f32 v161, v170, v171
    v_cvt_pk_bf16_f32 v162, v172, v173
    v_cvt_pk_bf16_f32 v163, v174, v175
    buffer_store_dwordx4 v[160:163], v16, s[56:59], s89 offen offset:2048 sc1
    v_accvgpr_read_b32 v176, a176
    v_accvgpr_read_b32 v177, a177
    v_accvgpr_read_b32 v178, a178
    v_accvgpr_read_b32 v179, a179
    v_accvgpr_read_b32 v180, a180
    s_mov_b32 s82, 1441792
    s_add_u32 m0, s3, 114688
    s_nop 0
    buffer_load_dwordx4 v17, s[48:51], s82 offen lds
    buffer_load_dwordx4 v18, s[48:51], s82 offen offset:1024 lds
    v_accvgpr_read_b32 v181, a181
    v_accvgpr_read_b32 v182, a182
    v_accvgpr_read_b32 v183, a183
    v_accvgpr_read_b32 v184, a184
    v_accvgpr_read_b32 v185, a185
    v_accvgpr_read_b32 v186, a186
    v_accvgpr_read_b32 v187, a187
    v_accvgpr_read_b32 v188, a188
    v_accvgpr_read_b32 v189, a189
    v_accvgpr_read_b32 v190, a190
    v_accvgpr_read_b32 v191, a191
    v_pk_mul_f32 v[34:35], v[176:177], v[176:177]
    v_pk_mul_f32 v[36:37], v[178:179], v[178:179]
    v_pk_mul_f32 v[38:39], v[180:181], v[180:181]
    v_pk_mul_f32 v[40:41], v[182:183], v[182:183]
    v_pk_fma_f32 v[34:35], v[34:35], s[94:95], v[26:27]
    v_pk_fma_f32 v[36:37], v[36:37], s[94:95], v[26:27]
    v_pk_fma_f32 v[38:39], v[38:39], s[94:95], v[26:27]
    v_pk_fma_f32 v[40:41], v[40:41], s[94:95], v[26:27]
    v_pk_mul_f32 v[34:35], v[34:35], v[176:177]
    v_pk_mul_f32 v[36:37], v[36:37], v[178:179]
    v_pk_mul_f32 v[38:39], v[38:39], v[180:181]
    v_pk_mul_f32 v[40:41], v[40:41], v[182:183]
    v_exp_f32 v34, v34
    v_exp_f32 v35, v35
    v_exp_f32 v36, v36
    v_exp_f32 v37, v37
    v_exp_f32 v38, v38
    s_mov_b32 s83, 1671168
    s_add_u32 m0, s3, 122880
    s_nop 0
    buffer_load_dwordx4 v17, s[48:51], s83 offen lds
    buffer_load_dwordx4 v18, s[48:51], s83 offen offset:1024 lds
    v_exp_f32 v39, v39
    v_exp_f32 v40, v40
    v_exp_f32 v41, v41
    v_pk_mul_f32 v[184:185], v[184:185], v[176:177]
    v_pk_mul_f32 v[186:187], v[186:187], v[178:179]
    v_pk_mul_f32 v[188:189], v[188:189], v[180:181]
    v_pk_mul_f32 v[190:191], v[190:191], v[182:183]
    v_pk_add_f32 v[34:35], v[34:35], 1.0 op_sel_hi:[1,0]
    v_pk_add_f32 v[36:37], v[36:37], 1.0 op_sel_hi:[1,0]
    v_pk_add_f32 v[38:39], v[38:39], 1.0 op_sel_hi:[1,0]
    v_pk_add_f32 v[40:41], v[40:41], 1.0 op_sel_hi:[1,0]
    v_rcp_f32 v34, v34
    v_rcp_f32 v35, v35
    v_rcp_f32 v36, v36
    v_rcp_f32 v37, v37
    v_rcp_f32 v38, v38
    v_rcp_f32 v39, v39
    v_rcp_f32 v40, v40
    v_rcp_f32 v41, v41
    v_pk_mul_f32 v[184:185], v[184:185], v[34:35]
    v_pk_mul_f32 v[186:187], v[186:187], v[36:37]
    v_pk_mul_f32 v[188:189], v[188:189], v[38:39]
    v_pk_mul_f32 v[190:191], v[190:191], v[40:41]
    v_cvt_pk_bf16_f32 v176, v184, v185
    v_cvt_pk_bf16_f32 v177, v186, v187
    v_cvt_pk_bf16_f32 v178, v188, v189
    v_cvt_pk_bf16_f32 v179, v190, v191
    buffer_store_dwordx4 v[176:179], v16, s[56:59], s89 offen offset:3072 sc1
    v_accvgpr_read_b32 v128, a192
    v_accvgpr_read_b32 v129, a193
    v_accvgpr_read_b32 v130, a194
    v_accvgpr_read_b32 v131, a195
    v_accvgpr_read_b32 v132, a196
    s_mov_b32 s82, 131072
    s_add_u32 m0, s3, 131072
    s_nop 0
    buffer_load_dwordx4 v17, s[48:51], s82 offen lds
    buffer_load_dwordx4 v18, s[48:51], s82 offen offset:1024 lds
    v_accvgpr_read_b32 v133, a197
    v_accvgpr_read_b32 v134, a198
    v_accvgpr_read_b32 v135, a199
    v_accvgpr_read_b32 v136, a200
    v_accvgpr_read_b32 v137, a201
    v_accvgpr_read_b32 v138, a202
    v_accvgpr_read_b32 v139, a203
    v_accvgpr_read_b32 v140, a204
    v_accvgpr_read_b32 v141, a205
    v_accvgpr_read_b32 v142, a206
    v_accvgpr_read_b32 v143, a207
    v_pk_mul_f32 v[34:35], v[128:129], v[128:129]
    v_pk_mul_f32 v[36:37], v[130:131], v[130:131]
    v_pk_mul_f32 v[38:39], v[132:133], v[132:133]
    v_pk_mul_f32 v[40:41], v[134:135], v[134:135]
    v_pk_fma_f32 v[34:35], v[34:35], s[94:95], v[26:27]
    v_pk_fma_f32 v[36:37], v[36:37], s[94:95], v[26:27]
    v_pk_fma_f32 v[38:39], v[38:39], s[94:95], v[26:27]
    v_pk_fma_f32 v[40:41], v[40:41], s[94:95], v[26:27]
    v_pk_mul_f32 v[34:35], v[34:35], v[128:129]
    v_pk_mul_f32 v[36:37], v[36:37], v[130:131]
    v_pk_mul_f32 v[38:39], v[38:39], v[132:133]
    v_pk_mul_f32 v[40:41], v[40:41], v[134:135]
    v_exp_f32 v34, v34
    v_exp_f32 v35, v35
    v_exp_f32 v36, v36
    v_exp_f32 v37, v37
    v_exp_f32 v38, v38
    s_mov_b32 s83, 360448
    s_add_u32 m0, s3, 139264
    s_nop 0
    buffer_load_dwordx4 v17, s[48:51], s83 offen lds
    buffer_load_dwordx4 v18, s[48:51], s83 offen offset:1024 lds
    v_exp_f32 v39, v39
    v_exp_f32 v40, v40
    v_exp_f32 v41, v41
    v_pk_mul_f32 v[136:137], v[136:137], v[128:129]
    v_pk_mul_f32 v[138:139], v[138:139], v[130:131]
    v_pk_mul_f32 v[140:141], v[140:141], v[132:133]
    v_pk_mul_f32 v[142:143], v[142:143], v[134:135]
    v_pk_add_f32 v[34:35], v[34:35], 1.0 op_sel_hi:[1,0]
    v_pk_add_f32 v[36:37], v[36:37], 1.0 op_sel_hi:[1,0]
    v_pk_add_f32 v[38:39], v[38:39], 1.0 op_sel_hi:[1,0]
    v_pk_add_f32 v[40:41], v[40:41], 1.0 op_sel_hi:[1,0]
    v_rcp_f32 v34, v34
    v_rcp_f32 v35, v35
    v_rcp_f32 v36, v36
    v_rcp_f32 v37, v37
    v_rcp_f32 v38, v38
    v_rcp_f32 v39, v39
    v_rcp_f32 v40, v40
    v_rcp_f32 v41, v41
    v_pk_mul_f32 v[136:137], v[136:137], v[34:35]
    v_pk_mul_f32 v[138:139], v[138:139], v[36:37]
    v_pk_mul_f32 v[140:141], v[140:141], v[38:39]
    v_pk_mul_f32 v[142:143], v[142:143], v[40:41]
    v_cvt_pk_bf16_f32 v128, v136, v137
    v_cvt_pk_bf16_f32 v129, v138, v139
    v_cvt_pk_bf16_f32 v130, v140, v141
    v_cvt_pk_bf16_f32 v131, v142, v143
    s_add_u32 s89, s89, 4096
    buffer_store_dwordx4 v[128:131], v16, s[56:59], s89 offen offset:0 sc1
    v_accvgpr_read_b32 v144, a208
    v_accvgpr_read_b32 v145, a209
    v_accvgpr_read_b32 v146, a210
    v_accvgpr_read_b32 v147, a211
    v_accvgpr_read_b32 v148, a212
    s_mov_b32 s82, 589824
    s_add_u32 m0, s3, 147456
    s_nop 0
    buffer_load_dwordx4 v17, s[48:51], s82 offen lds
    buffer_load_dwordx4 v18, s[48:51], s82 offen offset:1024 lds
    v_accvgpr_read_b32 v149, a213
    v_accvgpr_read_b32 v150, a214
    v_accvgpr_read_b32 v151, a215
    v_accvgpr_read_b32 v152, a216
    v_accvgpr_read_b32 v153, a217
    v_accvgpr_read_b32 v154, a218
    v_accvgpr_read_b32 v155, a219
    v_accvgpr_read_b32 v156, a220
    v_accvgpr_read_b32 v157, a221
    v_accvgpr_read_b32 v158, a222
    v_accvgpr_read_b32 v159, a223
    v_pk_mul_f32 v[34:35], v[144:145], v[144:145]
    v_pk_mul_f32 v[36:37], v[146:147], v[146:147]
    v_pk_mul_f32 v[38:39], v[148:149], v[148:149]
    v_pk_mul_f32 v[40:41], v[150:151], v[150:151]
    v_pk_fma_f32 v[34:35], v[34:35], s[94:95], v[26:27]
    v_pk_fma_f32 v[36:37], v[36:37], s[94:95], v[26:27]
    v_pk_fma_f32 v[38:39], v[38:39], s[94:95], v[26:27]
    v_pk_fma_f32 v[40:41], v[40:41], s[94:95], v[26:27]
    v_pk_mul_f32 v[34:35], v[34:35], v[144:145]
    v_pk_mul_f32 v[36:37], v[36:37], v[146:147]
    v_pk_mul_f32 v[38:39], v[38:39], v[148:149]
    v_pk_mul_f32 v[40:41], v[40:41], v[150:151]
    v_exp_f32 v34, v34
    v_exp_f32 v35, v35
    v_exp_f32 v36, v36
    v_exp_f32 v37, v37
    v_exp_f32 v38, v38
    s_mov_b32 s83, 819200
    s_add_u32 m0, s3, 155648
    s_nop 0
    buffer_load_dwordx4 v17, s[48:51], s83 offen lds
    buffer_load_dwordx4 v18, s[48:51], s83 offen offset:1024 lds
    v_exp_f32 v39, v39
    v_exp_f32 v40, v40
    v_exp_f32 v41, v41
    v_pk_mul_f32 v[152:153], v[152:153], v[144:145]
    v_pk_mul_f32 v[154:155], v[154:155], v[146:147]
    v_pk_mul_f32 v[156:157], v[156:157], v[148:149]
    v_pk_mul_f32 v[158:159], v[158:159], v[150:151]
    v_pk_add_f32 v[34:35], v[34:35], 1.0 op_sel_hi:[1,0]
    v_pk_add_f32 v[36:37], v[36:37], 1.0 op_sel_hi:[1,0]
    v_pk_add_f32 v[38:39], v[38:39], 1.0 op_sel_hi:[1,0]
    v_pk_add_f32 v[40:41], v[40:41], 1.0 op_sel_hi:[1,0]
    v_rcp_f32 v34, v34
    v_rcp_f32 v35, v35
    v_rcp_f32 v36, v36
    v_rcp_f32 v37, v37
    v_rcp_f32 v38, v38
    v_rcp_f32 v39, v39
    v_rcp_f32 v40, v40
    v_rcp_f32 v41, v41
    v_pk_mul_f32 v[152:153], v[152:153], v[34:35]
    v_pk_mul_f32 v[154:155], v[154:155], v[36:37]
    v_pk_mul_f32 v[156:157], v[156:157], v[38:39]
    v_pk_mul_f32 v[158:159], v[158:159], v[40:41]
    v_cvt_pk_bf16_f32 v144, v152, v153
    v_cvt_pk_bf16_f32 v145, v154, v155
    v_cvt_pk_bf16_f32 v146, v156, v157
    v_cvt_pk_bf16_f32 v147, v158, v159
    buffer_store_dwordx4 v[144:147], v16, s[56:59], s89 offen offset:1024 sc1
    v_accvgpr_read_b32 v160, a224
    v_accvgpr_read_b32 v161, a225
    v_accvgpr_read_b32 v162, a226
    v_accvgpr_read_b32 v163, a227
    v_accvgpr_read_b32 v164, a228
    v_accvgpr_read_b32 v165, a229
    v_accvgpr_read_b32 v166, a230
    v_accvgpr_read_b32 v167, a231
    v_accvgpr_read_b32 v168, a232
    v_accvgpr_read_b32 v169, a233
    s_branch L_over7
L_stub7:
    s_branch L_stub8
L_over7:
    v_accvgpr_read_b32 v170, a234
    v_accvgpr_read_b32 v171, a235
    v_accvgpr_read_b32 v172, a236
    v_accvgpr_read_b32 v173, a237
    v_accvgpr_read_b32 v174, a238
    v_accvgpr_read_b32 v175, a239
    v_pk_mul_f32 v[34:35], v[160:161], v[160:161]
    v_pk_mul_f32 v[36:37], v[162:163], v[162:163]
    v_pk_mul_f32 v[38:39], v[164:165], v[164:165]
    v_pk_mul_f32 v[40:41], v[166:167], v[166:167]
    v_pk_fma_f32 v[34:35], v[34:35], s[94:95], v[26:27]
    v_pk_fma_f32 v[36:37], v[36:37], s[94:95], v[26:27]
    v_pk_fma_f32 v[38:39], v[38:39], s[94:95], v[26:27]
    v_pk_fma_f32 v[40:41], v[40:41], s[94:95], v[26:27]
    v_pk_mul_f32 v[34:35], v[34:35], v[160:161]
    v_pk_mul_f32 v[36:37], v[36:37], v[162:163]
    v_pk_mul_f32 v[38:39], v[38:39], v[164:165]
    v_pk_mul_f32 v[40:41], v[40:41], v[166:167]
    v_exp_f32 v34, v34
    v_exp_f32 v35, v35
    v_exp_f32 v36, v36
    v_exp_f32 v37, v37
    v_exp_f32 v38, v38
    v_exp_f32 v39, v39
    v_exp_f32 v40, v40
    v_exp_f32 v41, v41
    v_pk_mul_f32 v[168:169], v[168:169], v[160:161]
    v_pk_mul_f32 v[170:171], v[170:171], v[162:163]
    v_pk_mul_f32 v[172:173], v[172:173], v[164:165]
    v_pk_mul_f32 v[174:175], v[174:175], v[166:167]
    v_pk_add_f32 v[34:35], v[34:35], 1.0 op_sel_hi:[1,0]
    v_pk_add_f32 v[36:37], v[36:37], 1.0 op_sel_hi:[1,0]
    v_pk_add_f32 v[38:39], v[38:39], 1.0 op_sel_hi:[1,0]
    v_pk_add_f32 v[40:41], v[40:41], 1.0 op_sel_hi:[1,0]
    v_rcp_f32 v34, v34
    v_rcp_f32 v35, v35
    v_rcp_f32 v36, v36
    v_rcp_f32 v37, v37
    v_rcp_f32 v38, v38
    v_rcp_f32 v39, v39
    v_rcp_f32 v40, v40
    v_rcp_f32 v41, v41
    v_pk_mul_f32 v[168:169], v[168:169], v[34:35]
    v_pk_mul_f32 v[170:171], v[170:171], v[36:37]
    v_pk_mul_f32 v[172:173], v[172:173], v[38:39]
    v_pk_mul_f32 v[174:175], v[174:175], v[40:41]
    v_cvt_pk_bf16_f32 v160, v168, v169
    v_cvt_pk_bf16_f32 v161, v170, v171
    v_cvt_pk_bf16_f32 v162, v172, v173
    v_cvt_pk_bf16_f32 v163, v174, v175
    buffer_store_dwordx4 v[160:163], v16, s[56:59], s89 offen offset:2048 sc1
    buffer_load_dword v43, off, s[56:59], s92 sc1
    v_accvgpr_read_b32 v176, a240
    v_accvgpr_read_b32 v177, a241
    v_accvgpr_read_b32 v178, a242
    v_accvgpr_read_b32 v179, a243
    v_accvgpr_read_b32 v180, a244
    v_accvgpr_read_b32 v181, a245
    v_accvgpr_read_b32 v182, a246
    v_accvgpr_read_b32 v183, a247
    v_accvgpr_read_b32 v184, a248
    v_accvgpr_read_b32 v185, a249
    v_accvgpr_read_b32 v186, a250
    v_accvgpr_read_b32 v187, a251
    v_accvgpr_read_b32 v188, a252
    v_accvgpr_read_b32 v189, a253
    v_accvgpr_read_b32 v190, a254
    v_accvgpr_read_b32 v191, a255
    v_pk_mul_f32 v[34:35], v[176:177], v[176:177]
    v_pk_mul_f32 v[36:37], v[178:179], v[178:179]
    v_pk_mul_f32 v[38:39], v[180:181], v[180:181]
    v_pk_mul_f32 v[40:41], v[182:183], v[182:183]
    v_pk_fma_f32 v[34:35], v[34:35], s[94:95], v[26:27]
    v_pk_fma_f32 v[36:37], v[36:37], s[94:95], v[26:27]
    v_pk_fma_f32 v[38:39], v[38:39], s[94:95], v[26:27]
    v_pk_fma_f32 v[40:41], v[40:41], s[94:95], v[26:27]
    v_pk_mul_f32 v[34:35], v[34:35], v[176:177]
    v_pk_mul_f32 v[36:37], v[36:37], v[178:179]
    v_pk_mul_f32 v[38:39], v[38:39], v[180:181]
    v_pk_mul_f32 v[40:41], v[40:41], v[182:183]
    v_exp_f32 v34, v34
    v_exp_f32 v35, v35
    v_exp_f32 v36, v36
    v_exp_f32 v37, v37
    v_exp_f32 v38, v38
    v_exp_f32 v39, v39
    v_exp_f32 v40, v40
    v_exp_f32 v41, v41
    v_pk_mul_f32 v[184:185], v[184:185], v[176:177]
    v_pk_mul_f32 v[186:187], v[186:187], v[178:179]
    v_pk_mul_f32 v[188:189], v[188:189], v[180:181]
    v_pk_mul_f32 v[190:191], v[190:191], v[182:183]
    v_pk_add_f32 v[34:35], v[34:35], 1.0 op_sel_hi:[1,0]
    v_pk_add_f32 v[36:37], v[36:37], 1.0 op_sel_hi:[1,0]
    v_pk_add_f32 v[38:39], v[38:39], 1.0 op_sel_hi:[1,0]
    v_pk_add_f32 v[40:41], v[40:41], 1.0 op_sel_hi:[1,0]
    v_rcp_f32 v34, v34
    v_rcp_f32 v35, v35
    v_rcp_f32 v36, v36
    v_rcp_f32 v37, v37
    v_rcp_f32 v38, v38
    v_rcp_f32 v39, v39
    v_rcp_f32 v40, v40
    v_rcp_f32 v41, v41
    v_pk_mul_f32 v[184:185], v[184:185], v[34:35]
    v_pk_mul_f32 v[186:187], v[186:187], v[36:37]
    v_pk_mul_f32 v[188:189], v[188:189], v[38:39]
    v_pk_mul_f32 v[190:191], v[190:191], v[40:41]
    v_cvt_pk_bf16_f32 v176, v184, v185
    v_cvt_pk_bf16_f32 v177, v186, v187
    v_cvt_pk_bf16_f32 v178, v188, v189
    v_cvt_pk_bf16_f32 v179, v190, v191
    buffer_store_dwordx4 v[176:179], v16, s[56:59], s89 offen offset:3072 sc1
    s_waitcnt vmcnt(1)
    v_readfirstlane_b32 s86, v43
    s_bfe_u32 s86, s86, 0x80000
    s_cmp_eq_u32 s86, 32
    s_cbranch_scc0 L_spA1
L_okA1:
    v_pk_mul_f32 v[34:35], v[48:49], v[48:49]
    buffer_load_dwordx4 a[0:3], v21, s[56:59], s68 offen sc1
    v_pk_mul_f32 v[36:37], v[50:51], v[50:51]
    v_pk_mul_f32 v[38:39], v[52:53], v[52:53]
    v_pk_mul_f32 v[40:41], v[54:55], v[54:55]
    v_pk_fma_f32 v[34:35], v[34:35], s[94:95], v[26:27]
    buffer_load_dwordx4 a[4:7], v22, s[56:59], s68 offen sc1
    v_pk_fma_f32 v[36:37], v[36:37], s[94:95], v[26:27]
    v_pk_fma_f32 v[38:39], v[38:39], s[94:95], v[26:27]
    v_pk_fma_f32 v[40:41], v[40:41], s[94:95], v[26:27]
    v_pk_mul_f32 v[34:35], v[34:35], v[48:49]
    buffer_load_dwordx4 a[8:11], v23, s[56:59], s68 offen sc1
    v_pk_mul_f32 v[36:37], v[36:37], v[50:51]
    v_pk_mul_f32 v[38:39], v[38:39], v[52:53]
    v_pk_mul_f32 v[40:41], v[40:41], v[54:55]
    v_exp_f32 v34, v34
    buffer_load_dwordx4 a[12:15], v24, s[56:59], s68 offen sc1
    v_exp_f32 v35, v35
    v_exp_f32 v36, v36
    v_exp_f32 v37, v37
    v_exp_f32 v38, v38
    s_add_u32 s68, s68, 16384
    v_exp_f32 v39, v39
    v_exp_f32 v40, v40
    v_exp_f32 v41, v41
    v_pk_mul_f32 v[56:57], v[56:57], v[48:49]
    buffer_load_dwordx4 a[16:19], v21, s[56:59], s68 offen sc1
    v_pk_mul_f32 v[58:59], v[58:59], v[50:51]
    v_pk_mul_f32 v[60:61], v[60:61], v[52:53]
    v_pk_mul_f32 v[62:63], v[62:63], v[54:55]
    v_pk_add_f32 v[34:35], v[34:35], 1.0 op_sel_hi:[1,0]
    buffer_load_dwordx4 a[20:23], v22, s[56:59], s68 offen sc1
    v_pk_add_f32 v[36:37], v[36:37], 1.0 op_sel_hi:[1,0]
    v_pk_add_f32 v[38:39], v[38:39], 1.0 op_sel_hi:[1,0]
    v_pk_add_f32 v[40:41], v[40:41], 1.0 op_sel_hi:[1,0]
    v_rcp_f32 v34, v34
    buffer_load_dwordx4 a[24:27], v23, s[56:59], s68 offen sc1
    v_rcp_f32 v35, v35
    v_rcp_f32 v36, v36
    v_rcp_f32 v37, v37
    v_rcp_f32 v38, v38
    buffer_load_dwordx4 a[28:31], v24, s[56:59], s68 offen sc1
    v_rcp_f32 v39, v39
    v_rcp_f32 v40, v40
    v_rcp_f32 v41, v41
    v_pk_mul_f32 v[56:57], v[56:57], v[34:35]
    s_add_u32 s68, s68, 16384
    v_pk_mul_f32 v[58:59], v[58:59], v[36:37]
    v_pk_mul_f32 v[60:61], v[60:61], v[38:39]
    v_pk_mul_f32 v[62:63], v[62:63], v[40:41]
    v_cvt_pk_bf16_f32 v48, v56, v57
    v_cvt_pk_bf16_f32 v49, v58, v59
    v_cvt_pk_bf16_f32 v50, v60, v61
    v_cvt_pk_bf16_f32 v51, v62, v63
    s_nop 0
    v_permlane16_swap_b32 v48, v50
    v_permlane16_swap_b32 v49, v51
    buffer_store_dwordx4 v[48:51], v28, s[56:59], s90 offen offset:0 sc1
    v_pk_mul_f32 v[34:35], v[64:65], v[64:65]
    buffer_load_dwordx4 a[32:35], v21, s[56:59], s68 offen sc1
    v_pk_mul_f32 v[36:37], v[66:67], v[66:67]
    v_pk_mul_f32 v[38:39], v[68:69], v[68:69]
    v_pk_mul_f32 v[40:41], v[70:71], v[70:71]
    v_pk_fma_f32 v[34:35], v[34:35], s[94:95], v[26:27]
    buffer_load_dwordx4 a[36:39], v22, s[56:59], s68 offen sc1
    v_pk_fma_f32 v[36:37], v[36:37], s[94:95], v[26:27]
    v_pk_fma_f32 v[38:39], v[38:39], s[94:95], v[26:27]
    v_pk_fma_f32 v[40:41], v[40:41], s[94:95], v[26:27]
    v_pk_mul_f32 v[34:35], v[34:35], v[64:65]
    buffer_load_dwordx4 a[40:43], v23, s[56:59], s68 offen sc1
    v_pk_mul_f32 v[36:37], v[36:37], v[66:67]
    v_pk_mul_f32 v[38:39], v[38:39], v[68:69]
    v_pk_mul_f32 v[40:41], v[40:41], v[70:71]
    v_exp_f32 v34, v34
    buffer_load_dwordx4 a[44:47], v24, s[56:59], s68 offen sc1
    v_exp_f32 v35, v35
    v_exp_f32 v36, v36
    v_exp_f32 v37, v37
    v_exp_f32 v38, v38
    s_add_u32 s68, s68, 16384
    v_exp_f32 v39, v39
    v_exp_f32 v40, v40
    v_exp_f32 v41, v41
    v_pk_mul_f32 v[72:73], v[72:73], v[64:65]
    buffer_load_dwordx4 a[48:51], v21, s[56:59], s68 offen sc1
    v_pk_mul_f32 v[74:75], v[74:75], v[66:67]
    v_pk_mul_f32 v[76:77], v[76:77], v[68:69]
    v_pk_mul_f32 v[78:79], v[78:79], v[70:71]
    v_pk_add_f32 v[34:35], v[34:35], 1.0 op_sel_hi:[1,0]
    buffer_load_dwordx4 a[52:55], v22, s[56:59], s68 offen sc1
    v_pk_add_f32 v[36:37], v[36:37], 1.0 op_sel_hi:[1,0]
    v_pk_add_f32 v[38:39], v[38:39], 1.0 op_sel_hi:[1,0]
    v_pk_add_f32 v[40:41], v[40:41], 1.0 op_sel_hi:[1,0]
    v_rcp_f32 v34, v34
    buffer_load_dwordx4 a[56:59], v23, s[56:59], s68 offen sc1
    v_rcp_f32 v35, v35
    v_rcp_f32 v36, v36
    v_rcp_f32 v37, v37
    v_rcp_f32 v38, v38
    buffer_load_dwordx4 a[60:63], v24, s[56:59], s68 offen sc1
    v_rcp_f32 v39, v39
    v_rcp_f32 v40, v40
    v_rcp_f32 v41, v41
    v_pk_mul_f32 v[72:73], v[72:73], v[34:35]
    s_add_u32 s68, s68, 16384
    v_pk_mul_f32 v[74:75], v[74:75], v[36:37]
    v_pk_mul_f32 v[76:77], v[76:77], v[38:39]
    v_pk_mul_f32 v[78:79], v[78:79], v[40:41]
    v_cvt_pk_bf16_f32 v64, v72, v73
    v_cvt_pk_bf16_f32 v65, v74, v75
    v_cvt_pk_bf16_f32 v66, v76, v77
    v_cvt_pk_bf16_f32 v67, v78, v79
    s_nop 0
    v_permlane16_swap_b32 v64, v66
    v_permlane16_swap_b32 v65, v67
    buffer_store_dwordx4 v[64:67], v28, s[56:59], s90 offen offset:2048 sc1
    s_waitcnt vmcnt(18)
    s_mov_b64 exec, 1
    buffer_atomic_add v29, off, s[56:59], s92 sc1
    s_mov_b64 exec, -1
    v_pk_mul_f32 v[34:35], v[80:81], v[80:81]
    buffer_load_dwordx4 a[64:67], v21, s[56:59], s68 offen sc1
    v_pk_mul_f32 v[36:37], v[82:83], v[82:83]
    v_pk_mul_f32 v[38:39], v[84:85], v[84:85]
    v_pk_mul_f32 v[40:41], v[86:87], v[86:87]
    v_pk_fma_f32 v[34:35], v[34:35], s[94:95], v[26:27]
    buffer_load_dwordx4 a[68:71], v22, s[56:59], s68 offen sc1
    v_pk_fma_f32 v[36:37], v[36:37], s[94:95], v[26:27]
    v_pk_fma_f32 v[38:39], v[38:39], s[94:95], v[26:27]
    v_pk_fma_f32 v[40:41], v[40:41], s[94:95], v[26:27]
    v_pk_mul_f32 v[34:35], v[34:35], v[80:81]
    buffer_load_dwordx4 a[72:75], v23, s[56:59], s68 offen sc1
    v_pk_mul_f32 v[36:37], v[36:37], v[82:83]
    v_pk_mul_f32 v[38:39], v[38:39], v[84:85]
    v_pk_mul_f32 v[40:41], v[40:41], v[86:87]
    v_exp_f32 v34, v34
    buffer_load_dwordx4 a[76:79], v24, s[56:59], s68 offen sc1
    v_exp_f32 v35, v35
    v_exp_f32 v36, v36
    v_exp_f32 v37, v37
    v_exp_f32 v38, v38
    s_add_u32 s68, s68, 16384
    v_exp_f32 v39, v39
    v_exp_f32 v40, v40
    v_exp_f32 v41, v41
    v_pk_mul_f32 v[88:89], v[88:89], v[80:81]
    buffer_load_dwordx4 a[80:83], v21, s[56:59], s68 offen sc1
    v_pk_mul_f32 v[90:91], v[90:91], v[82:83]
    v_pk_mul_f32 v[92:93], v[92:93], v[84:85]
    v_pk_mul_f32 v[94:95], v[94:95], v[86:87]
    v_pk_add_f32 v[34:35], v[34:35], 1.0 op_sel_hi:[1,0]
    buffer_load_dwordx4 a[84:87], v22, s[56:59], s68 offen sc1
    v_pk_add_f32 v[36:37], v[36:37], 1.0 op_sel_hi:[1,0]
    v_pk_add_f32 v[38:39], v[38:39], 1.0 op_sel_hi:[1,0]
    v_pk_add_f32 v[40:41], v[40:41], 1.0 op_sel_hi:[1,0]
    v_rcp_f32 v34, v34
    buffer_load_dwordx4 a[88:91], v23, s[56:59], s68 offen sc1
    v_rcp_f32 v35, v35
    v_rcp_f32 v36, v36
    v_rcp_f32 v37, v37
    v_rcp_f32 v38, v38
    buffer_load_dwordx4 a[92:95], v24, s[56:59], s68 offen sc1
    v_rcp_f32 v39, v39
    v_rcp_f32 v40, v40
    v_rcp_f32 v41, v41
    v_pk_mul_f32 v[88:89], v[88:89], v[34:35]
    s_add_u32 s68, s68, 16384
    v_pk_mul_f32 v[90:91], v[90:91], v[36:37]
    v_pk_mul_f32 v[92:93], v[92:93], v[38:39]
    v_pk_mul_f32 v[94:95], v[94:95], v[40:41]
    v_cvt_pk_bf16_f32 v80, v88, v89
    v_cvt_pk_bf16_f32 v81, v90, v91
    v_cvt_pk_bf16_f32 v82, v92, v93
    v_cvt_pk_bf16_f32 v83, v94, v95
    s_nop 0
    v_permlane16_swap_b32 v80, v82
    v_permlane16_swap_b32 v81, v83
    s_add_u32 s90, s90, 4096
    buffer_store_dwordx4 v[80:83], v28, s[56:59], s90 offen offset:0 sc1
    v_pk_mul_f32 v[34:35], v[96:97], v[96:97]
    buffer_load_dwordx4 a[96:99], v21, s[56:59], s68 offen sc1
    v_pk_mul_f32 v[36:37], v[98:99], v[98:99]
    v_pk_mul_f32 v[38:39], v[100:101], v[100:101]
    v_pk_mul_f32 v[40:41], v[102:103], v[102:103]
    v_pk_fma_f32 v[34:35], v[34:35], s[94:95], v[26:27]
    buffer_load_dwordx4 a[100:103], v22, s[56:59], s68 offen sc1
    v_pk_fma_f32 v[36:37], v[36:37], s[94:95], v[26:27]
    v_pk_fma_f32 v[38:39], v[38:39], s[94:95], v[26:27]
    v_pk_fma_f32 v[40:41], v[40:41], s[94:95], v[26:27]
    v_pk_mul_f32 v[34:35], v[34:35], v[96:97]
    buffer_load_dwordx4 a[104:107], v23, s[56:59], s68 offen sc1
    v_pk_mul_f32 v[36:37], v[36:37], v[98:99]
    v_pk_mul_f32 v[38:39], v[38:39], v[100:101]
    v_pk_mul_f32 v[40:41], v[40:41], v[102:103]
    v_exp_f32 v34, v34
    buffer_load_dwordx4 a[108:111], v24, s[56:59], s68 offen sc1
    v_exp_f32 v35, v35
    v_exp_f32 v36, v36
    v_exp_f32 v37, v37
    v_exp_f32 v38, v38
    s_add_u32 s68, s68, 16384
    v_exp_f32 v39, v39
    v_exp_f32 v40, v40
    v_exp_f32 v41, v41
    v_pk_mul_f32 v[104:105], v[104:105], v[96:97]
    buffer_load_dwordx4 a[112:115], v21, s[56:59], s68 offen sc1
    v_pk_mul_f32 v[106:107], v[106:107], v[98:99]
    v_pk_mul_f32 v[108:109], v[108:109], v[100:101]
    v_pk_mul_f32 v[110:111], v[110:111], v[102:103]
    v_pk_add_f32 v[34:35], v[34:35], 1.0 op_sel_hi:[1,0]
    buffer_load_dwordx4 a[116:119], v22, s[56:59], s68 offen sc1
    v_pk_add_f32 v[36:37], v[36:37], 1.0 op_sel_hi:[1,0]
    v_pk_add_f32 v[38:39], v[38:39], 1.0 op_sel_hi:[1,0]
    v_pk_add_f32 v[40:41], v[40:41], 1.0 op_sel_hi:[1,0]
    v_rcp_f32 v34, v34
    buffer_load_dwordx4 a[120:123], v23, s[56:59], s68 offen sc1
    v_rcp_f32 v35, v35
    v_rcp_f32 v36, v36
    v_rcp_f32 v37, v37
    v_rcp_f32 v38, v38
    buffer_load_dwordx4 a[124:127], v24, s[56:59], s68 offen sc1
    v_rcp_f32 v39, v39
    v_rcp_f32 v40, v40
    v_rcp_f32 v41, v41
    v_pk_mul_f32 v[104:105], v[104:105], v[34:35]
    s_add_u32 s68, s68, 16384
    v_pk_mul_f32 v[106:107], v[106:107], v[36:37]
    v_pk_mul_f32 v[108:109], v[108:109], v[38:39]
    v_pk_mul_f32 v[110:111], v[110:111], v[40:41]
    v_cvt_pk_bf16_f32 v96, v104, v105
    v_cvt_pk_bf16_f32 v97, v106, v107
    v_cvt_pk_bf16_f32 v98, v108, v109
    v_cvt_pk_bf16_f32 v99, v110, v111
    s_nop 0
    v_permlane16_swap_b32 v96, v98
    v_permlane16_swap_b32 v97, v99
    buffer_store_dwordx4 v[96:99], v28, s[56:59], s90 offen offset:2048 sc1
    s_barrier
L_D:
    v_lshrrev_b32 v34, 2, v0
    v_and_b32 v35, 3, v0
    v_lshlrev_b32 v35, 3, v35
    v_lshl_add_u32 v35, v34, 8, v35
    v_and_b32 v34, 7, v34
    v_xor_b32 v36, 0, v34
    v_lshl_add_u32 v8, v36, 5, v35
    v_xor_b32 v36, 1, v34
    v_lshl_add_u32 v9, v36, 5, v35
    v_xor_b32 v36, 2, v34
    v_lshl_add_u32 v10, v36, 5, v35
    v_xor_b32 v36, 3, v34
    v_lshl_add_u32 v11, v36, 5, v35
    v_xor_b32 v36, 4, v34
    v_lshl_add_u32 v12, v36, 5, v35
    v_xor_b32 v36, 5, v34
    v_lshl_add_u32 v13, v36, 5, v35
    v_xor_b32 v36, 6, v34
    v_lshl_add_u32 v14, v36, 5, v35
    v_xor_b32 v36, 7, v34
    v_lshl_add_u32 v15, v36, 5, v35
    ds_read_b64_tr_b16 a[128:129], v8 offset:0
    ds_read_b64_tr_b16 a[130:131], v8 offset:4096
    ds_read_b64_tr_b16 a[132:133], v9 offset:0
    ds_read_b64_tr_b16 a[134:135], v9 offset:4096
    ds_read_b64_tr_b16 a[136:137], v10 offset:0
    ds_read_b64_tr_b16 a[138:139], v10 offset:4096
    ds_read_b64_tr_b16 a[140:141], v11 offset:0
    ds_read_b64_tr_b16 a[142:143], v11 offset:4096
    ds_read_b64_tr_b16 a[144:145], v12 offset:0
    ds_read_b64_tr_b16 a[146:147], v12 offset:4096
    ds_read_b64_tr_b16 a[148:149], v13 offset:0
    ds_read_b64_tr_b16 a[150:151], v13 offset:4096
    ds_read_b64_tr_b16 a[152:153], v14 offset:0
    ds_read_b64_tr_b16 a[154:155], v14 offset:4096
    ds_read_b64_tr_b16 a[156:157], v15 offset:0
    ds_read_b64_tr_b16 a[158:159], v15 offset:4096
    v_add_u32 v48, 0x10000, v8
    v_add_u32 v56, 0x20000, v8
    v_add_u32 v49, 0x10000, v9
    v_add_u32 v57, 0x20000, v9
    v_add_u32 v50, 0x10000, v10
    v_add_u32 v58, 0x20000, v10
    v_add_u32 v51, 0x10000, v11
    v_add_u32 v59, 0x20000, v11
    v_add_u32 v52, 0x10000, v12
    v_add_u32 v60, 0x20000, v12
    v_add_u32 v53, 0x10000, v13
    v_add_u32 v61, 0x20000, v13
    v_add_u32 v54, 0x10000, v14
    v_add_u32 v62, 0x20000, v14
    v_add_u32 v55, 0x10000, v15
    v_add_u32 v63, 0x20000, v15
    s_lshl_b32 s84, s63, 2
    s_add_u32 s84, s84, s60
    s_lshl_b32 s84, s84, 2
    s_add_u32 s84, s84, s65
    s_lshl_b32 s84, s84, 15
    s_lshl_b32 s85, s66, 8
    s_add_u32 s84, s84, s85
    v_and_b32 v34, 15, v0
    v_lshrrev_b32 v35, 4, v0
    v_lshlrev_b32 v36, 11, v34
    v_add_u32 v36, s84, v36
    v_lshl_add_u32 v1, v35, 3, v36
    v_and_b32 v2, 1, v35
    v_lshl_add_u32 v36, v2, 5, v36
    v_lshrrev_b32 v2, 1, v35
    v_lshl_add_u32 v2, v2, 4, v36
    v_lshrrev_b32 v36, 3, v34
    v_mul_u32_u24 v36, 16320, v36
    v_sub_u32 v1, v2, v36
    v_xor_b32 v5, 64, v1
    v_add_u32 v5, 16384, v5
    v_cmp_gt_u32 s[4:5], 8, v34
    v_lshlrev_b32 v35, 2, v35
    v_sub_u32 v34, v34, v35
    v_mov_b32 v26, 0
    v_mov_b32 v27, 0
    v_mov_b32 v30, 0
    v_mov_b32 v31, 0
    v_mov_b32 v35, 0x3f80
    v_mov_b32 v36, 0x3f800000
    v_cmp_eq_u32 vcc, 0, v34
    s_nop 1
    v_cndmask_b32 v28, v26, v35, vcc
    v_cmp_eq_u32 vcc, 1, v34
    s_nop 1
    v_cndmask_b32 v28, v28, v36, vcc
    v_cmp_eq_u32 vcc, 2, v34
    s_nop 1
    v_cndmask_b32 v29, v26, v35, vcc
    v_cmp_eq_u32 vcc, 3, v34
    s_nop 1
    v_cndmask_b32 v29, v29, v36, vcc
    s_mov_b32 s14, 0xbfb8aa3b
    s_mov_b32 s15, 0xbfb8aa3b
    s_waitcnt vmcnt(31) lgkmcnt(14)
    v_mfma_f32_16x16x32_bf16 v[128:131], a[128:131], a[0:3], 0
    s_waitcnt vmcnt(30)
    v_mfma_f32_16x16x32_bf16 v[160:163], a[128:131], a[4:7], 0
    ds_read_b64_tr_b16 a[160:161], v8 offset:8192
    s_waitcnt vmcnt(29)
    v_mfma_f32_16x16x32_bf16 v[192:195], a[128:131], a[8:11], 0
    ds_read_b64_tr_b16 a[162:163], v8 offset:12288
    s_waitcnt vmcnt(28)
    v_mfma_f32_16x16x32_bf16 v[224:227], a[128:131], a[12:15], 0
    s_waitcnt lgkmcnt(14)
    v_mfma_f32_16x16x32_bf16 v[132:135], a[132:135], a[0:3], 0
    ds_read_b64_tr_b16 a[164:165], v9 offset:8192
    v_mfma_f32_16x16x32_bf16 v[164:167], a[132:135], a[4:7], 0
    ds_read_b64_tr_b16 a[166:167], v9 offset:12288
    v_mfma_f32_16x16x32_bf16 v[196:199], a[132:135], a[8:11], 0
    v_mfma_f32_16x16x32_bf16 v[228:231], a[132:135], a[12:15], 0
    ds_read_b64_tr_b16 a[168:169], v10 offset:8192
    s_waitcnt lgkmcnt(15)
    v_mfma_f32_16x16x32_bf16 v[136:139], a[136:139], a[0:3], 0
    ds_read_b64_tr_b16 a[170:171], v10 offset:12288
    v_mfma_f32_16x16x32_bf16 v[168:171], a[136:139], a[4:7], 0
    v_mfma_f32_16x16x32_bf16 v[200:203], a[136:139], a[8:11], 0
    ds_read_b64_tr_b16 a[172:173], v11 offset:8192
    v_mfma_f32_16x16x32_bf16 v[232:235], a[136:139], a[12:15], 0
    ds_read_b64_tr_b16 a[174:175], v11 offset:12288
    s_waitcnt lgkmcnt(15)
    v_mfma_f32_16x16x32_bf16 v[140:143], a[140:143], a[0:3], 0
    v_mfma_f32_16x16x32_bf16 v[172:175], a[140:143], a[4:7], 0
    ds_read_b64_tr_b16 a[176:177], v12 offset:8192
    v_mfma_f32_16x16x32_bf16 v[204:207], a[140:143], a[8:11], 0
    ds_read_b64_tr_b16 a[178:179], v12 offset:12288
    v_mfma_f32_16x16x32_bf16 v[236:239], a[140:143], a[12:15], 0
    s_waitcnt lgkmcnt(15)
    v_mfma_f32_16x16x32_bf16 v[144:147], a[144:147], a[0:3], 0
    ds_read_b64_tr_b16 a[180:181], v13 offset:8192
    v_mfma_f32_16x16x32_bf16 v[176:179], a[144:147], a[4:7], 0
    ds_read_b64_tr_b16 a[182:183], v13 offset:12288
    v_mfma_f32_16x16x32_bf16 v[208:211], a[144:147], a[8:11], 0
    v_mfma_f32_16x16x32_bf16 v[240:243], a[144:147], a[12:15], 0
    ds_read_b64_tr_b16 a[184:185], v14 offset:8192
    s_waitcnt lgkmcnt(15)
    v_mfma_f32_16x16x32_bf16 v[148:151], a[148:151], a[0:3], 0
    ds_read_b64_tr_b16 a[186:187], v14 offset:12288
    s_waitcnt vmcnt(0)
    s_mov_b64 exec, 1
    buffer_atomic_add v42, off, s[56:59], s93 sc1
    s_mov_b64 exec, -1
    v_mfma_f32_16x16x32_bf16 v[180:183], a[148:151], a[4:7], 0
    v_mfma_f32_16x16x32_bf16 v[212:215], a[148:151], a[8:11], 0
    ds_read_b64_tr_b16 a[188:189], v15 offset:8192
    v_mfma_f32_16x16x32_bf16 v[244:247], a[148:151], a[12:15], 0
    ds_read_b64_tr_b16 a[190:191], v15 offset:12288
    v_mfma_f32_16x16x32_bf16 v[152:155], a[152:155], a[0:3], 0
    v_mfma_f32_16x16x32_bf16 v[184:187], a[152:155], a[4:7], 0
    v_mfma_f32_16x16x32_bf16 v[216:219], a[152:155], a[8:11], 0
    v_mfma_f32_16x16x32_bf16 v[248:251], a[152:155], a[12:15], 0
    s_waitcnt lgkmcnt(15)
    v_mfma_f32_16x16x32_bf16 v[156:159], a[156:159], a[0:3], 0
    v_mfma_f32_16x16x32_bf16 v[188:191], a[156:159], a[4:7], 0
    v_mfma_f32_16x16x32_bf16 v[220:223], a[156:159], a[8:11], 0
    v_mfma_f32_16x16x32_bf16 v[252:255], a[156:159], a[12:15], 0
    s_waitcnt lgkmcnt(14)
    v_mfma_f32_16x16x32_bf16 v[128:131], a[160:163], a[16:19], v[128:131]
    buffer_load_dwordx4 a[0:3], v21, s[56:59], s68 offen sc1
    v_mfma_f32_16x16x32_bf16 v[160:163], a[160:163], a[20:23], v[160:163]
    ds_read_b64_tr_b16 a[128:129], v8 offset:16384
    v_mfma_f32_16x16x32_bf16 v[192:195], a[160:163], a[24:27], v[192:195]
    ds_read_b64_tr_b16 a[130:131], v8 offset:20480
    buffer_load_dwordx4 a[4:7], v22, s[56:59], s68 offen sc1
    v_mfma_f32_16x16x32_bf16 v[224:227], a[160:163], a[28:31], v[224:227]
    s_waitcnt lgkmcnt(14)
    v_mfma_f32_16x16x32_bf16 v[132:135], a[164:167], a[16:19], v[132:135]
    ds_read_b64_tr_b16 a[132:133], v9 offset:16384
    buffer_load_dwordx4 a[8:11], v23, s[56:59], s68 offen sc1
    v_mfma_f32_16x16x32_bf16 v[164:167], a[164:167], a[20:23], v[164:167]
    ds_read_b64_tr_b16 a[134:135], v9 offset:20480
    v_mfma_f32_16x16x32_bf16 v[196:199], a[164:167], a[24:27], v[196:199]
    buffer_load_dwordx4 a[12:15], v24, s[56:59], s68 offen sc1
    v_mfma_f32_16x16x32_bf16 v[228:231], a[164:167], a[28:31], v[228:231]
    ds_read_b64_tr_b16 a[136:137], v10 offset:16384
    s_waitcnt lgkmcnt(15)
    v_mfma_f32_16x16x32_bf16 v[136:139], a[168:171], a[16:19], v[136:139]
    ds_read_b64_tr_b16 a[138:139], v10 offset:20480
    s_add_u32 s68, s68, 16384
    v_mfma_f32_16x16x32_bf16 v[168:171], a[168:171], a[20:23], v[168:171]
    v_mfma_f32_16x16x32_bf16 v[200:203], a[168:171], a[24:27], v[200:203]
    ds_read_b64_tr_b16 a[140:141], v11 offset:16384
    v_mfma_f32_16x16x32_bf16 v[232:235], a[168:171], a[28:31], v[232:235]
    ds_read_b64_tr_b16 a[142:143], v11 offset:20480
    s_waitcnt lgkmcnt(15)
    v_mfma_f32_16x16x32_bf16 v[140:143], a[172:175], a[16:19], v[140:143]
    v_mfma_f32_16x16x32_bf16 v[172:175], a[172:175], a[20:23], v[172:175]
    ds_read_b64_tr_b16 a[144:145], v12 offset:16384
    v_mfma_f32_16x16x32_bf16 v[204:207], a[172:175], a[24:27], v[204:207]
    ds_read_b64_tr_b16 a[146:147], v12 offset:20480
    v_mfma_f32_16x16x32_bf16 v[236:239], a[172:175], a[28:31], v[236:239]
    s_waitcnt lgkmcnt(15)
    v_mfma_f32_16x16x32_bf16 v[144:147], a[176:179], a[16:19], v[144:147]
    ds_read_b64_tr_b16 a[148:149], v13 offset:16384
    v_mfma_f32_16x16x32_bf16 v[176:179], a[176:179], a[20:23], v[176:179]
    ds_read_b64_tr_b16 a[150:151], v13 offset:20480
    v_mfma_f32_16x16x32_bf16 v[208:211], a[176:179], a[24:27], v[208:211]
    v_mfma_f32_16x16x32_bf16 v[240:243], a[176:179], a[28:31], v[240:243]
    ds_read_b64_tr_b16 a[152:153], v14 offset:16384
    s_waitcnt lgkmcnt(15)
    v_mfma_f32_16x16x32_bf16 v[148:151], a[180:183], a[16:19], v[148:151]
    ds_read_b64_tr_b16 a[154:155], v14 offset:20480
    v_mfma_f32_16x16x32_bf16 v[180:183], a[180:183], a[20:23], v[180:183]
    v_mfma_f32_16x16x32_bf16 v[212:215], a[180:183], a[24:27], v[212:215]
    ds_read_b64_tr_b16 a[156:157], v15 offset:16384
    v_mfma_f32_16x16x32_bf16 v[244:247], a[180:183], a[28:31], v[244:247]
    ds_read_b64_tr_b16 a[158:159], v15 offset:20480
    v_mfma_f32_16x16x32_bf16 v[152:155], a[184:187], a[16:19], v[152:155]
    v_mfma_f32_16x16x32_bf16 v[184:187], a[184:187], a[20:23], v[184:187]
    v_mfma_f32_16x16x32_bf16 v[216:219], a[184:187], a[24:27], v[216:219]
    v_mfma_f32_16x16x32_bf16 v[248:251], a[184:187], a[28:31], v[248:251]
    s_waitcnt lgkmcnt(15)
    v_mfma_f32_16x16x32_bf16 v[156:159], a[188:191], a[16:19], v[156:159]
    v_mfma_f32_16x16x32_bf16 v[188:191], a[188:191], a[20:23], v[188:191]
    v_mfma_f32_16x16x32_bf16 v[220:223], a[188:191], a[24:27], v[220:223]
    v_mfma_f32_16x16x32_bf16 v[252:255], a[188:191], a[28:31], v[252:255]
    s_waitcnt lgkmcnt(14)
    v_mfma_f32_16x16x32_bf16 v[128:131], a[128:131], a[32:35], v[128:131]
    buffer_load_dwordx4 a[16:19], v21, s[56:59], s68 offen sc1
    v_mfma_f32_16x16x32_bf16 v[160:163], a[128:131], a[36:39], v[160:163]
    ds_read_b64_tr_b16 a[160:161], v8 offset:24576
    v_mfma_f32_16x16x32_bf16 v[192:195], a[128:131], a[40:43], v[192:195]
    ds_read_b64_tr_b16 a[162:163], v8 offset:28672
    buffer_load_dwordx4 a[20:23], v22, s[56:59], s68 offen sc1
    v_mfma_f32_16x16x32_bf16 v[224:227], a[128:131], a[44:47], v[224:227]
    s_waitcnt lgkmcnt(14)
    v_mfma_f32_16x16x32_bf16 v[132:135], a[132:135], a[32:35], v[132:135]
    ds_read_b64_tr_b16 a[164:165], v9 offset:24576
    buffer_load_dwordx4 a[24:27], v23, s[56:59], s68 offen sc1
    v_mfma_f32_16x16x32_bf16 v[164:167], a[132:135], a[36:39], v[164:167]
    ds_read_b64_tr_b16 a[166:167], v9 offset:28672
    v_mfma_f32_16x16x32_bf16 v[196:199], a[132:135], a[40:43], v[196:199]
    buffer_load_dwordx4 a[28:31], v24, s[56:59], s68 offen sc1
    v_mfma_f32_16x16x32_bf16 v[228:231], a[132:135], a[44:47], v[228:231]
    ds_read_b64_tr_b16 a[168:169], v10 offset:24576
    s_waitcnt lgkmcnt(15)
    v_mfma_f32_16x16x32_bf16 v[136:139], a[136:139], a[32:35], v[136:139]
    ds_read_b64_tr_b16 a[170:171], v10 offset:28672
    s_add_u32 s68, s68, 16384
    v_mfma_f32_16x16x32_bf16 v[168:171], a[136:139], a[36:39], v[168:171]
    v_mfma_f32_16x16x32_bf16 v[200:203], a[136:139], a[40:43], v[200:203]
    ds_read_b64_tr_b16 a[172:173], v11 offset:24576
    global_load_dwordx4 v[64:67], v1, s[8:9] offset:0
    v_mfma_f32_16x16x32_bf16 v[232:235], a[136:139], a[44:47], v[232:235]
    ds_read_b64_tr_b16 a[174:175], v11 offset:28672
    s_branch L_over8
L_stub8:
    s_branch L_stub9
L_over8:
    s_waitcnt lgkmcnt(15)
    v_mfma_f32_16x16x32_bf16 v[140:143], a[140:143], a[32:35], v[140:143]
    v_mfma_f32_16x16x32_bf16 v[172:175], a[140:143], a[36:39], v[172:175]
    ds_read_b64_tr_b16 a[176:177], v12 offset:24576
    v_mfma_f32_16x16x32_bf16 v[204:207], a[140:143], a[40:43], v[204:207]
    ds_read_b64_tr_b16 a[178:179], v12 offset:28672
    global_load_dwordx4 v[68:71], v5, s[8:9] offset:0
    v_mfma_f32_16x16x32_bf16 v[236:239], a[140:143], a[44:47], v[236:239]
    s_waitcnt lgkmcnt(15)
    v_mfma_f32_16x16x32_bf16 v[144:147], a[144:147], a[32:35], v[144:147]
    ds_read_b64_tr_b16 a[180:181], v13 offset:24576
    v_mfma_f32_16x16x32_bf16 v[176:179], a[144:147], a[36:39], v[176:179]
    ds_read_b64_tr_b16 a[182:183], v13 offset:28672
    v_mfma_f32_16x16x32_bf16 v[208:211], a[144:147], a[40:43], v[208:211]
    global_load_dwordx4 v[80:83], v1, s[8:9] offset:128
    v_mfma_f32_16x16x32_bf16 v[240:243], a[144:147], a[44:47], v[240:243]
    ds_read_b64_tr_b16 a[184:185], v14 offset:24576
    s_waitcnt lgkmcnt(15)
    v_mfma_f32_16x16x32_bf16 v[148:151], a[148:151], a[32:35], v[148:151]
    ds_read_b64_tr_b16 a[186:187], v14 offset:28672
    v_mfma_f32_16x16x32_bf16 v[180:183], a[148:151], a[36:39], v[180:183]
    v_mfma_f32_16x16x32_bf16 v[212:215], a[148:151], a[40:43], v[212:215]
    ds_read_b64_tr_b16 a[188:189], v15 offset:24576
    global_load_dwordx4 v[84:87], v5, s[8:9] offset:128
    v_mfma_f32_16x16x32_bf16 v[244:247], a[148:151], a[44:47], v[244:247]
    ds_read_b64_tr_b16 a[190:191], v15 offset:28672
    v_mfma_f32_16x16x32_bf16 v[152:155], a[152:155], a[32:35], v[152:155]
    v_mfma_f32_16x16x32_bf16 v[184:187], a[152:155], a[36:39], v[184:187]
    v_mfma_f32_16x16x32_bf16 v[216:219], a[152:155], a[40:43], v[216:219]
    v_mfma_f32_16x16x32_bf16 v[248:251], a[152:155], a[44:47], v[248:251]
    s_waitcnt lgkmcnt(15)
    v_mfma_f32_16x16x32_bf16 v[156:159], a[156:159], a[32:35], v[156:159]
    v_mfma_f32_16x16x32_bf16 v[188:191], a[156:159], a[36:39], v[188:191]
    v_mfma_f32_16x16x32_bf16 v[220:223], a[156:159], a[40:43], v[220:223]
    v_mfma_f32_16x16x32_bf16 v[252:255], a[156:159], a[44:47], v[252:255]
    s_waitcnt lgkmcnt(14)
    v_mfma_f32_16x16x32_bf16 v[128:131], a[160:163], a[48:51], v[128:131]
    buffer_load_dwordx4 a[32:35], v21, s[56:59], s68 offen sc1
    v_mfma_f32_16x16x32_bf16 v[160:163], a[160:163], a[52:55], v[160:163]
    ds_read_b64_tr_b16 a[128:129], v8 offset:32768
    v_mfma_f32_16x16x32_bf16 v[192:195], a[160:163], a[56:59], v[192:195]
    ds_read_b64_tr_b16 a[130:131], v8 offset:36864
    buffer_load_dwordx4 a[36:39], v22, s[56:59], s68 offen sc1
    v_mfma_f32_16x16x32_bf16 v[224:227], a[160:163], a[60:63], v[224:227]
    s_waitcnt lgkmcnt(14)
    v_mfma_f32_16x16x32_bf16 v[132:135], a[164:167], a[48:51], v[132:135]
    ds_read_b64_tr_b16 a[132:133], v9 offset:32768
    buffer_load_dwordx4 a[40:43], v23, s[56:59], s68 offen sc1
    v_mfma_f32_16x16x32_bf16 v[164:167], a[164:167], a[52:55], v[164:167]
    ds_read_b64_tr_b16 a[134:135], v9 offset:36864
    v_mfma_f32_16x16x32_bf16 v[196:199], a[164:167], a[56:59], v[196:199]
    buffer_load_dwordx4 a[44:47], v24, s[56:59], s68 offen sc1
    v_mfma_f32_16x16x32_bf16 v[228:231], a[164:167], a[60:63], v[228:231]
    ds_read_b64_tr_b16 a[136:137], v10 offset:32768
    s_waitcnt lgkmcnt(15)
    v_mfma_f32_16x16x32_bf16 v[136:139], a[168:171], a[48:51], v[136:139]
    ds_read_b64_tr_b16 a[138:139], v10 offset:36864
    s_add_u32 s68, s68, 16384
    v_mfma_f32_16x16x32_bf16 v[168:171], a[168:171], a[52:55], v[168:171]
    v_mfma_f32_16x16x32_bf16 v[200:203], a[168:171], a[56:59], v[200:203]
    ds_read_b64_tr_b16 a[140:141], v11 offset:32768
    v_mfma_f32_16x16x32_bf16 v[232:235], a[168:171], a[60:63], v[232:235]
    ds_read_b64_tr_b16 a[142:143], v11 offset:36864
    s_waitcnt lgkmcnt(15)
    v_mfma_f32_16x16x32_bf16 v[140:143], a[172:175], a[48:51], v[140:143]
    v_mfma_f32_16x16x32_bf16 v[172:175], a[172:175], a[52:55], v[172:175]
    ds_read_b64_tr_b16 a[144:145], v12 offset:32768
    v_mfma_f32_16x16x32_bf16 v[204:207], a[172:175], a[56:59], v[204:207]
    ds_read_b64_tr_b16 a[146:147], v12 offset:36864
    v_mfma_f32_16x16x32_bf16 v[236:239], a[172:175], a[60:63], v[236:239]
    s_waitcnt lgkmcnt(15)
    v_mfma_f32_16x16x32_bf16 v[144:147], a[176:179], a[48:51], v[144:147]
    ds_read_b64_tr_b16 a[148:149], v13 offset:32768
    v_mfma_f32_16x16x32_bf16 v[176:179], a[176:179], a[52:55], v[176:179]
    ds_read_b64_tr_b16 a[150:151], v13 offset:36864
    v_mfma_f32_16x16x32_bf16 v[208:211], a[176:179], a[56:59], v[208:211]
    v_mfma_f32_16x16x32_bf16 v[240:243], a[176:179], a[60:63], v[240:243]
    ds_read_b64_tr_b16 a[152:153], v14 offset:32768
    s_waitcnt lgkmcnt(15)
    v_mfma_f32_16x16x32_bf16 v[148:151], a[180:183], a[48:51], v[148:151]
    ds_read_b64_tr_b16 a[154:155], v14 offset:36864
    v_mfma_f32_16x16x32_bf16 v[180:183], a[180:183], a[52:55], v[180:183]
    v_mfma_f32_16x16x32_bf16 v[212:215], a[180:183], a[56:59], v[212:215]
    ds_read_b64_tr_b16 a[156:157], v15 offset:32768
    v_mfma_f32_16x16x32_bf16 v[244:247], a[180:183], a[60:63], v[244:247]
    ds_read_b64_tr_b16 a[158:159], v15 offset:36864
    v_mfma_f32_16x16x32_bf16 v[152:155], a[184:187], a[48:51], v[152:155]
    v_mfma_f32_16x16x32_bf16 v[184:187], a[184:187], a[52:55], v[184:187]
    v_mfma_f32_16x16x32_bf16 v[216:219], a[184:187], a[56:59], v[216:219]
    v_mfma_f32_16x16x32_bf16 v[248:251], a[184:187], a[60:63], v[248:251]
    s_waitcnt lgkmcnt(15)
    v_mfma_f32_16x16x32_bf16 v[156:159], a[188:191], a[48:51], v[156:159]
    buffer_load_dword v43, off, s[56:59], s92 sc1
    v_mfma_f32_16x16x32_bf16 v[188:191], a[188:191], a[52:55], v[188:191]
    v_mfma_f32_16x16x32_bf16 v[220:223], a[188:191], a[56:59], v[220:223]
    v_mfma_f32_16x16x32_bf16 v[252:255], a[188:191], a[60:63], v[252:255]
    s_barrier
    s_waitcnt lgkmcnt(14)
    v_mfma_f32_16x16x32_bf16 v[128:131], a[128:131], a[64:67], v[128:131]
    buffer_load_dwordx4 a[48:51], v21, s[56:59], s68 offen sc1
    v_mfma_f32_16x16x32_bf16 v[160:163], a[128:131], a[68:71], v[160:163]
    ds_read_b64_tr_b16 a[160:161], v8 offset:40960
    v_mfma_f32_16x16x32_bf16 v[192:195], a[128:131], a[72:75], v[192:195]
    ds_read_b64_tr_b16 a[162:163], v8 offset:45056
    buffer_load_dwordx4 a[52:55], v22, s[56:59], s68 offen sc1
    v_mfma_f32_16x16x32_bf16 v[224:227], a[128:131], a[76:79], v[224:227]
    s_waitcnt lgkmcnt(14)
    v_mfma_f32_16x16x32_bf16 v[132:135], a[132:135], a[64:67], v[132:135]
    ds_read_b64_tr_b16 a[164:165], v9 offset:40960
    buffer_load_dwordx4 a[56:59], v23, s[56:59], s68 offen sc1
    v_mfma_f32_16x16x32_bf16 v[164:167], a[132:135], a[68:71], v[164:167]
    ds_read_b64_tr_b16 a[166:167], v9 offset:45056
    v_mfma_f32_16x16x32_bf16 v[196:199], a[132:135], a[72:75], v[196:199]
    buffer_load_dwordx4 a[60:63], v24, s[56:59], s68 offen sc1
    v_mfma_f32_16x16x32_bf16 v[228:231], a[132:135], a[76:79], v[228:231]
    ds_read_b64_tr_b16 a[168:169], v10 offset:40960
    s_waitcnt lgkmcnt(15)
    v_mfma_f32_16x16x32_bf16 v[136:139], a[136:139], a[64:67], v[136:139]
    ds_read_b64_tr_b16 a[170:171], v10 offset:45056
    s_add_u32 s68, s68, 16384
    v_mfma_f32_16x16x32_bf16 v[168:171], a[136:139], a[68:71], v[168:171]
    v_mfma_f32_16x16x32_bf16 v[200:203], a[136:139], a[72:75], v[200:203]
    ds_read_b64_tr_b16 a[172:173], v11 offset:40960
    v_mfma_f32_16x16x32_bf16 v[232:235], a[136:139], a[76:79], v[232:235]
    ds_read_b64_tr_b16 a[174:175], v11 offset:45056
    s_mov_b32 s82, 1048576
    s_add_u32 m0, s3, 0
    s_waitcnt lgkmcnt(15)
    v_mfma_f32_16x16x32_bf16 v[140:143], a[140:143], a[64:67], v[140:143]
    buffer_load_dwordx4 v17, s[48:51], s82 offen lds
    v_mfma_f32_16x16x32_bf16 v[172:175], a[140:143], a[68:71], v[172:175]
    ds_read_b64_tr_b16 a[176:177], v12 offset:40960
    v_mfma_f32_16x16x32_bf16 v[204:207], a[140:143], a[72:75], v[204:207]
    ds_read_b64_tr_b16 a[178:179], v12 offset:45056
    v_mfma_f32_16x16x32_bf16 v[236:239], a[140:143], a[76:79], v[236:239]
    s_waitcnt lgkmcnt(15)
    v_mfma_f32_16x16x32_bf16 v[144:147], a[144:147], a[64:67], v[144:147]
    ds_read_b64_tr_b16 a[180:181], v13 offset:40960
    buffer_load_dwordx4 v18, s[48:51], s82 offen offset:1024 lds
    v_mfma_f32_16x16x32_bf16 v[176:179], a[144:147], a[68:71], v[176:179]
    ds_read_b64_tr_b16 a[182:183], v13 offset:45056
    v_mfma_f32_16x16x32_bf16 v[208:211], a[144:147], a[72:75], v[208:211]
    v_mfma_f32_16x16x32_bf16 v[240:243], a[144:147], a[76:79], v[240:243]
    ds_read_b64_tr_b16 a[184:185], v14 offset:40960
    s_waitcnt lgkmcnt(15)
    v_mfma_f32_16x16x32_bf16 v[148:151], a[148:151], a[64:67], v[148:151]
    ds_read_b64_tr_b16 a[186:187], v14 offset:45056
    v_mfma_f32_16x16x32_bf16 v[180:183], a[148:151], a[68:71], v[180:183]
    v_mfma_f32_16x16x32_bf16 v[212:215], a[148:151], a[72:75], v[212:215]
    ds_read_b64_tr_b16 a[188:189], v15 offset:40960
    v_mfma_f32_16x16x32_bf16 v[244:247], a[148:151], a[76:79], v[244:247]
    ds_read_b64_tr_b16 a[190:191], v15 offset:45056
    v_mfma_f32_16x16x32_bf16 v[152:155], a[152:155], a[64:67], v[152:155]
    v_mfma_f32_16x16x32_bf16 v[184:187], a[152:155], a[68:71], v[184:187]
    v_mfma_f32_16x16x32_bf16 v[216:219], a[152:155], a[72:75], v[216:219]
    v_mfma_f32_16x16x32_bf16 v[248:251], a[152:155], a[76:79], v[248:251]
    s_waitcnt lgkmcnt(15)
    v_mfma_f32_16x16x32_bf16 v[156:159], a[156:159], a[64:67], v[156:159]
    v_mfma_f32_16x16x32_bf16 v[188:191], a[156:159], a[68:71], v[188:191]
    v_mfma_f32_16x16x32_bf16 v[220:223], a[156:159], a[72:75], v[220:223]
    v_mfma_f32_16x16x32_bf16 v[252:255], a[156:159], a[76:79], v[252:255]
    s_waitcnt lgkmcnt(14)
    v_mfma_f32_16x16x32_bf16 v[128:131], a[160:163], a[80:83], v[128:131]
    buffer_load_dwordx4 a[64:67], v21, s[56:59], s68 offen sc1
    v_mfma_f32_16x16x32_bf16 v[160:163], a[160:163], a[84:87], v[160:163]
    ds_read_b64_tr_b16 a[128:129], v8 offset:49152
    v_mfma_f32_16x16x32_bf16 v[192:195], a[160:163], a[88:91], v[192:195]
    ds_read_b64_tr_b16 a[130:131], v8 offset:53248
    buffer_load_dwordx4 a[68:71], v22, s[56:59], s68 offen sc1
    v_mfma_f32_16x16x32_bf16 v[224:227], a[160:163], a[92:95], v[224:227]
    s_waitcnt lgkmcnt(14)
    v_mfma_f32_16x16x32_bf16 v[132:135], a[164:167], a[80:83], v[132:135]
    ds_read_b64_tr_b16 a[132:133], v9 offset:49152
    buffer_load_dwordx4 a[72:75], v23, s[56:59], s68 offen sc1
    v_mfma_f32_16x16x32_bf16 v[164:167], a[164:167], a[84:87], v[164:167]
    ds_read_b64_tr_b16 a[134:135], v9 offset:53248
    v_mfma_f32_16x16x32_bf16 v[196:199], a[164:167], a[88:91], v[196:199]
    buffer_load_dwordx4 a[76:79], v24, s[56:59], s68 offen sc1
    v_mfma_f32_16x16x32_bf16 v[228:231], a[164:167], a[92:95], v[228:231]
    ds_read_b64_tr_b16 a[136:137], v10 offset:49152
    s_waitcnt lgkmcnt(15)
    v_mfma_f32_16x16x32_bf16 v[136:139], a[168:171], a[80:83], v[136:139]
    ds_read_b64_tr_b16 a[138:139], v10 offset:53248
    s_add_u32 s68, s68, 16384
    v_mfma_f32_16x16x32_bf16 v[168:171], a[168:171], a[84:87], v[168:171]
    v_mfma_f32_16x16x32_bf16 v[200:203], a[168:171], a[88:91], v[200:203]
    ds_read_b64_tr_b16 a[140:141], v11 offset:49152
    v_mfma_f32_16x16x32_bf16 v[232:235], a[168:171], a[92:95], v[232:235]
    ds_read_b64_tr_b16 a[142:143], v11 offset:53248
    s_mov_b32 s83, 1277952
    s_add_u32 m0, s3, 8192
    s_waitcnt lgkmcnt(15)
    v_mfma_f32_16x16x32_bf16 v[140:143], a[172:175], a[80:83], v[140:143]
    buffer_load_dwordx4 v17, s[48:51], s83 offen lds
    v_mfma_f32_16x16x32_bf16 v[172:175], a[172:175], a[84:87], v[172:175]
    ds_read_b64_tr_b16 a[144:145], v12 offset:49152
    v_mfma_f32_16x16x32_bf16 v[204:207], a[172:175], a[88:91], v[204:207]
    ds_read_b64_tr_b16 a[146:147], v12 offset:53248
    v_mfma_f32_16x16x32_bf16 v[236:239], a[172:175], a[92:95], v[236:239]
    s_waitcnt lgkmcnt(15)
    v_mfma_f32_16x16x32_bf16 v[144:147], a[176:179], a[80:83], v[144:147]
    ds_read_b64_tr_b16 a[148:149], v13 offset:49152
    buffer_load_dwordx4 v18, s[48:51], s83 offen offset:1024 lds
    v_mfma_f32_16x16x32_bf16 v[176:179], a[176:179], a[84:87], v[176:179]
    ds_read_b64_tr_b16 a[150:151], v13 offset:53248
    v_mfma_f32_16x16x32_bf16 v[208:211], a[176:179], a[88:91], v[208:211]
    v_mfma_f32_16x16x32_bf16 v[240:243], a[176:179], a[92:95], v[240:243]
    ds_read_b64_tr_b16 a[152:153], v14 offset:49152
    s_waitcnt lgkmcnt(15)
    v_mfma_f32_16x16x32_bf16 v[148:151], a[180:183], a[80:83], v[148:151]
    ds_read_b64_tr_b16 a[154:155], v14 offset:53248
    v_mfma_f32_16x16x32_bf16 v[180:183], a[180:183], a[84:87], v[180:183]
    v_mfma_f32_16x16x32_bf16 v[212:215], a[180:183], a[88:91], v[212:215]
    ds_read_b64_tr_b16 a[156:157], v15 offset:49152
    v_mfma_f32_16x16x32_bf16 v[244:247], a[180:183], a[92:95], v[244:247]
    ds_read_b64_tr_b16 a[158:159], v15 offset:53248
    v_mfma_f32_16x16x32_bf16 v[152:155], a[184:187], a[80:83], v[152:155]
    v_mfma_f32_16x16x32_bf16 v[184:187], a[184:187], a[84:87], v[184:187]
    v_mfma_f32_16x16x32_bf16 v[216:219], a[184:187], a[88:91], v[216:219]
    v_mfma_f32_16x16x32_bf16 v[248:251], a[184:187], a[92:95], v[248:251]
    s_waitcnt lgkmcnt(15)
    v_mfma_f32_16x16x32_bf16 v[156:159], a[188:191], a[80:83], v[156:159]
    v_mfma_f32_16x16x32_bf16 v[188:191], a[188:191], a[84:87], v[188:191]
    v_mfma_f32_16x16x32_bf16 v[220:223], a[188:191], a[88:91], v[220:223]
    v_mfma_f32_16x16x32_bf16 v[252:255], a[188:191], a[92:95], v[252:255]
    s_waitcnt lgkmcnt(14)
    v_mfma_f32_16x16x32_bf16 v[128:131], a[128:131], a[96:99], v[128:131]
    buffer_load_dwordx4 a[80:83], v21, s[56:59], s68 offen sc1
    v_mfma_f32_16x16x32_bf16 v[160:163], a[128:131], a[100:103], v[160:163]
    ds_read_b64_tr_b16 a[160:161], v8 offset:57344
    v_mfma_f32_16x16x32_bf16 v[192:195], a[128:131], a[104:107], v[192:195]
    ds_read_b64_tr_b16 a[162:163], v8 offset:61440
    buffer_load_dwordx4 a[84:87], v22, s[56:59], s68 offen sc1
    v_mfma_f32_16x16x32_bf16 v[224:227], a[128:131], a[108:111], v[224:227]
    s_waitcnt lgkmcnt(14)
    v_mfma_f32_16x16x32_bf16 v[132:135], a[132:135], a[96:99], v[132:135]
    ds_read_b64_tr_b16 a[164:165], v9 offset:57344
    buffer_load_dwordx4 a[88:91], v23, s[56:59], s68 offen sc1
    v_mfma_f32_16x16x32_bf16 v[164:167], a[132:135], a[100:103], v[164:167]
    ds_read_b64_tr_b16 a[166:167], v9 offset:61440
    v_mfma_f32_16x16x32_bf16 v[196:199], a[132:135], a[104:107], v[196:199]
    buffer_load_dwordx4 a[92:95], v24, s[56:59], s68 offen sc1
    v_mfma_f32_16x16x32_bf16 v[228:231], a[132:135], a[108:111], v[228:231]
    ds_read_b64_tr_b16 a[168:169], v10 offset:57344
    s_waitcnt lgkmcnt(15)
    v_mfma_f32_16x16x32_bf16 v[136:139], a[136:139], a[96:99], v[136:139]
    ds_read_b64_tr_b16 a[170:171], v10 offset:61440
    s_add_u32 s68, s68, 16384
    v_mfma_f32_16x16x32_bf16 v[168:171], a[136:139], a[100:103], v[168:171]
    v_mfma_f32_16x16x32_bf16 v[200:203], a[136:139], a[104:107], v[200:203]
    ds_read_b64_tr_b16 a[172:173], v11 offset:57344
    v_mfma_f32_16x16x32_bf16 v[232:235], a[136:139], a[108:111], v[232:235]
    ds_read_b64_tr_b16 a[174:175], v11 offset:61440
    s_mov_b32 s82, 1507328
    s_add_u32 m0, s3, 16384
    s_waitcnt lgkmcnt(15)
    v_mfma_f32_16x16x32_bf16 v[140:143], a[140:143], a[96:99], v[140:143]
    buffer_load_dwordx4 v17, s[48:51], s82 offen lds
    v_mfma_f32_16x16x32_bf16 v[172:175], a[140:143], a[100:103], v[172:175]
    ds_read_b64_tr_b16 a[176:177], v12 offset:57344
    v_mfma_f32_16x16x32_bf16 v[204:207], a[140:143], a[104:107], v[204:207]
    ds_read_b64_tr_b16 a[178:179], v12 offset:61440
    v_mfma_f32_16x16x32_bf16 v[236:239], a[140:143], a[108:111], v[236:239]
    s_waitcnt lgkmcnt(15)
    v_mfma_f32_16x16x32_bf16 v[144:147], a[144:147], a[96:99], v[144:147]
    ds_read_b64_tr_b16 a[180:181], v13 offset:57344
    buffer_load_dwordx4 v18, s[48:51], s82 offen offset:1024 lds
    v_mfma_f32_16x16x32_bf16 v[176:179], a[144:147], a[100:103], v[176:179]
    ds_read_b64_tr_b16 a[182:183], v13 offset:61440
    v_mfma_f32_16x16x32_bf16 v[208:211], a[144:147], a[104:107], v[208:211]
    v_mfma_f32_16x16x32_bf16 v[240:243], a[144:147], a[108:111], v[240:243]
    ds_read_b64_tr_b16 a[184:185], v14 offset:57344
    s_waitcnt lgkmcnt(15)
    v_mfma_f32_16x16x32_bf16 v[148:151], a[148:151], a[96:99], v[148:151]
    ds_read_b64_tr_b16 a[186:187], v14 offset:61440
    v_mfma_f32_16x16x32_bf16 v[180:183], a[148:151], a[100:103], v[180:183]
    v_mfma_f32_16x16x32_bf16 v[212:215], a[148:151], a[104:107], v[212:215]
    ds_read_b64_tr_b16 a[188:189], v15 offset:57344
    v_mfma_f32_16x16x32_bf16 v[244:247], a[148:151], a[108:111], v[244:247]
    ds_read_b64_tr_b16 a[190:191], v15 offset:61440
    v_mfma_f32_16x16x32_bf16 v[152:155], a[152:155], a[96:99], v[152:155]
    v_mfma_f32_16x16x32_bf16 v[184:187], a[152:155], a[100:103], v[184:187]
    v_mfma_f32_16x16x32_bf16 v[216:219], a[152:155], a[104:107], v[216:219]
    v_mfma_f32_16x16x32_bf16 v[248:251], a[152:155], a[108:111], v[248:251]
    s_waitcnt lgkmcnt(15)
    v_mfma_f32_16x16x32_bf16 v[156:159], a[156:159], a[96:99], v[156:159]
    v_mfma_f32_16x16x32_bf16 v[188:191], a[156:159], a[100:103], v[188:191]
    v_mfma_f32_16x16x32_bf16 v[220:223], a[156:159], a[104:107], v[220:223]
    v_mfma_f32_16x16x32_bf16 v[252:255], a[156:159], a[108:111], v[252:255]
    s_waitcnt lgkmcnt(14)
    v_mfma_f32_16x16x32_bf16 v[128:131], a[160:163], a[112:115], v[128:131]
    buffer_load_dwordx4 a[96:99], v21, s[56:59], s68 offen sc1
    v_mfma_f32_16x16x32_bf16 v[160:163], a[160:163], a[116:119], v[160:163]
    ds_read_b64_tr_b16 a[128:129], v48 offset:0
    v_mfma_f32_16x16x32_bf16 v[192:195], a[160:163], a[120:123], v[192:195]
    ds_read_b64_tr_b16 a[130:131], v48 offset:4096
    buffer_load_dwordx4 a[100:103], v22, s[56:59], s68 offen sc1
    v_mfma_f32_16x16x32_bf16 v[224:227], a[160:163], a[124:127], v[224:227]
    s_waitcnt lgkmcnt(14)
    v_mfma_f32_16x16x32_bf16 v[132:135], a[164:167], a[112:115], v[132:135]
    ds_read_b64_tr_b16 a[132:133], v49 offset:0
    buffer_load_dwordx4 a[104:107], v23, s[56:59], s68 offen sc1
    v_mfma_f32_16x16x32_bf16 v[164:167], a[164:167], a[116:119], v[164:167]
    ds_read_b64_tr_b16 a[134:135], v49 offset:4096
    v_mfma_f32_16x16x32_bf16 v[196:199], a[164:167], a[120:123], v[196:199]
    buffer_load_dwordx4 a[108:111], v24, s[56:59], s68 offen sc1
    v_mfma_f32_16x16x32_bf16 v[228:231], a[164:167], a[124:127], v[228:231]
    ds_read_b64_tr_b16 a[136:137], v50 offset:0
    s_waitcnt lgkmcnt(15)
    v_mfma_f32_16x16x32_bf16 v[136:139], a[168:171], a[112:115], v[136:139]
    ds_read_b64_tr_b16 a[138:139], v50 offset:4096
    s_add_u32 s68, s68, 16384
    v_mfma_f32_16x16x32_bf16 v[168:171], a[168:171], a[116:119], v[168:171]
    v_mfma_f32_16x16x32_bf16 v[200:203], a[168:171], a[120:123], v[200:203]
    ds_read_b64_tr_b16 a[140:141], v51 offset:0
    v_mfma_f32_16x16x32_bf16 v[232:235], a[168:171], a[124:127], v[232:235]
    ds_read_b64_tr_b16 a[142:143], v51 offset:4096
    s_mov_b32 s83, 1736704
    s_add_u32 m0, s3, 24576
    s_waitcnt lgkmcnt(15)
    v_mfma_f32_16x16x32_bf16 v[140:143], a[172:175], a[112:115], v[140:143]
    buffer_load_dwordx4 v17, s[48:51], s83 offen lds
    v_mfma_f32_16x16x32_bf16 v[172:175], a[172:175], a[116:119], v[172:175]
    ds_read_b64_tr_b16 a[144:145], v52 offset:0
    v_mfma_f32_16x16x32_bf16 v[204:207], a[172:175], a[120:123], v[204:207]
    ds_read_b64_tr_b16 a[146:147], v52 offset:4096
    v_mfma_f32_16x16x32_bf16 v[236:239], a[172:175], a[124:127], v[236:239]
    s_waitcnt lgkmcnt(15)
    v_mfma_f32_16x16x32_bf16 v[144:147], a[176:179], a[112:115], v[144:147]
    ds_read_b64_tr_b16 a[148:149], v53 offset:0
    buffer_load_dwordx4 v18, s[48:51], s83 offen offset:1024 lds
    v_mfma_f32_16x16x32_bf16 v[176:179], a[176:179], a[116:119], v[176:179]
    ds_read_b64_tr_b16 a[150:151], v53 offset:4096
    v_mfma_f32_16x16x32_bf16 v[208:211], a[176:179], a[120:123], v[208:211]
    v_mfma_f32_16x16x32_bf16 v[240:243], a[176:179], a[124:127], v[240:243]
    ds_read_b64_tr_b16 a[152:153], v54 offset:0
    s_waitcnt lgkmcnt(15)
    v_mfma_f32_16x16x32_bf16 v[148:151], a[180:183], a[112:115], v[148:151]
    ds_read_b64_tr_b16 a[154:155], v54 offset:4096
    v_mfma_f32_16x16x32_bf16 v[180:183], a[180:183], a[116:119], v[180:183]
    v_mfma_f32_16x16x32_bf16 v[212:215], a[180:183], a[120:123], v[212:215]
    ds_read_b64_tr_b16 a[156:157], v55 offset:0
    v_mfma_f32_16x16x32_bf16 v[244:247], a[180:183], a[124:127], v[244:247]
    ds_read_b64_tr_b16 a[158:159], v55 offset:4096
    v_mfma_f32_16x16x32_bf16 v[152:155], a[184:187], a[112:115], v[152:155]
    v_mfma_f32_16x16x32_bf16 v[184:187], a[184:187], a[116:119], v[184:187]
    v_mfma_f32_16x16x32_bf16 v[216:219], a[184:187], a[120:123], v[216:219]
    v_mfma_f32_16x16x32_bf16 v[248:251], a[184:187], a[124:127], v[248:251]
    s_waitcnt lgkmcnt(15)
    v_mfma_f32_16x16x32_bf16 v[156:159], a[188:191], a[112:115], v[156:159]
    v_mfma_f32_16x16x32_bf16 v[188:191], a[188:191], a[116:119], v[188:191]
    v_mfma_f32_16x16x32_bf16 v[220:223], a[188:191], a[120:123], v[220:223]
    v_mfma_f32_16x16x32_bf16 v[252:255], a[188:191], a[124:127], v[252:255]
    s_barrier
    s_waitcnt vmcnt(40) lgkmcnt(14)
    v_mfma_f32_16x16x32_bf16 v[128:131], a[128:131], a[0:3], v[128:131]
    buffer_load_dwordx4 a[112:115], v21, s[56:59], s68 offen sc1
    s_waitcnt vmcnt(40)
    v_mfma_f32_16x16x32_bf16 v[160:163], a[128:131], a[4:7], v[160:163]
    ds_read_b64_tr_b16 a[160:161], v48 offset:8192
    s_waitcnt vmcnt(39)
    v_mfma_f32_16x16x32_bf16 v[192:195], a[128:131], a[8:11], v[192:195]
    ds_read_b64_tr_b16 a[162:163], v48 offset:12288
    buffer_load_dwordx4 a[116:119], v22, s[56:59], s68 offen sc1
    s_waitcnt vmcnt(39)
    v_mfma_f32_16x16x32_bf16 v[224:227], a[128:131], a[12:15], v[224:227]
    s_waitcnt lgkmcnt(14)
    v_mfma_f32_16x16x32_bf16 v[132:135], a[132:135], a[0:3], v[132:135]
    ds_read_b64_tr_b16 a[164:165], v49 offset:8192
    buffer_load_dwordx4 a[120:123], v23, s[56:59], s68 offen sc1
    v_mfma_f32_16x16x32_bf16 v[164:167], a[132:135], a[4:7], v[164:167]
    ds_read_b64_tr_b16 a[166:167], v49 offset:12288
    v_mfma_f32_16x16x32_bf16 v[196:199], a[132:135], a[8:11], v[196:199]
    buffer_load_dwordx4 a[124:127], v24, s[56:59], s68 offen sc1
    v_mfma_f32_16x16x32_bf16 v[228:231], a[132:135], a[12:15], v[228:231]
    ds_read_b64_tr_b16 a[168:169], v50 offset:8192
    s_waitcnt lgkmcnt(15)
    v_mfma_f32_16x16x32_bf16 v[136:139], a[136:139], a[0:3], v[136:139]
    ds_read_b64_tr_b16 a[170:171], v50 offset:12288
    s_add_u32 s68, s68, 16384
    v_mfma_f32_16x16x32_bf16 v[168:171], a[136:139], a[4:7], v[168:171]
    v_mfma_f32_16x16x32_bf16 v[200:203], a[136:139], a[8:11], v[200:203]
    ds_read_b64_tr_b16 a[172:173], v51 offset:8192
    v_mfma_f32_16x16x32_bf16 v[232:235], a[136:139], a[12:15], v[232:235]
    ds_read_b64_tr_b16 a[174:175], v51 offset:12288
    s_mov_b32 s82, 196608
    s_add_u32 m0, s3, 32768
    s_waitcnt lgkmcnt(15)
    v_mfma_f32_16x16x32_bf16 v[140:143], a[140:143], a[0:3], v[140:143]
    buffer_load_dwordx4 v19, s[48:51], s82 offen lds
    v_mfma_f32_16x16x32_bf16 v[172:175], a[140:143], a[4:7], v[172:175]
    ds_read_b64_tr_b16 a[176:177], v52 offset:8192
    v_mfma_f32_16x16x32_bf16 v[204:207], a[140:143], a[8:11], v[204:207]
    ds_read_b64_tr_b16 a[178:179], v52 offset:12288
    v_mfma_f32_16x16x32_bf16 v[236:239], a[140:143], a[12:15], v[236:239]
    s_waitcnt lgkmcnt(15)
    v_mfma_f32_16x16x32_bf16 v[144:147], a[144:147], a[0:3], v[144:147]
    ds_read_b64_tr_b16 a[180:181], v53 offset:8192
    buffer_load_dwordx4 v20, s[48:51], s82 offen offset:1024 lds
    v_mfma_f32_16x16x32_bf16 v[176:179], a[144:147], a[4:7], v[176:179]
    ds_read_b64_tr_b16 a[182:183], v53 offset:12288
    v_mfma_f32_16x16x32_bf16 v[208:211], a[144:147], a[8:11], v[208:211]
    v_mfma_f32_16x16x32_bf16 v[240:243], a[144:147], a[12:15], v[240:243]
    ds_read_b64_tr_b16 a[184:185], v54 offset:8192
    s_waitcnt lgkmcnt(15)
    v_mfma_f32_16x16x32_bf16 v[148:151], a[148:151], a[0:3], v[148:151]
    ds_read_b64_tr_b16 a[186:187], v54 offset:12288
    v_mfma_f32_16x16x32_bf16 v[180:183], a[148:151], a[4:7], v[180:183]
    v_mfma_f32_16x16x32_bf16 v[212:215], a[148:151], a[8:11], v[212:215]
    ds_read_b64_tr_b16 a[188:189], v55 offset:8192
    v_mfma_f32_16x16x32_bf16 v[244:247], a[148:151], a[12:15], v[244:247]
    ds_read_b64_tr_b16 a[190:191], v55 offset:12288
    v_mfma_f32_16x16x32_bf16 v[152:155], a[152:155], a[0:3], v[152:155]
    v_mfma_f32_16x16x32_bf16 v[184:187], a[152:155], a[4:7], v[184:187]
    v_mfma_f32_16x16x32_bf16 v[216:219], a[152:155], a[8:11], v[216:219]
    v_mfma_f32_16x16x32_bf16 v[248:251], a[152:155], a[12:15], v[248:251]
    s_waitcnt lgkmcnt(15)
    v_mfma_f32_16x16x32_bf16 v[156:159], a[156:159], a[0:3], v[156:159]
    v_mfma_f32_16x16x32_bf16 v[188:191], a[156:159], a[4:7], v[188:191]
    v_mfma_f32_16x16x32_bf16 v[220:223], a[156:159], a[8:11], v[220:223]
    v_mfma_f32_16x16x32_bf16 v[252:255], a[156:159], a[12:15], v[252:255]
    s_waitcnt vmcnt(42) lgkmcnt(14)
    v_mfma_f32_16x16x32_bf16 v[128:131], a[160:163], a[16:19], v[128:131]
    s_waitcnt vmcnt(30)
    v_readfirstlane_b32 s86, v43
    s_bfe_u32 s86, s86, 0x80008
    s_cmp_eq_u32 s86, 16
    s_cbranch_scc0 L_spB
L_okB:
    buffer_load_dwordx4 a[0:3], v21, s[56:59], s68 offen sc1
    v_mfma_f32_16x16x32_bf16 v[160:163], a[160:163], a[20:23], v[160:163]
    ds_read_b64_tr_b16 a[128:129], v48 offset:16384
    v_mfma_f32_16x16x32_bf16 v[192:195], a[160:163], a[24:27], v[192:195]
    ds_read_b64_tr_b16 a[130:131], v48 offset:20480
    buffer_load_dwordx4 a[4:7], v22, s[56:59], s68 offen sc1
    v_mfma_f32_16x16x32_bf16 v[224:227], a[160:163], a[28:31], v[224:227]
    s_waitcnt lgkmcnt(14)
    v_mfma_f32_16x16x32_bf16 v[132:135], a[164:167], a[16:19], v[132:135]
    ds_read_b64_tr_b16 a[132:133], v49 offset:16384
    buffer_load_dwordx4 a[8:11], v23, s[56:59], s68 offen sc1
    v_mfma_f32_16x16x32_bf16 v[164:167], a[164:167], a[20:23], v[164:167]
    ds_read_b64_tr_b16 a[134:135], v49 offset:20480
    v_mfma_f32_16x16x32_bf16 v[196:199], a[164:167], a[24:27], v[196:199]
    buffer_load_dwordx4 a[12:15], v24, s[56:59], s68 offen sc1
    v_mfma_f32_16x16x32_bf16 v[228:231], a[164:167], a[28:31], v[228:231]
    ds_read_b64_tr_b16 a[136:137], v50 offset:16384
    s_waitcnt lgkmcnt(15)
    v_mfma_f32_16x16x32_bf16 v[136:139], a[168:171], a[16:19], v[136:139]
    ds_read_b64_tr_b16 a[138:139], v50 offset:20480
    s_add_u32 s68, s68, 16384
    v_mfma_f32_16x16x32_bf16 v[168:171], a[168:171], a[20:23], v[168:171]
    v_mfma_f32_16x16x32_bf16 v[200:203], a[168:171], a[24:27], v[200:203]
    ds_read_b64_tr_b16 a[140:141], v51 offset:16384
    v_mfma_f32_16x16x32_bf16 v[232:235], a[168:171], a[28:31], v[232:235]
    ds_read_b64_tr_b16 a[142:143], v51 offset:20480
    s_mov_b32 s83, 655360
    s_add_u32 m0, s3, 40960
    s_waitcnt lgkmcnt(15)
    v_mfma_f32_16x16x32_bf16 v[140:143], a[172:175], a[16:19], v[140:143]
    buffer_load_dwordx4 v19, s[48:51], s83 offen lds
    v_mfma_f32_16x16x32_bf16 v[172:175], a[172:175], a[20:23], v[172:175]
    ds_read_b64_tr_b16 a[144:145], v52 offset:16384
    v_mfma_f32_16x16x32_bf16 v[204:207], a[172:175], a[24:27], v[204:207]
    ds_read_b64_tr_b16 a[146:147], v52 offset:20480
    v_mfma_f32_16x16x32_bf16 v[236:239], a[172:175], a[28:31], v[236:239]
    s_waitcnt lgkmcnt(15)
    v_mfma_f32_16x16x32_bf16 v[144:147], a[176:179], a[16:19], v[144:147]
    ds_read_b64_tr_b16 a[148:149], v53 offset:16384
    buffer_load_dwordx4 v20, s[48:51], s83 offen offset:1024 lds
    v_mfma_f32_16x16x32_bf16 v[176:179], a[176:179], a[20:23], v[176:179]
    ds_read_b64_tr_b16 a[150:151], v53 offset:20480
    v_mfma_f32_16x16x32_bf16 v[208:211], a[176:179], a[24:27], v[208:211]
    v_mfma_f32_16x16x32_bf16 v[240:243], a[176:179], a[28:31], v[240:243]
    ds_read_b64_tr_b16 a[152:153], v54 offset:16384
    s_waitcnt lgkmcnt(15)
    v_mfma_f32_16x16x32_bf16 v[148:151], a[180:183], a[16:19], v[148:151]
    ds_read_b64_tr_b16 a[154:155], v54 offset:20480
    v_mfma_f32_16x16x32_bf16 v[180:183], a[180:183], a[20:23], v[180:183]
    v_mfma_f32_16x16x32_bf16 v[212:215], a[180:183], a[24:27], v[212:215]
    ds_read_b64_tr_b16 a[156:157], v55 offset:16384
    v_mfma_f32_16x16x32_bf16 v[244:247], a[180:183], a[28:31], v[244:247]
    ds_read_b64_tr_b16 a[158:159], v55 offset:20480
    v_mfma_f32_16x16x32_bf16 v[152:155], a[184:187], a[16:19], v[152:155]
    v_mfma_f32_16x16x32_bf16 v[184:187], a[184:187], a[20:23], v[184:187]
    v_mfma_f32_16x16x32_bf16 v[216:219], a[184:187], a[24:27], v[216:219]
    v_mfma_f32_16x16x32_bf16 v[248:251], a[184:187], a[28:31], v[248:251]
    s_waitcnt lgkmcnt(15)
    v_mfma_f32_16x16x32_bf16 v[156:159], a[188:191], a[16:19], v[156:159]
    v_mfma_f32_16x16x32_bf16 v[188:191], a[188:191], a[20:23], v[188:191]
    v_mfma_f32_16x16x32_bf16 v[220:223], a[188:191], a[24:27], v[220:223]
    v_mfma_f32_16x16x32_bf16 v[252:255], a[188:191], a[28:31], v[252:255]
    s_waitcnt lgkmcnt(14)
    v_mfma_f32_16x16x32_bf16 v[128:131], a[128:131], a[32:35], v[128:131]
    buffer_load_dwordx4 a[16:19], v21, s[56:59], s68 offen sc1
    v_mfma_f32_16x16x32_bf16 v[160:163], a[128:131], a[36:39], v[160:163]
    ds_read_b64_tr_b16 a[160:161], v48 offset:24576
    v_mfma_f32_16x16x32_bf16 v[192:195], a[128:131], a[40:43], v[192:195]
    ds_read_b64_tr_b16 a[162:163], v48 offset:28672
    buffer_load_dwordx4 a[20:23], v22, s[56:59], s68 offen sc1
    v_mfma_f32_16x16x32_bf16 v[224:227], a[128:131], a[44:47], v[224:227]
    s_waitcnt lgkmcnt(14)
    v_mfma_f32_16x16x32_bf16 v[132:135], a[132:135], a[32:35], v[132:135]
    ds_read_b64_tr_b16 a[164:165], v49 offset:24576
    buffer_load_dwordx4 a[24:27], v23, s[56:59], s68 offen sc1
    v_mfma_f32_16x16x32_bf16 v[164:167], a[132:135], a[36:39], v[164:167]
    ds_read_b64_tr_b16 a[166:167], v49 offset:28672
    v_mfma_f32_16x16x32_bf16 v[196:199], a[132:135], a[40:43], v[196:199]
    buffer_load_dwordx4 a[28:31], v24, s[56:59], s68 offen sc1
    v_mfma_f32_16x16x32_bf16 v[228:231], a[132:135], a[44:47], v[228:231]
    ds_read_b64_tr_b16 a[168:169], v50 offset:24576
    s_waitcnt lgkmcnt(15)
    v_mfma_f32_16x16x32_bf16 v[136:139], a[136:139], a[32:35], v[136:139]
    ds_read_b64_tr_b16 a[170:171], v50 offset:28672
    s_add_u32 s68, s68, 16384
    v_mfma_f32_16x16x32_bf16 v[168:171], a[136:139], a[36:39], v[168:171]
    v_mfma_f32_16x16x32_bf16 v[200:203], a[136:139], a[40:43], v[200:203]
    ds_read_b64_tr_b16 a[172:173], v51 offset:24576
    v_mfma_f32_16x16x32_bf16 v[232:235], a[136:139], a[44:47], v[232:235]
    ds_read_b64_tr_b16 a[174:175], v51 offset:28672
    s_mov_b32 s82, 1114112
    s_add_u32 m0, s3, 49152
    s_waitcnt lgkmcnt(15)
    v_mfma_f32_16x16x32_bf16 v[140:143], a[140:143], a[32:35], v[140:143]
    buffer_load_dwordx4 v19, s[48:51], s82 offen lds
    v_mfma_f32_16x16x32_bf16 v[172:175], a[140:143], a[36:39], v[172:175]
    ds_read_b64_tr_b16 a[176:177], v52 offset:24576
    v_mfma_f32_16x16x32_bf16 v[204:207], a[140:143], a[40:43], v[204:207]
    ds_read_b64_tr_b16 a[178:179], v52 offset:28672
    v_mfma_f32_16x16x32_bf16 v[236:239], a[140:143], a[44:47], v[236:239]
    s_waitcnt lgkmcnt(15)
    v_mfma_f32_16x16x32_bf16 v[144:147], a[144:147], a[32:35], v[144:147]
    ds_read_b64_tr_b16 a[180:181], v53 offset:24576
    buffer_load_dwordx4 v20, s[48:51], s82 offen offset:1024 lds
    v_mfma_f32_16x16x32_bf16 v[176:179], a[144:147], a[36:39], v[176:179]
    ds_read_b64_tr_b16 a[182:183], v53 offset:28672
    v_mfma_f32_16x16x32_bf16 v[208:211], a[144:147], a[40:43], v[208:211]
    v_mfma_f32_16x16x32_bf16 v[240:243], a[144:147], a[44:47], v[240:243]
    ds_read_b64_tr_b16 a[184:185], v54 offset:24576
    s_waitcnt lgkmcnt(15)
    v_mfma_f32_16x16x32_bf16 v[148:151], a[148:151], a[32:35], v[148:151]
    ds_read_b64_tr_b16 a[186:187], v54 offset:28672
    v_mfma_f32_16x16x32_bf16 v[180:183], a[148:151], a[36:39], v[180:183]
    v_mfma_f32_16x16x32_bf16 v[212:215], a[148:151], a[40:43], v[212:215]
    ds_read_b64_tr_b16 a[188:189], v55 offset:24576
    v_mfma_f32_16x16x32_bf16 v[244:247], a[148:151], a[44:47], v[244:247]
    ds_read_b64_tr_b16 a[190:191], v55 offset:28672
    v_mfma_f32_16x16x32_bf16 v[152:155], a[152:155], a[32:35], v[152:155]
    s_branch L_over9
L_stub9:
    s_branch L_stub10
L_over9:
    v_mfma_f32_16x16x32_bf16 v[184:187], a[152:155], a[36:39], v[184:187]
    v_mfma_f32_16x16x32_bf16 v[216:219], a[152:155], a[40:43], v[216:219]
    v_mfma_f32_16x16x32_bf16 v[248:251], a[152:155], a[44:47], v[248:251]
    s_waitcnt lgkmcnt(15)
    v_mfma_f32_16x16x32_bf16 v[156:159], a[156:159], a[32:35], v[156:159]
    buffer_load_dword v43, off, s[56:59], s92 sc1
    v_mfma_f32_16x16x32_bf16 v[188:191], a[156:159], a[36:39], v[188:191]
    v_mfma_f32_16x16x32_bf16 v[220:223], a[156:159], a[40:43], v[220:223]
    v_mfma_f32_16x16x32_bf16 v[252:255], a[156:159], a[44:47], v[252:255]
    s_waitcnt vmcnt(42) lgkmcnt(14)
    v_mfma_f32_16x16x32_bf16 v[128:131], a[160:163], a[48:51], v[128:131]
    buffer_load_dwordx4 a[32:35], v21, s[56:59], s68 offen sc1
    s_waitcnt vmcnt(42)
    v_mfma_f32_16x16x32_bf16 v[160:163], a[160:163], a[52:55], v[160:163]
    ds_read_b64_tr_b16 a[128:129], v48 offset:32768
    s_waitcnt vmcnt(41)
    v_mfma_f32_16x16x32_bf16 v[192:195], a[160:163], a[56:59], v[192:195]
    ds_read_b64_tr_b16 a[130:131], v48 offset:36864
    buffer_load_dwordx4 a[36:39], v22, s[56:59], s68 offen sc1
    s_waitcnt vmcnt(41)
    v_mfma_f32_16x16x32_bf16 v[224:227], a[160:163], a[60:63], v[224:227]
    s_waitcnt lgkmcnt(14)
    v_mfma_f32_16x16x32_bf16 v[132:135], a[164:167], a[48:51], v[132:135]
    ds_read_b64_tr_b16 a[132:133], v49 offset:32768
    buffer_load_dwordx4 a[40:43], v23, s[56:59], s68 offen sc1
    v_mfma_f32_16x16x32_bf16 v[164:167], a[164:167], a[52:55], v[164:167]
    ds_read_b64_tr_b16 a[134:135], v49 offset:36864
    v_mfma_f32_16x16x32_bf16 v[196:199], a[164:167], a[56:59], v[196:199]
    buffer_load_dwordx4 a[44:47], v24, s[56:59], s68 offen sc1
    v_mfma_f32_16x16x32_bf16 v[228:231], a[164:167], a[60:63], v[228:231]
    ds_read_b64_tr_b16 a[136:137], v50 offset:32768
    s_waitcnt lgkmcnt(15)
    v_mfma_f32_16x16x32_bf16 v[136:139], a[168:171], a[48:51], v[136:139]
    ds_read_b64_tr_b16 a[138:139], v50 offset:36864
    s_add_u32 s68, s68, 16384
    v_mfma_f32_16x16x32_bf16 v[168:171], a[168:171], a[52:55], v[168:171]
    v_mfma_f32_16x16x32_bf16 v[200:203], a[168:171], a[56:59], v[200:203]
    ds_read_b64_tr_b16 a[140:141], v51 offset:32768
    v_mfma_f32_16x16x32_bf16 v[232:235], a[168:171], a[60:63], v[232:235]
    ds_read_b64_tr_b16 a[142:143], v51 offset:36864
    s_mov_b32 s83, 1572864
    s_add_u32 m0, s3, 57344
    s_waitcnt lgkmcnt(15)
    v_mfma_f32_16x16x32_bf16 v[140:143], a[172:175], a[48:51], v[140:143]
    buffer_load_dwordx4 v19, s[48:51], s83 offen lds
    v_mfma_f32_16x16x32_bf16 v[172:175], a[172:175], a[52:55], v[172:175]
    ds_read_b64_tr_b16 a[144:145], v52 offset:32768
    v_mfma_f32_16x16x32_bf16 v[204:207], a[172:175], a[56:59], v[204:207]
    ds_read_b64_tr_b16 a[146:147], v52 offset:36864
    v_mfma_f32_16x16x32_bf16 v[236:239], a[172:175], a[60:63], v[236:239]
    s_waitcnt lgkmcnt(15)
    v_mfma_f32_16x16x32_bf16 v[144:147], a[176:179], a[48:51], v[144:147]
    ds_read_b64_tr_b16 a[148:149], v53 offset:32768
    buffer_load_dwordx4 v20, s[48:51], s83 offen offset:1024 lds
    v_mfma_f32_16x16x32_bf16 v[176:179], a[176:179], a[52:55], v[176:179]
    ds_read_b64_tr_b16 a[150:151], v53 offset:36864
    v_mfma_f32_16x16x32_bf16 v[208:211], a[176:179], a[56:59], v[208:211]
    v_mfma_f32_16x16x32_bf16 v[240:243], a[176:179], a[60:63], v[240:243]
    ds_read_b64_tr_b16 a[152:153], v54 offset:32768
    s_waitcnt lgkmcnt(15)
    v_mfma_f32_16x16x32_bf16 v[148:151], a[180:183], a[48:51], v[148:151]
    ds_read_b64_tr_b16 a[154:155], v54 offset:36864
    v_mfma_f32_16x16x32_bf16 v[180:183], a[180:183], a[52:55], v[180:183]
    v_mfma_f32_16x16x32_bf16 v[212:215], a[180:183], a[56:59], v[212:215]
    ds_read_b64_tr_b16 a[156:157], v55 offset:32768
    v_mfma_f32_16x16x32_bf16 v[244:247], a[180:183], a[60:63], v[244:247]
    ds_read_b64_tr_b16 a[158:159], v55 offset:36864
    v_mfma_f32_16x16x32_bf16 v[152:155], a[184:187], a[48:51], v[152:155]
    v_mfma_f32_16x16x32_bf16 v[184:187], a[184:187], a[52:55], v[184:187]
    v_mfma_f32_16x16x32_bf16 v[216:219], a[184:187], a[56:59], v[216:219]
    v_mfma_f32_16x16x32_bf16 v[248:251], a[184:187], a[60:63], v[248:251]
    s_waitcnt lgkmcnt(15)
    v_mfma_f32_16x16x32_bf16 v[156:159], a[188:191], a[48:51], v[156:159]
    v_mfma_f32_16x16x32_bf16 v[188:191], a[188:191], a[52:55], v[188:191]
    v_mfma_f32_16x16x32_bf16 v[220:223], a[188:191], a[56:59], v[220:223]
    v_mfma_f32_16x16x32_bf16 v[252:255], a[188:191], a[60:63], v[252:255]
    s_barrier
    s_waitcnt vmcnt(42) lgkmcnt(14)
    v_mfma_f32_16x16x32_bf16 v[128:131], a[128:131], a[64:67], v[128:131]
    buffer_load_dwordx4 a[48:51], v21, s[56:59], s68 offen sc1
    s_waitcnt vmcnt(42)
    v_mfma_f32_16x16x32_bf16 v[160:163], a[128:131], a[68:71], v[160:163]
    ds_read_b64_tr_b16 a[160:161], v48 offset:40960
    s_waitcnt vmcnt(41)
    v_mfma_f32_16x16x32_bf16 v[192:195], a[128:131], a[72:75], v[192:195]
    ds_read_b64_tr_b16 a[162:163], v48 offset:45056
    buffer_load_dwordx4 a[52:55], v22, s[56:59], s68 offen sc1
    s_waitcnt vmcnt(41)
    v_mfma_f32_16x16x32_bf16 v[224:227], a[128:131], a[76:79], v[224:227]
    s_waitcnt lgkmcnt(14)
    v_mfma_f32_16x16x32_bf16 v[132:135], a[132:135], a[64:67], v[132:135]
    ds_read_b64_tr_b16 a[164:165], v49 offset:40960
    buffer_load_dwordx4 a[56:59], v23, s[56:59], s68 offen sc1
    v_mfma_f32_16x16x32_bf16 v[164:167], a[132:135], a[68:71], v[164:167]
    ds_read_b64_tr_b16 a[166:167], v49 offset:45056
    v_mfma_f32_16x16x32_bf16 v[196:199], a[132:135], a[72:75], v[196:199]
    buffer_load_dwordx4 a[60:63], v24, s[56:59], s68 offen sc1
    v_mfma_f32_16x16x32_bf16 v[228:231], a[132:135], a[76:79], v[228:231]
    ds_read_b64_tr_b16 a[168:169], v50 offset:40960
    s_waitcnt lgkmcnt(15)
    v_mfma_f32_16x16x32_bf16 v[136:139], a[136:139], a[64:67], v[136:139]
    ds_read_b64_tr_b16 a[170:171], v50 offset:45056
    s_add_u32 s68, s68, 16384
    v_mfma_f32_16x16x32_bf16 v[168:171], a[136:139], a[68:71], v[168:171]
    v_mfma_f32_16x16x32_bf16 v[200:203], a[136:139], a[72:75], v[200:203]
    ds_read_b64_tr_b16 a[172:173], v51 offset:40960
    v_cndmask_b32 v72, v64, v68, s[4:5]
    v_mfma_f32_16x16x32_bf16 v[232:235], a[136:139], a[76:79], v[232:235]
    ds_read_b64_tr_b16 a[174:175], v51 offset:45056
    s_mov_b32 s82, 0
    s_add_u32 m0, s3, 65536
    v_cndmask_b32 v73, v65, v69, s[4:5]
    s_waitcnt lgkmcnt(15)
    v_mfma_f32_16x16x32_bf16 v[140:143], a[140:143], a[64:67], v[140:143]
    buffer_load_dwordx4 v17, s[52:55], s82 offen lds
    v_cndmask_b32 v74, v66, v70, s[4:5]
    v_mfma_f32_16x16x32_bf16 v[172:175], a[140:143], a[68:71], v[172:175]
    ds_read_b64_tr_b16 a[176:177], v52 offset:40960
    v_cndmask_b32 v75, v67, v71, s[4:5]
    v_mfma_f32_16x16x32_bf16 v[204:207], a[140:143], a[72:75], v[204:207]
    ds_read_b64_tr_b16 a[178:179], v52 offset:45056
    v_cndmask_b32 v64, v68, v64, s[4:5]
    v_mfma_f32_16x16x32_bf16 v[236:239], a[140:143], a[76:79], v[236:239]
    v_cndmask_b32 v65, v69, v65, s[4:5]
    s_waitcnt lgkmcnt(15)
    v_mfma_f32_16x16x32_bf16 v[144:147], a[144:147], a[64:67], v[144:147]
    ds_read_b64_tr_b16 a[180:181], v53 offset:40960
    buffer_load_dwordx4 v18, s[52:55], s82 offen offset:1024 lds
    v_cndmask_b32 v66, v70, v66, s[4:5]
    v_mfma_f32_16x16x32_bf16 v[176:179], a[144:147], a[68:71], v[176:179]
    ds_read_b64_tr_b16 a[182:183], v53 offset:45056
    v_cndmask_b32 v67, v71, v67, s[4:5]
    v_mfma_f32_16x16x32_bf16 v[208:211], a[144:147], a[72:75], v[208:211]
    v_mov_b32_dpp v76, v72 row_ror:8 row_mask:0xf bank_mask:0xf
    v_mfma_f32_16x16x32_bf16 v[240:243], a[144:147], a[76:79], v[240:243]
    ds_read_b64_tr_b16 a[184:185], v54 offset:40960
    v_mov_b32_dpp v77, v73 row_ror:8 row_mask:0xf bank_mask:0xf
    s_waitcnt lgkmcnt(15)
    v_mfma_f32_16x16x32_bf16 v[148:151], a[148:151], a[64:67], v[148:151]
    ds_read_b64_tr_b16 a[186:187], v54 offset:45056
    v_mov_b32_dpp v78, v74 row_ror:8 row_mask:0xf bank_mask:0xf
    v_mfma_f32_16x16x32_bf16 v[180:183], a[148:151], a[68:71], v[180:183]
    v_mov_b32_dpp v79, v75 row_ror:8 row_mask:0xf bank_mask:0xf
    v_mfma_f32_16x16x32_bf16 v[212:215], a[148:151], a[72:75], v[212:215]
    ds_read_b64_tr_b16 a[188:189], v55 offset:40960
    v_permlane16_swap_b32 v64, v66
    v_mfma_f32_16x16x32_bf16 v[244:247], a[148:151], a[76:79], v[244:247]
    ds_read_b64_tr_b16 a[190:191], v55 offset:45056
    v_permlane16_swap_b32 v65, v67
    v_mfma_f32_16x16x32_bf16 v[152:155], a[152:155], a[64:67], v[152:155]
    v_permlane16_swap_b32 v76, v78
    v_mfma_f32_16x16x32_bf16 v[184:187], a[152:155], a[68:71], v[184:187]
    v_permlane16_swap_b32 v77, v79
    v_mfma_f32_16x16x32_bf16 v[216:219], a[152:155], a[72:75], v[216:219]
    v_mfma_f32_16x16x32_bf16 v[248:251], a[152:155], a[76:79], v[248:251]
    s_waitcnt lgkmcnt(15)
    v_mfma_f32_16x16x32_bf16 v[156:159], a[156:159], a[64:67], v[156:159]
    v_mfma_f32_16x16x32_bf16 v[188:191], a[156:159], a[68:71], v[188:191]
    v_mfma_f32_16x16x32_bf16 v[220:223], a[156:159], a[72:75], v[220:223]
    v_mfma_f32_16x16x32_bf16 v[252:255], a[156:159], a[76:79], v[252:255]
    s_waitcnt vmcnt(42) lgkmcnt(14)
    v_mfma_f32_16x16x32_bf16 v[128:131], a[160:163], a[80:83], v[128:131]
    buffer_load_dwordx4 a[64:67], v21, s[56:59], s68 offen sc1
    s_waitcnt vmcnt(42)
    v_mfma_f32_16x16x32_bf16 v[160:163], a[160:163], a[84:87], v[160:163]
    ds_read_b64_tr_b16 a[128:129], v48 offset:49152
    s_waitcnt vmcnt(41)
    v_mfma_f32_16x16x32_bf16 v[192:195], a[160:163], a[88:91], v[192:195]
    ds_read_b64_tr_b16 a[130:131], v48 offset:53248
    buffer_load_dwordx4 a[68:71], v22, s[56:59], s68 offen sc1
    s_waitcnt vmcnt(41)
    v_mfma_f32_16x16x32_bf16 v[224:227], a[160:163], a[92:95], v[224:227]
    s_waitcnt lgkmcnt(14)
    v_mfma_f32_16x16x32_bf16 v[132:135], a[164:167], a[80:83], v[132:135]
    ds_read_b64_tr_b16 a[132:133], v49 offset:49152
    buffer_load_dwordx4 a[72:75], v23, s[56:59], s68 offen sc1
    v_mfma_f32_16x16x32_bf16 v[164:167], a[164:167], a[84:87], v[164:167]
    ds_read_b64_tr_b16 a[134:135], v49 offset:53248
    v_mfma_f32_16x16x32_bf16 v[196:199], a[164:167], a[88:91], v[196:199]
    buffer_load_dwordx4 a[76:79], v24, s[56:59], s68 offen sc1
    v_mfma_f32_16x16x32_bf16 v[228:231], a[164:167], a[92:95], v[228:231]
    ds_read_b64_tr_b16 a[136:137], v50 offset:49152
    s_waitcnt lgkmcnt(15)
    v_mfma_f32_16x16x32_bf16 v[136:139], a[168:171], a[80:83], v[136:139]
    ds_read_b64_tr_b16 a[138:139], v50 offset:53248
    s_add_u32 s68, s68, 16384
    v_mfma_f32_16x16x32_bf16 v[168:171], a[168:171], a[84:87], v[168:171]
    v_mfma_f32_16x16x32_bf16 v[200:203], a[168:171], a[88:91], v[200:203]
    ds_read_b64_tr_b16 a[140:141], v51 offset:49152
    v_and_b32 v71, 0xffff0000, v67
    v_mfma_f32_16x16x32_bf16 v[232:235], a[168:171], a[92:95], v[232:235]
    ds_read_b64_tr_b16 a[142:143], v51 offset:53248
    s_mov_b32 s83, 65536
    s_add_u32 m0, s3, 73728
    v_lshlrev_b32 v70, 16, v67
    s_waitcnt lgkmcnt(15)
    v_mfma_f32_16x16x32_bf16 v[140:143], a[172:175], a[80:83], v[140:143]
    buffer_load_dwordx4 v17, s[52:55], s83 offen lds
    v_and_b32 v69, 0xffff0000, v66
    v_mfma_f32_16x16x32_bf16 v[172:175], a[172:175], a[84:87], v[172:175]
    ds_read_b64_tr_b16 a[144:145], v52 offset:49152
    v_lshlrev_b32 v68, 16, v66
    v_mfma_f32_16x16x32_bf16 v[204:207], a[172:175], a[88:91], v[204:207]
    ds_read_b64_tr_b16 a[146:147], v52 offset:53248
    v_and_b32 v67, 0xffff0000, v65
    v_mfma_f32_16x16x32_bf16 v[236:239], a[172:175], a[92:95], v[236:239]
    v_lshlrev_b32 v66, 16, v65
    s_waitcnt lgkmcnt(15)
    v_mfma_f32_16x16x32_bf16 v[144:147], a[176:179], a[80:83], v[144:147]
    ds_read_b64_tr_b16 a[148:149], v53 offset:49152
    buffer_load_dwordx4 v18, s[52:55], s83 offen offset:1024 lds
    v_and_b32 v65, 0xffff0000, v64
    v_mfma_f32_16x16x32_bf16 v[176:179], a[176:179], a[84:87], v[176:179]
    ds_read_b64_tr_b16 a[150:151], v53 offset:53248
    v_lshlrev_b32 v64, 16, v64
    v_mfma_f32_16x16x32_bf16 v[208:211], a[176:179], a[88:91], v[208:211]
    v_lshlrev_b32 v72, 16, v76
    v_mfma_f32_16x16x32_bf16 v[240:243], a[176:179], a[92:95], v[240:243]
    ds_read_b64_tr_b16 a[152:153], v54 offset:49152
    v_and_b32 v73, 0xffff0000, v76
    s_waitcnt lgkmcnt(15)
    v_mfma_f32_16x16x32_bf16 v[148:151], a[180:183], a[80:83], v[148:151]
    ds_read_b64_tr_b16 a[154:155], v54 offset:53248
    v_lshlrev_b32 v74, 16, v77
    v_mfma_f32_16x16x32_bf16 v[180:183], a[180:183], a[84:87], v[180:183]
    v_and_b32 v75, 0xffff0000, v77
    v_mfma_f32_16x16x32_bf16 v[212:215], a[180:183], a[88:91], v[212:215]
    ds_read_b64_tr_b16 a[156:157], v55 offset:49152
    v_lshlrev_b32 v76, 16, v78
    v_mfma_f32_16x16x32_bf16 v[244:247], a[180:183], a[92:95], v[244:247]
    ds_read_b64_tr_b16 a[158:159], v55 offset:53248
    v_and_b32 v77, 0xffff0000, v78
    v_mfma_f32_16x16x32_bf16 v[152:155], a[184:187], a[80:83], v[152:155]
    v_lshlrev_b32 v78, 16, v79
    v_mfma_f32_16x16x32_bf16 v[184:187], a[184:187], a[84:87], v[184:187]
    v_and_b32 v79, 0xffff0000, v79
    v_mfma_f32_16x16x32_bf16 v[216:219], a[184:187], a[88:91], v[216:219]
    v_mfma_f32_16x16x32_bf16 v[248:251], a[184:187], a[92:95], v[248:251]
    s_waitcnt lgkmcnt(15)
    v_mfma_f32_16x16x32_bf16 v[156:159], a[188:191], a[80:83], v[156:159]
    buffer_load_dword v44, off, s[56:59], s76 sc1
    v_mfma_f32_16x16x32_bf16 v[188:191], a[188:191], a[84:87], v[188:191]
    v_mfma_f32_16x16x32_bf16 v[220:223], a[188:191], a[88:91], v[220:223]
    v_mfma_f32_16x16x32_bf16 v[252:255], a[188:191], a[92:95], v[252:255]
    s_waitcnt vmcnt(43) lgkmcnt(14)
    v_mfma_f32_16x16x32_bf16 v[128:131], a[128:131], a[96:99], v[128:131]
    buffer_load_dwordx4 a[80:83], v21, s[56:59], s68 offen sc1
    s_waitcnt vmcnt(43)
    v_mfma_f32_16x16x32_bf16 v[160:163], a[128:131], a[100:103], v[160:163]
    ds_read_b64_tr_b16 a[160:161], v48 offset:57344
    s_waitcnt vmcnt(42)
    v_mfma_f32_16x16x32_bf16 v[192:195], a[128:131], a[104:107], v[192:195]
    ds_read_b64_tr_b16 a[162:163], v48 offset:61440
    buffer_load_dwordx4 a[84:87], v22, s[56:59], s68 offen sc1
    s_waitcnt vmcnt(42)
    v_mfma_f32_16x16x32_bf16 v[224:227], a[128:131], a[108:111], v[224:227]
    s_waitcnt lgkmcnt(14)
    v_mfma_f32_16x16x32_bf16 v[132:135], a[132:135], a[96:99], v[132:135]
    ds_read_b64_tr_b16 a[164:165], v49 offset:57344
    buffer_load_dwordx4 a[88:91], v23, s[56:59], s68 offen sc1
    v_mfma_f32_16x16x32_bf16 v[164:167], a[132:135], a[100:103], v[164:167]
    ds_read_b64_tr_b16 a[166:167], v49 offset:61440
    v_mfma_f32_16x16x32_bf16 v[196:199], a[132:135], a[104:107], v[196:199]
    buffer_load_dwordx4 a[92:95], v24, s[56:59], s68 offen sc1
    v_mfma_f32_16x16x32_bf16 v[228:231], a[132:135], a[108:111], v[228:231]
    ds_read_b64_tr_b16 a[168:169], v50 offset:57344
    s_waitcnt lgkmcnt(15)
    v_mfma_f32_16x16x32_bf16 v[136:139], a[136:139], a[96:99], v[136:139]
    ds_read_b64_tr_b16 a[170:171], v50 offset:61440
    s_add_u32 s68, s68, 16384
    v_mfma_f32_16x16x32_bf16 v[168:171], a[136:139], a[100:103], v[168:171]
    v_mfma_f32_16x16x32_bf16 v[200:203], a[136:139], a[104:107], v[200:203]
    ds_read_b64_tr_b16 a[172:173], v51 offset:57344
    v_cndmask_b32 v88, v80, v84, s[4:5]
    v_mfma_f32_16x16x32_bf16 v[232:235], a[136:139], a[108:111], v[232:235]
    ds_read_b64_tr_b16 a[174:175], v51 offset:61440
    s_mov_b32 s82, 131072
    s_add_u32 m0, s3, 81920
    v_cndmask_b32 v89, v81, v85, s[4:5]
    s_waitcnt lgkmcnt(15)
    v_mfma_f32_16x16x32_bf16 v[140:143], a[140:143], a[96:99], v[140:143]
    buffer_load_dwordx4 v17, s[52:55], s82 offen lds
    v_cndmask_b32 v90, v82, v86, s[4:5]
    v_mfma_f32_16x16x32_bf16 v[172:175], a[140:143], a[100:103], v[172:175]
    ds_read_b64_tr_b16 a[176:177], v52 offset:57344
    v_cndmask_b32 v91, v83, v87, s[4:5]
    v_mfma_f32_16x16x32_bf16 v[204:207], a[140:143], a[104:107], v[204:207]
    ds_read_b64_tr_b16 a[178:179], v52 offset:61440
    v_cndmask_b32 v80, v84, v80, s[4:5]
    v_mfma_f32_16x16x32_bf16 v[236:239], a[140:143], a[108:111], v[236:239]
    v_cndmask_b32 v81, v85, v81, s[4:5]
    s_waitcnt lgkmcnt(15)
    v_mfma_f32_16x16x32_bf16 v[144:147], a[144:147], a[96:99], v[144:147]
    ds_read_b64_tr_b16 a[180:181], v53 offset:57344
    buffer_load_dwordx4 v18, s[52:55], s82 offen offset:1024 lds
    v_cndmask_b32 v82, v86, v82, s[4:5]
    v_mfma_f32_16x16x32_bf16 v[176:179], a[144:147], a[100:103], v[176:179]
    ds_read_b64_tr_b16 a[182:183], v53 offset:61440
    v_cndmask_b32 v83, v87, v83, s[4:5]
    v_mfma_f32_16x16x32_bf16 v[208:211], a[144:147], a[104:107], v[208:211]
    v_mov_b32_dpp v92, v88 row_ror:8 row_mask:0xf bank_mask:0xf
    v_mfma_f32_16x16x32_bf16 v[240:243], a[144:147], a[108:111], v[240:243]
    ds_read_b64_tr_b16 a[184:185], v54 offset:57344
    v_mov_b32_dpp v93, v89 row_ror:8 row_mask:0xf bank_mask:0xf
    s_waitcnt lgkmcnt(15)
    v_mfma_f32_16x16x32_bf16 v[148:151], a[148:151], a[96:99], v[148:151]
    ds_read_b64_tr_b16 a[186:187], v54 offset:61440
    v_mov_b32_dpp v94, v90 row_ror:8 row_mask:0xf bank_mask:0xf
    v_mfma_f32_16x16x32_bf16 v[180:183], a[148:151], a[100:103], v[180:183]
    v_mov_b32_dpp v95, v91 row_ror:8 row_mask:0xf bank_mask:0xf
    v_mfma_f32_16x16x32_bf16 v[212:215], a[148:151], a[104:107], v[212:215]
    ds_read_b64_tr_b16 a[188:189], v55 offset:57344
    v_permlane16_swap_b32 v80, v82
    v_mfma_f32_16x16x32_bf16 v[244:247], a[148:151], a[108:111], v[244:247]
    ds_read_b64_tr_b16 a[190:191], v55 offset:61440
    v_permlane16_swap_b32 v81, v83
    v_mfma_f32_16x16x32_bf16 v[152:155], a[152:155], a[96:99], v[152:155]
    v_permlane16_swap_b32 v92, v94
    v_mfma_f32_16x16x32_bf16 v[184:187], a[152:155], a[100:103], v[184:187]
    v_permlane16_swap_b32 v93, v95
    v_mfma_f32_16x16x32_bf16 v[216:219], a[152:155], a[104:107], v[216:219]
    v_mfma_f32_16x16x32_bf16 v[248:251], a[152:155], a[108:111], v[248:251]
    s_waitcnt lgkmcnt(15)
    v_mfma_f32_16x16x32_bf16 v[156:159], a[156:159], a[96:99], v[156:159]
    v_mfma_f32_16x16x32_bf16 v[188:191], a[156:159], a[100:103], v[188:191]
    v_mfma_f32_16x16x32_bf16 v[220:223], a[156:159], a[104:107], v[220:223]
    v_mfma_f32_16x16x32_bf16 v[252:255], a[156:159], a[108:111], v[252:255]
    s_waitcnt vmcnt(43) lgkmcnt(14)
    v_mfma_f32_16x16x32_bf16 v[128:131], a[160:163], a[112:115], v[128:131]
    buffer_load_dwordx4 a[96:99], v21, s[56:59], s68 offen sc1
    s_waitcnt vmcnt(43)
    v_mfma_f32_16x16x32_bf16 v[160:163], a[160:163], a[116:119], v[160:163]
    ds_read_b64_tr_b16 a[128:129], v56 offset:0
    s_waitcnt vmcnt(42)
    v_mfma_f32_16x16x32_bf16 v[192:195], a[160:163], a[120:123], v[192:195]
    ds_read_b64_tr_b16 a[130:131], v56 offset:4096
    buffer_load_dwordx4 a[100:103], v22, s[56:59], s68 offen sc1
    s_waitcnt vmcnt(42)
    v_mfma_f32_16x16x32_bf16 v[224:227], a[160:163], a[124:127], v[224:227]
    s_waitcnt lgkmcnt(14)
    v_mfma_f32_16x16x32_bf16 v[132:135], a[164:167], a[112:115], v[132:135]
    ds_read_b64_tr_b16 a[132:133], v57 offset:0
    buffer_load_dwordx4 a[104:107], v23, s[56:59], s68 offen sc1
    v_mfma_f32_16x16x32_bf16 v[164:167], a[164:167], a[116:119], v[164:167]
    ds_read_b64_tr_b16 a[134:135], v57 offset:4096
    v_mfma_f32_16x16x32_bf16 v[196:199], a[164:167], a[120:123], v[196:199]
    buffer_load_dwordx4 a[108:111], v24, s[56:59], s68 offen sc1
    v_mfma_f32_16x16x32_bf16 v[228:231], a[164:167], a[124:127], v[228:231]
    ds_read_b64_tr_b16 a[136:137], v58 offset:0
    s_waitcnt lgkmcnt(15)
    v_mfma_f32_16x16x32_bf16 v[136:139], a[168:171], a[112:115], v[136:139]
    ds_read_b64_tr_b16 a[138:139], v58 offset:4096
    s_add_u32 s68, s68, 16384
    v_mfma_f32_16x16x32_bf16 v[168:171], a[168:171], a[116:119], v[168:171]
    v_mfma_f32_16x16x32_bf16 v[200:203], a[168:171], a[120:123], v[200:203]
    ds_read_b64_tr_b16 a[140:141], v59 offset:0
    v_and_b32 v87, 0xffff0000, v83
    v_mfma_f32_16x16x32_bf16 v[232:235], a[168:171], a[124:127], v[232:235]
    ds_read_b64_tr_b16 a[142:143], v59 offset:4096
    s_mov_b32 s83, 196608
    s_add_u32 m0, s3, 90112
    v_lshlrev_b32 v86, 16, v83
    s_waitcnt lgkmcnt(15)
    v_mfma_f32_16x16x32_bf16 v[140:143], a[172:175], a[112:115], v[140:143]
    buffer_load_dwordx4 v17, s[52:55], s83 offen lds
    v_and_b32 v85, 0xffff0000, v82
    v_mfma_f32_16x16x32_bf16 v[172:175], a[172:175], a[116:119], v[172:175]
    ds_read_b64_tr_b16 a[144:145], v60 offset:0
    v_lshlrev_b32 v84, 16, v82
    v_mfma_f32_16x16x32_bf16 v[204:207], a[172:175], a[120:123], v[204:207]
    ds_read_b64_tr_b16 a[146:147], v60 offset:4096
    v_and_b32 v83, 0xffff0000, v81
    v_mfma_f32_16x16x32_bf16 v[236:239], a[172:175], a[124:127], v[236:239]
    v_lshlrev_b32 v82, 16, v81
    s_waitcnt lgkmcnt(15)
    v_mfma_f32_16x16x32_bf16 v[144:147], a[176:179], a[112:115], v[144:147]
    ds_read_b64_tr_b16 a[148:149], v61 offset:0
    buffer_load_dwordx4 v18, s[52:55], s83 offen offset:1024 lds
    v_and_b32 v81, 0xffff0000, v80
    v_mfma_f32_16x16x32_bf16 v[176:179], a[176:179], a[116:119], v[176:179]
    ds_read_b64_tr_b16 a[150:151], v61 offset:4096
    v_lshlrev_b32 v80, 16, v80
    v_mfma_f32_16x16x32_bf16 v[208:211], a[176:179], a[120:123], v[208:211]
    v_lshlrev_b32 v88, 16, v92
    v_mfma_f32_16x16x32_bf16 v[240:243], a[176:179], a[124:127], v[240:243]
    ds_read_b64_tr_b16 a[152:153], v62 offset:0
    v_and_b32 v89, 0xffff0000, v92
    s_waitcnt lgkmcnt(15)
    v_mfma_f32_16x16x32_bf16 v[148:151], a[180:183], a[112:115], v[148:151]
    ds_read_b64_tr_b16 a[154:155], v62 offset:4096
    v_lshlrev_b32 v90, 16, v93
    v_mfma_f32_16x16x32_bf16 v[180:183], a[180:183], a[116:119], v[180:183]
    v_and_b32 v91, 0xffff0000, v93
    v_mfma_f32_16x16x32_bf16 v[212:215], a[180:183], a[120:123], v[212:215]
    ds_read_b64_tr_b16 a[156:157], v63 offset:0
    v_lshlrev_b32 v92, 16, v94
    v_mfma_f32_16x16x32_bf16 v[244:247], a[180:183], a[124:127], v[244:247]
    ds_read_b64_tr_b16 a[158:159], v63 offset:4096
    v_and_b32 v93, 0xffff0000, v94
    v_mfma_f32_16x16x32_bf16 v[152:155], a[184:187], a[112:115], v[152:155]
    v_lshlrev_b32 v94, 16, v95
    v_mfma_f32_16x16x32_bf16 v[184:187], a[184:187], a[116:119], v[184:187]
    v_and_b32 v95, 0xffff0000, v95
    v_mfma_f32_16x16x32_bf16 v[216:219], a[184:187], a[120:123], v[216:219]
    v_mfma_f32_16x16x32_bf16 v[248:251], a[184:187], a[124:127], v[248:251]
    s_waitcnt lgkmcnt(15)
    v_mfma_f32_16x16x32_bf16 v[156:159], a[188:191], a[112:115], v[156:159]
    v_mfma_f32_16x16x32_bf16 v[188:191], a[188:191], a[116:119], v[188:191]
    v_mfma_f32_16x16x32_bf16 v[220:223], a[188:191], a[120:123], v[220:223]
    v_mfma_f32_16x16x32_bf16 v[252:255], a[188:191], a[124:127], v[252:255]
    s_barrier
    s_waitcnt vmcnt(43) lgkmcnt(14)
    v_mfma_f32_16x16x32_bf16 v[128:131], a[128:131], a[0:3], v[128:131]
    buffer_load_dwordx4 a[112:115], v21, s[56:59], s68 offen sc1
    s_waitcnt vmcnt(43)
    v_mfma_f32_16x16x32_bf16 v[160:163], a[128:131], a[4:7], v[160:163]
    ds_read_b64_tr_b16 a[160:161], v56 offset:8192
    s_waitcnt vmcnt(42)
    v_mfma_f32_16x16x32_bf16 v[192:195], a[128:131], a[8:11], v[192:195]
    ds_read_b64_tr_b16 a[162:163], v56 offset:12288
    buffer_load_dwordx4 a[116:119], v22, s[56:59], s68 offen sc1
    s_waitcnt vmcnt(42)
    v_mfma_f32_16x16x32_bf16 v[224:227], a[128:131], a[12:15], v[224:227]
    s_waitcnt lgkmcnt(14)
    v_mfma_f32_16x16x32_bf16 v[132:135], a[132:135], a[0:3], v[132:135]
    ds_read_b64_tr_b16 a[164:165], v57 offset:8192
    buffer_load_dwordx4 a[120:123], v23, s[56:59], s68 offen sc1
    v_mfma_f32_16x16x32_bf16 v[164:167], a[132:135], a[4:7], v[164:167]
    ds_read_b64_tr_b16 a[166:167], v57 offset:12288
    v_mfma_f32_16x16x32_bf16 v[196:199], a[132:135], a[8:11], v[196:199]
    buffer_load_dwordx4 a[124:127], v24, s[56:59], s68 offen sc1
    v_mfma_f32_16x16x32_bf16 v[228:231], a[132:135], a[12:15], v[228:231]
    ds_read_b64_tr_b16 a[168:169], v58 offset:8192
    s_waitcnt lgkmcnt(15)
    v_mfma_f32_16x16x32_bf16 v[136:139], a[136:139], a[0:3], v[136:139]
    ds_read_b64_tr_b16 a[170:171], v58 offset:12288
    s_add_u32 s68, s68, 16384
    v_mfma_f32_16x16x32_bf16 v[168:171], a[136:139], a[4:7], v[168:171]
    v_mfma_f32_16x16x32_bf16 v[200:203], a[136:139], a[8:11], v[200:203]
    ds_read_b64_tr_b16 a[172:173], v59 offset:8192
    v_mfma_f32_16x16x32_bf16 v[232:235], a[136:139], a[12:15], v[232:235]
    ds_read_b64_tr_b16 a[174:175], v59 offset:12288
    s_mov_b32 s82, 262144
    s_add_u32 m0, s3, 98304
    s_waitcnt lgkmcnt(15)
    v_mfma_f32_16x16x32_bf16 v[140:143], a[140:143], a[0:3], v[140:143]
    buffer_load_dwordx4 v17, s[52:55], s82 offen lds
    v_mfma_f32_16x16x32_bf16 v[172:175], a[140:143], a[4:7], v[172:175]
    ds_read_b64_tr_b16 a[176:177], v60 offset:8192
    v_mfma_f32_16x16x32_bf16 v[204:207], a[140:143], a[8:11], v[204:207]
    ds_read_b64_tr_b16 a[178:179], v60 offset:12288
    v_mfma_f32_16x16x32_bf16 v[236:239], a[140:143], a[12:15], v[236:239]
    s_waitcnt lgkmcnt(15)
    v_mfma_f32_16x16x32_bf16 v[144:147], a[144:147], a[0:3], v[144:147]
    ds_read_b64_tr_b16 a[180:181], v61 offset:8192
    buffer_load_dwordx4 v18, s[52:55], s82 offen offset:1024 lds
    v_mfma_f32_16x16x32_bf16 v[176:179], a[144:147], a[4:7], v[176:179]
    ds_read_b64_tr_b16 a[182:183], v61 offset:12288
    v_mfma_f32_16x16x32_bf16 v[208:211], a[144:147], a[8:11], v[208:211]
    v_mfma_f32_16x16x32_bf16 v[240:243], a[144:147], a[12:15], v[240:243]
    ds_read_b64_tr_b16 a[184:185], v62 offset:8192
    s_waitcnt lgkmcnt(15)
    v_mfma_f32_16x16x32_bf16 v[148:151], a[148:151], a[0:3], v[148:151]
    ds_read_b64_tr_b16 a[186:187], v62 offset:12288
    v_mfma_f32_16x16x32_bf16 v[180:183], a[148:151], a[4:7], v[180:183]
    v_mfma_f32_16x16x32_bf16 v[212:215], a[148:151], a[8:11], v[212:215]
    ds_read_b64_tr_b16 a[188:189], v63 offset:8192
    v_mfma_f32_16x16x32_bf16 v[244:247], a[148:151], a[12:15], v[244:247]
    ds_read_b64_tr_b16 a[190:191], v63 offset:12288
    v_mfma_f32_16x16x32_bf16 v[152:155], a[152:155], a[0:3], v[152:155]
    v_mfma_f32_16x16x32_bf16 v[184:187], a[152:155], a[4:7], v[184:187]
    v_mfma_f32_16x16x32_bf16 v[216:219], a[152:155], a[8:11], v[216:219]
    v_mfma_f32_16x16x32_bf16 v[248:251], a[152:155], a[12:15], v[248:251]
    s_waitcnt lgkmcnt(15)
    v_mfma_f32_16x16x32_bf16 v[156:159], a[156:159], a[0:3], v[156:159]
    v_mfma_f32_16x16x32_bf16 v[188:191], a[156:159], a[4:7], v[188:191]
    v_mfma_f32_16x16x32_bf16 v[220:223], a[156:159], a[8:11], v[220:223]
    v_mfma_f32_16x16x32_bf16 v[252:255], a[156:159], a[12:15], v[252:255]
    s_waitcnt vmcnt(43) lgkmcnt(14)
    v_mfma_f32_16x16x32_bf16 v[128:131], a[160:163], a[16:19], v[128:131]
    s_waitcnt vmcnt(37)
    v_readfirstlane_b32 s86, v43
    s_bfe_u32 s86, s86, 0x80010
    s_cmp_eq_u32 s86, 16
    s_cbranch_scc0 L_spC
L_okC:
    buffer_load_dwordx4 a[0:3], v21, s[56:59], s68 offen sc1
    v_mfma_f32_16x16x32_bf16 v[160:163], a[160:163], a[20:23], v[160:163]
    ds_read_b64_tr_b16 a[128:129], v56 offset:16384
    v_mfma_f32_16x16x32_bf16 v[192:195], a[160:163], a[24:27], v[192:195]
    ds_read_b64_tr_b16 a[130:131], v56 offset:20480
    buffer_load_dwordx4 a[4:7], v22, s[56:59], s68 offen sc1
    v_mfma_f32_16x16x32_bf16 v[224:227], a[160:163], a[28:31], v[224:227]
    s_waitcnt lgkmcnt(14)
    v_mfma_f32_16x16x32_bf16 v[132:135], a[164:167], a[16:19], v[132:135]
    ds_read_b64_tr_b16 a[132:133], v57 offset:16384
    buffer_load_dwordx4 a[8:11], v23, s[56:59], s68 offen sc1
    v_mfma_f32_16x16x32_bf16 v[164:167], a[164:167], a[20:23], v[164:167]
    ds_read_b64_tr_b16 a[134:135], v57 offset:20480
    v_mfma_f32_16x16x32_bf16 v[196:199], a[164:167], a[24:27], v[196:199]
    buffer_load_dwordx4 a[12:15], v24, s[56:59], s68 offen sc1
    v_mfma_f32_16x16x32_bf16 v[228:231], a[164:167], a[28:31], v[228:231]
    ds_read_b64_tr_b16 a[136:137], v58 offset:16384
    s_waitcnt lgkmcnt(15)
    v_mfma_f32_16x16x32_bf16 v[136:139], a[168:171], a[16:19], v[136:139]
    ds_read_b64_tr_b16 a[138:139], v58 offset:20480
    s_add_u32 s68, s68, 16384
    v_mfma_f32_16x16x32_bf16 v[168:171], a[168:171], a[20:23], v[168:171]
    v_mfma_f32_16x16x32_bf16 v[200:203], a[168:171], a[24:27], v[200:203]
    ds_read_b64_tr_b16 a[140:141], v59 offset:16384
    v_mfma_f32_16x16x32_bf16 v[232:235], a[168:171], a[28:31], v[232:235]
    ds_read_b64_tr_b16 a[142:143], v59 offset:20480
    s_mov_b32 s83, 327680
    s_add_u32 m0, s3, 106496
    s_waitcnt lgkmcnt(15)
    v_mfma_f32_16x16x32_bf16 v[140:143], a[172:175], a[16:19], v[140:143]
    buffer_load_dwordx4 v17, s[52:55], s83 offen lds
    v_mfma_f32_16x16x32_bf16 v[172:175], a[172:175], a[20:23], v[172:175]
    ds_read_b64_tr_b16 a[144:145], v60 offset:16384
    v_mfma_f32_16x16x32_bf16 v[204:207], a[172:175], a[24:27], v[204:207]
    ds_read_b64_tr_b16 a[146:147], v60 offset:20480
    v_mfma_f32_16x16x32_bf16 v[236:239], a[172:175], a[28:31], v[236:239]
    s_waitcnt lgkmcnt(15)
    v_mfma_f32_16x16x32_bf16 v[144:147], a[176:179], a[16:19], v[144:147]
    ds_read_b64_tr_b16 a[148:149], v61 offset:16384
    buffer_load_dwordx4 v18, s[52:55], s83 offen offset:1024 lds
    v_mfma_f32_16x16x32_bf16 v[176:179], a[176:179], a[20:23], v[176:179]
    ds_read_b64_tr_b16 a[150:151], v61 offset:20480
    v_mfma_f32_16x16x32_bf16 v[208:211], a[176:179], a[24:27], v[208:211]
    v_mfma_f32_16x16x32_bf16 v[240:243], a[176:179], a[28:31], v[240:243]
    ds_read_b64_tr_b16 a[152:153], v62 offset:16384
    s_waitcnt lgkmcnt(15)
    v_mfma_f32_16x16x32_bf16 v[148:151], a[180:183], a[16:19], v[148:151]
    ds_read_b64_tr_b16 a[154:155], v62 offset:20480
    v_mfma_f32_16x16x32_bf16 v[180:183], a[180:183], a[20:23], v[180:183]
    v_mfma_f32_16x16x32_bf16 v[212:215], a[180:183], a[24:27], v[212:215]
    ds_read_b64_tr_b16 a[156:157], v63 offset:16384
    v_mfma_f32_16x16x32_bf16 v[244:247], a[180:183], a[28:31], v[244:247]
    ds_read_b64_tr_b16 a[158:159], v63 offset:20480
    v_mfma_f32_16x16x32_bf16 v[152:155], a[184:187], a[16:19], v[152:155]
    v_mfma_f32_16x16x32_bf16 v[184:187], a[184:187], a[20:23], v[184:187]
    v_mfma_f32_16x16x32_bf16 v[216:219], a[184:187], a[24:27], v[216:219]
    v_mfma_f32_16x16x32_bf16 v[248:251], a[184:187], a[28:31], v[248:251]
    s_waitcnt lgkmcnt(15)
    v_mfma_f32_16x16x32_bf16 v[156:159], a[188:191], a[16:19], v[156:159]
    v_mfma_f32_16x16x32_bf16 v[188:191], a[188:191], a[20:23], v[188:191]
    v_mfma_f32_16x16x32_bf16 v[220:223], a[188:191], a[24:27], v[220:223]
    v_mfma_f32_16x16x32_bf16 v[252:255], a[188:191], a[28:31], v[252:255]
    s_waitcnt vmcnt(42) lgkmcnt(14)
    v_mfma_f32_16x16x32_bf16 v[128:131], a[128:131], a[32:35], v[128:131]
    buffer_load_dwordx4 a[16:19], v21, s[56:59], s68 offen sc1
    s_waitcnt vmcnt(42)
    v_mfma_f32_16x16x32_bf16 v[160:163], a[128:131], a[36:39], v[160:163]
    ds_read_b64_tr_b16 a[160:161], v56 offset:24576
    s_waitcnt vmcnt(41)
    v_mfma_f32_16x16x32_bf16 v[192:195], a[128:131], a[40:43], v[192:195]
    ds_read_b64_tr_b16 a[162:163], v56 offset:28672
    buffer_load_dwordx4 a[20:23], v22, s[56:59], s68 offen sc1
    s_waitcnt vmcnt(41)
    v_mfma_f32_16x16x32_bf16 v[224:227], a[128:131], a[44:47], v[224:227]
    s_waitcnt lgkmcnt(14)
    v_mfma_f32_16x16x32_bf16 v[132:135], a[132:135], a[32:35], v[132:135]
    ds_read_b64_tr_b16 a[164:165], v57 offset:24576
    buffer_load_dwordx4 a[24:27], v23, s[56:59], s68 offen sc1
    s_branch L_over10
L_stub10:
    s_branch L_stub11
L_over10:
    v_mfma_f32_16x16x32_bf16 v[164:167], a[132:135], a[36:39], v[164:167]
    ds_read_b64_tr_b16 a[166:167], v57 offset:28672
    v_mfma_f32_16x16x32_bf16 v[196:199], a[132:135], a[40:43], v[196:199]
    buffer_load_dwordx4 a[28:31], v24, s[56:59], s68 offen sc1
    v_mfma_f32_16x16x32_bf16 v[228:231], a[132:135], a[44:47], v[228:231]
    ds_read_b64_tr_b16 a[168:169], v58 offset:24576
    s_waitcnt lgkmcnt(15)
    v_mfma_f32_16x16x32_bf16 v[136:139], a[136:139], a[32:35], v[136:139]
    ds_read_b64_tr_b16 a[170:171], v58 offset:28672
    s_add_u32 s68, s68, 16384
    v_mfma_f32_16x16x32_bf16 v[168:171], a[136:139], a[36:39], v[168:171]
    v_mfma_f32_16x16x32_bf16 v[200:203], a[136:139], a[40:43], v[200:203]
    ds_read_b64_tr_b16 a[172:173], v59 offset:24576
    v_mfma_f32_16x16x32_bf16 v[232:235], a[136:139], a[44:47], v[232:235]
    ds_read_b64_tr_b16 a[174:175], v59 offset:28672
    s_mov_b32 s82, 393216
    s_add_u32 m0, s3, 114688
    s_waitcnt lgkmcnt(15)
    v_mfma_f32_16x16x32_bf16 v[140:143], a[140:143], a[32:35], v[140:143]
    buffer_load_dwordx4 v17, s[52:55], s82 offen lds
    v_mfma_f32_16x16x32_bf16 v[172:175], a[140:143], a[36:39], v[172:175]
    ds_read_b64_tr_b16 a[176:177], v60 offset:24576
    v_mfma_f32_16x16x32_bf16 v[204:207], a[140:143], a[40:43], v[204:207]
    ds_read_b64_tr_b16 a[178:179], v60 offset:28672
    v_mfma_f32_16x16x32_bf16 v[236:239], a[140:143], a[44:47], v[236:239]
    s_waitcnt lgkmcnt(15)
    v_mfma_f32_16x16x32_bf16 v[144:147], a[144:147], a[32:35], v[144:147]
    ds_read_b64_tr_b16 a[180:181], v61 offset:24576
    buffer_load_dwordx4 v18, s[52:55], s82 offen offset:1024 lds
    v_mfma_f32_16x16x32_bf16 v[176:179], a[144:147], a[36:39], v[176:179]
    ds_read_b64_tr_b16 a[182:183], v61 offset:28672
    v_mfma_f32_16x16x32_bf16 v[208:211], a[144:147], a[40:43], v[208:211]
    v_mfma_f32_16x16x32_bf16 v[240:243], a[144:147], a[44:47], v[240:243]
    ds_read_b64_tr_b16 a[184:185], v62 offset:24576
    s_waitcnt lgkmcnt(15)
    v_mfma_f32_16x16x32_bf16 v[148:151], a[148:151], a[32:35], v[148:151]
    ds_read_b64_tr_b16 a[186:187], v62 offset:28672
    v_mfma_f32_16x16x32_bf16 v[180:183], a[148:151], a[36:39], v[180:183]
    v_mfma_f32_16x16x32_bf16 v[212:215], a[148:151], a[40:43], v[212:215]
    ds_read_b64_tr_b16 a[188:189], v63 offset:24576
    v_mfma_f32_16x16x32_bf16 v[244:247], a[148:151], a[44:47], v[244:247]
    ds_read_b64_tr_b16 a[190:191], v63 offset:28672
    v_mfma_f32_16x16x32_bf16 v[152:155], a[152:155], a[32:35], v[152:155]
    v_mfma_f32_16x16x32_bf16 v[184:187], a[152:155], a[36:39], v[184:187]
    v_mfma_f32_16x16x32_bf16 v[216:219], a[152:155], a[40:43], v[216:219]
    v_mfma_f32_16x16x32_bf16 v[248:251], a[152:155], a[44:47], v[248:251]
    s_waitcnt lgkmcnt(15)
    v_mfma_f32_16x16x32_bf16 v[156:159], a[156:159], a[32:35], v[156:159]
    v_mfma_f32_16x16x32_bf16 v[188:191], a[156:159], a[36:39], v[188:191]
    v_mfma_f32_16x16x32_bf16 v[220:223], a[156:159], a[40:43], v[220:223]
    v_mfma_f32_16x16x32_bf16 v[252:255], a[156:159], a[44:47], v[252:255]
    s_waitcnt vmcnt(42) lgkmcnt(14)
    v_mfma_f32_16x16x32_bf16 v[128:131], a[160:163], a[48:51], v[128:131]
    buffer_load_dwordx4 a[32:35], v21, s[56:59], s68 offen sc1
    s_waitcnt vmcnt(42)
    v_mfma_f32_16x16x32_bf16 v[160:163], a[160:163], a[52:55], v[160:163]
    ds_read_b64_tr_b16 a[128:129], v8 offset:0
    s_waitcnt vmcnt(41)
    v_mfma_f32_16x16x32_bf16 v[192:195], a[160:163], a[56:59], v[192:195]
    ds_read_b64_tr_b16 a[130:131], v8 offset:4096
    buffer_load_dwordx4 a[36:39], v22, s[56:59], s68 offen sc1
    s_waitcnt vmcnt(41)
    v_mfma_f32_16x16x32_bf16 v[224:227], a[160:163], a[60:63], v[224:227]
    s_waitcnt lgkmcnt(14)
    v_mfma_f32_16x16x32_bf16 v[132:135], a[164:167], a[48:51], v[132:135]
    ds_read_b64_tr_b16 a[132:133], v9 offset:0
    buffer_load_dwordx4 a[40:43], v23, s[56:59], s68 offen sc1
    v_mfma_f32_16x16x32_bf16 v[164:167], a[164:167], a[52:55], v[164:167]
    ds_read_b64_tr_b16 a[134:135], v9 offset:4096
    v_mfma_f32_16x16x32_bf16 v[196:199], a[164:167], a[56:59], v[196:199]
    buffer_load_dwordx4 a[44:47], v24, s[56:59], s68 offen sc1
    v_mfma_f32_16x16x32_bf16 v[228:231], a[164:167], a[60:63], v[228:231]
    ds_read_b64_tr_b16 a[136:137], v10 offset:0
    s_waitcnt lgkmcnt(15)
    v_mfma_f32_16x16x32_bf16 v[136:139], a[168:171], a[48:51], v[136:139]
    ds_read_b64_tr_b16 a[138:139], v10 offset:4096
    s_add_u32 s68, s68, 16384
    v_mfma_f32_16x16x32_bf16 v[168:171], a[168:171], a[52:55], v[168:171]
    v_mfma_f32_16x16x32_bf16 v[200:203], a[168:171], a[56:59], v[200:203]
    ds_read_b64_tr_b16 a[140:141], v11 offset:0
    v_mfma_f32_16x16x32_bf16 v[232:235], a[168:171], a[60:63], v[232:235]
    ds_read_b64_tr_b16 a[142:143], v11 offset:4096
    s_mov_b32 s83, 458752
    s_add_u32 m0, s3, 122880
    s_waitcnt lgkmcnt(15)
    v_mfma_f32_16x16x32_bf16 v[140:143], a[172:175], a[48:51], v[140:143]
    buffer_load_dwordx4 v17, s[52:55], s83 offen lds
    v_mfma_f32_16x16x32_bf16 v[172:175], a[172:175], a[52:55], v[172:175]
    ds_read_b64_tr_b16 a[144:145], v12 offset:0
    v_mfma_f32_16x16x32_bf16 v[204:207], a[172:175], a[56:59], v[204:207]
    ds_read_b64_tr_b16 a[146:147], v12 offset:4096
    v_mfma_f32_16x16x32_bf16 v[236:239], a[172:175], a[60:63], v[236:239]
    s_waitcnt lgkmcnt(15)
    v_mfma_f32_16x16x32_bf16 v[144:147], a[176:179], a[48:51], v[144:147]
    ds_read_b64_tr_b16 a[148:149], v13 offset:0
    buffer_load_dwordx4 v18, s[52:55], s83 offen offset:1024 lds
    v_mfma_f32_16x16x32_bf16 v[176:179], a[176:179], a[52:55], v[176:179]
    ds_read_b64_tr_b16 a[150:151], v13 offset:4096
    v_mfma_f32_16x16x32_bf16 v[208:211], a[176:179], a[56:59], v[208:211]
    v_mfma_f32_16x16x32_bf16 v[240:243], a[176:179], a[60:63], v[240:243]
    ds_read_b64_tr_b16 a[152:153], v14 offset:0
    s_waitcnt lgkmcnt(15)
    v_mfma_f32_16x16x32_bf16 v[148:151], a[180:183], a[48:51], v[148:151]
    ds_read_b64_tr_b16 a[154:155], v14 offset:4096
    v_mfma_f32_16x16x32_bf16 v[180:183], a[180:183], a[52:55], v[180:183]
    v_mfma_f32_16x16x32_bf16 v[212:215], a[180:183], a[56:59], v[212:215]
    ds_read_b64_tr_b16 a[156:157], v15 offset:0
    v_mfma_f32_16x16x32_bf16 v[244:247], a[180:183], a[60:63], v[244:247]
    ds_read_b64_tr_b16 a[158:159], v15 offset:4096
    v_mfma_f32_16x16x32_bf16 v[152:155], a[184:187], a[48:51], v[152:155]
    v_mfma_f32_16x16x32_bf16 v[184:187], a[184:187], a[52:55], v[184:187]
    v_mfma_f32_16x16x32_bf16 v[216:219], a[184:187], a[56:59], v[216:219]
    v_mfma_f32_16x16x32_bf16 v[248:251], a[184:187], a[60:63], v[248:251]
    s_waitcnt lgkmcnt(15)
    v_mfma_f32_16x16x32_bf16 v[156:159], a[188:191], a[48:51], v[156:159]
    v_mfma_f32_16x16x32_bf16 v[188:191], a[188:191], a[52:55], v[188:191]
    v_mfma_f32_16x16x32_bf16 v[220:223], a[188:191], a[56:59], v[220:223]
    v_mfma_f32_16x16x32_bf16 v[252:255], a[188:191], a[60:63], v[252:255]
    s_barrier
    s_waitcnt vmcnt(42) lgkmcnt(14)
    v_mfma_f32_16x16x32_bf16 v[128:131], a[128:131], a[64:67], v[128:131]
    buffer_load_dwordx4 a[48:51], v21, s[56:59], s68 offen sc1
    s_waitcnt vmcnt(42)
    v_mfma_f32_16x16x32_bf16 v[160:163], a[128:131], a[68:71], v[160:163]
    ds_read_b64_tr_b16 a[160:161], v8 offset:8192
    s_waitcnt vmcnt(41)
    v_mfma_f32_16x16x32_bf16 v[192:195], a[128:131], a[72:75], v[192:195]
    ds_read_b64_tr_b16 a[162:163], v8 offset:12288
    buffer_load_dwordx4 a[52:55], v22, s[56:59], s68 offen sc1
    s_waitcnt vmcnt(41)
    v_mfma_f32_16x16x32_bf16 v[224:227], a[128:131], a[76:79], v[224:227]
    s_waitcnt lgkmcnt(14)
    v_mfma_f32_16x16x32_bf16 v[132:135], a[132:135], a[64:67], v[132:135]
    ds_read_b64_tr_b16 a[164:165], v9 offset:8192
    buffer_load_dwordx4 a[56:59], v23, s[56:59], s68 offen sc1
    v_mfma_f32_16x16x32_bf16 v[164:167], a[132:135], a[68:71], v[164:167]
    ds_read_b64_tr_b16 a[166:167], v9 offset:12288
    v_mfma_f32_16x16x32_bf16 v[196:199], a[132:135], a[72:75], v[196:199]
    buffer_load_dwordx4 a[60:63], v24, s[56:59], s68 offen sc1
    v_mfma_f32_16x16x32_bf16 v[228:231], a[132:135], a[76:79], v[228:231]
    ds_read_b64_tr_b16 a[168:169], v10 offset:8192
    s_waitcnt lgkmcnt(15)
    v_mfma_f32_16x16x32_bf16 v[136:139], a[136:139], a[64:67], v[136:139]
    ds_read_b64_tr_b16 a[170:171], v10 offset:12288
    s_add_u32 s68, s68, 16384
    v_mfma_f32_16x16x32_bf16 v[168:171], a[136:139], a[68:71], v[168:171]
    v_mfma_f32_16x16x32_bf16 v[200:203], a[136:139], a[72:75], v[200:203]
    ds_read_b64_tr_b16 a[172:173], v11 offset:8192
    v_mfma_f32_16x16x32_bf16 v[232:235], a[136:139], a[76:79], v[232:235]
    ds_read_b64_tr_b16 a[174:175], v11 offset:12288
    s_mov_b32 s82, 524288
    s_add_u32 m0, s3, 131072
    s_waitcnt lgkmcnt(15)
    v_mfma_f32_16x16x32_bf16 v[140:143], a[140:143], a[64:67], v[140:143]
    buffer_load_dwordx4 v17, s[52:55], s82 offen lds
    v_mfma_f32_16x16x32_bf16 v[172:175], a[140:143], a[68:71], v[172:175]
    ds_read_b64_tr_b16 a[176:177], v12 offset:8192
    v_mfma_f32_16x16x32_bf16 v[204:207], a[140:143], a[72:75], v[204:207]
    ds_read_b64_tr_b16 a[178:179], v12 offset:12288
    v_mfma_f32_16x16x32_bf16 v[236:239], a[140:143], a[76:79], v[236:239]
    s_waitcnt lgkmcnt(15)
    v_mfma_f32_16x16x32_bf16 v[144:147], a[144:147], a[64:67], v[144:147]
    ds_read_b64_tr_b16 a[180:181], v13 offset:8192
    buffer_load_dwordx4 v18, s[52:55], s82 offen offset:1024 lds
    v_mfma_f32_16x16x32_bf16 v[176:179], a[144:147], a[68:71], v[176:179]
    ds_read_b64_tr_b16 a[182:183], v13 offset:12288
    v_mfma_f32_16x16x32_bf16 v[208:211], a[144:147], a[72:75], v[208:211]
    v_mfma_f32_16x16x32_bf16 v[240:243], a[144:147], a[76:79], v[240:243]
    ds_read_b64_tr_b16 a[184:185], v14 offset:8192
    s_waitcnt lgkmcnt(15)
    v_mfma_f32_16x16x32_bf16 v[148:151], a[148:151], a[64:67], v[148:151]
    ds_read_b64_tr_b16 a[186:187], v14 offset:12288
    v_mfma_f32_16x16x32_bf16 v[180:183], a[148:151], a[68:71], v[180:183]
    v_mfma_f32_16x16x32_bf16 v[212:215], a[148:151], a[72:75], v[212:215]
    ds_read_b64_tr_b16 a[188:189], v15 offset:8192
    v_mfma_f32_16x16x32_bf16 v[244:247], a[148:151], a[76:79], v[244:247]
    ds_read_b64_tr_b16 a[190:191], v15 offset:12288
    v_mfma_f32_16x16x32_bf16 v[152:155], a[152:155], a[64:67], v[152:155]
    v_mfma_f32_16x16x32_bf16 v[184:187], a[152:155], a[68:71], v[184:187]
    v_mfma_f32_16x16x32_bf16 v[216:219], a[152:155], a[72:75], v[216:219]
    v_mfma_f32_16x16x32_bf16 v[248:251], a[152:155], a[76:79], v[248:251]
    s_waitcnt lgkmcnt(15)
    v_mfma_f32_16x16x32_bf16 v[156:159], a[156:159], a[64:67], v[156:159]
    v_mfma_f32_16x16x32_bf16 v[188:191], a[156:159], a[68:71], v[188:191]
    v_mfma_f32_16x16x32_bf16 v[220:223], a[156:159], a[72:75], v[220:223]
    v_mfma_f32_16x16x32_bf16 v[252:255], a[156:159], a[76:79], v[252:255]
    s_waitcnt vmcnt(41) lgkmcnt(14)
    v_mfma_f32_16x16x32_bf16 v[128:131], a[160:163], a[80:83], v[128:131]
    v_readfirstlane_b32 s86, v44
    s_cmp_eq_u32 s86, 64
    s_cbranch_scc0 L_spO
L_okO:
    buffer_load_dwordx4 a[64:67], v16, s[56:59], s69 offen offset:0 sc1
    s_waitcnt vmcnt(41)
    v_mfma_f32_16x16x32_bf16 v[160:163], a[160:163], a[84:87], v[160:163]
    ds_read_b64_tr_b16 a[128:129], v8 offset:16384
    s_waitcnt vmcnt(40)
    v_mfma_f32_16x16x32_bf16 v[192:195], a[160:163], a[88:91], v[192:195]
    ds_read_b64_tr_b16 a[130:131], v8 offset:20480
    buffer_load_dwordx4 a[68:71], v16, s[56:59], s69 offen offset:1024 sc1
    s_waitcnt vmcnt(40)
    v_mfma_f32_16x16x32_bf16 v[224:227], a[160:163], a[92:95], v[224:227]
    s_waitcnt lgkmcnt(14)
    v_mfma_f32_16x16x32_bf16 v[132:135], a[164:167], a[80:83], v[132:135]
    ds_read_b64_tr_b16 a[132:133], v9 offset:16384
    buffer_load_dwordx4 a[72:75], v16, s[56:59], s69 offen offset:2048 sc1
    v_mfma_f32_16x16x32_bf16 v[164:167], a[164:167], a[84:87], v[164:167]
    ds_read_b64_tr_b16 a[134:135], v9 offset:20480
    v_mfma_f32_16x16x32_bf16 v[196:199], a[164:167], a[88:91], v[196:199]
    buffer_load_dwordx4 a[76:79], v16, s[56:59], s69 offen offset:3072 sc1
    v_mfma_f32_16x16x32_bf16 v[228:231], a[164:167], a[92:95], v[228:231]
    ds_read_b64_tr_b16 a[136:137], v10 offset:16384
    s_waitcnt lgkmcnt(15)
    v_mfma_f32_16x16x32_bf16 v[136:139], a[168:171], a[80:83], v[136:139]
    ds_read_b64_tr_b16 a[138:139], v10 offset:20480
    s_add_u32 s69, s69, 4096
    v_mfma_f32_16x16x32_bf16 v[168:171], a[168:171], a[84:87], v[168:171]
    v_mfma_f32_16x16x32_bf16 v[200:203], a[168:171], a[88:91], v[200:203]
    ds_read_b64_tr_b16 a[140:141], v11 offset:16384
    v_mfma_f32_16x16x32_bf16 v[232:235], a[168:171], a[92:95], v[232:235]
    ds_read_b64_tr_b16 a[142:143], v11 offset:20480
    s_mov_b32 s83, 589824
    s_add_u32 m0, s3, 139264
    s_waitcnt lgkmcnt(15)
    v_mfma_f32_16x16x32_bf16 v[140:143], a[172:175], a[80:83], v[140:143]
    buffer_load_dwordx4 v17, s[52:55], s83 offen lds
    v_mfma_f32_16x16x32_bf16 v[172:175], a[172:175], a[84:87], v[172:175]
    ds_read_b64_tr_b16 a[144:145], v12 offset:16384
    v_mfma_f32_16x16x32_bf16 v[204:207], a[172:175], a[88:91], v[204:207]
    ds_read_b64_tr_b16 a[146:147], v12 offset:20480
    v_mfma_f32_16x16x32_bf16 v[236:239], a[172:175], a[92:95], v[236:239]
    s_waitcnt lgkmcnt(15)
    v_mfma_f32_16x16x32_bf16 v[144:147], a[176:179], a[80:83], v[144:147]
    ds_read_b64_tr_b16 a[148:149], v13 offset:16384
    buffer_load_dwordx4 v18, s[52:55], s83 offen offset:1024 lds
    v_mfma_f32_16x16x32_bf16 v[176:179], a[176:179], a[84:87], v[176:179]
    ds_read_b64_tr_b16 a[150:151], v13 offset:20480
    v_mfma_f32_16x16x32_bf16 v[208:211], a[176:179], a[88:91], v[208:211]
    v_mfma_f32_16x16x32_bf16 v[240:243], a[176:179], a[92:95], v[240:243]
    ds_read_b64_tr_b16 a[152:153], v14 offset:16384
    s_waitcnt lgkmcnt(15)
    v_mfma_f32_16x16x32_bf16 v[148:151], a[180:183], a[80:83], v[148:151]
    ds_read_b64_tr_b16 a[154:155], v14 offset:20480
    v_mfma_f32_16x16x32_bf16 v[180:183], a[180:183], a[84:87], v[180:183]
    v_mfma_f32_16x16x32_bf16 v[212:215], a[180:183], a[88:91], v[212:215]
    ds_read_b64_tr_b16 a[156:157], v15 offset:16384
    v_mfma_f32_16x16x32_bf16 v[244:247], a[180:183], a[92:95], v[244:247]
    ds_read_b64_tr_b16 a[158:159], v15 offset:20480
    v_mfma_f32_16x16x32_bf16 v[152:155], a[184:187], a[80:83], v[152:155]
    v_mfma_f32_16x16x32_bf16 v[184:187], a[184:187], a[84:87], v[184:187]
    v_mfma_f32_16x16x32_bf16 v[216:219], a[184:187], a[88:91], v[216:219]
    v_mfma_f32_16x16x32_bf16 v[248:251], a[184:187], a[92:95], v[248:251]
    s_waitcnt lgkmcnt(15)
    v_mfma_f32_16x16x32_bf16 v[156:159], a[188:191], a[80:83], v[156:159]
    v_mfma_f32_16x16x32_bf16 v[188:191], a[188:191], a[84:87], v[188:191]
    v_mfma_f32_16x16x32_bf16 v[220:223], a[188:191], a[88:91], v[220:223]
    v_mfma_f32_16x16x32_bf16 v[252:255], a[188:191], a[92:95], v[252:255]
    s_waitcnt vmcnt(41) lgkmcnt(14)
    v_mfma_f32_16x16x32_bf16 v[128:131], a[128:131], a[96:99], v[128:131]
    buffer_load_dwordx4 a[80:83], v16, s[56:59], s69 offen offset:0 sc1
    s_waitcnt vmcnt(41)
    v_mfma_f32_16x16x32_bf16 v[160:163], a[128:131], a[100:103], v[160:163]
    ds_read_b64_tr_b16 a[160:161], v8 offset:24576
    s_waitcnt vmcnt(40)
    v_mfma_f32_16x16x32_bf16 v[192:195], a[128:131], a[104:107], v[192:195]
    ds_read_b64_tr_b16 a[162:163], v8 offset:28672
    buffer_load_dwordx4 a[84:87], v16, s[56:59], s69 offen offset:1024 sc1
    s_waitcnt vmcnt(40)
    v_mfma_f32_16x16x32_bf16 v[224:227], a[128:131], a[108:111], v[224:227]
    s_waitcnt lgkmcnt(14)
    v_mfma_f32_16x16x32_bf16 v[132:135], a[132:135], a[96:99], v[132:135]
    ds_read_b64_tr_b16 a[164:165], v9 offset:24576
    buffer_load_dwordx4 a[88:91], v16, s[56:59], s69 offen offset:2048 sc1
    v_mfma_f32_16x16x32_bf16 v[164:167], a[132:135], a[100:103], v[164:167]
    ds_read_b64_tr_b16 a[166:167], v9 offset:28672
    v_mfma_f32_16x16x32_bf16 v[196:199], a[132:135], a[104:107], v[196:199]
    buffer_load_dwordx4 a[92:95], v16, s[56:59], s69 offen offset:3072 sc1
    v_mfma_f32_16x16x32_bf16 v[228:231], a[132:135], a[108:111], v[228:231]
    ds_read_b64_tr_b16 a[168:169], v10 offset:24576
    s_waitcnt lgkmcnt(15)
    v_mfma_f32_16x16x32_bf16 v[136:139], a[136:139], a[96:99], v[136:139]
    ds_read_b64_tr_b16 a[170:171], v10 offset:28672
    s_add_u32 s69, s69, 4096
    v_mfma_f32_16x16x32_bf16 v[168:171], a[136:139], a[100:103], v[168:171]
    v_mfma_f32_16x16x32_bf16 v[200:203], a[136:139], a[104:107], v[200:203]
    ds_read_b64_tr_b16 a[172:173], v11 offset:24576
    v_mfma_f32_16x16x32_bf16 v[232:235], a[136:139], a[108:111], v[232:235]
    ds_read_b64_tr_b16 a[174:175], v11 offset:28672
    s_mov_b32 s82, 655360
    s_add_u32 m0, s3, 147456
    s_waitcnt lgkmcnt(15)
    v_mfma_f32_16x16x32_bf16 v[140:143], a[140:143], a[96:99], v[140:143]
    buffer_load_dwordx4 v17, s[52:55], s82 offen lds
    v_mfma_f32_16x16x32_bf16 v[172:175], a[140:143], a[100:103], v[172:175]
    ds_read_b64_tr_b16 a[176:177], v12 offset:24576
    v_mfma_f32_16x16x32_bf16 v[204:207], a[140:143], a[104:107], v[204:207]
    ds_read_b64_tr_b16 a[178:179], v12 offset:28672
    v_mfma_f32_16x16x32_bf16 v[236:239], a[140:143], a[108:111], v[236:239]
    s_waitcnt lgkmcnt(15)
    v_mfma_f32_16x16x32_bf16 v[144:147], a[144:147], a[96:99], v[144:147]
    ds_read_b64_tr_b16 a[180:181], v13 offset:24576
    buffer_load_dwordx4 v18, s[52:55], s82 offen offset:1024 lds
    v_mfma_f32_16x16x32_bf16 v[176:179], a[144:147], a[100:103], v[176:179]
    ds_read_b64_tr_b16 a[182:183], v13 offset:28672
    v_mfma_f32_16x16x32_bf16 v[208:211], a[144:147], a[104:107], v[208:211]
    v_mfma_f32_16x16x32_bf16 v[240:243], a[144:147], a[108:111], v[240:243]
    ds_read_b64_tr_b16 a[184:185], v14 offset:24576
    s_waitcnt lgkmcnt(15)
    v_mfma_f32_16x16x32_bf16 v[148:151], a[148:151], a[96:99], v[148:151]
    ds_read_b64_tr_b16 a[186:187], v14 offset:28672
    v_mfma_f32_16x16x32_bf16 v[180:183], a[148:151], a[100:103], v[180:183]
    v_mfma_f32_16x16x32_bf16 v[212:215], a[148:151], a[104:107], v[212:215]
    ds_read_b64_tr_b16 a[188:189], v15 offset:24576
    v_mfma_f32_16x16x32_bf16 v[244:247], a[148:151], a[108:111], v[244:247]
    ds_read_b64_tr_b16 a[190:191], v15 offset:28672
    v_mfma_f32_16x16x32_bf16 v[152:155], a[152:155], a[96:99], v[152:155]
    v_mfma_f32_16x16x32_bf16 v[184:187], a[152:155], a[100:103], v[184:187]
    v_mfma_f32_16x16x32_bf16 v[216:219], a[152:155], a[104:107], v[216:219]
    v_mfma_f32_16x16x32_bf16 v[248:251], a[152:155], a[108:111], v[248:251]
    s_waitcnt lgkmcnt(15)
    v_mfma_f32_16x16x32_bf16 v[156:159], a[156:159], a[96:99], v[156:159]
    v_mfma_f32_16x16x32_bf16 v[188:191], a[156:159], a[100:103], v[188:191]
    v_mfma_f32_16x16x32_bf16 v[220:223], a[156:159], a[104:107], v[220:223]
    v_mfma_f32_16x16x32_bf16 v[252:255], a[156:159], a[108:111], v[252:255]
    s_waitcnt vmcnt(41) lgkmcnt(14)
    v_mfma_f32_16x16x32_bf16 v[128:131], a[160:163], a[112:115], v[128:131]
    buffer_load_dwordx4 a[96:99], v16, s[56:59], s69 offen offset:0 sc1
    s_waitcnt vmcnt(41)
    v_mfma_f32_16x16x32_bf16 v[160:163], a[160:163], a[116:119], v[160:163]
    ds_read_b64_tr_b16 a[128:129], v8 offset:32768
    s_waitcnt vmcnt(40)
    v_mfma_f32_16x16x32_bf16 v[192:195], a[160:163], a[120:123], v[192:195]
    ds_read_b64_tr_b16 a[130:131], v8 offset:36864
    buffer_load_dwordx4 a[100:103], v16, s[56:59], s69 offen offset:1024 sc1
    s_waitcnt vmcnt(40)
    v_mfma_f32_16x16x32_bf16 v[224:227], a[160:163], a[124:127], v[224:227]
    s_waitcnt lgkmcnt(14)
    v_mfma_f32_16x16x32_bf16 v[132:135], a[164:167], a[112:115], v[132:135]
    ds_read_b64_tr_b16 a[132:133], v9 offset:32768
    buffer_load_dwordx4 a[104:107], v16, s[56:59], s69 offen offset:2048 sc1
    v_mfma_f32_16x16x32_bf16 v[164:167], a[164:167], a[116:119], v[164:167]
    ds_read_b64_tr_b16 a[134:135], v9 offset:36864
    v_mfma_f32_16x16x32_bf16 v[196:199], a[164:167], a[120:123], v[196:199]
    buffer_load_dwordx4 a[108:111], v16, s[56:59], s69 offen offset:3072 sc1
    v_mfma_f32_16x16x32_bf16 v[228:231], a[164:167], a[124:127], v[228:231]
    ds_read_b64_tr_b16 a[136:137], v10 offset:32768
    s_waitcnt lgkmcnt(15)
    v_mfma_f32_16x16x32_bf16 v[136:139], a[168:171], a[112:115], v[136:139]
    ds_read_b64_tr_b16 a[138:139], v10 offset:36864
    s_add_u32 s69, s69, 4096
    v_mfma_f32_16x16x32_bf16 v[168:171], a[168:171], a[116:119], v[168:171]
    v_mfma_f32_16x16x32_bf16 v[200:203], a[168:171], a[120:123], v[200:203]
    ds_read_b64_tr_b16 a[140:141], v11 offset:32768
    v_mfma_f32_16x16x32_bf16 v[232:235], a[168:171], a[124:127], v[232:235]
    ds_read_b64_tr_b16 a[142:143], v11 offset:36864
    s_mov_b32 s83, 720896
    s_add_u32 m0, s3, 155648
    s_waitcnt lgkmcnt(15)
    v_mfma_f32_16x16x32_bf16 v[140:143], a[172:175], a[112:115], v[140:143]
    buffer_load_dwordx4 v17, s[52:55], s83 offen lds
    v_mfma_f32_16x16x32_bf16 v[172:175], a[172:175], a[116:119], v[172:175]
    ds_read_b64_tr_b16 a[144:145], v12 offset:32768
    v_mfma_f32_16x16x32_bf16 v[204:207], a[172:175], a[120:123], v[204:207]
    ds_read_b64_tr_b16 a[146:147], v12 offset:36864
    v_mfma_f32_16x16x32_bf16 v[236:239], a[172:175], a[124:127], v[236:239]
    s_waitcnt lgkmcnt(15)
    v_mfma_f32_16x16x32_bf16 v[144:147], a[176:179], a[112:115], v[144:147]
    ds_read_b64_tr_b16 a[148:149], v13 offset:32768
    buffer_load_dwordx4 v18, s[52:55], s83 offen offset:1024 lds
    v_mfma_f32_16x16x32_bf16 v[176:179], a[176:179], a[116:119], v[176:179]
    ds_read_b64_tr_b16 a[150:151], v13 offset:36864
    v_mfma_f32_16x16x32_bf16 v[208:211], a[176:179], a[120:123], v[208:211]
    v_mfma_f32_16x16x32_bf16 v[240:243], a[176:179], a[124:127], v[240:243]
    ds_read_b64_tr_b16 a[152:153], v14 offset:32768
    s_waitcnt lgkmcnt(15)
    v_mfma_f32_16x16x32_bf16 v[148:151], a[180:183], a[112:115], v[148:151]
    ds_read_b64_tr_b16 a[154:155], v14 offset:36864
    v_mfma_f32_16x16x32_bf16 v[180:183], a[180:183], a[116:119], v[180:183]
    v_mfma_f32_16x16x32_bf16 v[212:215], a[180:183], a[120:123], v[212:215]
    ds_read_b64_tr_b16 a[156:157], v15 offset:32768
    v_mfma_f32_16x16x32_bf16 v[244:247], a[180:183], a[124:127], v[244:247]
    ds_read_b64_tr_b16 a[158:159], v15 offset:36864
    v_mfma_f32_16x16x32_bf16 v[152:155], a[184:187], a[112:115], v[152:155]
    v_mfma_f32_16x16x32_bf16 v[184:187], a[184:187], a[116:119], v[184:187]
    v_mfma_f32_16x16x32_bf16 v[216:219], a[184:187], a[120:123], v[216:219]
    v_mfma_f32_16x16x32_bf16 v[248:251], a[184:187], a[124:127], v[248:251]
    s_waitcnt lgkmcnt(15)
    v_mfma_f32_16x16x32_bf16 v[156:159], a[188:191], a[112:115], v[156:159]
    v_mfma_f32_16x16x32_bf16 v[188:191], a[188:191], a[116:119], v[188:191]
    v_mfma_f32_16x16x32_bf16 v[220:223], a[188:191], a[120:123], v[220:223]
    v_mfma_f32_16x16x32_bf16 v[252:255], a[188:191], a[124:127], v[252:255]
    s_barrier
    s_waitcnt vmcnt(41) lgkmcnt(14)
    v_mfma_f32_16x16x32_bf16 v[128:131], a[128:131], a[0:3], v[128:131]
    buffer_load_dwordx4 a[112:115], v16, s[56:59], s69 offen offset:0 sc1
    s_waitcnt vmcnt(41)
    v_mfma_f32_16x16x32_bf16 v[160:163], a[128:131], a[4:7], v[160:163]
    ds_read_b64_tr_b16 a[160:161], v8 offset:40960
    s_waitcnt vmcnt(40)
    v_mfma_f32_16x16x32_bf16 v[192:195], a[128:131], a[8:11], v[192:195]
    ds_read_b64_tr_b16 a[162:163], v8 offset:45056
    buffer_load_dwordx4 a[116:119], v16, s[56:59], s69 offen offset:1024 sc1
    s_waitcnt vmcnt(40)
    v_mfma_f32_16x16x32_bf16 v[224:227], a[128:131], a[12:15], v[224:227]
    s_waitcnt lgkmcnt(14)
    v_mfma_f32_16x16x32_bf16 v[132:135], a[132:135], a[0:3], v[132:135]
    ds_read_b64_tr_b16 a[164:165], v9 offset:40960
    buffer_load_dwordx4 a[120:123], v16, s[56:59], s69 offen offset:2048 sc1
    v_mfma_f32_16x16x32_bf16 v[164:167], a[132:135], a[4:7], v[164:167]
    ds_read_b64_tr_b16 a[166:167], v9 offset:45056
    v_mfma_f32_16x16x32_bf16 v[196:199], a[132:135], a[8:11], v[196:199]
    buffer_load_dwordx4 a[124:127], v16, s[56:59], s69 offen offset:3072 sc1
    v_mfma_f32_16x16x32_bf16 v[228:231], a[132:135], a[12:15], v[228:231]
    ds_read_b64_tr_b16 a[168:169], v10 offset:40960
    s_waitcnt lgkmcnt(15)
    v_mfma_f32_16x16x32_bf16 v[136:139], a[136:139], a[0:3], v[136:139]
    ds_read_b64_tr_b16 a[170:171], v10 offset:45056
    s_add_u32 s69, s69, 4096
    v_mfma_f32_16x16x32_bf16 v[168:171], a[136:139], a[4:7], v[168:171]
    v_mfma_f32_16x16x32_bf16 v[200:203], a[136:139], a[8:11], v[200:203]
    ds_read_b64_tr_b16 a[172:173], v11 offset:40960
    v_mfma_f32_16x16x32_bf16 v[232:235], a[136:139], a[12:15], v[232:235]
    ds_read_b64_tr_b16 a[174:175], v11 offset:45056
    s_mov_b32 s82, 786432
    s_add_u32 m0, s3, 0
    s_waitcnt lgkmcnt(15)
    v_mfma_f32_16x16x32_bf16 v[140:143], a[140:143], a[0:3], v[140:143]
    buffer_load_dwordx4 v17, s[52:55], s82 offen lds
    v_mfma_f32_16x16x32_bf16 v[172:175], a[140:143], a[4:7], v[172:175]
    ds_read_b64_tr_b16 a[176:177], v12 offset:40960
    v_mfma_f32_16x16x32_bf16 v[204:207], a[140:143], a[8:11], v[204:207]
    ds_read_b64_tr_b16 a[178:179], v12 offset:45056
    v_mfma_f32_16x16x32_bf16 v[236:239], a[140:143], a[12:15], v[236:239]
    s_waitcnt lgkmcnt(15)
    v_mfma_f32_16x16x32_bf16 v[144:147], a[144:147], a[0:3], v[144:147]
    ds_read_b64_tr_b16 a[180:181], v13 offset:40960
    buffer_load_dwordx4 v18, s[52:55], s82 offen offset:1024 lds
    v_mfma_f32_16x16x32_bf16 v[176:179], a[144:147], a[4:7], v[176:179]
    ds_read_b64_tr_b16 a[182:183], v13 offset:45056
    v_mfma_f32_16x16x32_bf16 v[208:211], a[144:147], a[8:11], v[208:211]
    v_mfma_f32_16x16x32_bf16 v[240:243], a[144:147], a[12:15], v[240:243]
    ds_read_b64_tr_b16 a[184:185], v14 offset:40960
    s_waitcnt lgkmcnt(15)
    v_mfma_f32_16x16x32_bf16 v[148:151], a[148:151], a[0:3], v[148:151]
    ds_read_b64_tr_b16 a[186:187], v14 offset:45056
    v_mfma_f32_16x16x32_bf16 v[180:183], a[148:151], a[4:7], v[180:183]
    v_mfma_f32_16x16x32_bf16 v[212:215], a[148:151], a[8:11], v[212:215]
    ds_read_b64_tr_b16 a[188:189], v15 offset:40960
    v_mfma_f32_16x16x32_bf16 v[244:247], a[148:151], a[12:15], v[244:247]
    ds_read_b64_tr_b16 a[190:191], v15 offset:45056
    v_mfma_f32_16x16x32_bf16 v[152:155], a[152:155], a[0:3], v[152:155]
    v_mfma_f32_16x16x32_bf16 v[184:187], a[152:155], a[4:7], v[184:187]
    v_mfma_f32_16x16x32_bf16 v[216:219], a[152:155], a[8:11], v[216:219]
    v_mfma_f32_16x16x32_bf16 v[248:251], a[152:155], a[12:15], v[248:251]
    s_waitcnt lgkmcnt(15)
    v_mfma_f32_16x16x32_bf16 v[156:159], a[156:159], a[0:3], v[156:159]
    v_mfma_f32_16x16x32_bf16 v[188:191], a[156:159], a[4:7], v[188:191]
    v_mfma_f32_16x16x32_bf16 v[220:223], a[156:159], a[8:11], v[220:223]
    v_mfma_f32_16x16x32_bf16 v[252:255], a[156:159], a[12:15], v[252:255]
    s_waitcnt vmcnt(41) lgkmcnt(14)
    v_mfma_f32_16x16x32_bf16 v[128:131], a[160:163], a[16:19], v[128:131]
    buffer_load_dwordx4 a[0:3], v16, s[56:59], s69 offen offset:0 sc1
    s_waitcnt vmcnt(41)
    v_mfma_f32_16x16x32_bf16 v[160:163], a[160:163], a[20:23], v[160:163]
    ds_read_b64_tr_b16 a[128:129], v8 offset:49152
    s_waitcnt vmcnt(40)
    v_mfma_f32_16x16x32_bf16 v[192:195], a[160:163], a[24:27], v[192:195]
    ds_read_b64_tr_b16 a[130:131], v8 offset:53248
    buffer_load_dwordx4 a[4:7], v16, s[56:59], s69 offen offset:1024 sc1
    s_waitcnt vmcnt(40)
    v_mfma_f32_16x16x32_bf16 v[224:227], a[160:163], a[28:31], v[224:227]
    s_waitcnt lgkmcnt(14)
    v_mfma_f32_16x16x32_bf16 v[132:135], a[164:167], a[16:19], v[132:135]
    ds_read_b64_tr_b16 a[132:133], v9 offset:49152
    buffer_load_dwordx4 a[8:11], v16, s[56:59], s69 offen offset:2048 sc1
    v_mfma_f32_16x16x32_bf16 v[164:167], a[164:167], a[20:23], v[164:167]
    ds_read_b64_tr_b16 a[134:135], v9 offset:53248
    v_mfma_f32_16x16x32_bf16 v[196:199], a[164:167], a[24:27], v[196:199]
    buffer_load_dwordx4 a[12:15], v16, s[56:59], s69 offen offset:3072 sc1
    v_mfma_f32_16x16x32_bf16 v[228:231], a[164:167], a[28:31], v[228:231]
    ds_read_b64_tr_b16 a[136:137], v10 offset:49152
    s_waitcnt lgkmcnt(15)
    v_mfma_f32_16x16x32_bf16 v[136:139], a[168:171], a[16:19], v[136:139]
    ds_read_b64_tr_b16 a[138:139], v10 offset:53248
    s_add_u32 s69, s69, 4096
    v_mfma_f32_16x16x32_bf16 v[168:171], a[168:171], a[20:23], v[168:171]
    v_mfma_f32_16x16x32_bf16 v[200:203], a[168:171], a[24:27], v[200:203]
    ds_read_b64_tr_b16 a[140:141], v11 offset:49152
    v_mfma_f32_16x16x32_bf16 v[232:235], a[168:171], a[28:31], v[232:235]
    ds_read_b64_tr_b16 a[142:143], v11 offset:53248
    s_mov_b32 s83, 851968
    s_add_u32 m0, s3, 8192
    s_waitcnt lgkmcnt(15)
    v_mfma_f32_16x16x32_bf16 v[140:143], a[172:175], a[16:19], v[140:143]
    buffer_load_dwordx4 v17, s[52:55], s83 offen lds
    v_mfma_f32_16x16x32_bf16 v[172:175], a[172:175], a[20:23], v[172:175]
    ds_read_b64_tr_b16 a[144:145], v12 offset:49152
    v_mfma_f32_16x16x32_bf16 v[204:207], a[172:175], a[24:27], v[204:207]
    ds_read_b64_tr_b16 a[146:147], v12 offset:53248
    v_mfma_f32_16x16x32_bf16 v[236:239], a[172:175], a[28:31], v[236:239]
    s_waitcnt lgkmcnt(15)
    v_mfma_f32_16x16x32_bf16 v[144:147], a[176:179], a[16:19], v[144:147]
    ds_read_b64_tr_b16 a[148:149], v13 offset:49152
    buffer_load_dwordx4 v18, s[52:55], s83 offen offset:1024 lds
    v_mfma_f32_16x16x32_bf16 v[176:179], a[176:179], a[20:23], v[176:179]
    ds_read_b64_tr_b16 a[150:151], v13 offset:53248
    v_mfma_f32_16x16x32_bf16 v[208:211], a[176:179], a[24:27], v[208:211]
    v_mfma_f32_16x16x32_bf16 v[240:243], a[176:179], a[28:31], v[240:243]
    ds_read_b64_tr_b16 a[152:153], v14 offset:49152
    s_waitcnt lgkmcnt(15)
    v_mfma_f32_16x16x32_bf16 v[148:151], a[180:183], a[16:19], v[148:151]
    ds_read_b64_tr_b16 a[154:155], v14 offset:53248
    v_mfma_f32_16x16x32_bf16 v[180:183], a[180:183], a[20:23], v[180:183]
    v_mfma_f32_16x16x32_bf16 v[212:215], a[180:183], a[24:27], v[212:215]
    ds_read_b64_tr_b16 a[156:157], v15 offset:49152
    v_mfma_f32_16x16x32_bf16 v[244:247], a[180:183], a[28:31], v[244:247]
    ds_read_b64_tr_b16 a[158:159], v15 offset:53248
    v_mfma_f32_16x16x32_bf16 v[152:155], a[184:187], a[16:19], v[152:155]
    v_mfma_f32_16x16x32_bf16 v[184:187], a[184:187], a[20:23], v[184:187]
    v_mfma_f32_16x16x32_bf16 v[216:219], a[184:187], a[24:27], v[216:219]
    v_mfma_f32_16x16x32_bf16 v[248:251], a[184:187], a[28:31], v[248:251]
    s_waitcnt lgkmcnt(15)
    v_mfma_f32_16x16x32_bf16 v[156:159], a[188:191], a[16:19], v[156:159]
    v_mfma_f32_16x16x32_bf16 v[188:191], a[188:191], a[20:23], v[188:191]
    v_mfma_f32_16x16x32_bf16 v[220:223], a[188:191], a[24:27], v[220:223]
    v_mfma_f32_16x16x32_bf16 v[252:255], a[188:191], a[28:31], v[252:255]
    s_waitcnt vmcnt(41) lgkmcnt(14)
    v_mfma_f32_16x16x32_bf16 v[128:131], a[128:131], a[32:35], v[128:131]
    buffer_load_dwordx4 a[16:19], v16, s[56:59], s69 offen offset:0 sc1
    s_waitcnt vmcnt(41)
    v_mfma_f32_16x16x32_bf16 v[160:163], a[128:131], a[36:39], v[160:163]
    ds_read_b64_tr_b16 a[160:161], v8 offset:57344
    s_waitcnt vmcnt(40)
    v_mfma_f32_16x16x32_bf16 v[192:195], a[128:131], a[40:43], v[192:195]
    ds_read_b64_tr_b16 a[162:163], v8 offset:61440
    buffer_load_dwordx4 a[20:23], v16, s[56:59], s69 offen offset:1024 sc1
    s_waitcnt vmcnt(40)
    v_mfma_f32_16x16x32_bf16 v[224:227], a[128:131], a[44:47], v[224:227]
    s_waitcnt lgkmcnt(14)
    v_mfma_f32_16x16x32_bf16 v[132:135], a[132:135], a[32:35], v[132:135]
    ds_read_b64_tr_b16 a[164:165], v9 offset:57344
    buffer_load_dwordx4 a[24:27], v16, s[56:59], s69 offen offset:2048 sc1
    v_mfma_f32_16x16x32_bf16 v[164:167], a[132:135], a[36:39], v[164:167]
    ds_read_b64_tr_b16 a[166:167], v9 offset:61440
    v_mfma_f32_16x16x32_bf16 v[196:199], a[132:135], a[40:43], v[196:199]
    buffer_load_dwordx4 a[28:31], v16, s[56:59], s69 offen offset:3072 sc1
    v_mfma_f32_16x16x32_bf16 v[228:231], a[132:135], a[44:47], v[228:231]
    ds_read_b64_tr_b16 a[168:169], v10 offset:57344
    s_waitcnt lgkmcnt(15)
    v_mfma_f32_16x16x32_bf16 v[136:139], a[136:139], a[32:35], v[136:139]
    ds_read_b64_tr_b16 a[170:171], v10 offset:61440
    s_add_u32 s69, s69, 4096
    v_mfma_f32_16x16x32_bf16 v[168:171], a[136:139], a[36:39], v[168:171]
    v_mfma_f32_16x16x32_bf16 v[200:203], a[136:139], a[40:43], v[200:203]
    ds_read_b64_tr_b16 a[172:173], v11 offset:57344
    s_branch L_over11
L_stub11:
    s_branch L_stub12
L_over11:
    v_mfma_f32_16x16x32_bf16 v[232:235], a[136:139], a[44:47], v[232:235]
    ds_read_b64_tr_b16 a[174:175], v11 offset:61440
    s_mov_b32 s82, 917504
    s_add_u32 m0, s3, 16384
    s_waitcnt lgkmcnt(15)
    v_mfma_f32_16x16x32_bf16 v[140:143], a[140:143], a[32:35], v[140:143]
    buffer_load_dwordx4 v17, s[52:55], s82 offen lds
    v_mfma_f32_16x16x32_bf16 v[172:175], a[140:143], a[36:39], v[172:175]
    ds_read_b64_tr_b16 a[176:177], v12 offset:57344
    v_mfma_f32_16x16x32_bf16 v[204:207], a[140:143], a[40:43], v[204:207]
    ds_read_b64_tr_b16 a[178:179], v12 offset:61440
    v_mfma_f32_16x16x32_bf16 v[236:239], a[140:143], a[44:47], v[236:239]
    s_waitcnt lgkmcnt(15)
    v_mfma_f32_16x16x32_bf16 v[144:147], a[144:147], a[32:35], v[144:147]
    ds_read_b64_tr_b16 a[180:181], v13 offset:57344
    buffer_load_dwordx4 v18, s[52:55], s82 offen offset:1024 lds
    v_mfma_f32_16x16x32_bf16 v[176:179], a[144:147], a[36:39], v[176:179]
    ds_read_b64_tr_b16 a[182:183], v13 offset:61440
    v_mfma_f32_16x16x32_bf16 v[208:211], a[144:147], a[40:43], v[208:211]
    v_mfma_f32_16x16x32_bf16 v[240:243], a[144:147], a[44:47], v[240:243]
    ds_read_b64_tr_b16 a[184:185], v14 offset:57344
    s_waitcnt lgkmcnt(15)
    v_mfma_f32_16x16x32_bf16 v[148:151], a[148:151], a[32:35], v[148:151]
    ds_read_b64_tr_b16 a[186:187], v14 offset:61440
    v_mfma_f32_16x16x32_bf16 v[180:183], a[148:151], a[36:39], v[180:183]
    v_mfma_f32_16x16x32_bf16 v[212:215], a[148:151], a[40:43], v[212:215]
    ds_read_b64_tr_b16 a[188:189], v15 offset:57344
    v_mfma_f32_16x16x32_bf16 v[244:247], a[148:151], a[44:47], v[244:247]
    ds_read_b64_tr_b16 a[190:191], v15 offset:61440
    v_mfma_f32_16x16x32_bf16 v[152:155], a[152:155], a[32:35], v[152:155]
    v_mfma_f32_16x16x32_bf16 v[184:187], a[152:155], a[36:39], v[184:187]
    v_mfma_f32_16x16x32_bf16 v[216:219], a[152:155], a[40:43], v[216:219]
    v_mfma_f32_16x16x32_bf16 v[248:251], a[152:155], a[44:47], v[248:251]
    s_waitcnt lgkmcnt(15)
    v_mfma_f32_16x16x32_bf16 v[156:159], a[156:159], a[32:35], v[156:159]
    v_mfma_f32_16x16x32_bf16 v[188:191], a[156:159], a[36:39], v[188:191]
    v_mfma_f32_16x16x32_bf16 v[220:223], a[156:159], a[40:43], v[220:223]
    v_mfma_f32_16x16x32_bf16 v[252:255], a[156:159], a[44:47], v[252:255]
    s_waitcnt vmcnt(40) lgkmcnt(14)
    v_mfma_f32_16x16x32_bf16 v[160:163], a[160:163], a[52:55], v[160:163]
    buffer_load_dwordx4 a[32:35], v16, s[56:59], s69 offen offset:0 sc1
    s_waitcnt lgkmcnt(12)
    v_mfma_f32_16x16x32_bf16 v[164:167], a[164:167], a[52:55], v[164:167]
    ds_read_b64_tr_b16 a[128:129], v48 offset:0
    s_waitcnt lgkmcnt(11)
    v_mfma_f32_16x16x32_bf16 v[168:171], a[168:171], a[52:55], v[168:171]
    ds_read_b64_tr_b16 a[130:131], v48 offset:4096
    buffer_load_dwordx4 a[36:39], v16, s[56:59], s69 offen offset:1024 sc1
    s_waitcnt lgkmcnt(10)
    v_mfma_f32_16x16x32_bf16 v[172:175], a[172:175], a[52:55], v[172:175]
    ds_read_b64_tr_b16 a[132:133], v49 offset:0
    s_waitcnt lgkmcnt(9)
    v_mfma_f32_16x16x32_bf16 v[176:179], a[176:179], a[52:55], v[176:179]
    ds_read_b64_tr_b16 a[134:135], v49 offset:4096
    buffer_load_dwordx4 a[40:43], v16, s[56:59], s69 offen offset:2048 sc1
    s_waitcnt lgkmcnt(8)
    v_mfma_f32_16x16x32_bf16 v[180:183], a[180:183], a[52:55], v[180:183]
    ds_read_b64_tr_b16 a[136:137], v50 offset:0
    s_waitcnt lgkmcnt(7)
    v_mfma_f32_16x16x32_bf16 v[184:187], a[184:187], a[52:55], v[184:187]
    ds_read_b64_tr_b16 a[138:139], v50 offset:4096
    buffer_load_dwordx4 a[44:47], v16, s[56:59], s69 offen offset:3072 sc1
    s_waitcnt lgkmcnt(6)
    v_mfma_f32_16x16x32_bf16 v[188:191], a[188:191], a[52:55], v[188:191]
    ds_read_b64_tr_b16 a[140:141], v51 offset:0
    s_waitcnt vmcnt(43)
    v_mfma_f32_16x16x32_bf16 v[192:195], a[160:163], a[56:59], v[192:195]
    ds_read_b64_tr_b16 a[142:143], v51 offset:4096
    s_add_u32 s69, s69, 4096
    v_mfma_f32_16x16x32_bf16 v[196:199], a[164:167], a[56:59], v[196:199]
    ds_read_b64_tr_b16 a[144:145], v52 offset:0
    v_mfma_f32_16x16x32_bf16 v[200:203], a[168:171], a[56:59], v[200:203]
    ds_read_b64_tr_b16 a[146:147], v52 offset:4096
    v_mfma_f32_16x16x32_bf16 v[204:207], a[172:175], a[56:59], v[204:207]
    ds_read_b64_tr_b16 a[148:149], v53 offset:0
    s_mov_b32 s83, 983040
    s_add_u32 m0, s3, 24576
    v_mfma_f32_16x16x32_bf16 v[208:211], a[176:179], a[56:59], v[208:211]
    ds_read_b64_tr_b16 a[150:151], v53 offset:4096
    buffer_load_dwordx4 v17, s[52:55], s83 offen lds
    v_cvt_pk_bf16_f32 v160, v160, v161
    v_cvt_pk_bf16_f32 v161, v162, v163
    v_mfma_f32_16x16x32_bf16 v[212:215], a[180:183], a[56:59], v[212:215]
    ds_read_b64_tr_b16 a[152:153], v54 offset:0
    v_cvt_pk_bf16_f32 v162, v164, v165
    v_cvt_pk_bf16_f32 v163, v166, v167
    v_mfma_f32_16x16x32_bf16 v[216:219], a[184:187], a[56:59], v[216:219]
    ds_read_b64_tr_b16 a[154:155], v54 offset:4096
    buffer_store_dwordx4 v[160:163], v16, s[56:59], s70 offen offset:0 sc1
    v_cvt_pk_bf16_f32 v168, v168, v169
    v_mfma_f32_16x16x32_bf16 v[220:223], a[188:191], a[56:59], v[220:223]
    v_cvt_pk_bf16_f32 v169, v170, v171
    v_cvt_pk_bf16_f32 v170, v172, v173
    s_waitcnt vmcnt(44)
    v_mfma_f32_16x16x32_bf16 v[224:227], a[160:163], a[60:63], v[224:227]
    buffer_load_dwordx4 v18, s[52:55], s83 offen offset:1024 lds
    v_cvt_pk_bf16_f32 v171, v174, v175
    buffer_store_dwordx4 v[168:171], v16, s[56:59], s70 offen offset:1024 sc1
    v_mfma_f32_16x16x32_bf16 v[228:231], a[164:167], a[60:63], v[228:231]
    v_cvt_pk_bf16_f32 v176, v176, v177
    v_cvt_pk_bf16_f32 v177, v178, v179
    v_mfma_f32_16x16x32_bf16 v[232:235], a[168:171], a[60:63], v[232:235]
    v_cvt_pk_bf16_f32 v178, v180, v181
    v_cvt_pk_bf16_f32 v179, v182, v183
    v_mfma_f32_16x16x32_bf16 v[236:239], a[172:175], a[60:63], v[236:239]
    buffer_store_dwordx4 v[176:179], v16, s[56:59], s70 offen offset:2048 sc1
    v_cvt_pk_bf16_f32 v184, v184, v185
    v_mfma_f32_16x16x32_bf16 v[240:243], a[176:179], a[60:63], v[240:243]
    v_cvt_pk_bf16_f32 v185, v186, v187
    v_cvt_pk_bf16_f32 v186, v188, v189
    v_mfma_f32_16x16x32_bf16 v[244:247], a[180:183], a[60:63], v[244:247]
    v_cvt_pk_bf16_f32 v187, v190, v191
    buffer_store_dwordx4 v[184:187], v16, s[56:59], s70 offen offset:3072 sc1
    v_mfma_f32_16x16x32_bf16 v[248:251], a[184:187], a[60:63], v[248:251]
    v_cvt_pk_bf16_f32 v192, v192, v193
    v_cvt_pk_bf16_f32 v193, v194, v195
    v_mfma_f32_16x16x32_bf16 v[252:255], a[188:191], a[60:63], v[252:255]
    v_cvt_pk_bf16_f32 v194, v196, v197
    v_cvt_pk_bf16_f32 v195, v198, v199
    v_mfma_f32_16x16x32_bf16 v[128:131], a[160:163], a[48:51], v[128:131]
    buffer_store_dwordx4 v[192:195], v16, s[56:59], s71 offen offset:0 sc1
    v_cvt_pk_bf16_f32 v200, v200, v201
    v_mfma_f32_16x16x32_bf16 v[132:135], a[164:167], a[48:51], v[132:135]
    v_cvt_pk_bf16_f32 v201, v202, v203
    v_cvt_pk_bf16_f32 v202, v204, v205
    v_mfma_f32_16x16x32_bf16 v[136:139], a[168:171], a[48:51], v[136:139]
    v_cvt_pk_bf16_f32 v203, v206, v207
    buffer_store_dwordx4 v[200:203], v16, s[56:59], s71 offen offset:1024 sc1
    v_mfma_f32_16x16x32_bf16 v[140:143], a[172:175], a[48:51], v[140:143]
    v_cvt_pk_bf16_f32 v208, v208, v209
    v_cvt_pk_bf16_f32 v209, v210, v211
    v_mfma_f32_16x16x32_bf16 v[144:147], a[176:179], a[48:51], v[144:147]
    v_cvt_pk_bf16_f32 v210, v212, v213
    v_cvt_pk_bf16_f32 v211, v214, v215
    v_mfma_f32_16x16x32_bf16 v[148:151], a[180:183], a[48:51], v[148:151]
    buffer_store_dwordx4 v[208:211], v16, s[56:59], s71 offen offset:2048 sc1
    v_cvt_pk_bf16_f32 v216, v216, v217
    v_mfma_f32_16x16x32_bf16 v[152:155], a[184:187], a[48:51], v[152:155]
    v_cvt_pk_bf16_f32 v217, v218, v219
    v_cvt_pk_bf16_f32 v218, v220, v221
    v_mfma_f32_16x16x32_bf16 v[156:159], a[188:191], a[48:51], v[156:159]
    v_cvt_pk_bf16_f32 v219, v222, v223
    buffer_store_dwordx4 v[216:219], v16, s[56:59], s71 offen offset:3072 sc1
    s_barrier
    buffer_load_dwordx4 a[48:51], v16, s[56:59], s69 offen offset:0 sc1
    buffer_load_dwordx4 a[52:55], v16, s[56:59], s69 offen offset:1024 sc1
    buffer_load_dwordx4 a[56:59], v16, s[56:59], s69 offen offset:2048 sc1
    buffer_load_dwordx4 a[60:63], v16, s[56:59], s69 offen offset:3072 sc1
    s_add_u32 s69, s69, 4096
    s_waitcnt vmcnt(53) lgkmcnt(12)
    v_mfma_f32_16x16x32_bf16 v[96:99], a[128:131], a[64:67], 0
    ds_read_b64_tr_b16 a[156:157], v55 offset:0
    ds_read_b64_tr_b16 a[158:159], v55 offset:4096
    v_cvt_pk_bf16_f32 v224, v224, v225
    v_cvt_pk_bf16_f32 v225, v226, v227
    s_waitcnt lgkmcnt(12)
    v_mfma_f32_16x16x32_bf16 v[100:103], a[132:135], a[64:67], 0
    ds_read_b64_tr_b16 a[160:161], v48 offset:8192
    ds_read_b64_tr_b16 a[162:163], v48 offset:12288
    v_cvt_pk_bf16_f32 v226, v228, v229
    v_cvt_pk_bf16_f32 v227, v230, v231
    s_waitcnt lgkmcnt(12)
    v_mfma_f32_16x16x32_bf16 v[104:107], a[136:139], a[64:67], 0
    ds_read_b64_tr_b16 a[164:165], v49 offset:8192
    ds_read_b64_tr_b16 a[166:167], v49 offset:12288
    buffer_store_dwordx4 v[224:227], v16, s[56:59], s72 offen offset:0 sc1
    v_cvt_pk_bf16_f32 v232, v232, v233
    s_waitcnt lgkmcnt(12)
    v_mfma_f32_16x16x32_bf16 v[108:111], a[140:143], a[64:67], 0
    ds_read_b64_tr_b16 a[168:169], v50 offset:8192
    ds_read_b64_tr_b16 a[170:171], v50 offset:12288
    v_cvt_pk_bf16_f32 v233, v234, v235
    v_cvt_pk_bf16_f32 v234, v236, v237
    s_waitcnt lgkmcnt(12)
    v_mfma_f32_16x16x32_bf16 v[112:115], a[144:147], a[64:67], 0
    ds_read_b64_tr_b16 a[172:173], v51 offset:8192
    ds_read_b64_tr_b16 a[174:175], v51 offset:12288
    v_cvt_pk_bf16_f32 v235, v238, v239
    buffer_store_dwordx4 v[232:235], v16, s[56:59], s72 offen offset:1024 sc1
    s_waitcnt lgkmcnt(12)
    v_mfma_f32_16x16x32_bf16 v[116:119], a[148:151], a[64:67], 0
    ds_read_b64_tr_b16 a[176:177], v52 offset:8192
    ds_read_b64_tr_b16 a[178:179], v52 offset:12288
    v_cvt_pk_bf16_f32 v240, v240, v241
    v_cvt_pk_bf16_f32 v241, v242, v243
    s_waitcnt lgkmcnt(12)
    v_mfma_f32_16x16x32_bf16 v[120:123], a[152:155], a[64:67], 0
    ds_read_b64_tr_b16 a[180:181], v53 offset:8192
    ds_read_b64_tr_b16 a[182:183], v53 offset:12288
    v_cvt_pk_bf16_f32 v242, v244, v245
    v_cvt_pk_bf16_f32 v243, v246, v247
    s_waitcnt lgkmcnt(12)
    v_mfma_f32_16x16x32_bf16 v[124:127], a[156:159], a[64:67], 0
    ds_read_b64_tr_b16 a[184:185], v54 offset:8192
    ds_read_b64_tr_b16 a[186:187], v54 offset:12288
    buffer_store_dwordx4 v[240:243], v16, s[56:59], s72 offen offset:2048 sc1
    v_cvt_pk_bf16_f32 v248, v248, v249
    s_waitcnt vmcnt(55) lgkmcnt(12)
    v_mfma_f32_16x16x32_bf16 v[96:99], a[160:163], a[68:71], v[96:99]
    ds_read_b64_tr_b16 a[188:189], v55 offset:8192
    ds_read_b64_tr_b16 a[190:191], v55 offset:12288
    v_cvt_pk_bf16_f32 v249, v250, v251
    v_cvt_pk_bf16_f32 v250, v252, v253
    s_waitcnt lgkmcnt(12)
    v_mfma_f32_16x16x32_bf16 v[100:103], a[164:167], a[68:71], v[100:103]
    ds_read_b64_tr_b16 a[128:129], v48 offset:16384
    ds_read_b64_tr_b16 a[130:131], v48 offset:20480
    v_cvt_pk_bf16_f32 v251, v254, v255
    buffer_store_dwordx4 v[248:251], v16, s[56:59], s72 offen offset:3072 sc1
    s_waitcnt lgkmcnt(12)
    v_mfma_f32_16x16x32_bf16 v[104:107], a[168:171], a[68:71], v[104:107]
    ds_read_b64_tr_b16 a[132:133], v49 offset:16384
    ds_read_b64_tr_b16 a[134:135], v49 offset:20480
    s_mov_b32 s82, 1048576
    s_add_u32 m0, s3, 32768
    s_nop 0
    buffer_load_dwordx4 v17, s[52:55], s82 offen lds
    s_waitcnt lgkmcnt(12)
    v_mfma_f32_16x16x32_bf16 v[108:111], a[172:175], a[68:71], v[108:111]
    ds_read_b64_tr_b16 a[136:137], v50 offset:16384
    ds_read_b64_tr_b16 a[138:139], v50 offset:20480
    s_waitcnt lgkmcnt(12)
    v_mfma_f32_16x16x32_bf16 v[112:115], a[176:179], a[68:71], v[112:115]
    ds_read_b64_tr_b16 a[140:141], v51 offset:16384
    ds_read_b64_tr_b16 a[142:143], v51 offset:20480
    s_waitcnt lgkmcnt(12)
    v_mfma_f32_16x16x32_bf16 v[116:119], a[180:183], a[68:71], v[116:119]
    ds_read_b64_tr_b16 a[144:145], v52 offset:16384
    ds_read_b64_tr_b16 a[146:147], v52 offset:20480
    buffer_load_dwordx4 v18, s[52:55], s82 offen offset:1024 lds
    s_waitcnt lgkmcnt(12)
    v_mfma_f32_16x16x32_bf16 v[120:123], a[184:187], a[68:71], v[120:123]
    ds_read_b64_tr_b16 a[148:149], v53 offset:16384
    ds_read_b64_tr_b16 a[150:151], v53 offset:20480
    s_waitcnt lgkmcnt(12)
    v_mfma_f32_16x16x32_bf16 v[124:127], a[188:191], a[68:71], v[124:127]
    ds_read_b64_tr_b16 a[152:153], v54 offset:16384
    ds_read_b64_tr_b16 a[154:155], v54 offset:20480
    s_waitcnt vmcnt(57) lgkmcnt(12)
    v_mfma_f32_16x16x32_bf16 v[96:99], a[128:131], a[72:75], v[96:99]
    ds_read_b64_tr_b16 a[156:157], v55 offset:16384
    ds_read_b64_tr_b16 a[158:159], v55 offset:20480
    s_mov_b32 s83, 1114112
    s_add_u32 m0, s3, 40960
    s_nop 0
    buffer_load_dwordx4 v17, s[52:55], s83 offen lds
    s_waitcnt lgkmcnt(12)
    v_mfma_f32_16x16x32_bf16 v[100:103], a[132:135], a[72:75], v[100:103]
    ds_read_b64_tr_b16 a[160:161], v48 offset:24576
    ds_read_b64_tr_b16 a[162:163], v48 offset:28672
    s_waitcnt lgkmcnt(12)
    v_mfma_f32_16x16x32_bf16 v[104:107], a[136:139], a[72:75], v[104:107]
    ds_read_b64_tr_b16 a[164:165], v49 offset:24576
    ds_read_b64_tr_b16 a[166:167], v49 offset:28672
    s_waitcnt lgkmcnt(12)
    v_mfma_f32_16x16x32_bf16 v[108:111], a[140:143], a[72:75], v[108:111]
    ds_read_b64_tr_b16 a[168:169], v50 offset:24576
    ds_read_b64_tr_b16 a[170:171], v50 offset:28672
    buffer_load_dwordx4 v18, s[52:55], s83 offen offset:1024 lds
    s_waitcnt lgkmcnt(12)
    v_mfma_f32_16x16x32_bf16 v[112:115], a[144:147], a[72:75], v[112:115]
    ds_read_b64_tr_b16 a[172:173], v51 offset:24576
    ds_read_b64_tr_b16 a[174:175], v51 offset:28672
    s_waitcnt lgkmcnt(12)
    v_mfma_f32_16x16x32_bf16 v[116:119], a[148:151], a[72:75], v[116:119]
    ds_read_b64_tr_b16 a[176:177], v52 offset:24576
    ds_read_b64_tr_b16 a[178:179], v52 offset:28672
    s_waitcnt lgkmcnt(12)
    v_mfma_f32_16x16x32_bf16 v[120:123], a[152:155], a[72:75], v[120:123]
    ds_read_b64_tr_b16 a[180:181], v53 offset:24576
    ds_read_b64_tr_b16 a[182:183], v53 offset:28672
    s_mov_b32 s82, 1179648
    s_add_u32 m0, s3, 49152
    s_nop 0
    buffer_load_dwordx4 v17, s[52:55], s82 offen lds
    s_waitcnt lgkmcnt(12)
    v_mfma_f32_16x16x32_bf16 v[124:127], a[156:159], a[72:75], v[124:127]
    ds_read_b64_tr_b16 a[184:185], v54 offset:24576
    ds_read_b64_tr_b16 a[186:187], v54 offset:28672
    s_waitcnt vmcnt(59) lgkmcnt(12)
    v_mfma_f32_16x16x32_bf16 v[96:99], a[160:163], a[76:79], v[96:99]
    ds_read_b64_tr_b16 a[188:189], v55 offset:24576
    ds_read_b64_tr_b16 a[190:191], v55 offset:28672
    s_waitcnt lgkmcnt(12)
    v_mfma_f32_16x16x32_bf16 v[100:103], a[164:167], a[76:79], v[100:103]
    ds_read_b64_tr_b16 a[128:129], v48 offset:32768
    ds_read_b64_tr_b16 a[130:131], v48 offset:36864
    buffer_load_dwordx4 v18, s[52:55], s82 offen offset:1024 lds
    s_waitcnt lgkmcnt(12)
    v_mfma_f32_16x16x32_bf16 v[104:107], a[168:171], a[76:79], v[104:107]
    ds_read_b64_tr_b16 a[132:133], v49 offset:32768
    ds_read_b64_tr_b16 a[134:135], v49 offset:36864
    s_waitcnt lgkmcnt(12)
    v_mfma_f32_16x16x32_bf16 v[108:111], a[172:175], a[76:79], v[108:111]
    ds_read_b64_tr_b16 a[136:137], v50 offset:32768
    ds_read_b64_tr_b16 a[138:139], v50 offset:36864
    s_waitcnt lgkmcnt(12)
    v_mfma_f32_16x16x32_bf16 v[112:115], a[176:179], a[76:79], v[112:115]
    ds_read_b64_tr_b16 a[140:141], v51 offset:32768
    ds_read_b64_tr_b16 a[142:143], v51 offset:36864
    s_mov_b32 s83, 1245184
    s_add_u32 m0, s3, 57344
    s_nop 0
    buffer_load_dwordx4 v17, s[52:55], s83 offen lds
    s_waitcnt lgkmcnt(12)
    v_mfma_f32_16x16x32_bf16 v[116:119], a[180:183], a[76:79], v[116:119]
    ds_read_b64_tr_b16 a[144:145], v52 offset:32768
    ds_read_b64_tr_b16 a[146:147], v52 offset:36864
    s_waitcnt lgkmcnt(12)
    v_mfma_f32_16x16x32_bf16 v[120:123], a[184:187], a[76:79], v[120:123]
    ds_read_b64_tr_b16 a[148:149], v53 offset:32768
    ds_read_b64_tr_b16 a[150:151], v53 offset:36864
    s_waitcnt lgkmcnt(12)
    v_mfma_f32_16x16x32_bf16 v[124:127], a[188:191], a[76:79], v[124:127]
    ds_read_b64_tr_b16 a[152:153], v54 offset:32768
    ds_read_b64_tr_b16 a[154:155], v54 offset:36864
    buffer_load_dwordx4 v18, s[52:55], s83 offen offset:1024 lds
    s_waitcnt vmcnt(59) lgkmcnt(12)
    v_mfma_f32_16x16x32_bf16 v[96:99], a[128:131], a[80:83], v[96:99]
    ds_read_b64_tr_b16 a[156:157], v55 offset:32768
    ds_read_b64_tr_b16 a[158:159], v55 offset:36864
    s_waitcnt lgkmcnt(12)
    v_mfma_f32_16x16x32_bf16 v[100:103], a[132:135], a[80:83], v[100:103]
    ds_read_b64_tr_b16 a[160:161], v48 offset:40960
    ds_read_b64_tr_b16 a[162:163], v48 offset:45056
    s_waitcnt lgkmcnt(12)
    v_mfma_f32_16x16x32_bf16 v[104:107], a[136:139], a[80:83], v[104:107]
    ds_read_b64_tr_b16 a[164:165], v49 offset:40960
    ds_read_b64_tr_b16 a[166:167], v49 offset:45056
    s_waitcnt lgkmcnt(12)
    v_mfma_f32_16x16x32_bf16 v[108:111], a[140:143], a[80:83], v[108:111]
    ds_read_b64_tr_b16 a[168:169], v50 offset:40960
    ds_read_b64_tr_b16 a[170:171], v50 offset:45056
    s_waitcnt lgkmcnt(12)
    v_mfma_f32_16x16x32_bf16 v[112:115], a[144:147], a[80:83], v[112:115]
    ds_read_b64_tr_b16 a[172:173], v51 offset:40960
    ds_read_b64_tr_b16 a[174:175], v51 offset:45056
    s_waitcnt lgkmcnt(12)
    v_mfma_f32_16x16x32_bf16 v[116:119], a[148:151], a[80:83], v[116:119]
    ds_read_b64_tr_b16 a[176:177], v52 offset:40960
    ds_read_b64_tr_b16 a[178:179], v52 offset:45056
    s_waitcnt lgkmcnt(12)
    v_mfma_f32_16x16x32_bf16 v[120:123], a[152:155], a[80:83], v[120:123]
    ds_read_b64_tr_b16 a[180:181], v53 offset:40960
    ds_read_b64_tr_b16 a[182:183], v53 offset:45056
    s_waitcnt lgkmcnt(12)
    v_mfma_f32_16x16x32_bf16 v[124:127], a[156:159], a[80:83], v[124:127]
    ds_read_b64_tr_b16 a[184:185], v54 offset:40960
    ds_read_b64_tr_b16 a[186:187], v54 offset:45056
    s_waitcnt vmcnt(58) lgkmcnt(12)
    v_mfma_f32_16x16x32_bf16 v[96:99], a[160:163], a[84:87], v[96:99]
    ds_read_b64_tr_b16 a[188:189], v55 offset:40960
    ds_read_b64_tr_b16 a[190:191], v55 offset:45056
    s_waitcnt lgkmcnt(12)
    v_mfma_f32_16x16x32_bf16 v[100:103], a[164:167], a[84:87], v[100:103]
    ds_read_b64_tr_b16 a[128:129], v48 offset:49152
    ds_read_b64_tr_b16 a[130:131], v48 offset:53248
    s_waitcnt lgkmcnt(12)
    v_mfma_f32_16x16x32_bf16 v[104:107], a[168:171], a[84:87], v[104:107]
    ds_read_b64_tr_b16 a[132:133], v49 offset:49152
    ds_read_b64_tr_b16 a[134:135], v49 offset:53248
    s_waitcnt lgkmcnt(12)
    v_mfma_f32_16x16x32_bf16 v[108:111], a[172:175], a[84:87], v[108:111]
    ds_read_b64_tr_b16 a[136:137], v50 offset:49152
    ds_read_b64_tr_b16 a[138:139], v50 offset:53248
    s_waitcnt lgkmcnt(12)
    v_mfma_f32_16x16x32_bf16 v[112:115], a[176:179], a[84:87], v[112:115]
    ds_read_b64_tr_b16 a[140:141], v51 offset:49152
    ds_read_b64_tr_b16 a[142:143], v51 offset:53248
    s_waitcnt lgkmcnt(12)
    v_mfma_f32_16x16x32_bf16 v[116:119], a[180:183], a[84:87], v[116:119]
    ds_read_b64_tr_b16 a[144:145], v52 offset:49152
    ds_read_b64_tr_b16 a[146:147], v52 offset:53248
    s_waitcnt lgkmcnt(12)
    v_mfma_f32_16x16x32_bf16 v[120:123], a[184:187], a[84:87], v[120:123]
    ds_read_b64_tr_b16 a[148:149], v53 offset:49152
    ds_read_b64_tr_b16 a[150:151], v53 offset:53248
    s_waitcnt lgkmcnt(12)
    v_mfma_f32_16x16x32_bf16 v[124:127], a[188:191], a[84:87], v[124:127]
    ds_read_b64_tr_b16 a[152:153], v54 offset:49152
    ds_read_b64_tr_b16 a[154:155], v54 offset:53248
    s_waitcnt vmcnt(23)
    s_barrier
    s_waitcnt lgkmcnt(12)
    v_mfma_f32_16x16x32_bf16 v[96:99], a[128:131], a[88:91], v[96:99]
    ds_read_b64_tr_b16 a[156:157], v55 offset:49152
    ds_read_b64_tr_b16 a[158:159], v55 offset:53248
    s_mov_b32 s82, 1310720
    s_add_u32 m0, s3, 65536
    s_nop 0
    buffer_load_dwordx4 v17, s[52:55], s82 offen lds
    s_waitcnt lgkmcnt(12)
    v_mfma_f32_16x16x32_bf16 v[100:103], a[132:135], a[88:91], v[100:103]
    ds_read_b64_tr_b16 a[160:161], v48 offset:57344
    ds_read_b64_tr_b16 a[162:163], v48 offset:61440
    s_waitcnt lgkmcnt(12)
    v_mfma_f32_16x16x32_bf16 v[104:107], a[136:139], a[88:91], v[104:107]
    ds_read_b64_tr_b16 a[164:165], v49 offset:57344
    ds_read_b64_tr_b16 a[166:167], v49 offset:61440
    s_waitcnt lgkmcnt(12)
    v_mfma_f32_16x16x32_bf16 v[108:111], a[140:143], a[88:91], v[108:111]
    ds_read_b64_tr_b16 a[168:169], v50 offset:57344
    ds_read_b64_tr_b16 a[170:171], v50 offset:61440
    buffer_load_dwordx4 v18, s[52:55], s82 offen offset:1024 lds
    s_waitcnt lgkmcnt(12)
    v_mfma_f32_16x16x32_bf16 v[112:115], a[144:147], a[88:91], v[112:115]
    ds_read_b64_tr_b16 a[172:173], v51 offset:57344
    ds_read_b64_tr_b16 a[174:175], v51 offset:61440
    s_waitcnt lgkmcnt(12)
    v_mfma_f32_16x16x32_bf16 v[116:119], a[148:151], a[88:91], v[116:119]
    ds_read_b64_tr_b16 a[176:177], v52 offset:57344
    ds_read_b64_tr_b16 a[178:179], v52 offset:61440
    s_waitcnt lgkmcnt(12)
    v_mfma_f32_16x16x32_bf16 v[120:123], a[152:155], a[88:91], v[120:123]
    ds_read_b64_tr_b16 a[180:181], v53 offset:57344
    ds_read_b64_tr_b16 a[182:183], v53 offset:61440
    s_mov_b32 s83, 1376256
    s_add_u32 m0, s3, 73728
    s_nop 0
    buffer_load_dwordx4 v17, s[52:55], s83 offen lds
    s_waitcnt lgkmcnt(12)
    v_mfma_f32_16x16x32_bf16 v[124:127], a[156:159], a[88:91], v[124:127]
    ds_read_b64_tr_b16 a[184:185], v54 offset:57344
    ds_read_b64_tr_b16 a[186:187], v54 offset:61440
    s_waitcnt lgkmcnt(12)
    v_mfma_f32_16x16x32_bf16 v[96:99], a[160:163], a[92:95], v[96:99]
    ds_read_b64_tr_b16 a[188:189], v55 offset:57344
    ds_read_b64_tr_b16 a[190:191], v55 offset:61440
    s_waitcnt vmcnt(11)
    s_mov_b64 exec, 1
    buffer_atomic_add v25, off, s[56:59], s77 sc1
    s_mov_b64 exec, -1
    s_waitcnt lgkmcnt(12)
    v_mfma_f32_16x16x32_bf16 v[100:103], a[164:167], a[92:95], v[100:103]
    ds_read_b64_tr_b16 a[128:129], v56 offset:0
    ds_read_b64_tr_b16 a[130:131], v56 offset:4096
    buffer_load_dwordx4 v18, s[52:55], s83 offen offset:1024 lds
    s_waitcnt lgkmcnt(12)
    v_mfma_f32_16x16x32_bf16 v[104:107], a[168:171], a[92:95], v[104:107]
    ds_read_b64_tr_b16 a[132:133], v57 offset:0
    ds_read_b64_tr_b16 a[134:135], v57 offset:4096
    s_waitcnt lgkmcnt(12)
    v_mfma_f32_16x16x32_bf16 v[108:111], a[172:175], a[92:95], v[108:111]
    ds_read_b64_tr_b16 a[136:137], v58 offset:0
    ds_read_b64_tr_b16 a[138:139], v58 offset:4096
    s_waitcnt lgkmcnt(12)
    v_mfma_f32_16x16x32_bf16 v[112:115], a[176:179], a[92:95], v[112:115]
    ds_read_b64_tr_b16 a[140:141], v59 offset:0
    ds_read_b64_tr_b16 a[142:143], v59 offset:4096
    s_mov_b32 s82, 1441792
    s_add_u32 m0, s3, 81920
    s_nop 0
    buffer_load_dwordx4 v17, s[52:55], s82 offen lds
    s_waitcnt lgkmcnt(12)
    v_mfma_f32_16x16x32_bf16 v[116:119], a[180:183], a[92:95], v[116:119]
    ds_read_b64_tr_b16 a[144:145], v60 offset:0
    ds_read_b64_tr_b16 a[146:147], v60 offset:4096
    s_waitcnt lgkmcnt(12)
    v_mfma_f32_16x16x32_bf16 v[120:123], a[184:187], a[92:95], v[120:123]
    ds_read_b64_tr_b16 a[148:149], v61 offset:0
    ds_read_b64_tr_b16 a[150:151], v61 offset:4096
    s_waitcnt lgkmcnt(12)
    v_mfma_f32_16x16x32_bf16 v[124:127], a[188:191], a[92:95], v[124:127]
    ds_read_b64_tr_b16 a[152:153], v62 offset:0
    ds_read_b64_tr_b16 a[154:155], v62 offset:4096
    buffer_load_dwordx4 v18, s[52:55], s82 offen offset:1024 lds
    s_waitcnt lgkmcnt(12)
    v_mfma_f32_16x16x32_bf16 v[96:99], a[128:131], a[96:99], v[96:99]
    ds_read_b64_tr_b16 a[156:157], v63 offset:0
    ds_read_b64_tr_b16 a[158:159], v63 offset:4096
    s_waitcnt lgkmcnt(12)
    v_mfma_f32_16x16x32_bf16 v[100:103], a[132:135], a[96:99], v[100:103]
    ds_read_b64_tr_b16 a[160:161], v56 offset:8192
    ds_read_b64_tr_b16 a[162:163], v56 offset:12288
    s_waitcnt lgkmcnt(12)
    v_mfma_f32_16x16x32_bf16 v[104:107], a[136:139], a[96:99], v[104:107]
    ds_read_b64_tr_b16 a[164:165], v57 offset:8192
    ds_read_b64_tr_b16 a[166:167], v57 offset:12288
    s_mov_b32 s83, 1507328
    s_add_u32 m0, s3, 90112
    s_nop 0
    buffer_load_dwordx4 v17, s[52:55], s83 offen lds
    s_waitcnt lgkmcnt(12)
    v_mfma_f32_16x16x32_bf16 v[108:111], a[140:143], a[96:99], v[108:111]
    ds_read_b64_tr_b16 a[168:169], v58 offset:8192
    ds_read_b64_tr_b16 a[170:171], v58 offset:12288
    s_waitcnt lgkmcnt(12)
    v_mfma_f32_16x16x32_bf16 v[112:115], a[144:147], a[96:99], v[112:115]
    ds_read_b64_tr_b16 a[172:173], v59 offset:8192
    ds_read_b64_tr_b16 a[174:175], v59 offset:12288
    s_waitcnt lgkmcnt(12)
    v_mfma_f32_16x16x32_bf16 v[116:119], a[148:151], a[96:99], v[116:119]
    ds_read_b64_tr_b16 a[176:177], v60 offset:8192
    ds_read_b64_tr_b16 a[178:179], v60 offset:12288
    buffer_load_dwordx4 v18, s[52:55], s83 offen offset:1024 lds
    s_waitcnt lgkmcnt(12)
    v_mfma_f32_16x16x32_bf16 v[120:123], a[152:155], a[96:99], v[120:123]
    ds_read_b64_tr_b16 a[180:181], v61 offset:8192
    ds_read_b64_tr_b16 a[182:183], v61 offset:12288
    s_waitcnt lgkmcnt(12)
    v_mfma_f32_16x16x32_bf16 v[124:127], a[156:159], a[96:99], v[124:127]
    ds_read_b64_tr_b16 a[184:185], v62 offset:8192
    ds_read_b64_tr_b16 a[186:187], v62 offset:12288
    s_waitcnt lgkmcnt(12)
    v_mfma_f32_16x16x32_bf16 v[96:99], a[160:163], a[100:103], v[96:99]
    ds_read_b64_tr_b16 a[188:189], v63 offset:8192
    ds_read_b64_tr_b16 a[190:191], v63 offset:12288
    s_mov_b32 s82, 1572864
    s_add_u32 m0, s3, 98304
    s_nop 0
    buffer_load_dwordx4 v17, s[52:55], s82 offen lds
    s_waitcnt lgkmcnt(12)
    v_mfma_f32_16x16x32_bf16 v[100:103], a[164:167], a[100:103], v[100:103]
    ds_read_b64_tr_b16 a[128:129], v56 offset:16384
    ds_read_b64_tr_b16 a[130:131], v56 offset:20480
    s_waitcnt lgkmcnt(12)
    v_mfma_f32_16x16x32_bf16 v[104:107], a[168:171], a[100:103], v[104:107]
    ds_read_b64_tr_b16 a[132:133], v57 offset:16384
    ds_read_b64_tr_b16 a[134:135], v57 offset:20480
    s_waitcnt lgkmcnt(12)
    v_mfma_f32_16x16x32_bf16 v[108:111], a[172:175], a[100:103], v[108:111]
    ds_read_b64_tr_b16 a[136:137], v58 offset:16384
    ds_read_b64_tr_b16 a[138:139], v58 offset:20480
    buffer_load_dwordx4 v18, s[52:55], s82 offen offset:1024 lds
    s_waitcnt lgkmcnt(12)
    v_mfma_f32_16x16x32_bf16 v[112:115], a[176:179], a[100:103], v[112:115]
    ds_read_b64_tr_b16 a[140:141], v59 offset:16384
    ds_read_b64_tr_b16 a[142:143], v59 offset:20480
    s_waitcnt lgkmcnt(12)
    v_mfma_f32_16x16x32_bf16 v[116:119], a[180:183], a[100:103], v[116:119]
    ds_read_b64_tr_b16 a[144:145], v60 offset:16384
    ds_read_b64_tr_b16 a[146:147], v60 offset:20480
    s_waitcnt lgkmcnt(12)
    v_mfma_f32_16x16x32_bf16 v[120:123], a[184:187], a[100:103], v[120:123]
    ds_read_b64_tr_b16 a[148:149], v61 offset:16384
    ds_read_b64_tr_b16 a[150:151], v61 offset:20480
    s_mov_b32 s83, 1638400
    s_add_u32 m0, s3, 106496
    s_nop 0
    buffer_load_dwordx4 v17, s[52:55], s83 offen lds
    s_waitcnt lgkmcnt(12)
    v_mfma_f32_16x16x32_bf16 v[124:127], a[188:191], a[100:103], v[124:127]
    ds_read_b64_tr_b16 a[152:153], v62 offset:16384
    ds_read_b64_tr_b16 a[154:155], v62 offset:20480
    s_waitcnt lgkmcnt(12)
    v_mfma_f32_16x16x32_bf16 v[96:99], a[128:131], a[104:107], v[96:99]
    ds_read_b64_tr_b16 a[156:157], v63 offset:16384
    ds_read_b64_tr_b16 a[158:159], v63 offset:20480
    s_waitcnt lgkmcnt(12)
    v_mfma_f32_16x16x32_bf16 v[100:103], a[132:135], a[104:107], v[100:103]
    ds_read_b64_tr_b16 a[160:161], v56 offset:24576
    ds_read_b64_tr_b16 a[162:163], v56 offset:28672
    buffer_load_dwordx4 v18, s[52:55], s83 offen offset:1024 lds
    s_waitcnt lgkmcnt(12)
    v_mfma_f32_16x16x32_bf16 v[104:107], a[136:139], a[104:107], v[104:107]
    ds_read_b64_tr_b16 a[164:165], v57 offset:24576
    ds_read_b64_tr_b16 a[166:167], v57 offset:28672
    s_waitcnt lgkmcnt(12)
    v_mfma_f32_16x16x32_bf16 v[108:111], a[140:143], a[104:107], v[108:111]
    ds_read_b64_tr_b16 a[168:169], v58 offset:24576
    ds_read_b64_tr_b16 a[170:171], v58 offset:28672
    s_waitcnt lgkmcnt(12)
    v_mfma_f32_16x16x32_bf16 v[112:115], a[144:147], a[104:107], v[112:115]
    ds_read_b64_tr_b16 a[172:173], v59 offset:24576
    ds_read_b64_tr_b16 a[174:175], v59 offset:28672
    s_waitcnt lgkmcnt(12)
    v_mfma_f32_16x16x32_bf16 v[116:119], a[148:151], a[104:107], v[116:119]
    ds_read_b64_tr_b16 a[176:177], v60 offset:24576
    ds_read_b64_tr_b16 a[178:179], v60 offset:28672
    s_branch L_over12
L_stub12:
    s_branch L_stub13
L_over12:
    s_waitcnt lgkmcnt(12)
    v_mfma_f32_16x16x32_bf16 v[120:123], a[152:155], a[104:107], v[120:123]
    ds_read_b64_tr_b16 a[180:181], v61 offset:24576
    ds_read_b64_tr_b16 a[182:183], v61 offset:28672
    s_waitcnt lgkmcnt(12)
    v_mfma_f32_16x16x32_bf16 v[124:127], a[156:159], a[104:107], v[124:127]
    ds_read_b64_tr_b16 a[184:185], v62 offset:24576
    ds_read_b64_tr_b16 a[186:187], v62 offset:28672
    s_waitcnt lgkmcnt(12)
    v_mfma_f32_16x16x32_bf16 v[96:99], a[160:163], a[108:111], v[96:99]
    ds_read_b64_tr_b16 a[188:189], v63 offset:24576
    ds_read_b64_tr_b16 a[190:191], v63 offset:28672
    s_waitcnt lgkmcnt(12)
    v_mfma_f32_16x16x32_bf16 v[100:103], a[164:167], a[108:111], v[100:103]
    ds_read_b64_tr_b16 a[128:129], v8 offset:0
    ds_read_b64_tr_b16 a[130:131], v8 offset:4096
    s_waitcnt lgkmcnt(12)
    v_mfma_f32_16x16x32_bf16 v[104:107], a[168:171], a[108:111], v[104:107]
    ds_read_b64_tr_b16 a[132:133], v9 offset:0
    ds_read_b64_tr_b16 a[134:135], v9 offset:4096
    s_waitcnt lgkmcnt(12)
    v_mfma_f32_16x16x32_bf16 v[108:111], a[172:175], a[108:111], v[108:111]
    ds_read_b64_tr_b16 a[136:137], v10 offset:0
    ds_read_b64_tr_b16 a[138:139], v10 offset:4096
    s_waitcnt lgkmcnt(12)
    v_mfma_f32_16x16x32_bf16 v[112:115], a[176:179], a[108:111], v[112:115]
    ds_read_b64_tr_b16 a[140:141], v11 offset:0
    ds_read_b64_tr_b16 a[142:143], v11 offset:4096
    s_waitcnt lgkmcnt(12)
    v_mfma_f32_16x16x32_bf16 v[116:119], a[180:183], a[108:111], v[116:119]
    ds_read_b64_tr_b16 a[144:145], v12 offset:0
    ds_read_b64_tr_b16 a[146:147], v12 offset:4096
    s_waitcnt lgkmcnt(12)
    v_mfma_f32_16x16x32_bf16 v[120:123], a[184:187], a[108:111], v[120:123]
    ds_read_b64_tr_b16 a[148:149], v13 offset:0
    ds_read_b64_tr_b16 a[150:151], v13 offset:4096
    s_waitcnt lgkmcnt(12)
    v_mfma_f32_16x16x32_bf16 v[124:127], a[188:191], a[108:111], v[124:127]
    ds_read_b64_tr_b16 a[152:153], v14 offset:0
    ds_read_b64_tr_b16 a[154:155], v14 offset:4096
    s_waitcnt lgkmcnt(12)
    v_mfma_f32_16x16x32_bf16 v[96:99], a[128:131], a[112:115], v[96:99]
    ds_read_b64_tr_b16 a[156:157], v15 offset:0
    ds_read_b64_tr_b16 a[158:159], v15 offset:4096
    s_waitcnt lgkmcnt(12)
    v_mfma_f32_16x16x32_bf16 v[100:103], a[132:135], a[112:115], v[100:103]
    ds_read_b64_tr_b16 a[160:161], v8 offset:8192
    ds_read_b64_tr_b16 a[162:163], v8 offset:12288
    s_waitcnt lgkmcnt(12)
    v_mfma_f32_16x16x32_bf16 v[104:107], a[136:139], a[112:115], v[104:107]
    ds_read_b64_tr_b16 a[164:165], v9 offset:8192
    ds_read_b64_tr_b16 a[166:167], v9 offset:12288
    s_waitcnt lgkmcnt(12)
    v_mfma_f32_16x16x32_bf16 v[108:111], a[140:143], a[112:115], v[108:111]
    ds_read_b64_tr_b16 a[168:169], v10 offset:8192
    ds_read_b64_tr_b16 a[170:171], v10 offset:12288
    s_waitcnt lgkmcnt(12)
    v_mfma_f32_16x16x32_bf16 v[112:115], a[144:147], a[112:115], v[112:115]
    ds_read_b64_tr_b16 a[172:173], v11 offset:8192
    ds_read_b64_tr_b16 a[174:175], v11 offset:12288
    s_waitcnt lgkmcnt(12)
    v_mfma_f32_16x16x32_bf16 v[116:119], a[148:151], a[112:115], v[116:119]
    ds_read_b64_tr_b16 a[176:177], v12 offset:8192
    ds_read_b64_tr_b16 a[178:179], v12 offset:12288
    s_waitcnt lgkmcnt(12)
    v_mfma_f32_16x16x32_bf16 v[120:123], a[152:155], a[112:115], v[120:123]
    ds_read_b64_tr_b16 a[180:181], v13 offset:8192
    ds_read_b64_tr_b16 a[182:183], v13 offset:12288
    s_waitcnt lgkmcnt(12)
    v_mfma_f32_16x16x32_bf16 v[124:127], a[156:159], a[112:115], v[124:127]
    ds_read_b64_tr_b16 a[184:185], v14 offset:8192
    ds_read_b64_tr_b16 a[186:187], v14 offset:12288
    s_waitcnt lgkmcnt(12)
    v_mfma_f32_16x16x32_bf16 v[96:99], a[160:163], a[116:119], v[96:99]
    ds_read_b64_tr_b16 a[188:189], v15 offset:8192
    ds_read_b64_tr_b16 a[190:191], v15 offset:12288
    s_waitcnt lgkmcnt(12)
    v_mfma_f32_16x16x32_bf16 v[100:103], a[164:167], a[116:119], v[100:103]
    ds_read_b64_tr_b16 a[128:129], v8 offset:16384
    ds_read_b64_tr_b16 a[130:131], v8 offset:20480
    s_waitcnt lgkmcnt(12)
    v_mfma_f32_16x16x32_bf16 v[104:107], a[168:171], a[116:119], v[104:107]
    ds_read_b64_tr_b16 a[132:133], v9 offset:16384
    ds_read_b64_tr_b16 a[134:135], v9 offset:20480
    s_waitcnt lgkmcnt(12)
    v_mfma_f32_16x16x32_bf16 v[108:111], a[172:175], a[116:119], v[108:111]
    ds_read_b64_tr_b16 a[136:137], v10 offset:16384
    ds_read_b64_tr_b16 a[138:139], v10 offset:20480
    s_waitcnt lgkmcnt(12)
    v_mfma_f32_16x16x32_bf16 v[112:115], a[176:179], a[116:119], v[112:115]
    ds_read_b64_tr_b16 a[140:141], v11 offset:16384
    ds_read_b64_tr_b16 a[142:143], v11 offset:20480
    s_waitcnt lgkmcnt(12)
    v_mfma_f32_16x16x32_bf16 v[116:119], a[180:183], a[116:119], v[116:119]
    ds_read_b64_tr_b16 a[144:145], v12 offset:16384
    ds_read_b64_tr_b16 a[146:147], v12 offset:20480
    s_waitcnt lgkmcnt(12)
    v_mfma_f32_16x16x32_bf16 v[120:123], a[184:187], a[116:119], v[120:123]
    ds_read_b64_tr_b16 a[148:149], v13 offset:16384
    ds_read_b64_tr_b16 a[150:151], v13 offset:20480
    s_waitcnt lgkmcnt(12)
    v_mfma_f32_16x16x32_bf16 v[124:127], a[188:191], a[116:119], v[124:127]
    ds_read_b64_tr_b16 a[152:153], v14 offset:16384
    ds_read_b64_tr_b16 a[154:155], v14 offset:20480
    s_waitcnt vmcnt(13)
    s_barrier
    s_waitcnt lgkmcnt(12)
    v_mfma_f32_16x16x32_bf16 v[96:99], a[128:131], a[120:123], v[96:99]
    ds_read_b64_tr_b16 a[156:157], v15 offset:16384
    ds_read_b64_tr_b16 a[158:159], v15 offset:20480
    s_mov_b32 s82, 1703936
    s_add_u32 m0, s3, 114688
    s_nop 0
    buffer_load_dwordx4 v17, s[52:55], s82 offen lds
    s_waitcnt lgkmcnt(12)
    v_mfma_f32_16x16x32_bf16 v[100:103], a[132:135], a[120:123], v[100:103]
    ds_read_b64_tr_b16 a[160:161], v8 offset:24576
    ds_read_b64_tr_b16 a[162:163], v8 offset:28672
    s_waitcnt lgkmcnt(12)
    v_mfma_f32_16x16x32_bf16 v[104:107], a[136:139], a[120:123], v[104:107]
    ds_read_b64_tr_b16 a[164:165], v9 offset:24576
    ds_read_b64_tr_b16 a[166:167], v9 offset:28672
    s_waitcnt lgkmcnt(12)
    v_mfma_f32_16x16x32_bf16 v[108:111], a[140:143], a[120:123], v[108:111]
    ds_read_b64_tr_b16 a[168:169], v10 offset:24576
    ds_read_b64_tr_b16 a[170:171], v10 offset:28672
    buffer_load_dwordx4 v18, s[52:55], s82 offen offset:1024 lds
    s_waitcnt lgkmcnt(12)
    v_mfma_f32_16x16x32_bf16 v[112:115], a[144:147], a[120:123], v[112:115]
    ds_read_b64_tr_b16 a[172:173], v11 offset:24576
    ds_read_b64_tr_b16 a[174:175], v11 offset:28672
    s_waitcnt lgkmcnt(12)
    v_mfma_f32_16x16x32_bf16 v[116:119], a[148:151], a[120:123], v[116:119]
    ds_read_b64_tr_b16 a[176:177], v12 offset:24576
    ds_read_b64_tr_b16 a[178:179], v12 offset:28672
    s_waitcnt lgkmcnt(12)
    v_mfma_f32_16x16x32_bf16 v[120:123], a[152:155], a[120:123], v[120:123]
    ds_read_b64_tr_b16 a[180:181], v13 offset:24576
    ds_read_b64_tr_b16 a[182:183], v13 offset:28672
    s_mov_b32 s83, 1769472
    s_add_u32 m0, s3, 122880
    s_nop 0
    buffer_load_dwordx4 v17, s[52:55], s83 offen lds
    s_waitcnt lgkmcnt(12)
    v_mfma_f32_16x16x32_bf16 v[124:127], a[156:159], a[120:123], v[124:127]
    ds_read_b64_tr_b16 a[184:185], v14 offset:24576
    ds_read_b64_tr_b16 a[186:187], v14 offset:28672
    s_waitcnt lgkmcnt(12)
    v_mfma_f32_16x16x32_bf16 v[96:99], a[160:163], a[124:127], v[96:99]
    ds_read_b64_tr_b16 a[188:189], v15 offset:24576
    ds_read_b64_tr_b16 a[190:191], v15 offset:28672
    buffer_load_dword v43, off, s[56:59], s77 sc1
    s_waitcnt lgkmcnt(12)
    v_mfma_f32_16x16x32_bf16 v[100:103], a[164:167], a[124:127], v[100:103]
    ds_read_b64_tr_b16 a[128:129], v8 offset:32768
    ds_read_b64_tr_b16 a[130:131], v8 offset:36864
    buffer_load_dwordx4 v18, s[52:55], s83 offen offset:1024 lds
    s_waitcnt lgkmcnt(12)
    v_mfma_f32_16x16x32_bf16 v[104:107], a[168:171], a[124:127], v[104:107]
    ds_read_b64_tr_b16 a[132:133], v9 offset:32768
    ds_read_b64_tr_b16 a[134:135], v9 offset:36864
    s_waitcnt lgkmcnt(12)
    v_mfma_f32_16x16x32_bf16 v[108:111], a[172:175], a[124:127], v[108:111]
    ds_read_b64_tr_b16 a[136:137], v10 offset:32768
    ds_read_b64_tr_b16 a[138:139], v10 offset:36864
    s_waitcnt lgkmcnt(12)
    v_mfma_f32_16x16x32_bf16 v[112:115], a[176:179], a[124:127], v[112:115]
    ds_read_b64_tr_b16 a[140:141], v11 offset:32768
    ds_read_b64_tr_b16 a[142:143], v11 offset:36864
    s_mov_b32 s82, 1835008
    s_add_u32 m0, s3, 131072
    s_nop 0
    buffer_load_dwordx4 v17, s[52:55], s82 offen lds
    s_waitcnt lgkmcnt(12)
    v_mfma_f32_16x16x32_bf16 v[116:119], a[180:183], a[124:127], v[116:119]
    ds_read_b64_tr_b16 a[144:145], v12 offset:32768
    ds_read_b64_tr_b16 a[146:147], v12 offset:36864
    s_waitcnt lgkmcnt(12)
    v_mfma_f32_16x16x32_bf16 v[120:123], a[184:187], a[124:127], v[120:123]
    ds_read_b64_tr_b16 a[148:149], v13 offset:32768
    ds_read_b64_tr_b16 a[150:151], v13 offset:36864
    s_waitcnt lgkmcnt(12)
    v_mfma_f32_16x16x32_bf16 v[124:127], a[188:191], a[124:127], v[124:127]
    ds_read_b64_tr_b16 a[152:153], v14 offset:32768
    ds_read_b64_tr_b16 a[154:155], v14 offset:36864
    buffer_load_dwordx4 v18, s[52:55], s82 offen offset:1024 lds
    s_waitcnt lgkmcnt(12)
    v_mfma_f32_16x16x32_bf16 v[96:99], a[128:131], a[0:3], v[96:99]
    ds_read_b64_tr_b16 a[156:157], v15 offset:32768
    ds_read_b64_tr_b16 a[158:159], v15 offset:36864
    s_waitcnt lgkmcnt(12)
    v_mfma_f32_16x16x32_bf16 v[100:103], a[132:135], a[0:3], v[100:103]
    ds_read_b64_tr_b16 a[160:161], v8 offset:40960
    ds_read_b64_tr_b16 a[162:163], v8 offset:45056
    s_waitcnt lgkmcnt(12)
    v_mfma_f32_16x16x32_bf16 v[104:107], a[136:139], a[0:3], v[104:107]
    ds_read_b64_tr_b16 a[164:165], v9 offset:40960
    ds_read_b64_tr_b16 a[166:167], v9 offset:45056
    s_mov_b32 s83, 1900544
    s_add_u32 m0, s3, 139264
    s_nop 0
    buffer_load_dwordx4 v17, s[52:55], s83 offen lds
    s_waitcnt lgkmcnt(12)
    v_mfma_f32_16x16x32_bf16 v[108:111], a[140:143], a[0:3], v[108:111]
    ds_read_b64_tr_b16 a[168:169], v10 offset:40960
    ds_read_b64_tr_b16 a[170:171], v10 offset:45056
    s_waitcnt lgkmcnt(12)
    v_mfma_f32_16x16x32_bf16 v[112:115], a[144:147], a[0:3], v[112:115]
    ds_read_b64_tr_b16 a[172:173], v11 offset:40960
    ds_read_b64_tr_b16 a[174:175], v11 offset:45056
    s_waitcnt lgkmcnt(12)
    v_mfma_f32_16x16x32_bf16 v[116:119], a[148:151], a[0:3], v[116:119]
    ds_read_b64_tr_b16 a[176:177], v12 offset:40960
    ds_read_b64_tr_b16 a[178:179], v12 offset:45056
    buffer_load_dwordx4 v18, s[52:55], s83 offen offset:1024 lds
    s_waitcnt lgkmcnt(12)
    v_mfma_f32_16x16x32_bf16 v[120:123], a[152:155], a[0:3], v[120:123]
    ds_read_b64_tr_b16 a[180:181], v13 offset:40960
    ds_read_b64_tr_b16 a[182:183], v13 offset:45056
    s_waitcnt lgkmcnt(12)
    v_mfma_f32_16x16x32_bf16 v[124:127], a[156:159], a[0:3], v[124:127]
    ds_read_b64_tr_b16 a[184:185], v14 offset:40960
    ds_read_b64_tr_b16 a[186:187], v14 offset:45056
    s_waitcnt lgkmcnt(12)
    v_mfma_f32_16x16x32_bf16 v[96:99], a[160:163], a[4:7], v[96:99]
    ds_read_b64_tr_b16 a[188:189], v15 offset:40960
    ds_read_b64_tr_b16 a[190:191], v15 offset:45056
    s_mov_b32 s82, 1966080
    s_add_u32 m0, s3, 147456
    s_nop 0
    buffer_load_dwordx4 v17, s[52:55], s82 offen lds
    s_waitcnt lgkmcnt(12)
    v_mfma_f32_16x16x32_bf16 v[100:103], a[164:167], a[4:7], v[100:103]
    ds_read_b64_tr_b16 a[128:129], v8 offset:49152
    ds_read_b64_tr_b16 a[130:131], v8 offset:53248
    s_waitcnt lgkmcnt(12)
    v_mfma_f32_16x16x32_bf16 v[104:107], a[168:171], a[4:7], v[104:107]
    ds_read_b64_tr_b16 a[132:133], v9 offset:49152
    ds_read_b64_tr_b16 a[134:135], v9 offset:53248
    s_waitcnt lgkmcnt(12)
    v_mfma_f32_16x16x32_bf16 v[108:111], a[172:175], a[4:7], v[108:111]
    ds_read_b64_tr_b16 a[136:137], v10 offset:49152
    ds_read_b64_tr_b16 a[138:139], v10 offset:53248
    buffer_load_dwordx4 v18, s[52:55], s82 offen offset:1024 lds
    s_waitcnt lgkmcnt(12)
    v_mfma_f32_16x16x32_bf16 v[112:115], a[176:179], a[4:7], v[112:115]
    ds_read_b64_tr_b16 a[140:141], v11 offset:49152
    ds_read_b64_tr_b16 a[142:143], v11 offset:53248
    s_waitcnt lgkmcnt(12)
    v_mfma_f32_16x16x32_bf16 v[116:119], a[180:183], a[4:7], v[116:119]
    ds_read_b64_tr_b16 a[144:145], v12 offset:49152
    ds_read_b64_tr_b16 a[146:147], v12 offset:53248
    s_waitcnt lgkmcnt(12)
    v_mfma_f32_16x16x32_bf16 v[120:123], a[184:187], a[4:7], v[120:123]
    ds_read_b64_tr_b16 a[148:149], v13 offset:49152
    ds_read_b64_tr_b16 a[150:151], v13 offset:53248
    s_mov_b32 s83, 2031616
    s_add_u32 m0, s3, 155648
    s_nop 0
    buffer_load_dwordx4 v17, s[52:55], s83 offen lds
    s_waitcnt lgkmcnt(12)
    v_mfma_f32_16x16x32_bf16 v[124:127], a[188:191], a[4:7], v[124:127]
    ds_read_b64_tr_b16 a[152:153], v14 offset:49152
    ds_read_b64_tr_b16 a[154:155], v14 offset:53248
    s_waitcnt vmcnt(12)
    s_barrier
    s_waitcnt lgkmcnt(12)
    v_mfma_f32_16x16x32_bf16 v[96:99], a[128:131], a[8:11], v[96:99]
    ds_read_b64_tr_b16 a[156:157], v15 offset:49152
    ds_read_b64_tr_b16 a[158:159], v15 offset:53248
    s_waitcnt lgkmcnt(12)
    v_mfma_f32_16x16x32_bf16 v[100:103], a[132:135], a[8:11], v[100:103]
    ds_read_b64_tr_b16 a[160:161], v8 offset:57344
    ds_read_b64_tr_b16 a[162:163], v8 offset:61440
    buffer_load_dwordx4 v18, s[52:55], s83 offen offset:1024 lds
    s_waitcnt lgkmcnt(12)
    v_mfma_f32_16x16x32_bf16 v[104:107], a[136:139], a[8:11], v[104:107]
    ds_read_b64_tr_b16 a[164:165], v9 offset:57344
    ds_read_b64_tr_b16 a[166:167], v9 offset:61440
    s_waitcnt lgkmcnt(12)
    v_mfma_f32_16x16x32_bf16 v[108:111], a[140:143], a[8:11], v[108:111]
    ds_read_b64_tr_b16 a[168:169], v10 offset:57344
    ds_read_b64_tr_b16 a[170:171], v10 offset:61440
    s_waitcnt lgkmcnt(12)
    v_mfma_f32_16x16x32_bf16 v[112:115], a[144:147], a[8:11], v[112:115]
    ds_read_b64_tr_b16 a[172:173], v11 offset:57344
    ds_read_b64_tr_b16 a[174:175], v11 offset:61440
    s_waitcnt lgkmcnt(12)
    v_mfma_f32_16x16x32_bf16 v[116:119], a[148:151], a[8:11], v[116:119]
    ds_read_b64_tr_b16 a[176:177], v12 offset:57344
    ds_read_b64_tr_b16 a[178:179], v12 offset:61440
    s_waitcnt lgkmcnt(12)
    v_mfma_f32_16x16x32_bf16 v[120:123], a[152:155], a[8:11], v[120:123]
    ds_read_b64_tr_b16 a[180:181], v13 offset:57344
    ds_read_b64_tr_b16 a[182:183], v13 offset:61440
    s_waitcnt lgkmcnt(12)
    v_mfma_f32_16x16x32_bf16 v[124:127], a[156:159], a[8:11], v[124:127]
    ds_read_b64_tr_b16 a[184:185], v14 offset:57344
    ds_read_b64_tr_b16 a[186:187], v14 offset:61440
    s_waitcnt lgkmcnt(12)
    v_mfma_f32_16x16x32_bf16 v[96:99], a[160:163], a[12:15], v[96:99]
    ds_read_b64_tr_b16 a[188:189], v15 offset:57344
    ds_read_b64_tr_b16 a[190:191], v15 offset:61440
    s_waitcnt lgkmcnt(12)
    v_mfma_f32_16x16x32_bf16 v[100:103], a[164:167], a[12:15], v[100:103]
    ds_read_b64_tr_b16 a[128:129], v48 offset:0
    ds_read_b64_tr_b16 a[130:131], v48 offset:4096
    s_waitcnt lgkmcnt(12)
    v_mfma_f32_16x16x32_bf16 v[104:107], a[168:171], a[12:15], v[104:107]
    ds_read_b64_tr_b16 a[132:133], v49 offset:0
    ds_read_b64_tr_b16 a[134:135], v49 offset:4096
    s_waitcnt lgkmcnt(12)
    v_mfma_f32_16x16x32_bf16 v[108:111], a[172:175], a[12:15], v[108:111]
    ds_read_b64_tr_b16 a[136:137], v50 offset:0
    ds_read_b64_tr_b16 a[138:139], v50 offset:4096
    s_waitcnt lgkmcnt(12)
    v_mfma_f32_16x16x32_bf16 v[112:115], a[176:179], a[12:15], v[112:115]
    ds_read_b64_tr_b16 a[140:141], v51 offset:0
    ds_read_b64_tr_b16 a[142:143], v51 offset:4096
    s_waitcnt lgkmcnt(12)
    v_mfma_f32_16x16x32_bf16 v[116:119], a[180:183], a[12:15], v[116:119]
    ds_read_b64_tr_b16 a[144:145], v52 offset:0
    ds_read_b64_tr_b16 a[146:147], v52 offset:4096
    s_waitcnt lgkmcnt(12)
    v_mfma_f32_16x16x32_bf16 v[120:123], a[184:187], a[12:15], v[120:123]
    ds_read_b64_tr_b16 a[148:149], v53 offset:0
    ds_read_b64_tr_b16 a[150:151], v53 offset:4096
    s_waitcnt lgkmcnt(12)
    v_mfma_f32_16x16x32_bf16 v[124:127], a[188:191], a[12:15], v[124:127]
    ds_read_b64_tr_b16 a[152:153], v54 offset:0
    ds_read_b64_tr_b16 a[154:155], v54 offset:4096
    s_waitcnt lgkmcnt(12)
    v_mfma_f32_16x16x32_bf16 v[96:99], a[128:131], a[16:19], v[96:99]
    ds_read_b64_tr_b16 a[156:157], v55 offset:0
    ds_read_b64_tr_b16 a[158:159], v55 offset:4096
    s_waitcnt vmcnt(9)
    v_readfirstlane_b32 s86, v43
    s_cmp_eq_u32 s86, 4
    s_cbranch_scc0 L_spP
L_okP:
    buffer_load_dwordx4 v[164:167], v16, s[56:59], s73 offen offset:0 sc1
    s_waitcnt lgkmcnt(12)
    v_mfma_f32_16x16x32_bf16 v[100:103], a[132:135], a[16:19], v[100:103]
    ds_read_b64_tr_b16 a[160:161], v48 offset:8192
    ds_read_b64_tr_b16 a[162:163], v48 offset:12288
    buffer_load_dwordx4 v[172:175], v16, s[56:59], s73 offen offset:1024 sc1
    s_waitcnt lgkmcnt(12)
    v_mfma_f32_16x16x32_bf16 v[104:107], a[136:139], a[16:19], v[104:107]
    ds_read_b64_tr_b16 a[164:165], v49 offset:8192
    ds_read_b64_tr_b16 a[166:167], v49 offset:12288
    buffer_load_dwordx4 v[180:183], v16, s[56:59], s73 offen offset:2048 sc1
    s_waitcnt lgkmcnt(12)
    v_mfma_f32_16x16x32_bf16 v[108:111], a[140:143], a[16:19], v[108:111]
    ds_read_b64_tr_b16 a[168:169], v50 offset:8192
    ds_read_b64_tr_b16 a[170:171], v50 offset:12288
    buffer_load_dwordx4 v[188:191], v16, s[56:59], s73 offen offset:3072 sc1
    s_waitcnt lgkmcnt(12)
    v_mfma_f32_16x16x32_bf16 v[112:115], a[144:147], a[16:19], v[112:115]
    ds_read_b64_tr_b16 a[172:173], v51 offset:8192
    ds_read_b64_tr_b16 a[174:175], v51 offset:12288
    buffer_load_dwordx4 v[196:199], v16, s[56:59], s74 offen offset:0 sc1
    s_waitcnt lgkmcnt(12)
    v_mfma_f32_16x16x32_bf16 v[116:119], a[148:151], a[16:19], v[116:119]
    ds_read_b64_tr_b16 a[176:177], v52 offset:8192
    ds_read_b64_tr_b16 a[178:179], v52 offset:12288
    buffer_load_dwordx4 v[204:207], v16, s[56:59], s74 offen offset:1024 sc1
    s_waitcnt lgkmcnt(12)
    v_mfma_f32_16x16x32_bf16 v[120:123], a[152:155], a[16:19], v[120:123]
    ds_read_b64_tr_b16 a[180:181], v53 offset:8192
    ds_read_b64_tr_b16 a[182:183], v53 offset:12288
    buffer_load_dwordx4 v[212:215], v16, s[56:59], s74 offen offset:2048 sc1
    s_waitcnt lgkmcnt(12)
    v_mfma_f32_16x16x32_bf16 v[124:127], a[156:159], a[16:19], v[124:127]
    ds_read_b64_tr_b16 a[184:185], v54 offset:8192
    ds_read_b64_tr_b16 a[186:187], v54 offset:12288
    buffer_load_dwordx4 v[220:223], v16, s[56:59], s74 offen offset:3072 sc1
    s_waitcnt lgkmcnt(12)
    v_mfma_f32_16x16x32_bf16 v[96:99], a[160:163], a[20:23], v[96:99]
    ds_read_b64_tr_b16 a[188:189], v55 offset:8192
    ds_read_b64_tr_b16 a[190:191], v55 offset:12288
    buffer_load_dwordx4 v[228:231], v16, s[56:59], s75 offen offset:0 sc1
    s_waitcnt lgkmcnt(12)
    v_mfma_f32_16x16x32_bf16 v[100:103], a[164:167], a[20:23], v[100:103]
    ds_read_b64_tr_b16 a[128:129], v48 offset:16384
    ds_read_b64_tr_b16 a[130:131], v48 offset:20480
    buffer_load_dwordx4 v[236:239], v16, s[56:59], s75 offen offset:1024 sc1
    s_waitcnt lgkmcnt(12)
    v_mfma_f32_16x16x32_bf16 v[104:107], a[168:171], a[20:23], v[104:107]
    ds_read_b64_tr_b16 a[132:133], v49 offset:16384
    ds_read_b64_tr_b16 a[134:135], v49 offset:20480
    buffer_load_dwordx4 v[244:247], v16, s[56:59], s75 offen offset:2048 sc1
    s_waitcnt lgkmcnt(12)
    v_mfma_f32_16x16x32_bf16 v[108:111], a[172:175], a[20:23], v[108:111]
    ds_read_b64_tr_b16 a[136:137], v50 offset:16384
    ds_read_b64_tr_b16 a[138:139], v50 offset:20480
    buffer_load_dwordx4 v[252:255], v16, s[56:59], s75 offen offset:3072 sc1
    s_waitcnt lgkmcnt(12)
    v_mfma_f32_16x16x32_bf16 v[112:115], a[176:179], a[20:23], v[112:115]
    ds_read_b64_tr_b16 a[140:141], v51 offset:16384
    ds_read_b64_tr_b16 a[142:143], v51 offset:20480
    s_waitcnt lgkmcnt(12)
    v_mfma_f32_16x16x32_bf16 v[116:119], a[180:183], a[20:23], v[116:119]
    ds_read_b64_tr_b16 a[144:145], v52 offset:16384
    ds_read_b64_tr_b16 a[146:147], v52 offset:20480
    s_waitcnt lgkmcnt(12)
    v_mfma_f32_16x16x32_bf16 v[120:123], a[184:187], a[20:23], v[120:123]
    ds_read_b64_tr_b16 a[148:149], v53 offset:16384
    ds_read_b64_tr_b16 a[150:151], v53 offset:20480
    s_waitcnt lgkmcnt(12)
    v_mfma_f32_16x16x32_bf16 v[124:127], a[188:191], a[20:23], v[124:127]
    ds_read_b64_tr_b16 a[152:153], v54 offset:16384
    ds_read_b64_tr_b16 a[154:155], v54 offset:20480
    s_waitcnt lgkmcnt(12)
    v_mfma_f32_16x16x32_bf16 v[96:99], a[128:131], a[24:27], v[96:99]
    ds_read_b64_tr_b16 a[156:157], v55 offset:16384
    ds_read_b64_tr_b16 a[158:159], v55 offset:20480
    s_waitcnt lgkmcnt(12)
    v_mfma_f32_16x16x32_bf16 v[100:103], a[132:135], a[24:27], v[100:103]
    ds_read_b64_tr_b16 a[160:161], v48 offset:24576
    ds_read_b64_tr_b16 a[162:163], v48 offset:28672
    s_waitcnt lgkmcnt(12)
    v_mfma_f32_16x16x32_bf16 v[104:107], a[136:139], a[24:27], v[104:107]
    ds_read_b64_tr_b16 a[164:165], v49 offset:24576
    ds_read_b64_tr_b16 a[166:167], v49 offset:28672
    s_waitcnt lgkmcnt(12)
    v_mfma_f32_16x16x32_bf16 v[108:111], a[140:143], a[24:27], v[108:111]
    ds_read_b64_tr_b16 a[168:169], v50 offset:24576
    ds_read_b64_tr_b16 a[170:171], v50 offset:28672
    s_waitcnt lgkmcnt(12)
    v_mfma_f32_16x16x32_bf16 v[112:115], a[144:147], a[24:27], v[112:115]
    ds_read_b64_tr_b16 a[172:173], v51 offset:24576
    ds_read_b64_tr_b16 a[174:175], v51 offset:28672
    s_waitcnt lgkmcnt(12)
    v_mfma_f32_16x16x32_bf16 v[116:119], a[148:151], a[24:27], v[116:119]
    ds_read_b64_tr_b16 a[176:177], v52 offset:24576
    ds_read_b64_tr_b16 a[178:179], v52 offset:28672
    s_waitcnt lgkmcnt(12)
    v_mfma_f32_16x16x32_bf16 v[120:123], a[152:155], a[24:27], v[120:123]
    ds_read_b64_tr_b16 a[180:181], v53 offset:24576
    ds_read_b64_tr_b16 a[182:183], v53 offset:28672
    s_waitcnt lgkmcnt(12)
    v_mfma_f32_16x16x32_bf16 v[124:127], a[156:159], a[24:27], v[124:127]
    ds_read_b64_tr_b16 a[184:185], v54 offset:24576
    ds_read_b64_tr_b16 a[186:187], v54 offset:28672
    s_waitcnt lgkmcnt(12)
    v_mfma_f32_16x16x32_bf16 v[96:99], a[160:163], a[28:31], v[96:99]
    ds_read_b64_tr_b16 a[188:189], v55 offset:24576
    ds_read_b64_tr_b16 a[190:191], v55 offset:28672
    s_waitcnt lgkmcnt(12)
    v_mfma_f32_16x16x32_bf16 v[100:103], a[164:167], a[28:31], v[100:103]
    ds_read_b64_tr_b16 a[128:129], v48 offset:32768
    ds_read_b64_tr_b16 a[130:131], v48 offset:36864
    s_waitcnt lgkmcnt(12)
    v_mfma_f32_16x16x32_bf16 v[104:107], a[168:171], a[28:31], v[104:107]
    ds_read_b64_tr_b16 a[132:133], v49 offset:32768
    ds_read_b64_tr_b16 a[134:135], v49 offset:36864
    s_waitcnt lgkmcnt(12)
    v_mfma_f32_16x16x32_bf16 v[108:111], a[172:175], a[28:31], v[108:111]
    ds_read_b64_tr_b16 a[136:137], v50 offset:32768
    ds_read_b64_tr_b16 a[138:139], v50 offset:36864
    s_waitcnt lgkmcnt(12)
    v_mfma_f32_16x16x32_bf16 v[112:115], a[176:179], a[28:31], v[112:115]
    ds_read_b64_tr_b16 a[140:141], v51 offset:32768
    ds_read_b64_tr_b16 a[142:143], v51 offset:36864
    s_waitcnt lgkmcnt(12)
    v_mfma_f32_16x16x32_bf16 v[116:119], a[180:183], a[28:31], v[116:119]
    ds_read_b64_tr_b16 a[144:145], v52 offset:32768
    ds_read_b64_tr_b16 a[146:147], v52 offset:36864
    s_waitcnt lgkmcnt(12)
    v_mfma_f32_16x16x32_bf16 v[120:123], a[184:187], a[28:31], v[120:123]
    ds_read_b64_tr_b16 a[148:149], v53 offset:32768
    ds_read_b64_tr_b16 a[150:151], v53 offset:36864
    s_waitcnt lgkmcnt(12)
    v_mfma_f32_16x16x32_bf16 v[124:127], a[188:191], a[28:31], v[124:127]
    ds_read_b64_tr_b16 a[152:153], v54 offset:32768
    ds_read_b64_tr_b16 a[154:155], v54 offset:36864
    s_waitcnt vmcnt(12)
    s_barrier
    s_waitcnt lgkmcnt(12)
    v_mfma_f32_16x16x32_bf16 v[96:99], a[128:131], a[32:35], v[96:99]
    ds_read_b64_tr_b16 a[156:157], v55 offset:32768
    ds_read_b64_tr_b16 a[158:159], v55 offset:36864
    s_waitcnt lgkmcnt(12)
    v_mfma_f32_16x16x32_bf16 v[100:103], a[132:135], a[32:35], v[100:103]
    ds_read_b64_tr_b16 a[160:161], v48 offset:40960
    ds_read_b64_tr_b16 a[162:163], v48 offset:45056
    s_waitcnt lgkmcnt(12)
    v_mfma_f32_16x16x32_bf16 v[104:107], a[136:139], a[32:35], v[104:107]
    ds_read_b64_tr_b16 a[164:165], v49 offset:40960
    ds_read_b64_tr_b16 a[166:167], v49 offset:45056
    s_waitcnt lgkmcnt(12)
    v_mfma_f32_16x16x32_bf16 v[108:111], a[140:143], a[32:35], v[108:111]
    ds_read_b64_tr_b16 a[168:169], v50 offset:40960
    ds_read_b64_tr_b16 a[170:171], v50 offset:45056
    s_waitcnt lgkmcnt(12)
    v_mfma_f32_16x16x32_bf16 v[112:115], a[144:147], a[32:35], v[112:115]
    ds_read_b64_tr_b16 a[172:173], v51 offset:40960
    ds_read_b64_tr_b16 a[174:175], v51 offset:45056
    s_waitcnt lgkmcnt(12)
    v_mfma_f32_16x16x32_bf16 v[116:119], a[148:151], a[32:35], v[116:119]
    ds_read_b64_tr_b16 a[176:177], v52 offset:40960
    ds_read_b64_tr_b16 a[178:179], v52 offset:45056
    s_waitcnt lgkmcnt(12)
    v_mfma_f32_16x16x32_bf16 v[120:123], a[152:155], a[32:35], v[120:123]
    ds_read_b64_tr_b16 a[180:181], v53 offset:40960
    ds_read_b64_tr_b16 a[182:183], v53 offset:45056
    s_waitcnt lgkmcnt(12)
    v_mfma_f32_16x16x32_bf16 v[124:127], a[156:159], a[32:35], v[124:127]
    ds_read_b64_tr_b16 a[184:185], v54 offset:40960
    ds_read_b64_tr_b16 a[186:187], v54 offset:45056
    s_waitcnt lgkmcnt(12)
    v_mfma_f32_16x16x32_bf16 v[96:99], a[160:163], a[36:39], v[96:99]
    ds_read_b64_tr_b16 a[188:189], v55 offset:40960
    ds_read_b64_tr_b16 a[190:191], v55 offset:45056
    s_waitcnt lgkmcnt(12)
    v_mfma_f32_16x16x32_bf16 v[100:103], a[164:167], a[36:39], v[100:103]
    ds_read_b64_tr_b16 a[128:129], v48 offset:49152
    ds_read_b64_tr_b16 a[130:131], v48 offset:53248
    s_waitcnt lgkmcnt(12)
    v_mfma_f32_16x16x32_bf16 v[104:107], a[168:171], a[36:39], v[104:107]
    ds_read_b64_tr_b16 a[132:133], v49 offset:49152
    ds_read_b64_tr_b16 a[134:135], v49 offset:53248
    s_waitcnt lgkmcnt(12)
    v_mfma_f32_16x16x32_bf16 v[108:111], a[172:175], a[36:39], v[108:111]
    ds_read_b64_tr_b16 a[136:137], v50 offset:49152
    ds_read_b64_tr_b16 a[138:139], v50 offset:53248
    s_waitcnt lgkmcnt(12)
    v_mfma_f32_16x16x32_bf16 v[112:115], a[176:179], a[36:39], v[112:115]
    ds_read_b64_tr_b16 a[140:141], v51 offset:49152
    ds_read_b64_tr_b16 a[142:143], v51 offset:53248
    s_waitcnt lgkmcnt(12)
    v_mfma_f32_16x16x32_bf16 v[116:119], a[180:183], a[36:39], v[116:119]
    ds_read_b64_tr_b16 a[144:145], v52 offset:49152
    ds_read_b64_tr_b16 a[146:147], v52 offset:53248
    s_waitcnt lgkmcnt(12)
    v_mfma_f32_16x16x32_bf16 v[120:123], a[184:187], a[36:39], v[120:123]
    ds_read_b64_tr_b16 a[148:149], v53 offset:49152
    ds_read_b64_tr_b16 a[150:151], v53 offset:53248
    s_waitcnt lgkmcnt(12)
    v_mfma_f32_16x16x32_bf16 v[124:127], a[188:191], a[36:39], v[124:127]
    ds_read_b64_tr_b16 a[152:153], v54 offset:49152
    ds_read_b64_tr_b16 a[154:155], v54 offset:53248
    s_waitcnt lgkmcnt(12)
    v_mfma_f32_16x16x32_bf16 v[96:99], a[128:131], a[40:43], v[96:99]
    ds_read_b64_tr_b16 a[156:157], v55 offset:49152
    ds_read_b64_tr_b16 a[158:159], v55 offset:53248
    s_waitcnt lgkmcnt(12)
    v_mfma_f32_16x16x32_bf16 v[100:103], a[132:135], a[40:43], v[100:103]
    ds_read_b64_tr_b16 a[160:161], v48 offset:57344
    ds_read_b64_tr_b16 a[162:163], v48 offset:61440
    s_waitcnt lgkmcnt(12)
    v_mfma_f32_16x16x32_bf16 v[104:107], a[136:139], a[40:43], v[104:107]
    ds_read_b64_tr_b16 a[164:165], v49 offset:57344
    ds_read_b64_tr_b16 a[166:167], v49 offset:61440
    s_waitcnt lgkmcnt(12)
    v_mfma_f32_16x16x32_bf16 v[108:111], a[140:143], a[40:43], v[108:111]
    ds_read_b64_tr_b16 a[168:169], v50 offset:57344
    ds_read_b64_tr_b16 a[170:171], v50 offset:61440
    s_waitcnt lgkmcnt(12)
    v_mfma_f32_16x16x32_bf16 v[112:115], a[144:147], a[40:43], v[112:115]
    ds_read_b64_tr_b16 a[172:173], v51 offset:57344
    ds_read_b64_tr_b16 a[174:175], v51 offset:61440
    s_waitcnt lgkmcnt(12)
    v_mfma_f32_16x16x32_bf16 v[116:119], a[148:151], a[40:43], v[116:119]
    ds_read_b64_tr_b16 a[176:177], v52 offset:57344
    ds_read_b64_tr_b16 a[178:179], v52 offset:61440
    s_waitcnt lgkmcnt(12)
    v_mfma_f32_16x16x32_bf16 v[120:123], a[152:155], a[40:43], v[120:123]
    ds_read_b64_tr_b16 a[180:181], v53 offset:57344
    ds_read_b64_tr_b16 a[182:183], v53 offset:61440
    s_waitcnt lgkmcnt(12)
    v_mfma_f32_16x16x32_bf16 v[124:127], a[156:159], a[40:43], v[124:127]
    ds_read_b64_tr_b16 a[184:185], v54 offset:57344
    ds_read_b64_tr_b16 a[186:187], v54 offset:61440
    s_waitcnt lgkmcnt(12)
    v_mfma_f32_16x16x32_bf16 v[96:99], a[160:163], a[44:47], v[96:99]
    ds_read_b64_tr_b16 a[188:189], v55 offset:57344
    ds_read_b64_tr_b16 a[190:191], v55 offset:61440
    s_waitcnt lgkmcnt(12)
    v_mfma_f32_16x16x32_bf16 v[100:103], a[164:167], a[44:47], v[100:103]
    ds_read_b64_tr_b16 a[128:129], v56 offset:0
    ds_read_b64_tr_b16 a[130:131], v56 offset:4096
    s_waitcnt lgkmcnt(12)
    v_mfma_f32_16x16x32_bf16 v[104:107], a[168:171], a[44:47], v[104:107]
    ds_read_b64_tr_b16 a[132:133], v57 offset:0
    ds_read_b64_tr_b16 a[134:135], v57 offset:4096
    s_waitcnt lgkmcnt(12)
    s_branch L_over13
L_stub13:
    s_branch L_stubret
L_over13:
    v_mfma_f32_16x16x32_bf16 v[108:111], a[172:175], a[44:47], v[108:111]
    ds_read_b64_tr_b16 a[136:137], v58 offset:0
    ds_read_b64_tr_b16 a[138:139], v58 offset:4096
    s_waitcnt lgkmcnt(12)
    v_mfma_f32_16x16x32_bf16 v[112:115], a[176:179], a[44:47], v[112:115]
    ds_read_b64_tr_b16 a[140:141], v59 offset:0
    ds_read_b64_tr_b16 a[142:143], v59 offset:4096
    s_waitcnt lgkmcnt(12)
    v_mfma_f32_16x16x32_bf16 v[116:119], a[180:183], a[44:47], v[116:119]
    ds_read_b64_tr_b16 a[144:145], v60 offset:0
    ds_read_b64_tr_b16 a[146:147], v60 offset:4096
    s_waitcnt lgkmcnt(12)
    v_mfma_f32_16x16x32_bf16 v[120:123], a[184:187], a[44:47], v[120:123]
    ds_read_b64_tr_b16 a[148:149], v61 offset:0
    ds_read_b64_tr_b16 a[150:151], v61 offset:4096
    s_waitcnt lgkmcnt(12)
    v_mfma_f32_16x16x32_bf16 v[124:127], a[188:191], a[44:47], v[124:127]
    ds_read_b64_tr_b16 a[152:153], v62 offset:0
    ds_read_b64_tr_b16 a[154:155], v62 offset:4096
    s_waitcnt lgkmcnt(12)
    v_mfma_f32_16x16x32_bf16 v[96:99], a[128:131], a[48:51], v[96:99]
    ds_read_b64_tr_b16 a[156:157], v63 offset:0
    ds_read_b64_tr_b16 a[158:159], v63 offset:4096
    s_waitcnt lgkmcnt(12)
    v_mfma_f32_16x16x32_bf16 v[100:103], a[132:135], a[48:51], v[100:103]
    ds_read_b64_tr_b16 a[160:161], v56 offset:8192
    ds_read_b64_tr_b16 a[162:163], v56 offset:12288
    s_waitcnt lgkmcnt(12)
    v_mfma_f32_16x16x32_bf16 v[104:107], a[136:139], a[48:51], v[104:107]
    ds_read_b64_tr_b16 a[164:165], v57 offset:8192
    ds_read_b64_tr_b16 a[166:167], v57 offset:12288
    s_waitcnt lgkmcnt(12)
    v_mfma_f32_16x16x32_bf16 v[108:111], a[140:143], a[48:51], v[108:111]
    ds_read_b64_tr_b16 a[168:169], v58 offset:8192
    ds_read_b64_tr_b16 a[170:171], v58 offset:12288
    s_waitcnt lgkmcnt(12)
    v_mfma_f32_16x16x32_bf16 v[112:115], a[144:147], a[48:51], v[112:115]
    ds_read_b64_tr_b16 a[172:173], v59 offset:8192
    ds_read_b64_tr_b16 a[174:175], v59 offset:12288
    s_waitcnt lgkmcnt(12)
    v_mfma_f32_16x16x32_bf16 v[116:119], a[148:151], a[48:51], v[116:119]
    ds_read_b64_tr_b16 a[176:177], v60 offset:8192
    ds_read_b64_tr_b16 a[178:179], v60 offset:12288
    s_waitcnt lgkmcnt(12)
    v_mfma_f32_16x16x32_bf16 v[120:123], a[152:155], a[48:51], v[120:123]
    ds_read_b64_tr_b16 a[180:181], v61 offset:8192
    ds_read_b64_tr_b16 a[182:183], v61 offset:12288
    s_waitcnt lgkmcnt(12)
    v_mfma_f32_16x16x32_bf16 v[124:127], a[156:159], a[48:51], v[124:127]
    ds_read_b64_tr_b16 a[184:185], v62 offset:8192
    ds_read_b64_tr_b16 a[186:187], v62 offset:12288
    s_waitcnt lgkmcnt(12)
    v_mfma_f32_16x16x32_bf16 v[96:99], a[160:163], a[52:55], v[96:99]
    ds_read_b64_tr_b16 a[188:189], v63 offset:8192
    ds_read_b64_tr_b16 a[190:191], v63 offset:12288
    s_waitcnt lgkmcnt(12)
    v_mfma_f32_16x16x32_bf16 v[100:103], a[164:167], a[52:55], v[100:103]
    ds_read_b64_tr_b16 a[128:129], v56 offset:16384
    ds_read_b64_tr_b16 a[130:131], v56 offset:20480
    s_waitcnt lgkmcnt(12)
    v_mfma_f32_16x16x32_bf16 v[104:107], a[168:171], a[52:55], v[104:107]
    ds_read_b64_tr_b16 a[132:133], v57 offset:16384
    ds_read_b64_tr_b16 a[134:135], v57 offset:20480
    s_waitcnt lgkmcnt(12)
    v_mfma_f32_16x16x32_bf16 v[108:111], a[172:175], a[52:55], v[108:111]
    ds_read_b64_tr_b16 a[136:137], v58 offset:16384
    ds_read_b64_tr_b16 a[138:139], v58 offset:20480
    s_waitcnt lgkmcnt(12)
    v_mfma_f32_16x16x32_bf16 v[112:115], a[176:179], a[52:55], v[112:115]
    ds_read_b64_tr_b16 a[140:141], v59 offset:16384
    ds_read_b64_tr_b16 a[142:143], v59 offset:20480
    s_waitcnt lgkmcnt(12)
    v_mfma_f32_16x16x32_bf16 v[116:119], a[180:183], a[52:55], v[116:119]
    ds_read_b64_tr_b16 a[144:145], v60 offset:16384
    ds_read_b64_tr_b16 a[146:147], v60 offset:20480
    s_waitcnt lgkmcnt(12)
    v_mfma_f32_16x16x32_bf16 v[120:123], a[184:187], a[52:55], v[120:123]
    ds_read_b64_tr_b16 a[148:149], v61 offset:16384
    ds_read_b64_tr_b16 a[150:151], v61 offset:20480
    s_waitcnt lgkmcnt(12)
    v_mfma_f32_16x16x32_bf16 v[124:127], a[188:191], a[52:55], v[124:127]
    ds_read_b64_tr_b16 a[152:153], v62 offset:16384
    ds_read_b64_tr_b16 a[154:155], v62 offset:20480
    s_waitcnt lgkmcnt(12)
    v_mfma_f32_16x16x32_bf16 v[96:99], a[128:131], a[56:59], v[96:99]
    ds_read_b64_tr_b16 a[156:157], v63 offset:16384
    ds_read_b64_tr_b16 a[158:159], v63 offset:20480
    s_waitcnt lgkmcnt(12)
    v_mfma_f32_16x16x32_bf16 v[100:103], a[132:135], a[56:59], v[100:103]
    ds_read_b64_tr_b16 a[160:161], v56 offset:24576
    ds_read_b64_tr_b16 a[162:163], v56 offset:28672
    s_waitcnt lgkmcnt(12)
    v_mfma_f32_16x16x32_bf16 v[104:107], a[136:139], a[56:59], v[104:107]
    ds_read_b64_tr_b16 a[164:165], v57 offset:24576
    ds_read_b64_tr_b16 a[166:167], v57 offset:28672
    s_waitcnt lgkmcnt(12)
    v_mfma_f32_16x16x32_bf16 v[108:111], a[140:143], a[56:59], v[108:111]
    ds_read_b64_tr_b16 a[168:169], v58 offset:24576
    ds_read_b64_tr_b16 a[170:171], v58 offset:28672
    s_waitcnt lgkmcnt(12)
    v_mfma_f32_16x16x32_bf16 v[112:115], a[144:147], a[56:59], v[112:115]
    ds_read_b64_tr_b16 a[172:173], v59 offset:24576
    ds_read_b64_tr_b16 a[174:175], v59 offset:28672
    s_waitcnt lgkmcnt(12)
    v_mfma_f32_16x16x32_bf16 v[116:119], a[148:151], a[56:59], v[116:119]
    ds_read_b64_tr_b16 a[176:177], v60 offset:24576
    ds_read_b64_tr_b16 a[178:179], v60 offset:28672
    s_waitcnt lgkmcnt(12)
    v_mfma_f32_16x16x32_bf16 v[120:123], a[152:155], a[56:59], v[120:123]
    ds_read_b64_tr_b16 a[180:181], v61 offset:24576
    ds_read_b64_tr_b16 a[182:183], v61 offset:28672
    s_waitcnt lgkmcnt(12)
    v_mfma_f32_16x16x32_bf16 v[124:127], a[156:159], a[56:59], v[124:127]
    ds_read_b64_tr_b16 a[184:185], v62 offset:24576
    ds_read_b64_tr_b16 a[186:187], v62 offset:28672
    s_waitcnt lgkmcnt(12)
    v_mfma_f32_16x16x32_bf16 v[96:99], a[160:163], a[60:63], v[96:99]
    ds_read_b64_tr_b16 a[188:189], v63 offset:24576
    ds_read_b64_tr_b16 a[190:191], v63 offset:28672
    s_waitcnt lgkmcnt(12)
    v_mfma_f32_16x16x32_bf16 v[100:103], a[164:167], a[60:63], v[100:103]
    s_waitcnt lgkmcnt(10)
    v_mfma_f32_16x16x32_bf16 v[104:107], a[168:171], a[60:63], v[104:107]
    s_waitcnt lgkmcnt(8)
    v_mfma_f32_16x16x32_bf16 v[108:111], a[172:175], a[60:63], v[108:111]
    s_waitcnt lgkmcnt(6)
    v_mfma_f32_16x16x32_bf16 v[112:115], a[176:179], a[60:63], v[112:115]
    s_waitcnt lgkmcnt(4)
    v_mfma_f32_16x16x32_bf16 v[116:119], a[180:183], a[60:63], v[116:119]
    s_waitcnt lgkmcnt(2)
    v_mfma_f32_16x16x32_bf16 v[120:123], a[184:187], a[60:63], v[120:123]
    s_waitcnt lgkmcnt(0)
    v_mfma_f32_16x16x32_bf16 v[124:127], a[188:191], a[60:63], v[124:127]
    s_waitcnt vmcnt(11)
    v_mfma_f32_16x16x32_bf16 v[128:131], v[28:31], v[164:167], v[128:131]
    v_mfma_f32_16x16x32_bf16 v[132:135], v[26:29], v[164:167], v[132:135]
    s_waitcnt vmcnt(10)
    v_mfma_f32_16x16x32_bf16 v[136:139], v[28:31], v[172:175], v[136:139]
    v_mfma_f32_16x16x32_bf16 v[140:143], v[26:29], v[172:175], v[140:143]
    s_waitcnt vmcnt(9)
    v_mfma_f32_16x16x32_bf16 v[144:147], v[28:31], v[180:183], v[144:147]
    v_mfma_f32_16x16x32_bf16 v[148:151], v[26:29], v[180:183], v[148:151]
    s_waitcnt vmcnt(8)
    v_mfma_f32_16x16x32_bf16 v[152:155], v[28:31], v[188:191], v[152:155]
    v_mfma_f32_16x16x32_bf16 v[156:159], v[26:29], v[188:191], v[156:159]
    s_waitcnt vmcnt(7)
    v_mfma_f32_16x16x32_bf16 v[128:131], v[28:31], v[196:199], v[128:131]
    v_mfma_f32_16x16x32_bf16 v[132:135], v[26:29], v[196:199], v[132:135]
    s_waitcnt vmcnt(6)
    v_mfma_f32_16x16x32_bf16 v[136:139], v[28:31], v[204:207], v[136:139]
    v_mfma_f32_16x16x32_bf16 v[140:143], v[26:29], v[204:207], v[140:143]
    s_waitcnt vmcnt(5)
    v_mfma_f32_16x16x32_bf16 v[144:147], v[28:31], v[212:215], v[144:147]
    v_mfma_f32_16x16x32_bf16 v[148:151], v[26:29], v[212:215], v[148:151]
    s_waitcnt vmcnt(4)
    v_mfma_f32_16x16x32_bf16 v[152:155], v[28:31], v[220:223], v[152:155]
    v_mfma_f32_16x16x32_bf16 v[156:159], v[26:29], v[220:223], v[156:159]
    s_waitcnt vmcnt(3)
    v_mfma_f32_16x16x32_bf16 v[128:131], v[28:31], v[228:231], v[128:131]
    v_mfma_f32_16x16x32_bf16 v[132:135], v[26:29], v[228:231], v[132:135]
    s_waitcnt vmcnt(2)
    v_mfma_f32_16x16x32_bf16 v[136:139], v[28:31], v[236:239], v[136:139]
    v_mfma_f32_16x16x32_bf16 v[140:143], v[26:29], v[236:239], v[140:143]
    s_waitcnt vmcnt(1)
    v_mfma_f32_16x16x32_bf16 v[144:147], v[28:31], v[244:247], v[144:147]
    v_mfma_f32_16x16x32_bf16 v[148:151], v[26:29], v[244:247], v[148:151]
    s_waitcnt vmcnt(0)
    v_mfma_f32_16x16x32_bf16 v[152:155], v[28:31], v[252:255], v[152:155]
    v_mfma_f32_16x16x32_bf16 v[156:159], v[26:29], v[252:255], v[156:159]
    v_pk_mul_f32 v[34:35], v[128:129], s[14:15]
    v_pk_mul_f32 v[36:37], v[130:131], s[14:15]
    v_pk_mul_f32 v[38:39], v[132:133], s[14:15]
    v_pk_mul_f32 v[40:41], v[134:135], s[14:15]
    v_exp_f32 v34, v34
    v_exp_f32 v35, v35
    v_exp_f32 v36, v36
    v_exp_f32 v37, v37
    v_exp_f32 v38, v38
    v_exp_f32 v39, v39
    v_exp_f32 v40, v40
    v_exp_f32 v41, v41
    v_pk_mul_f32 v[96:97], v[96:97], v[128:129]
    v_pk_mul_f32 v[98:99], v[98:99], v[130:131]
    v_pk_mul_f32 v[100:101], v[100:101], v[132:133]
    v_pk_mul_f32 v[102:103], v[102:103], v[134:135]
    v_pk_add_f32 v[34:35], v[34:35], 1.0 op_sel_hi:[1,0]
    v_pk_add_f32 v[36:37], v[36:37], 1.0 op_sel_hi:[1,0]
    v_pk_add_f32 v[38:39], v[38:39], 1.0 op_sel_hi:[1,0]
    v_pk_add_f32 v[40:41], v[40:41], 1.0 op_sel_hi:[1,0]
    v_rcp_f32 v34, v34
    v_rcp_f32 v35, v35
    v_rcp_f32 v36, v36
    v_rcp_f32 v37, v37
    v_rcp_f32 v38, v38
    v_rcp_f32 v39, v39
    v_rcp_f32 v40, v40
    v_rcp_f32 v41, v41
    v_pk_fma_f32 v[96:97], v[96:97], v[34:35], v[64:65]
    v_pk_fma_f32 v[98:99], v[98:99], v[36:37], v[66:67]
    v_pk_fma_f32 v[100:101], v[100:101], v[38:39], v[68:69]
    v_pk_fma_f32 v[102:103], v[102:103], v[40:41], v[70:71]
    v_cvt_pk_bf16_f32 v96, v96, v97
    v_cvt_pk_bf16_f32 v97, v98, v99
    v_cvt_pk_bf16_f32 v98, v100, v101
    v_cvt_pk_bf16_f32 v99, v102, v103
    s_nop 0
    v_permlane16_swap_b32 v96, v98
    v_permlane16_swap_b32 v97, v99
    global_store_dwordx4 v2, v[96:99], s[22:23] offset:0 sc1
    v_pk_mul_f32 v[34:35], v[136:137], s[14:15]
    v_pk_mul_f32 v[36:37], v[138:139], s[14:15]
    v_pk_mul_f32 v[38:39], v[140:141], s[14:15]
    v_pk_mul_f32 v[40:41], v[142:143], s[14:15]
    v_exp_f32 v34, v34
    v_exp_f32 v35, v35
    v_exp_f32 v36, v36
    v_exp_f32 v37, v37
    v_exp_f32 v38, v38
    v_exp_f32 v39, v39
    v_exp_f32 v40, v40
    v_exp_f32 v41, v41
    v_pk_mul_f32 v[104:105], v[104:105], v[136:137]
    v_pk_mul_f32 v[106:107], v[106:107], v[138:139]
    v_pk_mul_f32 v[108:109], v[108:109], v[140:141]
    v_pk_mul_f32 v[110:111], v[110:111], v[142:143]
    v_pk_add_f32 v[34:35], v[34:35], 1.0 op_sel_hi:[1,0]
    v_pk_add_f32 v[36:37], v[36:37], 1.0 op_sel_hi:[1,0]
    v_pk_add_f32 v[38:39], v[38:39], 1.0 op_sel_hi:[1,0]
    v_pk_add_f32 v[40:41], v[40:41], 1.0 op_sel_hi:[1,0]
    v_rcp_f32 v34, v34
    v_rcp_f32 v35, v35
    v_rcp_f32 v36, v36
    v_rcp_f32 v37, v37
    v_rcp_f32 v38, v38
    v_rcp_f32 v39, v39
    v_rcp_f32 v40, v40
    v_rcp_f32 v41, v41
    v_pk_fma_f32 v[104:105], v[104:105], v[34:35], v[72:73]
    v_pk_fma_f32 v[106:107], v[106:107], v[36:37], v[74:75]
    v_pk_fma_f32 v[108:109], v[108:109], v[38:39], v[76:77]
    v_pk_fma_f32 v[110:111], v[110:111], v[40:41], v[78:79]
    v_cvt_pk_bf16_f32 v104, v104, v105
    v_cvt_pk_bf16_f32 v105, v106, v107
    v_cvt_pk_bf16_f32 v106, v108, v109
    v_cvt_pk_bf16_f32 v107, v110, v111
    s_nop 0
    v_permlane16_swap_b32 v104, v106
    v_permlane16_swap_b32 v105, v107
    global_store_dwordx4 v2, v[104:107], s[22:23] offset:64 sc1
    v_pk_mul_f32 v[34:35], v[144:145], s[14:15]
    v_pk_mul_f32 v[36:37], v[146:147], s[14:15]
    v_pk_mul_f32 v[38:39], v[148:149], s[14:15]
    v_pk_mul_f32 v[40:41], v[150:151], s[14:15]
    v_exp_f32 v34, v34
    v_exp_f32 v35, v35
    v_exp_f32 v36, v36
    v_exp_f32 v37, v37
    v_exp_f32 v38, v38
    v_exp_f32 v39, v39
    v_exp_f32 v40, v40
    v_exp_f32 v41, v41
    v_pk_mul_f32 v[112:113], v[112:113], v[144:145]
    v_pk_mul_f32 v[114:115], v[114:115], v[146:147]
    v_pk_mul_f32 v[116:117], v[116:117], v[148:149]
    v_pk_mul_f32 v[118:119], v[118:119], v[150:151]
    v_pk_add_f32 v[34:35], v[34:35], 1.0 op_sel_hi:[1,0]
    v_pk_add_f32 v[36:37], v[36:37], 1.0 op_sel_hi:[1,0]
    v_pk_add_f32 v[38:39], v[38:39], 1.0 op_sel_hi:[1,0]
    v_pk_add_f32 v[40:41], v[40:41], 1.0 op_sel_hi:[1,0]
    v_rcp_f32 v34, v34
    v_rcp_f32 v35, v35
    v_rcp_f32 v36, v36
    v_rcp_f32 v37, v37
    v_rcp_f32 v38, v38
    v_rcp_f32 v39, v39
    v_rcp_f32 v40, v40
    v_rcp_f32 v41, v41
    v_pk_fma_f32 v[112:113], v[112:113], v[34:35], v[80:81]
    v_pk_fma_f32 v[114:115], v[114:115], v[36:37], v[82:83]
    v_pk_fma_f32 v[116:117], v[116:117], v[38:39], v[84:85]
    v_pk_fma_f32 v[118:119], v[118:119], v[40:41], v[86:87]
    v_cvt_pk_bf16_f32 v112, v112, v113
    v_cvt_pk_bf16_f32 v113, v114, v115
    v_cvt_pk_bf16_f32 v114, v116, v117
    v_cvt_pk_bf16_f32 v115, v118, v119
    s_nop 0
    v_permlane16_swap_b32 v112, v114
    v_permlane16_swap_b32 v113, v115
    global_store_dwordx4 v2, v[112:115], s[22:23] offset:128 sc1
    v_pk_mul_f32 v[34:35], v[152:153], s[14:15]
    v_pk_mul_f32 v[36:37], v[154:155], s[14:15]
    v_pk_mul_f32 v[38:39], v[156:157], s[14:15]
    v_pk_mul_f32 v[40:41], v[158:159], s[14:15]
    v_exp_f32 v34, v34
    v_exp_f32 v35, v35
    v_exp_f32 v36, v36
    v_exp_f32 v37, v37
    v_exp_f32 v38, v38
    v_exp_f32 v39, v39
    v_exp_f32 v40, v40
    v_exp_f32 v41, v41
    v_pk_mul_f32 v[120:121], v[120:121], v[152:153]
    v_pk_mul_f32 v[122:123], v[122:123], v[154:155]
    v_pk_mul_f32 v[124:125], v[124:125], v[156:157]
    v_pk_mul_f32 v[126:127], v[126:127], v[158:159]
    v_pk_add_f32 v[34:35], v[34:35], 1.0 op_sel_hi:[1,0]
    v_pk_add_f32 v[36:37], v[36:37], 1.0 op_sel_hi:[1,0]
    v_pk_add_f32 v[38:39], v[38:39], 1.0 op_sel_hi:[1,0]
    v_pk_add_f32 v[40:41], v[40:41], 1.0 op_sel_hi:[1,0]
    v_rcp_f32 v34, v34
    v_rcp_f32 v35, v35
    v_rcp_f32 v36, v36
    v_rcp_f32 v37, v37
    v_rcp_f32 v38, v38
    v_rcp_f32 v39, v39
    v_rcp_f32 v40, v40
    v_rcp_f32 v41, v41
    v_pk_fma_f32 v[120:121], v[120:121], v[34:35], v[88:89]
    v_pk_fma_f32 v[122:123], v[122:123], v[36:37], v[90:91]
    v_pk_fma_f32 v[124:125], v[124:125], v[38:39], v[92:93]
    v_pk_fma_f32 v[126:127], v[126:127], v[40:41], v[94:95]
    v_cvt_pk_bf16_f32 v120, v120, v121
    v_cvt_pk_bf16_f32 v121, v122, v123
    v_cvt_pk_bf16_f32 v122, v124, v125
    v_cvt_pk_bf16_f32 v123, v126, v127
    s_nop 0
    v_permlane16_swap_b32 v120, v122
    v_permlane16_swap_b32 v121, v123
    global_store_dwordx4 v2, v[120:123], s[22:23] offset:192 sc1
L_end:
    s_endpgm
L_spA0:
    buffer_load_dword v43, off, s[56:59], s92 sc1
    s_waitcnt vmcnt(0)
    v_readfirstlane_b32 s86, v43
    s_bfe_u32 s86, s86, 0x80000
    s_cmp_eq_u32 s86, 32
    s_cbranch_scc1 L_okA0
    s_add_u32 s67, s67, 1
    s_cmp_lt_u32 s67, 0x40000
    s_cbranch_scc1 L_spA0
    s_branch L_okA0
L_spA1:
    buffer_load_dword v43, off, s[56:59], s92 sc1
    s_waitcnt vmcnt(0)
    v_readfirstlane_b32 s86, v43
    s_bfe_u32 s86, s86, 0x80000
    s_cmp_eq_u32 s86, 32
    s_cbranch_scc1 L_okA1
    s_add_u32 s67, s67, 1
    s_cmp_lt_u32 s67, 0x40000
    s_cbranch_scc1 L_spA1
    s_branch L_okA1
L_spB:
    buffer_load_dword v43, off, s[56:59], s92 sc1
    s_waitcnt vmcnt(0)
    v_readfirstlane_b32 s86, v43
    s_bfe_u32 s86, s86, 0x80008
    s_cmp_eq_u32 s86, 16
    s_cbranch_scc1 L_okB
    s_add_u32 s67, s67, 1
    s_cmp_lt_u32 s67, 0x40000
    s_cbranch_scc1 L_spB
    s_branch L_okB
L_spC:
    buffer_load_dword v43, off, s[56:59], s92 sc1
    s_waitcnt vmcnt(0)
    v_readfirstlane_b32 s86, v43
    s_bfe_u32 s86, s86, 0x80010
    s_cmp_eq_u32 s86, 16
    s_cbranch_scc1 L_okC
    s_add_u32 s67, s67, 1
    s_cmp_lt_u32 s67, 0x40000
    s_cbranch_scc1 L_spC
    s_branch L_okC
L_spO:
    buffer_load_dword v43, off, s[56:59], s76 sc1
    s_waitcnt vmcnt(0)
    v_readfirstlane_b32 s86, v43
    s_cmp_eq_u32 s86, 64
    s_cbranch_scc1 L_okO
    s_add_u32 s67, s67, 1
    s_cmp_lt_u32 s67, 0x40000
    s_cbranch_scc1 L_spO
    s_branch L_okO
L_spP:
    buffer_load_dword v43, off, s[56:59], s77 sc1
    s_waitcnt vmcnt(0)
    v_readfirstlane_b32 s86, v43
    s_cmp_eq_u32 s86, 4
    s_cbranch_scc1 L_okP
    s_add_u32 s67, s67, 1
    s_cmp_lt_u32 s67, 0x40000
    s_cbranch_scc1 L_spP
    s_branch L_okP
L_code_end:
.section .rodata,"a"
.p2align 6
.amdhsa_kernel recurrent_scan__sliding_local_dilated__glu_gated_geglu__prompt_kernel
  .amdhsa_next_free_vgpr 512
  .amdhsa_next_free_sgpr 102
  .amdhsa_accum_offset 256
  .amdhsa_group_segment_fixed_size 0
  .amdhsa_kernarg_size 80
  .amdhsa_user_sgpr_count 2
  .amdhsa_user_sgpr_kernarg_segment_ptr 1
  .amdhsa_system_sgpr_workgroup_id_x 1
.end_amdhsa_kernel
```

```asm
; @launch grid=(256,1,1) block=(256,1,1) lds=163840
.amdgcn_target "amdgcn-amd-amdhsa--gfx950"
.text
.p2align 8
.globl recurrent_scan__sliding_local_dilated__glu_gated_geglu__prompt_kernel
.type recurrent_scan__sliding_local_dilated__glu_gated_geglu__prompt_kernel,@function
recurrent_scan__sliding_local_dilated__glu_gated_geglu__prompt_kernel:
    s_cmp_ge_u32 s2, 256
    s_cbranch_scc1 L_end
    s_load_dwordx16 s[8:23], s[0:1], 0
    s_load_dwordx4 s[24:27], s[0:1], 64
    v_lshrrev_b32 v1, 6, v0
    v_and_b32 v0, 63, v0
    v_readfirstlane_b32 s60, v1
    s_getpc_b64 s[86:87]
L_pc:
    s_lshr_b32 s82, s2, 3
    s_lshl_b32 s82, s82, 2
    s_add_u32 s82, s82, s60
    s_lshl_b32 s82, s82, 10
    v_lshl_add_u32 v2, v0, 4, s82
    v_min_u32 v2, L_code_end-L_pc-4, v2
    global_load_dword v7, v2, s[86:87]
    s_and_b32 s82, s2, 7
    s_lshr_b32 s83, s2, 3
    s_lshr_b32 s65, s82, 1
    s_and_b32 s63, s82, 1
    s_lshl_b32 s63, s63, 2
    s_and_b32 s84, s83, 3
    s_add_u32 s63, s63, s84
    s_lshr_b32 s66, s83, 2
    s_lshl_b32 s64, s65, 3
    s_add_u32 s64, s64, s66
    s_lshr_b32 s61, s60, 1
    s_and_b32 s62, s60, 1
    v_lshlrev_b32 v16, 4, v0
    s_lshl_b32 s84, s64, 2
    s_add_u32 s84, s84, s60
    s_lshl_b32 s85, s63, 7
    s_add_u32 s84, s84, s85
    s_lshl_b32 s85, s84, 12
    v_add_u32 v36, s85, v16
    s_lshl_b32 s84, s84, 2
    s_add_u32 s84, s84, 39845888
    v_mov_b32 v37, s84
    s_waitcnt lgkmcnt(0)
    global_load_dwordx4 v[48:51], v36, s[8:9] offset:0 nt
    global_load_dwordx4 v[52:55], v36, s[8:9] offset:1024 nt
    global_load_dwordx4 v[56:59], v36, s[8:9] offset:2048 nt
    global_load_dwordx4 v[60:63], v36, s[8:9] offset:3072 nt
    s_lshl_b32 s84, s63, 9
    s_lshl_b32 s85, s61, 8
    s_add_u32 s85, s85, s84
    s_sub_u32 s84, s84, 32
    s_max_i32 s84, s84, 0
    s_cmp_eq_u32 s62, 0
    s_cselect_b32 s85, s85, s84
    s_cselect_b32 s84, 63, 7
    s_add_u32 s85, s85, 39845888
    v_and_b32 v38, s84, v0
    v_lshlrev_b32 v38, 2, v38
    v_add_u32 v38, s85, v38
    global_load_dword v39, v38, s[26:27] sc1
    global_load_dword v40, v37, s[26:27] sc1
    v_lshlrev_b32 v2, 6, v0
    v_sub_u32 v2, v2, v16
    v_add_u32 v2, v2, v36
    s_sub_u32 s84, s63, s62
    s_max_i32 s84, s84, 0
    s_lshl_b32 s84, s84, 5
    v_mov_b32 v41, s84
    s_mov_b32 s56, s26
    s_and_b32 s57, s27, 0xffff
    s_mov_b32 s58, 0x10000000
    s_mov_b32 s59, 0x20000
    s_lshl_b32 s84, s63, 2
    s_add_u32 s84, s84, s65
    s_lshl_b32 s92, s84, 8
    s_add_u32 s92, s92, 39849984
    s_mul_i32 s88, s84, 458752
    s_add_u32 s88, s88, 8388608
    s_lshl_b32 s93, s63, 8
    s_add_u32 s93, s93, 39858176
    s_cmp_lg_u32 s60, 3
    s_cbranch_scc1 L_nozero
    s_lshl_b32 s84, s63, 3
    s_add_u32 s84, s84, s66
    s_lshl_b32 s84, s84, 2
    s_add_u32 s84, s84, s65
    s_lshl_b32 s84, s84, 8
    s_add_u32 s84, s84, 39862272
    v_mov_b32 v2, s84
    v_writelane_b32 v2, s92, 1
    v_writelane_b32 v2, s93, 2
    s_cmp_eq_u32 s66, 0
    s_cselect_b32 s84, 3, 1
    s_cmp_eq_u32 s64, 0
    s_cselect_b32 s84, 7, s84
    v_mov_b32 v3, 0
    s_mov_b32 exec_hi, 0
    s_mov_b32 exec_lo, s84
    global_store_dword v2, v3, s[26:27] sc1
    s_mov_b64 exec, -1
L_nozero:
    v_lshrrev_b32 v20, 2, v0
    v_and_b32 v21, 3, v0
    v_lshrrev_b32 v22, 4, v0
    v_and_b32 v23, 15, v0
    v_lshrrev_b32 v24, 3, v20
    v_lshlrev_b32 v24, 1, v24
    v_xor_b32 v24, v21, v24
    v_mul_u32_u24 v2, 6144, v20
    v_lshl_add_u32 v2, v24, 4, v2
    v_mul_u32_u24 v25, 7168, v20
    v_lshl_add_u32 v3, v24, 4, v25
    s_mul_i32 s84, s61, 98304
    s_lshl_b32 s85, s64, 6
    s_add_u32 s84, s84, s85
    s_add_u32 s32, s10, s84
    s_addc_u32 s33, s11, 0
    s_sub_u32 s32, s32, 4096
    s_subb_u32 s33, s33, 0
    s_and_b32 s33, s33, 0xffff
    s_sub_u32 s34, 6295552, s84
    s_mov_b32 s35, 0x20000
    s_mul_i32 s84, s61, 114688
    s_mul_i32 s85, s64, 224
    s_add_u32 s84, s84, s85
    s_add_u32 s36, s16, s84
    s_addc_u32 s37, s17, 0
    s_sub_u32 s36, s36, 4096
    s_subb_u32 s37, s37, 0
    s_and_b32 s37, s37, 0xffff
    s_sub_u32 s38, 7344128, s84
    s_mov_b32 s39, 0x20000
    s_add_u32 s40, s18, s84
    s_addc_u32 s41, s19, 0
    s_sub_u32 s40, s40, 4096
    s_subb_u32 s41, s41, 0
    s_and_b32 s41, s41, 0xffff
    s_sub_u32 s42, 7344128, s84
    s_mov_b32 s43, 0x20000
    v_cmp_lt_u32 vcc, 1, v24
    v_and_b32 v24, 1, v24
    v_lshl_add_u32 v24, v24, 4, v25
    v_add_u32 v24, 3264, v24
    v_mov_b32 v25, 0
    s_add_u32 s82, s16, s84
    s_addc_u32 s83, s17, 0
    s_sub_u32 s82, s82, 4096
    s_subb_u32 s83, s83, 0
    v_lshl_add_u64 v[4:5], v[24:25], 0, s[82:83]
    s_add_u32 s82, s18, s84
    s_addc_u32 s83, s19, 0
    s_sub_u32 s82, s82, 4096
    s_subb_u32 s83, s83, 0
    v_lshl_add_u64 v[24:25], v[24:25], 0, s[82:83]
    v_cndmask_b32 v4, v4, v24, vcc
    v_cndmask_b32 v5, v5, v25, vcc
    s_mov_b32 s80, 229376
    s_mov_b32 s81, 0
    s_cmp_eq_u32 s62, 1
    s_cbranch_scc1 L_init1
    s_lshl_b32 s78, s61, 14
    s_mov_b32 s68, 4096
    s_mov_b32 s69, 19456
    s_mov_b32 s70, 34816
    s_mov_b32 s71, 50176
    s_mov_b32 s72, 69632
    s_mov_b32 s73, 84992
    s_mov_b32 s74, 100352
    s_mov_b32 s75, 115712
    s_lshl_b32 s84, s63, 1
    s_add_u32 s84, s84, s61
    s_lshl_b32 s84, s84, 18
    s_branch L_init2
L_init1:
    s_mul_i32 s78, s61, 10240
    s_add_u32 s78, s78, 69632
    s_mov_b32 s68, 6144
    s_mov_b32 s69, 7168
    s_mov_b32 s70, 2048
    s_mov_b32 s71, 1024
    s_mov_b32 s72, 4096
    s_mov_b32 s73, 3136
    s_mov_b32 s74, 2112
    s_mov_b32 s75, 1152
    s_mov_b32 s76, 4224
    s_mov_b32 s14, 151552
    s_cmp_eq_u32 s61, 0
    s_cselect_b32 s15, 67584, s14
    s_cselect_b32 s14, 32768, s14
    s_lshl_b32 s84, s63, 19
    s_sub_u32 s84, s84, 32768
    s_max_i32 s84, s84, 0
L_init2:
    s_add_u32 s28, s26, s84
    s_addc_u32 s29, s27, 0
    s_sub_u32 s28, s28, 4096
    s_subb_u32 s29, s29, 0
    s_and_b32 s29, s29, 0xffff
    s_sub_u32 s30, 4198400, s84
    s_mov_b32 s31, 0x20000
    v_lshrrev_b32 v24, 3, v0
    v_and_b32 v25, 6, v24
    v_and_b32 v1, 7, v0
    v_xor_b32 v25, v25, v1
    v_lshlrev_b32 v25, 4, v25
    v_lshl_add_u32 v1, v24, 11, v25
    s_cmp_eq_u32 s63, 0
    s_cselect_b32 s84, 1, 3
    s_and_b32 s85, s60, s84
    s_cmp_eq_u32 s85, s84
    s_cselect_b32 s85, 0x40000000, 0
    s_cselect_b32 s87, 1, 0
    v_add_u32 v1, s85, v1
    s_lshr_b32 s83, s2, 3
    v_lshrrev_b32 v24, 3, v0
    v_and_b32 v25, 7, v0
    s_lshr_b32 s84, s63, 2
    s_lshl_b32 s84, s84, 4
    s_lshr_b32 s85, s83, 1
    s_add_u32 s84, s84, s85
    s_and_b32 s83, s83, 1
    s_cmp_eq_u32 s60, 0
    s_cbranch_scc1 L_pf0
    s_cmp_eq_u32 s60, 1
    s_cselect_b32 s44, s16, s18
    s_cselect_b32 s45, s17, s19
    s_cmp_eq_u32 s60, 3
    s_cselect_b32 s46, 0, 7340032
    s_mov_b32 s79, 229376
    s_mul_i32 s84, s84, 7168
    s_lshl_b32 s85, s65, 1
    s_add_u32 s85, s85, s83
    s_mul_i32 s85, s85, 896
    s_add_u32 s84, s84, s85
    v_cmp_gt_u32 vcc, 7, v25
    v_lshlrev_b32 v25, 7, v25
    s_branch L_pfd
L_pf0:
    s_mov_b32 s44, s10
    s_mov_b32 s45, s11
    s_mov_b32 s46, 6291456
    s_mov_b32 s79, 196608
    s_mul_i32 s84, s84, 6144
    s_lshl_b32 s85, s65, 1
    s_add_u32 s85, s85, s83
    s_lshl_b32 s85, s85, 8
    s_add_u32 s84, s84, s85
    v_cmp_gt_u32 vcc, 6, v25
    v_and_b32 v6, 1, v25
    v_lshrrev_b32 v25, 1, v25
    v_lshlrev_b32 v25, 11, v25
    v_lshl_add_u32 v25, v6, 7, v25
L_pfd:
    v_add_u32 v25, s84, v25
    v_mov_b32 v6, 0x40000000
    v_cndmask_b32 v25, v6, v25, vcc
    v_mul_lo_u32 v42, v24, s79
    v_add_u32 v42, v42, v25
    s_lshr_b32 s84, s79, 1
    s_sub_u32 s85, 0, s84
    s_cmp_lt_u32 s63, 4
    s_cselect_b32 s84, s84, s85
    s_mul_i32 s85, s79, 6
    s_sub_u32 s84, s84, s85
    v_add_u32 v25, s84, v42
    v_cmp_gt_u32 vcc, 4, v24
    s_nop 1
    v_cndmask_b32 v6, v6, v25, vcc
    v_cmp_gt_u32 vcc, 2, v24
    s_nop 1
    v_cndmask_b32 v6, v6, v42, vcc
    s_mul_i32 s84, s79, 8
    v_add_u32 v6, s84, v6
    s_lshl_b32 s86, s79, 3
    s_mul_i32 s79, s79, 2
    s_lshr_b32 s84, s2, 3
    s_and_b32 s84, s84, 0
    s_cmp_eq_u32 s84, 0
    s_cselect_b32 s4, 0, 0x40000000
    s_lshl_b32 s84, s63, 4
    s_add_u32 s84, s84, s65
    s_lshl_b32 s84, s84, 15
    s_lshl_b32 s85, s66, 8
    s_add_u32 s84, s84, s85
    s_add_u32 s48, s8, s84
    s_addc_u32 s49, s9, 0
    s_mov_b32 s50, 424192
    s_mov_b32 s52, 131072
    v_lshrrev_b32 v33, 1, v0
    v_and_b32 v24, 1, v0
    v_lshlrev_b32 v24, 7, v24
    v_lshl_add_u32 v33, v33, 11, v24
    v_subrev_u32 v33, 524288, v33
    v_mov_b32 v24, 0x40000000
    v_cmp_gt_u32 vcc, 32, v0
    s_nop 1
    v_cndmask_b32 v33, v24, v33, vcc
    s_cmp_lg_u32 s60, 3
    s_cbranch_scc1 L_pf3d
    s_lshl_b32 s84, s2, 13
    s_add_u32 s48, s12, s84
    s_addc_u32 s49, s13, 0
    s_mov_b32 s50, 8192
    s_mov_b32 s52, 2048
    v_lshlrev_b32 v25, 7, v0
    v_subrev_u32 v33, 16384, v25
    v_cmp_gt_u32 vcc, 16, v0
    s_nop 1
    v_cndmask_b32 v33, v24, v33, vcc
    s_and_b32 s84, s2, 7
    s_lshl_b32 s84, s84, 5
    s_lshr_b32 s85, s2, 3
    s_add_u32 s84, s84, s85
    s_mul_i32 s84, s84, 28672
    s_add_u32 s44, s20, s84
    s_addc_u32 s45, s21, 0
    s_mov_b32 s46, 28672
    s_mov_b32 s79, 7168
    v_subrev_u32 v6, 71680, v25
    v_mov_b32 v42, 0x40000000
    v_cmp_gt_u32 vcc, 56, v0
    s_nop 1
    v_cndmask_b32 v6, v42, v6, vcc
L_pf3d:
    s_and_b32 s49, s49, 0xffff
    s_mov_b32 s51, 0x20000
    s_and_b32 s45, s45, 0xffff
    s_mov_b32 s47, 0x20000
    v_and_b32 v24, 6, v23
    v_xor_b32 v24, v24, v22
    v_lshlrev_b32 v24, 4, v24
    v_lshl_add_u32 v24, v23, 7, v24
    v_xor_b32 v25, 64, v24
    s_lshl_b32 s84, s61, 14
    v_add_u32 v8, s84, v24
    v_add_u32 v9, s84, v25
    s_mul_i32 s84, s61, -18432
    s_add_u32 s84, s84, 32768
    v_add_u32 v10, s84, v24
    v_add_u32 v11, s84, v25
    v_lshrrev_b32 v24, 5, v0
    v_mul_u32_u24 v24, 10240, v24
    v_and_b32 v26, 1, v22
    v_bfe_u32 v25, v0, 2, 2
    v_lshl_add_u32 v25, v26, 3, v25
    v_lshl_add_u32 v24, v25, 6, v24
    v_and_b32 v25, 1, v0
    v_lshl_add_u32 v24, v25, 3, v24
    v_bfe_u32 v27, v0, 1, 1
    v_lshlrev_b32 v26, 1, v26
    s_mul_i32 s84, s62, 5120
    s_add_u32 s84, s84, 69632
    v_add_u32 v24, s84, v24
    v_add_u32 v25, 0, v27
    v_xor_b32 v25, v25, v26
    v_lshl_add_u32 v12, v25, 4, v24
    v_add_u32 v13, 40960, v12
    v_add_u32 v25, 2, v27
    v_xor_b32 v25, v25, v26
    v_lshl_add_u32 v14, v25, 4, v24
    v_add_u32 v15, 40960, v14
    v_mov_b32 v28, 0
    v_mov_b32 v29, 0
    v_mov_b32 v30, 0
    v_mov_b32 v31, 0
    s_cmp_eq_u32 s62, 1
    s_cbranch_scc1 L_early1
    s_mov_b64 exec, 0xffffffff
    buffer_load_dword v7, v42, s[44:47], 0 offen
    s_mov_b64 exec, -1
    v_mfma_f32_32x32x16_bf16 a[128:143], v[28:31], v[28:31], 0
    v_mfma_f32_32x32x16_bf16 a[144:159], v[28:31], v[28:31], 0
    v_mfma_f32_32x32x16_bf16 a[160:175], v[28:31], v[28:31], 0
    v_mfma_f32_32x32x16_bf16 a[176:191], v[28:31], v[28:31], 0
    v_mfma_f32_32x32x16_bf16 a[192:207], v[28:31], v[28:31], 0
    v_mfma_f32_32x32x16_bf16 a[208:223], v[28:31], v[28:31], 0
    v_mfma_f32_32x32x16_bf16 a[224:239], v[28:31], v[28:31], 0
    v_mfma_f32_32x32x16_bf16 a[240:255], v[28:31], v[28:31], 0
    v_mfma_f32_32x32x16_bf16 v[128:143], v[28:31], v[28:31], 0
    v_mfma_f32_32x32x16_bf16 v[144:159], v[28:31], v[28:31], 0
    v_mfma_f32_32x32x16_bf16 v[160:175], v[28:31], v[28:31], 0
    v_mfma_f32_32x32x16_bf16 v[176:191], v[28:31], v[28:31], 0
    v_mfma_f32_32x32x16_bf16 v[192:207], v[28:31], v[28:31], 0
    v_mfma_f32_32x32x16_bf16 v[208:223], v[28:31], v[28:31], 0
    v_mfma_f32_32x32x16_bf16 v[224:239], v[28:31], v[28:31], 0
    v_mfma_f32_32x32x16_bf16 v[240:255], v[28:31], v[28:31], 0
    s_waitcnt vmcnt(3)
    s_branch L_ln
L_early1:
    s_mov_b64 exec, 0xffffffff
    buffer_load_dword v7, v42, s[44:47], 0 offen
    s_mov_b64 exec, -1
    v_mfma_f32_32x32x16_bf16 a[128:143], v[28:31], v[28:31], 0
    v_mfma_f32_32x32x16_bf16 a[144:159], v[28:31], v[28:31], 0
    v_mfma_f32_32x32x16_bf16 a[160:175], v[28:31], v[28:31], 0
    v_mfma_f32_32x32x16_bf16 a[176:191], v[28:31], v[28:31], 0
    v_mfma_f32_32x32x16_bf16 a[192:207], v[28:31], v[28:31], 0
    v_mfma_f32_32x32x16_bf16 a[208:223], v[28:31], v[28:31], 0
    v_mfma_f32_32x32x16_bf16 a[224:239], v[28:31], v[28:31], 0
    v_mfma_f32_32x32x16_bf16 a[240:255], v[28:31], v[28:31], 0
    v_mfma_f32_32x32x16_bf16 v[128:143], v[28:31], v[28:31], 0
    v_mfma_f32_32x32x16_bf16 v[144:159], v[28:31], v[28:31], 0
    v_mfma_f32_32x32x16_bf16 v[160:175], v[28:31], v[28:31], 0
    v_mfma_f32_32x32x16_bf16 v[176:191], v[28:31], v[28:31], 0
    v_mfma_f32_32x32x16_bf16 v[192:207], v[28:31], v[28:31], 0
    v_mfma_f32_32x32x16_bf16 v[208:223], v[28:31], v[28:31], 0
    v_mfma_f32_32x32x16_bf16 v[224:239], v[28:31], v[28:31], 0
    v_mfma_f32_32x32x16_bf16 v[240:255], v[28:31], v[28:31], 0
    s_waitcnt vmcnt(3)
L_ln:
    v_lshlrev_b32 v64, 16, v48
    v_and_b32 v65, 0xffff0000, v48
    v_lshlrev_b32 v66, 16, v49
    v_and_b32 v67, 0xffff0000, v49
    v_lshlrev_b32 v68, 16, v50
    v_and_b32 v69, 0xffff0000, v50
    v_lshlrev_b32 v70, 16, v51
    v_and_b32 v71, 0xffff0000, v51
    v_lshlrev_b32 v72, 16, v52
    v_and_b32 v73, 0xffff0000, v52
    v_lshlrev_b32 v74, 16, v53
    v_and_b32 v75, 0xffff0000, v53
    v_lshlrev_b32 v76, 16, v54
    v_and_b32 v77, 0xffff0000, v54
    v_lshlrev_b32 v78, 16, v55
    v_and_b32 v79, 0xffff0000, v55
    v_lshlrev_b32 v80, 16, v56
    v_and_b32 v81, 0xffff0000, v56
    v_lshlrev_b32 v82, 16, v57
    v_and_b32 v83, 0xffff0000, v57
    v_lshlrev_b32 v84, 16, v58
    v_and_b32 v85, 0xffff0000, v58
    v_lshlrev_b32 v86, 16, v59
    v_and_b32 v87, 0xffff0000, v59
    v_lshlrev_b32 v88, 16, v60
    v_and_b32 v89, 0xffff0000, v60
    v_lshlrev_b32 v90, 16, v61
    v_and_b32 v91, 0xffff0000, v61
    v_lshlrev_b32 v92, 16, v62
    v_and_b32 v93, 0xffff0000, v62
    v_lshlrev_b32 v94, 16, v63
    v_and_b32 v95, 0xffff0000, v63
    v_pk_add_f32 v[96:97], v[64:65], v[66:67]
    v_pk_add_f32 v[98:99], v[80:81], v[82:83]
    v_pk_add_f32 v[96:97], v[96:97], v[68:69]
    v_pk_add_f32 v[98:99], v[98:99], v[84:85]
    v_pk_add_f32 v[96:97], v[96:97], v[70:71]
    v_pk_add_f32 v[98:99], v[98:99], v[86:87]
    v_pk_add_f32 v[96:97], v[96:97], v[72:73]
    v_pk_add_f32 v[98:99], v[98:99], v[88:89]
    v_pk_add_f32 v[96:97], v[96:97], v[74:75]
    v_pk_add_f32 v[98:99], v[98:99], v[90:91]
    v_pk_add_f32 v[96:97], v[96:97], v[76:77]
    v_pk_add_f32 v[98:99], v[98:99], v[92:93]
    v_pk_add_f32 v[96:97], v[96:97], v[78:79]
    v_pk_add_f32 v[98:99], v[98:99], v[94:95]
    v_add_f32 v102, v96, v97
    v_add_f32 v103, v98, v99
    s_nop 1
    v_permlane32_swap_b32 v102, v103
    v_add_f32 v102, v102, v103
    v_mov_b32 v100, v102
    s_nop 1
    v_permlane16_swap_b32 v102, v100
    v_add_f32 v102, v102, v100
    s_nop 1
    v_add_f32_dpp v102, v102, v102 quad_perm:[1,0,3,2] row_mask:0xf bank_mask:0xf
    s_nop 1
    v_add_f32_dpp v102, v102, v102 quad_perm:[2,3,0,1] row_mask:0xf bank_mask:0xf
    s_nop 1
    v_add_f32_dpp v102, v102, v102 row_half_mirror row_mask:0xf bank_mask:0xf
    s_nop 1
    v_add_f32_dpp v102, v102, v102 row_mirror row_mask:0xf bank_mask:0xf
    v_mul_f32 v102, 0xba800000, v102
    v_cvt_pk_bf16_f32 v106, v102, v102
    v_lshlrev_b32 v106, 16, v106
    v_mov_b32 v103, v102
    s_nop 1
    v_permlane32_swap_b32 v102, v103
    v_mov_b32 v107, v106
    s_nop 1
    v_permlane32_swap_b32 v106, v107
    v_pk_add_f32 v[108:109], v[64:65], v[102:103] op_sel_hi:[1,0]
    v_pk_add_f32 v[110:111], v[80:81], v[102:103] op_sel:[0,1] op_sel_hi:[1,1]
    v_pk_mul_f32 v[96:97], v[108:109], v[108:109]
    v_pk_mul_f32 v[98:99], v[110:111], v[110:111]
    v_pk_add_f32 v[108:109], v[66:67], v[102:103] op_sel_hi:[1,0]
    v_pk_add_f32 v[110:111], v[82:83], v[102:103] op_sel:[0,1] op_sel_hi:[1,1]
    v_pk_fma_f32 v[96:97], v[108:109], v[108:109], v[96:97]
    v_pk_fma_f32 v[98:99], v[110:111], v[110:111], v[98:99]
    v_pk_add_f32 v[108:109], v[68:69], v[102:103] op_sel_hi:[1,0]
    v_pk_add_f32 v[110:111], v[84:85], v[102:103] op_sel:[0,1] op_sel_hi:[1,1]
    v_pk_fma_f32 v[96:97], v[108:109], v[108:109], v[96:97]
    v_pk_fma_f32 v[98:99], v[110:111], v[110:111], v[98:99]
    v_pk_add_f32 v[108:109], v[70:71], v[102:103] op_sel_hi:[1,0]
    v_pk_add_f32 v[110:111], v[86:87], v[102:103] op_sel:[0,1] op_sel_hi:[1,1]
    v_pk_fma_f32 v[96:97], v[108:109], v[108:109], v[96:97]
    v_pk_fma_f32 v[98:99], v[110:111], v[110:111], v[98:99]
    v_pk_add_f32 v[108:109], v[72:73], v[102:103] op_sel_hi:[1,0]
    v_pk_add_f32 v[110:111], v[88:89], v[102:103] op_sel:[0,1] op_sel_hi:[1,1]
    v_pk_fma_f32 v[96:97], v[108:109], v[108:109], v[96:97]
    v_pk_fma_f32 v[98:99], v[110:111], v[110:111], v[98:99]
    v_pk_add_f32 v[108:109], v[74:75], v[102:103] op_sel_hi:[1,0]
    v_pk_add_f32 v[110:111], v[90:91], v[102:103] op_sel:[0,1] op_sel_hi:[1,1]
    v_pk_fma_f32 v[96:97], v[108:109], v[108:109], v[96:97]
    v_pk_fma_f32 v[98:99], v[110:111], v[110:111], v[98:99]
    v_pk_add_f32 v[108:109], v[76:77], v[102:103] op_sel_hi:[1,0]
    v_pk_add_f32 v[110:111], v[92:93], v[102:103] op_sel:[0,1] op_sel_hi:[1,1]
    v_pk_fma_f32 v[96:97], v[108:109], v[108:109], v[96:97]
    v_pk_fma_f32 v[98:99], v[110:111], v[110:111], v[98:99]
    v_pk_add_f32 v[108:109], v[78:79], v[102:103] op_sel_hi:[1,0]
    v_pk_add_f32 v[110:111], v[94:95], v[102:103] op_sel:[0,1] op_sel_hi:[1,1]
    v_pk_fma_f32 v[96:97], v[108:109], v[108:109], v[96:97]
    v_pk_fma_f32 v[98:99], v[110:111], v[110:111], v[98:99]
    v_add_f32 v104, v96, v97
    v_add_f32 v105, v98, v99
    s_nop 1
    v_permlane32_swap_b32 v104, v105
    v_add_f32 v104, v104, v105
    v_mov_b32 v100, v104
    s_nop 1
    v_permlane16_swap_b32 v104, v100
    v_add_f32 v104, v104, v100
    s_nop 1
    v_add_f32_dpp v104, v104, v104 quad_perm:[1,0,3,2] row_mask:0xf bank_mask:0xf
    s_nop 1
    v_add_f32_dpp v104, v104, v104 quad_perm:[2,3,0,1] row_mask:0xf bank_mask:0xf
    s_nop 1
    v_add_f32_dpp v104, v104, v104 row_half_mirror row_mask:0xf bank_mask:0xf
    s_nop 1
    v_add_f32_dpp v104, v104, v104 row_mirror row_mask:0xf bank_mask:0xf
    v_mul_f32 v104, 0x3a800000, v104
    v_cvt_pk_bf16_f32 v104, v104, v104
    v_lshlrev_b32 v104, 16, v104
    v_add_f32 v104, 0x3727c5ac, v104
    v_cvt_pk_bf16_f32 v104, v104, v104
    v_lshlrev_b32 v104, 16, v104
    v_sqrt_f32 v104, v104
    s_nop 0
    v_cvt_pk_bf16_f32 v104, v104, v104
    v_lshlrev_b32 v104, 16, v104
    v_rcp_f32 v100, v104
    s_nop 0
    v_fma_f32 v104, -v104, v100, 1.0
    v_fma_f32 v104, v104, v100, v100
    v_mov_b32 v105, v104
    s_nop 1
    v_permlane32_swap_b32 v104, v105
    v_pk_add_f32 v[64:65], v[64:65], v[106:107] op_sel_hi:[1,0]
    v_pk_add_f32 v[66:67], v[66:67], v[106:107] op_sel_hi:[1,0]
    v_pk_add_f32 v[68:69], v[68:69], v[106:107] op_sel_hi:[1,0]
    v_pk_add_f32 v[70:71], v[70:71], v[106:107] op_sel_hi:[1,0]
    v_cvt_pk_bf16_f32 v65, v64, v65
    v_cvt_pk_bf16_f32 v67, v66, v67
    v_cvt_pk_bf16_f32 v69, v68, v69
    v_cvt_pk_bf16_f32 v71, v70, v71
    v_lshlrev_b32 v64, 16, v65
    v_and_b32 v65, 0xffff0000, v65
    v_lshlrev_b32 v66, 16, v67
    v_and_b32 v67, 0xffff0000, v67
    v_lshlrev_b32 v68, 16, v69
    v_and_b32 v69, 0xffff0000, v69
    v_lshlrev_b32 v70, 16, v71
    v_and_b32 v71, 0xffff0000, v71
    v_pk_mul_f32 v[64:65], v[64:65], v[104:105] op_sel_hi:[1,0]
    v_pk_mul_f32 v[66:67], v[66:67], v[104:105] op_sel_hi:[1,0]
    v_pk_mul_f32 v[68:69], v[68:69], v[104:105] op_sel_hi:[1,0]
    v_pk_mul_f32 v[70:71], v[70:71], v[104:105] op_sel_hi:[1,0]
    v_cvt_pk_bf16_f32 v48, v64, v65
    v_cvt_pk_bf16_f32 v49, v66, v67
    v_cvt_pk_bf16_f32 v50, v68, v69
    v_cvt_pk_bf16_f32 v51, v70, v71
    global_store_dwordx4 v36, v[48:51], s[26:27] offset:0 sc1
    v_pk_add_f32 v[72:73], v[72:73], v[106:107] op_sel_hi:[1,0]
    v_pk_add_f32 v[74:75], v[74:75], v[106:107] op_sel_hi:[1,0]
    v_pk_add_f32 v[76:77], v[76:77], v[106:107] op_sel_hi:[1,0]
    v_pk_add_f32 v[78:79], v[78:79], v[106:107] op_sel_hi:[1,0]
    v_cvt_pk_bf16_f32 v73, v72, v73
    v_cvt_pk_bf16_f32 v75, v74, v75
    v_cvt_pk_bf16_f32 v77, v76, v77
    v_cvt_pk_bf16_f32 v79, v78, v79
    v_lshlrev_b32 v72, 16, v73
    v_and_b32 v73, 0xffff0000, v73
    v_lshlrev_b32 v74, 16, v75
    v_and_b32 v75, 0xffff0000, v75
    v_lshlrev_b32 v76, 16, v77
    v_and_b32 v77, 0xffff0000, v77
    v_lshlrev_b32 v78, 16, v79
    v_and_b32 v79, 0xffff0000, v79
    v_pk_mul_f32 v[72:73], v[72:73], v[104:105] op_sel_hi:[1,0]
    v_pk_mul_f32 v[74:75], v[74:75], v[104:105] op_sel_hi:[1,0]
    v_pk_mul_f32 v[76:77], v[76:77], v[104:105] op_sel_hi:[1,0]
    v_pk_mul_f32 v[78:79], v[78:79], v[104:105] op_sel_hi:[1,0]
    v_cvt_pk_bf16_f32 v52, v72, v73
    v_cvt_pk_bf16_f32 v53, v74, v75
    v_cvt_pk_bf16_f32 v54, v76, v77
    v_cvt_pk_bf16_f32 v55, v78, v79
    global_store_dwordx4 v36, v[52:55], s[26:27] offset:1024 sc1
    v_pk_add_f32 v[80:81], v[80:81], v[106:107] op_sel:[0,1] op_sel_hi:[1,1]
    v_pk_add_f32 v[82:83], v[82:83], v[106:107] op_sel:[0,1] op_sel_hi:[1,1]
    v_pk_add_f32 v[84:85], v[84:85], v[106:107] op_sel:[0,1] op_sel_hi:[1,1]
    v_pk_add_f32 v[86:87], v[86:87], v[106:107] op_sel:[0,1] op_sel_hi:[1,1]
    v_cvt_pk_bf16_f32 v81, v80, v81
    v_cvt_pk_bf16_f32 v83, v82, v83
    v_cvt_pk_bf16_f32 v85, v84, v85
    v_cvt_pk_bf16_f32 v87, v86, v87
    v_lshlrev_b32 v80, 16, v81
    v_and_b32 v81, 0xffff0000, v81
    v_lshlrev_b32 v82, 16, v83
    v_and_b32 v83, 0xffff0000, v83
    v_lshlrev_b32 v84, 16, v85
    v_and_b32 v85, 0xffff0000, v85
    v_lshlrev_b32 v86, 16, v87
    v_and_b32 v87, 0xffff0000, v87
    v_pk_mul_f32 v[80:81], v[80:81], v[104:105] op_sel:[0,1] op_sel_hi:[1,1]
    v_pk_mul_f32 v[82:83], v[82:83], v[104:105] op_sel:[0,1] op_sel_hi:[1,1]
    v_pk_mul_f32 v[84:85], v[84:85], v[104:105] op_sel:[0,1] op_sel_hi:[1,1]
    v_pk_mul_f32 v[86:87], v[86:87], v[104:105] op_sel:[0,1] op_sel_hi:[1,1]
    v_cvt_pk_bf16_f32 v56, v80, v81
    v_cvt_pk_bf16_f32 v57, v82, v83
    v_cvt_pk_bf16_f32 v58, v84, v85
    v_cvt_pk_bf16_f32 v59, v86, v87
    global_store_dwordx4 v36, v[56:59], s[26:27] offset:2048 sc1
    v_pk_add_f32 v[88:89], v[88:89], v[106:107] op_sel:[0,1] op_sel_hi:[1,1]
    v_pk_add_f32 v[90:91], v[90:91], v[106:107] op_sel:[0,1] op_sel_hi:[1,1]
    v_pk_add_f32 v[92:93], v[92:93], v[106:107] op_sel:[0,1] op_sel_hi:[1,1]
    v_pk_add_f32 v[94:95], v[94:95], v[106:107] op_sel:[0,1] op_sel_hi:[1,1]
    v_cvt_pk_bf16_f32 v89, v88, v89
    v_cvt_pk_bf16_f32 v91, v90, v91
    v_cvt_pk_bf16_f32 v93, v92, v93
    v_cvt_pk_bf16_f32 v95, v94, v95
    v_lshlrev_b32 v88, 16, v89
    v_and_b32 v89, 0xffff0000, v89
    v_lshlrev_b32 v90, 16, v91
    v_and_b32 v91, 0xffff0000, v91
    v_lshlrev_b32 v92, 16, v93
    v_and_b32 v93, 0xffff0000, v93
    v_lshlrev_b32 v94, 16, v95
    v_and_b32 v95, 0xffff0000, v95
    v_pk_mul_f32 v[88:89], v[88:89], v[104:105] op_sel:[0,1] op_sel_hi:[1,1]
    v_pk_mul_f32 v[90:91], v[90:91], v[104:105] op_sel:[0,1] op_sel_hi:[1,1]
    v_pk_mul_f32 v[92:93], v[92:93], v[104:105] op_sel:[0,1] op_sel_hi:[1,1]
    v_pk_mul_f32 v[94:95], v[94:95], v[104:105] op_sel:[0,1] op_sel_hi:[1,1]
    v_cvt_pk_bf16_f32 v60, v88, v89
    v_cvt_pk_bf16_f32 v61, v90, v91
    v_cvt_pk_bf16_f32 v62, v92, v93
    v_cvt_pk_bf16_f32 v63, v94, v95
    global_store_dwordx4 v36, v[60:63], s[26:27] offset:3072 sc1
    s_waitcnt vmcnt(5)
    v_add_u32 v40, 1, v40
    s_waitcnt vmcnt(0)
    s_mov_b64 exec, 1
    global_store_dword v37, v40, s[26:27] sc1
    s_mov_b64 exec, -1
    buffer_load_dword v7, v42, s[44:47], 0 offen
    v_add_u32_e64 v42, s86, v42
    s_barrier
    v_mfma_f32_32x32x16_bf16 v[48:63], v[28:31], v[28:31], 0
    v_mfma_f32_32x32x16_bf16 v[64:79], v[28:31], v[28:31], 0
    v_mfma_f32_32x32x16_bf16 v[80:95], v[28:31], v[28:31], 0
    v_mfma_f32_32x32x16_bf16 v[96:111], v[28:31], v[28:31], 0
    v_mfma_f32_32x32x16_bf16 v[112:127], v[28:31], v[28:31], 0
    s_mov_b32 s67, 0
    s_cmp_lg_u32 s60, 3
    s_cbranch_scc1 L_noarr
    s_lshl_b32 s84, s63, 5
    v_mov_b32 v20, s84
    v_mov_b32 v21, 1
    s_mov_b64 exec, 1
    global_atomic_add v20, v21, s[24:25] sc1
    s_mov_b64 exec, -1
L_noarr:
    s_cmp_eq_u32 s62, 0
    s_cbranch_scc1 L_now
    s_add_u32 m0, s78, 0
    s_nop 0
    buffer_load_dwordx4 v2, s[32:35], s68 offen offset:0 lds
    buffer_load_dwordx4 v2, s[32:35], s69 offen offset:1024 lds
    buffer_load_dwordx4 v2, s[32:35], s70 offen offset:2048 lds
    v_add_u32 v2, 196608, v2
    buffer_load_dwordx4 v3, s[36:39], s71 offen offset:3072 lds
    s_add_u32 m0, s78, 4096
    s_nop 0
    buffer_load_dwordx4 v3, s[40:43], s72 offen offset:0 lds
    buffer_load_dwordx4 v3, s[36:39], s73 offen offset:1024 lds
    buffer_load_dwordx4 v3, s[40:43], s74 offen offset:2048 lds
    buffer_load_dwordx4 v3, s[36:39], s75 offen offset:3072 lds
    s_add_u32 m0, s78, 8192
    s_nop 0
    buffer_load_dwordx4 v3, s[40:43], s76 offen offset:0 lds
    v_add_u32 v3, 229376, v3
    global_load_lds_dwordx4 v[4:5], off offset:1024
    v_lshl_add_u64 v[4:5], v[4:5], 0, s[80:81]
    s_add_u32 m0, s78, 20480
    s_nop 0
    buffer_load_dwordx4 v2, s[32:35], s68 offen offset:0 lds
    buffer_load_dwordx4 v2, s[32:35], s69 offen offset:1024 lds
    buffer_load_dwordx4 v2, s[32:35], s70 offen offset:2048 lds
    v_add_u32 v2, 196608, v2
    buffer_load_dwordx4 v3, s[36:39], s71 offen offset:3072 lds
    s_add_u32 m0, s78, 24576
    s_nop 0
    buffer_load_dwordx4 v3, s[40:43], s72 offen offset:0 lds
    buffer_load_dwordx4 v3, s[36:39], s73 offen offset:1024 lds
    buffer_load_dwordx4 v3, s[40:43], s74 offen offset:2048 lds
    buffer_load_dwordx4 v3, s[36:39], s75 offen offset:3072 lds
    s_add_u32 m0, s78, 28672
    s_nop 0
    buffer_load_dwordx4 v3, s[40:43], s76 offen offset:0 lds
    v_add_u32 v3, 229376, v3
    global_load_lds_dwordx4 v[4:5], off offset:1024
    v_lshl_add_u64 v[4:5], v[4:5], 0, s[80:81]
L_now:
    s_cmp_eq_u32 s60, 3
    s_cbranch_scc1 L_stub0
    s_cmp_eq_u32 s60, 2
    s_cbranch_scc1 L_stub1
    s_cmp_eq_u32 s60, 1
    s_cbranch_scc1 L_stub2
    s_cmp_eq_u32 s60, 0
    s_cbranch_scc1 L_stub3
L_stubret:
    s_cmp_eq_u32 s87, 1
    s_cbranch_scc1 L_lnok
L_lnpoll:
    global_load_dword v20, v38, s[26:27] sc1
    s_waitcnt vmcnt(0)
    v_cmp_ne_u32 vcc, v20, v39
    s_cmp_eq_u64 vcc, -1
    s_cbranch_scc1 L_lnok
    s_add_u32 s67, s67, 1
    s_and_b32 s84, s67, 3
    s_cbranch_scc1 L_lnpoll
    global_load_dword v20, v41, s[24:25] sc1
    s_waitcnt vmcnt(0)
    v_readfirstlane_b32 s84, v20
    s_cmp_ge_u32 s84, 32
    s_cbranch_scc1 L_lnok
    s_cmp_lt_u32 s67, 0x40000
    s_cbranch_scc1 L_lnpoll
L_lnok:
    s_cmp_eq_u32 s62, 1
    s_cbranch_scc1 L_g1_1
    s_branch L_g1_0
.p2align 12
L_stub0:
    s_branch L_stub4
L_g1_0:
    v_add_u32 v2, 131072, v1
    s_add_u32 m0, s78, 0
    s_nop 0
    buffer_load_dwordx4 v1, s[28:31], s68 offen offset:0 sc1 lds
    buffer_load_dwordx4 v1, s[28:31], s69 offen offset:1024 sc1 lds
    buffer_load_dwordx4 v1, s[28:31], s70 offen offset:2048 sc1 lds
    buffer_load_dwordx4 v1, s[28:31], s71 offen offset:3072 sc1 lds
    s_add_u32 m0, s78, 4096
    s_nop 0
    buffer_load_dwordx4 v1, s[28:31], s72 offen offset:0 sc1 lds
    buffer_load_dwordx4 v1, s[28:31], s73 offen offset:1024 sc1 lds
    buffer_load_dwordx4 v1, s[28:31], s74 offen offset:2048 sc1 lds
    buffer_load_dwordx4 v1, s[28:31], s75 offen offset:3072 sc1 lds
    v_add_u32 v1, 128, v1
    s_add_u32 m0, s78, 8192
    s_nop 0
    buffer_load_dwordx4 v2, s[28:31], s68 offen offset:0 sc1 lds
    buffer_load_dwordx4 v2, s[28:31], s69 offen offset:1024 sc1 lds
    buffer_load_dwordx4 v2, s[28:31], s70 offen offset:2048 sc1 lds
    buffer_load_dwordx4 v2, s[28:31], s71 offen offset:3072 sc1 lds
    s_add_u32 m0, s78, 12288
    s_nop 0
    buffer_load_dwordx4 v2, s[28:31], s72 offen offset:0 sc1 lds
    buffer_load_dwordx4 v2, s[28:31], s73 offen offset:1024 sc1 lds
    buffer_load_dwordx4 v2, s[28:31], s74 offen offset:2048 sc1 lds
    buffer_load_dwordx4 v2, s[28:31], s75 offen offset:3072 sc1 lds
    v_add_u32 v2, 128, v2
    s_add_u32 m0, s78, 34816
    s_nop 0
    buffer_load_dwordx4 v1, s[28:31], s68 offen offset:0 sc1 lds
    buffer_load_dwordx4 v1, s[28:31], s69 offen offset:1024 sc1 lds
    buffer_load_dwordx4 v1, s[28:31], s70 offen offset:2048 sc1 lds
    buffer_load_dwordx4 v1, s[28:31], s71 offen offset:3072 sc1 lds
    s_add_u32 m0, s78, 38912
    s_nop 0
    buffer_load_dwordx4 v1, s[28:31], s72 offen offset:0 sc1 lds
    buffer_load_dwordx4 v1, s[28:31], s73 offen offset:1024 sc1 lds
    buffer_load_dwordx4 v1, s[28:31], s74 offen offset:2048 sc1 lds
    buffer_load_dwordx4 v1, s[28:31], s75 offen offset:3072 sc1 lds
    v_add_u32 v1, 128, v1
    s_add_u32 m0, s78, 43008
    s_nop 0
    buffer_load_dwordx4 v2, s[28:31], s68 offen offset:0 sc1 lds
    buffer_load_dwordx4 v2, s[28:31], s69 offen offset:1024 sc1 lds
    buffer_load_dwordx4 v2, s[28:31], s70 offen offset:2048 sc1 lds
    buffer_load_dwordx4 v2, s[28:31], s71 offen offset:3072 sc1 lds
    s_add_u32 m0, s78, 47104
    s_nop 0
    buffer_load_dwordx4 v2, s[28:31], s72 offen offset:0 sc1 lds
    buffer_load_dwordx4 v2, s[28:31], s73 offen offset:1024 sc1 lds
    buffer_load_dwordx4 v2, s[28:31], s74 offen offset:2048 sc1 lds
    buffer_load_dwordx4 v2, s[28:31], s75 offen offset:3072 sc1 lds
    v_add_u32 v2, 128, v2
    s_waitcnt vmcnt(16)
    s_barrier
    ds_read_b64_tr_b16 a[64:65], v12 offset:0
    ds_read_b64_tr_b16 a[66:67], v12 offset:256
    ds_read_b64_tr_b16 a[68:69], v14 offset:0
    ds_read_b64_tr_b16 a[70:71], v14 offset:256
    ds_read_b64_tr_b16 a[72:73], v12 offset:1024
    ds_read_b64_tr_b16 a[74:75], v12 offset:1280
    ds_read_b64_tr_b16 a[76:77], v14 offset:1024
    ds_read_b64_tr_b16 a[78:79], v14 offset:1280
    ds_read_b64_tr_b16 a[80:81], v12 offset:2048
    ds_read_b64_tr_b16 a[82:83], v12 offset:2304
    ds_read_b64_tr_b16 a[84:85], v14 offset:2048
    ds_read_b64_tr_b16 a[86:87], v14 offset:2304
    ds_read_b64_tr_b16 a[88:89], v12 offset:3072
    ds_read_b64_tr_b16 a[90:91], v12 offset:3328
    ds_read_b64_tr_b16 a[92:93], v14 offset:3072
    ds_read_b64_tr_b16 a[94:95], v14 offset:3328
    ds_read_b64_tr_b16 a[96:97], v12 offset:4096
    ds_read_b64_tr_b16 a[98:99], v12 offset:4352
    ds_read_b64_tr_b16 a[100:101], v14 offset:4096
    ds_read_b64_tr_b16 a[102:103], v14 offset:4352
    ds_read_b128 a[0:3], v8 offset:0
    ds_read_b128 a[4:7], v8 offset:2048
    ds_read_b128 a[8:11], v8 offset:4096
    ds_read_b128 a[12:15], v8 offset:6144
    ds_read_b128 a[16:19], v8 offset:8192
    ds_read_b128 a[20:23], v8 offset:10240
    ds_read_b128 a[24:27], v8 offset:12288
    ds_read_b128 a[28:31], v8 offset:14336
    ds_read_b128 a[112:115], v10 offset:0
    s_mov_b32 s67, 7
    v_mov_b32 v20, 0x7ff00000
.p2align 3
L_loop0:
    s_waitcnt lgkmcnt(0)
    s_barrier
    v_mfma_f32_16x16x32_bf16 a[128:131], a[64:67], a[0:3], a[128:131]
    buffer_load_dword v7, v6, s[44:47], s4 offen
    v_add_u32_e64 v6, s79, v6
    v_mfma_f32_16x16x32_bf16 a[136:139], a[64:67], a[4:7], a[136:139]
    v_mfma_f32_16x16x32_bf16 a[144:147], a[64:67], a[8:11], a[144:147]
    ds_read_b128 a[32:35], v9 offset:0
    v_mfma_f32_16x16x32_bf16 a[152:155], a[64:67], a[12:15], a[152:155]
    v_mfma_f32_16x16x32_bf16 a[160:163], a[64:67], a[16:19], a[160:163]
    v_mfma_f32_16x16x32_bf16 a[168:171], a[64:67], a[20:23], a[168:171]
    v_mfma_f32_16x16x32_bf16 a[176:179], a[64:67], a[24:27], a[176:179]
    ds_read_b128 a[36:39], v9 offset:2048
    v_mfma_f32_16x16x32_bf16 a[184:187], a[64:67], a[28:31], a[184:187]
    v_mfma_f32_16x16x32_bf16 v[120:123], a[64:67], a[112:115], v[120:123]
    ds_read_b64_tr_b16 a[64:65], v12 offset:20480
    v_mfma_f32_16x16x32_bf16 a[132:135], a[68:71], a[0:3], a[132:135]
    ds_read_b64_tr_b16 a[66:67], v12 offset:20736
    v_mfma_f32_16x16x32_bf16 a[140:143], a[68:71], a[4:7], a[140:143]
    ds_read_b128 a[40:43], v9 offset:4096
    v_mfma_f32_16x16x32_bf16 a[148:151], a[68:71], a[8:11], a[148:151]
    v_mfma_f32_16x16x32_bf16 a[156:159], a[68:71], a[12:15], a[156:159]
    v_mfma_f32_16x16x32_bf16 a[164:167], a[68:71], a[16:19], a[164:167]
    v_mfma_f32_16x16x32_bf16 a[172:175], a[68:71], a[20:23], a[172:175]
    ds_read_b128 a[44:47], v9 offset:6144
    v_mfma_f32_16x16x32_bf16 a[180:183], a[68:71], a[24:27], a[180:183]
    v_mfma_f32_16x16x32_bf16 a[188:191], a[68:71], a[28:31], a[188:191]
    v_mfma_f32_16x16x32_bf16 v[124:127], a[68:71], a[112:115], v[124:127]
    ds_read_b64_tr_b16 a[68:69], v14 offset:20480
    v_mfma_f32_16x16x32_bf16 v[52:55], a[0:3], a[72:75], v[52:55]
    ds_read_b64_tr_b16 a[70:71], v14 offset:20736
    v_mfma_f32_16x16x32_bf16 v[56:59], a[4:7], a[72:75], v[56:59]
    v_mfma_f32_16x16x32_bf16 v[60:63], a[8:11], a[72:75], v[60:63]
    ds_read_b128 a[48:51], v9 offset:8192
    v_mfma_f32_16x16x32_bf16 v[64:67], a[12:15], a[72:75], v[64:67]
    v_mfma_f32_16x16x32_bf16 v[68:71], a[16:19], a[72:75], v[68:71]
    ds_read_b128 a[52:55], v9 offset:10240
    v_mfma_f32_16x16x32_bf16 v[72:75], a[20:23], a[72:75], v[72:75]
    v_mfma_f32_16x16x32_bf16 v[76:79], a[24:27], a[72:75], v[76:79]
    v_mfma_f32_16x16x32_bf16 v[80:83], a[28:31], a[72:75], v[80:83]
    v_mfma_f32_16x16x32_bf16 v[48:51], a[112:115], a[72:75], v[48:51]
    ds_read_b64_tr_b16 a[72:73], v12 offset:21504
    v_mfma_f32_16x16x32_bf16 v[88:91], a[0:3], a[76:79], v[88:91]
    ds_read_b64_tr_b16 a[74:75], v12 offset:21760
    v_mfma_f32_16x16x32_bf16 v[92:95], a[4:7], a[76:79], v[92:95]
    ds_read_b128 a[56:59], v9 offset:12288
    v_mfma_f32_16x16x32_bf16 v[96:99], a[8:11], a[76:79], v[96:99]
    v_mfma_f32_16x16x32_bf16 v[100:103], a[12:15], a[76:79], v[100:103]
    ds_read_b128 a[60:63], v9 offset:14336
    v_mfma_f32_16x16x32_bf16 v[104:107], a[16:19], a[76:79], v[104:107]
    v_mfma_f32_16x16x32_bf16 v[108:111], a[20:23], a[76:79], v[108:111]
    v_mfma_f32_16x16x32_bf16 v[112:115], a[24:27], a[76:79], v[112:115]
    v_mfma_f32_16x16x32_bf16 v[116:119], a[28:31], a[76:79], v[116:119]
    ds_read_b128 a[116:119], v11 offset:0
    v_mfma_f32_16x16x32_bf16 v[84:87], a[112:115], a[76:79], v[84:87]
    ds_read_b64_tr_b16 a[76:77], v14 offset:21504
    v_mfma_f32_16x16x32_bf16 a[192:195], a[80:83], a[0:3], a[192:195]
    ds_read_b64_tr_b16 a[78:79], v14 offset:21760
    v_mfma_f32_16x16x32_bf16 a[200:203], a[80:83], a[4:7], a[200:203]
    v_mfma_f32_16x16x32_bf16 a[208:211], a[80:83], a[8:11], a[208:211]
    ds_read_b64_tr_b16 a[104:105], v12 offset:24576
    v_mfma_f32_16x16x32_bf16 a[216:219], a[80:83], a[12:15], a[216:219]
    v_mfma_f32_16x16x32_bf16 a[224:227], a[80:83], a[16:19], a[224:227]
    v_mfma_f32_16x16x32_bf16 a[232:235], a[80:83], a[20:23], a[232:235]
    v_mfma_f32_16x16x32_bf16 a[240:243], a[80:83], a[24:27], a[240:243]
    ds_read_b64_tr_b16 a[106:107], v12 offset:24832
    v_mfma_f32_16x16x32_bf16 a[248:251], a[80:83], a[28:31], a[248:251]
    ds_read_b64_tr_b16 a[80:81], v12 offset:22528
    v_mfma_f32_16x16x32_bf16 a[196:199], a[84:87], a[0:3], a[196:199]
    ds_read_b64_tr_b16 a[82:83], v12 offset:22784
    v_mfma_f32_16x16x32_bf16 a[204:207], a[84:87], a[4:7], a[204:207]
    v_mfma_f32_16x16x32_bf16 a[212:215], a[84:87], a[8:11], a[212:215]
    ds_read_b64_tr_b16 a[108:109], v14 offset:24576
    v_mfma_f32_16x16x32_bf16 a[220:223], a[84:87], a[12:15], a[220:223]
    v_mfma_f32_16x16x32_bf16 a[228:231], a[84:87], a[16:19], a[228:231]
    v_mfma_f32_16x16x32_bf16 a[236:239], a[84:87], a[20:23], a[236:239]
    v_mfma_f32_16x16x32_bf16 a[244:247], a[84:87], a[24:27], a[244:247]
    ds_read_b64_tr_b16 a[110:111], v14 offset:24832
    v_mfma_f32_16x16x32_bf16 a[252:255], a[84:87], a[28:31], a[252:255]
    ds_read_b64_tr_b16 a[84:85], v14 offset:22528
    v_mfma_f32_16x16x32_bf16 v[128:131], a[88:91], a[0:3], v[128:131]
    ds_read_b64_tr_b16 a[86:87], v14 offset:22784
    v_mfma_f32_16x16x32_bf16 v[144:147], a[88:91], a[4:7], v[144:147]
    v_mfma_f32_16x16x32_bf16 v[160:163], a[88:91], a[8:11], v[160:163]
    v_mfma_f32_16x16x32_bf16 v[176:179], a[88:91], a[12:15], v[176:179]
    v_mfma_f32_16x16x32_bf16 v[192:195], a[88:91], a[16:19], v[192:195]
    v_mfma_f32_16x16x32_bf16 v[208:211], a[88:91], a[20:23], v[208:211]
    v_mfma_f32_16x16x32_bf16 v[224:227], a[88:91], a[24:27], v[224:227]
    v_mfma_f32_16x16x32_bf16 v[240:243], a[88:91], a[28:31], v[240:243]
    ds_read_b64_tr_b16 a[88:89], v12 offset:23552
    v_mfma_f32_16x16x32_bf16 v[132:135], a[92:95], a[0:3], v[132:135]
    ds_read_b64_tr_b16 a[90:91], v12 offset:23808
    v_mfma_f32_16x16x32_bf16 v[148:151], a[92:95], a[4:7], v[148:151]
    v_mfma_f32_16x16x32_bf16 v[164:167], a[92:95], a[8:11], v[164:167]
    v_mfma_f32_16x16x32_bf16 v[180:183], a[92:95], a[12:15], v[180:183]
    v_mfma_f32_16x16x32_bf16 v[196:199], a[92:95], a[16:19], v[196:199]
    v_mfma_f32_16x16x32_bf16 v[212:215], a[92:95], a[20:23], v[212:215]
    v_mfma_f32_16x16x32_bf16 v[228:231], a[92:95], a[24:27], v[228:231]
    v_mfma_f32_16x16x32_bf16 v[244:247], a[92:95], a[28:31], v[244:247]
    ds_read_b64_tr_b16 a[92:93], v14 offset:23552
    v_mfma_f32_16x16x32_bf16 v[136:139], a[96:99], a[0:3], v[136:139]
    ds_read_b64_tr_b16 a[94:95], v14 offset:23808
    v_mfma_f32_16x16x32_bf16 v[152:155], a[96:99], a[4:7], v[152:155]
    v_mfma_f32_16x16x32_bf16 v[168:171], a[96:99], a[8:11], v[168:171]
    v_mfma_f32_16x16x32_bf16 v[184:187], a[96:99], a[12:15], v[184:187]
    v_mfma_f32_16x16x32_bf16 v[200:203], a[96:99], a[16:19], v[200:203]
    v_mfma_f32_16x16x32_bf16 v[216:219], a[96:99], a[20:23], v[216:219]
    v_mfma_f32_16x16x32_bf16 v[232:235], a[96:99], a[24:27], v[232:235]
    v_mfma_f32_16x16x32_bf16 v[248:251], a[96:99], a[28:31], v[248:251]
    v_mfma_f32_16x16x32_bf16 v[140:143], a[100:103], a[0:3], v[140:143]
    v_mfma_f32_16x16x32_bf16 v[156:159], a[100:103], a[4:7], v[156:159]
    v_mfma_f32_16x16x32_bf16 v[172:175], a[100:103], a[8:11], v[172:175]
    v_mfma_f32_16x16x32_bf16 v[188:191], a[100:103], a[12:15], v[188:191]
    v_mfma_f32_16x16x32_bf16 v[204:207], a[100:103], a[16:19], v[204:207]
    v_mfma_f32_16x16x32_bf16 v[220:223], a[100:103], a[20:23], v[220:223]
    v_mfma_f32_16x16x32_bf16 v[236:239], a[100:103], a[24:27], v[236:239]
    v_mfma_f32_16x16x32_bf16 v[252:255], a[100:103], a[28:31], v[252:255]
    s_waitcnt vmcnt(1) lgkmcnt(0)
    s_barrier
    v_mfma_f32_16x16x32_bf16 a[128:131], a[64:67], a[32:35], a[128:131]
    s_add_u32 m0, s78, 0
    v_mfma_f32_16x16x32_bf16 a[136:139], a[64:67], a[36:39], a[136:139]
    buffer_load_dwordx4 v1, s[28:31], s68 offen offset:0 sc1 lds
    v_mfma_f32_16x16x32_bf16 a[144:147], a[64:67], a[40:43], a[144:147]
    ds_read_b128 a[0:3], v8 offset:34816
    v_mfma_f32_16x16x32_bf16 a[152:155], a[64:67], a[44:47], a[152:155]
    v_mfma_f32_16x16x32_bf16 a[160:163], a[64:67], a[48:51], a[160:163]
    buffer_load_dwordx4 v1, s[28:31], s69 offen offset:1024 sc1 lds
    v_mfma_f32_16x16x32_bf16 a[168:171], a[64:67], a[52:55], a[168:171]
    v_mfma_f32_16x16x32_bf16 a[176:179], a[64:67], a[56:59], a[176:179]
    ds_read_b128 a[4:7], v8 offset:36864
    v_mfma_f32_16x16x32_bf16 a[184:187], a[64:67], a[60:63], a[184:187]
    v_mfma_f32_16x16x32_bf16 v[120:123], a[64:67], a[116:119], v[120:123]
    ds_read_b64_tr_b16 a[64:65], v13 offset:0
    v_mfma_f32_16x16x32_bf16 a[132:135], a[68:71], a[32:35], a[132:135]
    ds_read_b64_tr_b16 a[66:67], v13 offset:256
    v_mfma_f32_16x16x32_bf16 a[140:143], a[68:71], a[36:39], a[140:143]
    ds_read_b128 a[8:11], v8 offset:38912
    v_mfma_f32_16x16x32_bf16 a[148:151], a[68:71], a[40:43], a[148:151]
    buffer_load_dwordx4 v1, s[28:31], s70 offen offset:2048 sc1 lds
    v_mfma_f32_16x16x32_bf16 a[156:159], a[68:71], a[44:47], a[156:159]
    buffer_load_dwordx4 v1, s[28:31], s71 offen offset:3072 sc1 lds
    v_mfma_f32_16x16x32_bf16 a[164:167], a[68:71], a[48:51], a[164:167]
    v_mfma_f32_16x16x32_bf16 a[172:175], a[68:71], a[52:55], a[172:175]
    ds_read_b128 a[12:15], v8 offset:40960
    v_mfma_f32_16x16x32_bf16 a[180:183], a[68:71], a[56:59], a[180:183]
    s_add_u32 m0, s78, 4096
    v_mfma_f32_16x16x32_bf16 a[188:191], a[68:71], a[60:63], a[188:191]
    buffer_load_dwordx4 v1, s[28:31], s72 offen offset:0 sc1 lds
    v_mfma_f32_16x16x32_bf16 v[124:127], a[68:71], a[116:119], v[124:127]
    ds_read_b64_tr_b16 a[68:69], v15 offset:0
    v_mfma_f32_16x16x32_bf16 v[52:55], a[32:35], a[72:75], v[52:55]
    ds_read_b64_tr_b16 a[70:71], v15 offset:256
    v_mfma_f32_16x16x32_bf16 v[56:59], a[36:39], a[72:75], v[56:59]
    v_mfma_f32_16x16x32_bf16 v[60:63], a[40:43], a[72:75], v[60:63]
    ds_read_b128 a[16:19], v8 offset:43008
    v_mfma_f32_16x16x32_bf16 v[64:67], a[44:47], a[72:75], v[64:67]
    buffer_load_dwordx4 v1, s[28:31], s73 offen offset:1024 sc1 lds
    v_mfma_f32_16x16x32_bf16 v[68:71], a[48:51], a[72:75], v[68:71]
    ds_read_b128 a[20:23], v8 offset:45056
    v_mfma_f32_16x16x32_bf16 v[72:75], a[52:55], a[72:75], v[72:75]
    v_mfma_f32_16x16x32_bf16 v[76:79], a[56:59], a[72:75], v[76:79]
    buffer_load_dwordx4 v1, s[28:31], s74 offen offset:2048 sc1 lds
    v_mfma_f32_16x16x32_bf16 v[80:83], a[60:63], a[72:75], v[80:83]
    v_mfma_f32_16x16x32_bf16 v[48:51], a[116:119], a[72:75], v[48:51]
    ds_read_b64_tr_b16 a[72:73], v13 offset:1024
    v_mfma_f32_16x16x32_bf16 v[88:91], a[32:35], a[76:79], v[88:91]
    ds_read_b64_tr_b16 a[74:75], v13 offset:1280
    v_mfma_f32_16x16x32_bf16 v[92:95], a[36:39], a[76:79], v[92:95]
    ds_read_b128 a[24:27], v8 offset:47104
    v_mfma_f32_16x16x32_bf16 v[96:99], a[40:43], a[76:79], v[96:99]
    buffer_load_dwordx4 v1, s[28:31], s75 offen offset:3072 sc1 lds
    v_add_u32 v1, 128, v1
    v_mfma_f32_16x16x32_bf16 v[100:103], a[44:47], a[76:79], v[100:103]
    ds_read_b128 a[28:31], v8 offset:49152
    v_mfma_f32_16x16x32_bf16 v[104:107], a[48:51], a[76:79], v[104:107]
    s_add_u32 m0, s78, 8192
    v_mfma_f32_16x16x32_bf16 v[108:111], a[52:55], a[76:79], v[108:111]
    buffer_load_dwordx4 v2, s[28:31], s68 offen offset:0 sc1 lds
    v_mfma_f32_16x16x32_bf16 v[112:115], a[56:59], a[76:79], v[112:115]
    v_mfma_f32_16x16x32_bf16 v[116:119], a[60:63], a[76:79], v[116:119]
    ds_read_b128 a[112:115], v10 offset:34816
    v_mfma_f32_16x16x32_bf16 v[84:87], a[116:119], a[76:79], v[84:87]
    ds_read_b64_tr_b16 a[76:77], v15 offset:1024
    v_mfma_f32_16x16x32_bf16 a[192:195], a[80:83], a[32:35], a[192:195]
    ds_read_b64_tr_b16 a[78:79], v15 offset:1280
    v_mfma_f32_16x16x32_bf16 a[200:203], a[80:83], a[36:39], a[200:203]
    buffer_load_dwordx4 v2, s[28:31], s69 offen offset:1024 sc1 lds
    v_mfma_f32_16x16x32_bf16 a[208:211], a[80:83], a[40:43], a[208:211]
    ds_read_b64_tr_b16 a[96:97], v13 offset:4096
    v_mfma_f32_16x16x32_bf16 a[216:219], a[80:83], a[44:47], a[216:219]
    buffer_load_dwordx4 v2, s[28:31], s70 offen offset:2048 sc1 lds
    v_mfma_f32_16x16x32_bf16 a[224:227], a[80:83], a[48:51], a[224:227]
    v_mfma_f32_16x16x32_bf16 a[232:235], a[80:83], a[52:55], a[232:235]
    v_mfma_f32_16x16x32_bf16 a[240:243], a[80:83], a[56:59], a[240:243]
    ds_read_b64_tr_b16 a[98:99], v13 offset:4352
    v_mfma_f32_16x16x32_bf16 a[248:251], a[80:83], a[60:63], a[248:251]
    ds_read_b64_tr_b16 a[80:81], v13 offset:2048
    v_mfma_f32_16x16x32_bf16 a[196:199], a[84:87], a[32:35], a[196:199]
    ds_read_b64_tr_b16 a[82:83], v13 offset:2304
    v_mfma_f32_16x16x32_bf16 a[204:207], a[84:87], a[36:39], a[204:207]
    buffer_load_dwordx4 v2, s[28:31], s71 offen offset:3072 sc1 lds
    v_mfma_f32_16x16x32_bf16 a[212:215], a[84:87], a[40:43], a[212:215]
    ds_read_b64_tr_b16 a[100:101], v15 offset:4096
    s_add_u32 m0, s78, 12288
    v_mfma_f32_16x16x32_bf16 a[220:223], a[84:87], a[44:47], a[220:223]
    buffer_load_dwordx4 v2, s[28:31], s72 offen offset:0 sc1 lds
    v_mfma_f32_16x16x32_bf16 a[228:231], a[84:87], a[48:51], a[228:231]
    v_mfma_f32_16x16x32_bf16 a[236:239], a[84:87], a[52:55], a[236:239]
    v_mfma_f32_16x16x32_bf16 a[244:247], a[84:87], a[56:59], a[244:247]
    ds_read_b64_tr_b16 a[102:103], v15 offset:4352
    v_mfma_f32_16x16x32_bf16 a[252:255], a[84:87], a[60:63], a[252:255]
    ds_read_b64_tr_b16 a[84:85], v15 offset:2048
    v_mfma_f32_16x16x32_bf16 v[128:131], a[88:91], a[32:35], v[128:131]
    ds_read_b64_tr_b16 a[86:87], v15 offset:2304
    v_mfma_f32_16x16x32_bf16 v[144:147], a[88:91], a[36:39], v[144:147]
    buffer_load_dwordx4 v2, s[28:31], s73 offen offset:1024 sc1 lds
    v_mfma_f32_16x16x32_bf16 v[160:163], a[88:91], a[40:43], v[160:163]
    v_mfma_f32_16x16x32_bf16 v[176:179], a[88:91], a[44:47], v[176:179]
    buffer_load_dwordx4 v2, s[28:31], s74 offen offset:2048 sc1 lds
    v_mfma_f32_16x16x32_bf16 v[192:195], a[88:91], a[48:51], v[192:195]
    v_mfma_f32_16x16x32_bf16 v[208:211], a[88:91], a[52:55], v[208:211]
    v_mfma_f32_16x16x32_bf16 v[224:227], a[88:91], a[56:59], v[224:227]
    v_mfma_f32_16x16x32_bf16 v[240:243], a[88:91], a[60:63], v[240:243]
    ds_read_b64_tr_b16 a[88:89], v13 offset:3072
    v_mfma_f32_16x16x32_bf16 v[132:135], a[92:95], a[32:35], v[132:135]
    ds_read_b64_tr_b16 a[90:91], v13 offset:3328
    v_mfma_f32_16x16x32_bf16 v[148:151], a[92:95], a[36:39], v[148:151]
    buffer_load_dwordx4 v2, s[28:31], s75 offen offset:3072 sc1 lds
    v_add_u32 v2, 128, v2
    v_mfma_f32_16x16x32_bf16 v[164:167], a[92:95], a[40:43], v[164:167]
    v_mfma_f32_16x16x32_bf16 v[180:183], a[92:95], a[44:47], v[180:183]
    v_mfma_f32_16x16x32_bf16 v[196:199], a[92:95], a[48:51], v[196:199]
    v_mfma_f32_16x16x32_bf16 v[212:215], a[92:95], a[52:55], v[212:215]
    v_mfma_f32_16x16x32_bf16 v[228:231], a[92:95], a[56:59], v[228:231]
    v_mfma_f32_16x16x32_bf16 v[244:247], a[92:95], a[60:63], v[244:247]
    ds_read_b64_tr_b16 a[92:93], v15 offset:3072
    v_mfma_f32_16x16x32_bf16 v[136:139], a[104:107], a[32:35], v[136:139]
    ds_read_b64_tr_b16 a[94:95], v15 offset:3328
    v_mfma_f32_16x16x32_bf16 v[152:155], a[104:107], a[36:39], v[152:155]
    v_mfma_f32_16x16x32_bf16 v[168:171], a[104:107], a[40:43], v[168:171]
    v_mfma_f32_16x16x32_bf16 v[184:187], a[104:107], a[44:47], v[184:187]
    v_mfma_f32_16x16x32_bf16 v[200:203], a[104:107], a[48:51], v[200:203]
    v_mfma_f32_16x16x32_bf16 v[216:219], a[104:107], a[52:55], v[216:219]
    v_mfma_f32_16x16x32_bf16 v[232:235], a[104:107], a[56:59], v[232:235]
    v_mfma_f32_16x16x32_bf16 v[248:251], a[104:107], a[60:63], v[248:251]
    v_mfma_f32_16x16x32_bf16 v[140:143], a[108:111], a[32:35], v[140:143]
    v_mfma_f32_16x16x32_bf16 v[156:159], a[108:111], a[36:39], v[156:159]
    v_mfma_f32_16x16x32_bf16 v[172:175], a[108:111], a[40:43], v[172:175]
    v_mfma_f32_16x16x32_bf16 v[188:191], a[108:111], a[44:47], v[188:191]
    v_mfma_f32_16x16x32_bf16 v[204:207], a[108:111], a[48:51], v[204:207]
    v_mfma_f32_16x16x32_bf16 v[220:223], a[108:111], a[52:55], v[220:223]
    v_mfma_f32_16x16x32_bf16 v[236:239], a[108:111], a[56:59], v[236:239]
    v_mfma_f32_16x16x32_bf16 v[252:255], a[108:111], a[60:63], v[252:255]
    s_waitcnt lgkmcnt(0)
    s_barrier
    v_mfma_f32_16x16x32_bf16 a[128:131], a[64:67], a[0:3], a[128:131]
    buffer_load_dword v7, v6, s[44:47], s4 offen
    v_add_u32_e64 v6, s79, v6
    v_mfma_f32_16x16x32_bf16 a[136:139], a[64:67], a[4:7], a[136:139]
    v_mfma_f32_16x16x32_bf16 a[144:147], a[64:67], a[8:11], a[144:147]
    ds_read_b128 a[32:35], v9 offset:34816
    v_mfma_f32_16x16x32_bf16 a[152:155], a[64:67], a[12:15], a[152:155]
    v_mfma_f32_16x16x32_bf16 a[160:163], a[64:67], a[16:19], a[160:163]
    v_mfma_f32_16x16x32_bf16 a[168:171], a[64:67], a[20:23], a[168:171]
    v_mfma_f32_16x16x32_bf16 a[176:179], a[64:67], a[24:27], a[176:179]
    ds_read_b128 a[36:39], v9 offset:36864
    v_mfma_f32_16x16x32_bf16 a[184:187], a[64:67], a[28:31], a[184:187]
    v_mfma_f32_16x16x32_bf16 v[120:123], a[64:67], a[112:115], v[120:123]
    ds_read_b64_tr_b16 a[64:65], v13 offset:20480
    v_mfma_f32_16x16x32_bf16 a[132:135], a[68:71], a[0:3], a[132:135]
    ds_read_b64_tr_b16 a[66:67], v13 offset:20736
    v_mfma_f32_16x16x32_bf16 a[140:143], a[68:71], a[4:7], a[140:143]
    ds_read_b128 a[40:43], v9 offset:38912
    v_mfma_f32_16x16x32_bf16 a[148:151], a[68:71], a[8:11], a[148:151]
    v_mfma_f32_16x16x32_bf16 a[156:159], a[68:71], a[12:15], a[156:159]
    v_mfma_f32_16x16x32_bf16 a[164:167], a[68:71], a[16:19], a[164:167]
    v_mfma_f32_16x16x32_bf16 a[172:175], a[68:71], a[20:23], a[172:175]
    ds_read_b128 a[44:47], v9 offset:40960
    v_mfma_f32_16x16x32_bf16 a[180:183], a[68:71], a[24:27], a[180:183]
    v_mfma_f32_16x16x32_bf16 a[188:191], a[68:71], a[28:31], a[188:191]
    v_mfma_f32_16x16x32_bf16 v[124:127], a[68:71], a[112:115], v[124:127]
    ds_read_b64_tr_b16 a[68:69], v15 offset:20480
    v_mfma_f32_16x16x32_bf16 v[52:55], a[0:3], a[72:75], v[52:55]
    ds_read_b64_tr_b16 a[70:71], v15 offset:20736
    v_mfma_f32_16x16x32_bf16 v[56:59], a[4:7], a[72:75], v[56:59]
    v_mfma_f32_16x16x32_bf16 v[60:63], a[8:11], a[72:75], v[60:63]
    ds_read_b128 a[48:51], v9 offset:43008
    v_mfma_f32_16x16x32_bf16 v[64:67], a[12:15], a[72:75], v[64:67]
    v_mfma_f32_16x16x32_bf16 v[68:71], a[16:19], a[72:75], v[68:71]
    ds_read_b128 a[52:55], v9 offset:45056
    v_mfma_f32_16x16x32_bf16 v[72:75], a[20:23], a[72:75], v[72:75]
    v_mfma_f32_16x16x32_bf16 v[76:79], a[24:27], a[72:75], v[76:79]
    v_mfma_f32_16x16x32_bf16 v[80:83], a[28:31], a[72:75], v[80:83]
    v_mfma_f32_16x16x32_bf16 v[48:51], a[112:115], a[72:75], v[48:51]
    ds_read_b64_tr_b16 a[72:73], v13 offset:21504
    v_mfma_f32_16x16x32_bf16 v[88:91], a[0:3], a[76:79], v[88:91]
    ds_read_b64_tr_b16 a[74:75], v13 offset:21760
    v_mfma_f32_16x16x32_bf16 v[92:95], a[4:7], a[76:79], v[92:95]
    ds_read_b128 a[56:59], v9 offset:47104
    v_mfma_f32_16x16x32_bf16 v[96:99], a[8:11], a[76:79], v[96:99]
    v_mfma_f32_16x16x32_bf16 v[100:103], a[12:15], a[76:79], v[100:103]
    ds_read_b128 a[60:63], v9 offset:49152
    v_mfma_f32_16x16x32_bf16 v[104:107], a[16:19], a[76:79], v[104:107]
    v_mfma_f32_16x16x32_bf16 v[108:111], a[20:23], a[76:79], v[108:111]
    v_mfma_f32_16x16x32_bf16 v[112:115], a[24:27], a[76:79], v[112:115]
    v_mfma_f32_16x16x32_bf16 v[116:119], a[28:31], a[76:79], v[116:119]
    ds_read_b128 a[116:119], v11 offset:34816
    v_mfma_f32_16x16x32_bf16 v[84:87], a[112:115], a[76:79], v[84:87]
    ds_read_b64_tr_b16 a[76:77], v15 offset:21504
    v_mfma_f32_16x16x32_bf16 a[192:195], a[80:83], a[0:3], a[192:195]
    ds_read_b64_tr_b16 a[78:79], v15 offset:21760
    v_mfma_f32_16x16x32_bf16 a[200:203], a[80:83], a[4:7], a[200:203]
    v_mfma_f32_16x16x32_bf16 a[208:211], a[80:83], a[8:11], a[208:211]
    ds_read_b64_tr_b16 a[104:105], v13 offset:24576
    v_mfma_f32_16x16x32_bf16 a[216:219], a[80:83], a[12:15], a[216:219]
    v_mfma_f32_16x16x32_bf16 a[224:227], a[80:83], a[16:19], a[224:227]
    v_mfma_f32_16x16x32_bf16 a[232:235], a[80:83], a[20:23], a[232:235]
    v_mfma_f32_16x16x32_bf16 a[240:243], a[80:83], a[24:27], a[240:243]
    ds_read_b64_tr_b16 a[106:107], v13 offset:24832
    v_mfma_f32_16x16x32_bf16 a[248:251], a[80:83], a[28:31], a[248:251]
    ds_read_b64_tr_b16 a[80:81], v13 offset:22528
    v_mfma_f32_16x16x32_bf16 a[196:199], a[84:87], a[0:3], a[196:199]
    ds_read_b64_tr_b16 a[82:83], v13 offset:22784
    v_mfma_f32_16x16x32_bf16 a[204:207], a[84:87], a[4:7], a[204:207]
    v_mfma_f32_16x16x32_bf16 a[212:215], a[84:87], a[8:11], a[212:215]
    ds_read_b64_tr_b16 a[108:109], v15 offset:24576
    v_mfma_f32_16x16x32_bf16 a[220:223], a[84:87], a[12:15], a[220:223]
    v_mfma_f32_16x16x32_bf16 a[228:231], a[84:87], a[16:19], a[228:231]
    v_mfma_f32_16x16x32_bf16 a[236:239], a[84:87], a[20:23], a[236:239]
    v_mfma_f32_16x16x32_bf16 a[244:247], a[84:87], a[24:27], a[244:247]
    ds_read_b64_tr_b16 a[110:111], v15 offset:24832
    v_mfma_f32_16x16x32_bf16 a[252:255], a[84:87], a[28:31], a[252:255]
    ds_read_b64_tr_b16 a[84:85], v15 offset:22528
    v_mfma_f32_16x16x32_bf16 v[128:131], a[88:91], a[0:3], v[128:131]
    ds_read_b64_tr_b16 a[86:87], v15 offset:22784
    v_mfma_f32_16x16x32_bf16 v[144:147], a[88:91], a[4:7], v[144:147]
    v_mfma_f32_16x16x32_bf16 v[160:163], a[88:91], a[8:11], v[160:163]
    v_mfma_f32_16x16x32_bf16 v[176:179], a[88:91], a[12:15], v[176:179]
    v_mfma_f32_16x16x32_bf16 v[192:195], a[88:91], a[16:19], v[192:195]
    v_mfma_f32_16x16x32_bf16 v[208:211], a[88:91], a[20:23], v[208:211]
    v_mfma_f32_16x16x32_bf16 v[224:227], a[88:91], a[24:27], v[224:227]
    v_mfma_f32_16x16x32_bf16 v[240:243], a[88:91], a[28:31], v[240:243]
    ds_read_b64_tr_b16 a[88:89], v13 offset:23552
    v_mfma_f32_16x16x32_bf16 v[132:135], a[92:95], a[0:3], v[132:135]
    ds_read_b64_tr_b16 a[90:91], v13 offset:23808
    v_mfma_f32_16x16x32_bf16 v[148:151], a[92:95], a[4:7], v[148:151]
    v_mfma_f32_16x16x32_bf16 v[164:167], a[92:95], a[8:11], v[164:167]
    v_mfma_f32_16x16x32_bf16 v[180:183], a[92:95], a[12:15], v[180:183]
    v_mfma_f32_16x16x32_bf16 v[196:199], a[92:95], a[16:19], v[196:199]
    v_mfma_f32_16x16x32_bf16 v[212:215], a[92:95], a[20:23], v[212:215]
    v_mfma_f32_16x16x32_bf16 v[228:231], a[92:95], a[24:27], v[228:231]
    v_mfma_f32_16x16x32_bf16 v[244:247], a[92:95], a[28:31], v[244:247]
    ds_read_b64_tr_b16 a[92:93], v15 offset:23552
    v_mfma_f32_16x16x32_bf16 v[136:139], a[96:99], a[0:3], v[136:139]
    ds_read_b64_tr_b16 a[94:95], v15 offset:23808
    v_mfma_f32_16x16x32_bf16 v[152:155], a[96:99], a[4:7], v[152:155]
    v_mfma_f32_16x16x32_bf16 v[168:171], a[96:99], a[8:11], v[168:171]
    v_mfma_f32_16x16x32_bf16 v[184:187], a[96:99], a[12:15], v[184:187]
    v_mfma_f32_16x16x32_bf16 v[200:203], a[96:99], a[16:19], v[200:203]
    v_mfma_f32_16x16x32_bf16 v[216:219], a[96:99], a[20:23], v[216:219]
    v_mfma_f32_16x16x32_bf16 v[232:235], a[96:99], a[24:27], v[232:235]
    v_mfma_f32_16x16x32_bf16 v[248:251], a[96:99], a[28:31], v[248:251]
    v_mfma_f32_16x16x32_bf16 v[140:143], a[100:103], a[0:3], v[140:143]
    v_mfma_f32_16x16x32_bf16 v[156:159], a[100:103], a[4:7], v[156:159]
    v_mfma_f32_16x16x32_bf16 v[172:175], a[100:103], a[8:11], v[172:175]
    v_mfma_f32_16x16x32_bf16 v[188:191], a[100:103], a[12:15], v[188:191]
    v_mfma_f32_16x16x32_bf16 v[204:207], a[100:103], a[16:19], v[204:207]
    v_mfma_f32_16x16x32_bf16 v[220:223], a[100:103], a[20:23], v[220:223]
    v_mfma_f32_16x16x32_bf16 v[236:239], a[100:103], a[24:27], v[236:239]
    v_mfma_f32_16x16x32_bf16 v[252:255], a[100:103], a[28:31], v[252:255]
    s_waitcnt vmcnt(1) lgkmcnt(0)
    s_barrier
    v_mfma_f32_16x16x32_bf16 a[128:131], a[64:67], a[32:35], a[128:131]
    s_add_u32 m0, s78, 34816
    v_mfma_f32_16x16x32_bf16 a[136:139], a[64:67], a[36:39], a[136:139]
    buffer_load_dwordx4 v1, s[28:31], s68 offen offset:0 sc1 lds
    v_mfma_f32_16x16x32_bf16 a[144:147], a[64:67], a[40:43], a[144:147]
    ds_read_b128 a[0:3], v8 offset:0
    v_mfma_f32_16x16x32_bf16 a[152:155], a[64:67], a[44:47], a[152:155]
    v_mfma_f32_16x16x32_bf16 a[160:163], a[64:67], a[48:51], a[160:163]
    buffer_load_dwordx4 v1, s[28:31], s69 offen offset:1024 sc1 lds
    v_mfma_f32_16x16x32_bf16 a[168:171], a[64:67], a[52:55], a[168:171]
    v_mfma_f32_16x16x32_bf16 a[176:179], a[64:67], a[56:59], a[176:179]
    ds_read_b128 a[4:7], v8 offset:2048
    v_mfma_f32_16x16x32_bf16 a[184:187], a[64:67], a[60:63], a[184:187]
    v_mfma_f32_16x16x32_bf16 v[120:123], a[64:67], a[116:119], v[120:123]
    ds_read_b64_tr_b16 a[64:65], v12 offset:0
    v_mfma_f32_16x16x32_bf16 a[132:135], a[68:71], a[32:35], a[132:135]
    ds_read_b64_tr_b16 a[66:67], v12 offset:256
    v_mfma_f32_16x16x32_bf16 a[140:143], a[68:71], a[36:39], a[140:143]
    ds_read_b128 a[8:11], v8 offset:4096
    v_mfma_f32_16x16x32_bf16 a[148:151], a[68:71], a[40:43], a[148:151]
    buffer_load_dwordx4 v1, s[28:31], s70 offen offset:2048 sc1 lds
    v_mfma_f32_16x16x32_bf16 a[156:159], a[68:71], a[44:47], a[156:159]
    buffer_load_dwordx4 v1, s[28:31], s71 offen offset:3072 sc1 lds
    v_mfma_f32_16x16x32_bf16 a[164:167], a[68:71], a[48:51], a[164:167]
    v_mfma_f32_16x16x32_bf16 a[172:175], a[68:71], a[52:55], a[172:175]
    ds_read_b128 a[12:15], v8 offset:6144
    v_mfma_f32_16x16x32_bf16 a[180:183], a[68:71], a[56:59], a[180:183]
    s_add_u32 m0, s78, 38912
    v_mfma_f32_16x16x32_bf16 a[188:191], a[68:71], a[60:63], a[188:191]
    buffer_load_dwordx4 v1, s[28:31], s72 offen offset:0 sc1 lds
    v_mfma_f32_16x16x32_bf16 v[124:127], a[68:71], a[116:119], v[124:127]
    ds_read_b64_tr_b16 a[68:69], v14 offset:0
    v_mfma_f32_16x16x32_bf16 v[52:55], a[32:35], a[72:75], v[52:55]
    ds_read_b64_tr_b16 a[70:71], v14 offset:256
    v_mfma_f32_16x16x32_bf16 v[56:59], a[36:39], a[72:75], v[56:59]
    v_mfma_f32_16x16x32_bf16 v[60:63], a[40:43], a[72:75], v[60:63]
    ds_read_b128 a[16:19], v8 offset:8192
    v_mfma_f32_16x16x32_bf16 v[64:67], a[44:47], a[72:75], v[64:67]
    buffer_load_dwordx4 v1, s[28:31], s73 offen offset:1024 sc1 lds
    v_mfma_f32_16x16x32_bf16 v[68:71], a[48:51], a[72:75], v[68:71]
    ds_read_b128 a[20:23], v8 offset:10240
    v_mfma_f32_16x16x32_bf16 v[72:75], a[52:55], a[72:75], v[72:75]
    v_mfma_f32_16x16x32_bf16 v[76:79], a[56:59], a[72:75], v[76:79]
    buffer_load_dwordx4 v1, s[28:31], s74 offen offset:2048 sc1 lds
    v_mfma_f32_16x16x32_bf16 v[80:83], a[60:63], a[72:75], v[80:83]
    v_mfma_f32_16x16x32_bf16 v[48:51], a[116:119], a[72:75], v[48:51]
    ds_read_b64_tr_b16 a[72:73], v12 offset:1024
    v_mfma_f32_16x16x32_bf16 v[88:91], a[32:35], a[76:79], v[88:91]
    ds_read_b64_tr_b16 a[74:75], v12 offset:1280
    v_mfma_f32_16x16x32_bf16 v[92:95], a[36:39], a[76:79], v[92:95]
    ds_read_b128 a[24:27], v8 offset:12288
    v_mfma_f32_16x16x32_bf16 v[96:99], a[40:43], a[76:79], v[96:99]
    buffer_load_dwordx4 v1, s[28:31], s75 offen offset:3072 sc1 lds
    v_add_u32 v1, 128, v1
    v_mfma_f32_16x16x32_bf16 v[100:103], a[44:47], a[76:79], v[100:103]
    ds_read_b128 a[28:31], v8 offset:14336
    v_mfma_f32_16x16x32_bf16 v[104:107], a[48:51], a[76:79], v[104:107]
    s_add_u32 m0, s78, 43008
    v_mfma_f32_16x16x32_bf16 v[108:111], a[52:55], a[76:79], v[108:111]
    buffer_load_dwordx4 v2, s[28:31], s68 offen offset:0 sc1 lds
    v_mfma_f32_16x16x32_bf16 v[112:115], a[56:59], a[76:79], v[112:115]
    v_mfma_f32_16x16x32_bf16 v[116:119], a[60:63], a[76:79], v[116:119]
    ds_read_b128 a[112:115], v10 offset:0
    v_mfma_f32_16x16x32_bf16 v[84:87], a[116:119], a[76:79], v[84:87]
    ds_read_b64_tr_b16 a[76:77], v14 offset:1024
    v_mfma_f32_16x16x32_bf16 a[192:195], a[80:83], a[32:35], a[192:195]
    ds_read_b64_tr_b16 a[78:79], v14 offset:1280
    v_mfma_f32_16x16x32_bf16 a[200:203], a[80:83], a[36:39], a[200:203]
    buffer_load_dwordx4 v2, s[28:31], s69 offen offset:1024 sc1 lds
    v_mfma_f32_16x16x32_bf16 a[208:211], a[80:83], a[40:43], a[208:211]
    ds_read_b64_tr_b16 a[96:97], v12 offset:4096
    v_mfma_f32_16x16x32_bf16 a[216:219], a[80:83], a[44:47], a[216:219]
    buffer_load_dwordx4 v2, s[28:31], s70 offen offset:2048 sc1 lds
    v_mfma_f32_16x16x32_bf16 a[224:227], a[80:83], a[48:51], a[224:227]
    v_mfma_f32_16x16x32_bf16 a[232:235], a[80:83], a[52:55], a[232:235]
    v_mfma_f32_16x16x32_bf16 a[240:243], a[80:83], a[56:59], a[240:243]
    ds_read_b64_tr_b16 a[98:99], v12 offset:4352
    v_mfma_f32_16x16x32_bf16 a[248:251], a[80:83], a[60:63], a[248:251]
    ds_read_b64_tr_b16 a[80:81], v12 offset:2048
    v_mfma_f32_16x16x32_bf16 a[196:199], a[84:87], a[32:35], a[196:199]
    ds_read_b64_tr_b16 a[82:83], v12 offset:2304
    v_mfma_f32_16x16x32_bf16 a[204:207], a[84:87], a[36:39], a[204:207]
    buffer_load_dwordx4 v2, s[28:31], s71 offen offset:3072 sc1 lds
    v_mfma_f32_16x16x32_bf16 a[212:215], a[84:87], a[40:43], a[212:215]
    ds_read_b64_tr_b16 a[100:101], v14 offset:4096
    s_add_u32 m0, s78, 47104
    v_mfma_f32_16x16x32_bf16 a[220:223], a[84:87], a[44:47], a[220:223]
    buffer_load_dwordx4 v2, s[28:31], s72 offen offset:0 sc1 lds
    v_mfma_f32_16x16x32_bf16 a[228:231], a[84:87], a[48:51], a[228:231]
    v_mfma_f32_16x16x32_bf16 a[236:239], a[84:87], a[52:55], a[236:239]
    v_mfma_f32_16x16x32_bf16 a[244:247], a[84:87], a[56:59], a[244:247]
    ds_read_b64_tr_b16 a[102:103], v14 offset:4352
    v_mfma_f32_16x16x32_bf16 a[252:255], a[84:87], a[60:63], a[252:255]
    ds_read_b64_tr_b16 a[84:85], v14 offset:2048
    v_mfma_f32_16x16x32_bf16 v[128:131], a[88:91], a[32:35], v[128:131]
    ds_read_b64_tr_b16 a[86:87], v14 offset:2304
    v_mfma_f32_16x16x32_bf16 v[144:147], a[88:91], a[36:39], v[144:147]
    buffer_load_dwordx4 v2, s[28:31], s73 offen offset:1024 sc1 lds
    v_mfma_f32_16x16x32_bf16 v[160:163], a[88:91], a[40:43], v[160:163]
    v_mfma_f32_16x16x32_bf16 v[176:179], a[88:91], a[44:47], v[176:179]
    buffer_load_dwordx4 v2, s[28:31], s74 offen offset:2048 sc1 lds
    v_mfma_f32_16x16x32_bf16 v[192:195], a[88:91], a[48:51], v[192:195]
    v_mfma_f32_16x16x32_bf16 v[208:211], a[88:91], a[52:55], v[208:211]
    v_mfma_f32_16x16x32_bf16 v[224:227], a[88:91], a[56:59], v[224:227]
    v_mfma_f32_16x16x32_bf16 v[240:243], a[88:91], a[60:63], v[240:243]
    ds_read_b64_tr_b16 a[88:89], v12 offset:3072
    v_mfma_f32_16x16x32_bf16 v[132:135], a[92:95], a[32:35], v[132:135]
    ds_read_b64_tr_b16 a[90:91], v12 offset:3328
    v_mfma_f32_16x16x32_bf16 v[148:151], a[92:95], a[36:39], v[148:151]
    buffer_load_dwordx4 v2, s[28:31], s75 offen offset:3072 sc1 lds
    v_add_u32 v2, 128, v2
    v_mfma_f32_16x16x32_bf16 v[164:167], a[92:95], a[40:43], v[164:167]
    v_mfma_f32_16x16x32_bf16 v[180:183], a[92:95], a[44:47], v[180:183]
    v_mfma_f32_16x16x32_bf16 v[196:199], a[92:95], a[48:51], v[196:199]
    v_mfma_f32_16x16x32_bf16 v[212:215], a[92:95], a[52:55], v[212:215]
    v_mfma_f32_16x16x32_bf16 v[228:231], a[92:95], a[56:59], v[228:231]
    v_mfma_f32_16x16x32_bf16 v[244:247], a[92:95], a[60:63], v[244:247]
    ds_read_b64_tr_b16 a[92:93], v14 offset:3072
    v_mfma_f32_16x16x32_bf16 v[136:139], a[104:107], a[32:35], v[136:139]
    ds_read_b64_tr_b16 a[94:95], v14 offset:3328
    v_mfma_f32_16x16x32_bf16 v[152:155], a[104:107], a[36:39], v[152:155]
    v_mfma_f32_16x16x32_bf16 v[168:171], a[104:107], a[40:43], v[168:171]
    v_mfma_f32_16x16x32_bf16 v[184:187], a[104:107], a[44:47], v[184:187]
    v_mfma_f32_16x16x32_bf16 v[200:203], a[104:107], a[48:51], v[200:203]
    v_mfma_f32_16x16x32_bf16 v[216:219], a[104:107], a[52:55], v[216:219]
    v_mfma_f32_16x16x32_bf16 v[232:235], a[104:107], a[56:59], v[232:235]
    v_mfma_f32_16x16x32_bf16 v[248:251], a[104:107], a[60:63], v[248:251]
    v_mfma_f32_16x16x32_bf16 v[140:143], a[108:111], a[32:35], v[140:143]
    v_mfma_f32_16x16x32_bf16 v[156:159], a[108:111], a[36:39], v[156:159]
    v_mfma_f32_16x16x32_bf16 v[172:175], a[108:111], a[40:43], v[172:175]
    v_mfma_f32_16x16x32_bf16 v[188:191], a[108:111], a[44:47], v[188:191]
    v_mfma_f32_16x16x32_bf16 v[204:207], a[108:111], a[48:51], v[204:207]
    v_mfma_f32_16x16x32_bf16 v[220:223], a[108:111], a[52:55], v[220:223]
    v_mfma_f32_16x16x32_bf16 v[236:239], a[108:111], a[56:59], v[236:239]
    v_mfma_f32_16x16x32_bf16 v[252:255], a[108:111], a[60:63], v[252:255]
    s_sub_u32 s67, s67, 1
    s_cmp_lg_u32 s67, 0
    s_cbranch_scc1 L_loop0
L_tail0:
    s_waitcnt lgkmcnt(0)
    s_barrier
    v_mfma_f32_16x16x32_bf16 a[128:131], a[64:67], a[0:3], a[128:131]
    s_getpc_b64 s[86:87]
L_pc0:
    s_sub_u32 s86, s86, L_pc0-L_tail0
    s_subb_u32 s87, s87, 0
    s_lshr_b32 s82, s2, 3
    s_lshl_b32 s82, s82, 2
    s_add_u32 s82, s82, s60
    s_lshl_b32 s82, s82, 10
    v_add_u32 v34, s82, v16
    v_min_u32 v34, L_code_end-L_tail0-4, v34
    global_load_dword v7, v34, s[86:87]
    v_mfma_f32_16x16x32_bf16 a[136:139], a[64:67], a[4:7], a[136:139]
    v_mfma_f32_16x16x32_bf16 a[144:147], a[64:67], a[8:11], a[144:147]
    ds_read_b128 a[32:35], v9 offset:0
    v_mfma_f32_16x16x32_bf16 a[152:155], a[64:67], a[12:15], a[152:155]
    v_mfma_f32_16x16x32_bf16 a[160:163], a[64:67], a[16:19], a[160:163]
    s_mul_i32 s82, s65, 1835008
    s_lshl_b32 s83, s66, 8
    v_mfma_f32_16x16x32_bf16 a[168:171], a[64:67], a[20:23], a[168:171]
    s_add_u32 s82, s82, s83
    s_add_u32 s48, s20, s82
    v_mfma_f32_16x16x32_bf16 a[176:179], a[64:67], a[24:27], a[176:179]
    ds_read_b128 a[36:39], v9 offset:2048
    s_addc_u32 s49, s21, 0
    s_and_b32 s49, s49, 0xffff
    v_mfma_f32_16x16x32_bf16 a[184:187], a[64:67], a[28:31], a[184:187]
    s_sub_u32 s50, 7340032, s82
    s_mov_b32 s51, 0x20000
    v_mfma_f32_16x16x32_bf16 v[120:123], a[64:67], a[112:115], v[120:123]
    ds_read_b64_tr_b16 a[64:65], v12 offset:20480
    s_add_u32 s52, s12, s83
    s_addc_u32 s53, s13, 0
    v_mfma_f32_16x16x32_bf16 a[132:135], a[68:71], a[0:3], a[132:135]
    ds_read_b64_tr_b16 a[66:67], v12 offset:20736
    s_and_b32 s53, s53, 0xffff
    s_sub_u32 s54, 2097152, s83
    v_mfma_f32_16x16x32_bf16 a[140:143], a[68:71], a[4:7], a[140:143]
    ds_read_b128 a[40:43], v9 offset:4096
    s_mov_b32 s55, 0x20000
    s_lshl_b32 s3, s60, 11
    v_mfma_f32_16x16x32_bf16 a[148:151], a[68:71], a[8:11], a[148:151]
    v_lshrrev_b32 v34, 4, v0
    v_and_b32 v35, 15, v0
    v_mfma_f32_16x16x32_bf16 a[156:159], a[68:71], a[12:15], a[156:159]
    v_lshlrev_b32 v36, 1, v34
    v_add_u32 v36, 0, v36
    v_mfma_f32_16x16x32_bf16 a[164:167], a[68:71], a[16:19], a[164:167]
    v_xor_b32 v36, v36, v35
    v_lshlrev_b32 v36, 4, v36
    v_mfma_f32_16x16x32_bf16 a[172:175], a[68:71], a[20:23], a[172:175]
    ds_read_b128 a[44:47], v9 offset:6144
    v_lshl_add_u32 v36, v34, 11, v36
    s_lshl_b32 s82, s60, 14
    v_mfma_f32_16x16x32_bf16 a[180:183], a[68:71], a[24:27], a[180:183]
    s_add_u32 s82, s82, 0
    v_add_u32 v17, s82, v36
    v_mfma_f32_16x16x32_bf16 a[188:191], a[68:71], a[28:31], a[188:191]
    s_lshl_b32 s82, s62, 1
    s_add_u32 s82, s82, 0
    v_mfma_f32_16x16x32_bf16 v[124:127], a[68:71], a[112:115], v[124:127]
    ds_read_b64_tr_b16 a[68:69], v14 offset:20480
    s_lshl_b32 s82, s82, 3
    s_lshl_b32 s83, s61, 2
    v_mfma_f32_16x16x32_bf16 v[52:55], a[0:3], a[72:75], v[52:55]
    ds_read_b64_tr_b16 a[70:71], v14 offset:20736
    s_add_u32 s82, s82, s83
    s_mul_i32 s83, s62, 96
    v_mfma_f32_16x16x32_bf16 v[56:59], a[4:7], a[72:75], v[56:59]
    s_add_u32 s82, s82, s83
    s_lshl_b32 s82, s82, 11
    v_mfma_f32_16x16x32_bf16 v[60:63], a[8:11], a[72:75], v[60:63]
    ds_read_b128 a[48:51], v9 offset:8192
    s_sub_u32 s82, s82, 0
    v_add_u32 v19, s82, v36
    v_mfma_f32_16x16x32_bf16 v[64:67], a[12:15], a[72:75], v[64:67]
    v_lshlrev_b32 v36, 1, v34
    v_add_u32 v36, 8, v36
    v_mfma_f32_16x16x32_bf16 v[68:71], a[16:19], a[72:75], v[68:71]
    ds_read_b128 a[52:55], v9 offset:10240
    v_xor_b32 v36, v36, v35
    v_lshlrev_b32 v36, 4, v36
    v_mfma_f32_16x16x32_bf16 v[72:75], a[20:23], a[72:75], v[72:75]
    v_lshl_add_u32 v36, v34, 11, v36
    s_lshl_b32 s82, s60, 14
    v_mfma_f32_16x16x32_bf16 v[76:79], a[24:27], a[72:75], v[76:79]
    s_add_u32 s82, s82, 7168
    v_add_u32 v18, s82, v36
    v_mfma_f32_16x16x32_bf16 v[80:83], a[28:31], a[72:75], v[80:83]
    s_lshl_b32 s82, s62, 1
    s_add_u32 s82, s82, 1
    v_mfma_f32_16x16x32_bf16 v[48:51], a[112:115], a[72:75], v[48:51]
    ds_read_b64_tr_b16 a[72:73], v12 offset:21504
    s_lshl_b32 s82, s82, 3
    s_lshl_b32 s83, s61, 2
    v_mfma_f32_16x16x32_bf16 v[88:91], a[0:3], a[76:79], v[88:91]
    ds_read_b64_tr_b16 a[74:75], v12 offset:21760
    s_add_u32 s82, s82, s83
    s_mul_i32 s83, s62, 96
    v_mfma_f32_16x16x32_bf16 v[92:95], a[4:7], a[76:79], v[92:95]
    ds_read_b128 a[56:59], v9 offset:12288
    s_add_u32 s82, s82, s83
    s_lshl_b32 s82, s82, 11
    v_mfma_f32_16x16x32_bf16 v[96:99], a[8:11], a[76:79], v[96:99]
    s_sub_u32 s82, s82, 1024
    v_add_u32 v20, s82, v36
    v_mfma_f32_16x16x32_bf16 v[100:103], a[12:15], a[76:79], v[100:103]
    ds_read_b128 a[60:63], v9 offset:14336
    v_mfma_f32_16x16x32_bf16 v[104:107], a[16:19], a[76:79], v[104:107]
    v_mfma_f32_16x16x32_bf16 v[108:111], a[20:23], a[76:79], v[108:111]
    v_mfma_f32_16x16x32_bf16 v[112:115], a[24:27], a[76:79], v[112:115]
    v_mfma_f32_16x16x32_bf16 v[116:119], a[28:31], a[76:79], v[116:119]
    ds_read_b128 a[116:119], v11 offset:0
    v_mfma_f32_16x16x32_bf16 v[84:87], a[112:115], a[76:79], v[84:87]
    ds_read_b64_tr_b16 a[76:77], v14 offset:21504
    v_mfma_f32_16x16x32_bf16 a[192:195], a[80:83], a[0:3], a[192:195]
    ds_read_b64_tr_b16 a[78:79], v14 offset:21760
    v_mfma_f32_16x16x32_bf16 a[200:203], a[80:83], a[4:7], a[200:203]
    v_mfma_f32_16x16x32_bf16 a[208:211], a[80:83], a[8:11], a[208:211]
    ds_read_b64_tr_b16 a[104:105], v12 offset:24576
    v_mfma_f32_16x16x32_bf16 a[216:219], a[80:83], a[12:15], a[216:219]
    v_mfma_f32_16x16x32_bf16 a[224:227], a[80:83], a[16:19], a[224:227]
    v_mfma_f32_16x16x32_bf16 a[232:235], a[80:83], a[20:23], a[232:235]
    v_mfma_f32_16x16x32_bf16 a[240:243], a[80:83], a[24:27], a[240:243]
    ds_read_b64_tr_b16 a[106:107], v12 offset:24832
    v_mfma_f32_16x16x32_bf16 a[248:251], a[80:83], a[28:31], a[248:251]
    ds_read_b64_tr_b16 a[80:81], v12 offset:22528
    v_mfma_f32_16x16x32_bf16 a[196:199], a[84:87], a[0:3], a[196:199]
    ds_read_b64_tr_b16 a[82:83], v12 offset:22784
    s_mov_b32 s81, 294912
    s_add_u32 m0, s3, 73728
    v_mfma_f32_16x16x32_bf16 a[204:207], a[84:87], a[4:7], a[204:207]
    buffer_load_dwordx4 v17, s[48:51], s81 offen lds
    v_mfma_f32_16x16x32_bf16 a[212:215], a[84:87], a[8:11], a[212:215]
    ds_read_b64_tr_b16 a[108:109], v14 offset:24576
    v_mfma_f32_16x16x32_bf16 a[220:223], a[84:87], a[12:15], a[220:223]
    v_mfma_f32_16x16x32_bf16 a[228:231], a[84:87], a[16:19], a[228:231]
    v_mfma_f32_16x16x32_bf16 a[236:239], a[84:87], a[20:23], a[236:239]
    v_mfma_f32_16x16x32_bf16 a[244:247], a[84:87], a[24:27], a[244:247]
    ds_read_b64_tr_b16 a[110:111], v14 offset:24832
    buffer_load_dwordx4 v18, s[48:51], s81 offen offset:1024 lds
    v_mfma_f32_16x16x32_bf16 a[252:255], a[84:87], a[28:31], a[252:255]
    ds_read_b64_tr_b16 a[84:85], v14 offset:22528
    v_mfma_f32_16x16x32_bf16 v[128:131], a[88:91], a[0:3], v[128:131]
    ds_read_b64_tr_b16 a[86:87], v14 offset:22784
    v_mfma_f32_16x16x32_bf16 v[144:147], a[88:91], a[4:7], v[144:147]
    v_mfma_f32_16x16x32_bf16 v[160:163], a[88:91], a[8:11], v[160:163]
    s_mov_b32 s80, 524288
    s_add_u32 m0, s3, 81920
    v_mfma_f32_16x16x32_bf16 v[176:179], a[88:91], a[12:15], v[176:179]
    buffer_load_dwordx4 v17, s[48:51], s80 offen lds
    v_mfma_f32_16x16x32_bf16 v[192:195], a[88:91], a[16:19], v[192:195]
    v_mfma_f32_16x16x32_bf16 v[208:211], a[88:91], a[20:23], v[208:211]
    v_mfma_f32_16x16x32_bf16 v[224:227], a[88:91], a[24:27], v[224:227]
    v_mfma_f32_16x16x32_bf16 v[240:243], a[88:91], a[28:31], v[240:243]
    ds_read_b64_tr_b16 a[88:89], v12 offset:23552
    v_mfma_f32_16x16x32_bf16 v[132:135], a[92:95], a[0:3], v[132:135]
    ds_read_b64_tr_b16 a[90:91], v12 offset:23808
    buffer_load_dwordx4 v18, s[48:51], s80 offen offset:1024 lds
    v_mfma_f32_16x16x32_bf16 v[148:151], a[92:95], a[4:7], v[148:151]
    v_mfma_f32_16x16x32_bf16 v[164:167], a[92:95], a[8:11], v[164:167]
    v_mfma_f32_16x16x32_bf16 v[180:183], a[92:95], a[12:15], v[180:183]
    v_mfma_f32_16x16x32_bf16 v[196:199], a[92:95], a[16:19], v[196:199]
    s_mov_b32 s81, 819200
    s_add_u32 m0, s3, 155648
    v_mfma_f32_16x16x32_bf16 v[212:215], a[92:95], a[20:23], v[212:215]
    buffer_load_dwordx4 v17, s[48:51], s81 offen lds
    v_mfma_f32_16x16x32_bf16 v[228:231], a[92:95], a[24:27], v[228:231]
    v_mfma_f32_16x16x32_bf16 v[244:247], a[92:95], a[28:31], v[244:247]
    ds_read_b64_tr_b16 a[92:93], v14 offset:23552
    v_mfma_f32_16x16x32_bf16 v[136:139], a[96:99], a[0:3], v[136:139]
    ds_read_b64_tr_b16 a[94:95], v14 offset:23808
    v_mfma_f32_16x16x32_bf16 v[152:155], a[96:99], a[4:7], v[152:155]
    v_mfma_f32_16x16x32_bf16 v[168:171], a[96:99], a[8:11], v[168:171]
    buffer_load_dwordx4 v18, s[48:51], s81 offen offset:1024 lds
    v_mfma_f32_16x16x32_bf16 v[184:187], a[96:99], a[12:15], v[184:187]
    v_mfma_f32_16x16x32_bf16 v[200:203], a[96:99], a[16:19], v[200:203]
    v_mfma_f32_16x16x32_bf16 v[216:219], a[96:99], a[20:23], v[216:219]
    v_mfma_f32_16x16x32_bf16 v[232:235], a[96:99], a[24:27], v[232:235]
    v_mfma_f32_16x16x32_bf16 v[248:251], a[96:99], a[28:31], v[248:251]
    v_mfma_f32_16x16x32_bf16 v[140:143], a[100:103], a[0:3], v[140:143]
    v_mfma_f32_16x16x32_bf16 v[156:159], a[100:103], a[4:7], v[156:159]
    v_mfma_f32_16x16x32_bf16 v[172:175], a[100:103], a[8:11], v[172:175]
    v_mfma_f32_16x16x32_bf16 v[188:191], a[100:103], a[12:15], v[188:191]
    v_mfma_f32_16x16x32_bf16 v[204:207], a[100:103], a[16:19], v[204:207]
    v_mfma_f32_16x16x32_bf16 v[220:223], a[100:103], a[20:23], v[220:223]
    v_mfma_f32_16x16x32_bf16 v[236:239], a[100:103], a[24:27], v[236:239]
    v_mfma_f32_16x16x32_bf16 v[252:255], a[100:103], a[28:31], v[252:255]
    s_waitcnt vmcnt(7) lgkmcnt(0)
    s_barrier
    v_mfma_f32_16x16x32_bf16 a[128:131], a[64:67], a[32:35], a[128:131]
    v_mfma_f32_16x16x32_bf16 a[136:139], a[64:67], a[36:39], a[136:139]
    v_mfma_f32_16x16x32_bf16 a[144:147], a[64:67], a[40:43], a[144:147]
    ds_read_b128 a[0:3], v8 offset:34816
    s_mov_b32 s80, 0
    s_add_u32 m0, s3, 0
    v_mfma_f32_16x16x32_bf16 a[152:155], a[64:67], a[44:47], a[152:155]
    buffer_load_dwordx4 v17, s[48:51], s80 offen lds
    v_mfma_f32_16x16x32_bf16 a[160:163], a[64:67], a[48:51], a[160:163]
    s_xor_b32 s82, s65, 0
    v_mfma_f32_16x16x32_bf16 a[168:171], a[64:67], a[52:55], a[168:171]
    s_lshl_b32 s82, s82, 10
    v_mfma_f32_16x16x32_bf16 a[176:179], a[64:67], a[56:59], a[176:179]
    ds_read_b128 a[4:7], v8 offset:36864
    v_add_u32 v21, s82, v16
    v_mfma_f32_16x16x32_bf16 a[184:187], a[64:67], a[60:63], a[184:187]
    s_xor_b32 s82, s65, 1
    v_mfma_f32_16x16x32_bf16 v[120:123], a[64:67], a[116:119], v[120:123]
    ds_read_b64_tr_b16 a[64:65], v13 offset:0
    s_lshl_b32 s82, s82, 10
    v_mfma_f32_16x16x32_bf16 a[132:135], a[68:71], a[32:35], a[132:135]
    ds_read_b64_tr_b16 a[66:67], v13 offset:256
    v_add_u32 v22, s82, v16
    buffer_load_dwordx4 v18, s[48:51], s80 offen offset:1024 lds
    v_mfma_f32_16x16x32_bf16 a[140:143], a[68:71], a[36:39], a[140:143]
    ds_read_b128 a[8:11], v8 offset:38912
    s_xor_b32 s82, s65, 2
    v_mfma_f32_16x16x32_bf16 a[148:151], a[68:71], a[40:43], a[148:151]
    s_lshl_b32 s82, s82, 10
    v_mfma_f32_16x16x32_bf16 a[156:159], a[68:71], a[44:47], a[156:159]
    v_add_u32 v23, s82, v16
    v_mfma_f32_16x16x32_bf16 a[164:167], a[68:71], a[48:51], a[164:167]
    s_xor_b32 s82, s65, 3
    v_mfma_f32_16x16x32_bf16 a[172:175], a[68:71], a[52:55], a[172:175]
    ds_read_b128 a[12:15], v8 offset:40960
    s_lshl_b32 s82, s82, 10
    s_mov_b32 s81, 229376
    s_add_u32 m0, s3, 8192
    v_mfma_f32_16x16x32_bf16 a[180:183], a[68:71], a[56:59], a[180:183]
    v_add_u32 v24, s82, v16
    buffer_load_dwordx4 v17, s[48:51], s81 offen lds
    v_mfma_f32_16x16x32_bf16 a[188:191], a[68:71], a[60:63], a[188:191]
    s_mov_b32 s94, 0xbdd2d3e8
    v_mfma_f32_16x16x32_bf16 v[124:127], a[68:71], a[116:119], v[124:127]
    ds_read_b64_tr_b16 a[68:69], v15 offset:0
    s_mov_b32 s95, 0xbdd2d3e8
    v_mfma_f32_16x16x32_bf16 v[52:55], a[32:35], a[72:75], v[52:55]
    ds_read_b64_tr_b16 a[70:71], v15 offset:256
    v_mov_b32 v26, 0xc0135761
    v_mfma_f32_16x16x32_bf16 v[56:59], a[36:39], a[72:75], v[56:59]
    v_mov_b32 v27, 0xc0135761
    v_mfma_f32_16x16x32_bf16 v[60:63], a[40:43], a[72:75], v[60:63]
    ds_read_b128 a[16:19], v8 offset:43008
    v_mov_b32 v25, 1
    v_mfma_f32_16x16x32_bf16 v[64:67], a[44:47], a[72:75], v[64:67]
    s_lshl_b32 s82, s60, 12
    buffer_load_dwordx4 v18, s[48:51], s81 offen offset:1024 lds
    v_mfma_f32_16x16x32_bf16 v[68:71], a[48:51], a[72:75], v[68:71]
    ds_read_b128 a[20:23], v8 offset:45056
    s_add_u32 s68, s88, s82
    v_mfma_f32_16x16x32_bf16 v[72:75], a[52:55], a[72:75], v[72:75]
    s_lshl_b32 s82, s61, 13
    v_mfma_f32_16x16x32_bf16 v[76:79], a[56:59], a[72:75], v[76:79]
    s_add_u32 s88, s88, s82
    v_mfma_f32_16x16x32_bf16 v[80:83], a[60:63], a[72:75], v[80:83]
    s_lshr_b32 s82, s66, 1
    v_mfma_f32_16x16x32_bf16 v[48:51], a[116:119], a[72:75], v[48:51]
    ds_read_b64_tr_b16 a[72:73], v13 offset:1024
    s_add_u32 s82, s82, 24
    s_mov_b32 s80, 458752
    s_add_u32 m0, s3, 16384
    v_mfma_f32_16x16x32_bf16 v[88:91], a[32:35], a[76:79], v[88:91]
    ds_read_b64_tr_b16 a[74:75], v13 offset:1280
    s_lshl_b32 s82, s82, 14
    buffer_load_dwordx4 v17, s[48:51], s80 offen lds
    v_mfma_f32_16x16x32_bf16 v[92:95], a[36:39], a[76:79], v[92:95]
    ds_read_b128 a[24:27], v8 offset:47104
    s_add_u32 s90, s88, s82
    v_mfma_f32_16x16x32_bf16 v[96:99], a[40:43], a[76:79], v[96:99]
    s_lshl_b32 s82, s66, 14
    v_mfma_f32_16x16x32_bf16 v[100:103], a[44:47], a[76:79], v[100:103]
    ds_read_b128 a[28:31], v8 offset:49152
    s_add_u32 s88, s88, s82
    v_mfma_f32_16x16x32_bf16 v[104:107], a[48:51], a[76:79], v[104:107]
    s_add_u32 s89, s88, 262144
    v_mfma_f32_16x16x32_bf16 v[108:111], a[52:55], a[76:79], v[108:111]
    s_mov_b32 s76, s93
    v_mfma_f32_16x16x32_bf16 v[112:115], a[56:59], a[76:79], v[112:115]
    s_lshl_b32 s82, s63, 4
    buffer_load_dwordx4 v18, s[48:51], s80 offen offset:1024 lds
    v_mfma_f32_16x16x32_bf16 v[116:119], a[60:63], a[76:79], v[116:119]
    ds_read_b128 a[112:115], v10 offset:34816
    s_lshl_b32 s83, s60, 2
    v_mfma_f32_16x16x32_bf16 v[84:87], a[116:119], a[76:79], v[84:87]
    ds_read_b64_tr_b16 a[76:77], v15 offset:1024
    s_add_u32 s83, s83, s82
    v_mfma_f32_16x16x32_bf16 a[192:195], a[80:83], a[32:35], a[192:195]
    ds_read_b64_tr_b16 a[78:79], v15 offset:1280
    s_add_u32 s83, s83, s65
    v_mfma_f32_16x16x32_bf16 a[200:203], a[80:83], a[36:39], a[200:203]
    s_lshl_b32 s83, s83, 15
    v_mfma_f32_16x16x32_bf16 a[208:211], a[80:83], a[40:43], a[208:211]
    ds_read_b64_tr_b16 a[96:97], v13 offset:4096
    s_add_u32 s69, s83, 4194304
    s_mov_b32 s81, 688128
    s_add_u32 m0, s3, 24576
    v_mfma_f32_16x16x32_bf16 a[216:219], a[80:83], a[44:47], a[216:219]
    s_lshl_b32 s84, s63, 3
    buffer_load_dwordx4 v17, s[48:51], s81 offen lds
    v_mfma_f32_16x16x32_bf16 a[224:227], a[80:83], a[48:51], a[224:227]
    s_add_u32 s84, s84, s66
    v_mfma_f32_16x16x32_bf16 a[232:235], a[80:83], a[52:55], a[232:235]
    s_lshl_b32 s85, s84, 2
    v_mfma_f32_16x16x32_bf16 a[240:243], a[80:83], a[56:59], a[240:243]
    ds_read_b64_tr_b16 a[98:99], v13 offset:4352
    s_add_u32 s85, s85, s60
    v_mfma_f32_16x16x32_bf16 a[248:251], a[80:83], a[60:63], a[248:251]
    ds_read_b64_tr_b16 a[80:81], v13 offset:2048
    s_lshl_b32 s85, s85, 8
    v_mfma_f32_16x16x32_bf16 a[196:199], a[84:87], a[32:35], a[196:199]
    ds_read_b64_tr_b16 a[82:83], v13 offset:2304
    s_add_u32 s77, s85, 39862272
    v_mfma_f32_16x16x32_bf16 a[204:207], a[84:87], a[36:39], a[204:207]
    s_lshl_b32 s84, s84, 18
    buffer_load_dwordx4 v18, s[48:51], s81 offen offset:1024 lds
    v_mfma_f32_16x16x32_bf16 a[212:215], a[84:87], a[40:43], a[212:215]
    ds_read_b64_tr_b16 a[100:101], v15 offset:4096
    s_lshl_b32 s85, s60, 12
    v_mfma_f32_16x16x32_bf16 a[220:223], a[84:87], a[44:47], a[220:223]
    s_add_u32 s84, s84, s85
    v_mfma_f32_16x16x32_bf16 a[228:231], a[84:87], a[48:51], a[228:231]
    s_add_u32 s84, s84, 23068672
    v_mfma_f32_16x16x32_bf16 a[236:239], a[84:87], a[52:55], a[236:239]
    s_xor_b32 s85, s65, 1
    v_mfma_f32_16x16x32_bf16 a[244:247], a[84:87], a[56:59], a[244:247]
    ds_read_b64_tr_b16 a[102:103], v15 offset:4352
    s_lshl_b32 s85, s85, 16
    s_mov_b32 s81, 753664
    s_add_u32 m0, s3, 90112
    v_mfma_f32_16x16x32_bf16 a[252:255], a[84:87], a[60:63], a[252:255]
    ds_read_b64_tr_b16 a[84:85], v15 offset:2048
    s_add_u32 s70, s84, s85
    buffer_load_dwordx4 v17, s[48:51], s81 offen lds
    v_mfma_f32_16x16x32_bf16 v[128:131], a[88:91], a[32:35], v[128:131]
    ds_read_b64_tr_b16 a[86:87], v15 offset:2304
    s_add_u32 s70, s70, 16384
    v_mfma_f32_16x16x32_bf16 v[144:147], a[88:91], a[36:39], v[144:147]
    s_lshl_b32 s85, s65, 16
    v_mfma_f32_16x16x32_bf16 v[160:163], a[88:91], a[40:43], v[160:163]
    s_add_u32 s73, s84, s85
    v_mfma_f32_16x16x32_bf16 v[176:179], a[88:91], a[44:47], v[176:179]
    v_mfma_f32_16x16x32_bf16 v[192:195], a[88:91], a[48:51], v[192:195]
    v_mfma_f32_16x16x32_bf16 v[208:211], a[88:91], a[52:55], v[208:211]
    buffer_load_dwordx4 v18, s[48:51], s81 offen offset:1024 lds
    v_mfma_f32_16x16x32_bf16 v[224:227], a[88:91], a[56:59], v[224:227]
    v_mfma_f32_16x16x32_bf16 v[240:243], a[88:91], a[60:63], v[240:243]
    ds_read_b64_tr_b16 a[88:89], v13 offset:3072
    v_mfma_f32_16x16x32_bf16 v[132:135], a[92:95], a[32:35], v[132:135]
    ds_read_b64_tr_b16 a[90:91], v13 offset:3328
    v_mfma_f32_16x16x32_bf16 v[148:151], a[92:95], a[36:39], v[148:151]
    v_mfma_f32_16x16x32_bf16 v[164:167], a[92:95], a[40:43], v[164:167]
    s_mov_b32 s80, 983040
    s_add_u32 m0, s3, 98304
    v_mfma_f32_16x16x32_bf16 v[180:183], a[92:95], a[44:47], v[180:183]
    buffer_load_dwordx4 v17, s[48:51], s80 offen lds
    v_mfma_f32_16x16x32_bf16 v[196:199], a[92:95], a[48:51], v[196:199]
    v_mfma_f32_16x16x32_bf16 v[212:215], a[92:95], a[52:55], v[212:215]
    v_mfma_f32_16x16x32_bf16 v[228:231], a[92:95], a[56:59], v[228:231]
    v_mfma_f32_16x16x32_bf16 v[244:247], a[92:95], a[60:63], v[244:247]
    ds_read_b64_tr_b16 a[92:93], v15 offset:3072
    v_mfma_f32_16x16x32_bf16 v[136:139], a[104:107], a[32:35], v[136:139]
    ds_read_b64_tr_b16 a[94:95], v15 offset:3328
    v_mfma_f32_16x16x32_bf16 v[152:155], a[104:107], a[36:39], v[152:155]
    buffer_load_dwordx4 v18, s[48:51], s80 offen offset:1024 lds
    v_mfma_f32_16x16x32_bf16 v[168:171], a[104:107], a[40:43], v[168:171]
    v_mfma_f32_16x16x32_bf16 v[184:187], a[104:107], a[44:47], v[184:187]
    v_mfma_f32_16x16x32_bf16 v[200:203], a[104:107], a[48:51], v[200:203]
    v_mfma_f32_16x16x32_bf16 v[216:219], a[104:107], a[52:55], v[216:219]
    v_mfma_f32_16x16x32_bf16 v[232:235], a[104:107], a[56:59], v[232:235]
    v_mfma_f32_16x16x32_bf16 v[248:251], a[104:107], a[60:63], v[248:251]
    v_mfma_f32_16x16x32_bf16 v[140:143], a[108:111], a[32:35], v[140:143]
    v_mfma_f32_16x16x32_bf16 v[156:159], a[108:111], a[36:39], v[156:159]
    v_mfma_f32_16x16x32_bf16 v[172:175], a[108:111], a[40:43], v[172:175]
    v_mfma_f32_16x16x32_bf16 v[188:191], a[108:111], a[44:47], v[188:191]
    v_mfma_f32_16x16x32_bf16 v[204:207], a[108:111], a[48:51], v[204:207]
    v_mfma_f32_16x16x32_bf16 v[220:223], a[108:111], a[52:55], v[220:223]
    v_mfma_f32_16x16x32_bf16 v[236:239], a[108:111], a[56:59], v[236:239]
    v_mfma_f32_16x16x32_bf16 v[252:255], a[108:111], a[60:63], v[252:255]
    s_waitcnt lgkmcnt(0)
    s_barrier
    v_mfma_f32_16x16x32_bf16 a[128:131], a[64:67], a[0:3], a[128:131]
    v_mfma_f32_16x16x32_bf16 a[136:139], a[64:67], a[4:7], a[136:139]
    v_mfma_f32_16x16x32_bf16 a[144:147], a[64:67], a[8:11], a[144:147]
    ds_read_b128 a[32:35], v9 offset:34816
    s_mov_b32 s81, 1212416
    s_add_u32 m0, s3, 106496
    v_mfma_f32_16x16x32_bf16 a[152:155], a[64:67], a[12:15], a[152:155]
    buffer_load_dwordx4 v17, s[48:51], s81 offen lds
    v_mfma_f32_16x16x32_bf16 a[160:163], a[64:67], a[16:19], a[160:163]
    s_add_u32 s73, s73, 16384
    v_mfma_f32_16x16x32_bf16 a[168:171], a[64:67], a[20:23], a[168:171]
    s_xor_b32 s85, s65, 2
    v_mfma_f32_16x16x32_bf16 a[176:179], a[64:67], a[24:27], a[176:179]
    ds_read_b128 a[36:39], v9 offset:36864
    s_lshl_b32 s85, s85, 16
    v_mfma_f32_16x16x32_bf16 a[184:187], a[64:67], a[28:31], a[184:187]
    s_add_u32 s71, s84, s85
    v_mfma_f32_16x16x32_bf16 v[120:123], a[64:67], a[112:115], v[120:123]
    ds_read_b64_tr_b16 a[64:65], v13 offset:20480
    s_add_u32 s71, s71, 32768
    v_mfma_f32_16x16x32_bf16 a[132:135], a[68:71], a[0:3], a[132:135]
    ds_read_b64_tr_b16 a[66:67], v13 offset:20736
    s_lshl_b32 s85, s65, 16
    v_mfma_f32_16x16x32_bf16 a[140:143], a[68:71], a[4:7], a[140:143]
    ds_read_b128 a[40:43], v9 offset:38912
    s_add_u32 s74, s84, s85
    v_mfma_f32_16x16x32_bf16 a[148:151], a[68:71], a[8:11], a[148:151]
    s_add_u32 s74, s74, 32768
    v_mfma_f32_16x16x32_bf16 a[156:159], a[68:71], a[12:15], a[156:159]
    s_xor_b32 s85, s65, 3
    v_mfma_f32_16x16x32_bf16 a[164:167], a[68:71], a[16:19], a[164:167]
    s_lshl_b32 s85, s85, 16
    v_mfma_f32_16x16x32_bf16 a[172:175], a[68:71], a[20:23], a[172:175]
    ds_read_b128 a[44:47], v9 offset:40960
    s_add_u32 s72, s84, s85
    v_mfma_f32_16x16x32_bf16 a[180:183], a[68:71], a[24:27], a[180:183]
    s_add_u32 s72, s72, 49152
    buffer_load_dwordx4 v18, s[48:51], s81 offen offset:1024 lds
    v_mfma_f32_16x16x32_bf16 a[188:191], a[68:71], a[28:31], a[188:191]
    s_lshl_b32 s85, s65, 16
    v_mfma_f32_16x16x32_bf16 v[124:127], a[68:71], a[112:115], v[124:127]
    ds_read_b64_tr_b16 a[68:69], v15 offset:20480
    s_add_u32 s75, s84, s85
    v_mfma_f32_16x16x32_bf16 v[52:55], a[0:3], a[72:75], v[52:55]
    ds_read_b64_tr_b16 a[70:71], v15 offset:20736
    s_add_u32 s75, s75, 49152
    v_mfma_f32_16x16x32_bf16 v[56:59], a[4:7], a[72:75], v[56:59]
    s_lshl_b32 s83, s61, 3
    v_mfma_f32_16x16x32_bf16 v[60:63], a[8:11], a[72:75], v[60:63]
    ds_read_b128 a[48:51], v9 offset:43008
    s_add_u32 s82, s82, s83
    v_mfma_f32_16x16x32_bf16 v[64:67], a[12:15], a[72:75], v[64:67]
    s_lshl_b32 s82, s82, 5
    v_mfma_f32_16x16x32_bf16 v[68:71], a[16:19], a[72:75], v[68:71]
    ds_read_b128 a[52:55], v9 offset:45056
    s_add_u32 s82, s82, s64
    v_mfma_f32_16x16x32_bf16 v[72:75], a[20:23], a[72:75], v[72:75]
    s_lshl_b32 s82, s82, 10
    v_mfma_f32_16x16x32_bf16 v[76:79], a[24:27], a[72:75], v[76:79]
    s_add_u32 s91, s82, 4194304
    v_mfma_f32_16x16x32_bf16 v[80:83], a[28:31], a[72:75], v[80:83]
    v_mov_b32 v42, 1
    v_mfma_f32_16x16x32_bf16 v[48:51], a[112:115], a[72:75], v[48:51]
    ds_read_b64_tr_b16 a[72:73], v13 offset:21504
    v_and_b32 v37, 1, v35
    s_mov_b32 s80, 1441792
    s_add_u32 m0, s3, 114688
    v_mfma_f32_16x16x32_bf16 v[88:91], a[0:3], a[76:79], v[88:91]
    ds_read_b64_tr_b16 a[74:75], v13 offset:21760
    v_lshl_add_u32 v36, v34, 2, v37
    buffer_load_dwordx4 v17, s[48:51], s80 offen lds
    v_mfma_f32_16x16x32_bf16 v[92:95], a[4:7], a[76:79], v[92:95]
    ds_read_b128 a[56:59], v9 offset:47104
    v_cmp_le_u32 s[4:5], v36, v35
    v_mfma_f32_16x16x32_bf16 v[96:99], a[8:11], a[76:79], v[96:99]
    v_add_u32 v36, 2, v36
    v_mfma_f32_16x16x32_bf16 v[100:103], a[12:15], a[76:79], v[100:103]
    ds_read_b128 a[60:63], v9 offset:49152
    v_cmp_le_u32 s[6:7], v36, v35
    v_mfma_f32_16x16x32_bf16 v[104:107], a[16:19], a[76:79], v[104:107]
    v_mul_u32_u24 v36, 0x0202, v37
    v_mfma_f32_16x16x32_bf16 v[108:111], a[20:23], a[76:79], v[108:111]
    v_lshlrev_b32 v36, 16, v36
    v_mfma_f32_16x16x32_bf16 v[112:115], a[24:27], a[76:79], v[112:115]
    v_add_u32 v36, 0x01000c0c, v36
    v_mfma_f32_16x16x32_bf16 v[116:119], a[28:31], a[76:79], v[116:119]
    ds_read_b128 a[116:119], v11 offset:34816
    v_add_u32 v38, 0x04040000, v36
    v_mfma_f32_16x16x32_bf16 v[84:87], a[112:115], a[76:79], v[84:87]
    ds_read_b64_tr_b16 a[76:77], v15 offset:21504
    v_cndmask_b32 v28, v36, v38, s[4:5]
    v_mfma_f32_16x16x32_bf16 a[192:195], a[80:83], a[0:3], a[192:195]
    ds_read_b64_tr_b16 a[78:79], v15 offset:21760
    v_cndmask_b32 v29, v36, v38, s[6:7]
    v_mfma_f32_16x16x32_bf16 a[200:203], a[80:83], a[4:7], a[200:203]
    v_cmp_eq_u32 vcc, 1, v37
    v_mfma_f32_16x16x32_bf16 a[208:211], a[80:83], a[8:11], a[208:211]
    ds_read_b64_tr_b16 a[104:105], v13 offset:24576
    v_mov_b32 v36, 0x0c0c0100
    v_mfma_f32_16x16x32_bf16 a[216:219], a[80:83], a[12:15], a[216:219]
    v_mov_b32 v38, 0x01000c0c
    buffer_load_dwordx4 v18, s[48:51], s80 offen offset:1024 lds
    v_mfma_f32_16x16x32_bf16 a[224:227], a[80:83], a[16:19], a[224:227]
    v_cndmask_b32 v36, v36, v38, vcc
    v_mfma_f32_16x16x32_bf16 a[232:235], a[80:83], a[20:23], a[232:235]
    v_mov_b32 v38, 0x0c0c0302
    v_mfma_f32_16x16x32_bf16 a[240:243], a[80:83], a[24:27], a[240:243]
    ds_read_b64_tr_b16 a[106:107], v13 offset:24832
    v_mov_b32 v39, 0x03020c0c
    v_mfma_f32_16x16x32_bf16 a[248:251], a[80:83], a[28:31], a[248:251]
    ds_read_b64_tr_b16 a[80:81], v13 offset:22528
    v_cndmask_b32 v38, v38, v39, vcc
    v_mfma_f32_16x16x32_bf16 a[196:199], a[84:87], a[0:3], a[196:199]
    ds_read_b64_tr_b16 a[82:83], v13 offset:22784
    v_mov_b32 v39, 0x0c0c0c0c
    v_mfma_f32_16x16x32_bf16 a[204:207], a[84:87], a[4:7], a[204:207]
    s_branch L_over1
L_stub1:
    s_branch L_stub5
L_over1:
    v_cndmask_b32 v30, v36, v39, s[4:5]
    v_mfma_f32_16x16x32_bf16 a[212:215], a[84:87], a[8:11], a[212:215]
    ds_read_b64_tr_b16 a[108:109], v15 offset:24576
    v_cndmask_b32 v31, v38, v39, s[6:7]
    v_mfma_f32_16x16x32_bf16 a[220:223], a[84:87], a[12:15], a[220:223]
    v_cndmask_b32 v32, v39, v36, s[4:5]
    v_mfma_f32_16x16x32_bf16 a[228:231], a[84:87], a[16:19], a[228:231]
    v_cndmask_b32 v33, v39, v38, s[6:7]
    v_mfma_f32_16x16x32_bf16 a[236:239], a[84:87], a[20:23], a[236:239]
    s_or_b32 s82, s63, s61
    v_mfma_f32_16x16x32_bf16 a[244:247], a[84:87], a[24:27], a[244:247]
    ds_read_b64_tr_b16 a[110:111], v15 offset:24832
    s_cmp_eq_u32 s82, 0
    s_cselect_b64 s[4:5], s[4:5], -1
    s_cselect_b64 s[6:7], s[6:7], -1
    s_mov_b32 s81, 1671168
    s_add_u32 m0, s3, 122880
    v_mfma_f32_16x16x32_bf16 a[252:255], a[84:87], a[28:31], a[252:255]
    ds_read_b64_tr_b16 a[84:85], v15 offset:22528
    s_mov_b32 s14, 0x3e3504f3
    buffer_load_dwordx4 v17, s[48:51], s81 offen lds
    v_mfma_f32_16x16x32_bf16 v[128:131], a[88:91], a[0:3], v[128:131]
    ds_read_b64_tr_b16 a[86:87], v15 offset:22784
    s_mov_b32 s15, 0x3e3504f3
    v_mfma_f32_16x16x32_bf16 v[144:147], a[88:91], a[4:7], v[144:147]
    s_mov_b32 s98, 0x3fb8aa3b
    v_mfma_f32_16x16x32_bf16 v[160:163], a[88:91], a[8:11], v[160:163]
    s_mov_b32 s99, 0x3fb8aa3b
    v_mfma_f32_16x16x32_bf16 v[176:179], a[88:91], a[12:15], v[176:179]
    v_mfma_f32_16x16x32_bf16 v[192:195], a[88:91], a[16:19], v[192:195]
    v_mfma_f32_16x16x32_bf16 v[208:211], a[88:91], a[20:23], v[208:211]
    v_mfma_f32_16x16x32_bf16 v[224:227], a[88:91], a[24:27], v[224:227]
    v_mfma_f32_16x16x32_bf16 v[240:243], a[88:91], a[28:31], v[240:243]
    ds_read_b64_tr_b16 a[88:89], v13 offset:23552
    v_mfma_f32_16x16x32_bf16 v[132:135], a[92:95], a[0:3], v[132:135]
    ds_read_b64_tr_b16 a[90:91], v13 offset:23808
    v_mfma_f32_16x16x32_bf16 v[148:151], a[92:95], a[4:7], v[148:151]
    v_mfma_f32_16x16x32_bf16 v[164:167], a[92:95], a[8:11], v[164:167]
    v_mfma_f32_16x16x32_bf16 v[180:183], a[92:95], a[12:15], v[180:183]
    buffer_load_dwordx4 v18, s[48:51], s81 offen offset:1024 lds
    v_mfma_f32_16x16x32_bf16 v[196:199], a[92:95], a[16:19], v[196:199]
    v_mfma_f32_16x16x32_bf16 v[212:215], a[92:95], a[20:23], v[212:215]
    v_mfma_f32_16x16x32_bf16 v[228:231], a[92:95], a[24:27], v[228:231]
    v_mfma_f32_16x16x32_bf16 v[244:247], a[92:95], a[28:31], v[244:247]
    ds_read_b64_tr_b16 a[92:93], v15 offset:23552
    v_mfma_f32_16x16x32_bf16 v[136:139], a[96:99], a[0:3], v[136:139]
    ds_read_b64_tr_b16 a[94:95], v15 offset:23808
    v_mfma_f32_16x16x32_bf16 v[152:155], a[96:99], a[4:7], v[152:155]
    v_mfma_f32_16x16x32_bf16 v[168:171], a[96:99], a[8:11], v[168:171]
    v_mfma_f32_16x16x32_bf16 v[184:187], a[96:99], a[12:15], v[184:187]
    v_mfma_f32_16x16x32_bf16 v[200:203], a[96:99], a[16:19], v[200:203]
    v_mfma_f32_16x16x32_bf16 v[216:219], a[96:99], a[20:23], v[216:219]
    v_mfma_f32_16x16x32_bf16 v[232:235], a[96:99], a[24:27], v[232:235]
    v_mfma_f32_16x16x32_bf16 v[248:251], a[96:99], a[28:31], v[248:251]
    v_mfma_f32_16x16x32_bf16 v[140:143], a[100:103], a[0:3], v[140:143]
    v_mfma_f32_16x16x32_bf16 v[156:159], a[100:103], a[4:7], v[156:159]
    v_mfma_f32_16x16x32_bf16 v[172:175], a[100:103], a[8:11], v[172:175]
    v_mfma_f32_16x16x32_bf16 v[188:191], a[100:103], a[12:15], v[188:191]
    v_mfma_f32_16x16x32_bf16 v[204:207], a[100:103], a[16:19], v[204:207]
    v_mfma_f32_16x16x32_bf16 v[220:223], a[100:103], a[20:23], v[220:223]
    v_mfma_f32_16x16x32_bf16 v[236:239], a[100:103], a[24:27], v[236:239]
    v_mfma_f32_16x16x32_bf16 v[252:255], a[100:103], a[28:31], v[252:255]
    s_waitcnt lgkmcnt(0)
    s_barrier
    v_mfma_f32_16x16x32_bf16 a[128:131], a[64:67], a[32:35], a[128:131]
    v_mfma_f32_16x16x32_bf16 a[136:139], a[64:67], a[36:39], a[136:139]
    v_mfma_f32_16x16x32_bf16 a[144:147], a[64:67], a[40:43], a[144:147]
    s_mov_b32 s80, 917504
    s_add_u32 m0, s3, 32768
    v_mfma_f32_16x16x32_bf16 a[152:155], a[64:67], a[44:47], a[152:155]
    buffer_load_dwordx4 v17, s[48:51], s80 offen lds
    v_mfma_f32_16x16x32_bf16 a[160:163], a[64:67], a[48:51], a[160:163]
    v_lshrrev_b32 v3, 2, v0
    v_mfma_f32_16x16x32_bf16 a[168:171], a[64:67], a[52:55], a[168:171]
    v_and_b32 v4, 3, v0
    v_mfma_f32_16x16x32_bf16 a[176:179], a[64:67], a[56:59], a[176:179]
    v_lshlrev_b32 v4, 3, v4
    v_mfma_f32_16x16x32_bf16 a[184:187], a[64:67], a[60:63], a[184:187]
    buffer_load_dwordx4 v18, s[48:51], s80 offen offset:1024 lds
    v_lshl_add_u32 v4, v3, 8, v4
    v_mfma_f32_16x16x32_bf16 v[120:123], a[64:67], a[116:119], v[120:123]
    v_and_b32 v3, 7, v3
    v_mfma_f32_16x16x32_bf16 a[132:135], a[68:71], a[32:35], a[132:135]
    v_xor_b32 v5, 0, v3
    v_mfma_f32_16x16x32_bf16 a[140:143], a[68:71], a[36:39], a[140:143]
    v_lshl_add_u32 v8, v5, 5, v4
    v_mfma_f32_16x16x32_bf16 a[148:151], a[68:71], a[40:43], a[148:151]
    s_mov_b32 s81, 1146880
    s_add_u32 m0, s3, 40960
    v_xor_b32 v5, 1, v3
    v_mfma_f32_16x16x32_bf16 a[156:159], a[68:71], a[44:47], a[156:159]
    buffer_load_dwordx4 v17, s[48:51], s81 offen lds
    v_lshl_add_u32 v9, v5, 5, v4
    v_mfma_f32_16x16x32_bf16 a[164:167], a[68:71], a[48:51], a[164:167]
    v_xor_b32 v5, 2, v3
    v_mfma_f32_16x16x32_bf16 a[172:175], a[68:71], a[52:55], a[172:175]
    v_lshl_add_u32 v10, v5, 5, v4
    v_mfma_f32_16x16x32_bf16 a[180:183], a[68:71], a[56:59], a[180:183]
    v_xor_b32 v5, 3, v3
    v_mfma_f32_16x16x32_bf16 a[188:191], a[68:71], a[60:63], a[188:191]
    buffer_load_dwordx4 v18, s[48:51], s81 offen offset:1024 lds
    v_lshl_add_u32 v11, v5, 5, v4
    v_mfma_f32_16x16x32_bf16 v[124:127], a[68:71], a[116:119], v[124:127]
    v_xor_b32 v5, 4, v3
    v_mfma_f32_16x16x32_bf16 v[52:55], a[32:35], a[72:75], v[52:55]
    v_lshl_add_u32 v12, v5, 5, v4
    v_mfma_f32_16x16x32_bf16 v[56:59], a[36:39], a[72:75], v[56:59]
    v_xor_b32 v5, 5, v3
    v_mfma_f32_16x16x32_bf16 v[60:63], a[40:43], a[72:75], v[60:63]
    s_mov_b32 s80, 1376256
    s_add_u32 m0, s3, 49152
    v_lshl_add_u32 v13, v5, 5, v4
    v_mfma_f32_16x16x32_bf16 v[64:67], a[44:47], a[72:75], v[64:67]
    buffer_load_dwordx4 v17, s[48:51], s80 offen lds
    v_xor_b32 v5, 6, v3
    v_mfma_f32_16x16x32_bf16 v[68:71], a[48:51], a[72:75], v[68:71]
    v_lshl_add_u32 v14, v5, 5, v4
    v_mfma_f32_16x16x32_bf16 v[72:75], a[52:55], a[72:75], v[72:75]
    v_xor_b32 v5, 7, v3
    v_mfma_f32_16x16x32_bf16 v[76:79], a[56:59], a[72:75], v[76:79]
    v_lshl_add_u32 v15, v5, 5, v4
    v_mfma_f32_16x16x32_bf16 v[80:83], a[60:63], a[72:75], v[80:83]
    buffer_load_dwordx4 v18, s[48:51], s80 offen offset:1024 lds
    v_mfma_f32_16x16x32_bf16 v[48:51], a[116:119], a[72:75], v[48:51]
    v_mfma_f32_16x16x32_bf16 v[88:91], a[32:35], a[76:79], v[88:91]
    v_mfma_f32_16x16x32_bf16 v[92:95], a[36:39], a[76:79], v[92:95]
    v_mfma_f32_16x16x32_bf16 v[96:99], a[40:43], a[76:79], v[96:99]
    s_mov_b32 s81, 1605632
    s_add_u32 m0, s3, 57344
    v_mfma_f32_16x16x32_bf16 v[100:103], a[44:47], a[76:79], v[100:103]
    buffer_load_dwordx4 v17, s[48:51], s81 offen lds
    v_mfma_f32_16x16x32_bf16 v[104:107], a[48:51], a[76:79], v[104:107]
    v_mfma_f32_16x16x32_bf16 v[108:111], a[52:55], a[76:79], v[108:111]
    v_mfma_f32_16x16x32_bf16 v[112:115], a[56:59], a[76:79], v[112:115]
    v_mfma_f32_16x16x32_bf16 v[116:119], a[60:63], a[76:79], v[116:119]
    buffer_load_dwordx4 v18, s[48:51], s81 offen offset:1024 lds
    v_mfma_f32_16x16x32_bf16 v[84:87], a[116:119], a[76:79], v[84:87]
    v_mfma_f32_16x16x32_bf16 a[192:195], a[80:83], a[32:35], a[192:195]
    v_mfma_f32_16x16x32_bf16 a[200:203], a[80:83], a[36:39], a[200:203]
    v_mfma_f32_16x16x32_bf16 a[208:211], a[80:83], a[40:43], a[208:211]
    s_mov_b32 s80, 65536
    s_add_u32 m0, s3, 65536
    v_mfma_f32_16x16x32_bf16 a[216:219], a[80:83], a[44:47], a[216:219]
    buffer_load_dwordx4 v17, s[48:51], s80 offen lds
    v_mfma_f32_16x16x32_bf16 a[224:227], a[80:83], a[48:51], a[224:227]
    v_mfma_f32_16x16x32_bf16 a[232:235], a[80:83], a[52:55], a[232:235]
    v_mfma_f32_16x16x32_bf16 a[240:243], a[80:83], a[56:59], a[240:243]
    v_mfma_f32_16x16x32_bf16 a[248:251], a[80:83], a[60:63], a[248:251]
    buffer_load_dwordx4 v18, s[48:51], s80 offen offset:1024 lds
    v_mfma_f32_16x16x32_bf16 a[196:199], a[84:87], a[32:35], a[196:199]
    v_mfma_f32_16x16x32_bf16 a[204:207], a[84:87], a[36:39], a[204:207]
    v_mfma_f32_16x16x32_bf16 a[212:215], a[84:87], a[40:43], a[212:215]
    v_mfma_f32_16x16x32_bf16 a[220:223], a[84:87], a[44:47], a[220:223]
    s_mov_b32 s80, 131072
    s_add_u32 m0, s3, 131072
    v_mfma_f32_16x16x32_bf16 a[228:231], a[84:87], a[48:51], a[228:231]
    buffer_load_dwordx4 v17, s[48:51], s80 offen lds
    v_mfma_f32_16x16x32_bf16 a[236:239], a[84:87], a[52:55], a[236:239]
    v_mfma_f32_16x16x32_bf16 a[244:247], a[84:87], a[56:59], a[244:247]
    v_mfma_f32_16x16x32_bf16 a[252:255], a[84:87], a[60:63], a[252:255]
    v_mfma_f32_16x16x32_bf16 v[128:131], a[88:91], a[32:35], v[128:131]
    buffer_load_dwordx4 v18, s[48:51], s80 offen offset:1024 lds
    v_mfma_f32_16x16x32_bf16 v[144:147], a[88:91], a[36:39], v[144:147]
    v_mfma_f32_16x16x32_bf16 v[160:163], a[88:91], a[40:43], v[160:163]
    v_mfma_f32_16x16x32_bf16 v[176:179], a[88:91], a[44:47], v[176:179]
    v_mfma_f32_16x16x32_bf16 v[192:195], a[88:91], a[48:51], v[192:195]
    s_mov_b32 s81, 360448
    s_add_u32 m0, s3, 139264
    v_mfma_f32_16x16x32_bf16 v[208:211], a[88:91], a[52:55], v[208:211]
    buffer_load_dwordx4 v17, s[48:51], s81 offen lds
    v_mfma_f32_16x16x32_bf16 v[224:227], a[88:91], a[56:59], v[224:227]
    v_mfma_f32_16x16x32_bf16 v[240:243], a[88:91], a[60:63], v[240:243]
    v_mfma_f32_16x16x32_bf16 v[132:135], a[92:95], a[32:35], v[132:135]
    v_mfma_f32_16x16x32_bf16 v[148:151], a[92:95], a[36:39], v[148:151]
    buffer_load_dwordx4 v18, s[48:51], s81 offen offset:1024 lds
    v_mfma_f32_16x16x32_bf16 v[164:167], a[92:95], a[40:43], v[164:167]
    v_mfma_f32_16x16x32_bf16 v[180:183], a[92:95], a[44:47], v[180:183]
    v_mfma_f32_16x16x32_bf16 v[196:199], a[92:95], a[48:51], v[196:199]
    v_mfma_f32_16x16x32_bf16 v[212:215], a[92:95], a[52:55], v[212:215]
    s_mov_b32 s80, 589824
    s_add_u32 m0, s3, 147456
    v_mfma_f32_16x16x32_bf16 v[228:231], a[92:95], a[56:59], v[228:231]
    buffer_load_dwordx4 v17, s[48:51], s80 offen lds
    v_mfma_f32_16x16x32_bf16 v[244:247], a[92:95], a[60:63], v[244:247]
    v_mfma_f32_16x16x32_bf16 v[136:139], a[104:107], a[32:35], v[136:139]
    v_mfma_f32_16x16x32_bf16 v[152:155], a[104:107], a[36:39], v[152:155]
    v_mfma_f32_16x16x32_bf16 v[168:171], a[104:107], a[40:43], v[168:171]
    buffer_load_dwordx4 v18, s[48:51], s80 offen offset:1024 lds
    v_mfma_f32_16x16x32_bf16 v[184:187], a[104:107], a[44:47], v[184:187]
    v_mfma_f32_16x16x32_bf16 v[200:203], a[104:107], a[48:51], v[200:203]
    v_mfma_f32_16x16x32_bf16 v[216:219], a[104:107], a[52:55], v[216:219]
    v_mfma_f32_16x16x32_bf16 v[232:235], a[104:107], a[56:59], v[232:235]
    v_mfma_f32_16x16x32_bf16 v[248:251], a[104:107], a[60:63], v[248:251]
    v_mfma_f32_16x16x32_bf16 v[140:143], a[108:111], a[32:35], v[140:143]
    v_mfma_f32_16x16x32_bf16 v[156:159], a[108:111], a[36:39], v[156:159]
    v_mfma_f32_16x16x32_bf16 v[172:175], a[108:111], a[40:43], v[172:175]
    v_mfma_f32_16x16x32_bf16 v[188:191], a[108:111], a[44:47], v[188:191]
    v_mfma_f32_16x16x32_bf16 v[204:207], a[108:111], a[48:51], v[204:207]
    v_mfma_f32_16x16x32_bf16 v[220:223], a[108:111], a[52:55], v[220:223]
    v_mfma_f32_16x16x32_bf16 v[236:239], a[108:111], a[56:59], v[236:239]
    v_mfma_f32_16x16x32_bf16 v[252:255], a[108:111], a[60:63], v[252:255]
    s_branch L_epi
L_stub2:
    s_branch L_stub6
L_g1_1:
    s_mov_b32 m0, s14
    s_mov_b32 s77, 4096
    buffer_load_dwordx4 v1, s[28:31], s77 offen sc1 lds
    s_mov_b32 s77, 19456
    buffer_load_dwordx4 v1, s[28:31], s77 offen offset:1024 sc1 lds
    v_add_u32 v1, 128, v1
    s_mov_b32 m0, s15
    s_mov_b32 s77, 4096
    buffer_load_dwordx4 v1, s[28:31], s77 offen sc1 lds
    s_mov_b32 s77, 19456
    buffer_load_dwordx4 v1, s[28:31], s77 offen offset:1024 sc1 lds
    v_add_u32 v1, 128, v1
    s_waitcnt vmcnt(2)
    s_barrier
    ds_read_b64_tr_b16 a[64:65], v12 offset:0
    ds_read_b64_tr_b16 a[66:67], v12 offset:256
    ds_read_b64_tr_b16 a[68:69], v14 offset:0
    ds_read_b64_tr_b16 a[70:71], v14 offset:256
    ds_read_b64_tr_b16 a[72:73], v12 offset:1024
    ds_read_b64_tr_b16 a[74:75], v12 offset:1280
    ds_read_b64_tr_b16 a[76:77], v14 offset:1024
    ds_read_b64_tr_b16 a[78:79], v14 offset:1280
    ds_read_b64_tr_b16 a[80:81], v12 offset:2048
    ds_read_b64_tr_b16 a[82:83], v12 offset:2304
    ds_read_b64_tr_b16 a[84:85], v14 offset:2048
    ds_read_b64_tr_b16 a[86:87], v14 offset:2304
    ds_read_b64_tr_b16 a[88:89], v12 offset:3072
    ds_read_b64_tr_b16 a[90:91], v12 offset:3328
    ds_read_b64_tr_b16 a[92:93], v14 offset:3072
    ds_read_b64_tr_b16 a[94:95], v14 offset:3328
    ds_read_b64_tr_b16 a[96:97], v12 offset:4096
    ds_read_b64_tr_b16 a[98:99], v12 offset:4352
    ds_read_b64_tr_b16 a[100:101], v14 offset:4096
    ds_read_b64_tr_b16 a[102:103], v14 offset:4352
    ds_read_b128 a[0:3], v8 offset:0
    ds_read_b128 a[4:7], v8 offset:2048
    ds_read_b128 a[8:11], v8 offset:4096
    ds_read_b128 a[12:15], v8 offset:6144
    ds_read_b128 a[16:19], v8 offset:8192
    ds_read_b128 a[20:23], v8 offset:10240
    ds_read_b128 a[24:27], v8 offset:12288
    ds_read_b128 a[28:31], v8 offset:14336
    s_add_u32 m0, s78, 40960
    s_nop 0
    buffer_load_dwordx4 v2, s[32:35], s68 offen offset:0 lds
    buffer_load_dwordx4 v2, s[32:35], s69 offen offset:1024 lds
    buffer_load_dwordx4 v2, s[32:35], s70 offen offset:2048 lds
    v_add_u32 v2, 196608, v2
    buffer_load_dwordx4 v3, s[36:39], s71 offen offset:3072 lds
    s_add_u32 m0, s78, 45056
    s_nop 0
    buffer_load_dwordx4 v3, s[40:43], s72 offen offset:0 lds
    buffer_load_dwordx4 v3, s[36:39], s73 offen offset:1024 lds
    buffer_load_dwordx4 v3, s[40:43], s74 offen offset:2048 lds
    buffer_load_dwordx4 v3, s[36:39], s75 offen offset:3072 lds
    s_add_u32 m0, s78, 49152
    s_nop 0
    buffer_load_dwordx4 v3, s[40:43], s76 offen offset:0 lds
    v_add_u32 v3, 229376, v3
    global_load_lds_dwordx4 v[4:5], off offset:1024
    v_lshl_add_u64 v[4:5], v[4:5], 0, s[80:81]
    s_add_u32 m0, s78, 61440
    s_nop 0
    buffer_load_dwordx4 v2, s[32:35], s68 offen offset:0 lds
    buffer_load_dwordx4 v2, s[32:35], s69 offen offset:1024 lds
    buffer_load_dwordx4 v2, s[32:35], s70 offen offset:2048 lds
    v_add_u32 v2, 196608, v2
    buffer_load_dwordx4 v3, s[36:39], s71 offen offset:3072 lds
    s_add_u32 m0, s78, 65536
    s_nop 0
    buffer_load_dwordx4 v3, s[40:43], s72 offen offset:0 lds
    buffer_load_dwordx4 v3, s[36:39], s73 offen offset:1024 lds
    buffer_load_dwordx4 v3, s[40:43], s74 offen offset:2048 lds
    buffer_load_dwordx4 v3, s[36:39], s75 offen offset:3072 lds
    s_add_u32 m0, s78, 69632
    s_nop 0
    buffer_load_dwordx4 v3, s[40:43], s76 offen offset:0 lds
    v_add_u32 v3, 229376, v3
    global_load_lds_dwordx4 v[4:5], off offset:1024
    v_lshl_add_u64 v[4:5], v[4:5], 0, s[80:81]
    s_mov_b32 s67, 7
    v_mov_b32 v20, 0x7ff00000
.p2align 3
L_loop1:
    s_waitcnt vmcnt(24) lgkmcnt(0)
    s_barrier
    v_mfma_f32_16x16x32_bf16 v[128:131], a[64:67], a[0:3], v[128:131]
    s_add_u32 m0, s78, 0
    buffer_load_dword v7, v6, s[44:47], s4 offen
    v_add_u32_e64 v6, s79, v6
    v_mfma_f32_16x16x32_bf16 v[144:147], a[64:67], a[4:7], v[144:147]
    buffer_load_dwordx4 v2, s[32:35], s68 offen offset:0 lds
    buffer_load_dword v7, v33, s[48:51], 0 offen
    v_add_u32_e64 v33, s52, v33
    v_mfma_f32_16x16x32_bf16 v[160:163], a[64:67], a[8:11], v[160:163]
    ds_read_b128 a[32:35], v9 offset:0
    v_mfma_f32_16x16x32_bf16 v[176:179], a[64:67], a[12:15], v[176:179]
    v_mfma_f32_16x16x32_bf16 v[192:195], a[64:67], a[16:19], v[192:195]
    v_mfma_f32_16x16x32_bf16 v[208:211], a[64:67], a[20:23], v[208:211]
    v_mfma_f32_16x16x32_bf16 v[224:227], a[64:67], a[24:27], v[224:227]
    ds_read_b128 a[36:39], v9 offset:2048
    v_mfma_f32_16x16x32_bf16 v[240:243], a[64:67], a[28:31], v[240:243]
    ds_read_b64_tr_b16 a[64:65], v12 offset:20480
    v_mfma_f32_16x16x32_bf16 v[132:135], a[68:71], a[0:3], v[132:135]
    ds_read_b64_tr_b16 a[66:67], v12 offset:20736
    v_mfma_f32_16x16x32_bf16 v[148:151], a[68:71], a[4:7], v[148:151]
    buffer_load_dwordx4 v2, s[32:35], s69 offen offset:1024 lds
    v_mfma_f32_16x16x32_bf16 v[164:167], a[68:71], a[8:11], v[164:167]
    ds_read_b128 a[40:43], v9 offset:4096
    v_mfma_f32_16x16x32_bf16 v[180:183], a[68:71], a[12:15], v[180:183]
    v_mfma_f32_16x16x32_bf16 v[196:199], a[68:71], a[16:19], v[196:199]
    v_mfma_f32_16x16x32_bf16 v[212:215], a[68:71], a[20:23], v[212:215]
    buffer_load_dwordx4 v2, s[32:35], s70 offen offset:2048 lds
    v_add_u32 v2, 196608, v2
    v_mfma_f32_16x16x32_bf16 v[228:231], a[68:71], a[24:27], v[228:231]
    ds_read_b128 a[44:47], v9 offset:6144
    v_mfma_f32_16x16x32_bf16 v[244:247], a[68:71], a[28:31], v[244:247]
    ds_read_b64_tr_b16 a[68:69], v14 offset:20480
    v_mfma_f32_16x16x32_bf16 v[136:139], a[72:75], a[0:3], v[136:139]
    ds_read_b64_tr_b16 a[70:71], v14 offset:20736
    v_mfma_f32_16x16x32_bf16 v[152:155], a[72:75], a[4:7], v[152:155]
    v_mfma_f32_16x16x32_bf16 v[168:171], a[72:75], a[8:11], v[168:171]
    ds_read_b128 a[48:51], v9 offset:8192
    v_mfma_f32_16x16x32_bf16 v[184:187], a[72:75], a[12:15], v[184:187]
    buffer_load_dwordx4 v3, s[36:39], s71 offen offset:3072 lds
    v_mfma_f32_16x16x32_bf16 v[200:203], a[72:75], a[16:19], v[200:203]
    v_mfma_f32_16x16x32_bf16 v[216:219], a[72:75], a[20:23], v[216:219]
    v_mfma_f32_16x16x32_bf16 v[232:235], a[72:75], a[24:27], v[232:235]
    ds_read_b128 a[52:55], v9 offset:10240
    v_mfma_f32_16x16x32_bf16 v[248:251], a[72:75], a[28:31], v[248:251]
    ds_read_b64_tr_b16 a[72:73], v12 offset:21504
    v_mfma_f32_16x16x32_bf16 v[140:143], a[76:79], a[0:3], v[140:143]
    ds_read_b64_tr_b16 a[74:75], v12 offset:21760
    s_add_u32 m0, s78, 4096
    v_mfma_f32_16x16x32_bf16 v[156:159], a[76:79], a[4:7], v[156:159]
    buffer_load_dwordx4 v3, s[40:43], s72 offen offset:0 lds
    v_mfma_f32_16x16x32_bf16 v[172:175], a[76:79], a[8:11], v[172:175]
    ds_read_b128 a[56:59], v9 offset:12288
    v_mfma_f32_16x16x32_bf16 v[188:191], a[76:79], a[12:15], v[188:191]
    v_mfma_f32_16x16x32_bf16 v[204:207], a[76:79], a[16:19], v[204:207]
    v_mfma_f32_16x16x32_bf16 v[220:223], a[76:79], a[20:23], v[220:223]
    v_mfma_f32_16x16x32_bf16 v[236:239], a[76:79], a[24:27], v[236:239]
    ds_read_b128 a[60:63], v9 offset:14336
    v_mfma_f32_16x16x32_bf16 v[252:255], a[76:79], a[28:31], v[252:255]
    ds_read_b64_tr_b16 a[76:77], v14 offset:21504
    v_mfma_f32_16x16x32_bf16 a[128:131], a[80:83], a[0:3], a[128:131]
    ds_read_b64_tr_b16 a[78:79], v14 offset:21760
    v_mfma_f32_16x16x32_bf16 a[144:147], a[80:83], a[4:7], a[144:147]
    buffer_load_dwordx4 v3, s[36:39], s73 offen offset:1024 lds
    v_mfma_f32_16x16x32_bf16 a[160:163], a[80:83], a[8:11], a[160:163]
    ds_read_b64_tr_b16 a[104:105], v12 offset:24576
    v_mfma_f32_16x16x32_bf16 a[176:179], a[80:83], a[12:15], a[176:179]
    v_mfma_f32_16x16x32_bf16 a[192:195], a[80:83], a[16:19], a[192:195]
    v_mfma_f32_16x16x32_bf16 a[208:211], a[80:83], a[20:23], a[208:211]
    v_mfma_f32_16x16x32_bf16 a[224:227], a[80:83], a[24:27], a[224:227]
    ds_read_b64_tr_b16 a[106:107], v12 offset:24832
    v_mfma_f32_16x16x32_bf16 a[240:243], a[80:83], a[28:31], a[240:243]
    ds_read_b64_tr_b16 a[80:81], v12 offset:22528
    v_mfma_f32_16x16x32_bf16 a[132:135], a[84:87], a[0:3], a[132:135]
    ds_read_b64_tr_b16 a[82:83], v12 offset:22784
    v_mfma_f32_16x16x32_bf16 a[148:151], a[84:87], a[4:7], a[148:151]
    buffer_load_dwordx4 v3, s[40:43], s74 offen offset:2048 lds
    v_mfma_f32_16x16x32_bf16 a[164:167], a[84:87], a[8:11], a[164:167]
    ds_read_b64_tr_b16 a[108:109], v14 offset:24576
    v_mfma_f32_16x16x32_bf16 a[180:183], a[84:87], a[12:15], a[180:183]
    v_mfma_f32_16x16x32_bf16 a[196:199], a[84:87], a[16:19], a[196:199]
    buffer_load_dwordx4 v3, s[36:39], s75 offen offset:3072 lds
    v_mfma_f32_16x16x32_bf16 a[212:215], a[84:87], a[20:23], a[212:215]
    v_mfma_f32_16x16x32_bf16 a[228:231], a[84:87], a[24:27], a[228:231]
    ds_read_b64_tr_b16 a[110:111], v14 offset:24832
    v_mfma_f32_16x16x32_bf16 a[244:247], a[84:87], a[28:31], a[244:247]
    ds_read_b64_tr_b16 a[84:85], v14 offset:22528
    v_mfma_f32_16x16x32_bf16 a[136:139], a[88:91], a[0:3], a[136:139]
    ds_read_b64_tr_b16 a[86:87], v14 offset:22784
    v_mfma_f32_16x16x32_bf16 a[152:155], a[88:91], a[4:7], a[152:155]
    s_add_u32 m0, s78, 8192
    v_mfma_f32_16x16x32_bf16 a[168:171], a[88:91], a[8:11], a[168:171]
    buffer_load_dwordx4 v3, s[40:43], s76 offen offset:0 lds
    v_add_u32 v3, 229376, v3
    v_mfma_f32_16x16x32_bf16 a[184:187], a[88:91], a[12:15], a[184:187]
    v_mfma_f32_16x16x32_bf16 a[200:203], a[88:91], a[16:19], a[200:203]
    v_mfma_f32_16x16x32_bf16 a[216:219], a[88:91], a[20:23], a[216:219]
    v_mfma_f32_16x16x32_bf16 a[232:235], a[88:91], a[24:27], a[232:235]
    v_mfma_f32_16x16x32_bf16 a[248:251], a[88:91], a[28:31], a[248:251]
    ds_read_b64_tr_b16 a[88:89], v12 offset:23552
    v_mfma_f32_16x16x32_bf16 a[140:143], a[92:95], a[0:3], a[140:143]
    ds_read_b64_tr_b16 a[90:91], v12 offset:23808
    v_mfma_f32_16x16x32_bf16 a[156:159], a[92:95], a[4:7], a[156:159]
    global_load_lds_dwordx4 v[4:5], off offset:1024
    v_lshl_add_u64 v[4:5], v[4:5], 0, s[80:81]
    v_mfma_f32_16x16x32_bf16 a[172:175], a[92:95], a[8:11], a[172:175]
    v_mfma_f32_16x16x32_bf16 a[188:191], a[92:95], a[12:15], a[188:191]
    v_mfma_f32_16x16x32_bf16 a[204:207], a[92:95], a[16:19], a[204:207]
    v_mfma_f32_16x16x32_bf16 a[220:223], a[92:95], a[20:23], a[220:223]
    v_mfma_f32_16x16x32_bf16 a[236:239], a[92:95], a[24:27], a[236:239]
    v_mfma_f32_16x16x32_bf16 a[252:255], a[92:95], a[28:31], a[252:255]
    ds_read_b64_tr_b16 a[92:93], v14 offset:23552
    v_mfma_f32_16x16x32_bf16 v[48:51], a[96:99], a[0:3], v[48:51]
    ds_read_b64_tr_b16 a[94:95], v14 offset:23808
    v_mfma_f32_16x16x32_bf16 v[52:55], a[96:99], a[4:7], v[52:55]
    v_mfma_f32_16x16x32_bf16 v[64:67], a[96:99], a[8:11], v[64:67]
    v_mfma_f32_16x16x32_bf16 v[68:71], a[96:99], a[12:15], v[68:71]
    v_mfma_f32_16x16x32_bf16 v[80:83], a[96:99], a[16:19], v[80:83]
    v_mfma_f32_16x16x32_bf16 v[84:87], a[96:99], a[20:23], v[84:87]
    v_mfma_f32_16x16x32_bf16 v[96:99], a[96:99], a[24:27], v[96:99]
    v_mfma_f32_16x16x32_bf16 v[100:103], a[96:99], a[28:31], v[100:103]
    v_mfma_f32_16x16x32_bf16 v[56:59], a[100:103], a[0:3], v[56:59]
    v_mfma_f32_16x16x32_bf16 v[60:63], a[100:103], a[4:7], v[60:63]
    v_mfma_f32_16x16x32_bf16 v[72:75], a[100:103], a[8:11], v[72:75]
    v_mfma_f32_16x16x32_bf16 v[76:79], a[100:103], a[12:15], v[76:79]
    v_mfma_f32_16x16x32_bf16 v[88:91], a[100:103], a[16:19], v[88:91]
    v_mfma_f32_16x16x32_bf16 v[92:95], a[100:103], a[20:23], v[92:95]
    v_mfma_f32_16x16x32_bf16 v[104:107], a[100:103], a[24:27], v[104:107]
    v_mfma_f32_16x16x32_bf16 v[108:111], a[100:103], a[28:31], v[108:111]
    s_waitcnt vmcnt(22) lgkmcnt(0)
    s_barrier
    v_mfma_f32_16x16x32_bf16 v[128:131], a[64:67], a[32:35], v[128:131]
    s_mov_b32 m0, s14
    s_mov_b32 s77, 4096
    v_mfma_f32_16x16x32_bf16 v[144:147], a[64:67], a[36:39], v[144:147]
    buffer_load_dwordx4 v1, s[28:31], s77 offen sc1 lds
    v_mfma_f32_16x16x32_bf16 v[160:163], a[64:67], a[40:43], v[160:163]
    ds_read_b128 a[0:3], v8 offset:34816
    v_mfma_f32_16x16x32_bf16 v[176:179], a[64:67], a[44:47], v[176:179]
    v_mfma_f32_16x16x32_bf16 v[192:195], a[64:67], a[48:51], v[192:195]
    v_mfma_f32_16x16x32_bf16 v[208:211], a[64:67], a[52:55], v[208:211]
    v_mfma_f32_16x16x32_bf16 v[224:227], a[64:67], a[56:59], v[224:227]
    ds_read_b128 a[4:7], v8 offset:36864
    v_mfma_f32_16x16x32_bf16 v[240:243], a[64:67], a[60:63], v[240:243]
    ds_read_b64_tr_b16 a[64:65], v13 offset:0
    v_mfma_f32_16x16x32_bf16 v[132:135], a[68:71], a[32:35], v[132:135]
    ds_read_b64_tr_b16 a[66:67], v13 offset:256
    s_mov_b32 s77, 19456
    v_mfma_f32_16x16x32_bf16 v[148:151], a[68:71], a[36:39], v[148:151]
    buffer_load_dwordx4 v1, s[28:31], s77 offen offset:1024 sc1 lds
    v_add_u32 v1, 128, v1
    v_mfma_f32_16x16x32_bf16 v[164:167], a[68:71], a[40:43], v[164:167]
    ds_read_b128 a[8:11], v8 offset:38912
    s_add_u32 m0, s78, 20480
    v_mfma_f32_16x16x32_bf16 v[180:183], a[68:71], a[44:47], v[180:183]
    buffer_load_dwordx4 v2, s[32:35], s68 offen offset:0 lds
    v_mfma_f32_16x16x32_bf16 v[196:199], a[68:71], a[48:51], v[196:199]
    v_mfma_f32_16x16x32_bf16 v[212:215], a[68:71], a[52:55], v[212:215]
    v_mfma_f32_16x16x32_bf16 v[228:231], a[68:71], a[56:59], v[228:231]
    ds_read_b128 a[12:15], v8 offset:40960
    v_mfma_f32_16x16x32_bf16 v[244:247], a[68:71], a[60:63], v[244:247]
    ds_read_b64_tr_b16 a[68:69], v15 offset:0
    v_mfma_f32_16x16x32_bf16 v[136:139], a[72:75], a[32:35], v[136:139]
    ds_read_b64_tr_b16 a[70:71], v15 offset:256
    v_mfma_f32_16x16x32_bf16 v[152:155], a[72:75], a[36:39], v[152:155]
    buffer_load_dwordx4 v2, s[32:35], s69 offen offset:1024 lds
    v_mfma_f32_16x16x32_bf16 v[168:171], a[72:75], a[40:43], v[168:171]
    ds_read_b128 a[16:19], v8 offset:43008
    v_mfma_f32_16x16x32_bf16 v[184:187], a[72:75], a[44:47], v[184:187]
    v_mfma_f32_16x16x32_bf16 v[200:203], a[72:75], a[48:51], v[200:203]
    v_mfma_f32_16x16x32_bf16 v[216:219], a[72:75], a[52:55], v[216:219]
    buffer_load_dwordx4 v2, s[32:35], s70 offen offset:2048 lds
    v_add_u32 v2, 196608, v2
    v_mfma_f32_16x16x32_bf16 v[232:235], a[72:75], a[56:59], v[232:235]
    ds_read_b128 a[20:23], v8 offset:45056
    v_mfma_f32_16x16x32_bf16 v[248:251], a[72:75], a[60:63], v[248:251]
    ds_read_b64_tr_b16 a[72:73], v13 offset:1024
    v_mfma_f32_16x16x32_bf16 v[140:143], a[76:79], a[32:35], v[140:143]
    ds_read_b64_tr_b16 a[74:75], v13 offset:1280
    v_mfma_f32_16x16x32_bf16 v[156:159], a[76:79], a[36:39], v[156:159]
    v_mfma_f32_16x16x32_bf16 v[172:175], a[76:79], a[40:43], v[172:175]
    ds_read_b128 a[24:27], v8 offset:47104
    v_mfma_f32_16x16x32_bf16 v[188:191], a[76:79], a[44:47], v[188:191]
    buffer_load_dwordx4 v3, s[36:39], s71 offen offset:3072 lds
    v_mfma_f32_16x16x32_bf16 v[204:207], a[76:79], a[48:51], v[204:207]
    v_mfma_f32_16x16x32_bf16 v[220:223], a[76:79], a[52:55], v[220:223]
    v_mfma_f32_16x16x32_bf16 v[236:239], a[76:79], a[56:59], v[236:239]
    ds_read_b128 a[28:31], v8 offset:49152
    v_mfma_f32_16x16x32_bf16 v[252:255], a[76:79], a[60:63], v[252:255]
    ds_read_b64_tr_b16 a[76:77], v15 offset:1024
    v_mfma_f32_16x16x32_bf16 a[128:131], a[80:83], a[32:35], a[128:131]
    ds_read_b64_tr_b16 a[78:79], v15 offset:1280
    s_add_u32 m0, s78, 24576
    v_mfma_f32_16x16x32_bf16 a[144:147], a[80:83], a[36:39], a[144:147]
    buffer_load_dwordx4 v3, s[40:43], s72 offen offset:0 lds
    v_mfma_f32_16x16x32_bf16 a[160:163], a[80:83], a[40:43], a[160:163]
    ds_read_b64_tr_b16 a[96:97], v13 offset:4096
    v_mfma_f32_16x16x32_bf16 a[176:179], a[80:83], a[44:47], a[176:179]
    v_mfma_f32_16x16x32_bf16 a[192:195], a[80:83], a[48:51], a[192:195]
    v_mfma_f32_16x16x32_bf16 a[208:211], a[80:83], a[52:55], a[208:211]
    buffer_load_dwordx4 v3, s[36:39], s73 offen offset:1024 lds
    v_mfma_f32_16x16x32_bf16 a[224:227], a[80:83], a[56:59], a[224:227]
    ds_read_b64_tr_b16 a[98:99], v13 offset:4352
    v_mfma_f32_16x16x32_bf16 a[240:243], a[80:83], a[60:63], a[240:243]
    ds_read_b64_tr_b16 a[80:81], v13 offset:2048
    v_mfma_f32_16x16x32_bf16 a[132:135], a[84:87], a[32:35], a[132:135]
    ds_read_b64_tr_b16 a[82:83], v13 offset:2304
    v_mfma_f32_16x16x32_bf16 a[148:151], a[84:87], a[36:39], a[148:151]
    v_mfma_f32_16x16x32_bf16 a[164:167], a[84:87], a[40:43], a[164:167]
    ds_read_b64_tr_b16 a[100:101], v15 offset:4096
    v_mfma_f32_16x16x32_bf16 a[180:183], a[84:87], a[44:47], a[180:183]
    buffer_load_dwordx4 v3, s[40:43], s74 offen offset:2048 lds
    v_mfma_f32_16x16x32_bf16 a[196:199], a[84:87], a[48:51], a[196:199]
    v_mfma_f32_16x16x32_bf16 a[212:215], a[84:87], a[52:55], a[212:215]
    v_mfma_f32_16x16x32_bf16 a[228:231], a[84:87], a[56:59], a[228:231]
    ds_read_b64_tr_b16 a[102:103], v15 offset:4352
    v_mfma_f32_16x16x32_bf16 a[244:247], a[84:87], a[60:63], a[244:247]
    ds_read_b64_tr_b16 a[84:85], v15 offset:2048
    v_mfma_f32_16x16x32_bf16 a[136:139], a[88:91], a[32:35], a[136:139]
    ds_read_b64_tr_b16 a[86:87], v15 offset:2304
    v_mfma_f32_16x16x32_bf16 a[152:155], a[88:91], a[36:39], a[152:155]
    buffer_load_dwordx4 v3, s[36:39], s75 offen offset:3072 lds
    v_mfma_f32_16x16x32_bf16 a[168:171], a[88:91], a[40:43], a[168:171]
    v_mfma_f32_16x16x32_bf16 a[184:187], a[88:91], a[44:47], a[184:187]
    s_add_u32 m0, s78, 28672
    v_mfma_f32_16x16x32_bf16 a[200:203], a[88:91], a[48:51], a[200:203]
    buffer_load_dwordx4 v3, s[40:43], s76 offen offset:0 lds
    v_add_u32 v3, 229376, v3
    v_mfma_f32_16x16x32_bf16 a[216:219], a[88:91], a[52:55], a[216:219]
    v_mfma_f32_16x16x32_bf16 a[232:235], a[88:91], a[56:59], a[232:235]
    v_mfma_f32_16x16x32_bf16 a[248:251], a[88:91], a[60:63], a[248:251]
    ds_read_b64_tr_b16 a[88:89], v13 offset:3072
    v_mfma_f32_16x16x32_bf16 a[140:143], a[92:95], a[32:35], a[140:143]
    ds_read_b64_tr_b16 a[90:91], v13 offset:3328
    v_mfma_f32_16x16x32_bf16 a[156:159], a[92:95], a[36:39], a[156:159]
    global_load_lds_dwordx4 v[4:5], off offset:1024
    v_lshl_add_u64 v[4:5], v[4:5], 0, s[80:81]
    v_mfma_f32_16x16x32_bf16 a[172:175], a[92:95], a[40:43], a[172:175]
    v_mfma_f32_16x16x32_bf16 a[188:191], a[92:95], a[44:47], a[188:191]
    v_mfma_f32_16x16x32_bf16 a[204:207], a[92:95], a[48:51], a[204:207]
    v_mfma_f32_16x16x32_bf16 a[220:223], a[92:95], a[52:55], a[220:223]
    v_mfma_f32_16x16x32_bf16 a[236:239], a[92:95], a[56:59], a[236:239]
    v_mfma_f32_16x16x32_bf16 a[252:255], a[92:95], a[60:63], a[252:255]
    ds_read_b64_tr_b16 a[92:93], v15 offset:3072
    v_mfma_f32_16x16x32_bf16 v[48:51], a[104:107], a[32:35], v[48:51]
    ds_read_b64_tr_b16 a[94:95], v15 offset:3328
    v_mfma_f32_16x16x32_bf16 v[52:55], a[104:107], a[36:39], v[52:55]
    v_mfma_f32_16x16x32_bf16 v[64:67], a[104:107], a[40:43], v[64:67]
    v_mfma_f32_16x16x32_bf16 v[68:71], a[104:107], a[44:47], v[68:71]
    v_mfma_f32_16x16x32_bf16 v[80:83], a[104:107], a[48:51], v[80:83]
    v_mfma_f32_16x16x32_bf16 v[84:87], a[104:107], a[52:55], v[84:87]
    v_mfma_f32_16x16x32_bf16 v[96:99], a[104:107], a[56:59], v[96:99]
    v_mfma_f32_16x16x32_bf16 v[100:103], a[104:107], a[60:63], v[100:103]
    v_mfma_f32_16x16x32_bf16 v[56:59], a[108:111], a[32:35], v[56:59]
    v_mfma_f32_16x16x32_bf16 v[60:63], a[108:111], a[36:39], v[60:63]
    v_mfma_f32_16x16x32_bf16 v[72:75], a[108:111], a[40:43], v[72:75]
    v_mfma_f32_16x16x32_bf16 v[76:79], a[108:111], a[44:47], v[76:79]
    v_mfma_f32_16x16x32_bf16 v[88:91], a[108:111], a[48:51], v[88:91]
    v_mfma_f32_16x16x32_bf16 v[92:95], a[108:111], a[52:55], v[92:95]
    v_mfma_f32_16x16x32_bf16 v[104:107], a[108:111], a[56:59], v[104:107]
    v_mfma_f32_16x16x32_bf16 v[108:111], a[108:111], a[60:63], v[108:111]
    s_waitcnt vmcnt(24) lgkmcnt(0)
    s_barrier
    v_mfma_f32_16x16x32_bf16 v[128:131], a[64:67], a[0:3], v[128:131]
    s_add_u32 m0, s78, 40960
    buffer_load_dword v7, v6, s[44:47], s4 offen
    v_add_u32_e64 v6, s79, v6
    v_mfma_f32_16x16x32_bf16 v[144:147], a[64:67], a[4:7], v[144:147]
    buffer_load_dwordx4 v2, s[32:35], s68 offen offset:0 lds
    buffer_load_dword v7, v33, s[48:51], 0 offen
    v_add_u32_e64 v33, s52, v33
    v_mfma_f32_16x16x32_bf16 v[160:163], a[64:67], a[8:11], v[160:163]
    ds_read_b128 a[32:35], v9 offset:34816
    v_mfma_f32_16x16x32_bf16 v[176:179], a[64:67], a[12:15], v[176:179]
    v_mfma_f32_16x16x32_bf16 v[192:195], a[64:67], a[16:19], v[192:195]
    v_mfma_f32_16x16x32_bf16 v[208:211], a[64:67], a[20:23], v[208:211]
    v_mfma_f32_16x16x32_bf16 v[224:227], a[64:67], a[24:27], v[224:227]
    ds_read_b128 a[36:39], v9 offset:36864
    v_mfma_f32_16x16x32_bf16 v[240:243], a[64:67], a[28:31], v[240:243]
    ds_read_b64_tr_b16 a[64:65], v13 offset:20480
    v_mfma_f32_16x16x32_bf16 v[132:135], a[68:71], a[0:3], v[132:135]
    ds_read_b64_tr_b16 a[66:67], v13 offset:20736
    v_mfma_f32_16x16x32_bf16 v[148:151], a[68:71], a[4:7], v[148:151]
    buffer_load_dwordx4 v2, s[32:35], s69 offen offset:1024 lds
    v_mfma_f32_16x16x32_bf16 v[164:167], a[68:71], a[8:11], v[164:167]
    ds_read_b128 a[40:43], v9 offset:38912
    v_mfma_f32_16x16x32_bf16 v[180:183], a[68:71], a[12:15], v[180:183]
    v_mfma_f32_16x16x32_bf16 v[196:199], a[68:71], a[16:19], v[196:199]
    v_mfma_f32_16x16x32_bf16 v[212:215], a[68:71], a[20:23], v[212:215]
    buffer_load_dwordx4 v2, s[32:35], s70 offen offset:2048 lds
    v_add_u32 v2, 196608, v2
    v_mfma_f32_16x16x32_bf16 v[228:231], a[68:71], a[24:27], v[228:231]
    ds_read_b128 a[44:47], v9 offset:40960
    v_mfma_f32_16x16x32_bf16 v[244:247], a[68:71], a[28:31], v[244:247]
    ds_read_b64_tr_b16 a[68:69], v15 offset:20480
    v_mfma_f32_16x16x32_bf16 v[136:139], a[72:75], a[0:3], v[136:139]
    ds_read_b64_tr_b16 a[70:71], v15 offset:20736
    v_mfma_f32_16x16x32_bf16 v[152:155], a[72:75], a[4:7], v[152:155]
    v_mfma_f32_16x16x32_bf16 v[168:171], a[72:75], a[8:11], v[168:171]
    ds_read_b128 a[48:51], v9 offset:43008
    v_mfma_f32_16x16x32_bf16 v[184:187], a[72:75], a[12:15], v[184:187]
    buffer_load_dwordx4 v3, s[36:39], s71 offen offset:3072 lds
    v_mfma_f32_16x16x32_bf16 v[200:203], a[72:75], a[16:19], v[200:203]
    v_mfma_f32_16x16x32_bf16 v[216:219], a[72:75], a[20:23], v[216:219]
    v_mfma_f32_16x16x32_bf16 v[232:235], a[72:75], a[24:27], v[232:235]
    ds_read_b128 a[52:55], v9 offset:45056
    v_mfma_f32_16x16x32_bf16 v[248:251], a[72:75], a[28:31], v[248:251]
    ds_read_b64_tr_b16 a[72:73], v13 offset:21504
    v_mfma_f32_16x16x32_bf16 v[140:143], a[76:79], a[0:3], v[140:143]
    ds_read_b64_tr_b16 a[74:75], v13 offset:21760
    s_add_u32 m0, s78, 45056
    v_mfma_f32_16x16x32_bf16 v[156:159], a[76:79], a[4:7], v[156:159]
    buffer_load_dwordx4 v3, s[40:43], s72 offen offset:0 lds
    v_mfma_f32_16x16x32_bf16 v[172:175], a[76:79], a[8:11], v[172:175]
    ds_read_b128 a[56:59], v9 offset:47104
    v_mfma_f32_16x16x32_bf16 v[188:191], a[76:79], a[12:15], v[188:191]
    v_mfma_f32_16x16x32_bf16 v[204:207], a[76:79], a[16:19], v[204:207]
    v_mfma_f32_16x16x32_bf16 v[220:223], a[76:79], a[20:23], v[220:223]
    v_mfma_f32_16x16x32_bf16 v[236:239], a[76:79], a[24:27], v[236:239]
    ds_read_b128 a[60:63], v9 offset:49152
    v_mfma_f32_16x16x32_bf16 v[252:255], a[76:79], a[28:31], v[252:255]
    ds_read_b64_tr_b16 a[76:77], v15 offset:21504
    v_mfma_f32_16x16x32_bf16 a[128:131], a[80:83], a[0:3], a[128:131]
    ds_read_b64_tr_b16 a[78:79], v15 offset:21760
    v_mfma_f32_16x16x32_bf16 a[144:147], a[80:83], a[4:7], a[144:147]
    buffer_load_dwordx4 v3, s[36:39], s73 offen offset:1024 lds
    v_mfma_f32_16x16x32_bf16 a[160:163], a[80:83], a[8:11], a[160:163]
    ds_read_b64_tr_b16 a[104:105], v13 offset:24576
    v_mfma_f32_16x16x32_bf16 a[176:179], a[80:83], a[12:15], a[176:179]
    v_mfma_f32_16x16x32_bf16 a[192:195], a[80:83], a[16:19], a[192:195]
    v_mfma_f32_16x16x32_bf16 a[208:211], a[80:83], a[20:23], a[208:211]
    v_mfma_f32_16x16x32_bf16 a[224:227], a[80:83], a[24:27], a[224:227]
    ds_read_b64_tr_b16 a[106:107], v13 offset:24832
    v_mfma_f32_16x16x32_bf16 a[240:243], a[80:83], a[28:31], a[240:243]
    ds_read_b64_tr_b16 a[80:81], v13 offset:22528
    v_mfma_f32_16x16x32_bf16 a[132:135], a[84:87], a[0:3], a[132:135]
    ds_read_b64_tr_b16 a[82:83], v13 offset:22784
    v_mfma_f32_16x16x32_bf16 a[148:151], a[84:87], a[4:7], a[148:151]
    buffer_load_dwordx4 v3, s[40:43], s74 offen offset:2048 lds
    v_mfma_f32_16x16x32_bf16 a[164:167], a[84:87], a[8:11], a[164:167]
    ds_read_b64_tr_b16 a[108:109], v15 offset:24576
    v_mfma_f32_16x16x32_bf16 a[180:183], a[84:87], a[12:15], a[180:183]
    v_mfma_f32_16x16x32_bf16 a[196:199], a[84:87], a[16:19], a[196:199]
    buffer_load_dwordx4 v3, s[36:39], s75 offen offset:3072 lds
    v_mfma_f32_16x16x32_bf16 a[212:215], a[84:87], a[20:23], a[212:215]
    v_mfma_f32_16x16x32_bf16 a[228:231], a[84:87], a[24:27], a[228:231]
    ds_read_b64_tr_b16 a[110:111], v15 offset:24832
    v_mfma_f32_16x16x32_bf16 a[244:247], a[84:87], a[28:31], a[244:247]
    ds_read_b64_tr_b16 a[84:85], v15 offset:22528
    v_mfma_f32_16x16x32_bf16 a[136:139], a[88:91], a[0:3], a[136:139]
    ds_read_b64_tr_b16 a[86:87], v15 offset:22784
    v_mfma_f32_16x16x32_bf16 a[152:155], a[88:91], a[4:7], a[152:155]
    s_add_u32 m0, s78, 49152
    v_mfma_f32_16x16x32_bf16 a[168:171], a[88:91], a[8:11], a[168:171]
    buffer_load_dwordx4 v3, s[40:43], s76 offen offset:0 lds
    v_add_u32 v3, 229376, v3
    v_mfma_f32_16x16x32_bf16 a[184:187], a[88:91], a[12:15], a[184:187]
    v_mfma_f32_16x16x32_bf16 a[200:203], a[88:91], a[16:19], a[200:203]
    v_mfma_f32_16x16x32_bf16 a[216:219], a[88:91], a[20:23], a[216:219]
    v_mfma_f32_16x16x32_bf16 a[232:235], a[88:91], a[24:27], a[232:235]
    v_mfma_f32_16x16x32_bf16 a[248:251], a[88:91], a[28:31], a[248:251]
    ds_read_b64_tr_b16 a[88:89], v13 offset:23552
    v_mfma_f32_16x16x32_bf16 a[140:143], a[92:95], a[0:3], a[140:143]
    ds_read_b64_tr_b16 a[90:91], v13 offset:23808
    v_mfma_f32_16x16x32_bf16 a[156:159], a[92:95], a[4:7], a[156:159]
    global_load_lds_dwordx4 v[4:5], off offset:1024
    v_lshl_add_u64 v[4:5], v[4:5], 0, s[80:81]
    v_mfma_f32_16x16x32_bf16 a[172:175], a[92:95], a[8:11], a[172:175]
    v_mfma_f32_16x16x32_bf16 a[188:191], a[92:95], a[12:15], a[188:191]
    v_mfma_f32_16x16x32_bf16 a[204:207], a[92:95], a[16:19], a[204:207]
    v_mfma_f32_16x16x32_bf16 a[220:223], a[92:95], a[20:23], a[220:223]
    v_mfma_f32_16x16x32_bf16 a[236:239], a[92:95], a[24:27], a[236:239]
    v_mfma_f32_16x16x32_bf16 a[252:255], a[92:95], a[28:31], a[252:255]
    ds_read_b64_tr_b16 a[92:93], v15 offset:23552
    v_mfma_f32_16x16x32_bf16 v[48:51], a[96:99], a[0:3], v[48:51]
    ds_read_b64_tr_b16 a[94:95], v15 offset:23808
    v_mfma_f32_16x16x32_bf16 v[52:55], a[96:99], a[4:7], v[52:55]
    v_mfma_f32_16x16x32_bf16 v[64:67], a[96:99], a[8:11], v[64:67]
    v_mfma_f32_16x16x32_bf16 v[68:71], a[96:99], a[12:15], v[68:71]
    v_mfma_f32_16x16x32_bf16 v[80:83], a[96:99], a[16:19], v[80:83]
    v_mfma_f32_16x16x32_bf16 v[84:87], a[96:99], a[20:23], v[84:87]
    v_mfma_f32_16x16x32_bf16 v[96:99], a[96:99], a[24:27], v[96:99]
    v_mfma_f32_16x16x32_bf16 v[100:103], a[96:99], a[28:31], v[100:103]
    v_mfma_f32_16x16x32_bf16 v[56:59], a[100:103], a[0:3], v[56:59]
    v_mfma_f32_16x16x32_bf16 v[60:63], a[100:103], a[4:7], v[60:63]
    v_mfma_f32_16x16x32_bf16 v[72:75], a[100:103], a[8:11], v[72:75]
    v_mfma_f32_16x16x32_bf16 v[76:79], a[100:103], a[12:15], v[76:79]
    v_mfma_f32_16x16x32_bf16 v[88:91], a[100:103], a[16:19], v[88:91]
    v_mfma_f32_16x16x32_bf16 v[92:95], a[100:103], a[20:23], v[92:95]
    v_mfma_f32_16x16x32_bf16 v[104:107], a[100:103], a[24:27], v[104:107]
    v_mfma_f32_16x16x32_bf16 v[108:111], a[100:103], a[28:31], v[108:111]
    s_waitcnt vmcnt(22) lgkmcnt(0)
    s_barrier
    v_mfma_f32_16x16x32_bf16 v[128:131], a[64:67], a[32:35], v[128:131]
    s_mov_b32 m0, s15
    s_mov_b32 s77, 4096
    v_mfma_f32_16x16x32_bf16 v[144:147], a[64:67], a[36:39], v[144:147]
    buffer_load_dwordx4 v1, s[28:31], s77 offen sc1 lds
    v_mfma_f32_16x16x32_bf16 v[160:163], a[64:67], a[40:43], v[160:163]
    ds_read_b128 a[0:3], v8 offset:0
    v_mfma_f32_16x16x32_bf16 v[176:179], a[64:67], a[44:47], v[176:179]
    v_mfma_f32_16x16x32_bf16 v[192:195], a[64:67], a[48:51], v[192:195]
    v_mfma_f32_16x16x32_bf16 v[208:211], a[64:67], a[52:55], v[208:211]
    v_mfma_f32_16x16x32_bf16 v[224:227], a[64:67], a[56:59], v[224:227]
    ds_read_b128 a[4:7], v8 offset:2048
    v_mfma_f32_16x16x32_bf16 v[240:243], a[64:67], a[60:63], v[240:243]
    ds_read_b64_tr_b16 a[64:65], v12 offset:0
    v_mfma_f32_16x16x32_bf16 v[132:135], a[68:71], a[32:35], v[132:135]
    ds_read_b64_tr_b16 a[66:67], v12 offset:256
    s_mov_b32 s77, 19456
    v_mfma_f32_16x16x32_bf16 v[148:151], a[68:71], a[36:39], v[148:151]
    buffer_load_dwordx4 v1, s[28:31], s77 offen offset:1024 sc1 lds
    v_add_u32 v1, 128, v1
    v_mfma_f32_16x16x32_bf16 v[164:167], a[68:71], a[40:43], v[164:167]
    ds_read_b128 a[8:11], v8 offset:4096
    s_add_u32 m0, s78, 61440
    v_mfma_f32_16x16x32_bf16 v[180:183], a[68:71], a[44:47], v[180:183]
    buffer_load_dwordx4 v2, s[32:35], s68 offen offset:0 lds
    v_mfma_f32_16x16x32_bf16 v[196:199], a[68:71], a[48:51], v[196:199]
    v_mfma_f32_16x16x32_bf16 v[212:215], a[68:71], a[52:55], v[212:215]
    v_mfma_f32_16x16x32_bf16 v[228:231], a[68:71], a[56:59], v[228:231]
    ds_read_b128 a[12:15], v8 offset:6144
    v_mfma_f32_16x16x32_bf16 v[244:247], a[68:71], a[60:63], v[244:247]
    ds_read_b64_tr_b16 a[68:69], v14 offset:0
    v_mfma_f32_16x16x32_bf16 v[136:139], a[72:75], a[32:35], v[136:139]
    ds_read_b64_tr_b16 a[70:71], v14 offset:256
    v_mfma_f32_16x16x32_bf16 v[152:155], a[72:75], a[36:39], v[152:155]
    buffer_load_dwordx4 v2, s[32:35], s69 offen offset:1024 lds
    v_mfma_f32_16x16x32_bf16 v[168:171], a[72:75], a[40:43], v[168:171]
    ds_read_b128 a[16:19], v8 offset:8192
    v_mfma_f32_16x16x32_bf16 v[184:187], a[72:75], a[44:47], v[184:187]
    v_mfma_f32_16x16x32_bf16 v[200:203], a[72:75], a[48:51], v[200:203]
    v_mfma_f32_16x16x32_bf16 v[216:219], a[72:75], a[52:55], v[216:219]
    buffer_load_dwordx4 v2, s[32:35], s70 offen offset:2048 lds
    v_add_u32 v2, 196608, v2
    v_mfma_f32_16x16x32_bf16 v[232:235], a[72:75], a[56:59], v[232:235]
    ds_read_b128 a[20:23], v8 offset:10240
    v_mfma_f32_16x16x32_bf16 v[248:251], a[72:75], a[60:63], v[248:251]
    ds_read_b64_tr_b16 a[72:73], v12 offset:1024
    v_mfma_f32_16x16x32_bf16 v[140:143], a[76:79], a[32:35], v[140:143]
    ds_read_b64_tr_b16 a[74:75], v12 offset:1280
    v_mfma_f32_16x16x32_bf16 v[156:159], a[76:79], a[36:39], v[156:159]
    v_mfma_f32_16x16x32_bf16 v[172:175], a[76:79], a[40:43], v[172:175]
    ds_read_b128 a[24:27], v8 offset:12288
    v_mfma_f32_16x16x32_bf16 v[188:191], a[76:79], a[44:47], v[188:191]
    buffer_load_dwordx4 v3, s[36:39], s71 offen offset:3072 lds
    v_mfma_f32_16x16x32_bf16 v[204:207], a[76:79], a[48:51], v[204:207]
    v_mfma_f32_16x16x32_bf16 v[220:223], a[76:79], a[52:55], v[220:223]
    v_mfma_f32_16x16x32_bf16 v[236:239], a[76:79], a[56:59], v[236:239]
    ds_read_b128 a[28:31], v8 offset:14336
    v_mfma_f32_16x16x32_bf16 v[252:255], a[76:79], a[60:63], v[252:255]
    ds_read_b64_tr_b16 a[76:77], v14 offset:1024
    v_mfma_f32_16x16x32_bf16 a[128:131], a[80:83], a[32:35], a[128:131]
    ds_read_b64_tr_b16 a[78:79], v14 offset:1280
    s_add_u32 m0, s78, 65536
    v_mfma_f32_16x16x32_bf16 a[144:147], a[80:83], a[36:39], a[144:147]
    buffer_load_dwordx4 v3, s[40:43], s72 offen offset:0 lds
    v_mfma_f32_16x16x32_bf16 a[160:163], a[80:83], a[40:43], a[160:163]
    ds_read_b64_tr_b16 a[96:97], v12 offset:4096
    v_mfma_f32_16x16x32_bf16 a[176:179], a[80:83], a[44:47], a[176:179]
    v_mfma_f32_16x16x32_bf16 a[192:195], a[80:83], a[48:51], a[192:195]
    v_mfma_f32_16x16x32_bf16 a[208:211], a[80:83], a[52:55], a[208:211]
    buffer_load_dwordx4 v3, s[36:39], s73 offen offset:1024 lds
    v_mfma_f32_16x16x32_bf16 a[224:227], a[80:83], a[56:59], a[224:227]
    ds_read_b64_tr_b16 a[98:99], v12 offset:4352
    v_mfma_f32_16x16x32_bf16 a[240:243], a[80:83], a[60:63], a[240:243]
    ds_read_b64_tr_b16 a[80:81], v12 offset:2048
    v_mfma_f32_16x16x32_bf16 a[132:135], a[84:87], a[32:35], a[132:135]
    ds_read_b64_tr_b16 a[82:83], v12 offset:2304
    v_mfma_f32_16x16x32_bf16 a[148:151], a[84:87], a[36:39], a[148:151]
    v_mfma_f32_16x16x32_bf16 a[164:167], a[84:87], a[40:43], a[164:167]
    ds_read_b64_tr_b16 a[100:101], v14 offset:4096
    v_mfma_f32_16x16x32_bf16 a[180:183], a[84:87], a[44:47], a[180:183]
    buffer_load_dwordx4 v3, s[40:43], s74 offen offset:2048 lds
    v_mfma_f32_16x16x32_bf16 a[196:199], a[84:87], a[48:51], a[196:199]
    v_mfma_f32_16x16x32_bf16 a[212:215], a[84:87], a[52:55], a[212:215]
    v_mfma_f32_16x16x32_bf16 a[228:231], a[84:87], a[56:59], a[228:231]
    ds_read_b64_tr_b16 a[102:103], v14 offset:4352
    v_mfma_f32_16x16x32_bf16 a[244:247], a[84:87], a[60:63], a[244:247]
    ds_read_b64_tr_b16 a[84:85], v14 offset:2048
    v_mfma_f32_16x16x32_bf16 a[136:139], a[88:91], a[32:35], a[136:139]
    ds_read_b64_tr_b16 a[86:87], v14 offset:2304
    v_mfma_f32_16x16x32_bf16 a[152:155], a[88:91], a[36:39], a[152:155]
    buffer_load_dwordx4 v3, s[36:39], s75 offen offset:3072 lds
    v_mfma_f32_16x16x32_bf16 a[168:171], a[88:91], a[40:43], a[168:171]
    v_mfma_f32_16x16x32_bf16 a[184:187], a[88:91], a[44:47], a[184:187]
    s_add_u32 m0, s78, 69632
    v_mfma_f32_16x16x32_bf16 a[200:203], a[88:91], a[48:51], a[200:203]
    buffer_load_dwordx4 v3, s[40:43], s76 offen offset:0 lds
    v_add_u32 v3, 229376, v3
    v_mfma_f32_16x16x32_bf16 a[216:219], a[88:91], a[52:55], a[216:219]
    v_mfma_f32_16x16x32_bf16 a[232:235], a[88:91], a[56:59], a[232:235]
    v_mfma_f32_16x16x32_bf16 a[248:251], a[88:91], a[60:63], a[248:251]
    ds_read_b64_tr_b16 a[88:89], v12 offset:3072
    v_mfma_f32_16x16x32_bf16 a[140:143], a[92:95], a[32:35], a[140:143]
    ds_read_b64_tr_b16 a[90:91], v12 offset:3328
    v_mfma_f32_16x16x32_bf16 a[156:159], a[92:95], a[36:39], a[156:159]
    global_load_lds_dwordx4 v[4:5], off offset:1024
    v_lshl_add_u64 v[4:5], v[4:5], 0, s[80:81]
    v_mfma_f32_16x16x32_bf16 a[172:175], a[92:95], a[40:43], a[172:175]
    v_mfma_f32_16x16x32_bf16 a[188:191], a[92:95], a[44:47], a[188:191]
    v_mfma_f32_16x16x32_bf16 a[204:207], a[92:95], a[48:51], a[204:207]
    v_mfma_f32_16x16x32_bf16 a[220:223], a[92:95], a[52:55], a[220:223]
    v_mfma_f32_16x16x32_bf16 a[236:239], a[92:95], a[56:59], a[236:239]
    v_mfma_f32_16x16x32_bf16 a[252:255], a[92:95], a[60:63], a[252:255]
    ds_read_b64_tr_b16 a[92:93], v14 offset:3072
    v_mfma_f32_16x16x32_bf16 v[48:51], a[104:107], a[32:35], v[48:51]
    ds_read_b64_tr_b16 a[94:95], v14 offset:3328
    v_mfma_f32_16x16x32_bf16 v[52:55], a[104:107], a[36:39], v[52:55]
    v_mfma_f32_16x16x32_bf16 v[64:67], a[104:107], a[40:43], v[64:67]
    v_mfma_f32_16x16x32_bf16 v[68:71], a[104:107], a[44:47], v[68:71]
    v_mfma_f32_16x16x32_bf16 v[80:83], a[104:107], a[48:51], v[80:83]
    v_mfma_f32_16x16x32_bf16 v[84:87], a[104:107], a[52:55], v[84:87]
    v_mfma_f32_16x16x32_bf16 v[96:99], a[104:107], a[56:59], v[96:99]
    v_mfma_f32_16x16x32_bf16 v[100:103], a[104:107], a[60:63], v[100:103]
    v_mfma_f32_16x16x32_bf16 v[56:59], a[108:111], a[32:35], v[56:59]
    v_mfma_f32_16x16x32_bf16 v[60:63], a[108:111], a[36:39], v[60:63]
    v_mfma_f32_16x16x32_bf16 v[72:75], a[108:111], a[40:43], v[72:75]
    v_mfma_f32_16x16x32_bf16 v[76:79], a[108:111], a[44:47], v[76:79]
    v_mfma_f32_16x16x32_bf16 v[88:91], a[108:111], a[48:51], v[88:91]
    v_mfma_f32_16x16x32_bf16 v[92:95], a[108:111], a[52:55], v[92:95]
    v_mfma_f32_16x16x32_bf16 v[104:107], a[108:111], a[56:59], v[104:107]
    v_mfma_f32_16x16x32_bf16 v[108:111], a[108:111], a[60:63], v[108:111]
    s_sub_u32 s67, s67, 1
    s_cmp_lg_u32 s67, 0
    s_cbranch_scc1 L_loop1
L_tail1:
    s_waitcnt vmcnt(24) lgkmcnt(0)
    s_barrier
    v_mfma_f32_16x16x32_bf16 v[128:131], a[64:67], a[0:3], v[128:131]
    s_getpc_b64 s[86:87]
L_pc1:
    s_sub_u32 s86, s86, L_pc1-L_tail0
    s_subb_u32 s87, s87, 0
    s_lshr_b32 s82, s2, 3
    s_lshl_b32 s82, s82, 2
    s_add_u32 s82, s82, s60
    s_lshl_b32 s82, s82, 10
    v_add_u32 v34, s82, v16
    v_min_u32 v34, L_code_end-L_tail0-4, v34
    global_load_dword v7, v34, s[86:87]
    v_mfma_f32_16x16x32_bf16 v[144:147], a[64:67], a[4:7], v[144:147]
    v_mfma_f32_16x16x32_bf16 v[160:163], a[64:67], a[8:11], v[160:163]
    ds_read_b128 a[32:35], v9 offset:0
    v_mfma_f32_16x16x32_bf16 v[176:179], a[64:67], a[12:15], v[176:179]
    v_mfma_f32_16x16x32_bf16 v[192:195], a[64:67], a[16:19], v[192:195]
    s_mul_i32 s82, s65, 1835008
    s_lshl_b32 s83, s66, 8
    v_mfma_f32_16x16x32_bf16 v[208:211], a[64:67], a[20:23], v[208:211]
    s_add_u32 s82, s82, s83
    s_add_u32 s48, s20, s82
    v_mfma_f32_16x16x32_bf16 v[224:227], a[64:67], a[24:27], v[224:227]
    ds_read_b128 a[36:39], v9 offset:2048
    s_addc_u32 s49, s21, 0
    s_and_b32 s49, s49, 0xffff
    v_mfma_f32_16x16x32_bf16 v[240:243], a[64:67], a[28:31], v[240:243]
    ds_read_b64_tr_b16 a[64:65], v12 offset:20480
    s_sub_u32 s50, 7340032, s82
    s_mov_b32 s51, 0x20000
    v_mfma_f32_16x16x32_bf16 v[132:135], a[68:71], a[0:3], v[132:135]
    ds_read_b64_tr_b16 a[66:67], v12 offset:20736
    s_add_u32 s52, s12, s83
    s_addc_u32 s53, s13, 0
    v_mfma_f32_16x16x32_bf16 v[148:151], a[68:71], a[4:7], v[148:151]
    s_and_b32 s53, s53, 0xffff
    s_sub_u32 s54, 2097152, s83
    v_mfma_f32_16x16x32_bf16 v[164:167], a[68:71], a[8:11], v[164:167]
    ds_read_b128 a[40:43], v9 offset:4096
    s_mov_b32 s55, 0x20000
    s_lshl_b32 s3, s60, 11
    v_mfma_f32_16x16x32_bf16 v[180:183], a[68:71], a[12:15], v[180:183]
    v_lshrrev_b32 v34, 4, v0
    v_and_b32 v35, 15, v0
    v_mfma_f32_16x16x32_bf16 v[196:199], a[68:71], a[16:19], v[196:199]
    v_lshlrev_b32 v36, 1, v34
    v_add_u32 v36, 0, v36
    v_mfma_f32_16x16x32_bf16 v[212:215], a[68:71], a[20:23], v[212:215]
    v_xor_b32 v36, v36, v35
    v_lshlrev_b32 v36, 4, v36
    v_mfma_f32_16x16x32_bf16 v[228:231], a[68:71], a[24:27], v[228:231]
    ds_read_b128 a[44:47], v9 offset:6144
    v_lshl_add_u32 v36, v34, 11, v36
    s_lshl_b32 s82, s60, 14
    v_mfma_f32_16x16x32_bf16 v[244:247], a[68:71], a[28:31], v[244:247]
    ds_read_b64_tr_b16 a[68:69], v14 offset:20480
    s_add_u32 s82, s82, 0
    v_add_u32 v17, s82, v36
    v_mfma_f32_16x16x32_bf16 v[136:139], a[72:75], a[0:3], v[136:139]
    ds_read_b64_tr_b16 a[70:71], v14 offset:20736
    s_lshl_b32 s82, s62, 1
    s_add_u32 s82, s82, 0
    v_mfma_f32_16x16x32_bf16 v[152:155], a[72:75], a[4:7], v[152:155]
    s_lshl_b32 s82, s82, 3
    s_lshl_b32 s83, s61, 2
    v_mfma_f32_16x16x32_bf16 v[168:171], a[72:75], a[8:11], v[168:171]
    ds_read_b128 a[48:51], v9 offset:8192
    s_add_u32 s82, s82, s83
    s_mul_i32 s83, s62, 96
    v_mfma_f32_16x16x32_bf16 v[184:187], a[72:75], a[12:15], v[184:187]
    s_add_u32 s82, s82, s83
    s_lshl_b32 s82, s82, 11
    v_mfma_f32_16x16x32_bf16 v[200:203], a[72:75], a[16:19], v[200:203]
    s_sub_u32 s82, s82, 0
    v_add_u32 v19, s82, v36
    v_mfma_f32_16x16x32_bf16 v[216:219], a[72:75], a[20:23], v[216:219]
    v_lshlrev_b32 v36, 1, v34
    v_add_u32 v36, 8, v36
    v_mfma_f32_16x16x32_bf16 v[232:235], a[72:75], a[24:27], v[232:235]
    ds_read_b128 a[52:55], v9 offset:10240
    v_xor_b32 v36, v36, v35
    v_lshlrev_b32 v36, 4, v36
    v_mfma_f32_16x16x32_bf16 v[248:251], a[72:75], a[28:31], v[248:251]
    ds_read_b64_tr_b16 a[72:73], v12 offset:21504
    v_lshl_add_u32 v36, v34, 11, v36
    s_lshl_b32 s82, s60, 14
    v_mfma_f32_16x16x32_bf16 v[140:143], a[76:79], a[0:3], v[140:143]
    ds_read_b64_tr_b16 a[74:75], v12 offset:21760
    s_add_u32 s82, s82, 7168
    v_add_u32 v18, s82, v36
    v_mfma_f32_16x16x32_bf16 v[156:159], a[76:79], a[4:7], v[156:159]
    s_lshl_b32 s82, s62, 1
    s_add_u32 s82, s82, 1
    v_mfma_f32_16x16x32_bf16 v[172:175], a[76:79], a[8:11], v[172:175]
    ds_read_b128 a[56:59], v9 offset:12288
    s_lshl_b32 s82, s82, 3
    s_lshl_b32 s83, s61, 2
    v_mfma_f32_16x16x32_bf16 v[188:191], a[76:79], a[12:15], v[188:191]
    s_add_u32 s82, s82, s83
    s_mul_i32 s83, s62, 96
    v_mfma_f32_16x16x32_bf16 v[204:207], a[76:79], a[16:19], v[204:207]
    s_add_u32 s82, s82, s83
    s_lshl_b32 s82, s82, 11
    v_mfma_f32_16x16x32_bf16 v[220:223], a[76:79], a[20:23], v[220:223]
    s_sub_u32 s82, s82, 1024
    v_add_u32 v20, s82, v36
    v_mfma_f32_16x16x32_bf16 v[236:239], a[76:79], a[24:27], v[236:239]
    ds_read_b128 a[60:63], v9 offset:14336
    v_mfma_f32_16x16x32_bf16 v[252:255], a[76:79], a[28:31], v[252:255]
    ds_read_b64_tr_b16 a[76:77], v14 offset:21504
    v_mfma_f32_16x16x32_bf16 a[128:131], a[80:83], a[0:3], a[128:131]
    ds_read_b64_tr_b16 a[78:79], v14 offset:21760
    v_mfma_f32_16x16x32_bf16 a[144:147], a[80:83], a[4:7], a[144:147]
    v_mfma_f32_16x16x32_bf16 a[160:163], a[80:83], a[8:11], a[160:163]
    ds_read_b64_tr_b16 a[104:105], v12 offset:24576
    v_mfma_f32_16x16x32_bf16 a[176:179], a[80:83], a[12:15], a[176:179]
    v_mfma_f32_16x16x32_bf16 a[192:195], a[80:83], a[16:19], a[192:195]
    v_mfma_f32_16x16x32_bf16 a[208:211], a[80:83], a[20:23], a[208:211]
    v_mfma_f32_16x16x32_bf16 a[224:227], a[80:83], a[24:27], a[224:227]
    ds_read_b64_tr_b16 a[106:107], v12 offset:24832
    v_mfma_f32_16x16x32_bf16 a[240:243], a[80:83], a[28:31], a[240:243]
    ds_read_b64_tr_b16 a[80:81], v12 offset:22528
    v_mfma_f32_16x16x32_bf16 a[132:135], a[84:87], a[0:3], a[132:135]
    ds_read_b64_tr_b16 a[82:83], v12 offset:22784
    v_mfma_f32_16x16x32_bf16 a[148:151], a[84:87], a[4:7], a[148:151]
    v_mfma_f32_16x16x32_bf16 a[164:167], a[84:87], a[8:11], a[164:167]
    ds_read_b64_tr_b16 a[108:109], v14 offset:24576
    v_mfma_f32_16x16x32_bf16 a[180:183], a[84:87], a[12:15], a[180:183]
    v_mfma_f32_16x16x32_bf16 a[196:199], a[84:87], a[16:19], a[196:199]
    s_mov_b32 s81, 294912
    s_add_u32 m0, s3, 73728
    v_mfma_f32_16x16x32_bf16 a[212:215], a[84:87], a[20:23], a[212:215]
    buffer_load_dwordx4 v17, s[48:51], s81 offen lds
    v_mfma_f32_16x16x32_bf16 a[228:231], a[84:87], a[24:27], a[228:231]
    ds_read_b64_tr_b16 a[110:111], v14 offset:24832
    v_mfma_f32_16x16x32_bf16 a[244:247], a[84:87], a[28:31], a[244:247]
    ds_read_b64_tr_b16 a[84:85], v14 offset:22528
    v_mfma_f32_16x16x32_bf16 a[136:139], a[88:91], a[0:3], a[136:139]
    ds_read_b64_tr_b16 a[86:87], v14 offset:22784
    v_mfma_f32_16x16x32_bf16 a[152:155], a[88:91], a[4:7], a[152:155]
    v_mfma_f32_16x16x32_bf16 a[168:171], a[88:91], a[8:11], a[168:171]
    buffer_load_dwordx4 v18, s[48:51], s81 offen offset:1024 lds
    v_mfma_f32_16x16x32_bf16 a[184:187], a[88:91], a[12:15], a[184:187]
    v_mfma_f32_16x16x32_bf16 a[200:203], a[88:91], a[16:19], a[200:203]
    v_mfma_f32_16x16x32_bf16 a[216:219], a[88:91], a[20:23], a[216:219]
    v_mfma_f32_16x16x32_bf16 a[232:235], a[88:91], a[24:27], a[232:235]
    s_mov_b32 s80, 524288
    s_add_u32 m0, s3, 81920
    v_mfma_f32_16x16x32_bf16 a[248:251], a[88:91], a[28:31], a[248:251]
    ds_read_b64_tr_b16 a[88:89], v12 offset:23552
    buffer_load_dwordx4 v17, s[48:51], s80 offen lds
    v_mfma_f32_16x16x32_bf16 a[140:143], a[92:95], a[0:3], a[140:143]
    ds_read_b64_tr_b16 a[90:91], v12 offset:23808
    v_mfma_f32_16x16x32_bf16 a[156:159], a[92:95], a[4:7], a[156:159]
    v_mfma_f32_16x16x32_bf16 a[172:175], a[92:95], a[8:11], a[172:175]
    v_mfma_f32_16x16x32_bf16 a[188:191], a[92:95], a[12:15], a[188:191]
    v_mfma_f32_16x16x32_bf16 a[204:207], a[92:95], a[16:19], a[204:207]
    buffer_load_dwordx4 v18, s[48:51], s80 offen offset:1024 lds
    v_mfma_f32_16x16x32_bf16 a[220:223], a[92:95], a[20:23], a[220:223]
    v_mfma_f32_16x16x32_bf16 a[236:239], a[92:95], a[24:27], a[236:239]
    v_mfma_f32_16x16x32_bf16 a[252:255], a[92:95], a[28:31], a[252:255]
    ds_read_b64_tr_b16 a[92:93], v14 offset:23552
    v_mfma_f32_16x16x32_bf16 v[48:51], a[96:99], a[0:3], v[48:51]
    ds_read_b64_tr_b16 a[94:95], v14 offset:23808
    s_mov_b32 s81, 819200
    s_add_u32 m0, s3, 155648
    v_mfma_f32_16x16x32_bf16 v[52:55], a[96:99], a[4:7], v[52:55]
    buffer_load_dwordx4 v17, s[48:51], s81 offen lds
    v_mfma_f32_16x16x32_bf16 v[64:67], a[96:99], a[8:11], v[64:67]
    v_mfma_f32_16x16x32_bf16 v[68:71], a[96:99], a[12:15], v[68:71]
    v_mfma_f32_16x16x32_bf16 v[80:83], a[96:99], a[16:19], v[80:83]
    v_mfma_f32_16x16x32_bf16 v[84:87], a[96:99], a[20:23], v[84:87]
    v_mfma_f32_16x16x32_bf16 v[96:99], a[96:99], a[24:27], v[96:99]
    buffer_load_dwordx4 v18, s[48:51], s81 offen offset:1024 lds
    v_mfma_f32_16x16x32_bf16 v[100:103], a[96:99], a[28:31], v[100:103]
    v_mfma_f32_16x16x32_bf16 v[56:59], a[100:103], a[0:3], v[56:59]
    v_mfma_f32_16x16x32_bf16 v[60:63], a[100:103], a[4:7], v[60:63]
    v_mfma_f32_16x16x32_bf16 v[72:75], a[100:103], a[8:11], v[72:75]
    v_mfma_f32_16x16x32_bf16 v[76:79], a[100:103], a[12:15], v[76:79]
    v_mfma_f32_16x16x32_bf16 v[88:91], a[100:103], a[16:19], v[88:91]
    v_mfma_f32_16x16x32_bf16 v[92:95], a[100:103], a[20:23], v[92:95]
    v_mfma_f32_16x16x32_bf16 v[104:107], a[100:103], a[24:27], v[104:107]
    v_mfma_f32_16x16x32_bf16 v[108:111], a[100:103], a[28:31], v[108:111]
    s_waitcnt vmcnt(17) lgkmcnt(0)
    s_barrier
    v_mfma_f32_16x16x32_bf16 v[128:131], a[64:67], a[32:35], v[128:131]
    v_mfma_f32_16x16x32_bf16 v[144:147], a[64:67], a[36:39], v[144:147]
    v_mfma_f32_16x16x32_bf16 v[160:163], a[64:67], a[40:43], v[160:163]
    ds_read_b128 a[0:3], v8 offset:34816
    s_mov_b32 s80, 0
    s_add_u32 m0, s3, 0
    v_mfma_f32_16x16x32_bf16 v[176:179], a[64:67], a[44:47], v[176:179]
    buffer_load_dwordx4 v17, s[48:51], s80 offen lds
    v_mfma_f32_16x16x32_bf16 v[192:195], a[64:67], a[48:51], v[192:195]
    s_xor_b32 s82, s65, 0
    v_mfma_f32_16x16x32_bf16 v[208:211], a[64:67], a[52:55], v[208:211]
    s_lshl_b32 s82, s82, 10
    v_mfma_f32_16x16x32_bf16 v[224:227], a[64:67], a[56:59], v[224:227]
    ds_read_b128 a[4:7], v8 offset:36864
    v_add_u32 v21, s82, v16
    v_mfma_f32_16x16x32_bf16 v[240:243], a[64:67], a[60:63], v[240:243]
    ds_read_b64_tr_b16 a[64:65], v13 offset:0
    s_xor_b32 s82, s65, 1
    v_mfma_f32_16x16x32_bf16 v[132:135], a[68:71], a[32:35], v[132:135]
    ds_read_b64_tr_b16 a[66:67], v13 offset:256
    s_lshl_b32 s82, s82, 10
    v_mfma_f32_16x16x32_bf16 v[148:151], a[68:71], a[36:39], v[148:151]
    v_add_u32 v22, s82, v16
    buffer_load_dwordx4 v18, s[48:51], s80 offen offset:1024 lds
    v_mfma_f32_16x16x32_bf16 v[164:167], a[68:71], a[40:43], v[164:167]
    ds_read_b128 a[8:11], v8 offset:38912
    s_xor_b32 s82, s65, 2
    v_mfma_f32_16x16x32_bf16 v[180:183], a[68:71], a[44:47], v[180:183]
    s_lshl_b32 s82, s82, 10
    v_mfma_f32_16x16x32_bf16 v[196:199], a[68:71], a[48:51], v[196:199]
    v_add_u32 v23, s82, v16
    v_mfma_f32_16x16x32_bf16 v[212:215], a[68:71], a[52:55], v[212:215]
    s_xor_b32 s82, s65, 3
    v_mfma_f32_16x16x32_bf16 v[228:231], a[68:71], a[56:59], v[228:231]
    ds_read_b128 a[12:15], v8 offset:40960
    s_lshl_b32 s82, s82, 10
    s_mov_b32 s81, 229376
    s_add_u32 m0, s3, 8192
    v_mfma_f32_16x16x32_bf16 v[244:247], a[68:71], a[60:63], v[244:247]
    ds_read_b64_tr_b16 a[68:69], v15 offset:0
    v_add_u32 v24, s82, v16
    buffer_load_dwordx4 v17, s[48:51], s81 offen lds
    v_mfma_f32_16x16x32_bf16 v[136:139], a[72:75], a[32:35], v[136:139]
    ds_read_b64_tr_b16 a[70:71], v15 offset:256
    s_mov_b32 s94, 0xbdd2d3e8
    v_mfma_f32_16x16x32_bf16 v[152:155], a[72:75], a[36:39], v[152:155]
    s_mov_b32 s95, 0xbdd2d3e8
    v_mfma_f32_16x16x32_bf16 v[168:171], a[72:75], a[40:43], v[168:171]
    ds_read_b128 a[16:19], v8 offset:43008
    v_mov_b32 v26, 0xc0135761
    v_mfma_f32_16x16x32_bf16 v[184:187], a[72:75], a[44:47], v[184:187]
    v_mov_b32 v27, 0xc0135761
    v_mfma_f32_16x16x32_bf16 v[200:203], a[72:75], a[48:51], v[200:203]
    v_mov_b32 v25, 1
    v_mfma_f32_16x16x32_bf16 v[216:219], a[72:75], a[52:55], v[216:219]
    s_lshl_b32 s82, s60, 12
    buffer_load_dwordx4 v18, s[48:51], s81 offen offset:1024 lds
    v_mfma_f32_16x16x32_bf16 v[232:235], a[72:75], a[56:59], v[232:235]
    ds_read_b128 a[20:23], v8 offset:45056
    s_add_u32 s68, s88, s82
    v_mfma_f32_16x16x32_bf16 v[248:251], a[72:75], a[60:63], v[248:251]
    ds_read_b64_tr_b16 a[72:73], v13 offset:1024
    s_lshl_b32 s82, s61, 13
    v_mfma_f32_16x16x32_bf16 v[140:143], a[76:79], a[32:35], v[140:143]
    ds_read_b64_tr_b16 a[74:75], v13 offset:1280
    s_add_u32 s88, s88, s82
    v_mfma_f32_16x16x32_bf16 v[156:159], a[76:79], a[36:39], v[156:159]
    s_lshr_b32 s82, s66, 1
    v_mfma_f32_16x16x32_bf16 v[172:175], a[76:79], a[40:43], v[172:175]
    ds_read_b128 a[24:27], v8 offset:47104
    s_add_u32 s82, s82, 24
    s_mov_b32 s80, 458752
    s_add_u32 m0, s3, 16384
    v_mfma_f32_16x16x32_bf16 v[188:191], a[76:79], a[44:47], v[188:191]
    s_lshl_b32 s82, s82, 14
    buffer_load_dwordx4 v17, s[48:51], s80 offen lds
    v_mfma_f32_16x16x32_bf16 v[204:207], a[76:79], a[48:51], v[204:207]
    s_add_u32 s90, s88, s82
    v_mfma_f32_16x16x32_bf16 v[220:223], a[76:79], a[52:55], v[220:223]
    s_lshl_b32 s82, s66, 14
    v_mfma_f32_16x16x32_bf16 v[236:239], a[76:79], a[56:59], v[236:239]
    ds_read_b128 a[28:31], v8 offset:49152
    s_add_u32 s88, s88, s82
    v_mfma_f32_16x16x32_bf16 v[252:255], a[76:79], a[60:63], v[252:255]
    ds_read_b64_tr_b16 a[76:77], v15 offset:1024
    s_branch L_over3
L_stub3:
    s_branch L_stub7
L_over3:
    s_add_u32 s89, s88, 262144
    v_mfma_f32_16x16x32_bf16 a[128:131], a[80:83], a[32:35], a[128:131]
    ds_read_b64_tr_b16 a[78:79], v15 offset:1280
    s_add_u32 s88, s88, 131072
    v_mfma_f32_16x16x32_bf16 a[144:147], a[80:83], a[36:39], a[144:147]
    s_mov_b32 s76, s93
    buffer_load_dwordx4 v18, s[48:51], s80 offen offset:1024 lds
    v_mfma_f32_16x16x32_bf16 a[160:163], a[80:83], a[40:43], a[160:163]
    ds_read_b64_tr_b16 a[96:97], v13 offset:4096
    s_lshl_b32 s82, s63, 4
    v_mfma_f32_16x16x32_bf16 a[176:179], a[80:83], a[44:47], a[176:179]
    s_lshl_b32 s83, s60, 2
    v_mfma_f32_16x16x32_bf16 a[192:195], a[80:83], a[48:51], a[192:195]
    s_add_u32 s83, s83, s82
    v_mfma_f32_16x16x32_bf16 a[208:211], a[80:83], a[52:55], a[208:211]
    s_add_u32 s83, s83, s65
    v_mfma_f32_16x16x32_bf16 a[224:227], a[80:83], a[56:59], a[224:227]
    ds_read_b64_tr_b16 a[98:99], v13 offset:4352
    s_lshl_b32 s83, s83, 15
    s_mov_b32 s81, 688128
    s_add_u32 m0, s3, 24576
    v_mfma_f32_16x16x32_bf16 a[240:243], a[80:83], a[60:63], a[240:243]
    ds_read_b64_tr_b16 a[80:81], v13 offset:2048
    s_add_u32 s69, s83, 4194304
    buffer_load_dwordx4 v17, s[48:51], s81 offen lds
    v_mfma_f32_16x16x32_bf16 a[132:135], a[84:87], a[32:35], a[132:135]
    ds_read_b64_tr_b16 a[82:83], v13 offset:2304
    s_lshl_b32 s84, s63, 3
    v_mfma_f32_16x16x32_bf16 a[148:151], a[84:87], a[36:39], a[148:151]
    s_add_u32 s84, s84, s66
    v_mfma_f32_16x16x32_bf16 a[164:167], a[84:87], a[40:43], a[164:167]
    ds_read_b64_tr_b16 a[100:101], v15 offset:4096
    s_lshl_b32 s85, s84, 2
    v_mfma_f32_16x16x32_bf16 a[180:183], a[84:87], a[44:47], a[180:183]
    v_mfma_f32_16x16x32_bf16 a[196:199], a[84:87], a[48:51], a[196:199]
    v_mfma_f32_16x16x32_bf16 a[212:215], a[84:87], a[52:55], a[212:215]
    buffer_load_dwordx4 v18, s[48:51], s81 offen offset:1024 lds
    v_mfma_f32_16x16x32_bf16 a[228:231], a[84:87], a[56:59], a[228:231]
    ds_read_b64_tr_b16 a[102:103], v15 offset:4352
    v_mfma_f32_16x16x32_bf16 a[244:247], a[84:87], a[60:63], a[244:247]
    ds_read_b64_tr_b16 a[84:85], v15 offset:2048
    v_mfma_f32_16x16x32_bf16 a[136:139], a[88:91], a[32:35], a[136:139]
    ds_read_b64_tr_b16 a[86:87], v15 offset:2304
    v_mfma_f32_16x16x32_bf16 a[152:155], a[88:91], a[36:39], a[152:155]
    v_mfma_f32_16x16x32_bf16 a[168:171], a[88:91], a[40:43], a[168:171]
    s_mov_b32 s81, 753664
    s_add_u32 m0, s3, 90112
    v_mfma_f32_16x16x32_bf16 a[184:187], a[88:91], a[44:47], a[184:187]
    buffer_load_dwordx4 v17, s[48:51], s81 offen lds
    v_mfma_f32_16x16x32_bf16 a[200:203], a[88:91], a[48:51], a[200:203]
    v_mfma_f32_16x16x32_bf16 a[216:219], a[88:91], a[52:55], a[216:219]
    v_mfma_f32_16x16x32_bf16 a[232:235], a[88:91], a[56:59], a[232:235]
    v_mfma_f32_16x16x32_bf16 a[248:251], a[88:91], a[60:63], a[248:251]
    ds_read_b64_tr_b16 a[88:89], v13 offset:3072
    v_mfma_f32_16x16x32_bf16 a[140:143], a[92:95], a[32:35], a[140:143]
    ds_read_b64_tr_b16 a[90:91], v13 offset:3328
    v_mfma_f32_16x16x32_bf16 a[156:159], a[92:95], a[36:39], a[156:159]
    buffer_load_dwordx4 v18, s[48:51], s81 offen offset:1024 lds
    v_mfma_f32_16x16x32_bf16 a[172:175], a[92:95], a[40:43], a[172:175]
    v_mfma_f32_16x16x32_bf16 a[188:191], a[92:95], a[44:47], a[188:191]
    v_mfma_f32_16x16x32_bf16 a[204:207], a[92:95], a[48:51], a[204:207]
    v_mfma_f32_16x16x32_bf16 a[220:223], a[92:95], a[52:55], a[220:223]
    v_mfma_f32_16x16x32_bf16 a[236:239], a[92:95], a[56:59], a[236:239]
    s_mov_b32 s80, 983040
    s_add_u32 m0, s3, 98304
    v_mfma_f32_16x16x32_bf16 a[252:255], a[92:95], a[60:63], a[252:255]
    ds_read_b64_tr_b16 a[92:93], v15 offset:3072
    buffer_load_dwordx4 v17, s[48:51], s80 offen lds
    v_mfma_f32_16x16x32_bf16 v[48:51], a[104:107], a[32:35], v[48:51]
    ds_read_b64_tr_b16 a[94:95], v15 offset:3328
    v_mfma_f32_16x16x32_bf16 v[52:55], a[104:107], a[36:39], v[52:55]
    v_mfma_f32_16x16x32_bf16 v[64:67], a[104:107], a[40:43], v[64:67]
    v_mfma_f32_16x16x32_bf16 v[68:71], a[104:107], a[44:47], v[68:71]
    v_mfma_f32_16x16x32_bf16 v[80:83], a[104:107], a[48:51], v[80:83]
    v_mfma_f32_16x16x32_bf16 v[84:87], a[104:107], a[52:55], v[84:87]
    buffer_load_dwordx4 v18, s[48:51], s80 offen offset:1024 lds
    v_mfma_f32_16x16x32_bf16 v[96:99], a[104:107], a[56:59], v[96:99]
    v_mfma_f32_16x16x32_bf16 v[100:103], a[104:107], a[60:63], v[100:103]
    v_mfma_f32_16x16x32_bf16 v[56:59], a[108:111], a[32:35], v[56:59]
    v_mfma_f32_16x16x32_bf16 v[60:63], a[108:111], a[36:39], v[60:63]
    v_mfma_f32_16x16x32_bf16 v[72:75], a[108:111], a[40:43], v[72:75]
    v_mfma_f32_16x16x32_bf16 v[76:79], a[108:111], a[44:47], v[76:79]
    v_mfma_f32_16x16x32_bf16 v[88:91], a[108:111], a[48:51], v[88:91]
    v_mfma_f32_16x16x32_bf16 v[92:95], a[108:111], a[52:55], v[92:95]
    v_mfma_f32_16x16x32_bf16 v[104:107], a[108:111], a[56:59], v[104:107]
    v_mfma_f32_16x16x32_bf16 v[108:111], a[108:111], a[60:63], v[108:111]
    s_waitcnt vmcnt(19) lgkmcnt(0)
    s_barrier
    v_mfma_f32_16x16x32_bf16 v[128:131], a[64:67], a[0:3], v[128:131]
    v_mfma_f32_16x16x32_bf16 v[144:147], a[64:67], a[4:7], v[144:147]
    v_mfma_f32_16x16x32_bf16 v[160:163], a[64:67], a[8:11], v[160:163]
    ds_read_b128 a[32:35], v9 offset:34816
    s_mov_b32 s81, 1212416
    s_add_u32 m0, s3, 106496
    v_mfma_f32_16x16x32_bf16 v[176:179], a[64:67], a[12:15], v[176:179]
    buffer_load_dwordx4 v17, s[48:51], s81 offen lds
    v_mfma_f32_16x16x32_bf16 v[192:195], a[64:67], a[16:19], v[192:195]
    s_add_u32 s85, s85, s60
    v_mfma_f32_16x16x32_bf16 v[208:211], a[64:67], a[20:23], v[208:211]
    s_lshl_b32 s85, s85, 8
    v_mfma_f32_16x16x32_bf16 v[224:227], a[64:67], a[24:27], v[224:227]
    ds_read_b128 a[36:39], v9 offset:36864
    s_add_u32 s77, s85, 39862272
    v_mfma_f32_16x16x32_bf16 v[240:243], a[64:67], a[28:31], v[240:243]
    ds_read_b64_tr_b16 a[64:65], v13 offset:20480
    s_lshl_b32 s84, s84, 18
    v_mfma_f32_16x16x32_bf16 v[132:135], a[68:71], a[0:3], v[132:135]
    ds_read_b64_tr_b16 a[66:67], v13 offset:20736
    s_lshl_b32 s85, s60, 12
    v_mfma_f32_16x16x32_bf16 v[148:151], a[68:71], a[4:7], v[148:151]
    s_add_u32 s84, s84, s85
    v_mfma_f32_16x16x32_bf16 v[164:167], a[68:71], a[8:11], v[164:167]
    ds_read_b128 a[40:43], v9 offset:38912
    s_add_u32 s84, s84, 23068672
    v_mfma_f32_16x16x32_bf16 v[180:183], a[68:71], a[12:15], v[180:183]
    s_xor_b32 s85, s65, 1
    v_mfma_f32_16x16x32_bf16 v[196:199], a[68:71], a[16:19], v[196:199]
    s_lshl_b32 s85, s85, 16
    v_mfma_f32_16x16x32_bf16 v[212:215], a[68:71], a[20:23], v[212:215]
    s_add_u32 s70, s84, s85
    v_mfma_f32_16x16x32_bf16 v[228:231], a[68:71], a[24:27], v[228:231]
    ds_read_b128 a[44:47], v9 offset:40960
    s_add_u32 s70, s70, 16384
    v_mfma_f32_16x16x32_bf16 v[244:247], a[68:71], a[28:31], v[244:247]
    ds_read_b64_tr_b16 a[68:69], v15 offset:20480
    s_lshl_b32 s85, s65, 16
    buffer_load_dwordx4 v18, s[48:51], s81 offen offset:1024 lds
    v_mfma_f32_16x16x32_bf16 v[136:139], a[72:75], a[0:3], v[136:139]
    ds_read_b64_tr_b16 a[70:71], v15 offset:20736
    s_add_u32 s73, s84, s85
    v_mfma_f32_16x16x32_bf16 v[152:155], a[72:75], a[4:7], v[152:155]
    s_add_u32 s73, s73, 16384
    v_mfma_f32_16x16x32_bf16 v[168:171], a[72:75], a[8:11], v[168:171]
    ds_read_b128 a[48:51], v9 offset:43008
    s_xor_b32 s85, s65, 2
    v_mfma_f32_16x16x32_bf16 v[184:187], a[72:75], a[12:15], v[184:187]
    s_lshl_b32 s85, s85, 16
    v_mfma_f32_16x16x32_bf16 v[200:203], a[72:75], a[16:19], v[200:203]
    s_add_u32 s71, s84, s85
    v_mfma_f32_16x16x32_bf16 v[216:219], a[72:75], a[20:23], v[216:219]
    s_add_u32 s71, s71, 32768
    v_mfma_f32_16x16x32_bf16 v[232:235], a[72:75], a[24:27], v[232:235]
    ds_read_b128 a[52:55], v9 offset:45056
    s_lshl_b32 s85, s65, 16
    v_mfma_f32_16x16x32_bf16 v[248:251], a[72:75], a[28:31], v[248:251]
    ds_read_b64_tr_b16 a[72:73], v13 offset:21504
    s_add_u32 s74, s84, s85
    v_mfma_f32_16x16x32_bf16 v[140:143], a[76:79], a[0:3], v[140:143]
    ds_read_b64_tr_b16 a[74:75], v13 offset:21760
    s_add_u32 s74, s74, 32768
    v_mfma_f32_16x16x32_bf16 v[156:159], a[76:79], a[4:7], v[156:159]
    s_xor_b32 s85, s65, 3
    v_mfma_f32_16x16x32_bf16 v[172:175], a[76:79], a[8:11], v[172:175]
    ds_read_b128 a[56:59], v9 offset:47104
    s_lshl_b32 s85, s85, 16
    s_mov_b32 s80, 1441792
    s_add_u32 m0, s3, 114688
    v_mfma_f32_16x16x32_bf16 v[188:191], a[76:79], a[12:15], v[188:191]
    s_add_u32 s72, s84, s85
    buffer_load_dwordx4 v17, s[48:51], s80 offen lds
    v_mfma_f32_16x16x32_bf16 v[204:207], a[76:79], a[16:19], v[204:207]
    s_add_u32 s72, s72, 49152
    v_mfma_f32_16x16x32_bf16 v[220:223], a[76:79], a[20:23], v[220:223]
    s_lshl_b32 s85, s65, 16
    v_mfma_f32_16x16x32_bf16 v[236:239], a[76:79], a[24:27], v[236:239]
    ds_read_b128 a[60:63], v9 offset:49152
    s_add_u32 s75, s84, s85
    v_mfma_f32_16x16x32_bf16 v[252:255], a[76:79], a[28:31], v[252:255]
    ds_read_b64_tr_b16 a[76:77], v15 offset:21504
    s_add_u32 s75, s75, 49152
    v_mfma_f32_16x16x32_bf16 a[128:131], a[80:83], a[0:3], a[128:131]
    ds_read_b64_tr_b16 a[78:79], v15 offset:21760
    v_and_b32 v36, 1, v34
    v_mfma_f32_16x16x32_bf16 a[144:147], a[80:83], a[4:7], a[144:147]
    v_lshlrev_b32 v36, 10, v36
    v_mfma_f32_16x16x32_bf16 a[160:163], a[80:83], a[8:11], a[160:163]
    ds_read_b64_tr_b16 a[104:105], v13 offset:24576
    v_lshrrev_b32 v34, 1, v34
    v_mfma_f32_16x16x32_bf16 a[176:179], a[80:83], a[12:15], a[176:179]
    v_lshl_add_u32 v36, v34, 8, v36
    v_mfma_f32_16x16x32_bf16 a[192:195], a[80:83], a[16:19], a[192:195]
    v_lshl_add_u32 v36, v35, 4, v36
    v_mfma_f32_16x16x32_bf16 a[208:211], a[80:83], a[20:23], a[208:211]
    s_and_b32 s82, s66, 1
    v_mfma_f32_16x16x32_bf16 a[224:227], a[80:83], a[24:27], a[224:227]
    ds_read_b64_tr_b16 a[106:107], v13 offset:24832
    s_lshl_b32 s82, s82, 9
    v_mfma_f32_16x16x32_bf16 a[240:243], a[80:83], a[28:31], a[240:243]
    ds_read_b64_tr_b16 a[80:81], v13 offset:22528
    v_add_u32 v28, s82, v36
    buffer_load_dwordx4 v18, s[48:51], s80 offen offset:1024 lds
    v_mfma_f32_16x16x32_bf16 a[132:135], a[84:87], a[0:3], a[132:135]
    ds_read_b64_tr_b16 a[82:83], v13 offset:22784
    v_mov_b32 v29, 0x100
    v_mfma_f32_16x16x32_bf16 a[148:151], a[84:87], a[4:7], a[148:151]
    v_mov_b32 v42, 0x10000
    v_mfma_f32_16x16x32_bf16 a[164:167], a[84:87], a[8:11], a[164:167]
    ds_read_b64_tr_b16 a[108:109], v15 offset:24576
    s_mov_b32 s93, s92
    v_mfma_f32_16x16x32_bf16 a[180:183], a[84:87], a[12:15], a[180:183]
    v_mfma_f32_16x16x32_bf16 a[196:199], a[84:87], a[16:19], a[196:199]
    v_mfma_f32_16x16x32_bf16 a[212:215], a[84:87], a[20:23], a[212:215]
    v_mfma_f32_16x16x32_bf16 a[228:231], a[84:87], a[24:27], a[228:231]
    ds_read_b64_tr_b16 a[110:111], v15 offset:24832
    v_mfma_f32_16x16x32_bf16 a[244:247], a[84:87], a[28:31], a[244:247]
    ds_read_b64_tr_b16 a[84:85], v15 offset:22528
    v_mfma_f32_16x16x32_bf16 a[136:139], a[88:91], a[0:3], a[136:139]
    ds_read_b64_tr_b16 a[86:87], v15 offset:22784
    v_mfma_f32_16x16x32_bf16 a[152:155], a[88:91], a[4:7], a[152:155]
    v_mfma_f32_16x16x32_bf16 a[168:171], a[88:91], a[8:11], a[168:171]
    s_mov_b32 s81, 1671168
    s_add_u32 m0, s3, 122880
    v_mfma_f32_16x16x32_bf16 a[184:187], a[88:91], a[12:15], a[184:187]
    buffer_load_dwordx4 v17, s[48:51], s81 offen lds
    v_mfma_f32_16x16x32_bf16 a[200:203], a[88:91], a[16:19], a[200:203]
    v_mfma_f32_16x16x32_bf16 a[216:219], a[88:91], a[20:23], a[216:219]
    v_mfma_f32_16x16x32_bf16 a[232:235], a[88:91], a[24:27], a[232:235]
    v_mfma_f32_16x16x32_bf16 a[248:251], a[88:91], a[28:31], a[248:251]
    ds_read_b64_tr_b16 a[88:89], v13 offset:23552
    v_mfma_f32_16x16x32_bf16 a[140:143], a[92:95], a[0:3], a[140:143]
    ds_read_b64_tr_b16 a[90:91], v13 offset:23808
    v_mfma_f32_16x16x32_bf16 a[156:159], a[92:95], a[4:7], a[156:159]
    v_mfma_f32_16x16x32_bf16 a[172:175], a[92:95], a[8:11], a[172:175]
    v_mfma_f32_16x16x32_bf16 a[188:191], a[92:95], a[12:15], a[188:191]
    v_mfma_f32_16x16x32_bf16 a[204:207], a[92:95], a[16:19], a[204:207]
    v_mfma_f32_16x16x32_bf16 a[220:223], a[92:95], a[20:23], a[220:223]
    v_mfma_f32_16x16x32_bf16 a[236:239], a[92:95], a[24:27], a[236:239]
    v_mfma_f32_16x16x32_bf16 a[252:255], a[92:95], a[28:31], a[252:255]
    ds_read_b64_tr_b16 a[92:93], v15 offset:23552
    buffer_load_dwordx4 v18, s[48:51], s81 offen offset:1024 lds
    v_mfma_f32_16x16x32_bf16 v[48:51], a[96:99], a[0:3], v[48:51]
    ds_read_b64_tr_b16 a[94:95], v15 offset:23808
    v_mfma_f32_16x16x32_bf16 v[52:55], a[96:99], a[4:7], v[52:55]
    v_mfma_f32_16x16x32_bf16 v[64:67], a[96:99], a[8:11], v[64:67]
    v_mfma_f32_16x16x32_bf16 v[68:71], a[96:99], a[12:15], v[68:71]
    v_mfma_f32_16x16x32_bf16 v[80:83], a[96:99], a[16:19], v[80:83]
    v_mfma_f32_16x16x32_bf16 v[84:87], a[96:99], a[20:23], v[84:87]
    v_mfma_f32_16x16x32_bf16 v[96:99], a[96:99], a[24:27], v[96:99]
    v_mfma_f32_16x16x32_bf16 v[100:103], a[96:99], a[28:31], v[100:103]
    v_mfma_f32_16x16x32_bf16 v[56:59], a[100:103], a[0:3], v[56:59]
    v_mfma_f32_16x16x32_bf16 v[60:63], a[100:103], a[4:7], v[60:63]
    v_mfma_f32_16x16x32_bf16 v[72:75], a[100:103], a[8:11], v[72:75]
    v_mfma_f32_16x16x32_bf16 v[76:79], a[100:103], a[12:15], v[76:79]
    v_mfma_f32_16x16x32_bf16 v[88:91], a[100:103], a[16:19], v[88:91]
    v_mfma_f32_16x16x32_bf16 v[92:95], a[100:103], a[20:23], v[92:95]
    v_mfma_f32_16x16x32_bf16 v[104:107], a[100:103], a[24:27], v[104:107]
    v_mfma_f32_16x16x32_bf16 v[108:111], a[100:103], a[28:31], v[108:111]
    s_waitcnt lgkmcnt(0)
    s_barrier
    v_mfma_f32_16x16x32_bf16 v[128:131], a[64:67], a[32:35], v[128:131]
    v_mfma_f32_16x16x32_bf16 v[144:147], a[64:67], a[36:39], v[144:147]
    v_mfma_f32_16x16x32_bf16 v[160:163], a[64:67], a[40:43], v[160:163]
    s_mov_b32 s80, 917504
    s_add_u32 m0, s3, 32768
    v_mfma_f32_16x16x32_bf16 v[176:179], a[64:67], a[44:47], v[176:179]
    buffer_load_dwordx4 v17, s[48:51], s80 offen lds
    v_mfma_f32_16x16x32_bf16 v[192:195], a[64:67], a[48:51], v[192:195]
    v_lshrrev_b32 v3, 2, v0
    v_mfma_f32_16x16x32_bf16 v[208:211], a[64:67], a[52:55], v[208:211]
    v_and_b32 v4, 3, v0
    v_mfma_f32_16x16x32_bf16 v[224:227], a[64:67], a[56:59], v[224:227]
    v_lshlrev_b32 v4, 3, v4
    v_mfma_f32_16x16x32_bf16 v[240:243], a[64:67], a[60:63], v[240:243]
    buffer_load_dwordx4 v18, s[48:51], s80 offen offset:1024 lds
    v_lshl_add_u32 v4, v3, 8, v4
    v_mfma_f32_16x16x32_bf16 v[132:135], a[68:71], a[32:35], v[132:135]
    v_and_b32 v3, 7, v3
    v_mfma_f32_16x16x32_bf16 v[148:151], a[68:71], a[36:39], v[148:151]
    v_xor_b32 v5, 0, v3
    v_mfma_f32_16x16x32_bf16 v[164:167], a[68:71], a[40:43], v[164:167]
    v_lshl_add_u32 v8, v5, 5, v4
    v_mfma_f32_16x16x32_bf16 v[180:183], a[68:71], a[44:47], v[180:183]
    s_mov_b32 s81, 1146880
    s_add_u32 m0, s3, 40960
    v_xor_b32 v5, 1, v3
    v_mfma_f32_16x16x32_bf16 v[196:199], a[68:71], a[48:51], v[196:199]
    buffer_load_dwordx4 v17, s[48:51], s81 offen lds
    v_lshl_add_u32 v9, v5, 5, v4
    v_mfma_f32_16x16x32_bf16 v[212:215], a[68:71], a[52:55], v[212:215]
    v_xor_b32 v5, 2, v3
    v_mfma_f32_16x16x32_bf16 v[228:231], a[68:71], a[56:59], v[228:231]
    v_lshl_add_u32 v10, v5, 5, v4
    v_mfma_f32_16x16x32_bf16 v[244:247], a[68:71], a[60:63], v[244:247]
    v_xor_b32 v5, 3, v3
    v_mfma_f32_16x16x32_bf16 v[136:139], a[72:75], a[32:35], v[136:139]
    buffer_load_dwordx4 v18, s[48:51], s81 offen offset:1024 lds
    v_lshl_add_u32 v11, v5, 5, v4
    v_mfma_f32_16x16x32_bf16 v[152:155], a[72:75], a[36:39], v[152:155]
    v_xor_b32 v5, 4, v3
    v_mfma_f32_16x16x32_bf16 v[168:171], a[72:75], a[40:43], v[168:171]
    v_lshl_add_u32 v12, v5, 5, v4
    v_mfma_f32_16x16x32_bf16 v[184:187], a[72:75], a[44:47], v[184:187]
    v_xor_b32 v5, 5, v3
    v_mfma_f32_16x16x32_bf16 v[200:203], a[72:75], a[48:51], v[200:203]
    s_mov_b32 s80, 1376256
    s_add_u32 m0, s3, 49152
    v_lshl_add_u32 v13, v5, 5, v4
    v_mfma_f32_16x16x32_bf16 v[216:219], a[72:75], a[52:55], v[216:219]
    buffer_load_dwordx4 v17, s[48:51], s80 offen lds
    v_xor_b32 v5, 6, v3
    v_mfma_f32_16x16x32_bf16 v[232:235], a[72:75], a[56:59], v[232:235]
    v_lshl_add_u32 v14, v5, 5, v4
    v_mfma_f32_16x16x32_bf16 v[248:251], a[72:75], a[60:63], v[248:251]
    v_xor_b32 v5, 7, v3
    v_mfma_f32_16x16x32_bf16 v[140:143], a[76:79], a[32:35], v[140:143]
    v_lshl_add_u32 v15, v5, 5, v4
    v_mfma_f32_16x16x32_bf16 v[156:159], a[76:79], a[36:39], v[156:159]
    buffer_load_dwordx4 v18, s[48:51], s80 offen offset:1024 lds
    v_mfma_f32_16x16x32_bf16 v[172:175], a[76:79], a[40:43], v[172:175]
    v_mfma_f32_16x16x32_bf16 v[188:191], a[76:79], a[44:47], v[188:191]
    v_mfma_f32_16x16x32_bf16 v[204:207], a[76:79], a[48:51], v[204:207]
    v_mfma_f32_16x16x32_bf16 v[220:223], a[76:79], a[52:55], v[220:223]
    s_mov_b32 s81, 1605632
    s_add_u32 m0, s3, 57344
    v_mfma_f32_16x16x32_bf16 v[236:239], a[76:79], a[56:59], v[236:239]
    buffer_load_dwordx4 v17, s[48:51], s81 offen lds
    v_mfma_f32_16x16x32_bf16 v[252:255], a[76:79], a[60:63], v[252:255]
    v_mfma_f32_16x16x32_bf16 a[128:131], a[80:83], a[32:35], a[128:131]
    v_mfma_f32_16x16x32_bf16 a[144:147], a[80:83], a[36:39], a[144:147]
    v_mfma_f32_16x16x32_bf16 a[160:163], a[80:83], a[40:43], a[160:163]
    buffer_load_dwordx4 v18, s[48:51], s81 offen offset:1024 lds
    v_mfma_f32_16x16x32_bf16 a[176:179], a[80:83], a[44:47], a[176:179]
    v_mfma_f32_16x16x32_bf16 a[192:195], a[80:83], a[48:51], a[192:195]
    v_mfma_f32_16x16x32_bf16 a[208:211], a[80:83], a[52:55], a[208:211]
    v_mfma_f32_16x16x32_bf16 a[224:227], a[80:83], a[56:59], a[224:227]
    s_mov_b32 s80, 65536
    s_add_u32 m0, s3, 65536
    v_mfma_f32_16x16x32_bf16 a[240:243], a[80:83], a[60:63], a[240:243]
    buffer_load_dwordx4 v17, s[48:51], s80 offen lds
    v_mfma_f32_16x16x32_bf16 a[132:135], a[84:87], a[32:35], a[132:135]
    v_mfma_f32_16x16x32_bf16 a[148:151], a[84:87], a[36:39], a[148:151]
    v_mfma_f32_16x16x32_bf16 a[164:167], a[84:87], a[40:43], a[164:167]
    v_mfma_f32_16x16x32_bf16 a[180:183], a[84:87], a[44:47], a[180:183]
    buffer_load_dwordx4 v18, s[48:51], s80 offen offset:1024 lds
    v_mfma_f32_16x16x32_bf16 a[196:199], a[84:87], a[48:51], a[196:199]
    v_mfma_f32_16x16x32_bf16 a[212:215], a[84:87], a[52:55], a[212:215]
    v_mfma_f32_16x16x32_bf16 a[228:231], a[84:87], a[56:59], a[228:231]
    v_mfma_f32_16x16x32_bf16 a[244:247], a[84:87], a[60:63], a[244:247]
    s_mov_b32 s80, 131072
    s_add_u32 m0, s3, 131072
    v_mfma_f32_16x16x32_bf16 a[136:139], a[88:91], a[32:35], a[136:139]
    buffer_load_dwordx4 v17, s[48:51], s80 offen lds
    v_mfma_f32_16x16x32_bf16 a[152:155], a[88:91], a[36:39], a[152:155]
    v_mfma_f32_16x16x32_bf16 a[168:171], a[88:91], a[40:43], a[168:171]
    v_mfma_f32_16x16x32_bf16 a[184:187], a[88:91], a[44:47], a[184:187]
    v_mfma_f32_16x16x32_bf16 a[200:203], a[88:91], a[48:51], a[200:203]
    buffer_load_dwordx4 v18, s[48:51], s80 offen offset:1024 lds
    v_mfma_f32_16x16x32_bf16 a[216:219], a[88:91], a[52:55], a[216:219]
    v_mfma_f32_16x16x32_bf16 a[232:235], a[88:91], a[56:59], a[232:235]
    v_mfma_f32_16x16x32_bf16 a[248:251], a[88:91], a[60:63], a[248:251]
    v_mfma_f32_16x16x32_bf16 a[140:143], a[92:95], a[32:35], a[140:143]
    s_mov_b32 s81, 360448
    s_add_u32 m0, s3, 139264
    v_mfma_f32_16x16x32_bf16 a[156:159], a[92:95], a[36:39], a[156:159]
    buffer_load_dwordx4 v17, s[48:51], s81 offen lds
    v_mfma_f32_16x16x32_bf16 a[172:175], a[92:95], a[40:43], a[172:175]
    v_mfma_f32_16x16x32_bf16 a[188:191], a[92:95], a[44:47], a[188:191]
    v_mfma_f32_16x16x32_bf16 a[204:207], a[92:95], a[48:51], a[204:207]
    v_mfma_f32_16x16x32_bf16 a[220:223], a[92:95], a[52:55], a[220:223]
    buffer_load_dwordx4 v18, s[48:51], s81 offen offset:1024 lds
    v_mfma_f32_16x16x32_bf16 a[236:239], a[92:95], a[56:59], a[236:239]
    v_mfma_f32_16x16x32_bf16 a[252:255], a[92:95], a[60:63], a[252:255]
    v_mfma_f32_16x16x32_bf16 v[48:51], a[104:107], a[32:35], v[48:51]
    v_mfma_f32_16x16x32_bf16 v[52:55], a[104:107], a[36:39], v[52:55]
    s_mov_b32 s80, 589824
    s_add_u32 m0, s3, 147456
    v_mfma_f32_16x16x32_bf16 v[64:67], a[104:107], a[40:43], v[64:67]
    buffer_load_dwordx4 v17, s[48:51], s80 offen lds
    v_mfma_f32_16x16x32_bf16 v[68:71], a[104:107], a[44:47], v[68:71]
    v_mfma_f32_16x16x32_bf16 v[80:83], a[104:107], a[48:51], v[80:83]
    v_mfma_f32_16x16x32_bf16 v[84:87], a[104:107], a[52:55], v[84:87]
    v_mfma_f32_16x16x32_bf16 v[96:99], a[104:107], a[56:59], v[96:99]
    buffer_load_dwordx4 v18, s[48:51], s80 offen offset:1024 lds
    v_mfma_f32_16x16x32_bf16 v[100:103], a[104:107], a[60:63], v[100:103]
    v_mfma_f32_16x16x32_bf16 v[56:59], a[108:111], a[32:35], v[56:59]
    v_mfma_f32_16x16x32_bf16 v[60:63], a[108:111], a[36:39], v[60:63]
    v_mfma_f32_16x16x32_bf16 v[72:75], a[108:111], a[40:43], v[72:75]
    v_mfma_f32_16x16x32_bf16 v[76:79], a[108:111], a[44:47], v[76:79]
    v_mfma_f32_16x16x32_bf16 v[88:91], a[108:111], a[48:51], v[88:91]
    v_mfma_f32_16x16x32_bf16 v[92:95], a[108:111], a[52:55], v[92:95]
    v_mfma_f32_16x16x32_bf16 v[104:107], a[108:111], a[56:59], v[104:107]
    v_mfma_f32_16x16x32_bf16 v[108:111], a[108:111], a[60:63], v[108:111]
L_epi:
    v_pk_mul_f32 v[34:35], v[128:129], v[128:129]
    v_pk_mul_f32 v[36:37], v[130:131], v[130:131]
    v_pk_mul_f32 v[38:39], v[132:133], v[132:133]
    v_pk_mul_f32 v[40:41], v[134:135], v[134:135]
    v_pk_fma_f32 v[34:35], v[34:35], s[94:95], v[26:27]
    v_pk_fma_f32 v[36:37], v[36:37], s[94:95], v[26:27]
    v_pk_fma_f32 v[38:39], v[38:39], s[94:95], v[26:27]
    v_pk_fma_f32 v[40:41], v[40:41], s[94:95], v[26:27]
    v_pk_mul_f32 v[34:35], v[34:35], v[128:129]
    v_pk_mul_f32 v[36:37], v[36:37], v[130:131]
    v_pk_mul_f32 v[38:39], v[38:39], v[132:133]
    v_pk_mul_f32 v[40:41], v[40:41], v[134:135]
    v_exp_f32 v34, v34
    v_exp_f32 v35, v35
    v_exp_f32 v36, v36
    v_exp_f32 v37, v37
    v_exp_f32 v38, v38
    v_exp_f32 v39, v39
    v_exp_f32 v40, v40
    v_exp_f32 v41, v41
    v_pk_mul_f32 v[136:137], v[136:137], v[128:129]
    v_pk_mul_f32 v[138:139], v[138:139], v[130:131]
    v_pk_mul_f32 v[140:141], v[140:141], v[132:133]
    v_pk_mul_f32 v[142:143], v[142:143], v[134:135]
    v_pk_add_f32 v[34:35], v[34:35], 1.0 op_sel_hi:[1,0]
    v_pk_add_f32 v[36:37], v[36:37], 1.0 op_sel_hi:[1,0]
    v_pk_add_f32 v[38:39], v[38:39], 1.0 op_sel_hi:[1,0]
    v_pk_add_f32 v[40:41], v[40:41], 1.0 op_sel_hi:[1,0]
    v_rcp_f32 v34, v34
    v_rcp_f32 v35, v35
    v_rcp_f32 v36, v36
    v_rcp_f32 v37, v37
    v_rcp_f32 v38, v38
    v_rcp_f32 v39, v39
    v_rcp_f32 v40, v40
    v_rcp_f32 v41, v41
    v_pk_mul_f32 v[136:137], v[136:137], v[34:35]
    v_pk_mul_f32 v[138:139], v[138:139], v[36:37]
    v_pk_mul_f32 v[140:141], v[140:141], v[38:39]
    v_pk_mul_f32 v[142:143], v[142:143], v[40:41]
    v_cvt_pk_bf16_f32 v128, v136, v137
    v_cvt_pk_bf16_f32 v129, v138, v139
    v_cvt_pk_bf16_f32 v130, v140, v141
    v_cvt_pk_bf16_f32 v131, v142, v143
    buffer_store_dwordx4 v[128:131], v16, s[56:59], s88 offen offset:0 sc1
    v_pk_mul_f32 v[34:35], v[144:145], v[144:145]
    v_pk_mul_f32 v[36:37], v[146:147], v[146:147]
    v_pk_mul_f32 v[38:39], v[148:149], v[148:149]
    v_pk_mul_f32 v[40:41], v[150:151], v[150:151]
    v_pk_fma_f32 v[34:35], v[34:35], s[94:95], v[26:27]
    v_pk_fma_f32 v[36:37], v[36:37], s[94:95], v[26:27]
    v_pk_fma_f32 v[38:39], v[38:39], s[94:95], v[26:27]
    v_pk_fma_f32 v[40:41], v[40:41], s[94:95], v[26:27]
    v_pk_mul_f32 v[34:35], v[34:35], v[144:145]
    v_pk_mul_f32 v[36:37], v[36:37], v[146:147]
    v_pk_mul_f32 v[38:39], v[38:39], v[148:149]
    v_pk_mul_f32 v[40:41], v[40:41], v[150:151]
    v_exp_f32 v34, v34
    v_exp_f32 v35, v35
    v_exp_f32 v36, v36
    v_exp_f32 v37, v37
    v_exp_f32 v38, v38
    v_exp_f32 v39, v39
    v_exp_f32 v40, v40
    v_exp_f32 v41, v41
    v_pk_mul_f32 v[152:153], v[152:153], v[144:145]
    v_pk_mul_f32 v[154:155], v[154:155], v[146:147]
    v_pk_mul_f32 v[156:157], v[156:157], v[148:149]
    v_pk_mul_f32 v[158:159], v[158:159], v[150:151]
    v_pk_add_f32 v[34:35], v[34:35], 1.0 op_sel_hi:[1,0]
    v_pk_add_f32 v[36:37], v[36:37], 1.0 op_sel_hi:[1,0]
    v_pk_add_f32 v[38:39], v[38:39], 1.0 op_sel_hi:[1,0]
    v_pk_add_f32 v[40:41], v[40:41], 1.0 op_sel_hi:[1,0]
    v_rcp_f32 v34, v34
    v_rcp_f32 v35, v35
    v_rcp_f32 v36, v36
    v_rcp_f32 v37, v37
    v_rcp_f32 v38, v38
    v_rcp_f32 v39, v39
    v_rcp_f32 v40, v40
    v_rcp_f32 v41, v41
    v_pk_mul_f32 v[152:153], v[152:153], v[34:35]
    v_pk_mul_f32 v[154:155], v[154:155], v[36:37]
    v_pk_mul_f32 v[156:157], v[156:157], v[38:39]
    v_pk_mul_f32 v[158:159], v[158:159], v[40:41]
    v_cvt_pk_bf16_f32 v144, v152, v153
    v_cvt_pk_bf16_f32 v145, v154, v155
    v_cvt_pk_bf16_f32 v146, v156, v157
    v_cvt_pk_bf16_f32 v147, v158, v159
    buffer_store_dwordx4 v[144:147], v16, s[56:59], s88 offen offset:1024 sc1
    v_pk_mul_f32 v[34:35], v[160:161], v[160:161]
    v_pk_mul_f32 v[36:37], v[162:163], v[162:163]
    v_pk_mul_f32 v[38:39], v[164:165], v[164:165]
    v_pk_mul_f32 v[40:41], v[166:167], v[166:167]
    v_pk_fma_f32 v[34:35], v[34:35], s[94:95], v[26:27]
    v_pk_fma_f32 v[36:37], v[36:37], s[94:95], v[26:27]
    v_pk_fma_f32 v[38:39], v[38:39], s[94:95], v[26:27]
    v_pk_fma_f32 v[40:41], v[40:41], s[94:95], v[26:27]
    v_pk_mul_f32 v[34:35], v[34:35], v[160:161]
    v_pk_mul_f32 v[36:37], v[36:37], v[162:163]
    v_pk_mul_f32 v[38:39], v[38:39], v[164:165]
    v_pk_mul_f32 v[40:41], v[40:41], v[166:167]
    v_exp_f32 v34, v34
    v_exp_f32 v35, v35
    v_exp_f32 v36, v36
    v_exp_f32 v37, v37
    v_exp_f32 v38, v38
    v_exp_f32 v39, v39
    v_exp_f32 v40, v40
    v_exp_f32 v41, v41
    v_pk_mul_f32 v[168:169], v[168:169], v[160:161]
    v_pk_mul_f32 v[170:171], v[170:171], v[162:163]
    v_pk_mul_f32 v[172:173], v[172:173], v[164:165]
    v_pk_mul_f32 v[174:175], v[174:175], v[166:167]
    v_pk_add_f32 v[34:35], v[34:35], 1.0 op_sel_hi:[1,0]
    v_pk_add_f32 v[36:37], v[36:37], 1.0 op_sel_hi:[1,0]
    v_pk_add_f32 v[38:39], v[38:39], 1.0 op_sel_hi:[1,0]
    v_pk_add_f32 v[40:41], v[40:41], 1.0 op_sel_hi:[1,0]
    v_rcp_f32 v34, v34
    v_rcp_f32 v35, v35
    v_rcp_f32 v36, v36
    v_rcp_f32 v37, v37
    v_rcp_f32 v38, v38
    v_rcp_f32 v39, v39
    v_rcp_f32 v40, v40
    v_rcp_f32 v41, v41
    v_pk_mul_f32 v[168:169], v[168:169], v[34:35]
    v_pk_mul_f32 v[170:171], v[170:171], v[36:37]
    v_pk_mul_f32 v[172:173], v[172:173], v[38:39]
    v_pk_mul_f32 v[174:175], v[174:175], v[40:41]
    v_cvt_pk_bf16_f32 v160, v168, v169
    v_cvt_pk_bf16_f32 v161, v170, v171
    v_cvt_pk_bf16_f32 v162, v172, v173
    v_cvt_pk_bf16_f32 v163, v174, v175
    buffer_store_dwordx4 v[160:163], v16, s[56:59], s88 offen offset:2048 sc1
    v_pk_mul_f32 v[34:35], v[176:177], v[176:177]
    v_pk_mul_f32 v[36:37], v[178:179], v[178:179]
    v_pk_mul_f32 v[38:39], v[180:181], v[180:181]
    v_pk_mul_f32 v[40:41], v[182:183], v[182:183]
    v_pk_fma_f32 v[34:35], v[34:35], s[94:95], v[26:27]
    v_pk_fma_f32 v[36:37], v[36:37], s[94:95], v[26:27]
    v_pk_fma_f32 v[38:39], v[38:39], s[94:95], v[26:27]
    v_pk_fma_f32 v[40:41], v[40:41], s[94:95], v[26:27]
    v_pk_mul_f32 v[34:35], v[34:35], v[176:177]
    v_pk_mul_f32 v[36:37], v[36:37], v[178:179]
    v_pk_mul_f32 v[38:39], v[38:39], v[180:181]
    v_pk_mul_f32 v[40:41], v[40:41], v[182:183]
    v_exp_f32 v34, v34
    v_exp_f32 v35, v35
    v_exp_f32 v36, v36
    v_exp_f32 v37, v37
    v_exp_f32 v38, v38
    v_exp_f32 v39, v39
    v_exp_f32 v40, v40
    v_exp_f32 v41, v41
    v_pk_mul_f32 v[184:185], v[184:185], v[176:177]
    v_pk_mul_f32 v[186:187], v[186:187], v[178:179]
    v_pk_mul_f32 v[188:189], v[188:189], v[180:181]
    v_pk_mul_f32 v[190:191], v[190:191], v[182:183]
    v_pk_add_f32 v[34:35], v[34:35], 1.0 op_sel_hi:[1,0]
    v_pk_add_f32 v[36:37], v[36:37], 1.0 op_sel_hi:[1,0]
    v_pk_add_f32 v[38:39], v[38:39], 1.0 op_sel_hi:[1,0]
    v_pk_add_f32 v[40:41], v[40:41], 1.0 op_sel_hi:[1,0]
    v_rcp_f32 v34, v34
    v_rcp_f32 v35, v35
    v_rcp_f32 v36, v36
    v_rcp_f32 v37, v37
    v_rcp_f32 v38, v38
    v_rcp_f32 v39, v39
    v_rcp_f32 v40, v40
    v_rcp_f32 v41, v41
    v_pk_mul_f32 v[184:185], v[184:185], v[34:35]
    v_pk_mul_f32 v[186:187], v[186:187], v[36:37]
    v_pk_mul_f32 v[188:189], v[188:189], v[38:39]
    v_pk_mul_f32 v[190:191], v[190:191], v[40:41]
    v_cvt_pk_bf16_f32 v176, v184, v185
    v_cvt_pk_bf16_f32 v177, v186, v187
    v_cvt_pk_bf16_f32 v178, v188, v189
    v_cvt_pk_bf16_f32 v179, v190, v191
    buffer_store_dwordx4 v[176:179], v16, s[56:59], s88 offen offset:3072 sc1
    v_pk_mul_f32 v[34:35], v[192:193], v[192:193]
    v_pk_mul_f32 v[36:37], v[194:195], v[194:195]
    v_pk_mul_f32 v[38:39], v[196:197], v[196:197]
    v_pk_mul_f32 v[40:41], v[198:199], v[198:199]
    v_pk_fma_f32 v[34:35], v[34:35], s[94:95], v[26:27]
    v_pk_fma_f32 v[36:37], v[36:37], s[94:95], v[26:27]
    v_pk_fma_f32 v[38:39], v[38:39], s[94:95], v[26:27]
    s_branch L_over4
L_stub4:
    s_branch L_stub8
L_over4:
    v_pk_fma_f32 v[40:41], v[40:41], s[94:95], v[26:27]
    v_pk_mul_f32 v[34:35], v[34:35], v[192:193]
    v_pk_mul_f32 v[36:37], v[36:37], v[194:195]
    v_pk_mul_f32 v[38:39], v[38:39], v[196:197]
    v_pk_mul_f32 v[40:41], v[40:41], v[198:199]
    v_exp_f32 v34, v34
    v_exp_f32 v35, v35
    v_exp_f32 v36, v36
    v_exp_f32 v37, v37
    v_exp_f32 v38, v38
    v_exp_f32 v39, v39
    v_exp_f32 v40, v40
    v_exp_f32 v41, v41
    v_pk_mul_f32 v[200:201], v[200:201], v[192:193]
    v_pk_mul_f32 v[202:203], v[202:203], v[194:195]
    v_pk_mul_f32 v[204:205], v[204:205], v[196:197]
    v_pk_mul_f32 v[206:207], v[206:207], v[198:199]
    v_pk_add_f32 v[34:35], v[34:35], 1.0 op_sel_hi:[1,0]
    v_pk_add_f32 v[36:37], v[36:37], 1.0 op_sel_hi:[1,0]
    v_pk_add_f32 v[38:39], v[38:39], 1.0 op_sel_hi:[1,0]
    v_pk_add_f32 v[40:41], v[40:41], 1.0 op_sel_hi:[1,0]
    v_rcp_f32 v34, v34
    v_rcp_f32 v35, v35
    v_rcp_f32 v36, v36
    v_rcp_f32 v37, v37
    v_rcp_f32 v38, v38
    v_rcp_f32 v39, v39
    v_rcp_f32 v40, v40
    v_rcp_f32 v41, v41
    v_pk_mul_f32 v[200:201], v[200:201], v[34:35]
    v_pk_mul_f32 v[202:203], v[202:203], v[36:37]
    v_pk_mul_f32 v[204:205], v[204:205], v[38:39]
    v_pk_mul_f32 v[206:207], v[206:207], v[40:41]
    v_cvt_pk_bf16_f32 v192, v200, v201
    v_cvt_pk_bf16_f32 v193, v202, v203
    v_cvt_pk_bf16_f32 v194, v204, v205
    v_cvt_pk_bf16_f32 v195, v206, v207
    s_add_u32 s88, s88, 4096
    buffer_store_dwordx4 v[192:195], v16, s[56:59], s88 offen offset:0 sc1
    v_pk_mul_f32 v[34:35], v[208:209], v[208:209]
    v_pk_mul_f32 v[36:37], v[210:211], v[210:211]
    v_pk_mul_f32 v[38:39], v[212:213], v[212:213]
    v_pk_mul_f32 v[40:41], v[214:215], v[214:215]
    v_pk_fma_f32 v[34:35], v[34:35], s[94:95], v[26:27]
    v_pk_fma_f32 v[36:37], v[36:37], s[94:95], v[26:27]
    v_pk_fma_f32 v[38:39], v[38:39], s[94:95], v[26:27]
    v_pk_fma_f32 v[40:41], v[40:41], s[94:95], v[26:27]
    v_pk_mul_f32 v[34:35], v[34:35], v[208:209]
    v_pk_mul_f32 v[36:37], v[36:37], v[210:211]
    v_pk_mul_f32 v[38:39], v[38:39], v[212:213]
    v_pk_mul_f32 v[40:41], v[40:41], v[214:215]
    v_exp_f32 v34, v34
    v_exp_f32 v35, v35
    v_exp_f32 v36, v36
    v_exp_f32 v37, v37
    v_exp_f32 v38, v38
    v_exp_f32 v39, v39
    v_exp_f32 v40, v40
    v_exp_f32 v41, v41
    v_pk_mul_f32 v[216:217], v[216:217], v[208:209]
    v_pk_mul_f32 v[218:219], v[218:219], v[210:211]
    v_pk_mul_f32 v[220:221], v[220:221], v[212:213]
    v_pk_mul_f32 v[222:223], v[222:223], v[214:215]
    v_pk_add_f32 v[34:35], v[34:35], 1.0 op_sel_hi:[1,0]
    v_pk_add_f32 v[36:37], v[36:37], 1.0 op_sel_hi:[1,0]
    v_pk_add_f32 v[38:39], v[38:39], 1.0 op_sel_hi:[1,0]
    v_pk_add_f32 v[40:41], v[40:41], 1.0 op_sel_hi:[1,0]
    v_rcp_f32 v34, v34
    v_rcp_f32 v35, v35
    v_rcp_f32 v36, v36
    v_rcp_f32 v37, v37
    v_rcp_f32 v38, v38
    v_rcp_f32 v39, v39
    v_rcp_f32 v40, v40
    v_rcp_f32 v41, v41
    v_pk_mul_f32 v[216:217], v[216:217], v[34:35]
    v_pk_mul_f32 v[218:219], v[218:219], v[36:37]
    v_pk_mul_f32 v[220:221], v[220:221], v[38:39]
    v_pk_mul_f32 v[222:223], v[222:223], v[40:41]
    v_cvt_pk_bf16_f32 v208, v216, v217
    v_cvt_pk_bf16_f32 v209, v218, v219
    v_cvt_pk_bf16_f32 v210, v220, v221
    v_cvt_pk_bf16_f32 v211, v222, v223
    buffer_store_dwordx4 v[208:211], v16, s[56:59], s88 offen offset:1024 sc1
    v_pk_mul_f32 v[34:35], v[224:225], v[224:225]
    v_pk_mul_f32 v[36:37], v[226:227], v[226:227]
    v_pk_mul_f32 v[38:39], v[228:229], v[228:229]
    v_pk_mul_f32 v[40:41], v[230:231], v[230:231]
    v_pk_fma_f32 v[34:35], v[34:35], s[94:95], v[26:27]
    v_pk_fma_f32 v[36:37], v[36:37], s[94:95], v[26:27]
    v_pk_fma_f32 v[38:39], v[38:39], s[94:95], v[26:27]
    v_pk_fma_f32 v[40:41], v[40:41], s[94:95], v[26:27]
    v_pk_mul_f32 v[34:35], v[34:35], v[224:225]
    v_pk_mul_f32 v[36:37], v[36:37], v[226:227]
    v_pk_mul_f32 v[38:39], v[38:39], v[228:229]
    v_pk_mul_f32 v[40:41], v[40:41], v[230:231]
    v_exp_f32 v34, v34
    v_exp_f32 v35, v35
    v_exp_f32 v36, v36
    v_exp_f32 v37, v37
    v_exp_f32 v38, v38
    v_exp_f32 v39, v39
    v_exp_f32 v40, v40
    v_exp_f32 v41, v41
    v_pk_mul_f32 v[232:233], v[232:233], v[224:225]
    v_pk_mul_f32 v[234:235], v[234:235], v[226:227]
    v_pk_mul_f32 v[236:237], v[236:237], v[228:229]
    v_pk_mul_f32 v[238:239], v[238:239], v[230:231]
    v_pk_add_f32 v[34:35], v[34:35], 1.0 op_sel_hi:[1,0]
    v_pk_add_f32 v[36:37], v[36:37], 1.0 op_sel_hi:[1,0]
    v_pk_add_f32 v[38:39], v[38:39], 1.0 op_sel_hi:[1,0]
    v_pk_add_f32 v[40:41], v[40:41], 1.0 op_sel_hi:[1,0]
    v_rcp_f32 v34, v34
    v_rcp_f32 v35, v35
    v_rcp_f32 v36, v36
    v_rcp_f32 v37, v37
    v_rcp_f32 v38, v38
    v_rcp_f32 v39, v39
    v_rcp_f32 v40, v40
    v_rcp_f32 v41, v41
    v_pk_mul_f32 v[232:233], v[232:233], v[34:35]
    v_pk_mul_f32 v[234:235], v[234:235], v[36:37]
    v_pk_mul_f32 v[236:237], v[236:237], v[38:39]
    v_pk_mul_f32 v[238:239], v[238:239], v[40:41]
    v_cvt_pk_bf16_f32 v224, v232, v233
    v_cvt_pk_bf16_f32 v225, v234, v235
    v_cvt_pk_bf16_f32 v226, v236, v237
    v_cvt_pk_bf16_f32 v227, v238, v239
    buffer_store_dwordx4 v[224:227], v16, s[56:59], s88 offen offset:2048 sc1
    v_pk_mul_f32 v[34:35], v[240:241], v[240:241]
    v_pk_mul_f32 v[36:37], v[242:243], v[242:243]
    v_pk_mul_f32 v[38:39], v[244:245], v[244:245]
    v_pk_mul_f32 v[40:41], v[246:247], v[246:247]
    v_pk_fma_f32 v[34:35], v[34:35], s[94:95], v[26:27]
    v_pk_fma_f32 v[36:37], v[36:37], s[94:95], v[26:27]
    v_pk_fma_f32 v[38:39], v[38:39], s[94:95], v[26:27]
    v_pk_fma_f32 v[40:41], v[40:41], s[94:95], v[26:27]
    v_pk_mul_f32 v[34:35], v[34:35], v[240:241]
    v_pk_mul_f32 v[36:37], v[36:37], v[242:243]
    v_pk_mul_f32 v[38:39], v[38:39], v[244:245]
    v_pk_mul_f32 v[40:41], v[40:41], v[246:247]
    v_exp_f32 v34, v34
    v_exp_f32 v35, v35
    v_exp_f32 v36, v36
    v_exp_f32 v37, v37
    v_exp_f32 v38, v38
    v_exp_f32 v39, v39
    v_exp_f32 v40, v40
    v_exp_f32 v41, v41
    v_pk_mul_f32 v[248:249], v[248:249], v[240:241]
    v_pk_mul_f32 v[250:251], v[250:251], v[242:243]
    v_pk_mul_f32 v[252:253], v[252:253], v[244:245]
    v_pk_mul_f32 v[254:255], v[254:255], v[246:247]
    v_pk_add_f32 v[34:35], v[34:35], 1.0 op_sel_hi:[1,0]
    v_pk_add_f32 v[36:37], v[36:37], 1.0 op_sel_hi:[1,0]
    v_pk_add_f32 v[38:39], v[38:39], 1.0 op_sel_hi:[1,0]
    v_pk_add_f32 v[40:41], v[40:41], 1.0 op_sel_hi:[1,0]
    v_rcp_f32 v34, v34
    v_rcp_f32 v35, v35
    v_rcp_f32 v36, v36
    v_rcp_f32 v37, v37
    v_rcp_f32 v38, v38
    v_rcp_f32 v39, v39
    v_rcp_f32 v40, v40
    v_rcp_f32 v41, v41
    v_pk_mul_f32 v[248:249], v[248:249], v[34:35]
    v_pk_mul_f32 v[250:251], v[250:251], v[36:37]
    v_pk_mul_f32 v[252:253], v[252:253], v[38:39]
    v_pk_mul_f32 v[254:255], v[254:255], v[40:41]
    v_cvt_pk_bf16_f32 v240, v248, v249
    v_cvt_pk_bf16_f32 v241, v250, v251
    v_cvt_pk_bf16_f32 v242, v252, v253
    v_cvt_pk_bf16_f32 v243, v254, v255
    buffer_store_dwordx4 v[240:243], v16, s[56:59], s88 offen offset:3072 sc1
    s_cmp_eq_u32 s62, 1
    s_cbranch_scc1 L_epi1
    v_mov_b32 v244, 0xce6e6b28
    v_cvt_pk_bf16_f32 v128, v120, v121
    v_cvt_pk_bf16_f32 v129, v122, v123
    v_cvt_pk_bf16_f32 v130, v124, v125
    v_cvt_pk_bf16_f32 v131, v126, v127
    v_accvgpr_read_b32 v34, a128
    v_accvgpr_read_b32 v35, a129
    v_accvgpr_read_b32 v36, a130
    v_accvgpr_read_b32 v37, a131
    v_accvgpr_read_b32 v38, a132
    v_accvgpr_read_b32 v39, a133
    v_accvgpr_read_b32 v40, a134
    v_accvgpr_read_b32 v41, a135
    v_cvt_pk_bf16_f32 v132, v34, v35
    v_cvt_pk_bf16_f32 v133, v36, v37
    v_cvt_pk_bf16_f32 v134, v38, v39
    v_cvt_pk_bf16_f32 v135, v40, v41
    v_accvgpr_read_b32 v246, a192
    v_accvgpr_read_b32 v247, a193
    v_accvgpr_read_b32 v248, a194
    v_accvgpr_read_b32 v249, a195
    v_accvgpr_read_b32 v250, a196
    v_accvgpr_read_b32 v251, a197
    v_accvgpr_read_b32 v252, a198
    v_accvgpr_read_b32 v253, a199
    v_cvt_pk_bf16_f32 v164, v246, v247
    v_cvt_pk_bf16_f32 v165, v248, v249
    v_cvt_pk_bf16_f32 v166, v250, v251
    v_cvt_pk_bf16_f32 v167, v252, v253
    v_accvgpr_read_b32 v34, a136
    v_accvgpr_read_b32 v35, a137
    v_accvgpr_read_b32 v36, a138
    v_accvgpr_read_b32 v37, a139
    v_accvgpr_read_b32 v38, a140
    v_accvgpr_read_b32 v39, a141
    v_accvgpr_read_b32 v40, a142
    v_accvgpr_read_b32 v41, a143
    v_cvt_pk_bf16_f32 v136, v34, v35
    v_cvt_pk_bf16_f32 v137, v36, v37
    v_cvt_pk_bf16_f32 v138, v38, v39
    v_cvt_pk_bf16_f32 v139, v40, v41
    v_accvgpr_read_b32 v246, a200
    v_accvgpr_read_b32 v247, a201
    v_accvgpr_read_b32 v248, a202
    v_accvgpr_read_b32 v249, a203
    v_accvgpr_read_b32 v250, a204
    v_accvgpr_read_b32 v251, a205
    v_accvgpr_read_b32 v252, a206
    v_accvgpr_read_b32 v253, a207
    v_cvt_pk_bf16_f32 v168, v246, v247
    v_cvt_pk_bf16_f32 v169, v248, v249
    v_cvt_pk_bf16_f32 v170, v250, v251
    v_cvt_pk_bf16_f32 v171, v252, v253
    v_accvgpr_read_b32 v34, a144
    v_accvgpr_read_b32 v35, a145
    v_accvgpr_read_b32 v36, a146
    v_accvgpr_read_b32 v37, a147
    v_accvgpr_read_b32 v38, a148
    v_accvgpr_read_b32 v39, a149
    v_accvgpr_read_b32 v40, a150
    v_accvgpr_read_b32 v41, a151
    v_cvt_pk_bf16_f32 v140, v34, v35
    v_cvt_pk_bf16_f32 v141, v36, v37
    v_cvt_pk_bf16_f32 v142, v38, v39
    v_cvt_pk_bf16_f32 v143, v40, v41
    v_accvgpr_read_b32 v246, a208
    v_accvgpr_read_b32 v247, a209
    v_accvgpr_read_b32 v248, a210
    v_accvgpr_read_b32 v249, a211
    v_accvgpr_read_b32 v250, a212
    v_accvgpr_read_b32 v251, a213
    v_accvgpr_read_b32 v252, a214
    v_accvgpr_read_b32 v253, a215
    v_cvt_pk_bf16_f32 v172, v246, v247
    v_cvt_pk_bf16_f32 v173, v248, v249
    v_cvt_pk_bf16_f32 v174, v250, v251
    v_cvt_pk_bf16_f32 v175, v252, v253
    v_accvgpr_read_b32 v34, a152
    v_accvgpr_read_b32 v35, a153
    v_accvgpr_read_b32 v36, a154
    v_accvgpr_read_b32 v37, a155
    v_accvgpr_read_b32 v38, a156
    v_accvgpr_read_b32 v39, a157
    v_accvgpr_read_b32 v40, a158
    v_accvgpr_read_b32 v41, a159
    v_cvt_pk_bf16_f32 v144, v34, v35
    v_cvt_pk_bf16_f32 v145, v36, v37
    v_cvt_pk_bf16_f32 v146, v38, v39
    v_cvt_pk_bf16_f32 v147, v40, v41
    v_accvgpr_read_b32 v246, a216
    v_accvgpr_read_b32 v247, a217
    v_accvgpr_read_b32 v248, a218
    v_accvgpr_read_b32 v249, a219
    v_accvgpr_read_b32 v250, a220
    v_accvgpr_read_b32 v251, a221
    v_accvgpr_read_b32 v252, a222
    v_accvgpr_read_b32 v253, a223
    v_cvt_pk_bf16_f32 v176, v246, v247
    v_cvt_pk_bf16_f32 v177, v248, v249
    v_cvt_pk_bf16_f32 v178, v250, v251
    v_cvt_pk_bf16_f32 v179, v252, v253
    v_mfma_f32_16x16x32_bf16 v[196:199], v[128:131], v[164:167], 0
    v_mfma_f32_16x16x32_bf16 v[200:203], v[132:135], v[164:167], 0
    v_mfma_f32_16x16x32_bf16 v[204:207], v[132:135], v[168:171], 0
    v_mfma_f32_16x16x32_bf16 v[208:211], v[136:139], v[168:171], 0
    v_mfma_f32_16x16x32_bf16 v[212:215], v[136:139], v[172:175], 0
    v_mfma_f32_16x16x32_bf16 v[216:219], v[140:143], v[172:175], 0
    v_mfma_f32_16x16x32_bf16 v[220:223], v[140:143], v[176:179], 0
    v_mfma_f32_16x16x32_bf16 v[224:227], v[144:147], v[176:179], 0
    s_waitcnt vmcnt(0)
    s_mov_b64 exec, 1
    buffer_atomic_add v25, off, s[56:59], s92 sc1
    s_mov_b64 exec, -1
    v_cvt_pk_bf16_f32 v48, v48, v49
    v_cvt_pk_bf16_f32 v49, v50, v51
    v_cvt_pk_bf16_f32 v84, v84, v85
    v_cvt_pk_bf16_f32 v85, v86, v87
    v_cvt_pk_bf16_f32 v50, v52, v53
    v_cvt_pk_bf16_f32 v51, v54, v55
    v_cvt_pk_bf16_f32 v86, v88, v89
    v_cvt_pk_bf16_f32 v87, v90, v91
    v_cvt_pk_bf16_f32 v52, v56, v57
    v_cvt_pk_bf16_f32 v53, v58, v59
    v_cvt_pk_bf16_f32 v88, v92, v93
    v_cvt_pk_bf16_f32 v89, v94, v95
    v_cvt_pk_bf16_f32 v54, v60, v61
    v_cvt_pk_bf16_f32 v55, v62, v63
    v_cvt_pk_bf16_f32 v90, v96, v97
    v_cvt_pk_bf16_f32 v91, v98, v99
    v_cvt_pk_bf16_f32 v56, v64, v65
    v_cvt_pk_bf16_f32 v57, v66, v67
    v_cvt_pk_bf16_f32 v92, v100, v101
    v_cvt_pk_bf16_f32 v93, v102, v103
    v_cvt_pk_bf16_f32 v58, v68, v69
    v_cvt_pk_bf16_f32 v59, v70, v71
    v_cvt_pk_bf16_f32 v94, v104, v105
    v_cvt_pk_bf16_f32 v95, v106, v107
    v_cvt_pk_bf16_f32 v60, v72, v73
    v_cvt_pk_bf16_f32 v61, v74, v75
    v_cvt_pk_bf16_f32 v96, v108, v109
    v_cvt_pk_bf16_f32 v97, v110, v111
    v_cvt_pk_bf16_f32 v62, v76, v77
    v_cvt_pk_bf16_f32 v63, v78, v79
    v_cvt_pk_bf16_f32 v98, v112, v113
    v_cvt_pk_bf16_f32 v99, v114, v115
    v_cvt_pk_bf16_f32 v64, v80, v81
    v_cvt_pk_bf16_f32 v65, v82, v83
    v_cvt_pk_bf16_f32 v100, v116, v117
    v_cvt_pk_bf16_f32 v101, v118, v119
    v_cvt_pk_bf16_f32 v196, v196, v197
    v_cvt_pk_bf16_f32 v198, v198, v199
    v_cvt_pk_bf16_f32 v200, v200, v201
    v_cvt_pk_bf16_f32 v202, v202, v203
    v_cvt_pk_bf16_f32 v204, v204, v205
    v_cvt_pk_bf16_f32 v206, v206, v207
    v_cvt_pk_bf16_f32 v208, v208, v209
    v_cvt_pk_bf16_f32 v210, v210, v211
    v_cvt_pk_bf16_f32 v212, v212, v213
    v_cvt_pk_bf16_f32 v214, v214, v215
    v_cvt_pk_bf16_f32 v216, v216, v217
    v_cvt_pk_bf16_f32 v218, v218, v219
    v_cvt_pk_bf16_f32 v220, v220, v221
    v_cvt_pk_bf16_f32 v222, v222, v223
    v_cvt_pk_bf16_f32 v224, v224, v225
    v_cvt_pk_bf16_f32 v226, v226, v227
    v_perm_b32 v228, v200, v196, v28
    v_perm_b32 v229, v202, v198, v29
    v_perm_b32 v230, v208, v204, v28
    v_perm_b32 v231, v210, v206, v29
    v_perm_b32 v232, v216, v212, v28
    v_perm_b32 v233, v218, v214, v29
    v_perm_b32 v234, v224, v220, v28
    v_perm_b32 v235, v226, v222, v29
    v_pk_mul_f32 v[228:229], v[228:229], s[14:15]
    v_pk_mul_f32 v[230:231], v[230:231], s[14:15]
    v_pk_mul_f32 v[232:233], v[232:233], s[14:15]
    v_pk_mul_f32 v[234:235], v[234:235], s[14:15]
    v_cvt_pk_bf16_f32 v229, v228, v229
    v_cvt_pk_bf16_f32 v231, v230, v231
    v_cvt_pk_bf16_f32 v233, v232, v233
    v_cvt_pk_bf16_f32 v235, v234, v235
    v_lshlrev_b32 v228, 16, v229
    v_and_b32 v229, 0xffff0000, v229
    v_lshlrev_b32 v230, 16, v231
    v_and_b32 v231, 0xffff0000, v231
    v_lshlrev_b32 v232, 16, v233
    v_and_b32 v233, 0xffff0000, v233
    v_lshlrev_b32 v234, 16, v235
    v_and_b32 v235, 0xffff0000, v235
    v_cndmask_b32 v228, v244, v228, s[4:5]
    v_cndmask_b32 v229, v244, v229, s[6:7]
    v_max_f32 v236, v228, v229
    v_max_f32 v238, v230, v231
    v_max_f32 v240, v232, v233
    v_max_f32 v242, v234, v235
    v_permlane16_swap_b32 v236, v238
    s_nop 0
    v_permlane16_swap_b32 v240, v242
    v_max_f32 v236, v236, v238
    v_max_f32 v240, v240, v242
    s_nop 1
    v_permlane32_swap_b32 v236, v240
    v_max_f32 v236, v236, v240
    v_mul_f32 v236, 0xbfb8aa3b, v236
    v_mov_b32 v240, v236
    s_nop 1
    v_permlane32_swap_b32 v236, v240
    v_mov_b32 v238, v236
    v_mov_b32 v242, v240
    s_nop 0
    v_permlane16_swap_b32 v236, v238
    v_permlane16_swap_b32 v240, v242
    v_pk_fma_f32 v[228:229], v[228:229], s[98:99], v[236:237] op_sel_hi:[1,1,0]
    v_pk_fma_f32 v[230:231], v[230:231], s[98:99], v[238:239] op_sel_hi:[1,1,0]
    v_pk_fma_f32 v[232:233], v[232:233], s[98:99], v[240:241] op_sel_hi:[1,1,0]
    v_pk_fma_f32 v[234:235], v[234:235], s[98:99], v[242:243] op_sel_hi:[1,1,0]
    v_exp_f32 v228, v228
    v_exp_f32 v229, v229
    v_exp_f32 v230, v230
    v_exp_f32 v231, v231
    v_exp_f32 v232, v232
    v_exp_f32 v233, v233
    v_exp_f32 v234, v234
    v_exp_f32 v235, v235
    v_add_f32 v236, v228, v229
    v_add_f32 v238, v230, v231
    v_add_f32 v240, v232, v233
    v_add_f32 v242, v234, v235
    v_permlane16_swap_b32 v236, v238
    s_nop 0
    v_permlane16_swap_b32 v240, v242
    v_add_f32 v236, v236, v238
    v_add_f32 v240, v240, v242
    s_nop 1
    v_permlane32_swap_b32 v236, v240
    v_add_f32 v236, v236, v240
    v_rcp_f32 v236, v236
    s_nop 0
    v_mov_b32 v240, v236
    s_nop 1
    v_permlane32_swap_b32 v236, v240
    v_mov_b32 v238, v236
    v_mov_b32 v242, v240
    s_nop 0
    v_permlane16_swap_b32 v236, v238
    v_permlane16_swap_b32 v240, v242
    v_pk_mul_f32 v[228:229], v[228:229], v[236:237] op_sel_hi:[1,0]
    v_pk_mul_f32 v[230:231], v[230:231], v[238:239] op_sel_hi:[1,0]
    v_pk_mul_f32 v[232:233], v[232:233], v[240:241] op_sel_hi:[1,0]
    v_pk_mul_f32 v[234:235], v[234:235], v[242:243] op_sel_hi:[1,0]
    v_cvt_pk_bf16_f32 v228, v228, v229
    v_cvt_pk_bf16_f32 v230, v230, v231
    v_cvt_pk_bf16_f32 v232, v232, v233
    v_cvt_pk_bf16_f32 v234, v234, v235
    v_perm_b32 v164, v228, v228, v30
    v_perm_b32 v165, v228, v228, v31
    v_perm_b32 v166, v228, v228, v32
    v_perm_b32 v167, v228, v228, v33
    v_perm_b32 v168, v230, v230, v30
    v_perm_b32 v169, v230, v230, v31
    v_perm_b32 v170, v230, v230, v32
    v_perm_b32 v171, v230, v230, v33
    v_perm_b32 v172, v232, v232, v30
    v_perm_b32 v173, v232, v232, v31
    v_perm_b32 v174, v232, v232, v32
    v_perm_b32 v175, v232, v232, v33
    v_perm_b32 v176, v234, v234, v30
    v_perm_b32 v177, v234, v234, v31
    v_perm_b32 v178, v234, v234, v32
    v_perm_b32 v179, v234, v234, v33
    v_mfma_f32_16x16x32_bf16 v[196:199], v[48:51], v[164:167], 0
    v_mfma_f32_16x16x32_bf16 v[200:203], v[84:87], v[164:167], 0
    v_mfma_f32_16x16x32_bf16 v[204:207], v[50:53], v[168:171], 0
    v_mfma_f32_16x16x32_bf16 v[208:211], v[86:89], v[168:171], 0
    v_mfma_f32_16x16x32_bf16 v[212:215], v[52:55], v[172:175], 0
    v_mfma_f32_16x16x32_bf16 v[216:219], v[88:91], v[172:175], 0
    v_mfma_f32_16x16x32_bf16 v[220:223], v[54:57], v[176:179], 0
    v_mfma_f32_16x16x32_bf16 v[224:227], v[90:93], v[176:179], 0
    v_accvgpr_read_b32 v34, a160
    v_accvgpr_read_b32 v35, a161
    v_accvgpr_read_b32 v36, a162
    v_accvgpr_read_b32 v37, a163
    v_accvgpr_read_b32 v38, a164
    v_accvgpr_read_b32 v39, a165
    v_accvgpr_read_b32 v40, a166
    v_accvgpr_read_b32 v41, a167
    v_cvt_pk_bf16_f32 v148, v34, v35
    v_cvt_pk_bf16_f32 v149, v36, v37
    v_cvt_pk_bf16_f32 v150, v38, v39
    v_cvt_pk_bf16_f32 v151, v40, v41
    v_accvgpr_read_b32 v246, a224
    v_accvgpr_read_b32 v247, a225
    v_accvgpr_read_b32 v248, a226
    v_accvgpr_read_b32 v249, a227
    v_accvgpr_read_b32 v250, a228
    v_accvgpr_read_b32 v251, a229
    v_accvgpr_read_b32 v252, a230
    v_accvgpr_read_b32 v253, a231
    v_cvt_pk_bf16_f32 v180, v246, v247
    v_cvt_pk_bf16_f32 v181, v248, v249
    v_cvt_pk_bf16_f32 v182, v250, v251
    v_cvt_pk_bf16_f32 v183, v252, v253
    v_accvgpr_read_b32 v34, a168
    v_accvgpr_read_b32 v35, a169
    v_accvgpr_read_b32 v36, a170
    v_accvgpr_read_b32 v37, a171
    v_accvgpr_read_b32 v38, a172
    v_accvgpr_read_b32 v39, a173
    v_accvgpr_read_b32 v40, a174
    v_accvgpr_read_b32 v41, a175
    v_cvt_pk_bf16_f32 v152, v34, v35
    v_cvt_pk_bf16_f32 v153, v36, v37
    v_cvt_pk_bf16_f32 v154, v38, v39
    v_cvt_pk_bf16_f32 v155, v40, v41
    v_accvgpr_read_b32 v246, a232
    v_accvgpr_read_b32 v247, a233
    v_accvgpr_read_b32 v248, a234
    v_accvgpr_read_b32 v249, a235
    v_accvgpr_read_b32 v250, a236
    v_accvgpr_read_b32 v251, a237
    v_accvgpr_read_b32 v252, a238
    v_accvgpr_read_b32 v253, a239
    v_cvt_pk_bf16_f32 v184, v246, v247
    v_cvt_pk_bf16_f32 v185, v248, v249
    v_cvt_pk_bf16_f32 v186, v250, v251
    v_cvt_pk_bf16_f32 v187, v252, v253
    v_accvgpr_read_b32 v34, a176
    v_accvgpr_read_b32 v35, a177
    v_accvgpr_read_b32 v36, a178
    v_accvgpr_read_b32 v37, a179
    v_accvgpr_read_b32 v38, a180
    v_accvgpr_read_b32 v39, a181
    v_accvgpr_read_b32 v40, a182
    v_accvgpr_read_b32 v41, a183
    v_cvt_pk_bf16_f32 v156, v34, v35
    v_cvt_pk_bf16_f32 v157, v36, v37
    v_cvt_pk_bf16_f32 v158, v38, v39
    v_cvt_pk_bf16_f32 v159, v40, v41
    v_accvgpr_read_b32 v246, a240
    v_accvgpr_read_b32 v247, a241
    v_accvgpr_read_b32 v248, a242
    v_accvgpr_read_b32 v249, a243
    v_accvgpr_read_b32 v250, a244
    v_accvgpr_read_b32 v251, a245
    v_accvgpr_read_b32 v252, a246
    v_accvgpr_read_b32 v253, a247
    v_cvt_pk_bf16_f32 v188, v246, v247
    v_cvt_pk_bf16_f32 v189, v248, v249
    v_cvt_pk_bf16_f32 v190, v250, v251
    v_cvt_pk_bf16_f32 v191, v252, v253
    v_accvgpr_read_b32 v34, a184
    v_accvgpr_read_b32 v35, a185
    v_accvgpr_read_b32 v36, a186
    v_accvgpr_read_b32 v37, a187
    v_accvgpr_read_b32 v38, a188
    v_accvgpr_read_b32 v39, a189
    v_accvgpr_read_b32 v40, a190
    v_accvgpr_read_b32 v41, a191
    v_cvt_pk_bf16_f32 v160, v34, v35
    v_cvt_pk_bf16_f32 v161, v36, v37
    v_cvt_pk_bf16_f32 v162, v38, v39
    v_cvt_pk_bf16_f32 v163, v40, v41
    v_accvgpr_read_b32 v246, a248
    v_accvgpr_read_b32 v247, a249
    v_accvgpr_read_b32 v248, a250
    v_accvgpr_read_b32 v249, a251
    v_accvgpr_read_b32 v250, a252
    v_accvgpr_read_b32 v251, a253
    v_accvgpr_read_b32 v252, a254
    v_accvgpr_read_b32 v253, a255
    v_cvt_pk_bf16_f32 v192, v246, v247
    v_cvt_pk_bf16_f32 v193, v248, v249
    v_cvt_pk_bf16_f32 v194, v250, v251
    v_cvt_pk_bf16_f32 v195, v252, v253
    v_cvt_pk_bf16_f32 v196, v196, v197
    v_cvt_pk_bf16_f32 v197, v198, v199
    v_cvt_pk_bf16_f32 v198, v200, v201
    v_cvt_pk_bf16_f32 v199, v202, v203
    buffer_store_dwordx4 v[196:199], v16, s[56:59], s91 offen offset:0 sc1
    s_add_u32 s91, s91, 32768
    v_cvt_pk_bf16_f32 v204, v204, v205
    v_cvt_pk_bf16_f32 v205, v206, v207
    v_cvt_pk_bf16_f32 v206, v208, v209
    v_cvt_pk_bf16_f32 v207, v210, v211
    buffer_store_dwordx4 v[204:207], v16, s[56:59], s91 offen offset:0 sc1
    s_add_u32 s91, s91, 32768
    v_cvt_pk_bf16_f32 v212, v212, v213
    v_cvt_pk_bf16_f32 v213, v214, v215
    v_cvt_pk_bf16_f32 v214, v216, v217
    v_cvt_pk_bf16_f32 v215, v218, v219
    buffer_store_dwordx4 v[212:215], v16, s[56:59], s91 offen offset:0 sc1
    s_add_u32 s91, s91, 32768
    v_cvt_pk_bf16_f32 v220, v220, v221
    v_cvt_pk_bf16_f32 v221, v222, v223
    v_cvt_pk_bf16_f32 v222, v224, v225
    v_cvt_pk_bf16_f32 v223, v226, v227
    s_branch L_over5
L_stub5:
    s_branch L_stub9
L_over5:
    buffer_store_dwordx4 v[220:223], v16, s[56:59], s91 offen offset:0 sc1
    s_add_u32 s91, s91, 32768
    s_mov_b32 s67, 0
    v_mfma_f32_16x16x32_bf16 v[196:199], v[144:147], v[180:183], 0
    v_mfma_f32_16x16x32_bf16 v[200:203], v[148:151], v[180:183], 0
    v_mfma_f32_16x16x32_bf16 v[204:207], v[148:151], v[184:187], 0
    v_mfma_f32_16x16x32_bf16 v[208:211], v[152:155], v[184:187], 0
    v_mfma_f32_16x16x32_bf16 v[212:215], v[152:155], v[188:191], 0
    v_mfma_f32_16x16x32_bf16 v[216:219], v[156:159], v[188:191], 0
    v_mfma_f32_16x16x32_bf16 v[220:223], v[156:159], v[192:195], 0
    v_mfma_f32_16x16x32_bf16 v[224:227], v[160:163], v[192:195], 0
    s_nop 0
    v_cvt_pk_bf16_f32 v196, v196, v197
    v_cvt_pk_bf16_f32 v198, v198, v199
    v_cvt_pk_bf16_f32 v200, v200, v201
    v_cvt_pk_bf16_f32 v202, v202, v203
    v_cvt_pk_bf16_f32 v204, v204, v205
    v_cvt_pk_bf16_f32 v206, v206, v207
    v_cvt_pk_bf16_f32 v208, v208, v209
    v_cvt_pk_bf16_f32 v210, v210, v211
    v_cvt_pk_bf16_f32 v212, v212, v213
    v_cvt_pk_bf16_f32 v214, v214, v215
    v_cvt_pk_bf16_f32 v216, v216, v217
    v_cvt_pk_bf16_f32 v218, v218, v219
    v_cvt_pk_bf16_f32 v220, v220, v221
    v_cvt_pk_bf16_f32 v222, v222, v223
    v_cvt_pk_bf16_f32 v224, v224, v225
    v_cvt_pk_bf16_f32 v226, v226, v227
    v_perm_b32 v228, v200, v196, v28
    v_perm_b32 v229, v202, v198, v29
    v_perm_b32 v230, v208, v204, v28
    v_perm_b32 v231, v210, v206, v29
    v_perm_b32 v232, v216, v212, v28
    v_perm_b32 v233, v218, v214, v29
    v_perm_b32 v234, v224, v220, v28
    v_perm_b32 v235, v226, v222, v29
    v_pk_mul_f32 v[228:229], v[228:229], s[14:15]
    v_pk_mul_f32 v[230:231], v[230:231], s[14:15]
    v_pk_mul_f32 v[232:233], v[232:233], s[14:15]
    v_pk_mul_f32 v[234:235], v[234:235], s[14:15]
    v_cvt_pk_bf16_f32 v229, v228, v229
    v_cvt_pk_bf16_f32 v231, v230, v231
    v_cvt_pk_bf16_f32 v233, v232, v233
    v_cvt_pk_bf16_f32 v235, v234, v235
    v_lshlrev_b32 v228, 16, v229
    v_and_b32 v229, 0xffff0000, v229
    v_lshlrev_b32 v230, 16, v231
    v_and_b32 v231, 0xffff0000, v231
    v_lshlrev_b32 v232, 16, v233
    v_and_b32 v233, 0xffff0000, v233
    v_lshlrev_b32 v234, 16, v235
    v_and_b32 v235, 0xffff0000, v235
    buffer_load_dword v43, off, s[56:59], s92 sc1
    v_max_f32 v236, v228, v229
    v_max_f32 v238, v230, v231
    v_max_f32 v240, v232, v233
    v_max_f32 v242, v234, v235
    v_permlane16_swap_b32 v236, v238
    s_nop 0
    v_permlane16_swap_b32 v240, v242
    v_max_f32 v236, v236, v238
    v_max_f32 v240, v240, v242
    s_nop 1
    v_permlane32_swap_b32 v236, v240
    v_max_f32 v236, v236, v240
    v_mul_f32 v236, 0xbfb8aa3b, v236
    v_mov_b32 v240, v236
    s_nop 1
    v_permlane32_swap_b32 v236, v240
    v_mov_b32 v238, v236
    v_mov_b32 v242, v240
    s_nop 0
    v_permlane16_swap_b32 v236, v238
    v_permlane16_swap_b32 v240, v242
    v_pk_fma_f32 v[228:229], v[228:229], s[98:99], v[236:237] op_sel_hi:[1,1,0]
    v_pk_fma_f32 v[230:231], v[230:231], s[98:99], v[238:239] op_sel_hi:[1,1,0]
    v_pk_fma_f32 v[232:233], v[232:233], s[98:99], v[240:241] op_sel_hi:[1,1,0]
    v_pk_fma_f32 v[234:235], v[234:235], s[98:99], v[242:243] op_sel_hi:[1,1,0]
    v_exp_f32 v228, v228
    v_exp_f32 v229, v229
    v_exp_f32 v230, v230
    v_exp_f32 v231, v231
    v_exp_f32 v232, v232
    v_exp_f32 v233, v233
    v_exp_f32 v234, v234
    v_exp_f32 v235, v235
    v_add_f32 v236, v228, v229
    v_add_f32 v238, v230, v231
    v_add_f32 v240, v232, v233
    v_add_f32 v242, v234, v235
    v_permlane16_swap_b32 v236, v238
    s_nop 0
    v_permlane16_swap_b32 v240, v242
    v_add_f32 v236, v236, v238
    v_add_f32 v240, v240, v242
    s_nop 1
    v_permlane32_swap_b32 v236, v240
    v_add_f32 v236, v236, v240
    v_rcp_f32 v236, v236
    s_nop 0
    v_mov_b32 v240, v236
    s_nop 1
    v_permlane32_swap_b32 v236, v240
    v_mov_b32 v238, v236
    v_mov_b32 v242, v240
    s_nop 0
    v_permlane16_swap_b32 v236, v238
    v_permlane16_swap_b32 v240, v242
    v_pk_mul_f32 v[228:229], v[228:229], v[236:237] op_sel_hi:[1,0]
    v_pk_mul_f32 v[230:231], v[230:231], v[238:239] op_sel_hi:[1,0]
    v_pk_mul_f32 v[232:233], v[232:233], v[240:241] op_sel_hi:[1,0]
    v_pk_mul_f32 v[234:235], v[234:235], v[242:243] op_sel_hi:[1,0]
    v_cvt_pk_bf16_f32 v228, v228, v229
    v_cvt_pk_bf16_f32 v230, v230, v231
    v_cvt_pk_bf16_f32 v232, v232, v233
    v_cvt_pk_bf16_f32 v234, v234, v235
    v_perm_b32 v180, v228, v228, v30
    v_perm_b32 v181, v228, v228, v31
    v_perm_b32 v182, v228, v228, v32
    v_perm_b32 v183, v228, v228, v33
    v_perm_b32 v184, v230, v230, v30
    v_perm_b32 v185, v230, v230, v31
    v_perm_b32 v186, v230, v230, v32
    v_perm_b32 v187, v230, v230, v33
    v_perm_b32 v188, v232, v232, v30
    v_perm_b32 v189, v232, v232, v31
    v_perm_b32 v190, v232, v232, v32
    v_perm_b32 v191, v232, v232, v33
    v_perm_b32 v192, v234, v234, v30
    v_perm_b32 v193, v234, v234, v31
    v_perm_b32 v194, v234, v234, v32
    v_perm_b32 v195, v234, v234, v33
    v_mfma_f32_16x16x32_bf16 v[196:199], v[56:59], v[180:183], 0
    v_mfma_f32_16x16x32_bf16 v[200:203], v[92:95], v[180:183], 0
    v_mfma_f32_16x16x32_bf16 v[204:207], v[58:61], v[184:187], 0
    v_mfma_f32_16x16x32_bf16 v[208:211], v[94:97], v[184:187], 0
    v_mfma_f32_16x16x32_bf16 v[212:215], v[60:63], v[188:191], 0
    v_mfma_f32_16x16x32_bf16 v[216:219], v[96:99], v[188:191], 0
    v_mfma_f32_16x16x32_bf16 v[220:223], v[62:65], v[192:195], 0
    v_mfma_f32_16x16x32_bf16 v[224:227], v[98:101], v[192:195], 0
    s_nop 0
    v_cvt_pk_bf16_f32 v196, v196, v197
    v_cvt_pk_bf16_f32 v197, v198, v199
    v_cvt_pk_bf16_f32 v198, v200, v201
    v_cvt_pk_bf16_f32 v199, v202, v203
    buffer_store_dwordx4 v[196:199], v16, s[56:59], s91 offen offset:0 sc1
    s_add_u32 s91, s91, 32768
    v_cvt_pk_bf16_f32 v204, v204, v205
    v_cvt_pk_bf16_f32 v205, v206, v207
    v_cvt_pk_bf16_f32 v206, v208, v209
    v_cvt_pk_bf16_f32 v207, v210, v211
    buffer_store_dwordx4 v[204:207], v16, s[56:59], s91 offen offset:0 sc1
    s_add_u32 s91, s91, 32768
    v_cvt_pk_bf16_f32 v212, v212, v213
    v_cvt_pk_bf16_f32 v213, v214, v215
    v_cvt_pk_bf16_f32 v214, v216, v217
    v_cvt_pk_bf16_f32 v215, v218, v219
    buffer_store_dwordx4 v[212:215], v16, s[56:59], s91 offen offset:0 sc1
    s_add_u32 s91, s91, 32768
    v_cvt_pk_bf16_f32 v220, v220, v221
    v_cvt_pk_bf16_f32 v221, v222, v223
    v_cvt_pk_bf16_f32 v222, v224, v225
    v_cvt_pk_bf16_f32 v223, v226, v227
    buffer_store_dwordx4 v[220:223], v16, s[56:59], s91 offen offset:0 sc1
    s_add_u32 s91, s91, 32768
    s_waitcnt vmcnt(4)
    v_readfirstlane_b32 s86, v43
    s_bfe_u32 s86, s86, 0x80000
    s_cmp_eq_u32 s86, 32
    s_cbranch_scc0 L_spA0
L_okA0:
    buffer_load_dwordx4 a[0:3], v21, s[56:59], s68 offen sc1
    buffer_load_dwordx4 a[4:7], v22, s[56:59], s68 offen sc1
    buffer_load_dwordx4 a[8:11], v23, s[56:59], s68 offen sc1
    buffer_load_dwordx4 a[12:15], v24, s[56:59], s68 offen sc1
    s_add_u32 s68, s68, 16384
    buffer_load_dwordx4 a[16:19], v21, s[56:59], s68 offen sc1
    buffer_load_dwordx4 a[20:23], v22, s[56:59], s68 offen sc1
    buffer_load_dwordx4 a[24:27], v23, s[56:59], s68 offen sc1
    buffer_load_dwordx4 a[28:31], v24, s[56:59], s68 offen sc1
    s_add_u32 s68, s68, 16384
    buffer_load_dwordx4 a[32:35], v21, s[56:59], s68 offen sc1
    buffer_load_dwordx4 a[36:39], v22, s[56:59], s68 offen sc1
    buffer_load_dwordx4 a[40:43], v23, s[56:59], s68 offen sc1
    buffer_load_dwordx4 a[44:47], v24, s[56:59], s68 offen sc1
    s_add_u32 s68, s68, 16384
    buffer_load_dwordx4 a[48:51], v21, s[56:59], s68 offen sc1
    buffer_load_dwordx4 a[52:55], v22, s[56:59], s68 offen sc1
    buffer_load_dwordx4 a[56:59], v23, s[56:59], s68 offen sc1
    buffer_load_dwordx4 a[60:63], v24, s[56:59], s68 offen sc1
    s_add_u32 s68, s68, 16384
    s_barrier
    s_branch L_D
L_stub6:
    s_branch L_stub10
L_epi1:
    s_mov_b32 s67, 0
    v_accvgpr_read_b32 v128, a128
    v_accvgpr_read_b32 v129, a129
    v_accvgpr_read_b32 v130, a130
    v_accvgpr_read_b32 v131, a131
    v_accvgpr_read_b32 v132, a132
    v_accvgpr_read_b32 v133, a133
    v_accvgpr_read_b32 v134, a134
    v_accvgpr_read_b32 v135, a135
    v_accvgpr_read_b32 v136, a136
    v_accvgpr_read_b32 v137, a137
    v_accvgpr_read_b32 v138, a138
    v_accvgpr_read_b32 v139, a139
    v_accvgpr_read_b32 v140, a140
    v_accvgpr_read_b32 v141, a141
    v_accvgpr_read_b32 v142, a142
    v_accvgpr_read_b32 v143, a143
    v_pk_mul_f32 v[34:35], v[128:129], v[128:129]
    v_pk_mul_f32 v[36:37], v[130:131], v[130:131]
    v_pk_mul_f32 v[38:39], v[132:133], v[132:133]
    v_pk_mul_f32 v[40:41], v[134:135], v[134:135]
    v_pk_fma_f32 v[34:35], v[34:35], s[94:95], v[26:27]
    v_pk_fma_f32 v[36:37], v[36:37], s[94:95], v[26:27]
    v_pk_fma_f32 v[38:39], v[38:39], s[94:95], v[26:27]
    v_pk_fma_f32 v[40:41], v[40:41], s[94:95], v[26:27]
    v_pk_mul_f32 v[34:35], v[34:35], v[128:129]
    v_pk_mul_f32 v[36:37], v[36:37], v[130:131]
    v_pk_mul_f32 v[38:39], v[38:39], v[132:133]
    v_pk_mul_f32 v[40:41], v[40:41], v[134:135]
    v_exp_f32 v34, v34
    v_exp_f32 v35, v35
    v_exp_f32 v36, v36
    v_exp_f32 v37, v37
    v_exp_f32 v38, v38
    v_exp_f32 v39, v39
    v_exp_f32 v40, v40
    v_exp_f32 v41, v41
    v_pk_mul_f32 v[136:137], v[136:137], v[128:129]
    v_pk_mul_f32 v[138:139], v[138:139], v[130:131]
    v_pk_mul_f32 v[140:141], v[140:141], v[132:133]
    v_pk_mul_f32 v[142:143], v[142:143], v[134:135]
    v_pk_add_f32 v[34:35], v[34:35], 1.0 op_sel_hi:[1,0]
    v_pk_add_f32 v[36:37], v[36:37], 1.0 op_sel_hi:[1,0]
    v_pk_add_f32 v[38:39], v[38:39], 1.0 op_sel_hi:[1,0]
    v_pk_add_f32 v[40:41], v[40:41], 1.0 op_sel_hi:[1,0]
    v_rcp_f32 v34, v34
    v_rcp_f32 v35, v35
    v_rcp_f32 v36, v36
    v_rcp_f32 v37, v37
    v_rcp_f32 v38, v38
    v_rcp_f32 v39, v39
    v_rcp_f32 v40, v40
    v_rcp_f32 v41, v41
    v_pk_mul_f32 v[136:137], v[136:137], v[34:35]
    v_pk_mul_f32 v[138:139], v[138:139], v[36:37]
    v_pk_mul_f32 v[140:141], v[140:141], v[38:39]
    v_pk_mul_f32 v[142:143], v[142:143], v[40:41]
    v_cvt_pk_bf16_f32 v128, v136, v137
    v_cvt_pk_bf16_f32 v129, v138, v139
    v_cvt_pk_bf16_f32 v130, v140, v141
    v_cvt_pk_bf16_f32 v131, v142, v143
    buffer_store_dwordx4 v[128:131], v16, s[56:59], s89 offen offset:0 sc1
    s_waitcnt vmcnt(1)
    s_mov_b64 exec, 1
    buffer_atomic_add v25, off, s[56:59], s92 sc1
    s_mov_b64 exec, -1
    v_accvgpr_read_b32 v144, a144
    v_accvgpr_read_b32 v145, a145
    v_accvgpr_read_b32 v146, a146
    v_accvgpr_read_b32 v147, a147
    v_accvgpr_read_b32 v148, a148
    v_accvgpr_read_b32 v149, a149
    v_accvgpr_read_b32 v150, a150
    v_accvgpr_read_b32 v151, a151
    v_accvgpr_read_b32 v152, a152
    v_accvgpr_read_b32 v153, a153
    v_accvgpr_read_b32 v154, a154
    v_accvgpr_read_b32 v155, a155
    v_accvgpr_read_b32 v156, a156
    v_accvgpr_read_b32 v157, a157
    v_accvgpr_read_b32 v158, a158
    v_accvgpr_read_b32 v159, a159
    v_pk_mul_f32 v[34:35], v[144:145], v[144:145]
    v_pk_mul_f32 v[36:37], v[146:147], v[146:147]
    v_pk_mul_f32 v[38:39], v[148:149], v[148:149]
    v_pk_mul_f32 v[40:41], v[150:151], v[150:151]
    v_pk_fma_f32 v[34:35], v[34:35], s[94:95], v[26:27]
    v_pk_fma_f32 v[36:37], v[36:37], s[94:95], v[26:27]
    v_pk_fma_f32 v[38:39], v[38:39], s[94:95], v[26:27]
    v_pk_fma_f32 v[40:41], v[40:41], s[94:95], v[26:27]
    v_pk_mul_f32 v[34:35], v[34:35], v[144:145]
    v_pk_mul_f32 v[36:37], v[36:37], v[146:147]
    v_pk_mul_f32 v[38:39], v[38:39], v[148:149]
    v_pk_mul_f32 v[40:41], v[40:41], v[150:151]
    v_exp_f32 v34, v34
    v_exp_f32 v35, v35
    v_exp_f32 v36, v36
    v_exp_f32 v37, v37
    v_exp_f32 v38, v38
    v_exp_f32 v39, v39
    v_exp_f32 v40, v40
    v_exp_f32 v41, v41
    v_pk_mul_f32 v[152:153], v[152:153], v[144:145]
    v_pk_mul_f32 v[154:155], v[154:155], v[146:147]
    v_pk_mul_f32 v[156:157], v[156:157], v[148:149]
    v_pk_mul_f32 v[158:159], v[158:159], v[150:151]
    v_pk_add_f32 v[34:35], v[34:35], 1.0 op_sel_hi:[1,0]
    v_pk_add_f32 v[36:37], v[36:37], 1.0 op_sel_hi:[1,0]
    v_pk_add_f32 v[38:39], v[38:39], 1.0 op_sel_hi:[1,0]
    v_pk_add_f32 v[40:41], v[40:41], 1.0 op_sel_hi:[1,0]
    v_rcp_f32 v34, v34
    v_rcp_f32 v35, v35
    v_rcp_f32 v36, v36
    v_rcp_f32 v37, v37
    v_rcp_f32 v38, v38
    v_rcp_f32 v39, v39
    v_rcp_f32 v40, v40
    v_rcp_f32 v41, v41
    v_pk_mul_f32 v[152:153], v[152:153], v[34:35]
    v_pk_mul_f32 v[154:155], v[154:155], v[36:37]
    v_pk_mul_f32 v[156:157], v[156:157], v[38:39]
    v_pk_mul_f32 v[158:159], v[158:159], v[40:41]
    v_cvt_pk_bf16_f32 v144, v152, v153
    v_cvt_pk_bf16_f32 v145, v154, v155
    v_cvt_pk_bf16_f32 v146, v156, v157
    v_cvt_pk_bf16_f32 v147, v158, v159
    buffer_store_dwordx4 v[144:147], v16, s[56:59], s89 offen offset:1024 sc1
    v_accvgpr_read_b32 v160, a160
    v_accvgpr_read_b32 v161, a161
    v_accvgpr_read_b32 v162, a162
    v_accvgpr_read_b32 v163, a163
    v_accvgpr_read_b32 v164, a164
    v_accvgpr_read_b32 v165, a165
    v_accvgpr_read_b32 v166, a166
    v_accvgpr_read_b32 v167, a167
    v_accvgpr_read_b32 v168, a168
    v_accvgpr_read_b32 v169, a169
    v_accvgpr_read_b32 v170, a170
    v_accvgpr_read_b32 v171, a171
    v_accvgpr_read_b32 v172, a172
    v_accvgpr_read_b32 v173, a173
    v_accvgpr_read_b32 v174, a174
    v_accvgpr_read_b32 v175, a175
    v_pk_mul_f32 v[34:35], v[160:161], v[160:161]
    v_pk_mul_f32 v[36:37], v[162:163], v[162:163]
    v_pk_mul_f32 v[38:39], v[164:165], v[164:165]
    v_pk_mul_f32 v[40:41], v[166:167], v[166:167]
    v_pk_fma_f32 v[34:35], v[34:35], s[94:95], v[26:27]
    v_pk_fma_f32 v[36:37], v[36:37], s[94:95], v[26:27]
    v_pk_fma_f32 v[38:39], v[38:39], s[94:95], v[26:27]
    v_pk_fma_f32 v[40:41], v[40:41], s[94:95], v[26:27]
    v_pk_mul_f32 v[34:35], v[34:35], v[160:161]
    v_pk_mul_f32 v[36:37], v[36:37], v[162:163]
    v_pk_mul_f32 v[38:39], v[38:39], v[164:165]
    v_pk_mul_f32 v[40:41], v[40:41], v[166:167]
    v_exp_f32 v34, v34
    v_exp_f32 v35, v35
    v_exp_f32 v36, v36
    v_exp_f32 v37, v37
    v_exp_f32 v38, v38
    v_exp_f32 v39, v39
    v_exp_f32 v40, v40
    v_exp_f32 v41, v41
    v_pk_mul_f32 v[168:169], v[168:169], v[160:161]
    v_pk_mul_f32 v[170:171], v[170:171], v[162:163]
    v_pk_mul_f32 v[172:173], v[172:173], v[164:165]
    v_pk_mul_f32 v[174:175], v[174:175], v[166:167]
    v_pk_add_f32 v[34:35], v[34:35], 1.0 op_sel_hi:[1,0]
    v_pk_add_f32 v[36:37], v[36:37], 1.0 op_sel_hi:[1,0]
    v_pk_add_f32 v[38:39], v[38:39], 1.0 op_sel_hi:[1,0]
    v_pk_add_f32 v[40:41], v[40:41], 1.0 op_sel_hi:[1,0]
    v_rcp_f32 v34, v34
    v_rcp_f32 v35, v35
    v_rcp_f32 v36, v36
    v_rcp_f32 v37, v37
    v_rcp_f32 v38, v38
    v_rcp_f32 v39, v39
    v_rcp_f32 v40, v40
    v_rcp_f32 v41, v41
    v_pk_mul_f32 v[168:169], v[168:169], v[34:35]
    v_pk_mul_f32 v[170:171], v[170:171], v[36:37]
    v_pk_mul_f32 v[172:173], v[172:173], v[38:39]
    v_pk_mul_f32 v[174:175], v[174:175], v[40:41]
    v_cvt_pk_bf16_f32 v160, v168, v169
    v_cvt_pk_bf16_f32 v161, v170, v171
    v_cvt_pk_bf16_f32 v162, v172, v173
    v_cvt_pk_bf16_f32 v163, v174, v175
    buffer_store_dwordx4 v[160:163], v16, s[56:59], s89 offen offset:2048 sc1
    v_accvgpr_read_b32 v176, a176
    v_accvgpr_read_b32 v177, a177
    v_accvgpr_read_b32 v178, a178
    v_accvgpr_read_b32 v179, a179
    v_accvgpr_read_b32 v180, a180
    v_accvgpr_read_b32 v181, a181
    v_accvgpr_read_b32 v182, a182
    v_accvgpr_read_b32 v183, a183
    v_accvgpr_read_b32 v184, a184
    v_accvgpr_read_b32 v185, a185
    v_accvgpr_read_b32 v186, a186
    v_accvgpr_read_b32 v187, a187
    v_accvgpr_read_b32 v188, a188
    v_accvgpr_read_b32 v189, a189
    v_accvgpr_read_b32 v190, a190
    v_accvgpr_read_b32 v191, a191
    v_pk_mul_f32 v[34:35], v[176:177], v[176:177]
    v_pk_mul_f32 v[36:37], v[178:179], v[178:179]
    v_pk_mul_f32 v[38:39], v[180:181], v[180:181]
    v_pk_mul_f32 v[40:41], v[182:183], v[182:183]
    v_pk_fma_f32 v[34:35], v[34:35], s[94:95], v[26:27]
    v_pk_fma_f32 v[36:37], v[36:37], s[94:95], v[26:27]
    v_pk_fma_f32 v[38:39], v[38:39], s[94:95], v[26:27]
    v_pk_fma_f32 v[40:41], v[40:41], s[94:95], v[26:27]
    v_pk_mul_f32 v[34:35], v[34:35], v[176:177]
    v_pk_mul_f32 v[36:37], v[36:37], v[178:179]
    v_pk_mul_f32 v[38:39], v[38:39], v[180:181]
    v_pk_mul_f32 v[40:41], v[40:41], v[182:183]
    v_exp_f32 v34, v34
    v_exp_f32 v35, v35
    v_exp_f32 v36, v36
    v_exp_f32 v37, v37
    v_exp_f32 v38, v38
    v_exp_f32 v39, v39
    v_exp_f32 v40, v40
    v_exp_f32 v41, v41
    v_pk_mul_f32 v[184:185], v[184:185], v[176:177]
    v_pk_mul_f32 v[186:187], v[186:187], v[178:179]
    v_pk_mul_f32 v[188:189], v[188:189], v[180:181]
    v_pk_mul_f32 v[190:191], v[190:191], v[182:183]
    v_pk_add_f32 v[34:35], v[34:35], 1.0 op_sel_hi:[1,0]
    v_pk_add_f32 v[36:37], v[36:37], 1.0 op_sel_hi:[1,0]
    v_pk_add_f32 v[38:39], v[38:39], 1.0 op_sel_hi:[1,0]
    v_pk_add_f32 v[40:41], v[40:41], 1.0 op_sel_hi:[1,0]
    v_rcp_f32 v34, v34
    v_rcp_f32 v35, v35
    v_rcp_f32 v36, v36
    v_rcp_f32 v37, v37
    v_rcp_f32 v38, v38
    v_rcp_f32 v39, v39
    v_rcp_f32 v40, v40
    v_rcp_f32 v41, v41
    v_pk_mul_f32 v[184:185], v[184:185], v[34:35]
    v_pk_mul_f32 v[186:187], v[186:187], v[36:37]
    v_pk_mul_f32 v[188:189], v[188:189], v[38:39]
    v_pk_mul_f32 v[190:191], v[190:191], v[40:41]
    v_cvt_pk_bf16_f32 v176, v184, v185
    v_cvt_pk_bf16_f32 v177, v186, v187
    v_cvt_pk_bf16_f32 v178, v188, v189
    v_cvt_pk_bf16_f32 v179, v190, v191
    buffer_store_dwordx4 v[176:179], v16, s[56:59], s89 offen offset:3072 sc1
    v_accvgpr_read_b32 v128, a192
    v_accvgpr_read_b32 v129, a193
    v_accvgpr_read_b32 v130, a194
    v_accvgpr_read_b32 v131, a195
    v_accvgpr_read_b32 v132, a196
    v_accvgpr_read_b32 v133, a197
    v_accvgpr_read_b32 v134, a198
    v_accvgpr_read_b32 v135, a199
    v_accvgpr_read_b32 v136, a200
    v_accvgpr_read_b32 v137, a201
    v_accvgpr_read_b32 v138, a202
    v_accvgpr_read_b32 v139, a203
    v_accvgpr_read_b32 v140, a204
    v_accvgpr_read_b32 v141, a205
    v_accvgpr_read_b32 v142, a206
    v_accvgpr_read_b32 v143, a207
    v_pk_mul_f32 v[34:35], v[128:129], v[128:129]
    v_pk_mul_f32 v[36:37], v[130:131], v[130:131]
    v_pk_mul_f32 v[38:39], v[132:133], v[132:133]
    v_pk_mul_f32 v[40:41], v[134:135], v[134:135]
    v_pk_fma_f32 v[34:35], v[34:35], s[94:95], v[26:27]
    v_pk_fma_f32 v[36:37], v[36:37], s[94:95], v[26:27]
    v_pk_fma_f32 v[38:39], v[38:39], s[94:95], v[26:27]
    v_pk_fma_f32 v[40:41], v[40:41], s[94:95], v[26:27]
    v_pk_mul_f32 v[34:35], v[34:35], v[128:129]
    v_pk_mul_f32 v[36:37], v[36:37], v[130:131]
    v_pk_mul_f32 v[38:39], v[38:39], v[132:133]
    v_pk_mul_f32 v[40:41], v[40:41], v[134:135]
    v_exp_f32 v34, v34
    v_exp_f32 v35, v35
    v_exp_f32 v36, v36
    v_exp_f32 v37, v37
    v_exp_f32 v38, v38
    v_exp_f32 v39, v39
    v_exp_f32 v40, v40
    v_exp_f32 v41, v41
    v_pk_mul_f32 v[136:137], v[136:137], v[128:129]
    v_pk_mul_f32 v[138:139], v[138:139], v[130:131]
    v_pk_mul_f32 v[140:141], v[140:141], v[132:133]
    v_pk_mul_f32 v[142:143], v[142:143], v[134:135]
    v_pk_add_f32 v[34:35], v[34:35], 1.0 op_sel_hi:[1,0]
    v_pk_add_f32 v[36:37], v[36:37], 1.0 op_sel_hi:[1,0]
    v_pk_add_f32 v[38:39], v[38:39], 1.0 op_sel_hi:[1,0]
    v_pk_add_f32 v[40:41], v[40:41], 1.0 op_sel_hi:[1,0]
    v_rcp_f32 v34, v34
    v_rcp_f32 v35, v35
    v_rcp_f32 v36, v36
    v_rcp_f32 v37, v37
    v_rcp_f32 v38, v38
    v_rcp_f32 v39, v39
    v_rcp_f32 v40, v40
    v_rcp_f32 v41, v41
    v_pk_mul_f32 v[136:137], v[136:137], v[34:35]
    v_pk_mul_f32 v[138:139], v[138:139], v[36:37]
    v_pk_mul_f32 v[140:141], v[140:141], v[38:39]
    v_pk_mul_f32 v[142:143], v[142:143], v[40:41]
    v_cvt_pk_bf16_f32 v128, v136, v137
    v_cvt_pk_bf16_f32 v129, v138, v139
    v_cvt_pk_bf16_f32 v130, v140, v141
    v_cvt_pk_bf16_f32 v131, v142, v143
    s_add_u32 s89, s89, 4096
    buffer_store_dwordx4 v[128:131], v16, s[56:59], s89 offen offset:0 sc1
    v_accvgpr_read_b32 v144, a208
    v_accvgpr_read_b32 v145, a209
    v_accvgpr_read_b32 v146, a210
    v_accvgpr_read_b32 v147, a211
    v_accvgpr_read_b32 v148, a212
    v_accvgpr_read_b32 v149, a213
    v_accvgpr_read_b32 v150, a214
    v_accvgpr_read_b32 v151, a215
    v_accvgpr_read_b32 v152, a216
    v_accvgpr_read_b32 v153, a217
    v_accvgpr_read_b32 v154, a218
    v_accvgpr_read_b32 v155, a219
    v_accvgpr_read_b32 v156, a220
    v_accvgpr_read_b32 v157, a221
    v_accvgpr_read_b32 v158, a222
    v_accvgpr_read_b32 v159, a223
    v_pk_mul_f32 v[34:35], v[144:145], v[144:145]
    v_pk_mul_f32 v[36:37], v[146:147], v[146:147]
    v_pk_mul_f32 v[38:39], v[148:149], v[148:149]
    v_pk_mul_f32 v[40:41], v[150:151], v[150:151]
    v_pk_fma_f32 v[34:35], v[34:35], s[94:95], v[26:27]
    v_pk_fma_f32 v[36:37], v[36:37], s[94:95], v[26:27]
    v_pk_fma_f32 v[38:39], v[38:39], s[94:95], v[26:27]
    v_pk_fma_f32 v[40:41], v[40:41], s[94:95], v[26:27]
    v_pk_mul_f32 v[34:35], v[34:35], v[144:145]
    v_pk_mul_f32 v[36:37], v[36:37], v[146:147]
    v_pk_mul_f32 v[38:39], v[38:39], v[148:149]
    v_pk_mul_f32 v[40:41], v[40:41], v[150:151]
    v_exp_f32 v34, v34
    v_exp_f32 v35, v35
    v_exp_f32 v36, v36
    v_exp_f32 v37, v37
    v_exp_f32 v38, v38
    v_exp_f32 v39, v39
    v_exp_f32 v40, v40
    v_exp_f32 v41, v41
    v_pk_mul_f32 v[152:153], v[152:153], v[144:145]
    v_pk_mul_f32 v[154:155], v[154:155], v[146:147]
    v_pk_mul_f32 v[156:157], v[156:157], v[148:149]
    v_pk_mul_f32 v[158:159], v[158:159], v[150:151]
    v_pk_add_f32 v[34:35], v[34:35], 1.0 op_sel_hi:[1,0]
    v_pk_add_f32 v[36:37], v[36:37], 1.0 op_sel_hi:[1,0]
    v_pk_add_f32 v[38:39], v[38:39], 1.0 op_sel_hi:[1,0]
    v_pk_add_f32 v[40:41], v[40:41], 1.0 op_sel_hi:[1,0]
    v_rcp_f32 v34, v34
    v_rcp_f32 v35, v35
    v_rcp_f32 v36, v36
    v_rcp_f32 v37, v37
    v_rcp_f32 v38, v38
    v_rcp_f32 v39, v39
    v_rcp_f32 v40, v40
    v_rcp_f32 v41, v41
    v_pk_mul_f32 v[152:153], v[152:153], v[34:35]
    v_pk_mul_f32 v[154:155], v[154:155], v[36:37]
    v_pk_mul_f32 v[156:157], v[156:157], v[38:39]
    v_pk_mul_f32 v[158:159], v[158:159], v[40:41]
    v_cvt_pk_bf16_f32 v144, v152, v153
    v_cvt_pk_bf16_f32 v145, v154, v155
    v_cvt_pk_bf16_f32 v146, v156, v157
    v_cvt_pk_bf16_f32 v147, v158, v159
    buffer_store_dwordx4 v[144:147], v16, s[56:59], s89 offen offset:1024 sc1
    v_accvgpr_read_b32 v160, a224
    v_accvgpr_read_b32 v161, a225
    v_accvgpr_read_b32 v162, a226
    v_accvgpr_read_b32 v163, a227
    v_accvgpr_read_b32 v164, a228
    v_accvgpr_read_b32 v165, a229
    v_accvgpr_read_b32 v166, a230
    v_accvgpr_read_b32 v167, a231
    v_accvgpr_read_b32 v168, a232
    v_accvgpr_read_b32 v169, a233
    v_accvgpr_read_b32 v170, a234
    v_accvgpr_read_b32 v171, a235
    v_accvgpr_read_b32 v172, a236
    v_accvgpr_read_b32 v173, a237
    v_accvgpr_read_b32 v174, a238
    v_accvgpr_read_b32 v175, a239
    v_pk_mul_f32 v[34:35], v[160:161], v[160:161]
    v_pk_mul_f32 v[36:37], v[162:163], v[162:163]
    v_pk_mul_f32 v[38:39], v[164:165], v[164:165]
    v_pk_mul_f32 v[40:41], v[166:167], v[166:167]
    v_pk_fma_f32 v[34:35], v[34:35], s[94:95], v[26:27]
    v_pk_fma_f32 v[36:37], v[36:37], s[94:95], v[26:27]
    v_pk_fma_f32 v[38:39], v[38:39], s[94:95], v[26:27]
    v_pk_fma_f32 v[40:41], v[40:41], s[94:95], v[26:27]
    v_pk_mul_f32 v[34:35], v[34:35], v[160:161]
    v_pk_mul_f32 v[36:37], v[36:37], v[162:163]
    v_pk_mul_f32 v[38:39], v[38:39], v[164:165]
    v_pk_mul_f32 v[40:41], v[40:41], v[166:167]
    s_branch L_over7
L_stub7:
    s_branch L_stub11
L_over7:
    v_exp_f32 v34, v34
    v_exp_f32 v35, v35
    v_exp_f32 v36, v36
    v_exp_f32 v37, v37
    v_exp_f32 v38, v38
    v_exp_f32 v39, v39
    v_exp_f32 v40, v40
    v_exp_f32 v41, v41
    v_pk_mul_f32 v[168:169], v[168:169], v[160:161]
    v_pk_mul_f32 v[170:171], v[170:171], v[162:163]
    v_pk_mul_f32 v[172:173], v[172:173], v[164:165]
    v_pk_mul_f32 v[174:175], v[174:175], v[166:167]
    v_pk_add_f32 v[34:35], v[34:35], 1.0 op_sel_hi:[1,0]
    v_pk_add_f32 v[36:37], v[36:37], 1.0 op_sel_hi:[1,0]
    v_pk_add_f32 v[38:39], v[38:39], 1.0 op_sel_hi:[1,0]
    v_pk_add_f32 v[40:41], v[40:41], 1.0 op_sel_hi:[1,0]
    v_rcp_f32 v34, v34
    v_rcp_f32 v35, v35
    v_rcp_f32 v36, v36
    v_rcp_f32 v37, v37
    v_rcp_f32 v38, v38
    v_rcp_f32 v39, v39
    v_rcp_f32 v40, v40
    v_rcp_f32 v41, v41
    v_pk_mul_f32 v[168:169], v[168:169], v[34:35]
    v_pk_mul_f32 v[170:171], v[170:171], v[36:37]
    v_pk_mul_f32 v[172:173], v[172:173], v[38:39]
    v_pk_mul_f32 v[174:175], v[174:175], v[40:41]
    v_cvt_pk_bf16_f32 v160, v168, v169
    v_cvt_pk_bf16_f32 v161, v170, v171
    v_cvt_pk_bf16_f32 v162, v172, v173
    v_cvt_pk_bf16_f32 v163, v174, v175
    buffer_store_dwordx4 v[160:163], v16, s[56:59], s89 offen offset:2048 sc1
    buffer_load_dword v43, off, s[56:59], s92 sc1
    v_accvgpr_read_b32 v176, a240
    v_accvgpr_read_b32 v177, a241
    v_accvgpr_read_b32 v178, a242
    v_accvgpr_read_b32 v179, a243
    v_accvgpr_read_b32 v180, a244
    v_accvgpr_read_b32 v181, a245
    v_accvgpr_read_b32 v182, a246
    v_accvgpr_read_b32 v183, a247
    v_accvgpr_read_b32 v184, a248
    v_accvgpr_read_b32 v185, a249
    v_accvgpr_read_b32 v186, a250
    v_accvgpr_read_b32 v187, a251
    v_accvgpr_read_b32 v188, a252
    v_accvgpr_read_b32 v189, a253
    v_accvgpr_read_b32 v190, a254
    v_accvgpr_read_b32 v191, a255
    v_pk_mul_f32 v[34:35], v[176:177], v[176:177]
    v_pk_mul_f32 v[36:37], v[178:179], v[178:179]
    v_pk_mul_f32 v[38:39], v[180:181], v[180:181]
    v_pk_mul_f32 v[40:41], v[182:183], v[182:183]
    v_pk_fma_f32 v[34:35], v[34:35], s[94:95], v[26:27]
    v_pk_fma_f32 v[36:37], v[36:37], s[94:95], v[26:27]
    v_pk_fma_f32 v[38:39], v[38:39], s[94:95], v[26:27]
    v_pk_fma_f32 v[40:41], v[40:41], s[94:95], v[26:27]
    v_pk_mul_f32 v[34:35], v[34:35], v[176:177]
    v_pk_mul_f32 v[36:37], v[36:37], v[178:179]
    v_pk_mul_f32 v[38:39], v[38:39], v[180:181]
    v_pk_mul_f32 v[40:41], v[40:41], v[182:183]
    v_exp_f32 v34, v34
    v_exp_f32 v35, v35
    v_exp_f32 v36, v36
    v_exp_f32 v37, v37
    v_exp_f32 v38, v38
    v_exp_f32 v39, v39
    v_exp_f32 v40, v40
    v_exp_f32 v41, v41
    v_pk_mul_f32 v[184:185], v[184:185], v[176:177]
    v_pk_mul_f32 v[186:187], v[186:187], v[178:179]
    v_pk_mul_f32 v[188:189], v[188:189], v[180:181]
    v_pk_mul_f32 v[190:191], v[190:191], v[182:183]
    v_pk_add_f32 v[34:35], v[34:35], 1.0 op_sel_hi:[1,0]
    v_pk_add_f32 v[36:37], v[36:37], 1.0 op_sel_hi:[1,0]
    v_pk_add_f32 v[38:39], v[38:39], 1.0 op_sel_hi:[1,0]
    v_pk_add_f32 v[40:41], v[40:41], 1.0 op_sel_hi:[1,0]
    v_rcp_f32 v34, v34
    v_rcp_f32 v35, v35
    v_rcp_f32 v36, v36
    v_rcp_f32 v37, v37
    v_rcp_f32 v38, v38
    v_rcp_f32 v39, v39
    v_rcp_f32 v40, v40
    v_rcp_f32 v41, v41
    v_pk_mul_f32 v[184:185], v[184:185], v[34:35]
    v_pk_mul_f32 v[186:187], v[186:187], v[36:37]
    v_pk_mul_f32 v[188:189], v[188:189], v[38:39]
    v_pk_mul_f32 v[190:191], v[190:191], v[40:41]
    v_cvt_pk_bf16_f32 v176, v184, v185
    v_cvt_pk_bf16_f32 v177, v186, v187
    v_cvt_pk_bf16_f32 v178, v188, v189
    v_cvt_pk_bf16_f32 v179, v190, v191
    buffer_store_dwordx4 v[176:179], v16, s[56:59], s89 offen offset:3072 sc1
    s_waitcnt vmcnt(1)
    v_readfirstlane_b32 s86, v43
    s_bfe_u32 s86, s86, 0x80000
    s_cmp_eq_u32 s86, 32
    s_cbranch_scc0 L_spA1
L_okA1:
    v_pk_mul_f32 v[34:35], v[48:49], v[48:49]
    buffer_load_dwordx4 a[0:3], v21, s[56:59], s68 offen sc1
    v_pk_mul_f32 v[36:37], v[50:51], v[50:51]
    v_pk_mul_f32 v[38:39], v[52:53], v[52:53]
    v_pk_mul_f32 v[40:41], v[54:55], v[54:55]
    v_pk_fma_f32 v[34:35], v[34:35], s[94:95], v[26:27]
    v_pk_fma_f32 v[36:37], v[36:37], s[94:95], v[26:27]
    v_pk_fma_f32 v[38:39], v[38:39], s[94:95], v[26:27]
    v_pk_fma_f32 v[40:41], v[40:41], s[94:95], v[26:27]
    v_pk_mul_f32 v[34:35], v[34:35], v[48:49]
    buffer_load_dwordx4 a[4:7], v22, s[56:59], s68 offen sc1
    v_pk_mul_f32 v[36:37], v[36:37], v[50:51]
    v_pk_mul_f32 v[38:39], v[38:39], v[52:53]
    v_pk_mul_f32 v[40:41], v[40:41], v[54:55]
    v_exp_f32 v34, v34
    v_exp_f32 v35, v35
    v_exp_f32 v36, v36
    v_exp_f32 v37, v37
    v_exp_f32 v38, v38
    buffer_load_dwordx4 a[8:11], v23, s[56:59], s68 offen sc1
    v_exp_f32 v39, v39
    v_exp_f32 v40, v40
    v_exp_f32 v41, v41
    v_pk_mul_f32 v[56:57], v[56:57], v[48:49]
    v_pk_mul_f32 v[58:59], v[58:59], v[50:51]
    v_pk_mul_f32 v[60:61], v[60:61], v[52:53]
    v_pk_mul_f32 v[62:63], v[62:63], v[54:55]
    v_pk_add_f32 v[34:35], v[34:35], 1.0 op_sel_hi:[1,0]
    buffer_load_dwordx4 a[12:15], v24, s[56:59], s68 offen sc1
    v_pk_add_f32 v[36:37], v[36:37], 1.0 op_sel_hi:[1,0]
    v_pk_add_f32 v[38:39], v[38:39], 1.0 op_sel_hi:[1,0]
    v_pk_add_f32 v[40:41], v[40:41], 1.0 op_sel_hi:[1,0]
    v_rcp_f32 v34, v34
    v_rcp_f32 v35, v35
    v_rcp_f32 v36, v36
    v_rcp_f32 v37, v37
    v_rcp_f32 v38, v38
    s_add_u32 s68, s68, 16384
    v_rcp_f32 v39, v39
    v_rcp_f32 v40, v40
    v_rcp_f32 v41, v41
    v_pk_mul_f32 v[56:57], v[56:57], v[34:35]
    v_pk_mul_f32 v[58:59], v[58:59], v[36:37]
    v_pk_mul_f32 v[60:61], v[60:61], v[38:39]
    v_pk_mul_f32 v[62:63], v[62:63], v[40:41]
    v_cvt_pk_bf16_f32 v48, v56, v57
    v_cvt_pk_bf16_f32 v49, v58, v59
    v_cvt_pk_bf16_f32 v50, v60, v61
    v_cvt_pk_bf16_f32 v51, v62, v63
    s_nop 0
    v_permlane16_swap_b32 v48, v50
    v_permlane16_swap_b32 v49, v51
    buffer_store_dwordx4 v[48:51], v28, s[56:59], s90 offen offset:0 sc1
    v_pk_mul_f32 v[34:35], v[64:65], v[64:65]
    buffer_load_dwordx4 a[16:19], v21, s[56:59], s68 offen sc1
    v_pk_mul_f32 v[36:37], v[66:67], v[66:67]
    v_pk_mul_f32 v[38:39], v[68:69], v[68:69]
    v_pk_mul_f32 v[40:41], v[70:71], v[70:71]
    v_pk_fma_f32 v[34:35], v[34:35], s[94:95], v[26:27]
    v_pk_fma_f32 v[36:37], v[36:37], s[94:95], v[26:27]
    v_pk_fma_f32 v[38:39], v[38:39], s[94:95], v[26:27]
    v_pk_fma_f32 v[40:41], v[40:41], s[94:95], v[26:27]
    v_pk_mul_f32 v[34:35], v[34:35], v[64:65]
    buffer_load_dwordx4 a[20:23], v22, s[56:59], s68 offen sc1
    v_pk_mul_f32 v[36:37], v[36:37], v[66:67]
    v_pk_mul_f32 v[38:39], v[38:39], v[68:69]
    v_pk_mul_f32 v[40:41], v[40:41], v[70:71]
    v_exp_f32 v34, v34
    v_exp_f32 v35, v35
    v_exp_f32 v36, v36
    v_exp_f32 v37, v37
    v_exp_f32 v38, v38
    buffer_load_dwordx4 a[24:27], v23, s[56:59], s68 offen sc1
    v_exp_f32 v39, v39
    v_exp_f32 v40, v40
    v_exp_f32 v41, v41
    v_pk_mul_f32 v[72:73], v[72:73], v[64:65]
    v_pk_mul_f32 v[74:75], v[74:75], v[66:67]
    v_pk_mul_f32 v[76:77], v[76:77], v[68:69]
    v_pk_mul_f32 v[78:79], v[78:79], v[70:71]
    v_pk_add_f32 v[34:35], v[34:35], 1.0 op_sel_hi:[1,0]
    buffer_load_dwordx4 a[28:31], v24, s[56:59], s68 offen sc1
    v_pk_add_f32 v[36:37], v[36:37], 1.0 op_sel_hi:[1,0]
    v_pk_add_f32 v[38:39], v[38:39], 1.0 op_sel_hi:[1,0]
    v_pk_add_f32 v[40:41], v[40:41], 1.0 op_sel_hi:[1,0]
    v_rcp_f32 v34, v34
    v_rcp_f32 v35, v35
    v_rcp_f32 v36, v36
    v_rcp_f32 v37, v37
    v_rcp_f32 v38, v38
    s_add_u32 s68, s68, 16384
    v_rcp_f32 v39, v39
    v_rcp_f32 v40, v40
    v_rcp_f32 v41, v41
    v_pk_mul_f32 v[72:73], v[72:73], v[34:35]
    v_pk_mul_f32 v[74:75], v[74:75], v[36:37]
    v_pk_mul_f32 v[76:77], v[76:77], v[38:39]
    v_pk_mul_f32 v[78:79], v[78:79], v[40:41]
    v_cvt_pk_bf16_f32 v64, v72, v73
    v_cvt_pk_bf16_f32 v65, v74, v75
    v_cvt_pk_bf16_f32 v66, v76, v77
    v_cvt_pk_bf16_f32 v67, v78, v79
    s_nop 0
    v_permlane16_swap_b32 v64, v66
    v_permlane16_swap_b32 v65, v67
    buffer_store_dwordx4 v[64:67], v28, s[56:59], s90 offen offset:2048 sc1
    s_waitcnt vmcnt(10)
    s_mov_b64 exec, 1
    buffer_atomic_add v29, off, s[56:59], s92 sc1
    s_mov_b64 exec, -1
    v_pk_mul_f32 v[34:35], v[80:81], v[80:81]
    buffer_load_dwordx4 a[32:35], v21, s[56:59], s68 offen sc1
    v_pk_mul_f32 v[36:37], v[82:83], v[82:83]
    v_pk_mul_f32 v[38:39], v[84:85], v[84:85]
    v_pk_mul_f32 v[40:41], v[86:87], v[86:87]
    v_pk_fma_f32 v[34:35], v[34:35], s[94:95], v[26:27]
    v_pk_fma_f32 v[36:37], v[36:37], s[94:95], v[26:27]
    v_pk_fma_f32 v[38:39], v[38:39], s[94:95], v[26:27]
    v_pk_fma_f32 v[40:41], v[40:41], s[94:95], v[26:27]
    v_pk_mul_f32 v[34:35], v[34:35], v[80:81]
    buffer_load_dwordx4 a[36:39], v22, s[56:59], s68 offen sc1
    v_pk_mul_f32 v[36:37], v[36:37], v[82:83]
    v_pk_mul_f32 v[38:39], v[38:39], v[84:85]
    v_pk_mul_f32 v[40:41], v[40:41], v[86:87]
    v_exp_f32 v34, v34
    v_exp_f32 v35, v35
    v_exp_f32 v36, v36
    v_exp_f32 v37, v37
    v_exp_f32 v38, v38
    buffer_load_dwordx4 a[40:43], v23, s[56:59], s68 offen sc1
    v_exp_f32 v39, v39
    v_exp_f32 v40, v40
    v_exp_f32 v41, v41
    v_pk_mul_f32 v[88:89], v[88:89], v[80:81]
    v_pk_mul_f32 v[90:91], v[90:91], v[82:83]
    v_pk_mul_f32 v[92:93], v[92:93], v[84:85]
    v_pk_mul_f32 v[94:95], v[94:95], v[86:87]
    v_pk_add_f32 v[34:35], v[34:35], 1.0 op_sel_hi:[1,0]
    buffer_load_dwordx4 a[44:47], v24, s[56:59], s68 offen sc1
    v_pk_add_f32 v[36:37], v[36:37], 1.0 op_sel_hi:[1,0]
    v_pk_add_f32 v[38:39], v[38:39], 1.0 op_sel_hi:[1,0]
    v_pk_add_f32 v[40:41], v[40:41], 1.0 op_sel_hi:[1,0]
    v_rcp_f32 v34, v34
    v_rcp_f32 v35, v35
    v_rcp_f32 v36, v36
    v_rcp_f32 v37, v37
    v_rcp_f32 v38, v38
    s_add_u32 s68, s68, 16384
    v_rcp_f32 v39, v39
    v_rcp_f32 v40, v40
    v_rcp_f32 v41, v41
    v_pk_mul_f32 v[88:89], v[88:89], v[34:35]
    v_pk_mul_f32 v[90:91], v[90:91], v[36:37]
    v_pk_mul_f32 v[92:93], v[92:93], v[38:39]
    v_pk_mul_f32 v[94:95], v[94:95], v[40:41]
    v_cvt_pk_bf16_f32 v80, v88, v89
    v_cvt_pk_bf16_f32 v81, v90, v91
    v_cvt_pk_bf16_f32 v82, v92, v93
    v_cvt_pk_bf16_f32 v83, v94, v95
    s_nop 0
    v_permlane16_swap_b32 v80, v82
    v_permlane16_swap_b32 v81, v83
    s_add_u32 s90, s90, 4096
    buffer_store_dwordx4 v[80:83], v28, s[56:59], s90 offen offset:0 sc1
    v_pk_mul_f32 v[34:35], v[96:97], v[96:97]
    buffer_load_dwordx4 a[48:51], v21, s[56:59], s68 offen sc1
    v_pk_mul_f32 v[36:37], v[98:99], v[98:99]
    v_pk_mul_f32 v[38:39], v[100:101], v[100:101]
    v_pk_mul_f32 v[40:41], v[102:103], v[102:103]
    v_pk_fma_f32 v[34:35], v[34:35], s[94:95], v[26:27]
    v_pk_fma_f32 v[36:37], v[36:37], s[94:95], v[26:27]
    v_pk_fma_f32 v[38:39], v[38:39], s[94:95], v[26:27]
    v_pk_fma_f32 v[40:41], v[40:41], s[94:95], v[26:27]
    v_pk_mul_f32 v[34:35], v[34:35], v[96:97]
    buffer_load_dwordx4 a[52:55], v22, s[56:59], s68 offen sc1
    v_pk_mul_f32 v[36:37], v[36:37], v[98:99]
    v_pk_mul_f32 v[38:39], v[38:39], v[100:101]
    v_pk_mul_f32 v[40:41], v[40:41], v[102:103]
    v_exp_f32 v34, v34
    v_exp_f32 v35, v35
    v_exp_f32 v36, v36
    v_exp_f32 v37, v37
    v_exp_f32 v38, v38
    buffer_load_dwordx4 a[56:59], v23, s[56:59], s68 offen sc1
    v_exp_f32 v39, v39
    v_exp_f32 v40, v40
    v_exp_f32 v41, v41
    v_pk_mul_f32 v[104:105], v[104:105], v[96:97]
    v_pk_mul_f32 v[106:107], v[106:107], v[98:99]
    v_pk_mul_f32 v[108:109], v[108:109], v[100:101]
    v_pk_mul_f32 v[110:111], v[110:111], v[102:103]
    v_pk_add_f32 v[34:35], v[34:35], 1.0 op_sel_hi:[1,0]
    buffer_load_dwordx4 a[60:63], v24, s[56:59], s68 offen sc1
    v_pk_add_f32 v[36:37], v[36:37], 1.0 op_sel_hi:[1,0]
    v_pk_add_f32 v[38:39], v[38:39], 1.0 op_sel_hi:[1,0]
    v_pk_add_f32 v[40:41], v[40:41], 1.0 op_sel_hi:[1,0]
    v_rcp_f32 v34, v34
    v_rcp_f32 v35, v35
    v_rcp_f32 v36, v36
    v_rcp_f32 v37, v37
    v_rcp_f32 v38, v38
    s_add_u32 s68, s68, 16384
    v_rcp_f32 v39, v39
    v_rcp_f32 v40, v40
    v_rcp_f32 v41, v41
    v_pk_mul_f32 v[104:105], v[104:105], v[34:35]
    v_pk_mul_f32 v[106:107], v[106:107], v[36:37]
    v_pk_mul_f32 v[108:109], v[108:109], v[38:39]
    v_pk_mul_f32 v[110:111], v[110:111], v[40:41]
    v_cvt_pk_bf16_f32 v96, v104, v105
    v_cvt_pk_bf16_f32 v97, v106, v107
    v_cvt_pk_bf16_f32 v98, v108, v109
    v_cvt_pk_bf16_f32 v99, v110, v111
    s_nop 0
    v_permlane16_swap_b32 v96, v98
    v_permlane16_swap_b32 v97, v99
    buffer_store_dwordx4 v[96:99], v28, s[56:59], s90 offen offset:2048 sc1
    s_barrier
L_D:
    ds_read_b64_tr_b16 a[128:129], v8 offset:0
    ds_read_b64_tr_b16 a[130:131], v8 offset:4096
    ds_read_b64_tr_b16 a[132:133], v9 offset:0
    ds_read_b64_tr_b16 a[134:135], v9 offset:4096
    ds_read_b64_tr_b16 a[136:137], v10 offset:0
    ds_read_b64_tr_b16 a[138:139], v10 offset:4096
    ds_read_b64_tr_b16 a[140:141], v11 offset:0
    ds_read_b64_tr_b16 a[142:143], v11 offset:4096
    ds_read_b64_tr_b16 a[144:145], v12 offset:0
    ds_read_b64_tr_b16 a[146:147], v12 offset:4096
    ds_read_b64_tr_b16 a[148:149], v13 offset:0
    ds_read_b64_tr_b16 a[150:151], v13 offset:4096
    ds_read_b64_tr_b16 a[152:153], v14 offset:0
    ds_read_b64_tr_b16 a[154:155], v14 offset:4096
    ds_read_b64_tr_b16 a[156:157], v15 offset:0
    ds_read_b64_tr_b16 a[158:159], v15 offset:4096
    s_waitcnt vmcnt(15) lgkmcnt(14)
    v_mfma_f32_16x16x32_bf16 v[128:131], a[128:131], a[0:3], 0
    buffer_load_dwordx4 a[64:67], v21, s[56:59], s68 offen sc1
    s_waitcnt vmcnt(15)
    v_mfma_f32_16x16x32_bf16 v[160:163], a[128:131], a[4:7], 0
    ds_read_b64_tr_b16 a[160:161], v8 offset:8192
    s_waitcnt vmcnt(14)
    v_mfma_f32_16x16x32_bf16 v[192:195], a[128:131], a[8:11], 0
    ds_read_b64_tr_b16 a[162:163], v8 offset:12288
    s_waitcnt vmcnt(13)
    v_mfma_f32_16x16x32_bf16 v[224:227], a[128:131], a[12:15], 0
    buffer_load_dwordx4 a[68:71], v22, s[56:59], s68 offen sc1
    s_waitcnt lgkmcnt(14)
    v_mfma_f32_16x16x32_bf16 v[132:135], a[132:135], a[0:3], 0
    ds_read_b64_tr_b16 a[164:165], v9 offset:8192
    v_mfma_f32_16x16x32_bf16 v[164:167], a[132:135], a[4:7], 0
    ds_read_b64_tr_b16 a[166:167], v9 offset:12288
    v_mfma_f32_16x16x32_bf16 v[196:199], a[132:135], a[8:11], 0
    buffer_load_dwordx4 a[72:75], v23, s[56:59], s68 offen sc1
    v_mfma_f32_16x16x32_bf16 v[228:231], a[132:135], a[12:15], 0
    ds_read_b64_tr_b16 a[168:169], v10 offset:8192
    s_waitcnt lgkmcnt(15)
    v_mfma_f32_16x16x32_bf16 v[136:139], a[136:139], a[0:3], 0
    ds_read_b64_tr_b16 a[170:171], v10 offset:12288
    v_mfma_f32_16x16x32_bf16 v[168:171], a[136:139], a[4:7], 0
    buffer_load_dwordx4 a[76:79], v24, s[56:59], s68 offen sc1
    v_mfma_f32_16x16x32_bf16 v[200:203], a[136:139], a[8:11], 0
    ds_read_b64_tr_b16 a[172:173], v11 offset:8192
    v_mfma_f32_16x16x32_bf16 v[232:235], a[136:139], a[12:15], 0
    ds_read_b64_tr_b16 a[174:175], v11 offset:12288
    s_waitcnt lgkmcnt(15)
    v_mfma_f32_16x16x32_bf16 v[140:143], a[140:143], a[0:3], 0
    s_add_u32 s68, s68, 16384
    v_mfma_f32_16x16x32_bf16 v[172:175], a[140:143], a[4:7], 0
    ds_read_b64_tr_b16 a[176:177], v12 offset:8192
    v_mfma_f32_16x16x32_bf16 v[204:207], a[140:143], a[8:11], 0
    ds_read_b64_tr_b16 a[178:179], v12 offset:12288
    v_mfma_f32_16x16x32_bf16 v[236:239], a[140:143], a[12:15], 0
    buffer_load_dwordx4 a[80:83], v21, s[56:59], s68 offen sc1
    s_waitcnt lgkmcnt(15)
    v_mfma_f32_16x16x32_bf16 v[144:147], a[144:147], a[0:3], 0
    ds_read_b64_tr_b16 a[180:181], v13 offset:8192
    v_mfma_f32_16x16x32_bf16 v[176:179], a[144:147], a[4:7], 0
    ds_read_b64_tr_b16 a[182:183], v13 offset:12288
    v_mfma_f32_16x16x32_bf16 v[208:211], a[144:147], a[8:11], 0
    buffer_load_dwordx4 a[84:87], v22, s[56:59], s68 offen sc1
    v_mfma_f32_16x16x32_bf16 v[240:243], a[144:147], a[12:15], 0
    ds_read_b64_tr_b16 a[184:185], v14 offset:8192
    s_waitcnt lgkmcnt(15)
    v_mfma_f32_16x16x32_bf16 v[148:151], a[148:151], a[0:3], 0
    ds_read_b64_tr_b16 a[186:187], v14 offset:12288
    s_waitcnt vmcnt(6)
    s_mov_b64 exec, 1
    buffer_atomic_add v42, off, s[56:59], s93 sc1
    s_mov_b64 exec, -1
    v_mfma_f32_16x16x32_bf16 v[180:183], a[148:151], a[4:7], 0
    buffer_load_dwordx4 a[88:91], v23, s[56:59], s68 offen sc1
    v_mfma_f32_16x16x32_bf16 v[212:215], a[148:151], a[8:11], 0
    ds_read_b64_tr_b16 a[188:189], v15 offset:8192
    v_mfma_f32_16x16x32_bf16 v[244:247], a[148:151], a[12:15], 0
    ds_read_b64_tr_b16 a[190:191], v15 offset:12288
    v_mfma_f32_16x16x32_bf16 v[152:155], a[152:155], a[0:3], 0
    v_mfma_f32_16x16x32_bf16 v[184:187], a[152:155], a[4:7], 0
    v_mfma_f32_16x16x32_bf16 v[216:219], a[152:155], a[8:11], 0
    v_mfma_f32_16x16x32_bf16 v[248:251], a[152:155], a[12:15], 0
    s_waitcnt lgkmcnt(15)
    v_mfma_f32_16x16x32_bf16 v[156:159], a[156:159], a[0:3], 0
    v_mfma_f32_16x16x32_bf16 v[188:191], a[156:159], a[4:7], 0
    v_mfma_f32_16x16x32_bf16 v[220:223], a[156:159], a[8:11], 0
    v_mfma_f32_16x16x32_bf16 v[252:255], a[156:159], a[12:15], 0
    s_waitcnt lgkmcnt(14)
    v_mfma_f32_16x16x32_bf16 v[128:131], a[160:163], a[16:19], v[128:131]
    buffer_load_dwordx4 a[92:95], v24, s[56:59], s68 offen sc1
    v_mfma_f32_16x16x32_bf16 v[160:163], a[160:163], a[20:23], v[160:163]
    ds_read_b64_tr_b16 a[128:129], v8 offset:16384
    v_mfma_f32_16x16x32_bf16 v[192:195], a[160:163], a[24:27], v[192:195]
    ds_read_b64_tr_b16 a[130:131], v8 offset:20480
    v_add_u32 v48, 0x10000, v8
    v_mfma_f32_16x16x32_bf16 v[224:227], a[160:163], a[28:31], v[224:227]
    s_add_u32 s68, s68, 16384
    v_add_u32 v56, 0x20000, v8
    s_waitcnt lgkmcnt(14)
    v_mfma_f32_16x16x32_bf16 v[132:135], a[164:167], a[16:19], v[132:135]
    ds_read_b64_tr_b16 a[132:133], v9 offset:16384
    v_add_u32 v49, 0x10000, v9
    v_mfma_f32_16x16x32_bf16 v[164:167], a[164:167], a[20:23], v[164:167]
    ds_read_b64_tr_b16 a[134:135], v9 offset:20480
    v_add_u32 v57, 0x20000, v9
    v_mfma_f32_16x16x32_bf16 v[196:199], a[164:167], a[24:27], v[196:199]
    buffer_load_dwordx4 a[96:99], v21, s[56:59], s68 offen sc1
    v_add_u32 v50, 0x10000, v10
    v_mfma_f32_16x16x32_bf16 v[228:231], a[164:167], a[28:31], v[228:231]
    ds_read_b64_tr_b16 a[136:137], v10 offset:16384
    v_add_u32 v58, 0x20000, v10
    s_waitcnt lgkmcnt(15)
    v_mfma_f32_16x16x32_bf16 v[136:139], a[168:171], a[16:19], v[136:139]
    ds_read_b64_tr_b16 a[138:139], v10 offset:20480
    v_add_u32 v51, 0x10000, v11
    v_mfma_f32_16x16x32_bf16 v[168:171], a[168:171], a[20:23], v[168:171]
    buffer_load_dwordx4 a[100:103], v22, s[56:59], s68 offen sc1
    v_add_u32 v59, 0x20000, v11
    v_mfma_f32_16x16x32_bf16 v[200:203], a[168:171], a[24:27], v[200:203]
    ds_read_b64_tr_b16 a[140:141], v11 offset:16384
    v_add_u32 v52, 0x10000, v12
    v_mfma_f32_16x16x32_bf16 v[232:235], a[168:171], a[28:31], v[232:235]
    ds_read_b64_tr_b16 a[142:143], v11 offset:20480
    v_add_u32 v60, 0x20000, v12
    s_waitcnt lgkmcnt(15)
    v_mfma_f32_16x16x32_bf16 v[140:143], a[172:175], a[16:19], v[140:143]
    buffer_load_dwordx4 a[104:107], v23, s[56:59], s68 offen sc1
    v_add_u32 v53, 0x10000, v13
    v_mfma_f32_16x16x32_bf16 v[172:175], a[172:175], a[20:23], v[172:175]
    ds_read_b64_tr_b16 a[144:145], v12 offset:16384
    v_add_u32 v61, 0x20000, v13
    v_mfma_f32_16x16x32_bf16 v[204:207], a[172:175], a[24:27], v[204:207]
    ds_read_b64_tr_b16 a[146:147], v12 offset:20480
    v_add_u32 v54, 0x10000, v14
    v_mfma_f32_16x16x32_bf16 v[236:239], a[172:175], a[28:31], v[236:239]
    buffer_load_dwordx4 a[108:111], v24, s[56:59], s68 offen sc1
    v_add_u32 v62, 0x20000, v14
    s_waitcnt lgkmcnt(15)
    v_mfma_f32_16x16x32_bf16 v[144:147], a[176:179], a[16:19], v[144:147]
    ds_read_b64_tr_b16 a[148:149], v13 offset:16384
    v_add_u32 v55, 0x10000, v15
    v_mfma_f32_16x16x32_bf16 v[176:179], a[176:179], a[20:23], v[176:179]
    ds_read_b64_tr_b16 a[150:151], v13 offset:20480
    v_add_u32 v63, 0x20000, v15
    v_mfma_f32_16x16x32_bf16 v[208:211], a[176:179], a[24:27], v[208:211]
    s_add_u32 s68, s68, 16384
    s_lshl_b32 s84, s63, 2
    v_mfma_f32_16x16x32_bf16 v[240:243], a[176:179], a[28:31], v[240:243]
    ds_read_b64_tr_b16 a[152:153], v14 offset:16384
    s_add_u32 s84, s84, s60
    s_waitcnt lgkmcnt(15)
    v_mfma_f32_16x16x32_bf16 v[148:151], a[180:183], a[16:19], v[148:151]
    ds_read_b64_tr_b16 a[154:155], v14 offset:20480
    s_lshl_b32 s84, s84, 2
    v_mfma_f32_16x16x32_bf16 v[180:183], a[180:183], a[20:23], v[180:183]
    buffer_load_dwordx4 a[112:115], v21, s[56:59], s68 offen sc1
    s_add_u32 s84, s84, s65
    v_mfma_f32_16x16x32_bf16 v[212:215], a[180:183], a[24:27], v[212:215]
    ds_read_b64_tr_b16 a[156:157], v15 offset:16384
    s_lshl_b32 s84, s84, 15
    v_mfma_f32_16x16x32_bf16 v[244:247], a[180:183], a[28:31], v[244:247]
    ds_read_b64_tr_b16 a[158:159], v15 offset:20480
    s_lshl_b32 s85, s66, 8
    v_mfma_f32_16x16x32_bf16 v[152:155], a[184:187], a[16:19], v[152:155]
    buffer_load_dwordx4 a[116:119], v22, s[56:59], s68 offen sc1
    s_add_u32 s84, s84, s85
    v_mfma_f32_16x16x32_bf16 v[184:187], a[184:187], a[20:23], v[184:187]
    v_and_b32 v34, 15, v0
    v_mfma_f32_16x16x32_bf16 v[216:219], a[184:187], a[24:27], v[216:219]
    v_lshrrev_b32 v35, 4, v0
    v_mfma_f32_16x16x32_bf16 v[248:251], a[184:187], a[28:31], v[248:251]
    v_lshlrev_b32 v36, 11, v34
    s_waitcnt lgkmcnt(15)
    v_mfma_f32_16x16x32_bf16 v[156:159], a[188:191], a[16:19], v[156:159]
    v_add_u32 v36, s84, v36
    v_mfma_f32_16x16x32_bf16 v[188:191], a[188:191], a[20:23], v[188:191]
    v_lshl_add_u32 v1, v35, 3, v36
    v_mfma_f32_16x16x32_bf16 v[220:223], a[188:191], a[24:27], v[220:223]
    v_mfma_f32_16x16x32_bf16 v[252:255], a[188:191], a[28:31], v[252:255]
    s_waitcnt lgkmcnt(14)
    v_mfma_f32_16x16x32_bf16 v[128:131], a[128:131], a[32:35], v[128:131]
    buffer_load_dwordx4 a[120:123], v23, s[56:59], s68 offen sc1
    v_mfma_f32_16x16x32_bf16 v[160:163], a[128:131], a[36:39], v[160:163]
    ds_read_b64_tr_b16 a[160:161], v8 offset:24576
    v_mfma_f32_16x16x32_bf16 v[192:195], a[128:131], a[40:43], v[192:195]
    ds_read_b64_tr_b16 a[162:163], v8 offset:28672
    v_and_b32 v2, 1, v35
    v_mfma_f32_16x16x32_bf16 v[224:227], a[128:131], a[44:47], v[224:227]
    buffer_load_dwordx4 a[124:127], v24, s[56:59], s68 offen sc1
    v_lshl_add_u32 v36, v2, 5, v36
    s_waitcnt lgkmcnt(14)
    v_mfma_f32_16x16x32_bf16 v[132:135], a[132:135], a[32:35], v[132:135]
    ds_read_b64_tr_b16 a[164:165], v9 offset:24576
    v_lshrrev_b32 v2, 1, v35
    v_mfma_f32_16x16x32_bf16 v[164:167], a[132:135], a[36:39], v[164:167]
    ds_read_b64_tr_b16 a[166:167], v9 offset:28672
    v_lshl_add_u32 v2, v2, 4, v36
    v_mfma_f32_16x16x32_bf16 v[196:199], a[132:135], a[40:43], v[196:199]
    s_add_u32 s68, s68, 16384
    v_lshrrev_b32 v36, 3, v34
    v_mfma_f32_16x16x32_bf16 v[228:231], a[132:135], a[44:47], v[228:231]
    ds_read_b64_tr_b16 a[168:169], v10 offset:24576
    v_mul_u32_u24 v36, 16320, v36
    s_waitcnt lgkmcnt(15)
    v_mfma_f32_16x16x32_bf16 v[136:139], a[136:139], a[32:35], v[136:139]
    ds_read_b64_tr_b16 a[170:171], v10 offset:28672
    v_sub_u32 v1, v2, v36
    v_mfma_f32_16x16x32_bf16 v[168:171], a[136:139], a[36:39], v[168:171]
    buffer_load_dwordx4 a[0:3], v21, s[56:59], s68 offen sc1
    v_xor_b32 v5, 64, v1
    v_mfma_f32_16x16x32_bf16 v[200:203], a[136:139], a[40:43], v[200:203]
    ds_read_b64_tr_b16 a[172:173], v11 offset:24576
    v_add_u32 v5, 16384, v5
    v_mfma_f32_16x16x32_bf16 v[232:235], a[136:139], a[44:47], v[232:235]
    ds_read_b64_tr_b16 a[174:175], v11 offset:28672
    v_cmp_gt_u32 s[4:5], 8, v34
    s_waitcnt lgkmcnt(15)
    v_mfma_f32_16x16x32_bf16 v[140:143], a[140:143], a[32:35], v[140:143]
    buffer_load_dwordx4 a[4:7], v22, s[56:59], s68 offen sc1
    v_lshlrev_b32 v35, 2, v35
    v_mfma_f32_16x16x32_bf16 v[172:175], a[140:143], a[36:39], v[172:175]
    ds_read_b64_tr_b16 a[176:177], v12 offset:24576
    v_sub_u32 v34, v34, v35
    v_mfma_f32_16x16x32_bf16 v[204:207], a[140:143], a[40:43], v[204:207]
    ds_read_b64_tr_b16 a[178:179], v12 offset:28672
    v_mov_b32 v26, 0
    v_mfma_f32_16x16x32_bf16 v[236:239], a[140:143], a[44:47], v[236:239]
    buffer_load_dwordx4 a[8:11], v23, s[56:59], s68 offen sc1
    v_mov_b32 v27, 0
    s_waitcnt lgkmcnt(15)
    v_mfma_f32_16x16x32_bf16 v[144:147], a[144:147], a[32:35], v[144:147]
    ds_read_b64_tr_b16 a[180:181], v13 offset:24576
    v_mov_b32 v30, 0
    v_mfma_f32_16x16x32_bf16 v[176:179], a[144:147], a[36:39], v[176:179]
    ds_read_b64_tr_b16 a[182:183], v13 offset:28672
    v_mov_b32 v31, 0
    v_mfma_f32_16x16x32_bf16 v[208:211], a[144:147], a[40:43], v[208:211]
    buffer_load_dwordx4 a[12:15], v24, s[56:59], s68 offen sc1
    v_mov_b32 v35, 0x3f80
    v_mfma_f32_16x16x32_bf16 v[240:243], a[144:147], a[44:47], v[240:243]
    ds_read_b64_tr_b16 a[184:185], v14 offset:24576
    v_mov_b32 v36, 0x3f800000
    s_waitcnt lgkmcnt(15)
    v_mfma_f32_16x16x32_bf16 v[148:151], a[148:151], a[32:35], v[148:151]
    ds_read_b64_tr_b16 a[186:187], v14 offset:28672
    v_cmp_eq_u32 vcc, 0, v34
    v_mfma_f32_16x16x32_bf16 v[180:183], a[148:151], a[36:39], v[180:183]
    s_add_u32 s68, s68, 16384
    v_cndmask_b32 v28, v26, v35, vcc
    v_mfma_f32_16x16x32_bf16 v[212:215], a[148:151], a[40:43], v[212:215]
    ds_read_b64_tr_b16 a[188:189], v15 offset:24576
    v_cmp_eq_u32 vcc, 1, v34
    v_mfma_f32_16x16x32_bf16 v[244:247], a[148:151], a[44:47], v[244:247]
    ds_read_b64_tr_b16 a[190:191], v15 offset:28672
    v_cndmask_b32 v28, v28, v36, vcc
    v_mfma_f32_16x16x32_bf16 v[152:155], a[152:155], a[32:35], v[152:155]
    buffer_load_dwordx4 a[16:19], v21, s[56:59], s68 offen sc1
    v_cmp_eq_u32 vcc, 2, v34
    v_mfma_f32_16x16x32_bf16 v[184:187], a[152:155], a[36:39], v[184:187]
    s_nop 0
    v_cndmask_b32 v29, v26, v35, vcc
    v_mfma_f32_16x16x32_bf16 v[216:219], a[152:155], a[40:43], v[216:219]
    v_cmp_eq_u32 vcc, 3, v34
    v_mfma_f32_16x16x32_bf16 v[248:251], a[152:155], a[44:47], v[248:251]
    s_nop 0
    v_cndmask_b32 v29, v29, v36, vcc
    s_waitcnt lgkmcnt(15)
    v_mfma_f32_16x16x32_bf16 v[156:159], a[156:159], a[32:35], v[156:159]
    s_mov_b32 s14, 0xbfb8aa3b
    v_mfma_f32_16x16x32_bf16 v[188:191], a[156:159], a[36:39], v[188:191]
    s_mov_b32 s15, 0xbfb8aa3b
    v_mfma_f32_16x16x32_bf16 v[220:223], a[156:159], a[40:43], v[220:223]
    v_mfma_f32_16x16x32_bf16 v[252:255], a[156:159], a[44:47], v[252:255]
    s_waitcnt lgkmcnt(14)
    v_mfma_f32_16x16x32_bf16 v[128:131], a[160:163], a[48:51], v[128:131]
    buffer_load_dwordx4 a[20:23], v22, s[56:59], s68 offen sc1
    v_mfma_f32_16x16x32_bf16 v[160:163], a[160:163], a[52:55], v[160:163]
    ds_read_b64_tr_b16 a[128:129], v8 offset:32768
    v_mfma_f32_16x16x32_bf16 v[192:195], a[160:163], a[56:59], v[192:195]
    ds_read_b64_tr_b16 a[130:131], v8 offset:36864
    v_mfma_f32_16x16x32_bf16 v[224:227], a[160:163], a[60:63], v[224:227]
    buffer_load_dwordx4 a[24:27], v23, s[56:59], s68 offen sc1
    s_waitcnt lgkmcnt(14)
    s_branch L_over8
L_stub8:
    s_branch L_stub12
L_over8:
    v_mfma_f32_16x16x32_bf16 v[132:135], a[164:167], a[48:51], v[132:135]
    ds_read_b64_tr_b16 a[132:133], v9 offset:32768
    v_mfma_f32_16x16x32_bf16 v[164:167], a[164:167], a[52:55], v[164:167]
    ds_read_b64_tr_b16 a[134:135], v9 offset:36864
    v_mfma_f32_16x16x32_bf16 v[196:199], a[164:167], a[56:59], v[196:199]
    buffer_load_dwordx4 a[28:31], v24, s[56:59], s68 offen sc1
    v_mfma_f32_16x16x32_bf16 v[228:231], a[164:167], a[60:63], v[228:231]
    ds_read_b64_tr_b16 a[136:137], v10 offset:32768
    s_waitcnt lgkmcnt(15)
    v_mfma_f32_16x16x32_bf16 v[136:139], a[168:171], a[48:51], v[136:139]
    ds_read_b64_tr_b16 a[138:139], v10 offset:36864
    v_mfma_f32_16x16x32_bf16 v[168:171], a[168:171], a[52:55], v[168:171]
    s_add_u32 s68, s68, 16384
    v_mfma_f32_16x16x32_bf16 v[200:203], a[168:171], a[56:59], v[200:203]
    ds_read_b64_tr_b16 a[140:141], v11 offset:32768
    global_load_dwordx4 v[64:67], v1, s[8:9] offset:0
    v_mfma_f32_16x16x32_bf16 v[232:235], a[168:171], a[60:63], v[232:235]
    ds_read_b64_tr_b16 a[142:143], v11 offset:36864
    s_waitcnt lgkmcnt(15)
    v_mfma_f32_16x16x32_bf16 v[140:143], a[172:175], a[48:51], v[140:143]
    buffer_load_dwordx4 a[32:35], v21, s[56:59], s68 offen sc1
    v_mfma_f32_16x16x32_bf16 v[172:175], a[172:175], a[52:55], v[172:175]
    ds_read_b64_tr_b16 a[144:145], v12 offset:32768
    v_mfma_f32_16x16x32_bf16 v[204:207], a[172:175], a[56:59], v[204:207]
    ds_read_b64_tr_b16 a[146:147], v12 offset:36864
    global_load_dwordx4 v[68:71], v5, s[8:9] offset:0
    v_mfma_f32_16x16x32_bf16 v[236:239], a[172:175], a[60:63], v[236:239]
    buffer_load_dwordx4 a[36:39], v22, s[56:59], s68 offen sc1
    s_waitcnt lgkmcnt(15)
    v_mfma_f32_16x16x32_bf16 v[144:147], a[176:179], a[48:51], v[144:147]
    ds_read_b64_tr_b16 a[148:149], v13 offset:32768
    v_mfma_f32_16x16x32_bf16 v[176:179], a[176:179], a[52:55], v[176:179]
    ds_read_b64_tr_b16 a[150:151], v13 offset:36864
    v_mfma_f32_16x16x32_bf16 v[208:211], a[176:179], a[56:59], v[208:211]
    buffer_load_dwordx4 a[40:43], v23, s[56:59], s68 offen sc1
    global_load_dwordx4 v[80:83], v1, s[8:9] offset:128
    v_mfma_f32_16x16x32_bf16 v[240:243], a[176:179], a[60:63], v[240:243]
    ds_read_b64_tr_b16 a[152:153], v14 offset:32768
    s_waitcnt lgkmcnt(15)
    v_mfma_f32_16x16x32_bf16 v[148:151], a[180:183], a[48:51], v[148:151]
    ds_read_b64_tr_b16 a[154:155], v14 offset:36864
    v_mfma_f32_16x16x32_bf16 v[180:183], a[180:183], a[52:55], v[180:183]
    buffer_load_dwordx4 a[44:47], v24, s[56:59], s68 offen sc1
    v_mfma_f32_16x16x32_bf16 v[212:215], a[180:183], a[56:59], v[212:215]
    ds_read_b64_tr_b16 a[156:157], v15 offset:32768
    global_load_dwordx4 v[84:87], v5, s[8:9] offset:128
    v_mfma_f32_16x16x32_bf16 v[244:247], a[180:183], a[60:63], v[244:247]
    ds_read_b64_tr_b16 a[158:159], v15 offset:36864
    v_mfma_f32_16x16x32_bf16 v[152:155], a[184:187], a[48:51], v[152:155]
    s_add_u32 s68, s68, 16384
    v_mfma_f32_16x16x32_bf16 v[184:187], a[184:187], a[52:55], v[184:187]
    v_mfma_f32_16x16x32_bf16 v[216:219], a[184:187], a[56:59], v[216:219]
    v_mfma_f32_16x16x32_bf16 v[248:251], a[184:187], a[60:63], v[248:251]
    s_waitcnt lgkmcnt(15)
    v_mfma_f32_16x16x32_bf16 v[156:159], a[188:191], a[48:51], v[156:159]
    buffer_load_dword v43, off, s[56:59], s92 sc1
    v_mfma_f32_16x16x32_bf16 v[188:191], a[188:191], a[52:55], v[188:191]
    v_mfma_f32_16x16x32_bf16 v[220:223], a[188:191], a[56:59], v[220:223]
    v_mfma_f32_16x16x32_bf16 v[252:255], a[188:191], a[60:63], v[252:255]
    s_barrier
    s_waitcnt vmcnt(33) lgkmcnt(14)
    v_mfma_f32_16x16x32_bf16 v[128:131], a[128:131], a[64:67], v[128:131]
    buffer_load_dwordx4 a[48:51], v21, s[56:59], s68 offen sc1
    s_waitcnt vmcnt(33)
    v_mfma_f32_16x16x32_bf16 v[160:163], a[128:131], a[68:71], v[160:163]
    ds_read_b64_tr_b16 a[160:161], v8 offset:40960
    s_waitcnt vmcnt(32)
    v_mfma_f32_16x16x32_bf16 v[192:195], a[128:131], a[72:75], v[192:195]
    ds_read_b64_tr_b16 a[162:163], v8 offset:45056
    buffer_load_dwordx4 a[52:55], v22, s[56:59], s68 offen sc1
    s_waitcnt vmcnt(32)
    v_mfma_f32_16x16x32_bf16 v[224:227], a[128:131], a[76:79], v[224:227]
    s_waitcnt lgkmcnt(14)
    v_mfma_f32_16x16x32_bf16 v[132:135], a[132:135], a[64:67], v[132:135]
    ds_read_b64_tr_b16 a[164:165], v9 offset:40960
    buffer_load_dwordx4 a[56:59], v23, s[56:59], s68 offen sc1
    v_mfma_f32_16x16x32_bf16 v[164:167], a[132:135], a[68:71], v[164:167]
    ds_read_b64_tr_b16 a[166:167], v9 offset:45056
    v_mfma_f32_16x16x32_bf16 v[196:199], a[132:135], a[72:75], v[196:199]
    buffer_load_dwordx4 a[60:63], v24, s[56:59], s68 offen sc1
    v_mfma_f32_16x16x32_bf16 v[228:231], a[132:135], a[76:79], v[228:231]
    ds_read_b64_tr_b16 a[168:169], v10 offset:40960
    s_waitcnt lgkmcnt(15)
    v_mfma_f32_16x16x32_bf16 v[136:139], a[136:139], a[64:67], v[136:139]
    ds_read_b64_tr_b16 a[170:171], v10 offset:45056
    s_add_u32 s68, s68, 16384
    v_mfma_f32_16x16x32_bf16 v[168:171], a[136:139], a[68:71], v[168:171]
    v_mfma_f32_16x16x32_bf16 v[200:203], a[136:139], a[72:75], v[200:203]
    ds_read_b64_tr_b16 a[172:173], v11 offset:40960
    v_mfma_f32_16x16x32_bf16 v[232:235], a[136:139], a[76:79], v[232:235]
    ds_read_b64_tr_b16 a[174:175], v11 offset:45056
    s_mov_b32 s82, 1048576
    s_add_u32 m0, s3, 0
    s_waitcnt lgkmcnt(15)
    v_mfma_f32_16x16x32_bf16 v[140:143], a[140:143], a[64:67], v[140:143]
    buffer_load_dwordx4 v17, s[48:51], s82 offen lds
    v_mfma_f32_16x16x32_bf16 v[172:175], a[140:143], a[68:71], v[172:175]
    ds_read_b64_tr_b16 a[176:177], v12 offset:40960
    v_mfma_f32_16x16x32_bf16 v[204:207], a[140:143], a[72:75], v[204:207]
    ds_read_b64_tr_b16 a[178:179], v12 offset:45056
    v_mfma_f32_16x16x32_bf16 v[236:239], a[140:143], a[76:79], v[236:239]
    s_waitcnt lgkmcnt(15)
    v_mfma_f32_16x16x32_bf16 v[144:147], a[144:147], a[64:67], v[144:147]
    ds_read_b64_tr_b16 a[180:181], v13 offset:40960
    buffer_load_dwordx4 v18, s[48:51], s82 offen offset:1024 lds
    v_mfma_f32_16x16x32_bf16 v[176:179], a[144:147], a[68:71], v[176:179]
    ds_read_b64_tr_b16 a[182:183], v13 offset:45056
    v_mfma_f32_16x16x32_bf16 v[208:211], a[144:147], a[72:75], v[208:211]
    v_mfma_f32_16x16x32_bf16 v[240:243], a[144:147], a[76:79], v[240:243]
    ds_read_b64_tr_b16 a[184:185], v14 offset:40960
    s_waitcnt lgkmcnt(15)
    v_mfma_f32_16x16x32_bf16 v[148:151], a[148:151], a[64:67], v[148:151]
    ds_read_b64_tr_b16 a[186:187], v14 offset:45056
    v_mfma_f32_16x16x32_bf16 v[180:183], a[148:151], a[68:71], v[180:183]
    v_mfma_f32_16x16x32_bf16 v[212:215], a[148:151], a[72:75], v[212:215]
    ds_read_b64_tr_b16 a[188:189], v15 offset:40960
    v_mfma_f32_16x16x32_bf16 v[244:247], a[148:151], a[76:79], v[244:247]
    ds_read_b64_tr_b16 a[190:191], v15 offset:45056
    v_mfma_f32_16x16x32_bf16 v[152:155], a[152:155], a[64:67], v[152:155]
    v_mfma_f32_16x16x32_bf16 v[184:187], a[152:155], a[68:71], v[184:187]
    v_mfma_f32_16x16x32_bf16 v[216:219], a[152:155], a[72:75], v[216:219]
    v_mfma_f32_16x16x32_bf16 v[248:251], a[152:155], a[76:79], v[248:251]
    s_waitcnt lgkmcnt(15)
    v_mfma_f32_16x16x32_bf16 v[156:159], a[156:159], a[64:67], v[156:159]
    v_mfma_f32_16x16x32_bf16 v[188:191], a[156:159], a[68:71], v[188:191]
    v_mfma_f32_16x16x32_bf16 v[220:223], a[156:159], a[72:75], v[220:223]
    v_mfma_f32_16x16x32_bf16 v[252:255], a[156:159], a[76:79], v[252:255]
    s_waitcnt vmcnt(35) lgkmcnt(14)
    v_mfma_f32_16x16x32_bf16 v[128:131], a[160:163], a[80:83], v[128:131]
    buffer_load_dwordx4 a[64:67], v21, s[56:59], s68 offen sc1
    s_waitcnt vmcnt(35)
    v_mfma_f32_16x16x32_bf16 v[160:163], a[160:163], a[84:87], v[160:163]
    ds_read_b64_tr_b16 a[128:129], v8 offset:49152
    s_waitcnt vmcnt(33)
    v_mfma_f32_16x16x32_bf16 v[192:195], a[160:163], a[88:91], v[192:195]
    ds_read_b64_tr_b16 a[130:131], v8 offset:53248
    buffer_load_dwordx4 a[68:71], v22, s[56:59], s68 offen sc1
    s_waitcnt vmcnt(33)
    v_mfma_f32_16x16x32_bf16 v[224:227], a[160:163], a[92:95], v[224:227]
    s_waitcnt lgkmcnt(14)
    v_mfma_f32_16x16x32_bf16 v[132:135], a[164:167], a[80:83], v[132:135]
    ds_read_b64_tr_b16 a[132:133], v9 offset:49152
    buffer_load_dwordx4 a[72:75], v23, s[56:59], s68 offen sc1
    v_mfma_f32_16x16x32_bf16 v[164:167], a[164:167], a[84:87], v[164:167]
    ds_read_b64_tr_b16 a[134:135], v9 offset:53248
    v_mfma_f32_16x16x32_bf16 v[196:199], a[164:167], a[88:91], v[196:199]
    buffer_load_dwordx4 a[76:79], v24, s[56:59], s68 offen sc1
    v_mfma_f32_16x16x32_bf16 v[228:231], a[164:167], a[92:95], v[228:231]
    ds_read_b64_tr_b16 a[136:137], v10 offset:49152
    s_waitcnt lgkmcnt(15)
    v_mfma_f32_16x16x32_bf16 v[136:139], a[168:171], a[80:83], v[136:139]
    ds_read_b64_tr_b16 a[138:139], v10 offset:53248
    s_add_u32 s68, s68, 16384
    v_mfma_f32_16x16x32_bf16 v[168:171], a[168:171], a[84:87], v[168:171]
    v_mfma_f32_16x16x32_bf16 v[200:203], a[168:171], a[88:91], v[200:203]
    ds_read_b64_tr_b16 a[140:141], v11 offset:49152
    v_mfma_f32_16x16x32_bf16 v[232:235], a[168:171], a[92:95], v[232:235]
    ds_read_b64_tr_b16 a[142:143], v11 offset:53248
    s_mov_b32 s83, 1277952
    s_add_u32 m0, s3, 8192
    s_waitcnt lgkmcnt(15)
    v_mfma_f32_16x16x32_bf16 v[140:143], a[172:175], a[80:83], v[140:143]
    buffer_load_dwordx4 v17, s[48:51], s83 offen lds
    v_mfma_f32_16x16x32_bf16 v[172:175], a[172:175], a[84:87], v[172:175]
    ds_read_b64_tr_b16 a[144:145], v12 offset:49152
    v_mfma_f32_16x16x32_bf16 v[204:207], a[172:175], a[88:91], v[204:207]
    ds_read_b64_tr_b16 a[146:147], v12 offset:53248
    v_mfma_f32_16x16x32_bf16 v[236:239], a[172:175], a[92:95], v[236:239]
    s_waitcnt lgkmcnt(15)
    v_mfma_f32_16x16x32_bf16 v[144:147], a[176:179], a[80:83], v[144:147]
    ds_read_b64_tr_b16 a[148:149], v13 offset:49152
    buffer_load_dwordx4 v18, s[48:51], s83 offen offset:1024 lds
    v_mfma_f32_16x16x32_bf16 v[176:179], a[176:179], a[84:87], v[176:179]
    ds_read_b64_tr_b16 a[150:151], v13 offset:53248
    v_mfma_f32_16x16x32_bf16 v[208:211], a[176:179], a[88:91], v[208:211]
    v_mfma_f32_16x16x32_bf16 v[240:243], a[176:179], a[92:95], v[240:243]
    ds_read_b64_tr_b16 a[152:153], v14 offset:49152
    s_waitcnt lgkmcnt(15)
    v_mfma_f32_16x16x32_bf16 v[148:151], a[180:183], a[80:83], v[148:151]
    ds_read_b64_tr_b16 a[154:155], v14 offset:53248
    v_mfma_f32_16x16x32_bf16 v[180:183], a[180:183], a[84:87], v[180:183]
    v_mfma_f32_16x16x32_bf16 v[212:215], a[180:183], a[88:91], v[212:215]
    ds_read_b64_tr_b16 a[156:157], v15 offset:49152
    v_mfma_f32_16x16x32_bf16 v[244:247], a[180:183], a[92:95], v[244:247]
    ds_read_b64_tr_b16 a[158:159], v15 offset:53248
    v_mfma_f32_16x16x32_bf16 v[152:155], a[184:187], a[80:83], v[152:155]
    v_mfma_f32_16x16x32_bf16 v[184:187], a[184:187], a[84:87], v[184:187]
    v_mfma_f32_16x16x32_bf16 v[216:219], a[184:187], a[88:91], v[216:219]
    v_mfma_f32_16x16x32_bf16 v[248:251], a[184:187], a[92:95], v[248:251]
    s_waitcnt lgkmcnt(15)
    v_mfma_f32_16x16x32_bf16 v[156:159], a[188:191], a[80:83], v[156:159]
    v_mfma_f32_16x16x32_bf16 v[188:191], a[188:191], a[84:87], v[188:191]
    v_mfma_f32_16x16x32_bf16 v[220:223], a[188:191], a[88:91], v[220:223]
    v_mfma_f32_16x16x32_bf16 v[252:255], a[188:191], a[92:95], v[252:255]
    s_waitcnt vmcnt(36) lgkmcnt(14)
    v_mfma_f32_16x16x32_bf16 v[128:131], a[128:131], a[96:99], v[128:131]
    buffer_load_dwordx4 a[80:83], v21, s[56:59], s68 offen sc1
    s_waitcnt vmcnt(36)
    v_mfma_f32_16x16x32_bf16 v[160:163], a[128:131], a[100:103], v[160:163]
    ds_read_b64_tr_b16 a[160:161], v8 offset:57344
    s_waitcnt vmcnt(35)
    v_mfma_f32_16x16x32_bf16 v[192:195], a[128:131], a[104:107], v[192:195]
    ds_read_b64_tr_b16 a[162:163], v8 offset:61440
    buffer_load_dwordx4 a[84:87], v22, s[56:59], s68 offen sc1
    s_waitcnt vmcnt(35)
    v_mfma_f32_16x16x32_bf16 v[224:227], a[128:131], a[108:111], v[224:227]
    s_waitcnt lgkmcnt(14)
    v_mfma_f32_16x16x32_bf16 v[132:135], a[132:135], a[96:99], v[132:135]
    ds_read_b64_tr_b16 a[164:165], v9 offset:57344
    buffer_load_dwordx4 a[88:91], v23, s[56:59], s68 offen sc1
    v_mfma_f32_16x16x32_bf16 v[164:167], a[132:135], a[100:103], v[164:167]
    ds_read_b64_tr_b16 a[166:167], v9 offset:61440
    v_mfma_f32_16x16x32_bf16 v[196:199], a[132:135], a[104:107], v[196:199]
    buffer_load_dwordx4 a[92:95], v24, s[56:59], s68 offen sc1
    v_mfma_f32_16x16x32_bf16 v[228:231], a[132:135], a[108:111], v[228:231]
    ds_read_b64_tr_b16 a[168:169], v10 offset:57344
    s_waitcnt lgkmcnt(15)
    v_mfma_f32_16x16x32_bf16 v[136:139], a[136:139], a[96:99], v[136:139]
    ds_read_b64_tr_b16 a[170:171], v10 offset:61440
    s_add_u32 s68, s68, 16384
    v_mfma_f32_16x16x32_bf16 v[168:171], a[136:139], a[100:103], v[168:171]
    v_mfma_f32_16x16x32_bf16 v[200:203], a[136:139], a[104:107], v[200:203]
    ds_read_b64_tr_b16 a[172:173], v11 offset:57344
    v_mfma_f32_16x16x32_bf16 v[232:235], a[136:139], a[108:111], v[232:235]
    ds_read_b64_tr_b16 a[174:175], v11 offset:61440
    s_mov_b32 s82, 1507328
    s_add_u32 m0, s3, 16384
    s_waitcnt lgkmcnt(15)
    v_mfma_f32_16x16x32_bf16 v[140:143], a[140:143], a[96:99], v[140:143]
    buffer_load_dwordx4 v17, s[48:51], s82 offen lds
    v_mfma_f32_16x16x32_bf16 v[172:175], a[140:143], a[100:103], v[172:175]
    ds_read_b64_tr_b16 a[176:177], v12 offset:57344
    v_mfma_f32_16x16x32_bf16 v[204:207], a[140:143], a[104:107], v[204:207]
    ds_read_b64_tr_b16 a[178:179], v12 offset:61440
    v_mfma_f32_16x16x32_bf16 v[236:239], a[140:143], a[108:111], v[236:239]
    s_waitcnt lgkmcnt(15)
    v_mfma_f32_16x16x32_bf16 v[144:147], a[144:147], a[96:99], v[144:147]
    ds_read_b64_tr_b16 a[180:181], v13 offset:57344
    buffer_load_dwordx4 v18, s[48:51], s82 offen offset:1024 lds
    v_mfma_f32_16x16x32_bf16 v[176:179], a[144:147], a[100:103], v[176:179]
    ds_read_b64_tr_b16 a[182:183], v13 offset:61440
    v_mfma_f32_16x16x32_bf16 v[208:211], a[144:147], a[104:107], v[208:211]
    v_mfma_f32_16x16x32_bf16 v[240:243], a[144:147], a[108:111], v[240:243]
    ds_read_b64_tr_b16 a[184:185], v14 offset:57344
    s_waitcnt lgkmcnt(15)
    v_mfma_f32_16x16x32_bf16 v[148:151], a[148:151], a[96:99], v[148:151]
    ds_read_b64_tr_b16 a[186:187], v14 offset:61440
    v_mfma_f32_16x16x32_bf16 v[180:183], a[148:151], a[100:103], v[180:183]
    v_mfma_f32_16x16x32_bf16 v[212:215], a[148:151], a[104:107], v[212:215]
    ds_read_b64_tr_b16 a[188:189], v15 offset:57344
    v_mfma_f32_16x16x32_bf16 v[244:247], a[148:151], a[108:111], v[244:247]
    ds_read_b64_tr_b16 a[190:191], v15 offset:61440
    v_mfma_f32_16x16x32_bf16 v[152:155], a[152:155], a[96:99], v[152:155]
    v_mfma_f32_16x16x32_bf16 v[184:187], a[152:155], a[100:103], v[184:187]
    v_mfma_f32_16x16x32_bf16 v[216:219], a[152:155], a[104:107], v[216:219]
    v_mfma_f32_16x16x32_bf16 v[248:251], a[152:155], a[108:111], v[248:251]
    s_waitcnt lgkmcnt(15)
    v_mfma_f32_16x16x32_bf16 v[156:159], a[156:159], a[96:99], v[156:159]
    v_mfma_f32_16x16x32_bf16 v[188:191], a[156:159], a[100:103], v[188:191]
    v_mfma_f32_16x16x32_bf16 v[220:223], a[156:159], a[104:107], v[220:223]
    v_mfma_f32_16x16x32_bf16 v[252:255], a[156:159], a[108:111], v[252:255]
    s_waitcnt vmcnt(38) lgkmcnt(14)
    v_mfma_f32_16x16x32_bf16 v[128:131], a[160:163], a[112:115], v[128:131]
    buffer_load_dwordx4 a[96:99], v21, s[56:59], s68 offen sc1
    s_waitcnt vmcnt(38)
    v_mfma_f32_16x16x32_bf16 v[160:163], a[160:163], a[116:119], v[160:163]
    ds_read_b64_tr_b16 a[128:129], v48 offset:0
    s_waitcnt vmcnt(37)
    v_mfma_f32_16x16x32_bf16 v[192:195], a[160:163], a[120:123], v[192:195]
    ds_read_b64_tr_b16 a[130:131], v48 offset:4096
    buffer_load_dwordx4 a[100:103], v22, s[56:59], s68 offen sc1
    s_waitcnt vmcnt(37)
    v_mfma_f32_16x16x32_bf16 v[224:227], a[160:163], a[124:127], v[224:227]
    s_waitcnt lgkmcnt(14)
    v_mfma_f32_16x16x32_bf16 v[132:135], a[164:167], a[112:115], v[132:135]
    ds_read_b64_tr_b16 a[132:133], v49 offset:0
    buffer_load_dwordx4 a[104:107], v23, s[56:59], s68 offen sc1
    v_mfma_f32_16x16x32_bf16 v[164:167], a[164:167], a[116:119], v[164:167]
    ds_read_b64_tr_b16 a[134:135], v49 offset:4096
    v_mfma_f32_16x16x32_bf16 v[196:199], a[164:167], a[120:123], v[196:199]
    buffer_load_dwordx4 a[108:111], v24, s[56:59], s68 offen sc1
    v_mfma_f32_16x16x32_bf16 v[228:231], a[164:167], a[124:127], v[228:231]
    ds_read_b64_tr_b16 a[136:137], v50 offset:0
    s_waitcnt lgkmcnt(15)
    v_mfma_f32_16x16x32_bf16 v[136:139], a[168:171], a[112:115], v[136:139]
    ds_read_b64_tr_b16 a[138:139], v50 offset:4096
    s_add_u32 s68, s68, 16384
    v_mfma_f32_16x16x32_bf16 v[168:171], a[168:171], a[116:119], v[168:171]
    v_mfma_f32_16x16x32_bf16 v[200:203], a[168:171], a[120:123], v[200:203]
    ds_read_b64_tr_b16 a[140:141], v51 offset:0
    v_mfma_f32_16x16x32_bf16 v[232:235], a[168:171], a[124:127], v[232:235]
    ds_read_b64_tr_b16 a[142:143], v51 offset:4096
    s_mov_b32 s83, 1736704
    s_add_u32 m0, s3, 24576
    s_waitcnt lgkmcnt(15)
    v_mfma_f32_16x16x32_bf16 v[140:143], a[172:175], a[112:115], v[140:143]
    buffer_load_dwordx4 v17, s[48:51], s83 offen lds
    v_mfma_f32_16x16x32_bf16 v[172:175], a[172:175], a[116:119], v[172:175]
    ds_read_b64_tr_b16 a[144:145], v52 offset:0
    v_mfma_f32_16x16x32_bf16 v[204:207], a[172:175], a[120:123], v[204:207]
    ds_read_b64_tr_b16 a[146:147], v52 offset:4096
    v_mfma_f32_16x16x32_bf16 v[236:239], a[172:175], a[124:127], v[236:239]
    s_waitcnt lgkmcnt(15)
    v_mfma_f32_16x16x32_bf16 v[144:147], a[176:179], a[112:115], v[144:147]
    ds_read_b64_tr_b16 a[148:149], v53 offset:0
    buffer_load_dwordx4 v18, s[48:51], s83 offen offset:1024 lds
    v_mfma_f32_16x16x32_bf16 v[176:179], a[176:179], a[116:119], v[176:179]
    ds_read_b64_tr_b16 a[150:151], v53 offset:4096
    v_mfma_f32_16x16x32_bf16 v[208:211], a[176:179], a[120:123], v[208:211]
    v_mfma_f32_16x16x32_bf16 v[240:243], a[176:179], a[124:127], v[240:243]
    ds_read_b64_tr_b16 a[152:153], v54 offset:0
    s_waitcnt lgkmcnt(15)
    v_mfma_f32_16x16x32_bf16 v[148:151], a[180:183], a[112:115], v[148:151]
    ds_read_b64_tr_b16 a[154:155], v54 offset:4096
    v_mfma_f32_16x16x32_bf16 v[180:183], a[180:183], a[116:119], v[180:183]
    v_mfma_f32_16x16x32_bf16 v[212:215], a[180:183], a[120:123], v[212:215]
    ds_read_b64_tr_b16 a[156:157], v55 offset:0
    v_mfma_f32_16x16x32_bf16 v[244:247], a[180:183], a[124:127], v[244:247]
    ds_read_b64_tr_b16 a[158:159], v55 offset:4096
    v_mfma_f32_16x16x32_bf16 v[152:155], a[184:187], a[112:115], v[152:155]
    v_mfma_f32_16x16x32_bf16 v[184:187], a[184:187], a[116:119], v[184:187]
    v_mfma_f32_16x16x32_bf16 v[216:219], a[184:187], a[120:123], v[216:219]
    v_mfma_f32_16x16x32_bf16 v[248:251], a[184:187], a[124:127], v[248:251]
    s_waitcnt lgkmcnt(15)
    v_mfma_f32_16x16x32_bf16 v[156:159], a[188:191], a[112:115], v[156:159]
    v_mfma_f32_16x16x32_bf16 v[188:191], a[188:191], a[116:119], v[188:191]
    v_mfma_f32_16x16x32_bf16 v[220:223], a[188:191], a[120:123], v[220:223]
    v_mfma_f32_16x16x32_bf16 v[252:255], a[188:191], a[124:127], v[252:255]
    s_barrier
    s_waitcnt vmcnt(40) lgkmcnt(14)
    v_mfma_f32_16x16x32_bf16 v[128:131], a[128:131], a[0:3], v[128:131]
    buffer_load_dwordx4 a[112:115], v21, s[56:59], s68 offen sc1
    s_waitcnt vmcnt(40)
    v_mfma_f32_16x16x32_bf16 v[160:163], a[128:131], a[4:7], v[160:163]
    ds_read_b64_tr_b16 a[160:161], v48 offset:8192
    s_waitcnt vmcnt(39)
    v_mfma_f32_16x16x32_bf16 v[192:195], a[128:131], a[8:11], v[192:195]
    ds_read_b64_tr_b16 a[162:163], v48 offset:12288
    buffer_load_dwordx4 a[116:119], v22, s[56:59], s68 offen sc1
    s_waitcnt vmcnt(39)
    v_mfma_f32_16x16x32_bf16 v[224:227], a[128:131], a[12:15], v[224:227]
    s_waitcnt lgkmcnt(14)
    v_mfma_f32_16x16x32_bf16 v[132:135], a[132:135], a[0:3], v[132:135]
    ds_read_b64_tr_b16 a[164:165], v49 offset:8192
    buffer_load_dwordx4 a[120:123], v23, s[56:59], s68 offen sc1
    v_mfma_f32_16x16x32_bf16 v[164:167], a[132:135], a[4:7], v[164:167]
    ds_read_b64_tr_b16 a[166:167], v49 offset:12288
    v_mfma_f32_16x16x32_bf16 v[196:199], a[132:135], a[8:11], v[196:199]
    buffer_load_dwordx4 a[124:127], v24, s[56:59], s68 offen sc1
    v_mfma_f32_16x16x32_bf16 v[228:231], a[132:135], a[12:15], v[228:231]
    ds_read_b64_tr_b16 a[168:169], v50 offset:8192
    s_waitcnt lgkmcnt(15)
    v_mfma_f32_16x16x32_bf16 v[136:139], a[136:139], a[0:3], v[136:139]
    ds_read_b64_tr_b16 a[170:171], v50 offset:12288
    s_add_u32 s68, s68, 16384
    v_mfma_f32_16x16x32_bf16 v[168:171], a[136:139], a[4:7], v[168:171]
    v_mfma_f32_16x16x32_bf16 v[200:203], a[136:139], a[8:11], v[200:203]
    ds_read_b64_tr_b16 a[172:173], v51 offset:8192
    v_mfma_f32_16x16x32_bf16 v[232:235], a[136:139], a[12:15], v[232:235]
    ds_read_b64_tr_b16 a[174:175], v51 offset:12288
    s_mov_b32 s82, 196608
    s_add_u32 m0, s3, 32768
    s_waitcnt lgkmcnt(15)
    v_mfma_f32_16x16x32_bf16 v[140:143], a[140:143], a[0:3], v[140:143]
    buffer_load_dwordx4 v19, s[48:51], s82 offen lds
    v_mfma_f32_16x16x32_bf16 v[172:175], a[140:143], a[4:7], v[172:175]
    ds_read_b64_tr_b16 a[176:177], v52 offset:8192
    v_mfma_f32_16x16x32_bf16 v[204:207], a[140:143], a[8:11], v[204:207]
    ds_read_b64_tr_b16 a[178:179], v52 offset:12288
    v_mfma_f32_16x16x32_bf16 v[236:239], a[140:143], a[12:15], v[236:239]
    s_waitcnt lgkmcnt(15)
    v_mfma_f32_16x16x32_bf16 v[144:147], a[144:147], a[0:3], v[144:147]
    ds_read_b64_tr_b16 a[180:181], v53 offset:8192
    buffer_load_dwordx4 v20, s[48:51], s82 offen offset:1024 lds
    v_mfma_f32_16x16x32_bf16 v[176:179], a[144:147], a[4:7], v[176:179]
    ds_read_b64_tr_b16 a[182:183], v53 offset:12288
    v_mfma_f32_16x16x32_bf16 v[208:211], a[144:147], a[8:11], v[208:211]
    v_mfma_f32_16x16x32_bf16 v[240:243], a[144:147], a[12:15], v[240:243]
    ds_read_b64_tr_b16 a[184:185], v54 offset:8192
    s_waitcnt lgkmcnt(15)
    v_mfma_f32_16x16x32_bf16 v[148:151], a[148:151], a[0:3], v[148:151]
    ds_read_b64_tr_b16 a[186:187], v54 offset:12288
    v_mfma_f32_16x16x32_bf16 v[180:183], a[148:151], a[4:7], v[180:183]
    v_mfma_f32_16x16x32_bf16 v[212:215], a[148:151], a[8:11], v[212:215]
    ds_read_b64_tr_b16 a[188:189], v55 offset:8192
    v_mfma_f32_16x16x32_bf16 v[244:247], a[148:151], a[12:15], v[244:247]
    ds_read_b64_tr_b16 a[190:191], v55 offset:12288
    v_mfma_f32_16x16x32_bf16 v[152:155], a[152:155], a[0:3], v[152:155]
    v_mfma_f32_16x16x32_bf16 v[184:187], a[152:155], a[4:7], v[184:187]
    v_mfma_f32_16x16x32_bf16 v[216:219], a[152:155], a[8:11], v[216:219]
    v_mfma_f32_16x16x32_bf16 v[248:251], a[152:155], a[12:15], v[248:251]
    s_waitcnt lgkmcnt(15)
    v_mfma_f32_16x16x32_bf16 v[156:159], a[156:159], a[0:3], v[156:159]
    v_mfma_f32_16x16x32_bf16 v[188:191], a[156:159], a[4:7], v[188:191]
    v_mfma_f32_16x16x32_bf16 v[220:223], a[156:159], a[8:11], v[220:223]
    v_mfma_f32_16x16x32_bf16 v[252:255], a[156:159], a[12:15], v[252:255]
    s_waitcnt vmcnt(42) lgkmcnt(14)
    v_mfma_f32_16x16x32_bf16 v[128:131], a[160:163], a[16:19], v[128:131]
    s_waitcnt vmcnt(30)
    v_readfirstlane_b32 s86, v43
    s_bfe_u32 s86, s86, 0x80008
    s_cmp_eq_u32 s86, 16
    s_cbranch_scc0 L_spB
L_okB:
    buffer_load_dwordx4 a[0:3], v21, s[56:59], s68 offen sc1
    v_mfma_f32_16x16x32_bf16 v[160:163], a[160:163], a[20:23], v[160:163]
    ds_read_b64_tr_b16 a[128:129], v48 offset:16384
    v_mfma_f32_16x16x32_bf16 v[192:195], a[160:163], a[24:27], v[192:195]
    ds_read_b64_tr_b16 a[130:131], v48 offset:20480
    buffer_load_dwordx4 a[4:7], v22, s[56:59], s68 offen sc1
    v_mfma_f32_16x16x32_bf16 v[224:227], a[160:163], a[28:31], v[224:227]
    s_waitcnt lgkmcnt(14)
    v_mfma_f32_16x16x32_bf16 v[132:135], a[164:167], a[16:19], v[132:135]
    ds_read_b64_tr_b16 a[132:133], v49 offset:16384
    buffer_load_dwordx4 a[8:11], v23, s[56:59], s68 offen sc1
    v_mfma_f32_16x16x32_bf16 v[164:167], a[164:167], a[20:23], v[164:167]
    ds_read_b64_tr_b16 a[134:135], v49 offset:20480
    v_mfma_f32_16x16x32_bf16 v[196:199], a[164:167], a[24:27], v[196:199]
    buffer_load_dwordx4 a[12:15], v24, s[56:59], s68 offen sc1
    v_mfma_f32_16x16x32_bf16 v[228:231], a[164:167], a[28:31], v[228:231]
    ds_read_b64_tr_b16 a[136:137], v50 offset:16384
    s_waitcnt lgkmcnt(15)
    v_mfma_f32_16x16x32_bf16 v[136:139], a[168:171], a[16:19], v[136:139]
    ds_read_b64_tr_b16 a[138:139], v50 offset:20480
    s_add_u32 s68, s68, 16384
    v_mfma_f32_16x16x32_bf16 v[168:171], a[168:171], a[20:23], v[168:171]
    v_mfma_f32_16x16x32_bf16 v[200:203], a[168:171], a[24:27], v[200:203]
    ds_read_b64_tr_b16 a[140:141], v51 offset:16384
    v_mfma_f32_16x16x32_bf16 v[232:235], a[168:171], a[28:31], v[232:235]
    ds_read_b64_tr_b16 a[142:143], v51 offset:20480
    s_mov_b32 s83, 655360
    s_add_u32 m0, s3, 40960
    s_waitcnt lgkmcnt(15)
    v_mfma_f32_16x16x32_bf16 v[140:143], a[172:175], a[16:19], v[140:143]
    buffer_load_dwordx4 v19, s[48:51], s83 offen lds
    v_mfma_f32_16x16x32_bf16 v[172:175], a[172:175], a[20:23], v[172:175]
    ds_read_b64_tr_b16 a[144:145], v52 offset:16384
    v_mfma_f32_16x16x32_bf16 v[204:207], a[172:175], a[24:27], v[204:207]
    ds_read_b64_tr_b16 a[146:147], v52 offset:20480
    v_mfma_f32_16x16x32_bf16 v[236:239], a[172:175], a[28:31], v[236:239]
    s_waitcnt lgkmcnt(15)
    v_mfma_f32_16x16x32_bf16 v[144:147], a[176:179], a[16:19], v[144:147]
    ds_read_b64_tr_b16 a[148:149], v53 offset:16384
    buffer_load_dwordx4 v20, s[48:51], s83 offen offset:1024 lds
    v_mfma_f32_16x16x32_bf16 v[176:179], a[176:179], a[20:23], v[176:179]
    ds_read_b64_tr_b16 a[150:151], v53 offset:20480
    v_mfma_f32_16x16x32_bf16 v[208:211], a[176:179], a[24:27], v[208:211]
    v_mfma_f32_16x16x32_bf16 v[240:243], a[176:179], a[28:31], v[240:243]
    ds_read_b64_tr_b16 a[152:153], v54 offset:16384
    s_waitcnt lgkmcnt(15)
    v_mfma_f32_16x16x32_bf16 v[148:151], a[180:183], a[16:19], v[148:151]
    ds_read_b64_tr_b16 a[154:155], v54 offset:20480
    v_mfma_f32_16x16x32_bf16 v[180:183], a[180:183], a[20:23], v[180:183]
    v_mfma_f32_16x16x32_bf16 v[212:215], a[180:183], a[24:27], v[212:215]
    ds_read_b64_tr_b16 a[156:157], v55 offset:16384
    v_mfma_f32_16x16x32_bf16 v[244:247], a[180:183], a[28:31], v[244:247]
    ds_read_b64_tr_b16 a[158:159], v55 offset:20480
    v_mfma_f32_16x16x32_bf16 v[152:155], a[184:187], a[16:19], v[152:155]
    v_mfma_f32_16x16x32_bf16 v[184:187], a[184:187], a[20:23], v[184:187]
    v_mfma_f32_16x16x32_bf16 v[216:219], a[184:187], a[24:27], v[216:219]
    v_mfma_f32_16x16x32_bf16 v[248:251], a[184:187], a[28:31], v[248:251]
    s_waitcnt lgkmcnt(15)
    v_mfma_f32_16x16x32_bf16 v[156:159], a[188:191], a[16:19], v[156:159]
    v_mfma_f32_16x16x32_bf16 v[188:191], a[188:191], a[20:23], v[188:191]
    v_mfma_f32_16x16x32_bf16 v[220:223], a[188:191], a[24:27], v[220:223]
    v_mfma_f32_16x16x32_bf16 v[252:255], a[188:191], a[28:31], v[252:255]
    s_waitcnt lgkmcnt(14)
    v_mfma_f32_16x16x32_bf16 v[128:131], a[128:131], a[32:35], v[128:131]
    buffer_load_dwordx4 a[16:19], v21, s[56:59], s68 offen sc1
    v_mfma_f32_16x16x32_bf16 v[160:163], a[128:131], a[36:39], v[160:163]
    ds_read_b64_tr_b16 a[160:161], v48 offset:24576
    v_mfma_f32_16x16x32_bf16 v[192:195], a[128:131], a[40:43], v[192:195]
    ds_read_b64_tr_b16 a[162:163], v48 offset:28672
    buffer_load_dwordx4 a[20:23], v22, s[56:59], s68 offen sc1
    v_mfma_f32_16x16x32_bf16 v[224:227], a[128:131], a[44:47], v[224:227]
    s_waitcnt lgkmcnt(14)
    v_mfma_f32_16x16x32_bf16 v[132:135], a[132:135], a[32:35], v[132:135]
    ds_read_b64_tr_b16 a[164:165], v49 offset:24576
    buffer_load_dwordx4 a[24:27], v23, s[56:59], s68 offen sc1
    v_mfma_f32_16x16x32_bf16 v[164:167], a[132:135], a[36:39], v[164:167]
    ds_read_b64_tr_b16 a[166:167], v49 offset:28672
    v_mfma_f32_16x16x32_bf16 v[196:199], a[132:135], a[40:43], v[196:199]
    buffer_load_dwordx4 a[28:31], v24, s[56:59], s68 offen sc1
    v_mfma_f32_16x16x32_bf16 v[228:231], a[132:135], a[44:47], v[228:231]
    ds_read_b64_tr_b16 a[168:169], v50 offset:24576
    s_waitcnt lgkmcnt(15)
    v_mfma_f32_16x16x32_bf16 v[136:139], a[136:139], a[32:35], v[136:139]
    ds_read_b64_tr_b16 a[170:171], v50 offset:28672
    s_add_u32 s68, s68, 16384
    v_mfma_f32_16x16x32_bf16 v[168:171], a[136:139], a[36:39], v[168:171]
    v_mfma_f32_16x16x32_bf16 v[200:203], a[136:139], a[40:43], v[200:203]
    ds_read_b64_tr_b16 a[172:173], v51 offset:24576
    v_mfma_f32_16x16x32_bf16 v[232:235], a[136:139], a[44:47], v[232:235]
    ds_read_b64_tr_b16 a[174:175], v51 offset:28672
    s_mov_b32 s82, 1114112
    s_add_u32 m0, s3, 49152
    s_waitcnt lgkmcnt(15)
    v_mfma_f32_16x16x32_bf16 v[140:143], a[140:143], a[32:35], v[140:143]
    buffer_load_dwordx4 v19, s[48:51], s82 offen lds
    v_mfma_f32_16x16x32_bf16 v[172:175], a[140:143], a[36:39], v[172:175]
    ds_read_b64_tr_b16 a[176:177], v52 offset:24576
    v_mfma_f32_16x16x32_bf16 v[204:207], a[140:143], a[40:43], v[204:207]
    ds_read_b64_tr_b16 a[178:179], v52 offset:28672
    v_mfma_f32_16x16x32_bf16 v[236:239], a[140:143], a[44:47], v[236:239]
    s_waitcnt lgkmcnt(15)
    v_mfma_f32_16x16x32_bf16 v[144:147], a[144:147], a[32:35], v[144:147]
    ds_read_b64_tr_b16 a[180:181], v53 offset:24576
    buffer_load_dwordx4 v20, s[48:51], s82 offen offset:1024 lds
    v_mfma_f32_16x16x32_bf16 v[176:179], a[144:147], a[36:39], v[176:179]
    ds_read_b64_tr_b16 a[182:183], v53 offset:28672
    v_mfma_f32_16x16x32_bf16 v[208:211], a[144:147], a[40:43], v[208:211]
    v_mfma_f32_16x16x32_bf16 v[240:243], a[144:147], a[44:47], v[240:243]
    ds_read_b64_tr_b16 a[184:185], v54 offset:24576
    s_waitcnt lgkmcnt(15)
    v_mfma_f32_16x16x32_bf16 v[148:151], a[148:151], a[32:35], v[148:151]
    ds_read_b64_tr_b16 a[186:187], v54 offset:28672
    v_mfma_f32_16x16x32_bf16 v[180:183], a[148:151], a[36:39], v[180:183]
    v_mfma_f32_16x16x32_bf16 v[212:215], a[148:151], a[40:43], v[212:215]
    ds_read_b64_tr_b16 a[188:189], v55 offset:24576
    v_mfma_f32_16x16x32_bf16 v[244:247], a[148:151], a[44:47], v[244:247]
    ds_read_b64_tr_b16 a[190:191], v55 offset:28672
    v_mfma_f32_16x16x32_bf16 v[152:155], a[152:155], a[32:35], v[152:155]
    v_mfma_f32_16x16x32_bf16 v[184:187], a[152:155], a[36:39], v[184:187]
    v_mfma_f32_16x16x32_bf16 v[216:219], a[152:155], a[40:43], v[216:219]
    v_mfma_f32_16x16x32_bf16 v[248:251], a[152:155], a[44:47], v[248:251]
    s_waitcnt lgkmcnt(15)
    v_mfma_f32_16x16x32_bf16 v[156:159], a[156:159], a[32:35], v[156:159]
    buffer_load_dword v43, off, s[56:59], s92 sc1
    v_mfma_f32_16x16x32_bf16 v[188:191], a[156:159], a[36:39], v[188:191]
    v_mfma_f32_16x16x32_bf16 v[220:223], a[156:159], a[40:43], v[220:223]
    v_mfma_f32_16x16x32_bf16 v[252:255], a[156:159], a[44:47], v[252:255]
    s_waitcnt vmcnt(42) lgkmcnt(14)
    v_mfma_f32_16x16x32_bf16 v[128:131], a[160:163], a[48:51], v[128:131]
    buffer_load_dwordx4 a[32:35], v21, s[56:59], s68 offen sc1
    s_waitcnt vmcnt(42)
    v_mfma_f32_16x16x32_bf16 v[160:163], a[160:163], a[52:55], v[160:163]
    ds_read_b64_tr_b16 a[128:129], v48 offset:32768
    s_waitcnt vmcnt(41)
    v_mfma_f32_16x16x32_bf16 v[192:195], a[160:163], a[56:59], v[192:195]
    ds_read_b64_tr_b16 a[130:131], v48 offset:36864
    buffer_load_dwordx4 a[36:39], v22, s[56:59], s68 offen sc1
    s_waitcnt vmcnt(41)
    v_mfma_f32_16x16x32_bf16 v[224:227], a[160:163], a[60:63], v[224:227]
    s_waitcnt lgkmcnt(14)
    v_mfma_f32_16x16x32_bf16 v[132:135], a[164:167], a[48:51], v[132:135]
    ds_read_b64_tr_b16 a[132:133], v49 offset:32768
    buffer_load_dwordx4 a[40:43], v23, s[56:59], s68 offen sc1
    v_mfma_f32_16x16x32_bf16 v[164:167], a[164:167], a[52:55], v[164:167]
    ds_read_b64_tr_b16 a[134:135], v49 offset:36864
    v_mfma_f32_16x16x32_bf16 v[196:199], a[164:167], a[56:59], v[196:199]
    buffer_load_dwordx4 a[44:47], v24, s[56:59], s68 offen sc1
    v_mfma_f32_16x16x32_bf16 v[228:231], a[164:167], a[60:63], v[228:231]
    ds_read_b64_tr_b16 a[136:137], v50 offset:32768
    s_branch L_over9
L_stub9:
    s_branch L_stub13
L_over9:
    s_waitcnt lgkmcnt(15)
    v_mfma_f32_16x16x32_bf16 v[136:139], a[168:171], a[48:51], v[136:139]
    ds_read_b64_tr_b16 a[138:139], v50 offset:36864
    s_add_u32 s68, s68, 16384
    v_mfma_f32_16x16x32_bf16 v[168:171], a[168:171], a[52:55], v[168:171]
    v_mfma_f32_16x16x32_bf16 v[200:203], a[168:171], a[56:59], v[200:203]
    ds_read_b64_tr_b16 a[140:141], v51 offset:32768
    v_mfma_f32_16x16x32_bf16 v[232:235], a[168:171], a[60:63], v[232:235]
    ds_read_b64_tr_b16 a[142:143], v51 offset:36864
    s_mov_b32 s83, 1572864
    s_add_u32 m0, s3, 57344
    s_waitcnt lgkmcnt(15)
    v_mfma_f32_16x16x32_bf16 v[140:143], a[172:175], a[48:51], v[140:143]
    buffer_load_dwordx4 v19, s[48:51], s83 offen lds
    v_mfma_f32_16x16x32_bf16 v[172:175], a[172:175], a[52:55], v[172:175]
    ds_read_b64_tr_b16 a[144:145], v52 offset:32768
    v_mfma_f32_16x16x32_bf16 v[204:207], a[172:175], a[56:59], v[204:207]
    ds_read_b64_tr_b16 a[146:147], v52 offset:36864
    v_mfma_f32_16x16x32_bf16 v[236:239], a[172:175], a[60:63], v[236:239]
    s_waitcnt lgkmcnt(15)
    v_mfma_f32_16x16x32_bf16 v[144:147], a[176:179], a[48:51], v[144:147]
    ds_read_b64_tr_b16 a[148:149], v53 offset:32768
    buffer_load_dwordx4 v20, s[48:51], s83 offen offset:1024 lds
    v_mfma_f32_16x16x32_bf16 v[176:179], a[176:179], a[52:55], v[176:179]
    ds_read_b64_tr_b16 a[150:151], v53 offset:36864
    v_mfma_f32_16x16x32_bf16 v[208:211], a[176:179], a[56:59], v[208:211]
    v_mfma_f32_16x16x32_bf16 v[240:243], a[176:179], a[60:63], v[240:243]
    ds_read_b64_tr_b16 a[152:153], v54 offset:32768
    s_waitcnt lgkmcnt(15)
    v_mfma_f32_16x16x32_bf16 v[148:151], a[180:183], a[48:51], v[148:151]
    ds_read_b64_tr_b16 a[154:155], v54 offset:36864
    v_mfma_f32_16x16x32_bf16 v[180:183], a[180:183], a[52:55], v[180:183]
    v_mfma_f32_16x16x32_bf16 v[212:215], a[180:183], a[56:59], v[212:215]
    ds_read_b64_tr_b16 a[156:157], v55 offset:32768
    v_mfma_f32_16x16x32_bf16 v[244:247], a[180:183], a[60:63], v[244:247]
    ds_read_b64_tr_b16 a[158:159], v55 offset:36864
    v_mfma_f32_16x16x32_bf16 v[152:155], a[184:187], a[48:51], v[152:155]
    v_mfma_f32_16x16x32_bf16 v[184:187], a[184:187], a[52:55], v[184:187]
    v_mfma_f32_16x16x32_bf16 v[216:219], a[184:187], a[56:59], v[216:219]
    v_mfma_f32_16x16x32_bf16 v[248:251], a[184:187], a[60:63], v[248:251]
    s_waitcnt lgkmcnt(15)
    v_mfma_f32_16x16x32_bf16 v[156:159], a[188:191], a[48:51], v[156:159]
    v_mfma_f32_16x16x32_bf16 v[188:191], a[188:191], a[52:55], v[188:191]
    v_mfma_f32_16x16x32_bf16 v[220:223], a[188:191], a[56:59], v[220:223]
    v_mfma_f32_16x16x32_bf16 v[252:255], a[188:191], a[60:63], v[252:255]
    s_barrier
    s_waitcnt vmcnt(42) lgkmcnt(14)
    v_mfma_f32_16x16x32_bf16 v[128:131], a[128:131], a[64:67], v[128:131]
    buffer_load_dwordx4 a[48:51], v21, s[56:59], s68 offen sc1
    s_waitcnt vmcnt(42)
    v_mfma_f32_16x16x32_bf16 v[160:163], a[128:131], a[68:71], v[160:163]
    ds_read_b64_tr_b16 a[160:161], v48 offset:40960
    s_waitcnt vmcnt(41)
    v_mfma_f32_16x16x32_bf16 v[192:195], a[128:131], a[72:75], v[192:195]
    ds_read_b64_tr_b16 a[162:163], v48 offset:45056
    buffer_load_dwordx4 a[52:55], v22, s[56:59], s68 offen sc1
    s_waitcnt vmcnt(41)
    v_mfma_f32_16x16x32_bf16 v[224:227], a[128:131], a[76:79], v[224:227]
    s_waitcnt lgkmcnt(14)
    v_mfma_f32_16x16x32_bf16 v[132:135], a[132:135], a[64:67], v[132:135]
    ds_read_b64_tr_b16 a[164:165], v49 offset:40960
    buffer_load_dwordx4 a[56:59], v23, s[56:59], s68 offen sc1
    v_mfma_f32_16x16x32_bf16 v[164:167], a[132:135], a[68:71], v[164:167]
    ds_read_b64_tr_b16 a[166:167], v49 offset:45056
    v_mfma_f32_16x16x32_bf16 v[196:199], a[132:135], a[72:75], v[196:199]
    buffer_load_dwordx4 a[60:63], v24, s[56:59], s68 offen sc1
    v_mfma_f32_16x16x32_bf16 v[228:231], a[132:135], a[76:79], v[228:231]
    ds_read_b64_tr_b16 a[168:169], v50 offset:40960
    s_waitcnt lgkmcnt(15)
    v_mfma_f32_16x16x32_bf16 v[136:139], a[136:139], a[64:67], v[136:139]
    ds_read_b64_tr_b16 a[170:171], v50 offset:45056
    s_add_u32 s68, s68, 16384
    v_mfma_f32_16x16x32_bf16 v[168:171], a[136:139], a[68:71], v[168:171]
    v_mfma_f32_16x16x32_bf16 v[200:203], a[136:139], a[72:75], v[200:203]
    ds_read_b64_tr_b16 a[172:173], v51 offset:40960
    v_cndmask_b32 v72, v64, v68, s[4:5]
    v_mfma_f32_16x16x32_bf16 v[232:235], a[136:139], a[76:79], v[232:235]
    ds_read_b64_tr_b16 a[174:175], v51 offset:45056
    s_mov_b32 s82, 0
    s_add_u32 m0, s3, 65536
    v_cndmask_b32 v73, v65, v69, s[4:5]
    s_waitcnt lgkmcnt(15)
    v_mfma_f32_16x16x32_bf16 v[140:143], a[140:143], a[64:67], v[140:143]
    buffer_load_dwordx4 v17, s[52:55], s82 offen lds
    v_cndmask_b32 v74, v66, v70, s[4:5]
    v_mfma_f32_16x16x32_bf16 v[172:175], a[140:143], a[68:71], v[172:175]
    ds_read_b64_tr_b16 a[176:177], v52 offset:40960
    v_cndmask_b32 v75, v67, v71, s[4:5]
    v_mfma_f32_16x16x32_bf16 v[204:207], a[140:143], a[72:75], v[204:207]
    ds_read_b64_tr_b16 a[178:179], v52 offset:45056
    v_cndmask_b32 v64, v68, v64, s[4:5]
    v_mfma_f32_16x16x32_bf16 v[236:239], a[140:143], a[76:79], v[236:239]
    v_cndmask_b32 v65, v69, v65, s[4:5]
    s_waitcnt lgkmcnt(15)
    v_mfma_f32_16x16x32_bf16 v[144:147], a[144:147], a[64:67], v[144:147]
    ds_read_b64_tr_b16 a[180:181], v53 offset:40960
    buffer_load_dwordx4 v18, s[52:55], s82 offen offset:1024 lds
    v_cndmask_b32 v66, v70, v66, s[4:5]
    v_mfma_f32_16x16x32_bf16 v[176:179], a[144:147], a[68:71], v[176:179]
    ds_read_b64_tr_b16 a[182:183], v53 offset:45056
    v_cndmask_b32 v67, v71, v67, s[4:5]
    v_mfma_f32_16x16x32_bf16 v[208:211], a[144:147], a[72:75], v[208:211]
    v_mov_b32_dpp v76, v72 row_ror:8 row_mask:0xf bank_mask:0xf
    v_mfma_f32_16x16x32_bf16 v[240:243], a[144:147], a[76:79], v[240:243]
    ds_read_b64_tr_b16 a[184:185], v54 offset:40960
    v_mov_b32_dpp v77, v73 row_ror:8 row_mask:0xf bank_mask:0xf
    s_waitcnt lgkmcnt(15)
    v_mfma_f32_16x16x32_bf16 v[148:151], a[148:151], a[64:67], v[148:151]
    ds_read_b64_tr_b16 a[186:187], v54 offset:45056
    v_mov_b32_dpp v78, v74 row_ror:8 row_mask:0xf bank_mask:0xf
    v_mfma_f32_16x16x32_bf16 v[180:183], a[148:151], a[68:71], v[180:183]
    v_mov_b32_dpp v79, v75 row_ror:8 row_mask:0xf bank_mask:0xf
    v_mfma_f32_16x16x32_bf16 v[212:215], a[148:151], a[72:75], v[212:215]
    ds_read_b64_tr_b16 a[188:189], v55 offset:40960
    v_permlane16_swap_b32 v64, v66
    v_mfma_f32_16x16x32_bf16 v[244:247], a[148:151], a[76:79], v[244:247]
    ds_read_b64_tr_b16 a[190:191], v55 offset:45056
    v_permlane16_swap_b32 v65, v67
    v_mfma_f32_16x16x32_bf16 v[152:155], a[152:155], a[64:67], v[152:155]
    v_permlane16_swap_b32 v76, v78
    v_mfma_f32_16x16x32_bf16 v[184:187], a[152:155], a[68:71], v[184:187]
    v_permlane16_swap_b32 v77, v79
    v_mfma_f32_16x16x32_bf16 v[216:219], a[152:155], a[72:75], v[216:219]
    v_mfma_f32_16x16x32_bf16 v[248:251], a[152:155], a[76:79], v[248:251]
    s_waitcnt lgkmcnt(15)
    v_mfma_f32_16x16x32_bf16 v[156:159], a[156:159], a[64:67], v[156:159]
    v_mfma_f32_16x16x32_bf16 v[188:191], a[156:159], a[68:71], v[188:191]
    v_mfma_f32_16x16x32_bf16 v[220:223], a[156:159], a[72:75], v[220:223]
    v_mfma_f32_16x16x32_bf16 v[252:255], a[156:159], a[76:79], v[252:255]
    s_waitcnt vmcnt(42) lgkmcnt(14)
    v_mfma_f32_16x16x32_bf16 v[128:131], a[160:163], a[80:83], v[128:131]
    buffer_load_dwordx4 a[64:67], v21, s[56:59], s68 offen sc1
    s_waitcnt vmcnt(42)
    v_mfma_f32_16x16x32_bf16 v[160:163], a[160:163], a[84:87], v[160:163]
    ds_read_b64_tr_b16 a[128:129], v48 offset:49152
    s_waitcnt vmcnt(41)
    v_mfma_f32_16x16x32_bf16 v[192:195], a[160:163], a[88:91], v[192:195]
    ds_read_b64_tr_b16 a[130:131], v48 offset:53248
    buffer_load_dwordx4 a[68:71], v22, s[56:59], s68 offen sc1
    s_waitcnt vmcnt(41)
    v_mfma_f32_16x16x32_bf16 v[224:227], a[160:163], a[92:95], v[224:227]
    s_waitcnt lgkmcnt(14)
    v_mfma_f32_16x16x32_bf16 v[132:135], a[164:167], a[80:83], v[132:135]
    ds_read_b64_tr_b16 a[132:133], v49 offset:49152
    buffer_load_dwordx4 a[72:75], v23, s[56:59], s68 offen sc1
    v_mfma_f32_16x16x32_bf16 v[164:167], a[164:167], a[84:87], v[164:167]
    ds_read_b64_tr_b16 a[134:135], v49 offset:53248
    v_mfma_f32_16x16x32_bf16 v[196:199], a[164:167], a[88:91], v[196:199]
    buffer_load_dwordx4 a[76:79], v24, s[56:59], s68 offen sc1
    v_mfma_f32_16x16x32_bf16 v[228:231], a[164:167], a[92:95], v[228:231]
    ds_read_b64_tr_b16 a[136:137], v50 offset:49152
    s_waitcnt lgkmcnt(15)
    v_mfma_f32_16x16x32_bf16 v[136:139], a[168:171], a[80:83], v[136:139]
    ds_read_b64_tr_b16 a[138:139], v50 offset:53248
    s_add_u32 s68, s68, 16384
    v_mfma_f32_16x16x32_bf16 v[168:171], a[168:171], a[84:87], v[168:171]
    v_mfma_f32_16x16x32_bf16 v[200:203], a[168:171], a[88:91], v[200:203]
    ds_read_b64_tr_b16 a[140:141], v51 offset:49152
    v_and_b32 v71, 0xffff0000, v67
    v_mfma_f32_16x16x32_bf16 v[232:235], a[168:171], a[92:95], v[232:235]
    ds_read_b64_tr_b16 a[142:143], v51 offset:53248
    s_mov_b32 s83, 65536
    s_add_u32 m0, s3, 73728
    v_lshlrev_b32 v70, 16, v67
    s_waitcnt lgkmcnt(15)
    v_mfma_f32_16x16x32_bf16 v[140:143], a[172:175], a[80:83], v[140:143]
    buffer_load_dwordx4 v17, s[52:55], s83 offen lds
    v_and_b32 v69, 0xffff0000, v66
    v_mfma_f32_16x16x32_bf16 v[172:175], a[172:175], a[84:87], v[172:175]
    ds_read_b64_tr_b16 a[144:145], v52 offset:49152
    v_lshlrev_b32 v68, 16, v66
    v_mfma_f32_16x16x32_bf16 v[204:207], a[172:175], a[88:91], v[204:207]
    ds_read_b64_tr_b16 a[146:147], v52 offset:53248
    v_and_b32 v67, 0xffff0000, v65
    v_mfma_f32_16x16x32_bf16 v[236:239], a[172:175], a[92:95], v[236:239]
    v_lshlrev_b32 v66, 16, v65
    s_waitcnt lgkmcnt(15)
    v_mfma_f32_16x16x32_bf16 v[144:147], a[176:179], a[80:83], v[144:147]
    ds_read_b64_tr_b16 a[148:149], v53 offset:49152
    buffer_load_dwordx4 v18, s[52:55], s83 offen offset:1024 lds
    v_and_b32 v65, 0xffff0000, v64
    v_mfma_f32_16x16x32_bf16 v[176:179], a[176:179], a[84:87], v[176:179]
    ds_read_b64_tr_b16 a[150:151], v53 offset:53248
    v_lshlrev_b32 v64, 16, v64
    v_mfma_f32_16x16x32_bf16 v[208:211], a[176:179], a[88:91], v[208:211]
    v_lshlrev_b32 v72, 16, v76
    v_mfma_f32_16x16x32_bf16 v[240:243], a[176:179], a[92:95], v[240:243]
    ds_read_b64_tr_b16 a[152:153], v54 offset:49152
    v_and_b32 v73, 0xffff0000, v76
    s_waitcnt lgkmcnt(15)
    v_mfma_f32_16x16x32_bf16 v[148:151], a[180:183], a[80:83], v[148:151]
    ds_read_b64_tr_b16 a[154:155], v54 offset:53248
    v_lshlrev_b32 v74, 16, v77
    v_mfma_f32_16x16x32_bf16 v[180:183], a[180:183], a[84:87], v[180:183]
    v_and_b32 v75, 0xffff0000, v77
    v_mfma_f32_16x16x32_bf16 v[212:215], a[180:183], a[88:91], v[212:215]
    ds_read_b64_tr_b16 a[156:157], v55 offset:49152
    v_lshlrev_b32 v76, 16, v78
    v_mfma_f32_16x16x32_bf16 v[244:247], a[180:183], a[92:95], v[244:247]
    ds_read_b64_tr_b16 a[158:159], v55 offset:53248
    v_and_b32 v77, 0xffff0000, v78
    v_mfma_f32_16x16x32_bf16 v[152:155], a[184:187], a[80:83], v[152:155]
    v_lshlrev_b32 v78, 16, v79
    v_mfma_f32_16x16x32_bf16 v[184:187], a[184:187], a[84:87], v[184:187]
    v_and_b32 v79, 0xffff0000, v79
    v_mfma_f32_16x16x32_bf16 v[216:219], a[184:187], a[88:91], v[216:219]
    v_mfma_f32_16x16x32_bf16 v[248:251], a[184:187], a[92:95], v[248:251]
    s_waitcnt lgkmcnt(15)
    v_mfma_f32_16x16x32_bf16 v[156:159], a[188:191], a[80:83], v[156:159]
    buffer_load_dword v44, off, s[56:59], s76 sc1
    v_mfma_f32_16x16x32_bf16 v[188:191], a[188:191], a[84:87], v[188:191]
    v_mfma_f32_16x16x32_bf16 v[220:223], a[188:191], a[88:91], v[220:223]
    v_mfma_f32_16x16x32_bf16 v[252:255], a[188:191], a[92:95], v[252:255]
    s_waitcnt vmcnt(43) lgkmcnt(14)
    v_mfma_f32_16x16x32_bf16 v[128:131], a[128:131], a[96:99], v[128:131]
    buffer_load_dwordx4 a[80:83], v21, s[56:59], s68 offen sc1
    s_waitcnt vmcnt(43)
    v_mfma_f32_16x16x32_bf16 v[160:163], a[128:131], a[100:103], v[160:163]
    ds_read_b64_tr_b16 a[160:161], v48 offset:57344
    s_waitcnt vmcnt(42)
    v_mfma_f32_16x16x32_bf16 v[192:195], a[128:131], a[104:107], v[192:195]
    ds_read_b64_tr_b16 a[162:163], v48 offset:61440
    buffer_load_dwordx4 a[84:87], v22, s[56:59], s68 offen sc1
    s_waitcnt vmcnt(42)
    v_mfma_f32_16x16x32_bf16 v[224:227], a[128:131], a[108:111], v[224:227]
    s_waitcnt lgkmcnt(14)
    v_mfma_f32_16x16x32_bf16 v[132:135], a[132:135], a[96:99], v[132:135]
    ds_read_b64_tr_b16 a[164:165], v49 offset:57344
    buffer_load_dwordx4 a[88:91], v23, s[56:59], s68 offen sc1
    v_mfma_f32_16x16x32_bf16 v[164:167], a[132:135], a[100:103], v[164:167]
    ds_read_b64_tr_b16 a[166:167], v49 offset:61440
    v_mfma_f32_16x16x32_bf16 v[196:199], a[132:135], a[104:107], v[196:199]
    buffer_load_dwordx4 a[92:95], v24, s[56:59], s68 offen sc1
    v_mfma_f32_16x16x32_bf16 v[228:231], a[132:135], a[108:111], v[228:231]
    ds_read_b64_tr_b16 a[168:169], v50 offset:57344
    s_waitcnt lgkmcnt(15)
    v_mfma_f32_16x16x32_bf16 v[136:139], a[136:139], a[96:99], v[136:139]
    ds_read_b64_tr_b16 a[170:171], v50 offset:61440
    s_add_u32 s68, s68, 16384
    v_mfma_f32_16x16x32_bf16 v[168:171], a[136:139], a[100:103], v[168:171]
    v_mfma_f32_16x16x32_bf16 v[200:203], a[136:139], a[104:107], v[200:203]
    ds_read_b64_tr_b16 a[172:173], v51 offset:57344
    v_cndmask_b32 v88, v80, v84, s[4:5]
    v_mfma_f32_16x16x32_bf16 v[232:235], a[136:139], a[108:111], v[232:235]
    ds_read_b64_tr_b16 a[174:175], v51 offset:61440
    s_mov_b32 s82, 131072
    s_add_u32 m0, s3, 81920
    v_cndmask_b32 v89, v81, v85, s[4:5]
    s_waitcnt lgkmcnt(15)
    v_mfma_f32_16x16x32_bf16 v[140:143], a[140:143], a[96:99], v[140:143]
    buffer_load_dwordx4 v17, s[52:55], s82 offen lds
    v_cndmask_b32 v90, v82, v86, s[4:5]
    v_mfma_f32_16x16x32_bf16 v[172:175], a[140:143], a[100:103], v[172:175]
    ds_read_b64_tr_b16 a[176:177], v52 offset:57344
    v_cndmask_b32 v91, v83, v87, s[4:5]
    v_mfma_f32_16x16x32_bf16 v[204:207], a[140:143], a[104:107], v[204:207]
    ds_read_b64_tr_b16 a[178:179], v52 offset:61440
    v_cndmask_b32 v80, v84, v80, s[4:5]
    v_mfma_f32_16x16x32_bf16 v[236:239], a[140:143], a[108:111], v[236:239]
    v_cndmask_b32 v81, v85, v81, s[4:5]
    s_waitcnt lgkmcnt(15)
    v_mfma_f32_16x16x32_bf16 v[144:147], a[144:147], a[96:99], v[144:147]
    ds_read_b64_tr_b16 a[180:181], v53 offset:57344
    buffer_load_dwordx4 v18, s[52:55], s82 offen offset:1024 lds
    v_cndmask_b32 v82, v86, v82, s[4:5]
    v_mfma_f32_16x16x32_bf16 v[176:179], a[144:147], a[100:103], v[176:179]
    ds_read_b64_tr_b16 a[182:183], v53 offset:61440
    v_cndmask_b32 v83, v87, v83, s[4:5]
    v_mfma_f32_16x16x32_bf16 v[208:211], a[144:147], a[104:107], v[208:211]
    v_mov_b32_dpp v92, v88 row_ror:8 row_mask:0xf bank_mask:0xf
    v_mfma_f32_16x16x32_bf16 v[240:243], a[144:147], a[108:111], v[240:243]
    ds_read_b64_tr_b16 a[184:185], v54 offset:57344
    v_mov_b32_dpp v93, v89 row_ror:8 row_mask:0xf bank_mask:0xf
    s_waitcnt lgkmcnt(15)
    v_mfma_f32_16x16x32_bf16 v[148:151], a[148:151], a[96:99], v[148:151]
    ds_read_b64_tr_b16 a[186:187], v54 offset:61440
    v_mov_b32_dpp v94, v90 row_ror:8 row_mask:0xf bank_mask:0xf
    v_mfma_f32_16x16x32_bf16 v[180:183], a[148:151], a[100:103], v[180:183]
    v_mov_b32_dpp v95, v91 row_ror:8 row_mask:0xf bank_mask:0xf
    v_mfma_f32_16x16x32_bf16 v[212:215], a[148:151], a[104:107], v[212:215]
    ds_read_b64_tr_b16 a[188:189], v55 offset:57344
    v_permlane16_swap_b32 v80, v82
    v_mfma_f32_16x16x32_bf16 v[244:247], a[148:151], a[108:111], v[244:247]
    ds_read_b64_tr_b16 a[190:191], v55 offset:61440
    v_permlane16_swap_b32 v81, v83
    v_mfma_f32_16x16x32_bf16 v[152:155], a[152:155], a[96:99], v[152:155]
    v_permlane16_swap_b32 v92, v94
    v_mfma_f32_16x16x32_bf16 v[184:187], a[152:155], a[100:103], v[184:187]
    v_permlane16_swap_b32 v93, v95
    v_mfma_f32_16x16x32_bf16 v[216:219], a[152:155], a[104:107], v[216:219]
    v_mfma_f32_16x16x32_bf16 v[248:251], a[152:155], a[108:111], v[248:251]
    s_waitcnt lgkmcnt(15)
    v_mfma_f32_16x16x32_bf16 v[156:159], a[156:159], a[96:99], v[156:159]
    v_mfma_f32_16x16x32_bf16 v[188:191], a[156:159], a[100:103], v[188:191]
    v_mfma_f32_16x16x32_bf16 v[220:223], a[156:159], a[104:107], v[220:223]
    v_mfma_f32_16x16x32_bf16 v[252:255], a[156:159], a[108:111], v[252:255]
    s_waitcnt vmcnt(43) lgkmcnt(14)
    v_mfma_f32_16x16x32_bf16 v[128:131], a[160:163], a[112:115], v[128:131]
    buffer_load_dwordx4 a[96:99], v21, s[56:59], s68 offen sc1
    s_waitcnt vmcnt(43)
    v_mfma_f32_16x16x32_bf16 v[160:163], a[160:163], a[116:119], v[160:163]
    ds_read_b64_tr_b16 a[128:129], v56 offset:0
    s_waitcnt vmcnt(42)
    v_mfma_f32_16x16x32_bf16 v[192:195], a[160:163], a[120:123], v[192:195]
    ds_read_b64_tr_b16 a[130:131], v56 offset:4096
    buffer_load_dwordx4 a[100:103], v22, s[56:59], s68 offen sc1
    s_waitcnt vmcnt(42)
    v_mfma_f32_16x16x32_bf16 v[224:227], a[160:163], a[124:127], v[224:227]
    s_waitcnt lgkmcnt(14)
    v_mfma_f32_16x16x32_bf16 v[132:135], a[164:167], a[112:115], v[132:135]
    ds_read_b64_tr_b16 a[132:133], v57 offset:0
    buffer_load_dwordx4 a[104:107], v23, s[56:59], s68 offen sc1
    v_mfma_f32_16x16x32_bf16 v[164:167], a[164:167], a[116:119], v[164:167]
    ds_read_b64_tr_b16 a[134:135], v57 offset:4096
    v_mfma_f32_16x16x32_bf16 v[196:199], a[164:167], a[120:123], v[196:199]
    buffer_load_dwordx4 a[108:111], v24, s[56:59], s68 offen sc1
    v_mfma_f32_16x16x32_bf16 v[228:231], a[164:167], a[124:127], v[228:231]
    ds_read_b64_tr_b16 a[136:137], v58 offset:0
    s_waitcnt lgkmcnt(15)
    v_mfma_f32_16x16x32_bf16 v[136:139], a[168:171], a[112:115], v[136:139]
    ds_read_b64_tr_b16 a[138:139], v58 offset:4096
    s_add_u32 s68, s68, 16384
    v_mfma_f32_16x16x32_bf16 v[168:171], a[168:171], a[116:119], v[168:171]
    v_mfma_f32_16x16x32_bf16 v[200:203], a[168:171], a[120:123], v[200:203]
    ds_read_b64_tr_b16 a[140:141], v59 offset:0
    v_and_b32 v87, 0xffff0000, v83
    v_mfma_f32_16x16x32_bf16 v[232:235], a[168:171], a[124:127], v[232:235]
    ds_read_b64_tr_b16 a[142:143], v59 offset:4096
    s_mov_b32 s83, 196608
    s_add_u32 m0, s3, 90112
    v_lshlrev_b32 v86, 16, v83
    s_waitcnt lgkmcnt(15)
    v_mfma_f32_16x16x32_bf16 v[140:143], a[172:175], a[112:115], v[140:143]
    buffer_load_dwordx4 v17, s[52:55], s83 offen lds
    v_and_b32 v85, 0xffff0000, v82
    v_mfma_f32_16x16x32_bf16 v[172:175], a[172:175], a[116:119], v[172:175]
    ds_read_b64_tr_b16 a[144:145], v60 offset:0
    v_lshlrev_b32 v84, 16, v82
    v_mfma_f32_16x16x32_bf16 v[204:207], a[172:175], a[120:123], v[204:207]
    ds_read_b64_tr_b16 a[146:147], v60 offset:4096
    v_and_b32 v83, 0xffff0000, v81
    v_mfma_f32_16x16x32_bf16 v[236:239], a[172:175], a[124:127], v[236:239]
    v_lshlrev_b32 v82, 16, v81
    s_waitcnt lgkmcnt(15)
    v_mfma_f32_16x16x32_bf16 v[144:147], a[176:179], a[112:115], v[144:147]
    ds_read_b64_tr_b16 a[148:149], v61 offset:0
    buffer_load_dwordx4 v18, s[52:55], s83 offen offset:1024 lds
    v_and_b32 v81, 0xffff0000, v80
    v_mfma_f32_16x16x32_bf16 v[176:179], a[176:179], a[116:119], v[176:179]
    ds_read_b64_tr_b16 a[150:151], v61 offset:4096
    v_lshlrev_b32 v80, 16, v80
    v_mfma_f32_16x16x32_bf16 v[208:211], a[176:179], a[120:123], v[208:211]
    v_lshlrev_b32 v88, 16, v92
    v_mfma_f32_16x16x32_bf16 v[240:243], a[176:179], a[124:127], v[240:243]
    ds_read_b64_tr_b16 a[152:153], v62 offset:0
    v_and_b32 v89, 0xffff0000, v92
    s_waitcnt lgkmcnt(15)
    v_mfma_f32_16x16x32_bf16 v[148:151], a[180:183], a[112:115], v[148:151]
    ds_read_b64_tr_b16 a[154:155], v62 offset:4096
    v_lshlrev_b32 v90, 16, v93
    v_mfma_f32_16x16x32_bf16 v[180:183], a[180:183], a[116:119], v[180:183]
    v_and_b32 v91, 0xffff0000, v93
    v_mfma_f32_16x16x32_bf16 v[212:215], a[180:183], a[120:123], v[212:215]
    ds_read_b64_tr_b16 a[156:157], v63 offset:0
    v_lshlrev_b32 v92, 16, v94
    v_mfma_f32_16x16x32_bf16 v[244:247], a[180:183], a[124:127], v[244:247]
    ds_read_b64_tr_b16 a[158:159], v63 offset:4096
    v_and_b32 v93, 0xffff0000, v94
    v_mfma_f32_16x16x32_bf16 v[152:155], a[184:187], a[112:115], v[152:155]
    v_lshlrev_b32 v94, 16, v95
    v_mfma_f32_16x16x32_bf16 v[184:187], a[184:187], a[116:119], v[184:187]
    v_and_b32 v95, 0xffff0000, v95
    v_mfma_f32_16x16x32_bf16 v[216:219], a[184:187], a[120:123], v[216:219]
    v_mfma_f32_16x16x32_bf16 v[248:251], a[184:187], a[124:127], v[248:251]
    s_waitcnt lgkmcnt(15)
    v_mfma_f32_16x16x32_bf16 v[156:159], a[188:191], a[112:115], v[156:159]
    v_mfma_f32_16x16x32_bf16 v[188:191], a[188:191], a[116:119], v[188:191]
    v_mfma_f32_16x16x32_bf16 v[220:223], a[188:191], a[120:123], v[220:223]
    v_mfma_f32_16x16x32_bf16 v[252:255], a[188:191], a[124:127], v[252:255]
    s_barrier
    s_waitcnt vmcnt(43) lgkmcnt(14)
    v_mfma_f32_16x16x32_bf16 v[128:131], a[128:131], a[0:3], v[128:131]
    buffer_load_dwordx4 a[112:115], v21, s[56:59], s68 offen sc1
    s_waitcnt vmcnt(43)
    v_mfma_f32_16x16x32_bf16 v[160:163], a[128:131], a[4:7], v[160:163]
    ds_read_b64_tr_b16 a[160:161], v56 offset:8192
    s_waitcnt vmcnt(42)
    v_mfma_f32_16x16x32_bf16 v[192:195], a[128:131], a[8:11], v[192:195]
    ds_read_b64_tr_b16 a[162:163], v56 offset:12288
    buffer_load_dwordx4 a[116:119], v22, s[56:59], s68 offen sc1
    s_waitcnt vmcnt(42)
    v_mfma_f32_16x16x32_bf16 v[224:227], a[128:131], a[12:15], v[224:227]
    s_waitcnt lgkmcnt(14)
    v_mfma_f32_16x16x32_bf16 v[132:135], a[132:135], a[0:3], v[132:135]
    ds_read_b64_tr_b16 a[164:165], v57 offset:8192
    buffer_load_dwordx4 a[120:123], v23, s[56:59], s68 offen sc1
    v_mfma_f32_16x16x32_bf16 v[164:167], a[132:135], a[4:7], v[164:167]
    ds_read_b64_tr_b16 a[166:167], v57 offset:12288
    v_mfma_f32_16x16x32_bf16 v[196:199], a[132:135], a[8:11], v[196:199]
    buffer_load_dwordx4 a[124:127], v24, s[56:59], s68 offen sc1
    v_mfma_f32_16x16x32_bf16 v[228:231], a[132:135], a[12:15], v[228:231]
    ds_read_b64_tr_b16 a[168:169], v58 offset:8192
    s_waitcnt lgkmcnt(15)
    v_mfma_f32_16x16x32_bf16 v[136:139], a[136:139], a[0:3], v[136:139]
    ds_read_b64_tr_b16 a[170:171], v58 offset:12288
    s_add_u32 s68, s68, 16384
    v_mfma_f32_16x16x32_bf16 v[168:171], a[136:139], a[4:7], v[168:171]
    v_mfma_f32_16x16x32_bf16 v[200:203], a[136:139], a[8:11], v[200:203]
    ds_read_b64_tr_b16 a[172:173], v59 offset:8192
    v_mfma_f32_16x16x32_bf16 v[232:235], a[136:139], a[12:15], v[232:235]
    ds_read_b64_tr_b16 a[174:175], v59 offset:12288
    s_mov_b32 s82, 262144
    s_add_u32 m0, s3, 98304
    s_waitcnt lgkmcnt(15)
    v_mfma_f32_16x16x32_bf16 v[140:143], a[140:143], a[0:3], v[140:143]
    buffer_load_dwordx4 v17, s[52:55], s82 offen lds
    v_mfma_f32_16x16x32_bf16 v[172:175], a[140:143], a[4:7], v[172:175]
    ds_read_b64_tr_b16 a[176:177], v60 offset:8192
    v_mfma_f32_16x16x32_bf16 v[204:207], a[140:143], a[8:11], v[204:207]
    ds_read_b64_tr_b16 a[178:179], v60 offset:12288
    v_mfma_f32_16x16x32_bf16 v[236:239], a[140:143], a[12:15], v[236:239]
    s_waitcnt lgkmcnt(15)
    v_mfma_f32_16x16x32_bf16 v[144:147], a[144:147], a[0:3], v[144:147]
    ds_read_b64_tr_b16 a[180:181], v61 offset:8192
    buffer_load_dwordx4 v18, s[52:55], s82 offen offset:1024 lds
    v_mfma_f32_16x16x32_bf16 v[176:179], a[144:147], a[4:7], v[176:179]
    ds_read_b64_tr_b16 a[182:183], v61 offset:12288
    v_mfma_f32_16x16x32_bf16 v[208:211], a[144:147], a[8:11], v[208:211]
    v_mfma_f32_16x16x32_bf16 v[240:243], a[144:147], a[12:15], v[240:243]
    ds_read_b64_tr_b16 a[184:185], v62 offset:8192
    s_waitcnt lgkmcnt(15)
    v_mfma_f32_16x16x32_bf16 v[148:151], a[148:151], a[0:3], v[148:151]
    ds_read_b64_tr_b16 a[186:187], v62 offset:12288
    v_mfma_f32_16x16x32_bf16 v[180:183], a[148:151], a[4:7], v[180:183]
    v_mfma_f32_16x16x32_bf16 v[212:215], a[148:151], a[8:11], v[212:215]
    ds_read_b64_tr_b16 a[188:189], v63 offset:8192
    v_mfma_f32_16x16x32_bf16 v[244:247], a[148:151], a[12:15], v[244:247]
    ds_read_b64_tr_b16 a[190:191], v63 offset:12288
    v_mfma_f32_16x16x32_bf16 v[152:155], a[152:155], a[0:3], v[152:155]
    v_mfma_f32_16x16x32_bf16 v[184:187], a[152:155], a[4:7], v[184:187]
    v_mfma_f32_16x16x32_bf16 v[216:219], a[152:155], a[8:11], v[216:219]
    v_mfma_f32_16x16x32_bf16 v[248:251], a[152:155], a[12:15], v[248:251]
    s_waitcnt lgkmcnt(15)
    v_mfma_f32_16x16x32_bf16 v[156:159], a[156:159], a[0:3], v[156:159]
    v_mfma_f32_16x16x32_bf16 v[188:191], a[156:159], a[4:7], v[188:191]
    v_mfma_f32_16x16x32_bf16 v[220:223], a[156:159], a[8:11], v[220:223]
    v_mfma_f32_16x16x32_bf16 v[252:255], a[156:159], a[12:15], v[252:255]
    s_waitcnt vmcnt(43) lgkmcnt(14)
    v_mfma_f32_16x16x32_bf16 v[128:131], a[160:163], a[16:19], v[128:131]
    s_waitcnt vmcnt(37)
    v_readfirstlane_b32 s86, v43
    s_bfe_u32 s86, s86, 0x80010
    s_cmp_eq_u32 s86, 16
    s_cbranch_scc0 L_spC
L_okC:
    buffer_load_dwordx4 a[0:3], v21, s[56:59], s68 offen sc1
    v_mfma_f32_16x16x32_bf16 v[160:163], a[160:163], a[20:23], v[160:163]
    ds_read_b64_tr_b16 a[128:129], v56 offset:16384
    v_mfma_f32_16x16x32_bf16 v[192:195], a[160:163], a[24:27], v[192:195]
    ds_read_b64_tr_b16 a[130:131], v56 offset:20480
    buffer_load_dwordx4 a[4:7], v22, s[56:59], s68 offen sc1
    v_mfma_f32_16x16x32_bf16 v[224:227], a[160:163], a[28:31], v[224:227]
    s_waitcnt lgkmcnt(14)
    v_mfma_f32_16x16x32_bf16 v[132:135], a[164:167], a[16:19], v[132:135]
    ds_read_b64_tr_b16 a[132:133], v57 offset:16384
    buffer_load_dwordx4 a[8:11], v23, s[56:59], s68 offen sc1
    v_mfma_f32_16x16x32_bf16 v[164:167], a[164:167], a[20:23], v[164:167]
    ds_read_b64_tr_b16 a[134:135], v57 offset:20480
    v_mfma_f32_16x16x32_bf16 v[196:199], a[164:167], a[24:27], v[196:199]
    buffer_load_dwordx4 a[12:15], v24, s[56:59], s68 offen sc1
    v_mfma_f32_16x16x32_bf16 v[228:231], a[164:167], a[28:31], v[228:231]
    ds_read_b64_tr_b16 a[136:137], v58 offset:16384
    s_waitcnt lgkmcnt(15)
    v_mfma_f32_16x16x32_bf16 v[136:139], a[168:171], a[16:19], v[136:139]
    ds_read_b64_tr_b16 a[138:139], v58 offset:20480
    s_add_u32 s68, s68, 16384
    v_mfma_f32_16x16x32_bf16 v[168:171], a[168:171], a[20:23], v[168:171]
    v_mfma_f32_16x16x32_bf16 v[200:203], a[168:171], a[24:27], v[200:203]
    ds_read_b64_tr_b16 a[140:141], v59 offset:16384
    v_mfma_f32_16x16x32_bf16 v[232:235], a[168:171], a[28:31], v[232:235]
    ds_read_b64_tr_b16 a[142:143], v59 offset:20480
    s_mov_b32 s83, 327680
    s_add_u32 m0, s3, 106496
    s_waitcnt lgkmcnt(15)
    v_mfma_f32_16x16x32_bf16 v[140:143], a[172:175], a[16:19], v[140:143]
    buffer_load_dwordx4 v17, s[52:55], s83 offen lds
    v_mfma_f32_16x16x32_bf16 v[172:175], a[172:175], a[20:23], v[172:175]
    ds_read_b64_tr_b16 a[144:145], v60 offset:16384
    v_mfma_f32_16x16x32_bf16 v[204:207], a[172:175], a[24:27], v[204:207]
    ds_read_b64_tr_b16 a[146:147], v60 offset:20480
    v_mfma_f32_16x16x32_bf16 v[236:239], a[172:175], a[28:31], v[236:239]
    s_waitcnt lgkmcnt(15)
    v_mfma_f32_16x16x32_bf16 v[144:147], a[176:179], a[16:19], v[144:147]
    ds_read_b64_tr_b16 a[148:149], v61 offset:16384
    buffer_load_dwordx4 v18, s[52:55], s83 offen offset:1024 lds
    v_mfma_f32_16x16x32_bf16 v[176:179], a[176:179], a[20:23], v[176:179]
    ds_read_b64_tr_b16 a[150:151], v61 offset:20480
    v_mfma_f32_16x16x32_bf16 v[208:211], a[176:179], a[24:27], v[208:211]
    v_mfma_f32_16x16x32_bf16 v[240:243], a[176:179], a[28:31], v[240:243]
    ds_read_b64_tr_b16 a[152:153], v62 offset:16384
    s_waitcnt lgkmcnt(15)
    v_mfma_f32_16x16x32_bf16 v[148:151], a[180:183], a[16:19], v[148:151]
    ds_read_b64_tr_b16 a[154:155], v62 offset:20480
    v_mfma_f32_16x16x32_bf16 v[180:183], a[180:183], a[20:23], v[180:183]
    v_mfma_f32_16x16x32_bf16 v[212:215], a[180:183], a[24:27], v[212:215]
    ds_read_b64_tr_b16 a[156:157], v63 offset:16384
    v_mfma_f32_16x16x32_bf16 v[244:247], a[180:183], a[28:31], v[244:247]
    ds_read_b64_tr_b16 a[158:159], v63 offset:20480
    v_mfma_f32_16x16x32_bf16 v[152:155], a[184:187], a[16:19], v[152:155]
    v_mfma_f32_16x16x32_bf16 v[184:187], a[184:187], a[20:23], v[184:187]
    v_mfma_f32_16x16x32_bf16 v[216:219], a[184:187], a[24:27], v[216:219]
    v_mfma_f32_16x16x32_bf16 v[248:251], a[184:187], a[28:31], v[248:251]
    s_waitcnt lgkmcnt(15)
    v_mfma_f32_16x16x32_bf16 v[156:159], a[188:191], a[16:19], v[156:159]
    v_mfma_f32_16x16x32_bf16 v[188:191], a[188:191], a[20:23], v[188:191]
    v_mfma_f32_16x16x32_bf16 v[220:223], a[188:191], a[24:27], v[220:223]
    v_mfma_f32_16x16x32_bf16 v[252:255], a[188:191], a[28:31], v[252:255]
    s_waitcnt vmcnt(42) lgkmcnt(14)
    v_mfma_f32_16x16x32_bf16 v[128:131], a[128:131], a[32:35], v[128:131]
    buffer_load_dwordx4 a[16:19], v21, s[56:59], s68 offen sc1
    s_waitcnt vmcnt(42)
    v_mfma_f32_16x16x32_bf16 v[160:163], a[128:131], a[36:39], v[160:163]
    ds_read_b64_tr_b16 a[160:161], v56 offset:24576
    s_waitcnt vmcnt(41)
    v_mfma_f32_16x16x32_bf16 v[192:195], a[128:131], a[40:43], v[192:195]
    ds_read_b64_tr_b16 a[162:163], v56 offset:28672
    buffer_load_dwordx4 a[20:23], v22, s[56:59], s68 offen sc1
    s_waitcnt vmcnt(41)
    v_mfma_f32_16x16x32_bf16 v[224:227], a[128:131], a[44:47], v[224:227]
    s_waitcnt lgkmcnt(14)
    v_mfma_f32_16x16x32_bf16 v[132:135], a[132:135], a[32:35], v[132:135]
    ds_read_b64_tr_b16 a[164:165], v57 offset:24576
    buffer_load_dwordx4 a[24:27], v23, s[56:59], s68 offen sc1
    v_mfma_f32_16x16x32_bf16 v[164:167], a[132:135], a[36:39], v[164:167]
    ds_read_b64_tr_b16 a[166:167], v57 offset:28672
    v_mfma_f32_16x16x32_bf16 v[196:199], a[132:135], a[40:43], v[196:199]
    buffer_load_dwordx4 a[28:31], v24, s[56:59], s68 offen sc1
    v_mfma_f32_16x16x32_bf16 v[228:231], a[132:135], a[44:47], v[228:231]
    ds_read_b64_tr_b16 a[168:169], v58 offset:24576
    s_waitcnt lgkmcnt(15)
    v_mfma_f32_16x16x32_bf16 v[136:139], a[136:139], a[32:35], v[136:139]
    ds_read_b64_tr_b16 a[170:171], v58 offset:28672
    s_add_u32 s68, s68, 16384
    v_mfma_f32_16x16x32_bf16 v[168:171], a[136:139], a[36:39], v[168:171]
    v_mfma_f32_16x16x32_bf16 v[200:203], a[136:139], a[40:43], v[200:203]
    ds_read_b64_tr_b16 a[172:173], v59 offset:24576
    v_mfma_f32_16x16x32_bf16 v[232:235], a[136:139], a[44:47], v[232:235]
    ds_read_b64_tr_b16 a[174:175], v59 offset:28672
    s_mov_b32 s82, 393216
    s_add_u32 m0, s3, 114688
    s_waitcnt lgkmcnt(15)
    v_mfma_f32_16x16x32_bf16 v[140:143], a[140:143], a[32:35], v[140:143]
    buffer_load_dwordx4 v17, s[52:55], s82 offen lds
    v_mfma_f32_16x16x32_bf16 v[172:175], a[140:143], a[36:39], v[172:175]
    ds_read_b64_tr_b16 a[176:177], v60 offset:24576
    v_mfma_f32_16x16x32_bf16 v[204:207], a[140:143], a[40:43], v[204:207]
    ds_read_b64_tr_b16 a[178:179], v60 offset:28672
    v_mfma_f32_16x16x32_bf16 v[236:239], a[140:143], a[44:47], v[236:239]
    s_waitcnt lgkmcnt(15)
    v_mfma_f32_16x16x32_bf16 v[144:147], a[144:147], a[32:35], v[144:147]
    ds_read_b64_tr_b16 a[180:181], v61 offset:24576
    buffer_load_dwordx4 v18, s[52:55], s82 offen offset:1024 lds
    s_branch L_over10
L_stub10:
    s_branch L_stubret
L_over10:
    v_mfma_f32_16x16x32_bf16 v[176:179], a[144:147], a[36:39], v[176:179]
    ds_read_b64_tr_b16 a[182:183], v61 offset:28672
    v_mfma_f32_16x16x32_bf16 v[208:211], a[144:147], a[40:43], v[208:211]
    v_mfma_f32_16x16x32_bf16 v[240:243], a[144:147], a[44:47], v[240:243]
    ds_read_b64_tr_b16 a[184:185], v62 offset:24576
    s_waitcnt lgkmcnt(15)
    v_mfma_f32_16x16x32_bf16 v[148:151], a[148:151], a[32:35], v[148:151]
    ds_read_b64_tr_b16 a[186:187], v62 offset:28672
    v_mfma_f32_16x16x32_bf16 v[180:183], a[148:151], a[36:39], v[180:183]
    v_mfma_f32_16x16x32_bf16 v[212:215], a[148:151], a[40:43], v[212:215]
    ds_read_b64_tr_b16 a[188:189], v63 offset:24576
    v_mfma_f32_16x16x32_bf16 v[244:247], a[148:151], a[44:47], v[244:247]
    ds_read_b64_tr_b16 a[190:191], v63 offset:28672
    v_mfma_f32_16x16x32_bf16 v[152:155], a[152:155], a[32:35], v[152:155]
    v_mfma_f32_16x16x32_bf16 v[184:187], a[152:155], a[36:39], v[184:187]
    v_mfma_f32_16x16x32_bf16 v[216:219], a[152:155], a[40:43], v[216:219]
    v_mfma_f32_16x16x32_bf16 v[248:251], a[152:155], a[44:47], v[248:251]
    s_waitcnt lgkmcnt(15)
    v_mfma_f32_16x16x32_bf16 v[156:159], a[156:159], a[32:35], v[156:159]
    v_mfma_f32_16x16x32_bf16 v[188:191], a[156:159], a[36:39], v[188:191]
    v_mfma_f32_16x16x32_bf16 v[220:223], a[156:159], a[40:43], v[220:223]
    v_mfma_f32_16x16x32_bf16 v[252:255], a[156:159], a[44:47], v[252:255]
    s_waitcnt vmcnt(42) lgkmcnt(14)
    v_mfma_f32_16x16x32_bf16 v[128:131], a[160:163], a[48:51], v[128:131]
    buffer_load_dwordx4 a[32:35], v21, s[56:59], s68 offen sc1
    s_waitcnt vmcnt(42)
    v_mfma_f32_16x16x32_bf16 v[160:163], a[160:163], a[52:55], v[160:163]
    ds_read_b64_tr_b16 a[128:129], v8 offset:0
    s_waitcnt vmcnt(41)
    v_mfma_f32_16x16x32_bf16 v[192:195], a[160:163], a[56:59], v[192:195]
    ds_read_b64_tr_b16 a[130:131], v8 offset:4096
    buffer_load_dwordx4 a[36:39], v22, s[56:59], s68 offen sc1
    s_waitcnt vmcnt(41)
    v_mfma_f32_16x16x32_bf16 v[224:227], a[160:163], a[60:63], v[224:227]
    s_waitcnt lgkmcnt(14)
    v_mfma_f32_16x16x32_bf16 v[132:135], a[164:167], a[48:51], v[132:135]
    ds_read_b64_tr_b16 a[132:133], v9 offset:0
    buffer_load_dwordx4 a[40:43], v23, s[56:59], s68 offen sc1
    v_mfma_f32_16x16x32_bf16 v[164:167], a[164:167], a[52:55], v[164:167]
    ds_read_b64_tr_b16 a[134:135], v9 offset:4096
    v_mfma_f32_16x16x32_bf16 v[196:199], a[164:167], a[56:59], v[196:199]
    buffer_load_dwordx4 a[44:47], v24, s[56:59], s68 offen sc1
    v_mfma_f32_16x16x32_bf16 v[228:231], a[164:167], a[60:63], v[228:231]
    ds_read_b64_tr_b16 a[136:137], v10 offset:0
    s_waitcnt lgkmcnt(15)
    v_mfma_f32_16x16x32_bf16 v[136:139], a[168:171], a[48:51], v[136:139]
    ds_read_b64_tr_b16 a[138:139], v10 offset:4096
    s_add_u32 s68, s68, 16384
    v_mfma_f32_16x16x32_bf16 v[168:171], a[168:171], a[52:55], v[168:171]
    v_mfma_f32_16x16x32_bf16 v[200:203], a[168:171], a[56:59], v[200:203]
    ds_read_b64_tr_b16 a[140:141], v11 offset:0
    v_mfma_f32_16x16x32_bf16 v[232:235], a[168:171], a[60:63], v[232:235]
    ds_read_b64_tr_b16 a[142:143], v11 offset:4096
    s_mov_b32 s83, 458752
    s_add_u32 m0, s3, 122880
    s_waitcnt lgkmcnt(15)
    v_mfma_f32_16x16x32_bf16 v[140:143], a[172:175], a[48:51], v[140:143]
    buffer_load_dwordx4 v17, s[52:55], s83 offen lds
    v_mfma_f32_16x16x32_bf16 v[172:175], a[172:175], a[52:55], v[172:175]
    ds_read_b64_tr_b16 a[144:145], v12 offset:0
    v_mfma_f32_16x16x32_bf16 v[204:207], a[172:175], a[56:59], v[204:207]
    ds_read_b64_tr_b16 a[146:147], v12 offset:4096
    v_mfma_f32_16x16x32_bf16 v[236:239], a[172:175], a[60:63], v[236:239]
    s_waitcnt lgkmcnt(15)
    v_mfma_f32_16x16x32_bf16 v[144:147], a[176:179], a[48:51], v[144:147]
    ds_read_b64_tr_b16 a[148:149], v13 offset:0
    buffer_load_dwordx4 v18, s[52:55], s83 offen offset:1024 lds
    v_mfma_f32_16x16x32_bf16 v[176:179], a[176:179], a[52:55], v[176:179]
    ds_read_b64_tr_b16 a[150:151], v13 offset:4096
    v_mfma_f32_16x16x32_bf16 v[208:211], a[176:179], a[56:59], v[208:211]
    v_mfma_f32_16x16x32_bf16 v[240:243], a[176:179], a[60:63], v[240:243]
    ds_read_b64_tr_b16 a[152:153], v14 offset:0
    s_waitcnt lgkmcnt(15)
    v_mfma_f32_16x16x32_bf16 v[148:151], a[180:183], a[48:51], v[148:151]
    ds_read_b64_tr_b16 a[154:155], v14 offset:4096
    v_mfma_f32_16x16x32_bf16 v[180:183], a[180:183], a[52:55], v[180:183]
    v_mfma_f32_16x16x32_bf16 v[212:215], a[180:183], a[56:59], v[212:215]
    ds_read_b64_tr_b16 a[156:157], v15 offset:0
    v_mfma_f32_16x16x32_bf16 v[244:247], a[180:183], a[60:63], v[244:247]
    ds_read_b64_tr_b16 a[158:159], v15 offset:4096
    v_mfma_f32_16x16x32_bf16 v[152:155], a[184:187], a[48:51], v[152:155]
    v_mfma_f32_16x16x32_bf16 v[184:187], a[184:187], a[52:55], v[184:187]
    v_mfma_f32_16x16x32_bf16 v[216:219], a[184:187], a[56:59], v[216:219]
    v_mfma_f32_16x16x32_bf16 v[248:251], a[184:187], a[60:63], v[248:251]
    s_waitcnt lgkmcnt(15)
    v_mfma_f32_16x16x32_bf16 v[156:159], a[188:191], a[48:51], v[156:159]
    v_mfma_f32_16x16x32_bf16 v[188:191], a[188:191], a[52:55], v[188:191]
    v_mfma_f32_16x16x32_bf16 v[220:223], a[188:191], a[56:59], v[220:223]
    v_mfma_f32_16x16x32_bf16 v[252:255], a[188:191], a[60:63], v[252:255]
    s_barrier
    s_waitcnt vmcnt(42) lgkmcnt(14)
    v_mfma_f32_16x16x32_bf16 v[128:131], a[128:131], a[64:67], v[128:131]
    buffer_load_dwordx4 a[48:51], v21, s[56:59], s68 offen sc1
    s_waitcnt vmcnt(42)
    v_mfma_f32_16x16x32_bf16 v[160:163], a[128:131], a[68:71], v[160:163]
    ds_read_b64_tr_b16 a[160:161], v8 offset:8192
    s_waitcnt vmcnt(41)
    v_mfma_f32_16x16x32_bf16 v[192:195], a[128:131], a[72:75], v[192:195]
    ds_read_b64_tr_b16 a[162:163], v8 offset:12288
    buffer_load_dwordx4 a[52:55], v22, s[56:59], s68 offen sc1
    s_waitcnt vmcnt(41)
    v_mfma_f32_16x16x32_bf16 v[224:227], a[128:131], a[76:79], v[224:227]
    s_waitcnt lgkmcnt(14)
    v_mfma_f32_16x16x32_bf16 v[132:135], a[132:135], a[64:67], v[132:135]
    ds_read_b64_tr_b16 a[164:165], v9 offset:8192
    buffer_load_dwordx4 a[56:59], v23, s[56:59], s68 offen sc1
    v_mfma_f32_16x16x32_bf16 v[164:167], a[132:135], a[68:71], v[164:167]
    ds_read_b64_tr_b16 a[166:167], v9 offset:12288
    v_mfma_f32_16x16x32_bf16 v[196:199], a[132:135], a[72:75], v[196:199]
    buffer_load_dwordx4 a[60:63], v24, s[56:59], s68 offen sc1
    v_mfma_f32_16x16x32_bf16 v[228:231], a[132:135], a[76:79], v[228:231]
    ds_read_b64_tr_b16 a[168:169], v10 offset:8192
    s_waitcnt lgkmcnt(15)
    v_mfma_f32_16x16x32_bf16 v[136:139], a[136:139], a[64:67], v[136:139]
    ds_read_b64_tr_b16 a[170:171], v10 offset:12288
    s_add_u32 s68, s68, 16384
    v_mfma_f32_16x16x32_bf16 v[168:171], a[136:139], a[68:71], v[168:171]
    v_mfma_f32_16x16x32_bf16 v[200:203], a[136:139], a[72:75], v[200:203]
    ds_read_b64_tr_b16 a[172:173], v11 offset:8192
    v_mfma_f32_16x16x32_bf16 v[232:235], a[136:139], a[76:79], v[232:235]
    ds_read_b64_tr_b16 a[174:175], v11 offset:12288
    s_mov_b32 s82, 524288
    s_add_u32 m0, s3, 131072
    s_waitcnt lgkmcnt(15)
    v_mfma_f32_16x16x32_bf16 v[140:143], a[140:143], a[64:67], v[140:143]
    buffer_load_dwordx4 v17, s[52:55], s82 offen lds
    v_mfma_f32_16x16x32_bf16 v[172:175], a[140:143], a[68:71], v[172:175]
    ds_read_b64_tr_b16 a[176:177], v12 offset:8192
    v_mfma_f32_16x16x32_bf16 v[204:207], a[140:143], a[72:75], v[204:207]
    ds_read_b64_tr_b16 a[178:179], v12 offset:12288
    v_mfma_f32_16x16x32_bf16 v[236:239], a[140:143], a[76:79], v[236:239]
    s_waitcnt lgkmcnt(15)
    v_mfma_f32_16x16x32_bf16 v[144:147], a[144:147], a[64:67], v[144:147]
    ds_read_b64_tr_b16 a[180:181], v13 offset:8192
    buffer_load_dwordx4 v18, s[52:55], s82 offen offset:1024 lds
    v_mfma_f32_16x16x32_bf16 v[176:179], a[144:147], a[68:71], v[176:179]
    ds_read_b64_tr_b16 a[182:183], v13 offset:12288
    v_mfma_f32_16x16x32_bf16 v[208:211], a[144:147], a[72:75], v[208:211]
    v_mfma_f32_16x16x32_bf16 v[240:243], a[144:147], a[76:79], v[240:243]
    ds_read_b64_tr_b16 a[184:185], v14 offset:8192
    s_waitcnt lgkmcnt(15)
    v_mfma_f32_16x16x32_bf16 v[148:151], a[148:151], a[64:67], v[148:151]
    ds_read_b64_tr_b16 a[186:187], v14 offset:12288
    v_mfma_f32_16x16x32_bf16 v[180:183], a[148:151], a[68:71], v[180:183]
    v_mfma_f32_16x16x32_bf16 v[212:215], a[148:151], a[72:75], v[212:215]
    ds_read_b64_tr_b16 a[188:189], v15 offset:8192
    v_mfma_f32_16x16x32_bf16 v[244:247], a[148:151], a[76:79], v[244:247]
    ds_read_b64_tr_b16 a[190:191], v15 offset:12288
    v_mfma_f32_16x16x32_bf16 v[152:155], a[152:155], a[64:67], v[152:155]
    v_mfma_f32_16x16x32_bf16 v[184:187], a[152:155], a[68:71], v[184:187]
    v_mfma_f32_16x16x32_bf16 v[216:219], a[152:155], a[72:75], v[216:219]
    v_mfma_f32_16x16x32_bf16 v[248:251], a[152:155], a[76:79], v[248:251]
    s_waitcnt lgkmcnt(15)
    v_mfma_f32_16x16x32_bf16 v[156:159], a[156:159], a[64:67], v[156:159]
    v_mfma_f32_16x16x32_bf16 v[188:191], a[156:159], a[68:71], v[188:191]
    v_mfma_f32_16x16x32_bf16 v[220:223], a[156:159], a[72:75], v[220:223]
    v_mfma_f32_16x16x32_bf16 v[252:255], a[156:159], a[76:79], v[252:255]
    s_waitcnt vmcnt(41) lgkmcnt(14)
    v_mfma_f32_16x16x32_bf16 v[128:131], a[160:163], a[80:83], v[128:131]
    v_readfirstlane_b32 s86, v44
    s_cmp_eq_u32 s86, 64
    s_cbranch_scc0 L_spO
L_okO:
    buffer_load_dwordx4 a[64:67], v16, s[56:59], s69 offen offset:0 sc1
    s_waitcnt vmcnt(41)
    v_mfma_f32_16x16x32_bf16 v[160:163], a[160:163], a[84:87], v[160:163]
    ds_read_b64_tr_b16 a[128:129], v8 offset:16384
    s_waitcnt vmcnt(40)
    v_mfma_f32_16x16x32_bf16 v[192:195], a[160:163], a[88:91], v[192:195]
    ds_read_b64_tr_b16 a[130:131], v8 offset:20480
    buffer_load_dwordx4 a[68:71], v16, s[56:59], s69 offen offset:1024 sc1
    s_waitcnt vmcnt(40)
    v_mfma_f32_16x16x32_bf16 v[224:227], a[160:163], a[92:95], v[224:227]
    s_waitcnt lgkmcnt(14)
    v_mfma_f32_16x16x32_bf16 v[132:135], a[164:167], a[80:83], v[132:135]
    ds_read_b64_tr_b16 a[132:133], v9 offset:16384
    buffer_load_dwordx4 a[72:75], v16, s[56:59], s69 offen offset:2048 sc1
    v_mfma_f32_16x16x32_bf16 v[164:167], a[164:167], a[84:87], v[164:167]
    ds_read_b64_tr_b16 a[134:135], v9 offset:20480
    v_mfma_f32_16x16x32_bf16 v[196:199], a[164:167], a[88:91], v[196:199]
    buffer_load_dwordx4 a[76:79], v16, s[56:59], s69 offen offset:3072 sc1
    v_mfma_f32_16x16x32_bf16 v[228:231], a[164:167], a[92:95], v[228:231]
    ds_read_b64_tr_b16 a[136:137], v10 offset:16384
    s_waitcnt lgkmcnt(15)
    v_mfma_f32_16x16x32_bf16 v[136:139], a[168:171], a[80:83], v[136:139]
    ds_read_b64_tr_b16 a[138:139], v10 offset:20480
    s_add_u32 s69, s69, 4096
    v_mfma_f32_16x16x32_bf16 v[168:171], a[168:171], a[84:87], v[168:171]
    v_mfma_f32_16x16x32_bf16 v[200:203], a[168:171], a[88:91], v[200:203]
    ds_read_b64_tr_b16 a[140:141], v11 offset:16384
    v_mfma_f32_16x16x32_bf16 v[232:235], a[168:171], a[92:95], v[232:235]
    ds_read_b64_tr_b16 a[142:143], v11 offset:20480
    s_mov_b32 s83, 589824
    s_add_u32 m0, s3, 139264
    s_waitcnt lgkmcnt(15)
    v_mfma_f32_16x16x32_bf16 v[140:143], a[172:175], a[80:83], v[140:143]
    buffer_load_dwordx4 v17, s[52:55], s83 offen lds
    v_mfma_f32_16x16x32_bf16 v[172:175], a[172:175], a[84:87], v[172:175]
    ds_read_b64_tr_b16 a[144:145], v12 offset:16384
    v_mfma_f32_16x16x32_bf16 v[204:207], a[172:175], a[88:91], v[204:207]
    ds_read_b64_tr_b16 a[146:147], v12 offset:20480
    v_mfma_f32_16x16x32_bf16 v[236:239], a[172:175], a[92:95], v[236:239]
    s_waitcnt lgkmcnt(15)
    v_mfma_f32_16x16x32_bf16 v[144:147], a[176:179], a[80:83], v[144:147]
    ds_read_b64_tr_b16 a[148:149], v13 offset:16384
    buffer_load_dwordx4 v18, s[52:55], s83 offen offset:1024 lds
    v_mfma_f32_16x16x32_bf16 v[176:179], a[176:179], a[84:87], v[176:179]
    ds_read_b64_tr_b16 a[150:151], v13 offset:20480
    v_mfma_f32_16x16x32_bf16 v[208:211], a[176:179], a[88:91], v[208:211]
    v_mfma_f32_16x16x32_bf16 v[240:243], a[176:179], a[92:95], v[240:243]
    ds_read_b64_tr_b16 a[152:153], v14 offset:16384
    s_waitcnt lgkmcnt(15)
    v_mfma_f32_16x16x32_bf16 v[148:151], a[180:183], a[80:83], v[148:151]
    ds_read_b64_tr_b16 a[154:155], v14 offset:20480
    v_mfma_f32_16x16x32_bf16 v[180:183], a[180:183], a[84:87], v[180:183]
    v_mfma_f32_16x16x32_bf16 v[212:215], a[180:183], a[88:91], v[212:215]
    ds_read_b64_tr_b16 a[156:157], v15 offset:16384
    v_mfma_f32_16x16x32_bf16 v[244:247], a[180:183], a[92:95], v[244:247]
    ds_read_b64_tr_b16 a[158:159], v15 offset:20480
    v_mfma_f32_16x16x32_bf16 v[152:155], a[184:187], a[80:83], v[152:155]
    v_mfma_f32_16x16x32_bf16 v[184:187], a[184:187], a[84:87], v[184:187]
    v_mfma_f32_16x16x32_bf16 v[216:219], a[184:187], a[88:91], v[216:219]
    v_mfma_f32_16x16x32_bf16 v[248:251], a[184:187], a[92:95], v[248:251]
    s_waitcnt lgkmcnt(15)
    v_mfma_f32_16x16x32_bf16 v[156:159], a[188:191], a[80:83], v[156:159]
    v_mfma_f32_16x16x32_bf16 v[188:191], a[188:191], a[84:87], v[188:191]
    v_mfma_f32_16x16x32_bf16 v[220:223], a[188:191], a[88:91], v[220:223]
    v_mfma_f32_16x16x32_bf16 v[252:255], a[188:191], a[92:95], v[252:255]
    s_waitcnt vmcnt(41) lgkmcnt(14)
    v_mfma_f32_16x16x32_bf16 v[128:131], a[128:131], a[96:99], v[128:131]
    buffer_load_dwordx4 a[80:83], v16, s[56:59], s69 offen offset:0 sc1
    s_waitcnt vmcnt(41)
    v_mfma_f32_16x16x32_bf16 v[160:163], a[128:131], a[100:103], v[160:163]
    ds_read_b64_tr_b16 a[160:161], v8 offset:24576
    s_waitcnt vmcnt(40)
    v_mfma_f32_16x16x32_bf16 v[192:195], a[128:131], a[104:107], v[192:195]
    ds_read_b64_tr_b16 a[162:163], v8 offset:28672
    buffer_load_dwordx4 a[84:87], v16, s[56:59], s69 offen offset:1024 sc1
    s_waitcnt vmcnt(40)
    v_mfma_f32_16x16x32_bf16 v[224:227], a[128:131], a[108:111], v[224:227]
    s_waitcnt lgkmcnt(14)
    v_mfma_f32_16x16x32_bf16 v[132:135], a[132:135], a[96:99], v[132:135]
    ds_read_b64_tr_b16 a[164:165], v9 offset:24576
    buffer_load_dwordx4 a[88:91], v16, s[56:59], s69 offen offset:2048 sc1
    v_mfma_f32_16x16x32_bf16 v[164:167], a[132:135], a[100:103], v[164:167]
    ds_read_b64_tr_b16 a[166:167], v9 offset:28672
    v_mfma_f32_16x16x32_bf16 v[196:199], a[132:135], a[104:107], v[196:199]
    buffer_load_dwordx4 a[92:95], v16, s[56:59], s69 offen offset:3072 sc1
    v_mfma_f32_16x16x32_bf16 v[228:231], a[132:135], a[108:111], v[228:231]
    ds_read_b64_tr_b16 a[168:169], v10 offset:24576
    s_waitcnt lgkmcnt(15)
    v_mfma_f32_16x16x32_bf16 v[136:139], a[136:139], a[96:99], v[136:139]
    ds_read_b64_tr_b16 a[170:171], v10 offset:28672
    s_add_u32 s69, s69, 4096
    v_mfma_f32_16x16x32_bf16 v[168:171], a[136:139], a[100:103], v[168:171]
    v_mfma_f32_16x16x32_bf16 v[200:203], a[136:139], a[104:107], v[200:203]
    ds_read_b64_tr_b16 a[172:173], v11 offset:24576
    v_mfma_f32_16x16x32_bf16 v[232:235], a[136:139], a[108:111], v[232:235]
    ds_read_b64_tr_b16 a[174:175], v11 offset:28672
    s_mov_b32 s82, 655360
    s_add_u32 m0, s3, 147456
    s_waitcnt lgkmcnt(15)
    v_mfma_f32_16x16x32_bf16 v[140:143], a[140:143], a[96:99], v[140:143]
    buffer_load_dwordx4 v17, s[52:55], s82 offen lds
    v_mfma_f32_16x16x32_bf16 v[172:175], a[140:143], a[100:103], v[172:175]
    ds_read_b64_tr_b16 a[176:177], v12 offset:24576
    v_mfma_f32_16x16x32_bf16 v[204:207], a[140:143], a[104:107], v[204:207]
    ds_read_b64_tr_b16 a[178:179], v12 offset:28672
    v_mfma_f32_16x16x32_bf16 v[236:239], a[140:143], a[108:111], v[236:239]
    s_waitcnt lgkmcnt(15)
    v_mfma_f32_16x16x32_bf16 v[144:147], a[144:147], a[96:99], v[144:147]
    ds_read_b64_tr_b16 a[180:181], v13 offset:24576
    buffer_load_dwordx4 v18, s[52:55], s82 offen offset:1024 lds
    v_mfma_f32_16x16x32_bf16 v[176:179], a[144:147], a[100:103], v[176:179]
    ds_read_b64_tr_b16 a[182:183], v13 offset:28672
    v_mfma_f32_16x16x32_bf16 v[208:211], a[144:147], a[104:107], v[208:211]
    v_mfma_f32_16x16x32_bf16 v[240:243], a[144:147], a[108:111], v[240:243]
    ds_read_b64_tr_b16 a[184:185], v14 offset:24576
    s_waitcnt lgkmcnt(15)
    v_mfma_f32_16x16x32_bf16 v[148:151], a[148:151], a[96:99], v[148:151]
    ds_read_b64_tr_b16 a[186:187], v14 offset:28672
    v_mfma_f32_16x16x32_bf16 v[180:183], a[148:151], a[100:103], v[180:183]
    v_mfma_f32_16x16x32_bf16 v[212:215], a[148:151], a[104:107], v[212:215]
    ds_read_b64_tr_b16 a[188:189], v15 offset:24576
    v_mfma_f32_16x16x32_bf16 v[244:247], a[148:151], a[108:111], v[244:247]
    ds_read_b64_tr_b16 a[190:191], v15 offset:28672
    v_mfma_f32_16x16x32_bf16 v[152:155], a[152:155], a[96:99], v[152:155]
    v_mfma_f32_16x16x32_bf16 v[184:187], a[152:155], a[100:103], v[184:187]
    v_mfma_f32_16x16x32_bf16 v[216:219], a[152:155], a[104:107], v[216:219]
    v_mfma_f32_16x16x32_bf16 v[248:251], a[152:155], a[108:111], v[248:251]
    s_waitcnt lgkmcnt(15)
    v_mfma_f32_16x16x32_bf16 v[156:159], a[156:159], a[96:99], v[156:159]
    v_mfma_f32_16x16x32_bf16 v[188:191], a[156:159], a[100:103], v[188:191]
    v_mfma_f32_16x16x32_bf16 v[220:223], a[156:159], a[104:107], v[220:223]
    v_mfma_f32_16x16x32_bf16 v[252:255], a[156:159], a[108:111], v[252:255]
    s_waitcnt vmcnt(41) lgkmcnt(14)
    v_mfma_f32_16x16x32_bf16 v[128:131], a[160:163], a[112:115], v[128:131]
    buffer_load_dwordx4 a[96:99], v16, s[56:59], s69 offen offset:0 sc1
    s_waitcnt vmcnt(41)
    v_mfma_f32_16x16x32_bf16 v[160:163], a[160:163], a[116:119], v[160:163]
    ds_read_b64_tr_b16 a[128:129], v8 offset:32768
    s_waitcnt vmcnt(40)
    v_mfma_f32_16x16x32_bf16 v[192:195], a[160:163], a[120:123], v[192:195]
    ds_read_b64_tr_b16 a[130:131], v8 offset:36864
    buffer_load_dwordx4 a[100:103], v16, s[56:59], s69 offen offset:1024 sc1
    s_waitcnt vmcnt(40)
    v_mfma_f32_16x16x32_bf16 v[224:227], a[160:163], a[124:127], v[224:227]
    s_waitcnt lgkmcnt(14)
    v_mfma_f32_16x16x32_bf16 v[132:135], a[164:167], a[112:115], v[132:135]
    ds_read_b64_tr_b16 a[132:133], v9 offset:32768
    buffer_load_dwordx4 a[104:107], v16, s[56:59], s69 offen offset:2048 sc1
    v_mfma_f32_16x16x32_bf16 v[164:167], a[164:167], a[116:119], v[164:167]
    ds_read_b64_tr_b16 a[134:135], v9 offset:36864
    v_mfma_f32_16x16x32_bf16 v[196:199], a[164:167], a[120:123], v[196:199]
    buffer_load_dwordx4 a[108:111], v16, s[56:59], s69 offen offset:3072 sc1
    v_mfma_f32_16x16x32_bf16 v[228:231], a[164:167], a[124:127], v[228:231]
    ds_read_b64_tr_b16 a[136:137], v10 offset:32768
    s_waitcnt lgkmcnt(15)
    v_mfma_f32_16x16x32_bf16 v[136:139], a[168:171], a[112:115], v[136:139]
    ds_read_b64_tr_b16 a[138:139], v10 offset:36864
    s_add_u32 s69, s69, 4096
    v_mfma_f32_16x16x32_bf16 v[168:171], a[168:171], a[116:119], v[168:171]
    v_mfma_f32_16x16x32_bf16 v[200:203], a[168:171], a[120:123], v[200:203]
    ds_read_b64_tr_b16 a[140:141], v11 offset:32768
    v_mfma_f32_16x16x32_bf16 v[232:235], a[168:171], a[124:127], v[232:235]
    ds_read_b64_tr_b16 a[142:143], v11 offset:36864
    s_mov_b32 s83, 720896
    s_add_u32 m0, s3, 155648
    s_waitcnt lgkmcnt(15)
    v_mfma_f32_16x16x32_bf16 v[140:143], a[172:175], a[112:115], v[140:143]
    buffer_load_dwordx4 v17, s[52:55], s83 offen lds
    v_mfma_f32_16x16x32_bf16 v[172:175], a[172:175], a[116:119], v[172:175]
    ds_read_b64_tr_b16 a[144:145], v12 offset:32768
    v_mfma_f32_16x16x32_bf16 v[204:207], a[172:175], a[120:123], v[204:207]
    ds_read_b64_tr_b16 a[146:147], v12 offset:36864
    v_mfma_f32_16x16x32_bf16 v[236:239], a[172:175], a[124:127], v[236:239]
    s_waitcnt lgkmcnt(15)
    v_mfma_f32_16x16x32_bf16 v[144:147], a[176:179], a[112:115], v[144:147]
    ds_read_b64_tr_b16 a[148:149], v13 offset:32768
    buffer_load_dwordx4 v18, s[52:55], s83 offen offset:1024 lds
    v_mfma_f32_16x16x32_bf16 v[176:179], a[176:179], a[116:119], v[176:179]
    ds_read_b64_tr_b16 a[150:151], v13 offset:36864
    v_mfma_f32_16x16x32_bf16 v[208:211], a[176:179], a[120:123], v[208:211]
    v_mfma_f32_16x16x32_bf16 v[240:243], a[176:179], a[124:127], v[240:243]
    ds_read_b64_tr_b16 a[152:153], v14 offset:32768
    s_waitcnt lgkmcnt(15)
    v_mfma_f32_16x16x32_bf16 v[148:151], a[180:183], a[112:115], v[148:151]
    ds_read_b64_tr_b16 a[154:155], v14 offset:36864
    v_mfma_f32_16x16x32_bf16 v[180:183], a[180:183], a[116:119], v[180:183]
    v_mfma_f32_16x16x32_bf16 v[212:215], a[180:183], a[120:123], v[212:215]
    ds_read_b64_tr_b16 a[156:157], v15 offset:32768
    v_mfma_f32_16x16x32_bf16 v[244:247], a[180:183], a[124:127], v[244:247]
    ds_read_b64_tr_b16 a[158:159], v15 offset:36864
    v_mfma_f32_16x16x32_bf16 v[152:155], a[184:187], a[112:115], v[152:155]
    v_mfma_f32_16x16x32_bf16 v[184:187], a[184:187], a[116:119], v[184:187]
    v_mfma_f32_16x16x32_bf16 v[216:219], a[184:187], a[120:123], v[216:219]
    v_mfma_f32_16x16x32_bf16 v[248:251], a[184:187], a[124:127], v[248:251]
    s_waitcnt lgkmcnt(15)
    v_mfma_f32_16x16x32_bf16 v[156:159], a[188:191], a[112:115], v[156:159]
    v_mfma_f32_16x16x32_bf16 v[188:191], a[188:191], a[116:119], v[188:191]
    v_mfma_f32_16x16x32_bf16 v[220:223], a[188:191], a[120:123], v[220:223]
    v_mfma_f32_16x16x32_bf16 v[252:255], a[188:191], a[124:127], v[252:255]
    s_barrier
    s_waitcnt vmcnt(41) lgkmcnt(14)
    v_mfma_f32_16x16x32_bf16 v[128:131], a[128:131], a[0:3], v[128:131]
    buffer_load_dwordx4 a[112:115], v16, s[56:59], s69 offen offset:0 sc1
    s_waitcnt vmcnt(41)
    v_mfma_f32_16x16x32_bf16 v[160:163], a[128:131], a[4:7], v[160:163]
    ds_read_b64_tr_b16 a[160:161], v8 offset:40960
    s_waitcnt vmcnt(40)
    v_mfma_f32_16x16x32_bf16 v[192:195], a[128:131], a[8:11], v[192:195]
    ds_read_b64_tr_b16 a[162:163], v8 offset:45056
    buffer_load_dwordx4 a[116:119], v16, s[56:59], s69 offen offset:1024 sc1
    s_waitcnt vmcnt(40)
    v_mfma_f32_16x16x32_bf16 v[224:227], a[128:131], a[12:15], v[224:227]
    s_waitcnt lgkmcnt(14)
    v_mfma_f32_16x16x32_bf16 v[132:135], a[132:135], a[0:3], v[132:135]
    ds_read_b64_tr_b16 a[164:165], v9 offset:40960
    buffer_load_dwordx4 a[120:123], v16, s[56:59], s69 offen offset:2048 sc1
    v_mfma_f32_16x16x32_bf16 v[164:167], a[132:135], a[4:7], v[164:167]
    ds_read_b64_tr_b16 a[166:167], v9 offset:45056
    v_mfma_f32_16x16x32_bf16 v[196:199], a[132:135], a[8:11], v[196:199]
    buffer_load_dwordx4 a[124:127], v16, s[56:59], s69 offen offset:3072 sc1
    v_mfma_f32_16x16x32_bf16 v[228:231], a[132:135], a[12:15], v[228:231]
    ds_read_b64_tr_b16 a[168:169], v10 offset:40960
    s_waitcnt lgkmcnt(15)
    v_mfma_f32_16x16x32_bf16 v[136:139], a[136:139], a[0:3], v[136:139]
    ds_read_b64_tr_b16 a[170:171], v10 offset:45056
    s_add_u32 s69, s69, 4096
    v_mfma_f32_16x16x32_bf16 v[168:171], a[136:139], a[4:7], v[168:171]
    v_mfma_f32_16x16x32_bf16 v[200:203], a[136:139], a[8:11], v[200:203]
    ds_read_b64_tr_b16 a[172:173], v11 offset:40960
    v_mfma_f32_16x16x32_bf16 v[232:235], a[136:139], a[12:15], v[232:235]
    ds_read_b64_tr_b16 a[174:175], v11 offset:45056
    s_mov_b32 s82, 786432
    s_add_u32 m0, s3, 0
    s_waitcnt lgkmcnt(15)
    v_mfma_f32_16x16x32_bf16 v[140:143], a[140:143], a[0:3], v[140:143]
    buffer_load_dwordx4 v17, s[52:55], s82 offen lds
    v_mfma_f32_16x16x32_bf16 v[172:175], a[140:143], a[4:7], v[172:175]
    ds_read_b64_tr_b16 a[176:177], v12 offset:40960
    v_mfma_f32_16x16x32_bf16 v[204:207], a[140:143], a[8:11], v[204:207]
    ds_read_b64_tr_b16 a[178:179], v12 offset:45056
    v_mfma_f32_16x16x32_bf16 v[236:239], a[140:143], a[12:15], v[236:239]
    s_waitcnt lgkmcnt(15)
    v_mfma_f32_16x16x32_bf16 v[144:147], a[144:147], a[0:3], v[144:147]
    ds_read_b64_tr_b16 a[180:181], v13 offset:40960
    buffer_load_dwordx4 v18, s[52:55], s82 offen offset:1024 lds
    v_mfma_f32_16x16x32_bf16 v[176:179], a[144:147], a[4:7], v[176:179]
    ds_read_b64_tr_b16 a[182:183], v13 offset:45056
    v_mfma_f32_16x16x32_bf16 v[208:211], a[144:147], a[8:11], v[208:211]
    v_mfma_f32_16x16x32_bf16 v[240:243], a[144:147], a[12:15], v[240:243]
    ds_read_b64_tr_b16 a[184:185], v14 offset:40960
    s_waitcnt lgkmcnt(15)
    v_mfma_f32_16x16x32_bf16 v[148:151], a[148:151], a[0:3], v[148:151]
    ds_read_b64_tr_b16 a[186:187], v14 offset:45056
    v_mfma_f32_16x16x32_bf16 v[180:183], a[148:151], a[4:7], v[180:183]
    v_mfma_f32_16x16x32_bf16 v[212:215], a[148:151], a[8:11], v[212:215]
    ds_read_b64_tr_b16 a[188:189], v15 offset:40960
    v_mfma_f32_16x16x32_bf16 v[244:247], a[148:151], a[12:15], v[244:247]
    ds_read_b64_tr_b16 a[190:191], v15 offset:45056
    v_mfma_f32_16x16x32_bf16 v[152:155], a[152:155], a[0:3], v[152:155]
    v_mfma_f32_16x16x32_bf16 v[184:187], a[152:155], a[4:7], v[184:187]
    v_mfma_f32_16x16x32_bf16 v[216:219], a[152:155], a[8:11], v[216:219]
    v_mfma_f32_16x16x32_bf16 v[248:251], a[152:155], a[12:15], v[248:251]
    s_waitcnt lgkmcnt(15)
    v_mfma_f32_16x16x32_bf16 v[156:159], a[156:159], a[0:3], v[156:159]
    v_mfma_f32_16x16x32_bf16 v[188:191], a[156:159], a[4:7], v[188:191]
    v_mfma_f32_16x16x32_bf16 v[220:223], a[156:159], a[8:11], v[220:223]
    v_mfma_f32_16x16x32_bf16 v[252:255], a[156:159], a[12:15], v[252:255]
    s_waitcnt vmcnt(41) lgkmcnt(14)
    v_mfma_f32_16x16x32_bf16 v[128:131], a[160:163], a[16:19], v[128:131]
    buffer_load_dwordx4 a[0:3], v16, s[56:59], s69 offen offset:0 sc1
    s_waitcnt vmcnt(41)
    v_mfma_f32_16x16x32_bf16 v[160:163], a[160:163], a[20:23], v[160:163]
    ds_read_b64_tr_b16 a[128:129], v8 offset:49152
    s_waitcnt vmcnt(40)
    v_mfma_f32_16x16x32_bf16 v[192:195], a[160:163], a[24:27], v[192:195]
    ds_read_b64_tr_b16 a[130:131], v8 offset:53248
    buffer_load_dwordx4 a[4:7], v16, s[56:59], s69 offen offset:1024 sc1
    s_waitcnt vmcnt(40)
    v_mfma_f32_16x16x32_bf16 v[224:227], a[160:163], a[28:31], v[224:227]
    s_waitcnt lgkmcnt(14)
    v_mfma_f32_16x16x32_bf16 v[132:135], a[164:167], a[16:19], v[132:135]
    ds_read_b64_tr_b16 a[132:133], v9 offset:49152
    buffer_load_dwordx4 a[8:11], v16, s[56:59], s69 offen offset:2048 sc1
    v_mfma_f32_16x16x32_bf16 v[164:167], a[164:167], a[20:23], v[164:167]
    ds_read_b64_tr_b16 a[134:135], v9 offset:53248
    v_mfma_f32_16x16x32_bf16 v[196:199], a[164:167], a[24:27], v[196:199]
    buffer_load_dwordx4 a[12:15], v16, s[56:59], s69 offen offset:3072 sc1
    v_mfma_f32_16x16x32_bf16 v[228:231], a[164:167], a[28:31], v[228:231]
    ds_read_b64_tr_b16 a[136:137], v10 offset:49152
    s_waitcnt lgkmcnt(15)
    v_mfma_f32_16x16x32_bf16 v[136:139], a[168:171], a[16:19], v[136:139]
    ds_read_b64_tr_b16 a[138:139], v10 offset:53248
    s_add_u32 s69, s69, 4096
    v_mfma_f32_16x16x32_bf16 v[168:171], a[168:171], a[20:23], v[168:171]
    v_mfma_f32_16x16x32_bf16 v[200:203], a[168:171], a[24:27], v[200:203]
    ds_read_b64_tr_b16 a[140:141], v11 offset:49152
    v_mfma_f32_16x16x32_bf16 v[232:235], a[168:171], a[28:31], v[232:235]
    ds_read_b64_tr_b16 a[142:143], v11 offset:53248
    s_mov_b32 s83, 851968
    s_add_u32 m0, s3, 8192
    s_waitcnt lgkmcnt(15)
    v_mfma_f32_16x16x32_bf16 v[140:143], a[172:175], a[16:19], v[140:143]
    buffer_load_dwordx4 v17, s[52:55], s83 offen lds
    v_mfma_f32_16x16x32_bf16 v[172:175], a[172:175], a[20:23], v[172:175]
    ds_read_b64_tr_b16 a[144:145], v12 offset:49152
    v_mfma_f32_16x16x32_bf16 v[204:207], a[172:175], a[24:27], v[204:207]
    ds_read_b64_tr_b16 a[146:147], v12 offset:53248
    v_mfma_f32_16x16x32_bf16 v[236:239], a[172:175], a[28:31], v[236:239]
    s_waitcnt lgkmcnt(15)
    v_mfma_f32_16x16x32_bf16 v[144:147], a[176:179], a[16:19], v[144:147]
    ds_read_b64_tr_b16 a[148:149], v13 offset:49152
    buffer_load_dwordx4 v18, s[52:55], s83 offen offset:1024 lds
    v_mfma_f32_16x16x32_bf16 v[176:179], a[176:179], a[20:23], v[176:179]
    ds_read_b64_tr_b16 a[150:151], v13 offset:53248
    v_mfma_f32_16x16x32_bf16 v[208:211], a[176:179], a[24:27], v[208:211]
    v_mfma_f32_16x16x32_bf16 v[240:243], a[176:179], a[28:31], v[240:243]
    ds_read_b64_tr_b16 a[152:153], v14 offset:49152
    s_waitcnt lgkmcnt(15)
    v_mfma_f32_16x16x32_bf16 v[148:151], a[180:183], a[16:19], v[148:151]
    ds_read_b64_tr_b16 a[154:155], v14 offset:53248
    v_mfma_f32_16x16x32_bf16 v[180:183], a[180:183], a[20:23], v[180:183]
    v_mfma_f32_16x16x32_bf16 v[212:215], a[180:183], a[24:27], v[212:215]
    ds_read_b64_tr_b16 a[156:157], v15 offset:49152
    v_mfma_f32_16x16x32_bf16 v[244:247], a[180:183], a[28:31], v[244:247]
    ds_read_b64_tr_b16 a[158:159], v15 offset:53248
    v_mfma_f32_16x16x32_bf16 v[152:155], a[184:187], a[16:19], v[152:155]
    v_mfma_f32_16x16x32_bf16 v[184:187], a[184:187], a[20:23], v[184:187]
    v_mfma_f32_16x16x32_bf16 v[216:219], a[184:187], a[24:27], v[216:219]
    v_mfma_f32_16x16x32_bf16 v[248:251], a[184:187], a[28:31], v[248:251]
    s_waitcnt lgkmcnt(15)
    v_mfma_f32_16x16x32_bf16 v[156:159], a[188:191], a[16:19], v[156:159]
    v_mfma_f32_16x16x32_bf16 v[188:191], a[188:191], a[20:23], v[188:191]
    v_mfma_f32_16x16x32_bf16 v[220:223], a[188:191], a[24:27], v[220:223]
    v_mfma_f32_16x16x32_bf16 v[252:255], a[188:191], a[28:31], v[252:255]
    s_waitcnt vmcnt(41) lgkmcnt(14)
    v_mfma_f32_16x16x32_bf16 v[128:131], a[128:131], a[32:35], v[128:131]
    buffer_load_dwordx4 a[16:19], v16, s[56:59], s69 offen offset:0 sc1
    s_waitcnt vmcnt(41)
    v_mfma_f32_16x16x32_bf16 v[160:163], a[128:131], a[36:39], v[160:163]
    ds_read_b64_tr_b16 a[160:161], v8 offset:57344
    s_waitcnt vmcnt(40)
    v_mfma_f32_16x16x32_bf16 v[192:195], a[128:131], a[40:43], v[192:195]
    ds_read_b64_tr_b16 a[162:163], v8 offset:61440
    buffer_load_dwordx4 a[20:23], v16, s[56:59], s69 offen offset:1024 sc1
    s_waitcnt vmcnt(40)
    v_mfma_f32_16x16x32_bf16 v[224:227], a[128:131], a[44:47], v[224:227]
    s_waitcnt lgkmcnt(14)
    v_mfma_f32_16x16x32_bf16 v[132:135], a[132:135], a[32:35], v[132:135]
    ds_read_b64_tr_b16 a[164:165], v9 offset:57344
    buffer_load_dwordx4 a[24:27], v16, s[56:59], s69 offen offset:2048 sc1
    v_mfma_f32_16x16x32_bf16 v[164:167], a[132:135], a[36:39], v[164:167]
    ds_read_b64_tr_b16 a[166:167], v9 offset:61440
    v_mfma_f32_16x16x32_bf16 v[196:199], a[132:135], a[40:43], v[196:199]
    buffer_load_dwordx4 a[28:31], v16, s[56:59], s69 offen offset:3072 sc1
    v_mfma_f32_16x16x32_bf16 v[228:231], a[132:135], a[44:47], v[228:231]
    ds_read_b64_tr_b16 a[168:169], v10 offset:57344
    s_waitcnt lgkmcnt(15)
    v_mfma_f32_16x16x32_bf16 v[136:139], a[136:139], a[32:35], v[136:139]
    ds_read_b64_tr_b16 a[170:171], v10 offset:61440
    s_add_u32 s69, s69, 4096
    v_mfma_f32_16x16x32_bf16 v[168:171], a[136:139], a[36:39], v[168:171]
    v_mfma_f32_16x16x32_bf16 v[200:203], a[136:139], a[40:43], v[200:203]
    ds_read_b64_tr_b16 a[172:173], v11 offset:57344
    v_mfma_f32_16x16x32_bf16 v[232:235], a[136:139], a[44:47], v[232:235]
    ds_read_b64_tr_b16 a[174:175], v11 offset:61440
    s_mov_b32 s82, 917504
    s_add_u32 m0, s3, 16384
    s_waitcnt lgkmcnt(15)
    v_mfma_f32_16x16x32_bf16 v[140:143], a[140:143], a[32:35], v[140:143]
    buffer_load_dwordx4 v17, s[52:55], s82 offen lds
    v_mfma_f32_16x16x32_bf16 v[172:175], a[140:143], a[36:39], v[172:175]
    ds_read_b64_tr_b16 a[176:177], v12 offset:57344
    v_mfma_f32_16x16x32_bf16 v[204:207], a[140:143], a[40:43], v[204:207]
    ds_read_b64_tr_b16 a[178:179], v12 offset:61440
    v_mfma_f32_16x16x32_bf16 v[236:239], a[140:143], a[44:47], v[236:239]
    s_waitcnt lgkmcnt(15)
    v_mfma_f32_16x16x32_bf16 v[144:147], a[144:147], a[32:35], v[144:147]
    ds_read_b64_tr_b16 a[180:181], v13 offset:57344
    buffer_load_dwordx4 v18, s[52:55], s82 offen offset:1024 lds
    v_mfma_f32_16x16x32_bf16 v[176:179], a[144:147], a[36:39], v[176:179]
    ds_read_b64_tr_b16 a[182:183], v13 offset:61440
    v_mfma_f32_16x16x32_bf16 v[208:211], a[144:147], a[40:43], v[208:211]
    v_mfma_f32_16x16x32_bf16 v[240:243], a[144:147], a[44:47], v[240:243]
    ds_read_b64_tr_b16 a[184:185], v14 offset:57344
    s_waitcnt lgkmcnt(15)
    v_mfma_f32_16x16x32_bf16 v[148:151], a[148:151], a[32:35], v[148:151]
    ds_read_b64_tr_b16 a[186:187], v14 offset:61440
    v_mfma_f32_16x16x32_bf16 v[180:183], a[148:151], a[36:39], v[180:183]
    v_mfma_f32_16x16x32_bf16 v[212:215], a[148:151], a[40:43], v[212:215]
    ds_read_b64_tr_b16 a[188:189], v15 offset:57344
    v_mfma_f32_16x16x32_bf16 v[244:247], a[148:151], a[44:47], v[244:247]
    ds_read_b64_tr_b16 a[190:191], v15 offset:61440
    v_mfma_f32_16x16x32_bf16 v[152:155], a[152:155], a[32:35], v[152:155]
    s_branch L_over11
L_stub11:
    s_branch L_stubret
L_over11:
    v_mfma_f32_16x16x32_bf16 v[184:187], a[152:155], a[36:39], v[184:187]
    v_mfma_f32_16x16x32_bf16 v[216:219], a[152:155], a[40:43], v[216:219]
    v_mfma_f32_16x16x32_bf16 v[248:251], a[152:155], a[44:47], v[248:251]
    s_waitcnt lgkmcnt(15)
    v_mfma_f32_16x16x32_bf16 v[156:159], a[156:159], a[32:35], v[156:159]
    v_mfma_f32_16x16x32_bf16 v[188:191], a[156:159], a[36:39], v[188:191]
    v_mfma_f32_16x16x32_bf16 v[220:223], a[156:159], a[40:43], v[220:223]
    v_mfma_f32_16x16x32_bf16 v[252:255], a[156:159], a[44:47], v[252:255]
    s_waitcnt vmcnt(40) lgkmcnt(14)
    v_mfma_f32_16x16x32_bf16 v[160:163], a[160:163], a[52:55], v[160:163]
    buffer_load_dwordx4 a[32:35], v16, s[56:59], s69 offen offset:0 sc1
    s_waitcnt lgkmcnt(12)
    v_mfma_f32_16x16x32_bf16 v[164:167], a[164:167], a[52:55], v[164:167]
    ds_read_b64_tr_b16 a[128:129], v48 offset:0
    s_waitcnt lgkmcnt(11)
    v_mfma_f32_16x16x32_bf16 v[168:171], a[168:171], a[52:55], v[168:171]
    ds_read_b64_tr_b16 a[130:131], v48 offset:4096
    buffer_load_dwordx4 a[36:39], v16, s[56:59], s69 offen offset:1024 sc1
    s_waitcnt lgkmcnt(10)
    v_mfma_f32_16x16x32_bf16 v[172:175], a[172:175], a[52:55], v[172:175]
    ds_read_b64_tr_b16 a[132:133], v49 offset:0
    s_waitcnt lgkmcnt(9)
    v_mfma_f32_16x16x32_bf16 v[176:179], a[176:179], a[52:55], v[176:179]
    ds_read_b64_tr_b16 a[134:135], v49 offset:4096
    buffer_load_dwordx4 a[40:43], v16, s[56:59], s69 offen offset:2048 sc1
    s_waitcnt lgkmcnt(8)
    v_mfma_f32_16x16x32_bf16 v[180:183], a[180:183], a[52:55], v[180:183]
    ds_read_b64_tr_b16 a[136:137], v50 offset:0
    s_waitcnt lgkmcnt(7)
    v_mfma_f32_16x16x32_bf16 v[184:187], a[184:187], a[52:55], v[184:187]
    ds_read_b64_tr_b16 a[138:139], v50 offset:4096
    buffer_load_dwordx4 a[44:47], v16, s[56:59], s69 offen offset:3072 sc1
    s_waitcnt lgkmcnt(6)
    v_mfma_f32_16x16x32_bf16 v[188:191], a[188:191], a[52:55], v[188:191]
    ds_read_b64_tr_b16 a[140:141], v51 offset:0
    s_waitcnt vmcnt(43)
    v_mfma_f32_16x16x32_bf16 v[192:195], a[160:163], a[56:59], v[192:195]
    ds_read_b64_tr_b16 a[142:143], v51 offset:4096
    s_add_u32 s69, s69, 4096
    v_mfma_f32_16x16x32_bf16 v[196:199], a[164:167], a[56:59], v[196:199]
    ds_read_b64_tr_b16 a[144:145], v52 offset:0
    v_mfma_f32_16x16x32_bf16 v[200:203], a[168:171], a[56:59], v[200:203]
    ds_read_b64_tr_b16 a[146:147], v52 offset:4096
    v_mfma_f32_16x16x32_bf16 v[204:207], a[172:175], a[56:59], v[204:207]
    ds_read_b64_tr_b16 a[148:149], v53 offset:0
    s_mov_b32 s83, 983040
    s_add_u32 m0, s3, 24576
    v_mfma_f32_16x16x32_bf16 v[208:211], a[176:179], a[56:59], v[208:211]
    ds_read_b64_tr_b16 a[150:151], v53 offset:4096
    buffer_load_dwordx4 v17, s[52:55], s83 offen lds
    v_cvt_pk_bf16_f32 v160, v160, v161
    v_cvt_pk_bf16_f32 v161, v162, v163
    v_mfma_f32_16x16x32_bf16 v[212:215], a[180:183], a[56:59], v[212:215]
    ds_read_b64_tr_b16 a[152:153], v54 offset:0
    v_cvt_pk_bf16_f32 v162, v164, v165
    v_cvt_pk_bf16_f32 v163, v166, v167
    v_mfma_f32_16x16x32_bf16 v[216:219], a[184:187], a[56:59], v[216:219]
    ds_read_b64_tr_b16 a[154:155], v54 offset:4096
    buffer_store_dwordx4 v[160:163], v16, s[56:59], s70 offen offset:0 sc1
    v_cvt_pk_bf16_f32 v168, v168, v169
    v_mfma_f32_16x16x32_bf16 v[220:223], a[188:191], a[56:59], v[220:223]
    v_cvt_pk_bf16_f32 v169, v170, v171
    v_cvt_pk_bf16_f32 v170, v172, v173
    s_waitcnt vmcnt(44)
    v_mfma_f32_16x16x32_bf16 v[224:227], a[160:163], a[60:63], v[224:227]
    buffer_load_dwordx4 v18, s[52:55], s83 offen offset:1024 lds
    v_cvt_pk_bf16_f32 v171, v174, v175
    buffer_store_dwordx4 v[168:171], v16, s[56:59], s70 offen offset:1024 sc1
    v_mfma_f32_16x16x32_bf16 v[228:231], a[164:167], a[60:63], v[228:231]
    v_cvt_pk_bf16_f32 v176, v176, v177
    v_cvt_pk_bf16_f32 v177, v178, v179
    v_mfma_f32_16x16x32_bf16 v[232:235], a[168:171], a[60:63], v[232:235]
    v_cvt_pk_bf16_f32 v178, v180, v181
    v_cvt_pk_bf16_f32 v179, v182, v183
    v_mfma_f32_16x16x32_bf16 v[236:239], a[172:175], a[60:63], v[236:239]
    buffer_store_dwordx4 v[176:179], v16, s[56:59], s70 offen offset:2048 sc1
    v_cvt_pk_bf16_f32 v184, v184, v185
    v_mfma_f32_16x16x32_bf16 v[240:243], a[176:179], a[60:63], v[240:243]
    v_cvt_pk_bf16_f32 v185, v186, v187
    v_cvt_pk_bf16_f32 v186, v188, v189
    v_mfma_f32_16x16x32_bf16 v[244:247], a[180:183], a[60:63], v[244:247]
    v_cvt_pk_bf16_f32 v187, v190, v191
    buffer_store_dwordx4 v[184:187], v16, s[56:59], s70 offen offset:3072 sc1
    v_mfma_f32_16x16x32_bf16 v[248:251], a[184:187], a[60:63], v[248:251]
    v_cvt_pk_bf16_f32 v192, v192, v193
    v_cvt_pk_bf16_f32 v193, v194, v195
    v_mfma_f32_16x16x32_bf16 v[252:255], a[188:191], a[60:63], v[252:255]
    v_cvt_pk_bf16_f32 v194, v196, v197
    v_cvt_pk_bf16_f32 v195, v198, v199
    v_mfma_f32_16x16x32_bf16 v[128:131], a[160:163], a[48:51], v[128:131]
    buffer_store_dwordx4 v[192:195], v16, s[56:59], s71 offen offset:0 sc1
    v_cvt_pk_bf16_f32 v200, v200, v201
    v_mfma_f32_16x16x32_bf16 v[132:135], a[164:167], a[48:51], v[132:135]
    v_cvt_pk_bf16_f32 v201, v202, v203
    v_cvt_pk_bf16_f32 v202, v204, v205
    v_mfma_f32_16x16x32_bf16 v[136:139], a[168:171], a[48:51], v[136:139]
    v_cvt_pk_bf16_f32 v203, v206, v207
    buffer_store_dwordx4 v[200:203], v16, s[56:59], s71 offen offset:1024 sc1
    v_mfma_f32_16x16x32_bf16 v[140:143], a[172:175], a[48:51], v[140:143]
    v_cvt_pk_bf16_f32 v208, v208, v209
    v_cvt_pk_bf16_f32 v209, v210, v211
    v_mfma_f32_16x16x32_bf16 v[144:147], a[176:179], a[48:51], v[144:147]
    v_cvt_pk_bf16_f32 v210, v212, v213
    v_cvt_pk_bf16_f32 v211, v214, v215
    v_mfma_f32_16x16x32_bf16 v[148:151], a[180:183], a[48:51], v[148:151]
    buffer_store_dwordx4 v[208:211], v16, s[56:59], s71 offen offset:2048 sc1
    v_cvt_pk_bf16_f32 v216, v216, v217
    v_mfma_f32_16x16x32_bf16 v[152:155], a[184:187], a[48:51], v[152:155]
    v_cvt_pk_bf16_f32 v217, v218, v219
    v_cvt_pk_bf16_f32 v218, v220, v221
    v_mfma_f32_16x16x32_bf16 v[156:159], a[188:191], a[48:51], v[156:159]
    v_cvt_pk_bf16_f32 v219, v222, v223
    buffer_store_dwordx4 v[216:219], v16, s[56:59], s71 offen offset:3072 sc1
    s_barrier
    buffer_load_dwordx4 a[48:51], v16, s[56:59], s69 offen offset:0 sc1
    buffer_load_dwordx4 a[52:55], v16, s[56:59], s69 offen offset:1024 sc1
    buffer_load_dwordx4 a[56:59], v16, s[56:59], s69 offen offset:2048 sc1
    buffer_load_dwordx4 a[60:63], v16, s[56:59], s69 offen offset:3072 sc1
    s_add_u32 s69, s69, 4096
    s_waitcnt vmcnt(53) lgkmcnt(12)
    v_mfma_f32_16x16x32_bf16 v[96:99], a[128:131], a[64:67], 0
    ds_read_b64_tr_b16 a[156:157], v55 offset:0
    ds_read_b64_tr_b16 a[158:159], v55 offset:4096
    v_cvt_pk_bf16_f32 v224, v224, v225
    v_cvt_pk_bf16_f32 v225, v226, v227
    s_waitcnt lgkmcnt(12)
    v_mfma_f32_16x16x32_bf16 v[100:103], a[132:135], a[64:67], 0
    ds_read_b64_tr_b16 a[160:161], v48 offset:8192
    ds_read_b64_tr_b16 a[162:163], v48 offset:12288
    v_cvt_pk_bf16_f32 v226, v228, v229
    v_cvt_pk_bf16_f32 v227, v230, v231
    s_waitcnt lgkmcnt(12)
    v_mfma_f32_16x16x32_bf16 v[104:107], a[136:139], a[64:67], 0
    ds_read_b64_tr_b16 a[164:165], v49 offset:8192
    ds_read_b64_tr_b16 a[166:167], v49 offset:12288
    buffer_store_dwordx4 v[224:227], v16, s[56:59], s72 offen offset:0 sc1
    v_cvt_pk_bf16_f32 v232, v232, v233
    s_waitcnt lgkmcnt(12)
    v_mfma_f32_16x16x32_bf16 v[108:111], a[140:143], a[64:67], 0
    ds_read_b64_tr_b16 a[168:169], v50 offset:8192
    ds_read_b64_tr_b16 a[170:171], v50 offset:12288
    v_cvt_pk_bf16_f32 v233, v234, v235
    v_cvt_pk_bf16_f32 v234, v236, v237
    s_waitcnt lgkmcnt(12)
    v_mfma_f32_16x16x32_bf16 v[112:115], a[144:147], a[64:67], 0
    ds_read_b64_tr_b16 a[172:173], v51 offset:8192
    ds_read_b64_tr_b16 a[174:175], v51 offset:12288
    v_cvt_pk_bf16_f32 v235, v238, v239
    buffer_store_dwordx4 v[232:235], v16, s[56:59], s72 offen offset:1024 sc1
    s_waitcnt lgkmcnt(12)
    v_mfma_f32_16x16x32_bf16 v[116:119], a[148:151], a[64:67], 0
    ds_read_b64_tr_b16 a[176:177], v52 offset:8192
    ds_read_b64_tr_b16 a[178:179], v52 offset:12288
    v_cvt_pk_bf16_f32 v240, v240, v241
    v_cvt_pk_bf16_f32 v241, v242, v243
    s_waitcnt lgkmcnt(12)
    v_mfma_f32_16x16x32_bf16 v[120:123], a[152:155], a[64:67], 0
    ds_read_b64_tr_b16 a[180:181], v53 offset:8192
    ds_read_b64_tr_b16 a[182:183], v53 offset:12288
    v_cvt_pk_bf16_f32 v242, v244, v245
    v_cvt_pk_bf16_f32 v243, v246, v247
    s_waitcnt lgkmcnt(12)
    v_mfma_f32_16x16x32_bf16 v[124:127], a[156:159], a[64:67], 0
    ds_read_b64_tr_b16 a[184:185], v54 offset:8192
    ds_read_b64_tr_b16 a[186:187], v54 offset:12288
    buffer_store_dwordx4 v[240:243], v16, s[56:59], s72 offen offset:2048 sc1
    v_cvt_pk_bf16_f32 v248, v248, v249
    s_waitcnt vmcnt(55) lgkmcnt(12)
    v_mfma_f32_16x16x32_bf16 v[96:99], a[160:163], a[68:71], v[96:99]
    ds_read_b64_tr_b16 a[188:189], v55 offset:8192
    ds_read_b64_tr_b16 a[190:191], v55 offset:12288
    v_cvt_pk_bf16_f32 v249, v250, v251
    v_cvt_pk_bf16_f32 v250, v252, v253
    s_waitcnt lgkmcnt(12)
    v_mfma_f32_16x16x32_bf16 v[100:103], a[164:167], a[68:71], v[100:103]
    ds_read_b64_tr_b16 a[128:129], v48 offset:16384
    ds_read_b64_tr_b16 a[130:131], v48 offset:20480
    v_cvt_pk_bf16_f32 v251, v254, v255
    buffer_store_dwordx4 v[248:251], v16, s[56:59], s72 offen offset:3072 sc1
    s_waitcnt lgkmcnt(12)
    v_mfma_f32_16x16x32_bf16 v[104:107], a[168:171], a[68:71], v[104:107]
    ds_read_b64_tr_b16 a[132:133], v49 offset:16384
    ds_read_b64_tr_b16 a[134:135], v49 offset:20480
    s_mov_b32 s82, 1048576
    s_add_u32 m0, s3, 32768
    s_nop 0
    buffer_load_dwordx4 v17, s[52:55], s82 offen lds
    s_waitcnt lgkmcnt(12)
    v_mfma_f32_16x16x32_bf16 v[108:111], a[172:175], a[68:71], v[108:111]
    ds_read_b64_tr_b16 a[136:137], v50 offset:16384
    ds_read_b64_tr_b16 a[138:139], v50 offset:20480
    s_waitcnt lgkmcnt(12)
    v_mfma_f32_16x16x32_bf16 v[112:115], a[176:179], a[68:71], v[112:115]
    ds_read_b64_tr_b16 a[140:141], v51 offset:16384
    ds_read_b64_tr_b16 a[142:143], v51 offset:20480
    s_waitcnt lgkmcnt(12)
    v_mfma_f32_16x16x32_bf16 v[116:119], a[180:183], a[68:71], v[116:119]
    ds_read_b64_tr_b16 a[144:145], v52 offset:16384
    ds_read_b64_tr_b16 a[146:147], v52 offset:20480
    buffer_load_dwordx4 v18, s[52:55], s82 offen offset:1024 lds
    s_waitcnt lgkmcnt(12)
    v_mfma_f32_16x16x32_bf16 v[120:123], a[184:187], a[68:71], v[120:123]
    ds_read_b64_tr_b16 a[148:149], v53 offset:16384
    ds_read_b64_tr_b16 a[150:151], v53 offset:20480
    s_waitcnt lgkmcnt(12)
    v_mfma_f32_16x16x32_bf16 v[124:127], a[188:191], a[68:71], v[124:127]
    ds_read_b64_tr_b16 a[152:153], v54 offset:16384
    ds_read_b64_tr_b16 a[154:155], v54 offset:20480
    s_waitcnt vmcnt(57) lgkmcnt(12)
    v_mfma_f32_16x16x32_bf16 v[96:99], a[128:131], a[72:75], v[96:99]
    ds_read_b64_tr_b16 a[156:157], v55 offset:16384
    ds_read_b64_tr_b16 a[158:159], v55 offset:20480
    s_mov_b32 s83, 1114112
    s_add_u32 m0, s3, 40960
    s_nop 0
    buffer_load_dwordx4 v17, s[52:55], s83 offen lds
    s_waitcnt lgkmcnt(12)
    v_mfma_f32_16x16x32_bf16 v[100:103], a[132:135], a[72:75], v[100:103]
    ds_read_b64_tr_b16 a[160:161], v48 offset:24576
    ds_read_b64_tr_b16 a[162:163], v48 offset:28672
    s_waitcnt lgkmcnt(12)
    v_mfma_f32_16x16x32_bf16 v[104:107], a[136:139], a[72:75], v[104:107]
    ds_read_b64_tr_b16 a[164:165], v49 offset:24576
    ds_read_b64_tr_b16 a[166:167], v49 offset:28672
    s_waitcnt lgkmcnt(12)
    v_mfma_f32_16x16x32_bf16 v[108:111], a[140:143], a[72:75], v[108:111]
    ds_read_b64_tr_b16 a[168:169], v50 offset:24576
    ds_read_b64_tr_b16 a[170:171], v50 offset:28672
    buffer_load_dwordx4 v18, s[52:55], s83 offen offset:1024 lds
    s_waitcnt lgkmcnt(12)
    v_mfma_f32_16x16x32_bf16 v[112:115], a[144:147], a[72:75], v[112:115]
    ds_read_b64_tr_b16 a[172:173], v51 offset:24576
    ds_read_b64_tr_b16 a[174:175], v51 offset:28672
    s_waitcnt lgkmcnt(12)
    v_mfma_f32_16x16x32_bf16 v[116:119], a[148:151], a[72:75], v[116:119]
    ds_read_b64_tr_b16 a[176:177], v52 offset:24576
    ds_read_b64_tr_b16 a[178:179], v52 offset:28672
    s_waitcnt lgkmcnt(12)
    v_mfma_f32_16x16x32_bf16 v[120:123], a[152:155], a[72:75], v[120:123]
    ds_read_b64_tr_b16 a[180:181], v53 offset:24576
    ds_read_b64_tr_b16 a[182:183], v53 offset:28672
    s_mov_b32 s82, 1179648
    s_add_u32 m0, s3, 49152
    s_nop 0
    buffer_load_dwordx4 v17, s[52:55], s82 offen lds
    s_waitcnt lgkmcnt(12)
    v_mfma_f32_16x16x32_bf16 v[124:127], a[156:159], a[72:75], v[124:127]
    ds_read_b64_tr_b16 a[184:185], v54 offset:24576
    ds_read_b64_tr_b16 a[186:187], v54 offset:28672
    s_waitcnt vmcnt(59) lgkmcnt(12)
    v_mfma_f32_16x16x32_bf16 v[96:99], a[160:163], a[76:79], v[96:99]
    ds_read_b64_tr_b16 a[188:189], v55 offset:24576
    ds_read_b64_tr_b16 a[190:191], v55 offset:28672
    s_waitcnt lgkmcnt(12)
    v_mfma_f32_16x16x32_bf16 v[100:103], a[164:167], a[76:79], v[100:103]
    ds_read_b64_tr_b16 a[128:129], v48 offset:32768
    ds_read_b64_tr_b16 a[130:131], v48 offset:36864
    buffer_load_dwordx4 v18, s[52:55], s82 offen offset:1024 lds
    s_waitcnt lgkmcnt(12)
    v_mfma_f32_16x16x32_bf16 v[104:107], a[168:171], a[76:79], v[104:107]
    ds_read_b64_tr_b16 a[132:133], v49 offset:32768
    ds_read_b64_tr_b16 a[134:135], v49 offset:36864
    s_waitcnt lgkmcnt(12)
    v_mfma_f32_16x16x32_bf16 v[108:111], a[172:175], a[76:79], v[108:111]
    ds_read_b64_tr_b16 a[136:137], v50 offset:32768
    ds_read_b64_tr_b16 a[138:139], v50 offset:36864
    s_waitcnt lgkmcnt(12)
    v_mfma_f32_16x16x32_bf16 v[112:115], a[176:179], a[76:79], v[112:115]
    ds_read_b64_tr_b16 a[140:141], v51 offset:32768
    ds_read_b64_tr_b16 a[142:143], v51 offset:36864
    s_mov_b32 s83, 1245184
    s_add_u32 m0, s3, 57344
    s_nop 0
    buffer_load_dwordx4 v17, s[52:55], s83 offen lds
    s_waitcnt lgkmcnt(12)
    v_mfma_f32_16x16x32_bf16 v[116:119], a[180:183], a[76:79], v[116:119]
    ds_read_b64_tr_b16 a[144:145], v52 offset:32768
    ds_read_b64_tr_b16 a[146:147], v52 offset:36864
    s_waitcnt lgkmcnt(12)
    v_mfma_f32_16x16x32_bf16 v[120:123], a[184:187], a[76:79], v[120:123]
    ds_read_b64_tr_b16 a[148:149], v53 offset:32768
    ds_read_b64_tr_b16 a[150:151], v53 offset:36864
    s_waitcnt lgkmcnt(12)
    v_mfma_f32_16x16x32_bf16 v[124:127], a[188:191], a[76:79], v[124:127]
    ds_read_b64_tr_b16 a[152:153], v54 offset:32768
    ds_read_b64_tr_b16 a[154:155], v54 offset:36864
    buffer_load_dwordx4 v18, s[52:55], s83 offen offset:1024 lds
    s_waitcnt vmcnt(59) lgkmcnt(12)
    v_mfma_f32_16x16x32_bf16 v[96:99], a[128:131], a[80:83], v[96:99]
    ds_read_b64_tr_b16 a[156:157], v55 offset:32768
    ds_read_b64_tr_b16 a[158:159], v55 offset:36864
    s_waitcnt lgkmcnt(12)
    v_mfma_f32_16x16x32_bf16 v[100:103], a[132:135], a[80:83], v[100:103]
    ds_read_b64_tr_b16 a[160:161], v48 offset:40960
    ds_read_b64_tr_b16 a[162:163], v48 offset:45056
    s_waitcnt lgkmcnt(12)
    v_mfma_f32_16x16x32_bf16 v[104:107], a[136:139], a[80:83], v[104:107]
    ds_read_b64_tr_b16 a[164:165], v49 offset:40960
    ds_read_b64_tr_b16 a[166:167], v49 offset:45056
    s_waitcnt lgkmcnt(12)
    v_mfma_f32_16x16x32_bf16 v[108:111], a[140:143], a[80:83], v[108:111]
    ds_read_b64_tr_b16 a[168:169], v50 offset:40960
    ds_read_b64_tr_b16 a[170:171], v50 offset:45056
    s_waitcnt lgkmcnt(12)
    v_mfma_f32_16x16x32_bf16 v[112:115], a[144:147], a[80:83], v[112:115]
    ds_read_b64_tr_b16 a[172:173], v51 offset:40960
    ds_read_b64_tr_b16 a[174:175], v51 offset:45056
    s_waitcnt lgkmcnt(12)
    v_mfma_f32_16x16x32_bf16 v[116:119], a[148:151], a[80:83], v[116:119]
    ds_read_b64_tr_b16 a[176:177], v52 offset:40960
    ds_read_b64_tr_b16 a[178:179], v52 offset:45056
    s_waitcnt lgkmcnt(12)
    v_mfma_f32_16x16x32_bf16 v[120:123], a[152:155], a[80:83], v[120:123]
    ds_read_b64_tr_b16 a[180:181], v53 offset:40960
    ds_read_b64_tr_b16 a[182:183], v53 offset:45056
    s_waitcnt lgkmcnt(12)
    v_mfma_f32_16x16x32_bf16 v[124:127], a[156:159], a[80:83], v[124:127]
    ds_read_b64_tr_b16 a[184:185], v54 offset:40960
    ds_read_b64_tr_b16 a[186:187], v54 offset:45056
    s_waitcnt vmcnt(58) lgkmcnt(12)
    v_mfma_f32_16x16x32_bf16 v[96:99], a[160:163], a[84:87], v[96:99]
    ds_read_b64_tr_b16 a[188:189], v55 offset:40960
    ds_read_b64_tr_b16 a[190:191], v55 offset:45056
    s_waitcnt lgkmcnt(12)
    v_mfma_f32_16x16x32_bf16 v[100:103], a[164:167], a[84:87], v[100:103]
    ds_read_b64_tr_b16 a[128:129], v48 offset:49152
    ds_read_b64_tr_b16 a[130:131], v48 offset:53248
    s_waitcnt lgkmcnt(12)
    v_mfma_f32_16x16x32_bf16 v[104:107], a[168:171], a[84:87], v[104:107]
    ds_read_b64_tr_b16 a[132:133], v49 offset:49152
    ds_read_b64_tr_b16 a[134:135], v49 offset:53248
    s_waitcnt lgkmcnt(12)
    v_mfma_f32_16x16x32_bf16 v[108:111], a[172:175], a[84:87], v[108:111]
    ds_read_b64_tr_b16 a[136:137], v50 offset:49152
    ds_read_b64_tr_b16 a[138:139], v50 offset:53248
    s_waitcnt lgkmcnt(12)
    v_mfma_f32_16x16x32_bf16 v[112:115], a[176:179], a[84:87], v[112:115]
    ds_read_b64_tr_b16 a[140:141], v51 offset:49152
    ds_read_b64_tr_b16 a[142:143], v51 offset:53248
    s_waitcnt lgkmcnt(12)
    v_mfma_f32_16x16x32_bf16 v[116:119], a[180:183], a[84:87], v[116:119]
    ds_read_b64_tr_b16 a[144:145], v52 offset:49152
    ds_read_b64_tr_b16 a[146:147], v52 offset:53248
    s_waitcnt lgkmcnt(12)
    v_mfma_f32_16x16x32_bf16 v[120:123], a[184:187], a[84:87], v[120:123]
    ds_read_b64_tr_b16 a[148:149], v53 offset:49152
    ds_read_b64_tr_b16 a[150:151], v53 offset:53248
    s_waitcnt lgkmcnt(12)
    v_mfma_f32_16x16x32_bf16 v[124:127], a[188:191], a[84:87], v[124:127]
    ds_read_b64_tr_b16 a[152:153], v54 offset:49152
    ds_read_b64_tr_b16 a[154:155], v54 offset:53248
    s_waitcnt vmcnt(23)
    s_barrier
    s_waitcnt lgkmcnt(12)
    v_mfma_f32_16x16x32_bf16 v[96:99], a[128:131], a[88:91], v[96:99]
    ds_read_b64_tr_b16 a[156:157], v55 offset:49152
    ds_read_b64_tr_b16 a[158:159], v55 offset:53248
    s_mov_b32 s82, 1310720
    s_add_u32 m0, s3, 65536
    s_nop 0
    buffer_load_dwordx4 v17, s[52:55], s82 offen lds
    s_waitcnt lgkmcnt(12)
    v_mfma_f32_16x16x32_bf16 v[100:103], a[132:135], a[88:91], v[100:103]
    ds_read_b64_tr_b16 a[160:161], v48 offset:57344
    ds_read_b64_tr_b16 a[162:163], v48 offset:61440
    s_waitcnt lgkmcnt(12)
    v_mfma_f32_16x16x32_bf16 v[104:107], a[136:139], a[88:91], v[104:107]
    ds_read_b64_tr_b16 a[164:165], v49 offset:57344
    ds_read_b64_tr_b16 a[166:167], v49 offset:61440
    s_waitcnt lgkmcnt(12)
    v_mfma_f32_16x16x32_bf16 v[108:111], a[140:143], a[88:91], v[108:111]
    ds_read_b64_tr_b16 a[168:169], v50 offset:57344
    ds_read_b64_tr_b16 a[170:171], v50 offset:61440
    buffer_load_dwordx4 v18, s[52:55], s82 offen offset:1024 lds
    s_waitcnt lgkmcnt(12)
    v_mfma_f32_16x16x32_bf16 v[112:115], a[144:147], a[88:91], v[112:115]
    ds_read_b64_tr_b16 a[172:173], v51 offset:57344
    ds_read_b64_tr_b16 a[174:175], v51 offset:61440
    s_waitcnt lgkmcnt(12)
    v_mfma_f32_16x16x32_bf16 v[116:119], a[148:151], a[88:91], v[116:119]
    ds_read_b64_tr_b16 a[176:177], v52 offset:57344
    ds_read_b64_tr_b16 a[178:179], v52 offset:61440
    s_waitcnt lgkmcnt(12)
    v_mfma_f32_16x16x32_bf16 v[120:123], a[152:155], a[88:91], v[120:123]
    ds_read_b64_tr_b16 a[180:181], v53 offset:57344
    ds_read_b64_tr_b16 a[182:183], v53 offset:61440
    s_mov_b32 s83, 1376256
    s_add_u32 m0, s3, 73728
    s_nop 0
    buffer_load_dwordx4 v17, s[52:55], s83 offen lds
    s_waitcnt lgkmcnt(12)
    v_mfma_f32_16x16x32_bf16 v[124:127], a[156:159], a[88:91], v[124:127]
    ds_read_b64_tr_b16 a[184:185], v54 offset:57344
    ds_read_b64_tr_b16 a[186:187], v54 offset:61440
    s_waitcnt lgkmcnt(12)
    v_mfma_f32_16x16x32_bf16 v[96:99], a[160:163], a[92:95], v[96:99]
    ds_read_b64_tr_b16 a[188:189], v55 offset:57344
    ds_read_b64_tr_b16 a[190:191], v55 offset:61440
    s_waitcnt vmcnt(11)
    s_mov_b64 exec, 1
    buffer_atomic_add v25, off, s[56:59], s77 sc1
    s_mov_b64 exec, -1
    s_waitcnt lgkmcnt(12)
    v_mfma_f32_16x16x32_bf16 v[100:103], a[164:167], a[92:95], v[100:103]
    ds_read_b64_tr_b16 a[128:129], v56 offset:0
    ds_read_b64_tr_b16 a[130:131], v56 offset:4096
    buffer_load_dwordx4 v18, s[52:55], s83 offen offset:1024 lds
    s_waitcnt lgkmcnt(12)
    v_mfma_f32_16x16x32_bf16 v[104:107], a[168:171], a[92:95], v[104:107]
    ds_read_b64_tr_b16 a[132:133], v57 offset:0
    ds_read_b64_tr_b16 a[134:135], v57 offset:4096
    s_waitcnt lgkmcnt(12)
    v_mfma_f32_16x16x32_bf16 v[108:111], a[172:175], a[92:95], v[108:111]
    ds_read_b64_tr_b16 a[136:137], v58 offset:0
    ds_read_b64_tr_b16 a[138:139], v58 offset:4096
    s_waitcnt lgkmcnt(12)
    v_mfma_f32_16x16x32_bf16 v[112:115], a[176:179], a[92:95], v[112:115]
    ds_read_b64_tr_b16 a[140:141], v59 offset:0
    ds_read_b64_tr_b16 a[142:143], v59 offset:4096
    s_mov_b32 s82, 1441792
    s_add_u32 m0, s3, 81920
    s_nop 0
    buffer_load_dwordx4 v17, s[52:55], s82 offen lds
    s_waitcnt lgkmcnt(12)
    v_mfma_f32_16x16x32_bf16 v[116:119], a[180:183], a[92:95], v[116:119]
    ds_read_b64_tr_b16 a[144:145], v60 offset:0
    ds_read_b64_tr_b16 a[146:147], v60 offset:4096
    s_waitcnt lgkmcnt(12)
    v_mfma_f32_16x16x32_bf16 v[120:123], a[184:187], a[92:95], v[120:123]
    ds_read_b64_tr_b16 a[148:149], v61 offset:0
    ds_read_b64_tr_b16 a[150:151], v61 offset:4096
    s_waitcnt lgkmcnt(12)
    v_mfma_f32_16x16x32_bf16 v[124:127], a[188:191], a[92:95], v[124:127]
    ds_read_b64_tr_b16 a[152:153], v62 offset:0
    ds_read_b64_tr_b16 a[154:155], v62 offset:4096
    buffer_load_dwordx4 v18, s[52:55], s82 offen offset:1024 lds
    s_waitcnt lgkmcnt(12)
    v_mfma_f32_16x16x32_bf16 v[96:99], a[128:131], a[96:99], v[96:99]
    ds_read_b64_tr_b16 a[156:157], v63 offset:0
    ds_read_b64_tr_b16 a[158:159], v63 offset:4096
    s_waitcnt lgkmcnt(12)
    v_mfma_f32_16x16x32_bf16 v[100:103], a[132:135], a[96:99], v[100:103]
    ds_read_b64_tr_b16 a[160:161], v56 offset:8192
    ds_read_b64_tr_b16 a[162:163], v56 offset:12288
    s_waitcnt lgkmcnt(12)
    v_mfma_f32_16x16x32_bf16 v[104:107], a[136:139], a[96:99], v[104:107]
    ds_read_b64_tr_b16 a[164:165], v57 offset:8192
    ds_read_b64_tr_b16 a[166:167], v57 offset:12288
    s_mov_b32 s83, 1507328
    s_add_u32 m0, s3, 90112
    s_nop 0
    buffer_load_dwordx4 v17, s[52:55], s83 offen lds
    s_waitcnt lgkmcnt(12)
    v_mfma_f32_16x16x32_bf16 v[108:111], a[140:143], a[96:99], v[108:111]
    ds_read_b64_tr_b16 a[168:169], v58 offset:8192
    ds_read_b64_tr_b16 a[170:171], v58 offset:12288
    s_waitcnt lgkmcnt(12)
    v_mfma_f32_16x16x32_bf16 v[112:115], a[144:147], a[96:99], v[112:115]
    ds_read_b64_tr_b16 a[172:173], v59 offset:8192
    ds_read_b64_tr_b16 a[174:175], v59 offset:12288
    s_waitcnt lgkmcnt(12)
    v_mfma_f32_16x16x32_bf16 v[116:119], a[148:151], a[96:99], v[116:119]
    ds_read_b64_tr_b16 a[176:177], v60 offset:8192
    ds_read_b64_tr_b16 a[178:179], v60 offset:12288
    buffer_load_dwordx4 v18, s[52:55], s83 offen offset:1024 lds
    s_waitcnt lgkmcnt(12)
    v_mfma_f32_16x16x32_bf16 v[120:123], a[152:155], a[96:99], v[120:123]
    ds_read_b64_tr_b16 a[180:181], v61 offset:8192
    ds_read_b64_tr_b16 a[182:183], v61 offset:12288
    s_waitcnt lgkmcnt(12)
    v_mfma_f32_16x16x32_bf16 v[124:127], a[156:159], a[96:99], v[124:127]
    ds_read_b64_tr_b16 a[184:185], v62 offset:8192
    ds_read_b64_tr_b16 a[186:187], v62 offset:12288
    s_waitcnt lgkmcnt(12)
    v_mfma_f32_16x16x32_bf16 v[96:99], a[160:163], a[100:103], v[96:99]
    ds_read_b64_tr_b16 a[188:189], v63 offset:8192
    ds_read_b64_tr_b16 a[190:191], v63 offset:12288
    s_mov_b32 s82, 1572864
    s_add_u32 m0, s3, 98304
    s_nop 0
    buffer_load_dwordx4 v17, s[52:55], s82 offen lds
    s_waitcnt lgkmcnt(12)
    v_mfma_f32_16x16x32_bf16 v[100:103], a[164:167], a[100:103], v[100:103]
    ds_read_b64_tr_b16 a[128:129], v56 offset:16384
    ds_read_b64_tr_b16 a[130:131], v56 offset:20480
    s_waitcnt lgkmcnt(12)
    v_mfma_f32_16x16x32_bf16 v[104:107], a[168:171], a[100:103], v[104:107]
    ds_read_b64_tr_b16 a[132:133], v57 offset:16384
    ds_read_b64_tr_b16 a[134:135], v57 offset:20480
    s_waitcnt lgkmcnt(12)
    v_mfma_f32_16x16x32_bf16 v[108:111], a[172:175], a[100:103], v[108:111]
    ds_read_b64_tr_b16 a[136:137], v58 offset:16384
    ds_read_b64_tr_b16 a[138:139], v58 offset:20480
    buffer_load_dwordx4 v18, s[52:55], s82 offen offset:1024 lds
    s_waitcnt lgkmcnt(12)
    v_mfma_f32_16x16x32_bf16 v[112:115], a[176:179], a[100:103], v[112:115]
    ds_read_b64_tr_b16 a[140:141], v59 offset:16384
    ds_read_b64_tr_b16 a[142:143], v59 offset:20480
    s_waitcnt lgkmcnt(12)
    v_mfma_f32_16x16x32_bf16 v[116:119], a[180:183], a[100:103], v[116:119]
    ds_read_b64_tr_b16 a[144:145], v60 offset:16384
    ds_read_b64_tr_b16 a[146:147], v60 offset:20480
    s_waitcnt lgkmcnt(12)
    v_mfma_f32_16x16x32_bf16 v[120:123], a[184:187], a[100:103], v[120:123]
    ds_read_b64_tr_b16 a[148:149], v61 offset:16384
    ds_read_b64_tr_b16 a[150:151], v61 offset:20480
    s_mov_b32 s83, 1638400
    s_add_u32 m0, s3, 106496
    s_nop 0
    buffer_load_dwordx4 v17, s[52:55], s83 offen lds
    s_waitcnt lgkmcnt(12)
    v_mfma_f32_16x16x32_bf16 v[124:127], a[188:191], a[100:103], v[124:127]
    ds_read_b64_tr_b16 a[152:153], v62 offset:16384
    ds_read_b64_tr_b16 a[154:155], v62 offset:20480
    s_waitcnt lgkmcnt(12)
    v_mfma_f32_16x16x32_bf16 v[96:99], a[128:131], a[104:107], v[96:99]
    ds_read_b64_tr_b16 a[156:157], v63 offset:16384
    ds_read_b64_tr_b16 a[158:159], v63 offset:20480
    s_waitcnt lgkmcnt(12)
    v_mfma_f32_16x16x32_bf16 v[100:103], a[132:135], a[104:107], v[100:103]
    ds_read_b64_tr_b16 a[160:161], v56 offset:24576
    ds_read_b64_tr_b16 a[162:163], v56 offset:28672
    buffer_load_dwordx4 v18, s[52:55], s83 offen offset:1024 lds
    s_waitcnt lgkmcnt(12)
    v_mfma_f32_16x16x32_bf16 v[104:107], a[136:139], a[104:107], v[104:107]
    ds_read_b64_tr_b16 a[164:165], v57 offset:24576
    ds_read_b64_tr_b16 a[166:167], v57 offset:28672
    s_waitcnt lgkmcnt(12)
    v_mfma_f32_16x16x32_bf16 v[108:111], a[140:143], a[104:107], v[108:111]
    ds_read_b64_tr_b16 a[168:169], v58 offset:24576
    ds_read_b64_tr_b16 a[170:171], v58 offset:28672
    s_waitcnt lgkmcnt(12)
    v_mfma_f32_16x16x32_bf16 v[112:115], a[144:147], a[104:107], v[112:115]
    ds_read_b64_tr_b16 a[172:173], v59 offset:24576
    ds_read_b64_tr_b16 a[174:175], v59 offset:28672
    s_waitcnt lgkmcnt(12)
    v_mfma_f32_16x16x32_bf16 v[116:119], a[148:151], a[104:107], v[116:119]
    ds_read_b64_tr_b16 a[176:177], v60 offset:24576
    ds_read_b64_tr_b16 a[178:179], v60 offset:28672
    s_waitcnt lgkmcnt(12)
    v_mfma_f32_16x16x32_bf16 v[120:123], a[152:155], a[104:107], v[120:123]
    ds_read_b64_tr_b16 a[180:181], v61 offset:24576
    ds_read_b64_tr_b16 a[182:183], v61 offset:28672
    s_waitcnt lgkmcnt(12)
    v_mfma_f32_16x16x32_bf16 v[124:127], a[156:159], a[104:107], v[124:127]
    ds_read_b64_tr_b16 a[184:185], v62 offset:24576
    ds_read_b64_tr_b16 a[186:187], v62 offset:28672
    s_waitcnt lgkmcnt(12)
    v_mfma_f32_16x16x32_bf16 v[96:99], a[160:163], a[108:111], v[96:99]
    ds_read_b64_tr_b16 a[188:189], v63 offset:24576
    ds_read_b64_tr_b16 a[190:191], v63 offset:28672
    s_waitcnt lgkmcnt(12)
    v_mfma_f32_16x16x32_bf16 v[100:103], a[164:167], a[108:111], v[100:103]
    ds_read_b64_tr_b16 a[128:129], v8 offset:0
    ds_read_b64_tr_b16 a[130:131], v8 offset:4096
    s_waitcnt lgkmcnt(12)
    v_mfma_f32_16x16x32_bf16 v[104:107], a[168:171], a[108:111], v[104:107]
    ds_read_b64_tr_b16 a[132:133], v9 offset:0
    ds_read_b64_tr_b16 a[134:135], v9 offset:4096
    s_waitcnt lgkmcnt(12)
    v_mfma_f32_16x16x32_bf16 v[108:111], a[172:175], a[108:111], v[108:111]
    ds_read_b64_tr_b16 a[136:137], v10 offset:0
    ds_read_b64_tr_b16 a[138:139], v10 offset:4096
    s_waitcnt lgkmcnt(12)
    v_mfma_f32_16x16x32_bf16 v[112:115], a[176:179], a[108:111], v[112:115]
    ds_read_b64_tr_b16 a[140:141], v11 offset:0
    ds_read_b64_tr_b16 a[142:143], v11 offset:4096
    s_waitcnt lgkmcnt(12)
    v_mfma_f32_16x16x32_bf16 v[116:119], a[180:183], a[108:111], v[116:119]
    ds_read_b64_tr_b16 a[144:145], v12 offset:0
    ds_read_b64_tr_b16 a[146:147], v12 offset:4096
    s_branch L_over12
L_stub12:
    s_branch L_stubret
L_over12:
    s_waitcnt lgkmcnt(12)
    v_mfma_f32_16x16x32_bf16 v[120:123], a[184:187], a[108:111], v[120:123]
    ds_read_b64_tr_b16 a[148:149], v13 offset:0
    ds_read_b64_tr_b16 a[150:151], v13 offset:4096
    s_waitcnt lgkmcnt(12)
    v_mfma_f32_16x16x32_bf16 v[124:127], a[188:191], a[108:111], v[124:127]
    ds_read_b64_tr_b16 a[152:153], v14 offset:0
    ds_read_b64_tr_b16 a[154:155], v14 offset:4096
    s_waitcnt lgkmcnt(12)
    v_mfma_f32_16x16x32_bf16 v[96:99], a[128:131], a[112:115], v[96:99]
    ds_read_b64_tr_b16 a[156:157], v15 offset:0
    ds_read_b64_tr_b16 a[158:159], v15 offset:4096
    s_waitcnt lgkmcnt(12)
    v_mfma_f32_16x16x32_bf16 v[100:103], a[132:135], a[112:115], v[100:103]
    ds_read_b64_tr_b16 a[160:161], v8 offset:8192
    ds_read_b64_tr_b16 a[162:163], v8 offset:12288
    s_waitcnt lgkmcnt(12)
    v_mfma_f32_16x16x32_bf16 v[104:107], a[136:139], a[112:115], v[104:107]
    ds_read_b64_tr_b16 a[164:165], v9 offset:8192
    ds_read_b64_tr_b16 a[166:167], v9 offset:12288
    s_waitcnt lgkmcnt(12)
    v_mfma_f32_16x16x32_bf16 v[108:111], a[140:143], a[112:115], v[108:111]
    ds_read_b64_tr_b16 a[168:169], v10 offset:8192
    ds_read_b64_tr_b16 a[170:171], v10 offset:12288
    s_waitcnt lgkmcnt(12)
    v_mfma_f32_16x16x32_bf16 v[112:115], a[144:147], a[112:115], v[112:115]
    ds_read_b64_tr_b16 a[172:173], v11 offset:8192
    ds_read_b64_tr_b16 a[174:175], v11 offset:12288
    s_waitcnt lgkmcnt(12)
    v_mfma_f32_16x16x32_bf16 v[116:119], a[148:151], a[112:115], v[116:119]
    ds_read_b64_tr_b16 a[176:177], v12 offset:8192
    ds_read_b64_tr_b16 a[178:179], v12 offset:12288
    s_waitcnt lgkmcnt(12)
    v_mfma_f32_16x16x32_bf16 v[120:123], a[152:155], a[112:115], v[120:123]
    ds_read_b64_tr_b16 a[180:181], v13 offset:8192
    ds_read_b64_tr_b16 a[182:183], v13 offset:12288
    s_waitcnt lgkmcnt(12)
    v_mfma_f32_16x16x32_bf16 v[124:127], a[156:159], a[112:115], v[124:127]
    ds_read_b64_tr_b16 a[184:185], v14 offset:8192
    ds_read_b64_tr_b16 a[186:187], v14 offset:12288
    s_waitcnt lgkmcnt(12)
    v_mfma_f32_16x16x32_bf16 v[96:99], a[160:163], a[116:119], v[96:99]
    ds_read_b64_tr_b16 a[188:189], v15 offset:8192
    ds_read_b64_tr_b16 a[190:191], v15 offset:12288
    s_waitcnt lgkmcnt(12)
    v_mfma_f32_16x16x32_bf16 v[100:103], a[164:167], a[116:119], v[100:103]
    ds_read_b64_tr_b16 a[128:129], v8 offset:16384
    ds_read_b64_tr_b16 a[130:131], v8 offset:20480
    s_waitcnt lgkmcnt(12)
    v_mfma_f32_16x16x32_bf16 v[104:107], a[168:171], a[116:119], v[104:107]
    ds_read_b64_tr_b16 a[132:133], v9 offset:16384
    ds_read_b64_tr_b16 a[134:135], v9 offset:20480
    s_waitcnt lgkmcnt(12)
    v_mfma_f32_16x16x32_bf16 v[108:111], a[172:175], a[116:119], v[108:111]
    ds_read_b64_tr_b16 a[136:137], v10 offset:16384
    ds_read_b64_tr_b16 a[138:139], v10 offset:20480
    s_waitcnt lgkmcnt(12)
    v_mfma_f32_16x16x32_bf16 v[112:115], a[176:179], a[116:119], v[112:115]
    ds_read_b64_tr_b16 a[140:141], v11 offset:16384
    ds_read_b64_tr_b16 a[142:143], v11 offset:20480
    s_waitcnt lgkmcnt(12)
    v_mfma_f32_16x16x32_bf16 v[116:119], a[180:183], a[116:119], v[116:119]
    ds_read_b64_tr_b16 a[144:145], v12 offset:16384
    ds_read_b64_tr_b16 a[146:147], v12 offset:20480
    s_waitcnt lgkmcnt(12)
    v_mfma_f32_16x16x32_bf16 v[120:123], a[184:187], a[116:119], v[120:123]
    ds_read_b64_tr_b16 a[148:149], v13 offset:16384
    ds_read_b64_tr_b16 a[150:151], v13 offset:20480
    s_waitcnt lgkmcnt(12)
    v_mfma_f32_16x16x32_bf16 v[124:127], a[188:191], a[116:119], v[124:127]
    ds_read_b64_tr_b16 a[152:153], v14 offset:16384
    ds_read_b64_tr_b16 a[154:155], v14 offset:20480
    s_waitcnt vmcnt(13)
    s_barrier
    s_waitcnt lgkmcnt(12)
    v_mfma_f32_16x16x32_bf16 v[96:99], a[128:131], a[120:123], v[96:99]
    ds_read_b64_tr_b16 a[156:157], v15 offset:16384
    ds_read_b64_tr_b16 a[158:159], v15 offset:20480
    s_mov_b32 s82, 1703936
    s_add_u32 m0, s3, 114688
    s_nop 0
    buffer_load_dwordx4 v17, s[52:55], s82 offen lds
    s_waitcnt lgkmcnt(12)
    v_mfma_f32_16x16x32_bf16 v[100:103], a[132:135], a[120:123], v[100:103]
    ds_read_b64_tr_b16 a[160:161], v8 offset:24576
    ds_read_b64_tr_b16 a[162:163], v8 offset:28672
    s_waitcnt lgkmcnt(12)
    v_mfma_f32_16x16x32_bf16 v[104:107], a[136:139], a[120:123], v[104:107]
    ds_read_b64_tr_b16 a[164:165], v9 offset:24576
    ds_read_b64_tr_b16 a[166:167], v9 offset:28672
    s_waitcnt lgkmcnt(12)
    v_mfma_f32_16x16x32_bf16 v[108:111], a[140:143], a[120:123], v[108:111]
    ds_read_b64_tr_b16 a[168:169], v10 offset:24576
    ds_read_b64_tr_b16 a[170:171], v10 offset:28672
    buffer_load_dwordx4 v18, s[52:55], s82 offen offset:1024 lds
    s_waitcnt lgkmcnt(12)
    v_mfma_f32_16x16x32_bf16 v[112:115], a[144:147], a[120:123], v[112:115]
    ds_read_b64_tr_b16 a[172:173], v11 offset:24576
    ds_read_b64_tr_b16 a[174:175], v11 offset:28672
    s_waitcnt lgkmcnt(12)
    v_mfma_f32_16x16x32_bf16 v[116:119], a[148:151], a[120:123], v[116:119]
    ds_read_b64_tr_b16 a[176:177], v12 offset:24576
    ds_read_b64_tr_b16 a[178:179], v12 offset:28672
    s_waitcnt lgkmcnt(12)
    v_mfma_f32_16x16x32_bf16 v[120:123], a[152:155], a[120:123], v[120:123]
    ds_read_b64_tr_b16 a[180:181], v13 offset:24576
    ds_read_b64_tr_b16 a[182:183], v13 offset:28672
    s_mov_b32 s83, 1769472
    s_add_u32 m0, s3, 122880
    s_nop 0
    buffer_load_dwordx4 v17, s[52:55], s83 offen lds
    s_waitcnt lgkmcnt(12)
    v_mfma_f32_16x16x32_bf16 v[124:127], a[156:159], a[120:123], v[124:127]
    ds_read_b64_tr_b16 a[184:185], v14 offset:24576
    ds_read_b64_tr_b16 a[186:187], v14 offset:28672
    s_waitcnt lgkmcnt(12)
    v_mfma_f32_16x16x32_bf16 v[96:99], a[160:163], a[124:127], v[96:99]
    ds_read_b64_tr_b16 a[188:189], v15 offset:24576
    ds_read_b64_tr_b16 a[190:191], v15 offset:28672
    buffer_load_dword v43, off, s[56:59], s77 sc1
    s_waitcnt lgkmcnt(12)
    v_mfma_f32_16x16x32_bf16 v[100:103], a[164:167], a[124:127], v[100:103]
    ds_read_b64_tr_b16 a[128:129], v8 offset:32768
    ds_read_b64_tr_b16 a[130:131], v8 offset:36864
    buffer_load_dwordx4 v18, s[52:55], s83 offen offset:1024 lds
    s_waitcnt lgkmcnt(12)
    v_mfma_f32_16x16x32_bf16 v[104:107], a[168:171], a[124:127], v[104:107]
    ds_read_b64_tr_b16 a[132:133], v9 offset:32768
    ds_read_b64_tr_b16 a[134:135], v9 offset:36864
    s_waitcnt lgkmcnt(12)
    v_mfma_f32_16x16x32_bf16 v[108:111], a[172:175], a[124:127], v[108:111]
    ds_read_b64_tr_b16 a[136:137], v10 offset:32768
    ds_read_b64_tr_b16 a[138:139], v10 offset:36864
    s_waitcnt lgkmcnt(12)
    v_mfma_f32_16x16x32_bf16 v[112:115], a[176:179], a[124:127], v[112:115]
    ds_read_b64_tr_b16 a[140:141], v11 offset:32768
    ds_read_b64_tr_b16 a[142:143], v11 offset:36864
    s_mov_b32 s82, 1835008
    s_add_u32 m0, s3, 131072
    s_nop 0
    buffer_load_dwordx4 v17, s[52:55], s82 offen lds
    s_waitcnt lgkmcnt(12)
    v_mfma_f32_16x16x32_bf16 v[116:119], a[180:183], a[124:127], v[116:119]
    ds_read_b64_tr_b16 a[144:145], v12 offset:32768
    ds_read_b64_tr_b16 a[146:147], v12 offset:36864
    s_waitcnt lgkmcnt(12)
    v_mfma_f32_16x16x32_bf16 v[120:123], a[184:187], a[124:127], v[120:123]
    ds_read_b64_tr_b16 a[148:149], v13 offset:32768
    ds_read_b64_tr_b16 a[150:151], v13 offset:36864
    s_waitcnt lgkmcnt(12)
    v_mfma_f32_16x16x32_bf16 v[124:127], a[188:191], a[124:127], v[124:127]
    ds_read_b64_tr_b16 a[152:153], v14 offset:32768
    ds_read_b64_tr_b16 a[154:155], v14 offset:36864
    buffer_load_dwordx4 v18, s[52:55], s82 offen offset:1024 lds
    s_waitcnt lgkmcnt(12)
    v_mfma_f32_16x16x32_bf16 v[96:99], a[128:131], a[0:3], v[96:99]
    ds_read_b64_tr_b16 a[156:157], v15 offset:32768
    ds_read_b64_tr_b16 a[158:159], v15 offset:36864
    s_waitcnt lgkmcnt(12)
    v_mfma_f32_16x16x32_bf16 v[100:103], a[132:135], a[0:3], v[100:103]
    ds_read_b64_tr_b16 a[160:161], v8 offset:40960
    ds_read_b64_tr_b16 a[162:163], v8 offset:45056
    s_waitcnt lgkmcnt(12)
    v_mfma_f32_16x16x32_bf16 v[104:107], a[136:139], a[0:3], v[104:107]
    ds_read_b64_tr_b16 a[164:165], v9 offset:40960
    ds_read_b64_tr_b16 a[166:167], v9 offset:45056
    s_mov_b32 s83, 1900544
    s_add_u32 m0, s3, 139264
    s_nop 0
    buffer_load_dwordx4 v17, s[52:55], s83 offen lds
    s_waitcnt lgkmcnt(12)
    v_mfma_f32_16x16x32_bf16 v[108:111], a[140:143], a[0:3], v[108:111]
    ds_read_b64_tr_b16 a[168:169], v10 offset:40960
    ds_read_b64_tr_b16 a[170:171], v10 offset:45056
    s_waitcnt lgkmcnt(12)
    v_mfma_f32_16x16x32_bf16 v[112:115], a[144:147], a[0:3], v[112:115]
    ds_read_b64_tr_b16 a[172:173], v11 offset:40960
    ds_read_b64_tr_b16 a[174:175], v11 offset:45056
    s_waitcnt lgkmcnt(12)
    v_mfma_f32_16x16x32_bf16 v[116:119], a[148:151], a[0:3], v[116:119]
    ds_read_b64_tr_b16 a[176:177], v12 offset:40960
    ds_read_b64_tr_b16 a[178:179], v12 offset:45056
    buffer_load_dwordx4 v18, s[52:55], s83 offen offset:1024 lds
    s_waitcnt lgkmcnt(12)
    v_mfma_f32_16x16x32_bf16 v[120:123], a[152:155], a[0:3], v[120:123]
    ds_read_b64_tr_b16 a[180:181], v13 offset:40960
    ds_read_b64_tr_b16 a[182:183], v13 offset:45056
    s_waitcnt lgkmcnt(12)
    v_mfma_f32_16x16x32_bf16 v[124:127], a[156:159], a[0:3], v[124:127]
    ds_read_b64_tr_b16 a[184:185], v14 offset:40960
    ds_read_b64_tr_b16 a[186:187], v14 offset:45056
    s_waitcnt lgkmcnt(12)
    v_mfma_f32_16x16x32_bf16 v[96:99], a[160:163], a[4:7], v[96:99]
    ds_read_b64_tr_b16 a[188:189], v15 offset:40960
    ds_read_b64_tr_b16 a[190:191], v15 offset:45056
    s_mov_b32 s82, 1966080
    s_add_u32 m0, s3, 147456
    s_nop 0
    buffer_load_dwordx4 v17, s[52:55], s82 offen lds
    s_waitcnt lgkmcnt(12)
    v_mfma_f32_16x16x32_bf16 v[100:103], a[164:167], a[4:7], v[100:103]
    ds_read_b64_tr_b16 a[128:129], v8 offset:49152
    ds_read_b64_tr_b16 a[130:131], v8 offset:53248
    s_waitcnt lgkmcnt(12)
    v_mfma_f32_16x16x32_bf16 v[104:107], a[168:171], a[4:7], v[104:107]
    ds_read_b64_tr_b16 a[132:133], v9 offset:49152
    ds_read_b64_tr_b16 a[134:135], v9 offset:53248
    s_waitcnt lgkmcnt(12)
    v_mfma_f32_16x16x32_bf16 v[108:111], a[172:175], a[4:7], v[108:111]
    ds_read_b64_tr_b16 a[136:137], v10 offset:49152
    ds_read_b64_tr_b16 a[138:139], v10 offset:53248
    buffer_load_dwordx4 v18, s[52:55], s82 offen offset:1024 lds
    s_waitcnt lgkmcnt(12)
    v_mfma_f32_16x16x32_bf16 v[112:115], a[176:179], a[4:7], v[112:115]
    ds_read_b64_tr_b16 a[140:141], v11 offset:49152
    ds_read_b64_tr_b16 a[142:143], v11 offset:53248
    s_waitcnt lgkmcnt(12)
    v_mfma_f32_16x16x32_bf16 v[116:119], a[180:183], a[4:7], v[116:119]
    ds_read_b64_tr_b16 a[144:145], v12 offset:49152
    ds_read_b64_tr_b16 a[146:147], v12 offset:53248
    s_waitcnt lgkmcnt(12)
    v_mfma_f32_16x16x32_bf16 v[120:123], a[184:187], a[4:7], v[120:123]
    ds_read_b64_tr_b16 a[148:149], v13 offset:49152
    ds_read_b64_tr_b16 a[150:151], v13 offset:53248
    s_mov_b32 s83, 2031616
    s_add_u32 m0, s3, 155648
    s_nop 0
    buffer_load_dwordx4 v17, s[52:55], s83 offen lds
    s_waitcnt lgkmcnt(12)
    v_mfma_f32_16x16x32_bf16 v[124:127], a[188:191], a[4:7], v[124:127]
    ds_read_b64_tr_b16 a[152:153], v14 offset:49152
    ds_read_b64_tr_b16 a[154:155], v14 offset:53248
    s_waitcnt vmcnt(12)
    s_barrier
    s_waitcnt lgkmcnt(12)
    v_mfma_f32_16x16x32_bf16 v[96:99], a[128:131], a[8:11], v[96:99]
    ds_read_b64_tr_b16 a[156:157], v15 offset:49152
    ds_read_b64_tr_b16 a[158:159], v15 offset:53248
    s_waitcnt lgkmcnt(12)
    v_mfma_f32_16x16x32_bf16 v[100:103], a[132:135], a[8:11], v[100:103]
    ds_read_b64_tr_b16 a[160:161], v8 offset:57344
    ds_read_b64_tr_b16 a[162:163], v8 offset:61440
    buffer_load_dwordx4 v18, s[52:55], s83 offen offset:1024 lds
    s_waitcnt lgkmcnt(12)
    v_mfma_f32_16x16x32_bf16 v[104:107], a[136:139], a[8:11], v[104:107]
    ds_read_b64_tr_b16 a[164:165], v9 offset:57344
    ds_read_b64_tr_b16 a[166:167], v9 offset:61440
    s_waitcnt lgkmcnt(12)
    v_mfma_f32_16x16x32_bf16 v[108:111], a[140:143], a[8:11], v[108:111]
    ds_read_b64_tr_b16 a[168:169], v10 offset:57344
    ds_read_b64_tr_b16 a[170:171], v10 offset:61440
    s_waitcnt lgkmcnt(12)
    v_mfma_f32_16x16x32_bf16 v[112:115], a[144:147], a[8:11], v[112:115]
    ds_read_b64_tr_b16 a[172:173], v11 offset:57344
    ds_read_b64_tr_b16 a[174:175], v11 offset:61440
    s_waitcnt lgkmcnt(12)
    v_mfma_f32_16x16x32_bf16 v[116:119], a[148:151], a[8:11], v[116:119]
    ds_read_b64_tr_b16 a[176:177], v12 offset:57344
    ds_read_b64_tr_b16 a[178:179], v12 offset:61440
    s_waitcnt lgkmcnt(12)
    v_mfma_f32_16x16x32_bf16 v[120:123], a[152:155], a[8:11], v[120:123]
    ds_read_b64_tr_b16 a[180:181], v13 offset:57344
    ds_read_b64_tr_b16 a[182:183], v13 offset:61440
    s_waitcnt lgkmcnt(12)
    v_mfma_f32_16x16x32_bf16 v[124:127], a[156:159], a[8:11], v[124:127]
    ds_read_b64_tr_b16 a[184:185], v14 offset:57344
    ds_read_b64_tr_b16 a[186:187], v14 offset:61440
    s_waitcnt lgkmcnt(12)
    v_mfma_f32_16x16x32_bf16 v[96:99], a[160:163], a[12:15], v[96:99]
    ds_read_b64_tr_b16 a[188:189], v15 offset:57344
    ds_read_b64_tr_b16 a[190:191], v15 offset:61440
    s_waitcnt lgkmcnt(12)
    v_mfma_f32_16x16x32_bf16 v[100:103], a[164:167], a[12:15], v[100:103]
    ds_read_b64_tr_b16 a[128:129], v48 offset:0
    ds_read_b64_tr_b16 a[130:131], v48 offset:4096
    s_waitcnt lgkmcnt(12)
    v_mfma_f32_16x16x32_bf16 v[104:107], a[168:171], a[12:15], v[104:107]
    ds_read_b64_tr_b16 a[132:133], v49 offset:0
    ds_read_b64_tr_b16 a[134:135], v49 offset:4096
    s_waitcnt lgkmcnt(12)
    v_mfma_f32_16x16x32_bf16 v[108:111], a[172:175], a[12:15], v[108:111]
    ds_read_b64_tr_b16 a[136:137], v50 offset:0
    ds_read_b64_tr_b16 a[138:139], v50 offset:4096
    s_waitcnt lgkmcnt(12)
    v_mfma_f32_16x16x32_bf16 v[112:115], a[176:179], a[12:15], v[112:115]
    ds_read_b64_tr_b16 a[140:141], v51 offset:0
    ds_read_b64_tr_b16 a[142:143], v51 offset:4096
    s_waitcnt lgkmcnt(12)
    v_mfma_f32_16x16x32_bf16 v[116:119], a[180:183], a[12:15], v[116:119]
    ds_read_b64_tr_b16 a[144:145], v52 offset:0
    ds_read_b64_tr_b16 a[146:147], v52 offset:4096
    s_waitcnt lgkmcnt(12)
    v_mfma_f32_16x16x32_bf16 v[120:123], a[184:187], a[12:15], v[120:123]
    ds_read_b64_tr_b16 a[148:149], v53 offset:0
    ds_read_b64_tr_b16 a[150:151], v53 offset:4096
    s_waitcnt lgkmcnt(12)
    v_mfma_f32_16x16x32_bf16 v[124:127], a[188:191], a[12:15], v[124:127]
    ds_read_b64_tr_b16 a[152:153], v54 offset:0
    ds_read_b64_tr_b16 a[154:155], v54 offset:4096
    s_waitcnt lgkmcnt(12)
    v_mfma_f32_16x16x32_bf16 v[96:99], a[128:131], a[16:19], v[96:99]
    ds_read_b64_tr_b16 a[156:157], v55 offset:0
    ds_read_b64_tr_b16 a[158:159], v55 offset:4096
    s_waitcnt vmcnt(9)
    v_readfirstlane_b32 s86, v43
    s_cmp_eq_u32 s86, 4
    s_cbranch_scc0 L_spP
L_okP:
    buffer_load_dwordx4 v[164:167], v16, s[56:59], s73 offen offset:0 sc1
    s_waitcnt lgkmcnt(12)
    v_mfma_f32_16x16x32_bf16 v[100:103], a[132:135], a[16:19], v[100:103]
    ds_read_b64_tr_b16 a[160:161], v48 offset:8192
    ds_read_b64_tr_b16 a[162:163], v48 offset:12288
    buffer_load_dwordx4 v[172:175], v16, s[56:59], s73 offen offset:1024 sc1
    s_waitcnt lgkmcnt(12)
    v_mfma_f32_16x16x32_bf16 v[104:107], a[136:139], a[16:19], v[104:107]
    ds_read_b64_tr_b16 a[164:165], v49 offset:8192
    ds_read_b64_tr_b16 a[166:167], v49 offset:12288
    buffer_load_dwordx4 v[180:183], v16, s[56:59], s73 offen offset:2048 sc1
    s_waitcnt lgkmcnt(12)
    v_mfma_f32_16x16x32_bf16 v[108:111], a[140:143], a[16:19], v[108:111]
    ds_read_b64_tr_b16 a[168:169], v50 offset:8192
    ds_read_b64_tr_b16 a[170:171], v50 offset:12288
    buffer_load_dwordx4 v[188:191], v16, s[56:59], s73 offen offset:3072 sc1
    s_waitcnt lgkmcnt(12)
    v_mfma_f32_16x16x32_bf16 v[112:115], a[144:147], a[16:19], v[112:115]
    ds_read_b64_tr_b16 a[172:173], v51 offset:8192
    ds_read_b64_tr_b16 a[174:175], v51 offset:12288
    buffer_load_dwordx4 v[196:199], v16, s[56:59], s74 offen offset:0 sc1
    s_waitcnt lgkmcnt(12)
    v_mfma_f32_16x16x32_bf16 v[116:119], a[148:151], a[16:19], v[116:119]
    ds_read_b64_tr_b16 a[176:177], v52 offset:8192
    ds_read_b64_tr_b16 a[178:179], v52 offset:12288
    buffer_load_dwordx4 v[204:207], v16, s[56:59], s74 offen offset:1024 sc1
    s_waitcnt lgkmcnt(12)
    v_mfma_f32_16x16x32_bf16 v[120:123], a[152:155], a[16:19], v[120:123]
    ds_read_b64_tr_b16 a[180:181], v53 offset:8192
    ds_read_b64_tr_b16 a[182:183], v53 offset:12288
    buffer_load_dwordx4 v[212:215], v16, s[56:59], s74 offen offset:2048 sc1
    s_waitcnt lgkmcnt(12)
    v_mfma_f32_16x16x32_bf16 v[124:127], a[156:159], a[16:19], v[124:127]
    ds_read_b64_tr_b16 a[184:185], v54 offset:8192
    ds_read_b64_tr_b16 a[186:187], v54 offset:12288
    buffer_load_dwordx4 v[220:223], v16, s[56:59], s74 offen offset:3072 sc1
    s_waitcnt lgkmcnt(12)
    v_mfma_f32_16x16x32_bf16 v[96:99], a[160:163], a[20:23], v[96:99]
    ds_read_b64_tr_b16 a[188:189], v55 offset:8192
    ds_read_b64_tr_b16 a[190:191], v55 offset:12288
    buffer_load_dwordx4 v[228:231], v16, s[56:59], s75 offen offset:0 sc1
    s_waitcnt lgkmcnt(12)
    v_mfma_f32_16x16x32_bf16 v[100:103], a[164:167], a[20:23], v[100:103]
    ds_read_b64_tr_b16 a[128:129], v48 offset:16384
    ds_read_b64_tr_b16 a[130:131], v48 offset:20480
    buffer_load_dwordx4 v[236:239], v16, s[56:59], s75 offen offset:1024 sc1
    s_waitcnt lgkmcnt(12)
    v_mfma_f32_16x16x32_bf16 v[104:107], a[168:171], a[20:23], v[104:107]
    ds_read_b64_tr_b16 a[132:133], v49 offset:16384
    ds_read_b64_tr_b16 a[134:135], v49 offset:20480
    buffer_load_dwordx4 v[244:247], v16, s[56:59], s75 offen offset:2048 sc1
    s_waitcnt lgkmcnt(12)
    v_mfma_f32_16x16x32_bf16 v[108:111], a[172:175], a[20:23], v[108:111]
    ds_read_b64_tr_b16 a[136:137], v50 offset:16384
    ds_read_b64_tr_b16 a[138:139], v50 offset:20480
    buffer_load_dwordx4 v[252:255], v16, s[56:59], s75 offen offset:3072 sc1
    s_waitcnt lgkmcnt(12)
    v_mfma_f32_16x16x32_bf16 v[112:115], a[176:179], a[20:23], v[112:115]
    ds_read_b64_tr_b16 a[140:141], v51 offset:16384
    ds_read_b64_tr_b16 a[142:143], v51 offset:20480
    s_waitcnt lgkmcnt(12)
    v_mfma_f32_16x16x32_bf16 v[116:119], a[180:183], a[20:23], v[116:119]
    ds_read_b64_tr_b16 a[144:145], v52 offset:16384
    ds_read_b64_tr_b16 a[146:147], v52 offset:20480
    s_waitcnt lgkmcnt(12)
    v_mfma_f32_16x16x32_bf16 v[120:123], a[184:187], a[20:23], v[120:123]
    ds_read_b64_tr_b16 a[148:149], v53 offset:16384
    ds_read_b64_tr_b16 a[150:151], v53 offset:20480
    s_waitcnt lgkmcnt(12)
    v_mfma_f32_16x16x32_bf16 v[124:127], a[188:191], a[20:23], v[124:127]
    ds_read_b64_tr_b16 a[152:153], v54 offset:16384
    ds_read_b64_tr_b16 a[154:155], v54 offset:20480
    s_waitcnt lgkmcnt(12)
    v_mfma_f32_16x16x32_bf16 v[96:99], a[128:131], a[24:27], v[96:99]
    ds_read_b64_tr_b16 a[156:157], v55 offset:16384
    ds_read_b64_tr_b16 a[158:159], v55 offset:20480
    s_waitcnt lgkmcnt(12)
    v_mfma_f32_16x16x32_bf16 v[100:103], a[132:135], a[24:27], v[100:103]
    ds_read_b64_tr_b16 a[160:161], v48 offset:24576
    ds_read_b64_tr_b16 a[162:163], v48 offset:28672
    s_waitcnt lgkmcnt(12)
    v_mfma_f32_16x16x32_bf16 v[104:107], a[136:139], a[24:27], v[104:107]
    ds_read_b64_tr_b16 a[164:165], v49 offset:24576
    ds_read_b64_tr_b16 a[166:167], v49 offset:28672
    s_waitcnt lgkmcnt(12)
    v_mfma_f32_16x16x32_bf16 v[108:111], a[140:143], a[24:27], v[108:111]
    ds_read_b64_tr_b16 a[168:169], v50 offset:24576
    ds_read_b64_tr_b16 a[170:171], v50 offset:28672
    s_waitcnt lgkmcnt(12)
    v_mfma_f32_16x16x32_bf16 v[112:115], a[144:147], a[24:27], v[112:115]
    ds_read_b64_tr_b16 a[172:173], v51 offset:24576
    ds_read_b64_tr_b16 a[174:175], v51 offset:28672
    s_waitcnt lgkmcnt(12)
    v_mfma_f32_16x16x32_bf16 v[116:119], a[148:151], a[24:27], v[116:119]
    ds_read_b64_tr_b16 a[176:177], v52 offset:24576
    ds_read_b64_tr_b16 a[178:179], v52 offset:28672
    s_waitcnt lgkmcnt(12)
    v_mfma_f32_16x16x32_bf16 v[120:123], a[152:155], a[24:27], v[120:123]
    ds_read_b64_tr_b16 a[180:181], v53 offset:24576
    ds_read_b64_tr_b16 a[182:183], v53 offset:28672
    s_waitcnt lgkmcnt(12)
    v_mfma_f32_16x16x32_bf16 v[124:127], a[156:159], a[24:27], v[124:127]
    ds_read_b64_tr_b16 a[184:185], v54 offset:24576
    ds_read_b64_tr_b16 a[186:187], v54 offset:28672
    s_waitcnt lgkmcnt(12)
    v_mfma_f32_16x16x32_bf16 v[96:99], a[160:163], a[28:31], v[96:99]
    ds_read_b64_tr_b16 a[188:189], v55 offset:24576
    ds_read_b64_tr_b16 a[190:191], v55 offset:28672
    s_waitcnt lgkmcnt(12)
    v_mfma_f32_16x16x32_bf16 v[100:103], a[164:167], a[28:31], v[100:103]
    ds_read_b64_tr_b16 a[128:129], v48 offset:32768
    ds_read_b64_tr_b16 a[130:131], v48 offset:36864
    s_waitcnt lgkmcnt(12)
    v_mfma_f32_16x16x32_bf16 v[104:107], a[168:171], a[28:31], v[104:107]
    ds_read_b64_tr_b16 a[132:133], v49 offset:32768
    ds_read_b64_tr_b16 a[134:135], v49 offset:36864
    s_waitcnt lgkmcnt(12)
    v_mfma_f32_16x16x32_bf16 v[108:111], a[172:175], a[28:31], v[108:111]
    ds_read_b64_tr_b16 a[136:137], v50 offset:32768
    ds_read_b64_tr_b16 a[138:139], v50 offset:36864
    s_waitcnt lgkmcnt(12)
    v_mfma_f32_16x16x32_bf16 v[112:115], a[176:179], a[28:31], v[112:115]
    ds_read_b64_tr_b16 a[140:141], v51 offset:32768
    ds_read_b64_tr_b16 a[142:143], v51 offset:36864
    s_waitcnt lgkmcnt(12)
    v_mfma_f32_16x16x32_bf16 v[116:119], a[180:183], a[28:31], v[116:119]
    ds_read_b64_tr_b16 a[144:145], v52 offset:32768
    ds_read_b64_tr_b16 a[146:147], v52 offset:36864
    s_waitcnt lgkmcnt(12)
    v_mfma_f32_16x16x32_bf16 v[120:123], a[184:187], a[28:31], v[120:123]
    ds_read_b64_tr_b16 a[148:149], v53 offset:32768
    ds_read_b64_tr_b16 a[150:151], v53 offset:36864
    s_waitcnt lgkmcnt(12)
    v_mfma_f32_16x16x32_bf16 v[124:127], a[188:191], a[28:31], v[124:127]
    ds_read_b64_tr_b16 a[152:153], v54 offset:32768
    ds_read_b64_tr_b16 a[154:155], v54 offset:36864
    s_waitcnt vmcnt(12)
    s_barrier
    s_waitcnt lgkmcnt(12)
    v_mfma_f32_16x16x32_bf16 v[96:99], a[128:131], a[32:35], v[96:99]
    ds_read_b64_tr_b16 a[156:157], v55 offset:32768
    ds_read_b64_tr_b16 a[158:159], v55 offset:36864
    s_waitcnt lgkmcnt(12)
    v_mfma_f32_16x16x32_bf16 v[100:103], a[132:135], a[32:35], v[100:103]
    ds_read_b64_tr_b16 a[160:161], v48 offset:40960
    ds_read_b64_tr_b16 a[162:163], v48 offset:45056
    s_waitcnt lgkmcnt(12)
    v_mfma_f32_16x16x32_bf16 v[104:107], a[136:139], a[32:35], v[104:107]
    ds_read_b64_tr_b16 a[164:165], v49 offset:40960
    ds_read_b64_tr_b16 a[166:167], v49 offset:45056
    s_waitcnt lgkmcnt(12)
    v_mfma_f32_16x16x32_bf16 v[108:111], a[140:143], a[32:35], v[108:111]
    ds_read_b64_tr_b16 a[168:169], v50 offset:40960
    ds_read_b64_tr_b16 a[170:171], v50 offset:45056
    s_waitcnt lgkmcnt(12)
    v_mfma_f32_16x16x32_bf16 v[112:115], a[144:147], a[32:35], v[112:115]
    ds_read_b64_tr_b16 a[172:173], v51 offset:40960
    ds_read_b64_tr_b16 a[174:175], v51 offset:45056
    s_waitcnt lgkmcnt(12)
    v_mfma_f32_16x16x32_bf16 v[116:119], a[148:151], a[32:35], v[116:119]
    ds_read_b64_tr_b16 a[176:177], v52 offset:40960
    ds_read_b64_tr_b16 a[178:179], v52 offset:45056
    s_waitcnt lgkmcnt(12)
    v_mfma_f32_16x16x32_bf16 v[120:123], a[152:155], a[32:35], v[120:123]
    ds_read_b64_tr_b16 a[180:181], v53 offset:40960
    ds_read_b64_tr_b16 a[182:183], v53 offset:45056
    s_waitcnt lgkmcnt(12)
    v_mfma_f32_16x16x32_bf16 v[124:127], a[156:159], a[32:35], v[124:127]
    ds_read_b64_tr_b16 a[184:185], v54 offset:40960
    ds_read_b64_tr_b16 a[186:187], v54 offset:45056
    s_waitcnt lgkmcnt(12)
    v_mfma_f32_16x16x32_bf16 v[96:99], a[160:163], a[36:39], v[96:99]
    ds_read_b64_tr_b16 a[188:189], v55 offset:40960
    ds_read_b64_tr_b16 a[190:191], v55 offset:45056
    s_waitcnt lgkmcnt(12)
    v_mfma_f32_16x16x32_bf16 v[100:103], a[164:167], a[36:39], v[100:103]
    ds_read_b64_tr_b16 a[128:129], v48 offset:49152
    ds_read_b64_tr_b16 a[130:131], v48 offset:53248
    s_waitcnt lgkmcnt(12)
    v_mfma_f32_16x16x32_bf16 v[104:107], a[168:171], a[36:39], v[104:107]
    ds_read_b64_tr_b16 a[132:133], v49 offset:49152
    ds_read_b64_tr_b16 a[134:135], v49 offset:53248
    s_waitcnt lgkmcnt(12)
    v_mfma_f32_16x16x32_bf16 v[108:111], a[172:175], a[36:39], v[108:111]
    ds_read_b64_tr_b16 a[136:137], v50 offset:49152
    ds_read_b64_tr_b16 a[138:139], v50 offset:53248
    s_waitcnt lgkmcnt(12)
    v_mfma_f32_16x16x32_bf16 v[112:115], a[176:179], a[36:39], v[112:115]
    ds_read_b64_tr_b16 a[140:141], v51 offset:49152
    ds_read_b64_tr_b16 a[142:143], v51 offset:53248
    s_waitcnt lgkmcnt(12)
    v_mfma_f32_16x16x32_bf16 v[116:119], a[180:183], a[36:39], v[116:119]
    ds_read_b64_tr_b16 a[144:145], v52 offset:49152
    ds_read_b64_tr_b16 a[146:147], v52 offset:53248
    s_waitcnt lgkmcnt(12)
    v_mfma_f32_16x16x32_bf16 v[120:123], a[184:187], a[36:39], v[120:123]
    ds_read_b64_tr_b16 a[148:149], v53 offset:49152
    ds_read_b64_tr_b16 a[150:151], v53 offset:53248
    s_waitcnt lgkmcnt(12)
    v_mfma_f32_16x16x32_bf16 v[124:127], a[188:191], a[36:39], v[124:127]
    ds_read_b64_tr_b16 a[152:153], v54 offset:49152
    ds_read_b64_tr_b16 a[154:155], v54 offset:53248
    s_waitcnt lgkmcnt(12)
    v_mfma_f32_16x16x32_bf16 v[96:99], a[128:131], a[40:43], v[96:99]
    ds_read_b64_tr_b16 a[156:157], v55 offset:49152
    ds_read_b64_tr_b16 a[158:159], v55 offset:53248
    s_waitcnt lgkmcnt(12)
    v_mfma_f32_16x16x32_bf16 v[100:103], a[132:135], a[40:43], v[100:103]
    ds_read_b64_tr_b16 a[160:161], v48 offset:57344
    ds_read_b64_tr_b16 a[162:163], v48 offset:61440
    s_waitcnt lgkmcnt(12)
    v_mfma_f32_16x16x32_bf16 v[104:107], a[136:139], a[40:43], v[104:107]
    ds_read_b64_tr_b16 a[164:165], v49 offset:57344
    ds_read_b64_tr_b16 a[166:167], v49 offset:61440
    s_waitcnt lgkmcnt(12)
    v_mfma_f32_16x16x32_bf16 v[108:111], a[140:143], a[40:43], v[108:111]
    ds_read_b64_tr_b16 a[168:169], v50 offset:57344
    ds_read_b64_tr_b16 a[170:171], v50 offset:61440
    s_waitcnt lgkmcnt(12)
    v_mfma_f32_16x16x32_bf16 v[112:115], a[144:147], a[40:43], v[112:115]
    ds_read_b64_tr_b16 a[172:173], v51 offset:57344
    ds_read_b64_tr_b16 a[174:175], v51 offset:61440
    s_waitcnt lgkmcnt(12)
    v_mfma_f32_16x16x32_bf16 v[116:119], a[148:151], a[40:43], v[116:119]
    ds_read_b64_tr_b16 a[176:177], v52 offset:57344
    ds_read_b64_tr_b16 a[178:179], v52 offset:61440
    s_waitcnt lgkmcnt(12)
    v_mfma_f32_16x16x32_bf16 v[120:123], a[152:155], a[40:43], v[120:123]
    ds_read_b64_tr_b16 a[180:181], v53 offset:57344
    ds_read_b64_tr_b16 a[182:183], v53 offset:61440
    s_waitcnt lgkmcnt(12)
    v_mfma_f32_16x16x32_bf16 v[124:127], a[156:159], a[40:43], v[124:127]
    ds_read_b64_tr_b16 a[184:185], v54 offset:57344
    ds_read_b64_tr_b16 a[186:187], v54 offset:61440
    s_waitcnt lgkmcnt(12)
    v_mfma_f32_16x16x32_bf16 v[96:99], a[160:163], a[44:47], v[96:99]
    ds_read_b64_tr_b16 a[188:189], v55 offset:57344
    ds_read_b64_tr_b16 a[190:191], v55 offset:61440
    s_waitcnt lgkmcnt(12)
    v_mfma_f32_16x16x32_bf16 v[100:103], a[164:167], a[44:47], v[100:103]
    ds_read_b64_tr_b16 a[128:129], v56 offset:0
    ds_read_b64_tr_b16 a[130:131], v56 offset:4096
    s_waitcnt lgkmcnt(12)
    v_mfma_f32_16x16x32_bf16 v[104:107], a[168:171], a[44:47], v[104:107]
    ds_read_b64_tr_b16 a[132:133], v57 offset:0
    ds_read_b64_tr_b16 a[134:135], v57 offset:4096
    s_waitcnt lgkmcnt(12)
    v_mfma_f32_16x16x32_bf16 v[108:111], a[172:175], a[44:47], v[108:111]
    ds_read_b64_tr_b16 a[136:137], v58 offset:0
    ds_read_b64_tr_b16 a[138:139], v58 offset:4096
    s_waitcnt lgkmcnt(12)
    v_mfma_f32_16x16x32_bf16 v[112:115], a[176:179], a[44:47], v[112:115]
    ds_read_b64_tr_b16 a[140:141], v59 offset:0
    ds_read_b64_tr_b16 a[142:143], v59 offset:4096
    s_waitcnt lgkmcnt(12)
    v_mfma_f32_16x16x32_bf16 v[116:119], a[180:183], a[44:47], v[116:119]
    ds_read_b64_tr_b16 a[144:145], v60 offset:0
    ds_read_b64_tr_b16 a[146:147], v60 offset:4096
    s_waitcnt lgkmcnt(12)
    v_mfma_f32_16x16x32_bf16 v[120:123], a[184:187], a[44:47], v[120:123]
    ds_read_b64_tr_b16 a[148:149], v61 offset:0
    ds_read_b64_tr_b16 a[150:151], v61 offset:4096
    s_waitcnt lgkmcnt(12)
    v_mfma_f32_16x16x32_bf16 v[124:127], a[188:191], a[44:47], v[124:127]
    ds_read_b64_tr_b16 a[152:153], v62 offset:0
    ds_read_b64_tr_b16 a[154:155], v62 offset:4096
    s_waitcnt lgkmcnt(12)
    v_mfma_f32_16x16x32_bf16 v[96:99], a[128:131], a[48:51], v[96:99]
    ds_read_b64_tr_b16 a[156:157], v63 offset:0
    ds_read_b64_tr_b16 a[158:159], v63 offset:4096
    s_waitcnt lgkmcnt(12)
    v_mfma_f32_16x16x32_bf16 v[100:103], a[132:135], a[48:51], v[100:103]
    ds_read_b64_tr_b16 a[160:161], v56 offset:8192
    ds_read_b64_tr_b16 a[162:163], v56 offset:12288
    s_waitcnt lgkmcnt(12)
    v_mfma_f32_16x16x32_bf16 v[104:107], a[136:139], a[48:51], v[104:107]
    ds_read_b64_tr_b16 a[164:165], v57 offset:8192
    ds_read_b64_tr_b16 a[166:167], v57 offset:12288
    s_waitcnt lgkmcnt(12)
    s_branch L_over13
L_stub13:
    s_branch L_stubret
L_over13:
    v_mfma_f32_16x16x32_bf16 v[108:111], a[140:143], a[48:51], v[108:111]
    ds_read_b64_tr_b16 a[168:169], v58 offset:8192
    ds_read_b64_tr_b16 a[170:171], v58 offset:12288
    s_waitcnt lgkmcnt(12)
    v_mfma_f32_16x16x32_bf16 v[112:115], a[144:147], a[48:51], v[112:115]
    ds_read_b64_tr_b16 a[172:173], v59 offset:8192
    ds_read_b64_tr_b16 a[174:175], v59 offset:12288
    s_waitcnt lgkmcnt(12)
    v_mfma_f32_16x16x32_bf16 v[116:119], a[148:151], a[48:51], v[116:119]
    ds_read_b64_tr_b16 a[176:177], v60 offset:8192
    ds_read_b64_tr_b16 a[178:179], v60 offset:12288
    s_waitcnt lgkmcnt(12)
    v_mfma_f32_16x16x32_bf16 v[120:123], a[152:155], a[48:51], v[120:123]
    ds_read_b64_tr_b16 a[180:181], v61 offset:8192
    ds_read_b64_tr_b16 a[182:183], v61 offset:12288
    s_waitcnt lgkmcnt(12)
    v_mfma_f32_16x16x32_bf16 v[124:127], a[156:159], a[48:51], v[124:127]
    ds_read_b64_tr_b16 a[184:185], v62 offset:8192
    ds_read_b64_tr_b16 a[186:187], v62 offset:12288
    s_waitcnt lgkmcnt(12)
    v_mfma_f32_16x16x32_bf16 v[96:99], a[160:163], a[52:55], v[96:99]
    ds_read_b64_tr_b16 a[188:189], v63 offset:8192
    ds_read_b64_tr_b16 a[190:191], v63 offset:12288
    s_waitcnt lgkmcnt(12)
    v_mfma_f32_16x16x32_bf16 v[100:103], a[164:167], a[52:55], v[100:103]
    ds_read_b64_tr_b16 a[128:129], v56 offset:16384
    ds_read_b64_tr_b16 a[130:131], v56 offset:20480
    s_waitcnt lgkmcnt(12)
    v_mfma_f32_16x16x32_bf16 v[104:107], a[168:171], a[52:55], v[104:107]
    ds_read_b64_tr_b16 a[132:133], v57 offset:16384
    ds_read_b64_tr_b16 a[134:135], v57 offset:20480
    s_waitcnt lgkmcnt(12)
    v_mfma_f32_16x16x32_bf16 v[108:111], a[172:175], a[52:55], v[108:111]
    ds_read_b64_tr_b16 a[136:137], v58 offset:16384
    ds_read_b64_tr_b16 a[138:139], v58 offset:20480
    s_waitcnt lgkmcnt(12)
    v_mfma_f32_16x16x32_bf16 v[112:115], a[176:179], a[52:55], v[112:115]
    ds_read_b64_tr_b16 a[140:141], v59 offset:16384
    ds_read_b64_tr_b16 a[142:143], v59 offset:20480
    s_waitcnt lgkmcnt(12)
    v_mfma_f32_16x16x32_bf16 v[116:119], a[180:183], a[52:55], v[116:119]
    ds_read_b64_tr_b16 a[144:145], v60 offset:16384
    ds_read_b64_tr_b16 a[146:147], v60 offset:20480
    s_waitcnt lgkmcnt(12)
    v_mfma_f32_16x16x32_bf16 v[120:123], a[184:187], a[52:55], v[120:123]
    ds_read_b64_tr_b16 a[148:149], v61 offset:16384
    ds_read_b64_tr_b16 a[150:151], v61 offset:20480
    s_waitcnt lgkmcnt(12)
    v_mfma_f32_16x16x32_bf16 v[124:127], a[188:191], a[52:55], v[124:127]
    ds_read_b64_tr_b16 a[152:153], v62 offset:16384
    ds_read_b64_tr_b16 a[154:155], v62 offset:20480
    s_waitcnt lgkmcnt(12)
    v_mfma_f32_16x16x32_bf16 v[96:99], a[128:131], a[56:59], v[96:99]
    ds_read_b64_tr_b16 a[156:157], v63 offset:16384
    ds_read_b64_tr_b16 a[158:159], v63 offset:20480
    s_waitcnt lgkmcnt(12)
    v_mfma_f32_16x16x32_bf16 v[100:103], a[132:135], a[56:59], v[100:103]
    ds_read_b64_tr_b16 a[160:161], v56 offset:24576
    ds_read_b64_tr_b16 a[162:163], v56 offset:28672
    s_waitcnt lgkmcnt(12)
    v_mfma_f32_16x16x32_bf16 v[104:107], a[136:139], a[56:59], v[104:107]
    ds_read_b64_tr_b16 a[164:165], v57 offset:24576
    ds_read_b64_tr_b16 a[166:167], v57 offset:28672
    s_waitcnt lgkmcnt(12)
    v_mfma_f32_16x16x32_bf16 v[108:111], a[140:143], a[56:59], v[108:111]
    ds_read_b64_tr_b16 a[168:169], v58 offset:24576
    ds_read_b64_tr_b16 a[170:171], v58 offset:28672
    s_waitcnt lgkmcnt(12)
    v_mfma_f32_16x16x32_bf16 v[112:115], a[144:147], a[56:59], v[112:115]
    ds_read_b64_tr_b16 a[172:173], v59 offset:24576
    ds_read_b64_tr_b16 a[174:175], v59 offset:28672
    s_waitcnt lgkmcnt(12)
    v_mfma_f32_16x16x32_bf16 v[116:119], a[148:151], a[56:59], v[116:119]
    ds_read_b64_tr_b16 a[176:177], v60 offset:24576
    ds_read_b64_tr_b16 a[178:179], v60 offset:28672
    s_waitcnt lgkmcnt(12)
    v_mfma_f32_16x16x32_bf16 v[120:123], a[152:155], a[56:59], v[120:123]
    ds_read_b64_tr_b16 a[180:181], v61 offset:24576
    ds_read_b64_tr_b16 a[182:183], v61 offset:28672
    s_waitcnt lgkmcnt(12)
    v_mfma_f32_16x16x32_bf16 v[124:127], a[156:159], a[56:59], v[124:127]
    ds_read_b64_tr_b16 a[184:185], v62 offset:24576
    ds_read_b64_tr_b16 a[186:187], v62 offset:28672
    s_waitcnt lgkmcnt(12)
    v_mfma_f32_16x16x32_bf16 v[96:99], a[160:163], a[60:63], v[96:99]
    ds_read_b64_tr_b16 a[188:189], v63 offset:24576
    ds_read_b64_tr_b16 a[190:191], v63 offset:28672
    s_waitcnt lgkmcnt(12)
    v_mfma_f32_16x16x32_bf16 v[100:103], a[164:167], a[60:63], v[100:103]
    s_waitcnt lgkmcnt(10)
    v_mfma_f32_16x16x32_bf16 v[104:107], a[168:171], a[60:63], v[104:107]
    s_waitcnt lgkmcnt(8)
    v_mfma_f32_16x16x32_bf16 v[108:111], a[172:175], a[60:63], v[108:111]
    s_waitcnt lgkmcnt(6)
    v_mfma_f32_16x16x32_bf16 v[112:115], a[176:179], a[60:63], v[112:115]
    s_waitcnt lgkmcnt(4)
    v_mfma_f32_16x16x32_bf16 v[116:119], a[180:183], a[60:63], v[116:119]
    s_waitcnt lgkmcnt(2)
    v_mfma_f32_16x16x32_bf16 v[120:123], a[184:187], a[60:63], v[120:123]
    s_waitcnt lgkmcnt(0)
    v_mfma_f32_16x16x32_bf16 v[124:127], a[188:191], a[60:63], v[124:127]
    s_waitcnt vmcnt(11)
    v_mfma_f32_16x16x32_bf16 v[128:131], v[28:31], v[164:167], v[128:131]
    v_mfma_f32_16x16x32_bf16 v[132:135], v[26:29], v[164:167], v[132:135]
    s_waitcnt vmcnt(10)
    v_mfma_f32_16x16x32_bf16 v[136:139], v[28:31], v[172:175], v[136:139]
    v_mfma_f32_16x16x32_bf16 v[140:143], v[26:29], v[172:175], v[140:143]
    s_waitcnt vmcnt(9)
    v_mfma_f32_16x16x32_bf16 v[144:147], v[28:31], v[180:183], v[144:147]
    v_mfma_f32_16x16x32_bf16 v[148:151], v[26:29], v[180:183], v[148:151]
    s_waitcnt vmcnt(8)
    v_mfma_f32_16x16x32_bf16 v[152:155], v[28:31], v[188:191], v[152:155]
    v_mfma_f32_16x16x32_bf16 v[156:159], v[26:29], v[188:191], v[156:159]
    s_waitcnt vmcnt(7)
    v_mfma_f32_16x16x32_bf16 v[128:131], v[28:31], v[196:199], v[128:131]
    v_mfma_f32_16x16x32_bf16 v[132:135], v[26:29], v[196:199], v[132:135]
    s_waitcnt vmcnt(6)
    v_mfma_f32_16x16x32_bf16 v[136:139], v[28:31], v[204:207], v[136:139]
    v_mfma_f32_16x16x32_bf16 v[140:143], v[26:29], v[204:207], v[140:143]
    s_waitcnt vmcnt(5)
    v_mfma_f32_16x16x32_bf16 v[144:147], v[28:31], v[212:215], v[144:147]
    v_mfma_f32_16x16x32_bf16 v[148:151], v[26:29], v[212:215], v[148:151]
    s_waitcnt vmcnt(4)
    v_mfma_f32_16x16x32_bf16 v[152:155], v[28:31], v[220:223], v[152:155]
    v_mfma_f32_16x16x32_bf16 v[156:159], v[26:29], v[220:223], v[156:159]
    s_waitcnt vmcnt(3)
    v_mfma_f32_16x16x32_bf16 v[128:131], v[28:31], v[228:231], v[128:131]
    v_mfma_f32_16x16x32_bf16 v[132:135], v[26:29], v[228:231], v[132:135]
    s_waitcnt vmcnt(2)
    v_mfma_f32_16x16x32_bf16 v[136:139], v[28:31], v[236:239], v[136:139]
    v_mfma_f32_16x16x32_bf16 v[140:143], v[26:29], v[236:239], v[140:143]
    s_waitcnt vmcnt(1)
    v_mfma_f32_16x16x32_bf16 v[144:147], v[28:31], v[244:247], v[144:147]
    v_mfma_f32_16x16x32_bf16 v[148:151], v[26:29], v[244:247], v[148:151]
    s_waitcnt vmcnt(0)
    v_mfma_f32_16x16x32_bf16 v[152:155], v[28:31], v[252:255], v[152:155]
    v_mfma_f32_16x16x32_bf16 v[156:159], v[26:29], v[252:255], v[156:159]
    v_pk_mul_f32 v[34:35], v[128:129], s[14:15]
    v_pk_mul_f32 v[36:37], v[130:131], s[14:15]
    v_pk_mul_f32 v[38:39], v[132:133], s[14:15]
    v_pk_mul_f32 v[40:41], v[134:135], s[14:15]
    v_exp_f32 v34, v34
    v_exp_f32 v35, v35
    v_exp_f32 v36, v36
    v_exp_f32 v37, v37
    v_exp_f32 v38, v38
    v_exp_f32 v39, v39
    v_exp_f32 v40, v40
    v_exp_f32 v41, v41
    v_pk_mul_f32 v[96:97], v[96:97], v[128:129]
    v_pk_mul_f32 v[98:99], v[98:99], v[130:131]
    v_pk_mul_f32 v[100:101], v[100:101], v[132:133]
    v_pk_mul_f32 v[102:103], v[102:103], v[134:135]
    v_pk_add_f32 v[34:35], v[34:35], 1.0 op_sel_hi:[1,0]
    v_pk_add_f32 v[36:37], v[36:37], 1.0 op_sel_hi:[1,0]
    v_pk_add_f32 v[38:39], v[38:39], 1.0 op_sel_hi:[1,0]
    v_pk_add_f32 v[40:41], v[40:41], 1.0 op_sel_hi:[1,0]
    v_rcp_f32 v34, v34
    v_rcp_f32 v35, v35
    v_rcp_f32 v36, v36
    v_rcp_f32 v37, v37
    v_rcp_f32 v38, v38
    v_rcp_f32 v39, v39
    v_rcp_f32 v40, v40
    v_rcp_f32 v41, v41
    v_pk_fma_f32 v[96:97], v[96:97], v[34:35], v[64:65]
    v_pk_fma_f32 v[98:99], v[98:99], v[36:37], v[66:67]
    v_pk_fma_f32 v[100:101], v[100:101], v[38:39], v[68:69]
    v_pk_fma_f32 v[102:103], v[102:103], v[40:41], v[70:71]
    v_cvt_pk_bf16_f32 v96, v96, v97
    v_cvt_pk_bf16_f32 v97, v98, v99
    v_cvt_pk_bf16_f32 v98, v100, v101
    v_cvt_pk_bf16_f32 v99, v102, v103
    s_nop 0
    v_permlane16_swap_b32 v96, v98
    v_permlane16_swap_b32 v97, v99
    global_store_dwordx4 v2, v[96:99], s[22:23] offset:0 sc1
    v_pk_mul_f32 v[34:35], v[136:137], s[14:15]
    v_pk_mul_f32 v[36:37], v[138:139], s[14:15]
    v_pk_mul_f32 v[38:39], v[140:141], s[14:15]
    v_pk_mul_f32 v[40:41], v[142:143], s[14:15]
    v_exp_f32 v34, v34
    v_exp_f32 v35, v35
    v_exp_f32 v36, v36
    v_exp_f32 v37, v37
    v_exp_f32 v38, v38
    v_exp_f32 v39, v39
    v_exp_f32 v40, v40
    v_exp_f32 v41, v41
    v_pk_mul_f32 v[104:105], v[104:105], v[136:137]
    v_pk_mul_f32 v[106:107], v[106:107], v[138:139]
    v_pk_mul_f32 v[108:109], v[108:109], v[140:141]
    v_pk_mul_f32 v[110:111], v[110:111], v[142:143]
    v_pk_add_f32 v[34:35], v[34:35], 1.0 op_sel_hi:[1,0]
    v_pk_add_f32 v[36:37], v[36:37], 1.0 op_sel_hi:[1,0]
    v_pk_add_f32 v[38:39], v[38:39], 1.0 op_sel_hi:[1,0]
    v_pk_add_f32 v[40:41], v[40:41], 1.0 op_sel_hi:[1,0]
    v_rcp_f32 v34, v34
    v_rcp_f32 v35, v35
    v_rcp_f32 v36, v36
    v_rcp_f32 v37, v37
    v_rcp_f32 v38, v38
    v_rcp_f32 v39, v39
    v_rcp_f32 v40, v40
    v_rcp_f32 v41, v41
    v_pk_fma_f32 v[104:105], v[104:105], v[34:35], v[72:73]
    v_pk_fma_f32 v[106:107], v[106:107], v[36:37], v[74:75]
    v_pk_fma_f32 v[108:109], v[108:109], v[38:39], v[76:77]
    v_pk_fma_f32 v[110:111], v[110:111], v[40:41], v[78:79]
    v_cvt_pk_bf16_f32 v104, v104, v105
    v_cvt_pk_bf16_f32 v105, v106, v107
    v_cvt_pk_bf16_f32 v106, v108, v109
    v_cvt_pk_bf16_f32 v107, v110, v111
    s_nop 0
    v_permlane16_swap_b32 v104, v106
    v_permlane16_swap_b32 v105, v107
    global_store_dwordx4 v2, v[104:107], s[22:23] offset:64 sc1
    v_pk_mul_f32 v[34:35], v[144:145], s[14:15]
    v_pk_mul_f32 v[36:37], v[146:147], s[14:15]
    v_pk_mul_f32 v[38:39], v[148:149], s[14:15]
    v_pk_mul_f32 v[40:41], v[150:151], s[14:15]
    v_exp_f32 v34, v34
    v_exp_f32 v35, v35
    v_exp_f32 v36, v36
    v_exp_f32 v37, v37
    v_exp_f32 v38, v38
    v_exp_f32 v39, v39
    v_exp_f32 v40, v40
    v_exp_f32 v41, v41
    v_pk_mul_f32 v[112:113], v[112:113], v[144:145]
    v_pk_mul_f32 v[114:115], v[114:115], v[146:147]
    v_pk_mul_f32 v[116:117], v[116:117], v[148:149]
    v_pk_mul_f32 v[118:119], v[118:119], v[150:151]
    v_pk_add_f32 v[34:35], v[34:35], 1.0 op_sel_hi:[1,0]
    v_pk_add_f32 v[36:37], v[36:37], 1.0 op_sel_hi:[1,0]
    v_pk_add_f32 v[38:39], v[38:39], 1.0 op_sel_hi:[1,0]
    v_pk_add_f32 v[40:41], v[40:41], 1.0 op_sel_hi:[1,0]
    v_rcp_f32 v34, v34
    v_rcp_f32 v35, v35
    v_rcp_f32 v36, v36
    v_rcp_f32 v37, v37
    v_rcp_f32 v38, v38
    v_rcp_f32 v39, v39
    v_rcp_f32 v40, v40
    v_rcp_f32 v41, v41
    v_pk_fma_f32 v[112:113], v[112:113], v[34:35], v[80:81]
    v_pk_fma_f32 v[114:115], v[114:115], v[36:37], v[82:83]
    v_pk_fma_f32 v[116:117], v[116:117], v[38:39], v[84:85]
    v_pk_fma_f32 v[118:119], v[118:119], v[40:41], v[86:87]
    v_cvt_pk_bf16_f32 v112, v112, v113
    v_cvt_pk_bf16_f32 v113, v114, v115
    v_cvt_pk_bf16_f32 v114, v116, v117
    v_cvt_pk_bf16_f32 v115, v118, v119
    s_nop 0
    v_permlane16_swap_b32 v112, v114
    v_permlane16_swap_b32 v113, v115
    global_store_dwordx4 v2, v[112:115], s[22:23] offset:128 sc1
    v_pk_mul_f32 v[34:35], v[152:153], s[14:15]
    v_pk_mul_f32 v[36:37], v[154:155], s[14:15]
    v_pk_mul_f32 v[38:39], v[156:157], s[14:15]
    v_pk_mul_f32 v[40:41], v[158:159], s[14:15]
    v_exp_f32 v34, v34
    v_exp_f32 v35, v35
    v_exp_f32 v36, v36
    v_exp_f32 v37, v37
    v_exp_f32 v38, v38
    v_exp_f32 v39, v39
    v_exp_f32 v40, v40
    v_exp_f32 v41, v41
    v_pk_mul_f32 v[120:121], v[120:121], v[152:153]
    v_pk_mul_f32 v[122:123], v[122:123], v[154:155]
    v_pk_mul_f32 v[124:125], v[124:125], v[156:157]
    v_pk_mul_f32 v[126:127], v[126:127], v[158:159]
    v_pk_add_f32 v[34:35], v[34:35], 1.0 op_sel_hi:[1,0]
    v_pk_add_f32 v[36:37], v[36:37], 1.0 op_sel_hi:[1,0]
    v_pk_add_f32 v[38:39], v[38:39], 1.0 op_sel_hi:[1,0]
    v_pk_add_f32 v[40:41], v[40:41], 1.0 op_sel_hi:[1,0]
    v_rcp_f32 v34, v34
    v_rcp_f32 v35, v35
    v_rcp_f32 v36, v36
    v_rcp_f32 v37, v37
    v_rcp_f32 v38, v38
    v_rcp_f32 v39, v39
    v_rcp_f32 v40, v40
    v_rcp_f32 v41, v41
    v_pk_fma_f32 v[120:121], v[120:121], v[34:35], v[88:89]
    v_pk_fma_f32 v[122:123], v[122:123], v[36:37], v[90:91]
    v_pk_fma_f32 v[124:125], v[124:125], v[38:39], v[92:93]
    v_pk_fma_f32 v[126:127], v[126:127], v[40:41], v[94:95]
    v_cvt_pk_bf16_f32 v120, v120, v121
    v_cvt_pk_bf16_f32 v121, v122, v123
    v_cvt_pk_bf16_f32 v122, v124, v125
    v_cvt_pk_bf16_f32 v123, v126, v127
    s_nop 0
    v_permlane16_swap_b32 v120, v122
    v_permlane16_swap_b32 v121, v123
    global_store_dwordx4 v2, v[120:123], s[22:23] offset:192 sc1
L_end:
    s_endpgm
L_spA0:
    buffer_load_dword v43, off, s[56:59], s92 sc1
    s_waitcnt vmcnt(0)
    v_readfirstlane_b32 s86, v43
    s_bfe_u32 s86, s86, 0x80000
    s_cmp_eq_u32 s86, 32
    s_cbranch_scc1 L_okA0
    s_add_u32 s67, s67, 1
    s_cmp_lt_u32 s67, 0x40000
    s_cbranch_scc1 L_spA0
    s_branch L_okA0
L_spA1:
    buffer_load_dword v43, off, s[56:59], s92 sc1
    s_waitcnt vmcnt(0)
    v_readfirstlane_b32 s86, v43
    s_bfe_u32 s86, s86, 0x80000
    s_cmp_eq_u32 s86, 32
    s_cbranch_scc1 L_okA1
    s_add_u32 s67, s67, 1
    s_cmp_lt_u32 s67, 0x40000
    s_cbranch_scc1 L_spA1
    s_branch L_okA1
L_spB:
    buffer_load_dword v43, off, s[56:59], s92 sc1
    s_waitcnt vmcnt(0)
    v_readfirstlane_b32 s86, v43
    s_bfe_u32 s86, s86, 0x80008
    s_cmp_eq_u32 s86, 16
    s_cbranch_scc1 L_okB
    s_add_u32 s67, s67, 1
    s_cmp_lt_u32 s67, 0x40000
    s_cbranch_scc1 L_spB
    s_branch L_okB
L_spC:
    buffer_load_dword v43, off, s[56:59], s92 sc1
    s_waitcnt vmcnt(0)
    v_readfirstlane_b32 s86, v43
    s_bfe_u32 s86, s86, 0x80010
    s_cmp_eq_u32 s86, 16
    s_cbranch_scc1 L_okC
    s_add_u32 s67, s67, 1
    s_cmp_lt_u32 s67, 0x40000
    s_cbranch_scc1 L_spC
    s_branch L_okC
L_spO:
    buffer_load_dword v43, off, s[56:59], s76 sc1
    s_waitcnt vmcnt(0)
    v_readfirstlane_b32 s86, v43
    s_cmp_eq_u32 s86, 64
    s_cbranch_scc1 L_okO
    s_add_u32 s67, s67, 1
    s_cmp_lt_u32 s67, 0x40000
    s_cbranch_scc1 L_spO
    s_branch L_okO
L_spP:
    buffer_load_dword v43, off, s[56:59], s77 sc1
    s_waitcnt vmcnt(0)
    v_readfirstlane_b32 s86, v43
    s_cmp_eq_u32 s86, 4
    s_cbranch_scc1 L_okP
    s_add_u32 s67, s67, 1
    s_cmp_lt_u32 s67, 0x40000
    s_cbranch_scc1 L_spP
    s_branch L_okP
L_code_end:
.section .rodata,"a"
.p2align 6
.amdhsa_kernel recurrent_scan__sliding_local_dilated__glu_gated_geglu__prompt_kernel
  .amdhsa_next_free_vgpr 512
  .amdhsa_next_free_sgpr 102
  .amdhsa_accum_offset 256
  .amdhsa_group_segment_fixed_size 0
  .amdhsa_kernarg_size 80
  .amdhsa_user_sgpr_count 2
  .amdhsa_user_sgpr_kernarg_segment_ptr 1
  .amdhsa_system_sgpr_workgroup_id_x 1
.end_amdhsa_kernel
```

```asm
; @launch grid=(256,1,1) block=(256,1,1) lds=163840
.amdgcn_target "amdgcn-amd-amdhsa--gfx950"
.text
.p2align 8
.globl recurrent_scan__sliding_local_dilated__glu_gated_geglu__prompt_kernel
.type recurrent_scan__sliding_local_dilated__glu_gated_geglu__prompt_kernel,@function
recurrent_scan__sliding_local_dilated__glu_gated_geglu__prompt_kernel:
    s_cmp_ge_u32 s2, 256
    s_cbranch_scc1 L_end
    s_load_dwordx16 s[8:23], s[0:1], 0
    s_load_dwordx4 s[24:27], s[0:1], 64
    v_lshrrev_b32 v1, 6, v0
    v_and_b32 v0, 63, v0
    v_readfirstlane_b32 s60, v1
    s_getpc_b64 s[86:87]
L_pc:
    s_lshr_b32 s82, s2, 3
    s_lshl_b32 s82, s82, 2
    s_add_u32 s82, s82, s60
    s_lshl_b32 s82, s82, 10
    v_lshl_add_u32 v2, v0, 4, s82
    v_min_u32 v2, L_code_end-L_pc-4, v2
    global_load_dword v7, v2, s[86:87]
    s_and_b32 s82, s2, 7
    s_lshr_b32 s83, s2, 3
    s_lshr_b32 s65, s82, 1
    s_and_b32 s63, s82, 1
    s_lshl_b32 s63, s63, 2
    s_and_b32 s84, s83, 3
    s_add_u32 s63, s63, s84
    s_lshr_b32 s66, s83, 2
    s_lshl_b32 s64, s65, 3
    s_add_u32 s64, s64, s66
    s_lshr_b32 s61, s60, 1
    s_and_b32 s62, s60, 1
    v_lshlrev_b32 v16, 4, v0
    s_lshl_b32 s84, s64, 2
    s_add_u32 s84, s84, s60
    s_lshl_b32 s85, s63, 7
    s_add_u32 s84, s84, s85
    s_lshl_b32 s85, s84, 12
    v_add_u32 v36, s85, v16
    s_lshl_b32 s84, s84, 2
    s_add_u32 s84, s84, 39845888
    v_mov_b32 v37, s84
    s_waitcnt lgkmcnt(0)
    global_load_dwordx4 v[48:51], v36, s[8:9] offset:0 nt
    global_load_dwordx4 v[52:55], v36, s[8:9] offset:1024 nt
    global_load_dwordx4 v[56:59], v36, s[8:9] offset:2048 nt
    global_load_dwordx4 v[60:63], v36, s[8:9] offset:3072 nt
    s_lshl_b32 s84, s63, 9
    s_lshl_b32 s85, s61, 8
    s_add_u32 s85, s85, s84
    s_sub_u32 s84, s84, 32
    s_max_i32 s84, s84, 0
    s_cmp_eq_u32 s62, 0
    s_cselect_b32 s85, s85, s84
    s_cselect_b32 s84, 63, 7
    s_add_u32 s85, s85, 39845888
    v_and_b32 v38, s84, v0
    v_lshlrev_b32 v38, 2, v38
    v_add_u32 v38, s85, v38
    global_load_dword v39, v38, s[26:27] sc1
    global_load_dword v40, v37, s[26:27] sc1
    v_lshlrev_b32 v2, 6, v0
    v_sub_u32 v2, v2, v16
    v_add_u32 v2, v2, v36
    s_sub_u32 s84, s63, s62
    s_max_i32 s84, s84, 0
    s_lshl_b32 s84, s84, 5
    v_mov_b32 v41, s84
    s_mov_b32 s56, s26
    s_and_b32 s57, s27, 0xffff
    s_mov_b32 s58, 0x10000000
    s_mov_b32 s59, 0x20000
    s_lshl_b32 s84, s63, 2
    s_add_u32 s84, s84, s65
    s_lshl_b32 s92, s84, 8
    s_add_u32 s92, s92, 39849984
    s_mul_i32 s88, s84, 458752
    s_add_u32 s88, s88, 8388608
    s_lshl_b32 s93, s63, 8
    s_add_u32 s93, s93, 39858176
    s_cmp_lg_u32 s60, 3
    s_cbranch_scc1 L_nozero
    s_lshl_b32 s84, s63, 3
    s_add_u32 s84, s84, s66
    s_lshl_b32 s84, s84, 2
    s_add_u32 s84, s84, s65
    s_lshl_b32 s84, s84, 8
    s_add_u32 s84, s84, 39862272
    v_mov_b32 v2, s84
    v_writelane_b32 v2, s92, 1
    v_writelane_b32 v2, s93, 2
    s_cmp_eq_u32 s66, 0
    s_cselect_b32 s84, 3, 1
    s_cmp_eq_u32 s64, 0
    s_cselect_b32 s84, 7, s84
    v_mov_b32 v3, 0
    s_mov_b32 exec_hi, 0
    s_mov_b32 exec_lo, s84
    global_store_dword v2, v3, s[26:27] sc1
    s_mov_b64 exec, -1
L_nozero:
    v_lshrrev_b32 v20, 2, v0
    v_and_b32 v21, 3, v0
    v_lshrrev_b32 v22, 4, v0
    v_and_b32 v23, 15, v0
    v_lshrrev_b32 v24, 3, v20
    v_lshlrev_b32 v24, 1, v24
    v_xor_b32 v24, v21, v24
    v_mul_u32_u24 v2, 6144, v20
    v_lshl_add_u32 v2, v24, 4, v2
    v_mul_u32_u24 v25, 7168, v20
    v_lshl_add_u32 v3, v24, 4, v25
    s_mul_i32 s84, s61, 98304
    s_lshl_b32 s85, s64, 6
    s_add_u32 s84, s84, s85
    s_add_u32 s32, s10, s84
    s_addc_u32 s33, s11, 0
    s_sub_u32 s32, s32, 4096
    s_subb_u32 s33, s33, 0
    s_and_b32 s33, s33, 0xffff
    s_sub_u32 s34, 6295552, s84
    s_mov_b32 s35, 0x20000
    s_mul_i32 s84, s61, 114688
    s_mul_i32 s85, s64, 224
    s_add_u32 s84, s84, s85
    s_add_u32 s36, s16, s84
    s_addc_u32 s37, s17, 0
    s_sub_u32 s36, s36, 4096
    s_subb_u32 s37, s37, 0
    s_and_b32 s37, s37, 0xffff
    s_sub_u32 s38, 7344128, s84
    s_mov_b32 s39, 0x20000
    s_add_u32 s40, s18, s84
    s_addc_u32 s41, s19, 0
    s_sub_u32 s40, s40, 4096
    s_subb_u32 s41, s41, 0
    s_and_b32 s41, s41, 0xffff
    s_sub_u32 s42, 7344128, s84
    s_mov_b32 s43, 0x20000
    v_cmp_lt_u32 vcc, 1, v24
    v_and_b32 v24, 1, v24
    v_lshl_add_u32 v24, v24, 4, v25
    v_add_u32 v24, 3264, v24
    v_mov_b32 v25, 0
    s_add_u32 s82, s16, s84
    s_addc_u32 s83, s17, 0
    s_sub_u32 s82, s82, 4096
    s_subb_u32 s83, s83, 0
    v_lshl_add_u64 v[4:5], v[24:25], 0, s[82:83]
    s_add_u32 s82, s18, s84
    s_addc_u32 s83, s19, 0
    s_sub_u32 s82, s82, 4096
    s_subb_u32 s83, s83, 0
    v_lshl_add_u64 v[24:25], v[24:25], 0, s[82:83]
    v_cndmask_b32 v4, v4, v24, vcc
    v_cndmask_b32 v5, v5, v25, vcc
    s_mov_b32 s80, 229376
    s_mov_b32 s81, 0
    s_cmp_eq_u32 s62, 1
    s_cbranch_scc1 L_init1
    s_lshl_b32 s78, s61, 14
    s_mov_b32 s68, 4096
    s_mov_b32 s69, 19456
    s_mov_b32 s70, 34816
    s_mov_b32 s71, 50176
    s_mov_b32 s72, 69632
    s_mov_b32 s73, 84992
    s_mov_b32 s74, 100352
    s_mov_b32 s75, 115712
    s_lshl_b32 s84, s63, 1
    s_add_u32 s84, s84, s61
    s_lshl_b32 s84, s84, 18
    s_branch L_init2
L_init1:
    s_mul_i32 s78, s61, 10240
    s_add_u32 s78, s78, 69632
    s_mov_b32 s68, 6144
    s_mov_b32 s69, 7168
    s_mov_b32 s70, 2048
    s_mov_b32 s71, 1024
    s_mov_b32 s72, 4096
    s_mov_b32 s73, 3136
    s_mov_b32 s74, 2112
    s_mov_b32 s75, 1152
    s_mov_b32 s76, 4224
    s_mov_b32 s14, 151552
    s_cmp_eq_u32 s61, 0
    s_cselect_b32 s15, 67584, s14
    s_cselect_b32 s14, 32768, s14
    s_lshl_b32 s84, s63, 19
    s_sub_u32 s84, s84, 32768
    s_max_i32 s84, s84, 0
L_init2:
    s_add_u32 s28, s26, s84
    s_addc_u32 s29, s27, 0
    s_sub_u32 s28, s28, 4096
    s_subb_u32 s29, s29, 0
    s_and_b32 s29, s29, 0xffff
    s_sub_u32 s30, 4198400, s84
    s_mov_b32 s31, 0x20000
    v_lshrrev_b32 v24, 3, v0
    v_and_b32 v25, 6, v24
    v_and_b32 v1, 7, v0
    v_xor_b32 v25, v25, v1
    v_lshlrev_b32 v25, 4, v25
    v_lshl_add_u32 v1, v24, 11, v25
    s_cmp_eq_u32 s63, 0
    s_cselect_b32 s84, 1, 3
    s_and_b32 s85, s60, s84
    s_cmp_eq_u32 s85, s84
    s_cselect_b32 s85, 0x40000000, 0
    s_cselect_b32 s87, 1, 0
    v_add_u32 v1, s85, v1
    s_lshr_b32 s83, s2, 3
    v_lshrrev_b32 v24, 3, v0
    v_and_b32 v25, 7, v0
    s_lshr_b32 s84, s63, 2
    s_lshl_b32 s84, s84, 4
    s_lshr_b32 s85, s83, 1
    s_add_u32 s84, s84, s85
    s_and_b32 s83, s83, 1
    s_cmp_eq_u32 s60, 0
    s_cbranch_scc1 L_pf0
    s_cmp_eq_u32 s60, 1
    s_cselect_b32 s44, s16, s18
    s_cselect_b32 s45, s17, s19
    s_cmp_eq_u32 s60, 3
    s_cselect_b32 s46, 0, 7340032
    s_mov_b32 s79, 229376
    s_mul_i32 s84, s84, 7168
    s_lshl_b32 s85, s65, 1
    s_add_u32 s85, s85, s83
    s_mul_i32 s85, s85, 896
    s_add_u32 s84, s84, s85
    v_cmp_gt_u32 vcc, 7, v25
    v_lshlrev_b32 v25, 7, v25
    s_branch L_pfd
L_pf0:
    s_mov_b32 s44, s10
    s_mov_b32 s45, s11
    s_mov_b32 s46, 6291456
    s_mov_b32 s79, 196608
    s_mul_i32 s84, s84, 6144
    s_lshl_b32 s85, s65, 1
    s_add_u32 s85, s85, s83
    s_lshl_b32 s85, s85, 8
    s_add_u32 s84, s84, s85
    v_cmp_gt_u32 vcc, 6, v25
    v_and_b32 v6, 1, v25
    v_lshrrev_b32 v25, 1, v25
    v_lshlrev_b32 v25, 11, v25
    v_lshl_add_u32 v25, v6, 7, v25
L_pfd:
    v_add_u32 v25, s84, v25
    v_mov_b32 v6, 0x40000000
    v_cndmask_b32 v25, v6, v25, vcc
    v_mul_lo_u32 v42, v24, s79
    v_add_u32 v42, v42, v25
    s_lshr_b32 s84, s79, 1
    s_sub_u32 s85, 0, s84
    s_cmp_lt_u32 s63, 4
    s_cselect_b32 s84, s84, s85
    s_mul_i32 s85, s79, 6
    s_sub_u32 s84, s84, s85
    v_add_u32 v25, s84, v42
    v_cmp_gt_u32 vcc, 4, v24
    s_nop 1
    v_cndmask_b32 v6, v6, v25, vcc
    v_cmp_gt_u32 vcc, 2, v24
    s_nop 1
    v_cndmask_b32 v6, v6, v42, vcc
    s_mul_i32 s84, s79, 8
    v_add_u32 v6, s84, v6
    s_lshl_b32 s86, s79, 3
    s_mul_i32 s79, s79, 2
    s_lshr_b32 s84, s2, 3
    s_and_b32 s84, s84, 0
    s_cmp_eq_u32 s84, 0
    s_cselect_b32 s4, 0, 0x40000000
    s_lshl_b32 s84, s63, 4
    s_add_u32 s84, s84, s65
    s_lshl_b32 s84, s84, 15
    s_lshl_b32 s85, s66, 8
    s_add_u32 s84, s84, s85
    s_add_u32 s48, s8, s84
    s_addc_u32 s49, s9, 0
    s_mov_b32 s50, 424192
    s_mov_b32 s52, 131072
    v_lshrrev_b32 v33, 1, v0
    v_and_b32 v24, 1, v0
    v_lshlrev_b32 v24, 7, v24
    v_lshl_add_u32 v33, v33, 11, v24
    v_subrev_u32 v33, 524288, v33
    v_mov_b32 v24, 0x40000000
    v_cmp_gt_u32 vcc, 32, v0
    s_nop 1
    v_cndmask_b32 v33, v24, v33, vcc
    s_cmp_lg_u32 s60, 3
    s_cbranch_scc1 L_pf3d
    s_lshl_b32 s84, s2, 13
    s_add_u32 s48, s12, s84
    s_addc_u32 s49, s13, 0
    s_mov_b32 s50, 8192
    s_mov_b32 s52, 2048
    v_lshlrev_b32 v25, 7, v0
    v_subrev_u32 v33, 16384, v25
    v_cmp_gt_u32 vcc, 16, v0
    s_nop 1
    v_cndmask_b32 v33, v24, v33, vcc
    s_and_b32 s84, s2, 7
    s_lshl_b32 s84, s84, 5
    s_lshr_b32 s85, s2, 3
    s_add_u32 s84, s84, s85
    s_mul_i32 s84, s84, 28672
    s_add_u32 s44, s20, s84
    s_addc_u32 s45, s21, 0
    s_mov_b32 s46, 28672
    s_mov_b32 s79, 7168
    v_subrev_u32 v6, 71680, v25
    v_mov_b32 v42, 0x40000000
    v_cmp_gt_u32 vcc, 56, v0
    s_nop 1
    v_cndmask_b32 v6, v42, v6, vcc
L_pf3d:
    s_and_b32 s49, s49, 0xffff
    s_mov_b32 s51, 0x20000
    s_and_b32 s45, s45, 0xffff
    s_mov_b32 s47, 0x20000
    v_and_b32 v24, 6, v23
    v_xor_b32 v24, v24, v22
    v_lshlrev_b32 v24, 4, v24
    v_lshl_add_u32 v24, v23, 7, v24
    v_xor_b32 v25, 64, v24
    s_lshl_b32 s84, s61, 14
    v_add_u32 v8, s84, v24
    v_add_u32 v9, s84, v25
    s_mul_i32 s84, s61, -18432
    s_add_u32 s84, s84, 32768
    v_add_u32 v10, s84, v24
    v_add_u32 v11, s84, v25
    v_lshrrev_b32 v24, 5, v0
    v_mul_u32_u24 v24, 10240, v24
    v_and_b32 v26, 1, v22
    v_bfe_u32 v25, v0, 2, 2
    v_lshl_add_u32 v25, v26, 3, v25
    v_lshl_add_u32 v24, v25, 6, v24
    v_and_b32 v25, 1, v0
    v_lshl_add_u32 v24, v25, 3, v24
    v_bfe_u32 v27, v0, 1, 1
    v_lshlrev_b32 v26, 1, v26
    s_mul_i32 s84, s62, 5120
    s_add_u32 s84, s84, 69632
    v_add_u32 v24, s84, v24
    v_add_u32 v25, 0, v27
    v_xor_b32 v25, v25, v26
    v_lshl_add_u32 v12, v25, 4, v24
    v_add_u32 v13, 40960, v12
    v_add_u32 v25, 2, v27
    v_xor_b32 v25, v25, v26
    v_lshl_add_u32 v14, v25, 4, v24
    v_add_u32 v15, 40960, v14
    v_mov_b32 v28, 0
    v_mov_b32 v29, 0
    v_mov_b32 v30, 0
    v_mov_b32 v31, 0
    s_cmp_eq_u32 s62, 1
    s_cbranch_scc1 L_early1
    s_mov_b64 exec, 0xffffffff
    buffer_load_dword v7, v42, s[44:47], 0 offen
    s_mov_b64 exec, -1
    v_mfma_f32_32x32x16_bf16 a[128:143], v[28:31], v[28:31], 0
    v_mfma_f32_32x32x16_bf16 a[144:159], v[28:31], v[28:31], 0
    v_mfma_f32_32x32x16_bf16 a[160:175], v[28:31], v[28:31], 0
    v_mfma_f32_32x32x16_bf16 a[176:191], v[28:31], v[28:31], 0
    v_mfma_f32_32x32x16_bf16 a[192:207], v[28:31], v[28:31], 0
    v_mfma_f32_32x32x16_bf16 a[208:223], v[28:31], v[28:31], 0
    v_mfma_f32_32x32x16_bf16 a[224:239], v[28:31], v[28:31], 0
    v_mfma_f32_32x32x16_bf16 a[240:255], v[28:31], v[28:31], 0
    v_mfma_f32_32x32x16_bf16 v[128:143], v[28:31], v[28:31], 0
    v_mfma_f32_32x32x16_bf16 v[144:159], v[28:31], v[28:31], 0
    v_mfma_f32_32x32x16_bf16 v[160:175], v[28:31], v[28:31], 0
    v_mfma_f32_32x32x16_bf16 v[176:191], v[28:31], v[28:31], 0
    v_mfma_f32_32x32x16_bf16 v[192:207], v[28:31], v[28:31], 0
    v_mfma_f32_32x32x16_bf16 v[208:223], v[28:31], v[28:31], 0
    v_mfma_f32_32x32x16_bf16 v[224:239], v[28:31], v[28:31], 0
    v_mfma_f32_32x32x16_bf16 v[240:255], v[28:31], v[28:31], 0
    s_waitcnt vmcnt(3)
    s_branch L_ln
L_early1:
    s_mov_b64 exec, 0xffffffff
    buffer_load_dword v7, v42, s[44:47], 0 offen
    s_mov_b64 exec, -1
    v_mfma_f32_32x32x16_bf16 a[128:143], v[28:31], v[28:31], 0
    v_mfma_f32_32x32x16_bf16 a[144:159], v[28:31], v[28:31], 0
    v_mfma_f32_32x32x16_bf16 a[160:175], v[28:31], v[28:31], 0
    v_mfma_f32_32x32x16_bf16 a[176:191], v[28:31], v[28:31], 0
    v_mfma_f32_32x32x16_bf16 a[192:207], v[28:31], v[28:31], 0
    v_mfma_f32_32x32x16_bf16 a[208:223], v[28:31], v[28:31], 0
    v_mfma_f32_32x32x16_bf16 a[224:239], v[28:31], v[28:31], 0
    v_mfma_f32_32x32x16_bf16 a[240:255], v[28:31], v[28:31], 0
    v_mfma_f32_32x32x16_bf16 v[128:143], v[28:31], v[28:31], 0
    v_mfma_f32_32x32x16_bf16 v[144:159], v[28:31], v[28:31], 0
    v_mfma_f32_32x32x16_bf16 v[160:175], v[28:31], v[28:31], 0
    v_mfma_f32_32x32x16_bf16 v[176:191], v[28:31], v[28:31], 0
    v_mfma_f32_32x32x16_bf16 v[192:207], v[28:31], v[28:31], 0
    v_mfma_f32_32x32x16_bf16 v[208:223], v[28:31], v[28:31], 0
    v_mfma_f32_32x32x16_bf16 v[224:239], v[28:31], v[28:31], 0
    v_mfma_f32_32x32x16_bf16 v[240:255], v[28:31], v[28:31], 0
    s_waitcnt vmcnt(3)
L_ln:
    v_lshlrev_b32 v64, 16, v48
    v_and_b32 v65, 0xffff0000, v48
    v_lshlrev_b32 v66, 16, v49
    v_and_b32 v67, 0xffff0000, v49
    v_lshlrev_b32 v68, 16, v50
    v_and_b32 v69, 0xffff0000, v50
    v_lshlrev_b32 v70, 16, v51
    v_and_b32 v71, 0xffff0000, v51
    v_lshlrev_b32 v72, 16, v52
    v_and_b32 v73, 0xffff0000, v52
    v_lshlrev_b32 v74, 16, v53
    v_and_b32 v75, 0xffff0000, v53
    v_lshlrev_b32 v76, 16, v54
    v_and_b32 v77, 0xffff0000, v54
    v_lshlrev_b32 v78, 16, v55
    v_and_b32 v79, 0xffff0000, v55
    v_lshlrev_b32 v80, 16, v56
    v_and_b32 v81, 0xffff0000, v56
    v_lshlrev_b32 v82, 16, v57
    v_and_b32 v83, 0xffff0000, v57
    v_lshlrev_b32 v84, 16, v58
    v_and_b32 v85, 0xffff0000, v58
    v_lshlrev_b32 v86, 16, v59
    v_and_b32 v87, 0xffff0000, v59
    v_lshlrev_b32 v88, 16, v60
    v_and_b32 v89, 0xffff0000, v60
    v_lshlrev_b32 v90, 16, v61
    v_and_b32 v91, 0xffff0000, v61
    v_lshlrev_b32 v92, 16, v62
    v_and_b32 v93, 0xffff0000, v62
    v_lshlrev_b32 v94, 16, v63
    v_and_b32 v95, 0xffff0000, v63
    v_pk_add_f32 v[96:97], v[64:65], v[66:67]
    v_pk_add_f32 v[98:99], v[80:81], v[82:83]
    v_pk_add_f32 v[96:97], v[96:97], v[68:69]
    v_pk_add_f32 v[98:99], v[98:99], v[84:85]
    v_pk_add_f32 v[96:97], v[96:97], v[70:71]
    v_pk_add_f32 v[98:99], v[98:99], v[86:87]
    v_pk_add_f32 v[96:97], v[96:97], v[72:73]
    v_pk_add_f32 v[98:99], v[98:99], v[88:89]
    v_pk_add_f32 v[96:97], v[96:97], v[74:75]
    v_pk_add_f32 v[98:99], v[98:99], v[90:91]
    v_pk_add_f32 v[96:97], v[96:97], v[76:77]
    v_pk_add_f32 v[98:99], v[98:99], v[92:93]
    v_pk_add_f32 v[96:97], v[96:97], v[78:79]
    v_pk_add_f32 v[98:99], v[98:99], v[94:95]
    v_add_f32 v102, v96, v97
    v_add_f32 v103, v98, v99
    s_nop 1
    v_permlane32_swap_b32 v102, v103
    v_add_f32 v102, v102, v103
    v_mov_b32 v100, v102
    s_nop 1
    v_permlane16_swap_b32 v102, v100
    v_add_f32 v102, v102, v100
    s_nop 1
    v_add_f32_dpp v102, v102, v102 quad_perm:[1,0,3,2] row_mask:0xf bank_mask:0xf
    s_nop 1
    v_add_f32_dpp v102, v102, v102 quad_perm:[2,3,0,1] row_mask:0xf bank_mask:0xf
    s_nop 1
    v_add_f32_dpp v102, v102, v102 row_half_mirror row_mask:0xf bank_mask:0xf
    s_nop 1
    v_add_f32_dpp v102, v102, v102 row_mirror row_mask:0xf bank_mask:0xf
    v_mul_f32 v102, 0xba800000, v102
    v_cvt_pk_bf16_f32 v106, v102, v102
    v_lshlrev_b32 v106, 16, v106
    v_mov_b32 v103, v102
    s_nop 1
    v_permlane32_swap_b32 v102, v103
    v_mov_b32 v107, v106
    s_nop 1
    v_permlane32_swap_b32 v106, v107
    v_pk_add_f32 v[108:109], v[64:65], v[102:103] op_sel_hi:[1,0]
    v_pk_add_f32 v[110:111], v[80:81], v[102:103] op_sel:[0,1] op_sel_hi:[1,1]
    v_pk_mul_f32 v[96:97], v[108:109], v[108:109]
    v_pk_mul_f32 v[98:99], v[110:111], v[110:111]
    v_pk_add_f32 v[108:109], v[66:67], v[102:103] op_sel_hi:[1,0]
    v_pk_add_f32 v[110:111], v[82:83], v[102:103] op_sel:[0,1] op_sel_hi:[1,1]
    v_pk_fma_f32 v[96:97], v[108:109], v[108:109], v[96:97]
    v_pk_fma_f32 v[98:99], v[110:111], v[110:111], v[98:99]
    v_pk_add_f32 v[108:109], v[68:69], v[102:103] op_sel_hi:[1,0]
    v_pk_add_f32 v[110:111], v[84:85], v[102:103] op_sel:[0,1] op_sel_hi:[1,1]
    v_pk_fma_f32 v[96:97], v[108:109], v[108:109], v[96:97]
    v_pk_fma_f32 v[98:99], v[110:111], v[110:111], v[98:99]
    v_pk_add_f32 v[108:109], v[70:71], v[102:103] op_sel_hi:[1,0]
    v_pk_add_f32 v[110:111], v[86:87], v[102:103] op_sel:[0,1] op_sel_hi:[1,1]
    v_pk_fma_f32 v[96:97], v[108:109], v[108:109], v[96:97]
    v_pk_fma_f32 v[98:99], v[110:111], v[110:111], v[98:99]
    v_pk_add_f32 v[108:109], v[72:73], v[102:103] op_sel_hi:[1,0]
    v_pk_add_f32 v[110:111], v[88:89], v[102:103] op_sel:[0,1] op_sel_hi:[1,1]
    v_pk_fma_f32 v[96:97], v[108:109], v[108:109], v[96:97]
    v_pk_fma_f32 v[98:99], v[110:111], v[110:111], v[98:99]
    v_pk_add_f32 v[108:109], v[74:75], v[102:103] op_sel_hi:[1,0]
    v_pk_add_f32 v[110:111], v[90:91], v[102:103] op_sel:[0,1] op_sel_hi:[1,1]
    v_pk_fma_f32 v[96:97], v[108:109], v[108:109], v[96:97]
    v_pk_fma_f32 v[98:99], v[110:111], v[110:111], v[98:99]
    v_pk_add_f32 v[108:109], v[76:77], v[102:103] op_sel_hi:[1,0]
    v_pk_add_f32 v[110:111], v[92:93], v[102:103] op_sel:[0,1] op_sel_hi:[1,1]
    v_pk_fma_f32 v[96:97], v[108:109], v[108:109], v[96:97]
    v_pk_fma_f32 v[98:99], v[110:111], v[110:111], v[98:99]
    v_pk_add_f32 v[108:109], v[78:79], v[102:103] op_sel_hi:[1,0]
    v_pk_add_f32 v[110:111], v[94:95], v[102:103] op_sel:[0,1] op_sel_hi:[1,1]
    v_pk_fma_f32 v[96:97], v[108:109], v[108:109], v[96:97]
    v_pk_fma_f32 v[98:99], v[110:111], v[110:111], v[98:99]
    v_add_f32 v104, v96, v97
    v_add_f32 v105, v98, v99
    s_nop 1
    v_permlane32_swap_b32 v104, v105
    v_add_f32 v104, v104, v105
    v_mov_b32 v100, v104
    s_nop 1
    v_permlane16_swap_b32 v104, v100
    v_add_f32 v104, v104, v100
    s_nop 1
    v_add_f32_dpp v104, v104, v104 quad_perm:[1,0,3,2] row_mask:0xf bank_mask:0xf
    s_nop 1
    v_add_f32_dpp v104, v104, v104 quad_perm:[2,3,0,1] row_mask:0xf bank_mask:0xf
    s_nop 1
    v_add_f32_dpp v104, v104, v104 row_half_mirror row_mask:0xf bank_mask:0xf
    s_nop 1
    v_add_f32_dpp v104, v104, v104 row_mirror row_mask:0xf bank_mask:0xf
    v_mul_f32 v104, 0x3a800000, v104
    v_cvt_pk_bf16_f32 v104, v104, v104
    v_lshlrev_b32 v104, 16, v104
    v_add_f32 v104, 0x3727c5ac, v104
    v_cvt_pk_bf16_f32 v104, v104, v104
    v_lshlrev_b32 v104, 16, v104
    v_sqrt_f32 v104, v104
    s_nop 0
    v_cvt_pk_bf16_f32 v104, v104, v104
    v_lshlrev_b32 v104, 16, v104
    v_rcp_f32 v100, v104
    s_nop 0
    v_fma_f32 v104, -v104, v100, 1.0
    v_fma_f32 v104, v104, v100, v100
    v_mov_b32 v105, v104
    s_nop 1
    v_permlane32_swap_b32 v104, v105
    v_pk_add_f32 v[64:65], v[64:65], v[106:107] op_sel_hi:[1,0]
    v_pk_add_f32 v[66:67], v[66:67], v[106:107] op_sel_hi:[1,0]
    v_pk_add_f32 v[68:69], v[68:69], v[106:107] op_sel_hi:[1,0]
    v_pk_add_f32 v[70:71], v[70:71], v[106:107] op_sel_hi:[1,0]
    v_cvt_pk_bf16_f32 v65, v64, v65
    v_cvt_pk_bf16_f32 v67, v66, v67
    v_cvt_pk_bf16_f32 v69, v68, v69
    v_cvt_pk_bf16_f32 v71, v70, v71
    v_lshlrev_b32 v64, 16, v65
    v_and_b32 v65, 0xffff0000, v65
    v_lshlrev_b32 v66, 16, v67
    v_and_b32 v67, 0xffff0000, v67
    v_lshlrev_b32 v68, 16, v69
    v_and_b32 v69, 0xffff0000, v69
    v_lshlrev_b32 v70, 16, v71
    v_and_b32 v71, 0xffff0000, v71
    v_pk_mul_f32 v[64:65], v[64:65], v[104:105] op_sel_hi:[1,0]
    v_pk_mul_f32 v[66:67], v[66:67], v[104:105] op_sel_hi:[1,0]
    v_pk_mul_f32 v[68:69], v[68:69], v[104:105] op_sel_hi:[1,0]
    v_pk_mul_f32 v[70:71], v[70:71], v[104:105] op_sel_hi:[1,0]
    v_cvt_pk_bf16_f32 v48, v64, v65
    v_cvt_pk_bf16_f32 v49, v66, v67
    v_cvt_pk_bf16_f32 v50, v68, v69
    v_cvt_pk_bf16_f32 v51, v70, v71
    global_store_dwordx4 v36, v[48:51], s[26:27] offset:0 sc1
    v_pk_add_f32 v[72:73], v[72:73], v[106:107] op_sel_hi:[1,0]
    v_pk_add_f32 v[74:75], v[74:75], v[106:107] op_sel_hi:[1,0]
    v_pk_add_f32 v[76:77], v[76:77], v[106:107] op_sel_hi:[1,0]
    v_pk_add_f32 v[78:79], v[78:79], v[106:107] op_sel_hi:[1,0]
    v_cvt_pk_bf16_f32 v73, v72, v73
    v_cvt_pk_bf16_f32 v75, v74, v75
    v_cvt_pk_bf16_f32 v77, v76, v77
    v_cvt_pk_bf16_f32 v79, v78, v79
    v_lshlrev_b32 v72, 16, v73
    v_and_b32 v73, 0xffff0000, v73
    v_lshlrev_b32 v74, 16, v75
    v_and_b32 v75, 0xffff0000, v75
    v_lshlrev_b32 v76, 16, v77
    v_and_b32 v77, 0xffff0000, v77
    v_lshlrev_b32 v78, 16, v79
    v_and_b32 v79, 0xffff0000, v79
    v_pk_mul_f32 v[72:73], v[72:73], v[104:105] op_sel_hi:[1,0]
    v_pk_mul_f32 v[74:75], v[74:75], v[104:105] op_sel_hi:[1,0]
    v_pk_mul_f32 v[76:77], v[76:77], v[104:105] op_sel_hi:[1,0]
    v_pk_mul_f32 v[78:79], v[78:79], v[104:105] op_sel_hi:[1,0]
    v_cvt_pk_bf16_f32 v52, v72, v73
    v_cvt_pk_bf16_f32 v53, v74, v75
    v_cvt_pk_bf16_f32 v54, v76, v77
    v_cvt_pk_bf16_f32 v55, v78, v79
    global_store_dwordx4 v36, v[52:55], s[26:27] offset:1024 sc1
    v_pk_add_f32 v[80:81], v[80:81], v[106:107] op_sel:[0,1] op_sel_hi:[1,1]
    v_pk_add_f32 v[82:83], v[82:83], v[106:107] op_sel:[0,1] op_sel_hi:[1,1]
    v_pk_add_f32 v[84:85], v[84:85], v[106:107] op_sel:[0,1] op_sel_hi:[1,1]
    v_pk_add_f32 v[86:87], v[86:87], v[106:107] op_sel:[0,1] op_sel_hi:[1,1]
    v_cvt_pk_bf16_f32 v81, v80, v81
    v_cvt_pk_bf16_f32 v83, v82, v83
    v_cvt_pk_bf16_f32 v85, v84, v85
    v_cvt_pk_bf16_f32 v87, v86, v87
    v_lshlrev_b32 v80, 16, v81
    v_and_b32 v81, 0xffff0000, v81
    v_lshlrev_b32 v82, 16, v83
    v_and_b32 v83, 0xffff0000, v83
    v_lshlrev_b32 v84, 16, v85
    v_and_b32 v85, 0xffff0000, v85
    v_lshlrev_b32 v86, 16, v87
    v_and_b32 v87, 0xffff0000, v87
    v_pk_mul_f32 v[80:81], v[80:81], v[104:105] op_sel:[0,1] op_sel_hi:[1,1]
    v_pk_mul_f32 v[82:83], v[82:83], v[104:105] op_sel:[0,1] op_sel_hi:[1,1]
    v_pk_mul_f32 v[84:85], v[84:85], v[104:105] op_sel:[0,1] op_sel_hi:[1,1]
    v_pk_mul_f32 v[86:87], v[86:87], v[104:105] op_sel:[0,1] op_sel_hi:[1,1]
    v_cvt_pk_bf16_f32 v56, v80, v81
    v_cvt_pk_bf16_f32 v57, v82, v83
    v_cvt_pk_bf16_f32 v58, v84, v85
    v_cvt_pk_bf16_f32 v59, v86, v87
    global_store_dwordx4 v36, v[56:59], s[26:27] offset:2048 sc1
    v_pk_add_f32 v[88:89], v[88:89], v[106:107] op_sel:[0,1] op_sel_hi:[1,1]
    v_pk_add_f32 v[90:91], v[90:91], v[106:107] op_sel:[0,1] op_sel_hi:[1,1]
    v_pk_add_f32 v[92:93], v[92:93], v[106:107] op_sel:[0,1] op_sel_hi:[1,1]
    v_pk_add_f32 v[94:95], v[94:95], v[106:107] op_sel:[0,1] op_sel_hi:[1,1]
    v_cvt_pk_bf16_f32 v89, v88, v89
    v_cvt_pk_bf16_f32 v91, v90, v91
    v_cvt_pk_bf16_f32 v93, v92, v93
    v_cvt_pk_bf16_f32 v95, v94, v95
    v_lshlrev_b32 v88, 16, v89
    v_and_b32 v89, 0xffff0000, v89
    v_lshlrev_b32 v90, 16, v91
    v_and_b32 v91, 0xffff0000, v91
    v_lshlrev_b32 v92, 16, v93
    v_and_b32 v93, 0xffff0000, v93
    v_lshlrev_b32 v94, 16, v95
    v_and_b32 v95, 0xffff0000, v95
    v_pk_mul_f32 v[88:89], v[88:89], v[104:105] op_sel:[0,1] op_sel_hi:[1,1]
    v_pk_mul_f32 v[90:91], v[90:91], v[104:105] op_sel:[0,1] op_sel_hi:[1,1]
    v_pk_mul_f32 v[92:93], v[92:93], v[104:105] op_sel:[0,1] op_sel_hi:[1,1]
    v_pk_mul_f32 v[94:95], v[94:95], v[104:105] op_sel:[0,1] op_sel_hi:[1,1]
    v_cvt_pk_bf16_f32 v60, v88, v89
    v_cvt_pk_bf16_f32 v61, v90, v91
    v_cvt_pk_bf16_f32 v62, v92, v93
    v_cvt_pk_bf16_f32 v63, v94, v95
    global_store_dwordx4 v36, v[60:63], s[26:27] offset:3072 sc1
    s_waitcnt vmcnt(5)
    v_add_u32 v40, 1, v40
    s_waitcnt vmcnt(0)
    s_mov_b64 exec, 1
    global_store_dword v37, v40, s[26:27] sc1
    s_mov_b64 exec, -1
    buffer_load_dword v7, v42, s[44:47], 0 offen
    v_add_u32_e64 v42, s86, v42
    s_barrier
    v_mfma_f32_32x32x16_bf16 v[48:63], v[28:31], v[28:31], 0
    v_mfma_f32_32x32x16_bf16 v[64:79], v[28:31], v[28:31], 0
    v_mfma_f32_32x32x16_bf16 v[80:95], v[28:31], v[28:31], 0
    v_mfma_f32_32x32x16_bf16 v[96:111], v[28:31], v[28:31], 0
    v_mfma_f32_32x32x16_bf16 v[112:127], v[28:31], v[28:31], 0
    s_mov_b32 s67, 0
    s_cmp_lg_u32 s60, 3
    s_cbranch_scc1 L_noarr
    s_lshl_b32 s84, s63, 5
    v_mov_b32 v20, s84
    v_mov_b32 v21, 1
    s_mov_b64 exec, 1
    global_atomic_add v20, v21, s[24:25] sc1
    s_mov_b64 exec, -1
L_noarr:
    s_cmp_eq_u32 s62, 0
    s_cbranch_scc1 L_now
    s_add_u32 m0, s78, 0
    s_nop 0
    buffer_load_dwordx4 v2, s[32:35], s68 offen offset:0 lds
    buffer_load_dwordx4 v2, s[32:35], s69 offen offset:1024 lds
    buffer_load_dwordx4 v2, s[32:35], s70 offen offset:2048 lds
    v_add_u32 v2, 196608, v2
    buffer_load_dwordx4 v3, s[36:39], s71 offen offset:3072 lds
    s_add_u32 m0, s78, 4096
    s_nop 0
    buffer_load_dwordx4 v3, s[40:43], s72 offen offset:0 lds
    buffer_load_dwordx4 v3, s[36:39], s73 offen offset:1024 lds
    buffer_load_dwordx4 v3, s[40:43], s74 offen offset:2048 lds
    buffer_load_dwordx4 v3, s[36:39], s75 offen offset:3072 lds
    s_add_u32 m0, s78, 8192
    s_nop 0
    buffer_load_dwordx4 v3, s[40:43], s76 offen offset:0 lds
    v_add_u32 v3, 229376, v3
    global_load_lds_dwordx4 v[4:5], off offset:1024
    v_lshl_add_u64 v[4:5], v[4:5], 0, s[80:81]
    s_add_u32 m0, s78, 20480
    s_nop 0
    buffer_load_dwordx4 v2, s[32:35], s68 offen offset:0 lds
    buffer_load_dwordx4 v2, s[32:35], s69 offen offset:1024 lds
    buffer_load_dwordx4 v2, s[32:35], s70 offen offset:2048 lds
    v_add_u32 v2, 196608, v2
    buffer_load_dwordx4 v3, s[36:39], s71 offen offset:3072 lds
    s_add_u32 m0, s78, 24576
    s_nop 0
    buffer_load_dwordx4 v3, s[40:43], s72 offen offset:0 lds
    buffer_load_dwordx4 v3, s[36:39], s73 offen offset:1024 lds
    buffer_load_dwordx4 v3, s[40:43], s74 offen offset:2048 lds
    buffer_load_dwordx4 v3, s[36:39], s75 offen offset:3072 lds
    s_add_u32 m0, s78, 28672
    s_nop 0
    buffer_load_dwordx4 v3, s[40:43], s76 offen offset:0 lds
    v_add_u32 v3, 229376, v3
    global_load_lds_dwordx4 v[4:5], off offset:1024
    v_lshl_add_u64 v[4:5], v[4:5], 0, s[80:81]
L_now:
    s_cmp_eq_u32 s60, 3
    s_cbranch_scc1 L_stub0
    s_cmp_eq_u32 s60, 2
    s_cbranch_scc1 L_stub1
    s_cmp_eq_u32 s60, 1
    s_cbranch_scc1 L_stub2
    s_cmp_eq_u32 s60, 0
    s_cbranch_scc1 L_stub3
L_stubret:
    s_cmp_eq_u32 s87, 1
    s_cbranch_scc1 L_lnok
L_lnpoll:
    global_load_dword v20, v38, s[26:27] sc1
    s_waitcnt vmcnt(0)
    v_cmp_ne_u32 vcc, v20, v39
    s_cmp_eq_u64 vcc, -1
    s_cbranch_scc1 L_lnok
    s_add_u32 s67, s67, 1
    s_and_b32 s84, s67, 3
    s_cbranch_scc1 L_lnpoll
    global_load_dword v20, v41, s[24:25] sc1
    s_waitcnt vmcnt(0)
    v_readfirstlane_b32 s84, v20
    s_cmp_ge_u32 s84, 32
    s_cbranch_scc1 L_lnok
    s_cmp_lt_u32 s67, 0x40000
    s_cbranch_scc1 L_lnpoll
L_lnok:
    s_cmp_eq_u32 s62, 1
    s_cbranch_scc1 L_g1_1
    s_branch L_g1_0
.p2align 12
L_stub0:
    s_branch L_stub4
L_g1_0:
    v_add_u32 v2, 131072, v1
    s_add_u32 m0, s78, 0
    s_nop 0
    buffer_load_dwordx4 v1, s[28:31], s68 offen offset:0 sc1 lds
    buffer_load_dwordx4 v1, s[28:31], s69 offen offset:1024 sc1 lds
    buffer_load_dwordx4 v1, s[28:31], s70 offen offset:2048 sc1 lds
    buffer_load_dwordx4 v1, s[28:31], s71 offen offset:3072 sc1 lds
    s_add_u32 m0, s78, 4096
    s_nop 0
    buffer_load_dwordx4 v1, s[28:31], s72 offen offset:0 sc1 lds
    buffer_load_dwordx4 v1, s[28:31], s73 offen offset:1024 sc1 lds
    buffer_load_dwordx4 v1, s[28:31], s74 offen offset:2048 sc1 lds
    buffer_load_dwordx4 v1, s[28:31], s75 offen offset:3072 sc1 lds
    v_add_u32 v1, 128, v1
    s_add_u32 m0, s78, 8192
    s_nop 0
    buffer_load_dwordx4 v2, s[28:31], s68 offen offset:0 sc1 lds
    buffer_load_dwordx4 v2, s[28:31], s69 offen offset:1024 sc1 lds
    buffer_load_dwordx4 v2, s[28:31], s70 offen offset:2048 sc1 lds
    buffer_load_dwordx4 v2, s[28:31], s71 offen offset:3072 sc1 lds
    s_add_u32 m0, s78, 12288
    s_nop 0
    buffer_load_dwordx4 v2, s[28:31], s72 offen offset:0 sc1 lds
    buffer_load_dwordx4 v2, s[28:31], s73 offen offset:1024 sc1 lds
    buffer_load_dwordx4 v2, s[28:31], s74 offen offset:2048 sc1 lds
    buffer_load_dwordx4 v2, s[28:31], s75 offen offset:3072 sc1 lds
    v_add_u32 v2, 128, v2
    s_add_u32 m0, s78, 34816
    s_nop 0
    buffer_load_dwordx4 v1, s[28:31], s68 offen offset:0 sc1 lds
    buffer_load_dwordx4 v1, s[28:31], s69 offen offset:1024 sc1 lds
    buffer_load_dwordx4 v1, s[28:31], s70 offen offset:2048 sc1 lds
    buffer_load_dwordx4 v1, s[28:31], s71 offen offset:3072 sc1 lds
    s_add_u32 m0, s78, 38912
    s_nop 0
    buffer_load_dwordx4 v1, s[28:31], s72 offen offset:0 sc1 lds
    buffer_load_dwordx4 v1, s[28:31], s73 offen offset:1024 sc1 lds
    buffer_load_dwordx4 v1, s[28:31], s74 offen offset:2048 sc1 lds
    buffer_load_dwordx4 v1, s[28:31], s75 offen offset:3072 sc1 lds
    v_add_u32 v1, 128, v1
    s_add_u32 m0, s78, 43008
    s_nop 0
    buffer_load_dwordx4 v2, s[28:31], s68 offen offset:0 sc1 lds
    buffer_load_dwordx4 v2, s[28:31], s69 offen offset:1024 sc1 lds
    buffer_load_dwordx4 v2, s[28:31], s70 offen offset:2048 sc1 lds
    buffer_load_dwordx4 v2, s[28:31], s71 offen offset:3072 sc1 lds
    s_add_u32 m0, s78, 47104
    s_nop 0
    buffer_load_dwordx4 v2, s[28:31], s72 offen offset:0 sc1 lds
    buffer_load_dwordx4 v2, s[28:31], s73 offen offset:1024 sc1 lds
    buffer_load_dwordx4 v2, s[28:31], s74 offen offset:2048 sc1 lds
    buffer_load_dwordx4 v2, s[28:31], s75 offen offset:3072 sc1 lds
    v_add_u32 v2, 128, v2
    s_waitcnt vmcnt(16)
    s_barrier
    ds_read_b64_tr_b16 a[64:65], v12 offset:0
    ds_read_b64_tr_b16 a[66:67], v12 offset:256
    ds_read_b64_tr_b16 a[68:69], v14 offset:0
    ds_read_b64_tr_b16 a[70:71], v14 offset:256
    ds_read_b64_tr_b16 a[72:73], v12 offset:1024
    ds_read_b64_tr_b16 a[74:75], v12 offset:1280
    ds_read_b64_tr_b16 a[76:77], v14 offset:1024
    ds_read_b64_tr_b16 a[78:79], v14 offset:1280
    ds_read_b64_tr_b16 a[80:81], v12 offset:2048
    ds_read_b64_tr_b16 a[82:83], v12 offset:2304
    ds_read_b64_tr_b16 a[84:85], v14 offset:2048
    ds_read_b64_tr_b16 a[86:87], v14 offset:2304
    ds_read_b64_tr_b16 a[88:89], v12 offset:3072
    ds_read_b64_tr_b16 a[90:91], v12 offset:3328
    ds_read_b64_tr_b16 a[92:93], v14 offset:3072
    ds_read_b64_tr_b16 a[94:95], v14 offset:3328
    ds_read_b64_tr_b16 a[96:97], v12 offset:4096
    ds_read_b64_tr_b16 a[98:99], v12 offset:4352
    ds_read_b64_tr_b16 a[100:101], v14 offset:4096
    ds_read_b64_tr_b16 a[102:103], v14 offset:4352
    ds_read_b128 a[0:3], v8 offset:0
    ds_read_b128 a[4:7], v8 offset:2048
    ds_read_b128 a[8:11], v8 offset:4096
    ds_read_b128 a[12:15], v8 offset:6144
    ds_read_b128 a[16:19], v8 offset:8192
    ds_read_b128 a[20:23], v8 offset:10240
    ds_read_b128 a[24:27], v8 offset:12288
    ds_read_b128 a[28:31], v8 offset:14336
    ds_read_b128 a[112:115], v10 offset:0
    s_mov_b32 s67, 7
    v_mov_b32 v20, 0x7ff00000
.p2align 3
L_loop0:
    s_waitcnt lgkmcnt(0)
    s_barrier
    v_mfma_f32_16x16x32_bf16 a[128:131], a[64:67], a[0:3], a[128:131]
    buffer_load_dword v7, v6, s[44:47], s4 offen
    v_add_u32_e64 v6, s79, v6
    v_mfma_f32_16x16x32_bf16 a[136:139], a[64:67], a[4:7], a[136:139]
    v_mfma_f32_16x16x32_bf16 a[144:147], a[64:67], a[8:11], a[144:147]
    ds_read_b128 a[32:35], v9 offset:0
    v_mfma_f32_16x16x32_bf16 a[152:155], a[64:67], a[12:15], a[152:155]
    v_mfma_f32_16x16x32_bf16 a[160:163], a[64:67], a[16:19], a[160:163]
    v_mfma_f32_16x16x32_bf16 a[168:171], a[64:67], a[20:23], a[168:171]
    v_mfma_f32_16x16x32_bf16 a[176:179], a[64:67], a[24:27], a[176:179]
    ds_read_b128 a[36:39], v9 offset:2048
    v_mfma_f32_16x16x32_bf16 a[184:187], a[64:67], a[28:31], a[184:187]
    v_mfma_f32_16x16x32_bf16 v[120:123], a[64:67], a[112:115], v[120:123]
    ds_read_b64_tr_b16 a[64:65], v12 offset:20480
    v_mfma_f32_16x16x32_bf16 a[132:135], a[68:71], a[0:3], a[132:135]
    ds_read_b64_tr_b16 a[66:67], v12 offset:20736
    v_mfma_f32_16x16x32_bf16 a[140:143], a[68:71], a[4:7], a[140:143]
    ds_read_b128 a[40:43], v9 offset:4096
    v_mfma_f32_16x16x32_bf16 a[148:151], a[68:71], a[8:11], a[148:151]
    v_mfma_f32_16x16x32_bf16 a[156:159], a[68:71], a[12:15], a[156:159]
    v_mfma_f32_16x16x32_bf16 a[164:167], a[68:71], a[16:19], a[164:167]
    v_mfma_f32_16x16x32_bf16 a[172:175], a[68:71], a[20:23], a[172:175]
    ds_read_b128 a[44:47], v9 offset:6144
    v_mfma_f32_16x16x32_bf16 a[180:183], a[68:71], a[24:27], a[180:183]
    v_mfma_f32_16x16x32_bf16 a[188:191], a[68:71], a[28:31], a[188:191]
    v_mfma_f32_16x16x32_bf16 v[124:127], a[68:71], a[112:115], v[124:127]
    ds_read_b64_tr_b16 a[68:69], v14 offset:20480
    v_mfma_f32_16x16x32_bf16 v[52:55], a[0:3], a[72:75], v[52:55]
    ds_read_b64_tr_b16 a[70:71], v14 offset:20736
    v_mfma_f32_16x16x32_bf16 v[56:59], a[4:7], a[72:75], v[56:59]
    v_mfma_f32_16x16x32_bf16 v[60:63], a[8:11], a[72:75], v[60:63]
    ds_read_b128 a[48:51], v9 offset:8192
    v_mfma_f32_16x16x32_bf16 v[64:67], a[12:15], a[72:75], v[64:67]
    v_mfma_f32_16x16x32_bf16 v[68:71], a[16:19], a[72:75], v[68:71]
    ds_read_b128 a[52:55], v9 offset:10240
    v_mfma_f32_16x16x32_bf16 v[72:75], a[20:23], a[72:75], v[72:75]
    v_mfma_f32_16x16x32_bf16 v[76:79], a[24:27], a[72:75], v[76:79]
    v_mfma_f32_16x16x32_bf16 v[80:83], a[28:31], a[72:75], v[80:83]
    v_mfma_f32_16x16x32_bf16 v[48:51], a[112:115], a[72:75], v[48:51]
    ds_read_b64_tr_b16 a[72:73], v12 offset:21504
    v_mfma_f32_16x16x32_bf16 v[88:91], a[0:3], a[76:79], v[88:91]
    ds_read_b64_tr_b16 a[74:75], v12 offset:21760
    v_mfma_f32_16x16x32_bf16 v[92:95], a[4:7], a[76:79], v[92:95]
    ds_read_b128 a[56:59], v9 offset:12288
    v_mfma_f32_16x16x32_bf16 v[96:99], a[8:11], a[76:79], v[96:99]
    v_mfma_f32_16x16x32_bf16 v[100:103], a[12:15], a[76:79], v[100:103]
    ds_read_b128 a[60:63], v9 offset:14336
    v_mfma_f32_16x16x32_bf16 v[104:107], a[16:19], a[76:79], v[104:107]
    v_mfma_f32_16x16x32_bf16 v[108:111], a[20:23], a[76:79], v[108:111]
    v_mfma_f32_16x16x32_bf16 v[112:115], a[24:27], a[76:79], v[112:115]
    v_mfma_f32_16x16x32_bf16 v[116:119], a[28:31], a[76:79], v[116:119]
    ds_read_b128 a[116:119], v11 offset:0
    v_mfma_f32_16x16x32_bf16 v[84:87], a[112:115], a[76:79], v[84:87]
    ds_read_b64_tr_b16 a[76:77], v14 offset:21504
    v_mfma_f32_16x16x32_bf16 a[192:195], a[80:83], a[0:3], a[192:195]
    ds_read_b64_tr_b16 a[78:79], v14 offset:21760
    v_mfma_f32_16x16x32_bf16 a[200:203], a[80:83], a[4:7], a[200:203]
    v_mfma_f32_16x16x32_bf16 a[208:211], a[80:83], a[8:11], a[208:211]
    ds_read_b64_tr_b16 a[104:105], v12 offset:24576
    v_mfma_f32_16x16x32_bf16 a[216:219], a[80:83], a[12:15], a[216:219]
    v_mfma_f32_16x16x32_bf16 a[224:227], a[80:83], a[16:19], a[224:227]
    v_mfma_f32_16x16x32_bf16 a[232:235], a[80:83], a[20:23], a[232:235]
    v_mfma_f32_16x16x32_bf16 a[240:243], a[80:83], a[24:27], a[240:243]
    ds_read_b64_tr_b16 a[106:107], v12 offset:24832
    v_mfma_f32_16x16x32_bf16 a[248:251], a[80:83], a[28:31], a[248:251]
    ds_read_b64_tr_b16 a[80:81], v12 offset:22528
    v_mfma_f32_16x16x32_bf16 a[196:199], a[84:87], a[0:3], a[196:199]
    ds_read_b64_tr_b16 a[82:83], v12 offset:22784
    v_mfma_f32_16x16x32_bf16 a[204:207], a[84:87], a[4:7], a[204:207]
    v_mfma_f32_16x16x32_bf16 a[212:215], a[84:87], a[8:11], a[212:215]
    ds_read_b64_tr_b16 a[108:109], v14 offset:24576
    v_mfma_f32_16x16x32_bf16 a[220:223], a[84:87], a[12:15], a[220:223]
    v_mfma_f32_16x16x32_bf16 a[228:231], a[84:87], a[16:19], a[228:231]
    v_mfma_f32_16x16x32_bf16 a[236:239], a[84:87], a[20:23], a[236:239]
    v_mfma_f32_16x16x32_bf16 a[244:247], a[84:87], a[24:27], a[244:247]
    ds_read_b64_tr_b16 a[110:111], v14 offset:24832
    v_mfma_f32_16x16x32_bf16 a[252:255], a[84:87], a[28:31], a[252:255]
    ds_read_b64_tr_b16 a[84:85], v14 offset:22528
    v_mfma_f32_16x16x32_bf16 v[128:131], a[88:91], a[0:3], v[128:131]
    ds_read_b64_tr_b16 a[86:87], v14 offset:22784
    v_mfma_f32_16x16x32_bf16 v[144:147], a[88:91], a[4:7], v[144:147]
    v_mfma_f32_16x16x32_bf16 v[160:163], a[88:91], a[8:11], v[160:163]
    v_mfma_f32_16x16x32_bf16 v[176:179], a[88:91], a[12:15], v[176:179]
    v_mfma_f32_16x16x32_bf16 v[192:195], a[88:91], a[16:19], v[192:195]
    v_mfma_f32_16x16x32_bf16 v[208:211], a[88:91], a[20:23], v[208:211]
    v_mfma_f32_16x16x32_bf16 v[224:227], a[88:91], a[24:27], v[224:227]
    v_mfma_f32_16x16x32_bf16 v[240:243], a[88:91], a[28:31], v[240:243]
    ds_read_b64_tr_b16 a[88:89], v12 offset:23552
    v_mfma_f32_16x16x32_bf16 v[132:135], a[92:95], a[0:3], v[132:135]
    ds_read_b64_tr_b16 a[90:91], v12 offset:23808
    v_mfma_f32_16x16x32_bf16 v[148:151], a[92:95], a[4:7], v[148:151]
    v_mfma_f32_16x16x32_bf16 v[164:167], a[92:95], a[8:11], v[164:167]
    v_mfma_f32_16x16x32_bf16 v[180:183], a[92:95], a[12:15], v[180:183]
    v_mfma_f32_16x16x32_bf16 v[196:199], a[92:95], a[16:19], v[196:199]
    v_mfma_f32_16x16x32_bf16 v[212:215], a[92:95], a[20:23], v[212:215]
    v_mfma_f32_16x16x32_bf16 v[228:231], a[92:95], a[24:27], v[228:231]
    v_mfma_f32_16x16x32_bf16 v[244:247], a[92:95], a[28:31], v[244:247]
    ds_read_b64_tr_b16 a[92:93], v14 offset:23552
    v_mfma_f32_16x16x32_bf16 v[136:139], a[96:99], a[0:3], v[136:139]
    ds_read_b64_tr_b16 a[94:95], v14 offset:23808
    v_mfma_f32_16x16x32_bf16 v[152:155], a[96:99], a[4:7], v[152:155]
    v_mfma_f32_16x16x32_bf16 v[168:171], a[96:99], a[8:11], v[168:171]
    v_mfma_f32_16x16x32_bf16 v[184:187], a[96:99], a[12:15], v[184:187]
    v_mfma_f32_16x16x32_bf16 v[200:203], a[96:99], a[16:19], v[200:203]
    v_mfma_f32_16x16x32_bf16 v[216:219], a[96:99], a[20:23], v[216:219]
    v_mfma_f32_16x16x32_bf16 v[232:235], a[96:99], a[24:27], v[232:235]
    v_mfma_f32_16x16x32_bf16 v[248:251], a[96:99], a[28:31], v[248:251]
    v_mfma_f32_16x16x32_bf16 v[140:143], a[100:103], a[0:3], v[140:143]
    v_mfma_f32_16x16x32_bf16 v[156:159], a[100:103], a[4:7], v[156:159]
    v_mfma_f32_16x16x32_bf16 v[172:175], a[100:103], a[8:11], v[172:175]
    v_mfma_f32_16x16x32_bf16 v[188:191], a[100:103], a[12:15], v[188:191]
    v_mfma_f32_16x16x32_bf16 v[204:207], a[100:103], a[16:19], v[204:207]
    v_mfma_f32_16x16x32_bf16 v[220:223], a[100:103], a[20:23], v[220:223]
    v_mfma_f32_16x16x32_bf16 v[236:239], a[100:103], a[24:27], v[236:239]
    v_mfma_f32_16x16x32_bf16 v[252:255], a[100:103], a[28:31], v[252:255]
    s_waitcnt vmcnt(1) lgkmcnt(0)
    s_barrier
    v_mfma_f32_16x16x32_bf16 a[128:131], a[64:67], a[32:35], a[128:131]
    s_add_u32 m0, s78, 0
    v_mfma_f32_16x16x32_bf16 a[136:139], a[64:67], a[36:39], a[136:139]
    buffer_load_dwordx4 v1, s[28:31], s68 offen offset:0 sc1 lds
    v_mfma_f32_16x16x32_bf16 a[144:147], a[64:67], a[40:43], a[144:147]
    ds_read_b128 a[0:3], v8 offset:34816
    v_mfma_f32_16x16x32_bf16 a[152:155], a[64:67], a[44:47], a[152:155]
    v_mfma_f32_16x16x32_bf16 a[160:163], a[64:67], a[48:51], a[160:163]
    buffer_load_dwordx4 v1, s[28:31], s69 offen offset:1024 sc1 lds
    v_mfma_f32_16x16x32_bf16 a[168:171], a[64:67], a[52:55], a[168:171]
    v_mfma_f32_16x16x32_bf16 a[176:179], a[64:67], a[56:59], a[176:179]
    ds_read_b128 a[4:7], v8 offset:36864
    v_mfma_f32_16x16x32_bf16 a[184:187], a[64:67], a[60:63], a[184:187]
    v_mfma_f32_16x16x32_bf16 v[120:123], a[64:67], a[116:119], v[120:123]
    ds_read_b64_tr_b16 a[64:65], v13 offset:0
    v_mfma_f32_16x16x32_bf16 a[132:135], a[68:71], a[32:35], a[132:135]
    ds_read_b64_tr_b16 a[66:67], v13 offset:256
    v_mfma_f32_16x16x32_bf16 a[140:143], a[68:71], a[36:39], a[140:143]
    ds_read_b128 a[8:11], v8 offset:38912
    v_mfma_f32_16x16x32_bf16 a[148:151], a[68:71], a[40:43], a[148:151]
    buffer_load_dwordx4 v1, s[28:31], s70 offen offset:2048 sc1 lds
    v_mfma_f32_16x16x32_bf16 a[156:159], a[68:71], a[44:47], a[156:159]
    buffer_load_dwordx4 v1, s[28:31], s71 offen offset:3072 sc1 lds
    v_mfma_f32_16x16x32_bf16 a[164:167], a[68:71], a[48:51], a[164:167]
    v_mfma_f32_16x16x32_bf16 a[172:175], a[68:71], a[52:55], a[172:175]
    ds_read_b128 a[12:15], v8 offset:40960
    v_mfma_f32_16x16x32_bf16 a[180:183], a[68:71], a[56:59], a[180:183]
    s_add_u32 m0, s78, 4096
    v_mfma_f32_16x16x32_bf16 a[188:191], a[68:71], a[60:63], a[188:191]
    buffer_load_dwordx4 v1, s[28:31], s72 offen offset:0 sc1 lds
    v_mfma_f32_16x16x32_bf16 v[124:127], a[68:71], a[116:119], v[124:127]
    ds_read_b64_tr_b16 a[68:69], v15 offset:0
    v_mfma_f32_16x16x32_bf16 v[52:55], a[32:35], a[72:75], v[52:55]
    ds_read_b64_tr_b16 a[70:71], v15 offset:256
    v_mfma_f32_16x16x32_bf16 v[56:59], a[36:39], a[72:75], v[56:59]
    v_mfma_f32_16x16x32_bf16 v[60:63], a[40:43], a[72:75], v[60:63]
    ds_read_b128 a[16:19], v8 offset:43008
    v_mfma_f32_16x16x32_bf16 v[64:67], a[44:47], a[72:75], v[64:67]
    buffer_load_dwordx4 v1, s[28:31], s73 offen offset:1024 sc1 lds
    v_mfma_f32_16x16x32_bf16 v[68:71], a[48:51], a[72:75], v[68:71]
    ds_read_b128 a[20:23], v8 offset:45056
    v_mfma_f32_16x16x32_bf16 v[72:75], a[52:55], a[72:75], v[72:75]
    v_mfma_f32_16x16x32_bf16 v[76:79], a[56:59], a[72:75], v[76:79]
    buffer_load_dwordx4 v1, s[28:31], s74 offen offset:2048 sc1 lds
    v_mfma_f32_16x16x32_bf16 v[80:83], a[60:63], a[72:75], v[80:83]
    v_mfma_f32_16x16x32_bf16 v[48:51], a[116:119], a[72:75], v[48:51]
    ds_read_b64_tr_b16 a[72:73], v13 offset:1024
    v_mfma_f32_16x16x32_bf16 v[88:91], a[32:35], a[76:79], v[88:91]
    ds_read_b64_tr_b16 a[74:75], v13 offset:1280
    v_mfma_f32_16x16x32_bf16 v[92:95], a[36:39], a[76:79], v[92:95]
    ds_read_b128 a[24:27], v8 offset:47104
    v_mfma_f32_16x16x32_bf16 v[96:99], a[40:43], a[76:79], v[96:99]
    buffer_load_dwordx4 v1, s[28:31], s75 offen offset:3072 sc1 lds
    v_add_u32 v1, 128, v1
    v_mfma_f32_16x16x32_bf16 v[100:103], a[44:47], a[76:79], v[100:103]
    ds_read_b128 a[28:31], v8 offset:49152
    v_mfma_f32_16x16x32_bf16 v[104:107], a[48:51], a[76:79], v[104:107]
    s_add_u32 m0, s78, 8192
    v_mfma_f32_16x16x32_bf16 v[108:111], a[52:55], a[76:79], v[108:111]
    buffer_load_dwordx4 v2, s[28:31], s68 offen offset:0 sc1 lds
    v_mfma_f32_16x16x32_bf16 v[112:115], a[56:59], a[76:79], v[112:115]
    v_mfma_f32_16x16x32_bf16 v[116:119], a[60:63], a[76:79], v[116:119]
    ds_read_b128 a[112:115], v10 offset:34816
    v_mfma_f32_16x16x32_bf16 v[84:87], a[116:119], a[76:79], v[84:87]
    ds_read_b64_tr_b16 a[76:77], v15 offset:1024
    v_mfma_f32_16x16x32_bf16 a[192:195], a[80:83], a[32:35], a[192:195]
    ds_read_b64_tr_b16 a[78:79], v15 offset:1280
    v_mfma_f32_16x16x32_bf16 a[200:203], a[80:83], a[36:39], a[200:203]
    buffer_load_dwordx4 v2, s[28:31], s69 offen offset:1024 sc1 lds
    v_mfma_f32_16x16x32_bf16 a[208:211], a[80:83], a[40:43], a[208:211]
    ds_read_b64_tr_b16 a[96:97], v13 offset:4096
    v_mfma_f32_16x16x32_bf16 a[216:219], a[80:83], a[44:47], a[216:219]
    buffer_load_dwordx4 v2, s[28:31], s70 offen offset:2048 sc1 lds
    v_mfma_f32_16x16x32_bf16 a[224:227], a[80:83], a[48:51], a[224:227]
    v_mfma_f32_16x16x32_bf16 a[232:235], a[80:83], a[52:55], a[232:235]
    v_mfma_f32_16x16x32_bf16 a[240:243], a[80:83], a[56:59], a[240:243]
    ds_read_b64_tr_b16 a[98:99], v13 offset:4352
    v_mfma_f32_16x16x32_bf16 a[248:251], a[80:83], a[60:63], a[248:251]
    ds_read_b64_tr_b16 a[80:81], v13 offset:2048
    v_mfma_f32_16x16x32_bf16 a[196:199], a[84:87], a[32:35], a[196:199]
    ds_read_b64_tr_b16 a[82:83], v13 offset:2304
    v_mfma_f32_16x16x32_bf16 a[204:207], a[84:87], a[36:39], a[204:207]
    buffer_load_dwordx4 v2, s[28:31], s71 offen offset:3072 sc1 lds
    v_mfma_f32_16x16x32_bf16 a[212:215], a[84:87], a[40:43], a[212:215]
    ds_read_b64_tr_b16 a[100:101], v15 offset:4096
    s_add_u32 m0, s78, 12288
    v_mfma_f32_16x16x32_bf16 a[220:223], a[84:87], a[44:47], a[220:223]
    buffer_load_dwordx4 v2, s[28:31], s72 offen offset:0 sc1 lds
    v_mfma_f32_16x16x32_bf16 a[228:231], a[84:87], a[48:51], a[228:231]
    v_mfma_f32_16x16x32_bf16 a[236:239], a[84:87], a[52:55], a[236:239]
    v_mfma_f32_16x16x32_bf16 a[244:247], a[84:87], a[56:59], a[244:247]
    ds_read_b64_tr_b16 a[102:103], v15 offset:4352
    v_mfma_f32_16x16x32_bf16 a[252:255], a[84:87], a[60:63], a[252:255]
    ds_read_b64_tr_b16 a[84:85], v15 offset:2048
    v_mfma_f32_16x16x32_bf16 v[128:131], a[88:91], a[32:35], v[128:131]
    ds_read_b64_tr_b16 a[86:87], v15 offset:2304
    v_mfma_f32_16x16x32_bf16 v[144:147], a[88:91], a[36:39], v[144:147]
    buffer_load_dwordx4 v2, s[28:31], s73 offen offset:1024 sc1 lds
    v_mfma_f32_16x16x32_bf16 v[160:163], a[88:91], a[40:43], v[160:163]
    v_mfma_f32_16x16x32_bf16 v[176:179], a[88:91], a[44:47], v[176:179]
    buffer_load_dwordx4 v2, s[28:31], s74 offen offset:2048 sc1 lds
    v_mfma_f32_16x16x32_bf16 v[192:195], a[88:91], a[48:51], v[192:195]
    v_mfma_f32_16x16x32_bf16 v[208:211], a[88:91], a[52:55], v[208:211]
    v_mfma_f32_16x16x32_bf16 v[224:227], a[88:91], a[56:59], v[224:227]
    v_mfma_f32_16x16x32_bf16 v[240:243], a[88:91], a[60:63], v[240:243]
    ds_read_b64_tr_b16 a[88:89], v13 offset:3072
    v_mfma_f32_16x16x32_bf16 v[132:135], a[92:95], a[32:35], v[132:135]
    ds_read_b64_tr_b16 a[90:91], v13 offset:3328
    v_mfma_f32_16x16x32_bf16 v[148:151], a[92:95], a[36:39], v[148:151]
    buffer_load_dwordx4 v2, s[28:31], s75 offen offset:3072 sc1 lds
    v_add_u32 v2, 128, v2
    v_mfma_f32_16x16x32_bf16 v[164:167], a[92:95], a[40:43], v[164:167]
    v_mfma_f32_16x16x32_bf16 v[180:183], a[92:95], a[44:47], v[180:183]
    v_mfma_f32_16x16x32_bf16 v[196:199], a[92:95], a[48:51], v[196:199]
    v_mfma_f32_16x16x32_bf16 v[212:215], a[92:95], a[52:55], v[212:215]
    v_mfma_f32_16x16x32_bf16 v[228:231], a[92:95], a[56:59], v[228:231]
    v_mfma_f32_16x16x32_bf16 v[244:247], a[92:95], a[60:63], v[244:247]
    ds_read_b64_tr_b16 a[92:93], v15 offset:3072
    v_mfma_f32_16x16x32_bf16 v[136:139], a[104:107], a[32:35], v[136:139]
    ds_read_b64_tr_b16 a[94:95], v15 offset:3328
    v_mfma_f32_16x16x32_bf16 v[152:155], a[104:107], a[36:39], v[152:155]
    v_mfma_f32_16x16x32_bf16 v[168:171], a[104:107], a[40:43], v[168:171]
    v_mfma_f32_16x16x32_bf16 v[184:187], a[104:107], a[44:47], v[184:187]
    v_mfma_f32_16x16x32_bf16 v[200:203], a[104:107], a[48:51], v[200:203]
    v_mfma_f32_16x16x32_bf16 v[216:219], a[104:107], a[52:55], v[216:219]
    v_mfma_f32_16x16x32_bf16 v[232:235], a[104:107], a[56:59], v[232:235]
    v_mfma_f32_16x16x32_bf16 v[248:251], a[104:107], a[60:63], v[248:251]
    v_mfma_f32_16x16x32_bf16 v[140:143], a[108:111], a[32:35], v[140:143]
    v_mfma_f32_16x16x32_bf16 v[156:159], a[108:111], a[36:39], v[156:159]
    v_mfma_f32_16x16x32_bf16 v[172:175], a[108:111], a[40:43], v[172:175]
    v_mfma_f32_16x16x32_bf16 v[188:191], a[108:111], a[44:47], v[188:191]
    v_mfma_f32_16x16x32_bf16 v[204:207], a[108:111], a[48:51], v[204:207]
    v_mfma_f32_16x16x32_bf16 v[220:223], a[108:111], a[52:55], v[220:223]
    v_mfma_f32_16x16x32_bf16 v[236:239], a[108:111], a[56:59], v[236:239]
    v_mfma_f32_16x16x32_bf16 v[252:255], a[108:111], a[60:63], v[252:255]
    s_waitcnt lgkmcnt(0)
    s_barrier
    v_mfma_f32_16x16x32_bf16 a[128:131], a[64:67], a[0:3], a[128:131]
    buffer_load_dword v7, v6, s[44:47], s4 offen
    v_add_u32_e64 v6, s79, v6
    v_mfma_f32_16x16x32_bf16 a[136:139], a[64:67], a[4:7], a[136:139]
    v_mfma_f32_16x16x32_bf16 a[144:147], a[64:67], a[8:11], a[144:147]
    ds_read_b128 a[32:35], v9 offset:34816
    v_mfma_f32_16x16x32_bf16 a[152:155], a[64:67], a[12:15], a[152:155]
    v_mfma_f32_16x16x32_bf16 a[160:163], a[64:67], a[16:19], a[160:163]
    v_mfma_f32_16x16x32_bf16 a[168:171], a[64:67], a[20:23], a[168:171]
    v_mfma_f32_16x16x32_bf16 a[176:179], a[64:67], a[24:27], a[176:179]
    ds_read_b128 a[36:39], v9 offset:36864
    v_mfma_f32_16x16x32_bf16 a[184:187], a[64:67], a[28:31], a[184:187]
    v_mfma_f32_16x16x32_bf16 v[120:123], a[64:67], a[112:115], v[120:123]
    ds_read_b64_tr_b16 a[64:65], v13 offset:20480
    v_mfma_f32_16x16x32_bf16 a[132:135], a[68:71], a[0:3], a[132:135]
    ds_read_b64_tr_b16 a[66:67], v13 offset:20736
    v_mfma_f32_16x16x32_bf16 a[140:143], a[68:71], a[4:7], a[140:143]
    ds_read_b128 a[40:43], v9 offset:38912
    v_mfma_f32_16x16x32_bf16 a[148:151], a[68:71], a[8:11], a[148:151]
    v_mfma_f32_16x16x32_bf16 a[156:159], a[68:71], a[12:15], a[156:159]
    v_mfma_f32_16x16x32_bf16 a[164:167], a[68:71], a[16:19], a[164:167]
    v_mfma_f32_16x16x32_bf16 a[172:175], a[68:71], a[20:23], a[172:175]
    ds_read_b128 a[44:47], v9 offset:40960
    v_mfma_f32_16x16x32_bf16 a[180:183], a[68:71], a[24:27], a[180:183]
    v_mfma_f32_16x16x32_bf16 a[188:191], a[68:71], a[28:31], a[188:191]
    v_mfma_f32_16x16x32_bf16 v[124:127], a[68:71], a[112:115], v[124:127]
    ds_read_b64_tr_b16 a[68:69], v15 offset:20480
    v_mfma_f32_16x16x32_bf16 v[52:55], a[0:3], a[72:75], v[52:55]
    ds_read_b64_tr_b16 a[70:71], v15 offset:20736
    v_mfma_f32_16x16x32_bf16 v[56:59], a[4:7], a[72:75], v[56:59]
    v_mfma_f32_16x16x32_bf16 v[60:63], a[8:11], a[72:75], v[60:63]
    ds_read_b128 a[48:51], v9 offset:43008
    v_mfma_f32_16x16x32_bf16 v[64:67], a[12:15], a[72:75], v[64:67]
    v_mfma_f32_16x16x32_bf16 v[68:71], a[16:19], a[72:75], v[68:71]
    ds_read_b128 a[52:55], v9 offset:45056
    v_mfma_f32_16x16x32_bf16 v[72:75], a[20:23], a[72:75], v[72:75]
    v_mfma_f32_16x16x32_bf16 v[76:79], a[24:27], a[72:75], v[76:79]
    v_mfma_f32_16x16x32_bf16 v[80:83], a[28:31], a[72:75], v[80:83]
    v_mfma_f32_16x16x32_bf16 v[48:51], a[112:115], a[72:75], v[48:51]
    ds_read_b64_tr_b16 a[72:73], v13 offset:21504
    v_mfma_f32_16x16x32_bf16 v[88:91], a[0:3], a[76:79], v[88:91]
    ds_read_b64_tr_b16 a[74:75], v13 offset:21760
    v_mfma_f32_16x16x32_bf16 v[92:95], a[4:7], a[76:79], v[92:95]
    ds_read_b128 a[56:59], v9 offset:47104
    v_mfma_f32_16x16x32_bf16 v[96:99], a[8:11], a[76:79], v[96:99]
    v_mfma_f32_16x16x32_bf16 v[100:103], a[12:15], a[76:79], v[100:103]
    ds_read_b128 a[60:63], v9 offset:49152
    v_mfma_f32_16x16x32_bf16 v[104:107], a[16:19], a[76:79], v[104:107]
    v_mfma_f32_16x16x32_bf16 v[108:111], a[20:23], a[76:79], v[108:111]
    v_mfma_f32_16x16x32_bf16 v[112:115], a[24:27], a[76:79], v[112:115]
    v_mfma_f32_16x16x32_bf16 v[116:119], a[28:31], a[76:79], v[116:119]
    ds_read_b128 a[116:119], v11 offset:34816
    v_mfma_f32_16x16x32_bf16 v[84:87], a[112:115], a[76:79], v[84:87]
    ds_read_b64_tr_b16 a[76:77], v15 offset:21504
    v_mfma_f32_16x16x32_bf16 a[192:195], a[80:83], a[0:3], a[192:195]
    ds_read_b64_tr_b16 a[78:79], v15 offset:21760
    v_mfma_f32_16x16x32_bf16 a[200:203], a[80:83], a[4:7], a[200:203]
    v_mfma_f32_16x16x32_bf16 a[208:211], a[80:83], a[8:11], a[208:211]
    ds_read_b64_tr_b16 a[104:105], v13 offset:24576
    v_mfma_f32_16x16x32_bf16 a[216:219], a[80:83], a[12:15], a[216:219]
    v_mfma_f32_16x16x32_bf16 a[224:227], a[80:83], a[16:19], a[224:227]
    v_mfma_f32_16x16x32_bf16 a[232:235], a[80:83], a[20:23], a[232:235]
    v_mfma_f32_16x16x32_bf16 a[240:243], a[80:83], a[24:27], a[240:243]
    ds_read_b64_tr_b16 a[106:107], v13 offset:24832
    v_mfma_f32_16x16x32_bf16 a[248:251], a[80:83], a[28:31], a[248:251]
    ds_read_b64_tr_b16 a[80:81], v13 offset:22528
    v_mfma_f32_16x16x32_bf16 a[196:199], a[84:87], a[0:3], a[196:199]
    ds_read_b64_tr_b16 a[82:83], v13 offset:22784
    v_mfma_f32_16x16x32_bf16 a[204:207], a[84:87], a[4:7], a[204:207]
    v_mfma_f32_16x16x32_bf16 a[212:215], a[84:87], a[8:11], a[212:215]
    ds_read_b64_tr_b16 a[108:109], v15 offset:24576
    v_mfma_f32_16x16x32_bf16 a[220:223], a[84:87], a[12:15], a[220:223]
    v_mfma_f32_16x16x32_bf16 a[228:231], a[84:87], a[16:19], a[228:231]
    v_mfma_f32_16x16x32_bf16 a[236:239], a[84:87], a[20:23], a[236:239]
    v_mfma_f32_16x16x32_bf16 a[244:247], a[84:87], a[24:27], a[244:247]
    ds_read_b64_tr_b16 a[110:111], v15 offset:24832
    v_mfma_f32_16x16x32_bf16 a[252:255], a[84:87], a[28:31], a[252:255]
    ds_read_b64_tr_b16 a[84:85], v15 offset:22528
    v_mfma_f32_16x16x32_bf16 v[128:131], a[88:91], a[0:3], v[128:131]
    ds_read_b64_tr_b16 a[86:87], v15 offset:22784
    v_mfma_f32_16x16x32_bf16 v[144:147], a[88:91], a[4:7], v[144:147]
    v_mfma_f32_16x16x32_bf16 v[160:163], a[88:91], a[8:11], v[160:163]
    v_mfma_f32_16x16x32_bf16 v[176:179], a[88:91], a[12:15], v[176:179]
    v_mfma_f32_16x16x32_bf16 v[192:195], a[88:91], a[16:19], v[192:195]
    v_mfma_f32_16x16x32_bf16 v[208:211], a[88:91], a[20:23], v[208:211]
    v_mfma_f32_16x16x32_bf16 v[224:227], a[88:91], a[24:27], v[224:227]
    v_mfma_f32_16x16x32_bf16 v[240:243], a[88:91], a[28:31], v[240:243]
    ds_read_b64_tr_b16 a[88:89], v13 offset:23552
    v_mfma_f32_16x16x32_bf16 v[132:135], a[92:95], a[0:3], v[132:135]
    ds_read_b64_tr_b16 a[90:91], v13 offset:23808
    v_mfma_f32_16x16x32_bf16 v[148:151], a[92:95], a[4:7], v[148:151]
    v_mfma_f32_16x16x32_bf16 v[164:167], a[92:95], a[8:11], v[164:167]
    v_mfma_f32_16x16x32_bf16 v[180:183], a[92:95], a[12:15], v[180:183]
    v_mfma_f32_16x16x32_bf16 v[196:199], a[92:95], a[16:19], v[196:199]
    v_mfma_f32_16x16x32_bf16 v[212:215], a[92:95], a[20:23], v[212:215]
    v_mfma_f32_16x16x32_bf16 v[228:231], a[92:95], a[24:27], v[228:231]
    v_mfma_f32_16x16x32_bf16 v[244:247], a[92:95], a[28:31], v[244:247]
    ds_read_b64_tr_b16 a[92:93], v15 offset:23552
    v_mfma_f32_16x16x32_bf16 v[136:139], a[96:99], a[0:3], v[136:139]
    ds_read_b64_tr_b16 a[94:95], v15 offset:23808
    v_mfma_f32_16x16x32_bf16 v[152:155], a[96:99], a[4:7], v[152:155]
    v_mfma_f32_16x16x32_bf16 v[168:171], a[96:99], a[8:11], v[168:171]
    v_mfma_f32_16x16x32_bf16 v[184:187], a[96:99], a[12:15], v[184:187]
    v_mfma_f32_16x16x32_bf16 v[200:203], a[96:99], a[16:19], v[200:203]
    v_mfma_f32_16x16x32_bf16 v[216:219], a[96:99], a[20:23], v[216:219]
    v_mfma_f32_16x16x32_bf16 v[232:235], a[96:99], a[24:27], v[232:235]
    v_mfma_f32_16x16x32_bf16 v[248:251], a[96:99], a[28:31], v[248:251]
    v_mfma_f32_16x16x32_bf16 v[140:143], a[100:103], a[0:3], v[140:143]
    v_mfma_f32_16x16x32_bf16 v[156:159], a[100:103], a[4:7], v[156:159]
    v_mfma_f32_16x16x32_bf16 v[172:175], a[100:103], a[8:11], v[172:175]
    v_mfma_f32_16x16x32_bf16 v[188:191], a[100:103], a[12:15], v[188:191]
    v_mfma_f32_16x16x32_bf16 v[204:207], a[100:103], a[16:19], v[204:207]
    v_mfma_f32_16x16x32_bf16 v[220:223], a[100:103], a[20:23], v[220:223]
    v_mfma_f32_16x16x32_bf16 v[236:239], a[100:103], a[24:27], v[236:239]
    v_mfma_f32_16x16x32_bf16 v[252:255], a[100:103], a[28:31], v[252:255]
    s_waitcnt vmcnt(1) lgkmcnt(0)
    s_barrier
    v_mfma_f32_16x16x32_bf16 a[128:131], a[64:67], a[32:35], a[128:131]
    s_add_u32 m0, s78, 34816
    v_mfma_f32_16x16x32_bf16 a[136:139], a[64:67], a[36:39], a[136:139]
    buffer_load_dwordx4 v1, s[28:31], s68 offen offset:0 sc1 lds
    v_mfma_f32_16x16x32_bf16 a[144:147], a[64:67], a[40:43], a[144:147]
    ds_read_b128 a[0:3], v8 offset:0
    v_mfma_f32_16x16x32_bf16 a[152:155], a[64:67], a[44:47], a[152:155]
    v_mfma_f32_16x16x32_bf16 a[160:163], a[64:67], a[48:51], a[160:163]
    buffer_load_dwordx4 v1, s[28:31], s69 offen offset:1024 sc1 lds
    v_mfma_f32_16x16x32_bf16 a[168:171], a[64:67], a[52:55], a[168:171]
    v_mfma_f32_16x16x32_bf16 a[176:179], a[64:67], a[56:59], a[176:179]
    ds_read_b128 a[4:7], v8 offset:2048
    v_mfma_f32_16x16x32_bf16 a[184:187], a[64:67], a[60:63], a[184:187]
    v_mfma_f32_16x16x32_bf16 v[120:123], a[64:67], a[116:119], v[120:123]
    ds_read_b64_tr_b16 a[64:65], v12 offset:0
    v_mfma_f32_16x16x32_bf16 a[132:135], a[68:71], a[32:35], a[132:135]
    ds_read_b64_tr_b16 a[66:67], v12 offset:256
    v_mfma_f32_16x16x32_bf16 a[140:143], a[68:71], a[36:39], a[140:143]
    ds_read_b128 a[8:11], v8 offset:4096
    v_mfma_f32_16x16x32_bf16 a[148:151], a[68:71], a[40:43], a[148:151]
    buffer_load_dwordx4 v1, s[28:31], s70 offen offset:2048 sc1 lds
    v_mfma_f32_16x16x32_bf16 a[156:159], a[68:71], a[44:47], a[156:159]
    buffer_load_dwordx4 v1, s[28:31], s71 offen offset:3072 sc1 lds
    v_mfma_f32_16x16x32_bf16 a[164:167], a[68:71], a[48:51], a[164:167]
    v_mfma_f32_16x16x32_bf16 a[172:175], a[68:71], a[52:55], a[172:175]
    ds_read_b128 a[12:15], v8 offset:6144
    v_mfma_f32_16x16x32_bf16 a[180:183], a[68:71], a[56:59], a[180:183]
    s_add_u32 m0, s78, 38912
    v_mfma_f32_16x16x32_bf16 a[188:191], a[68:71], a[60:63], a[188:191]
    buffer_load_dwordx4 v1, s[28:31], s72 offen offset:0 sc1 lds
    v_mfma_f32_16x16x32_bf16 v[124:127], a[68:71], a[116:119], v[124:127]
    ds_read_b64_tr_b16 a[68:69], v14 offset:0
    v_mfma_f32_16x16x32_bf16 v[52:55], a[32:35], a[72:75], v[52:55]
    ds_read_b64_tr_b16 a[70:71], v14 offset:256
    v_mfma_f32_16x16x32_bf16 v[56:59], a[36:39], a[72:75], v[56:59]
    v_mfma_f32_16x16x32_bf16 v[60:63], a[40:43], a[72:75], v[60:63]
    ds_read_b128 a[16:19], v8 offset:8192
    v_mfma_f32_16x16x32_bf16 v[64:67], a[44:47], a[72:75], v[64:67]
    buffer_load_dwordx4 v1, s[28:31], s73 offen offset:1024 sc1 lds
    v_mfma_f32_16x16x32_bf16 v[68:71], a[48:51], a[72:75], v[68:71]
    ds_read_b128 a[20:23], v8 offset:10240
    v_mfma_f32_16x16x32_bf16 v[72:75], a[52:55], a[72:75], v[72:75]
    v_mfma_f32_16x16x32_bf16 v[76:79], a[56:59], a[72:75], v[76:79]
    buffer_load_dwordx4 v1, s[28:31], s74 offen offset:2048 sc1 lds
    v_mfma_f32_16x16x32_bf16 v[80:83], a[60:63], a[72:75], v[80:83]
    v_mfma_f32_16x16x32_bf16 v[48:51], a[116:119], a[72:75], v[48:51]
    ds_read_b64_tr_b16 a[72:73], v12 offset:1024
    v_mfma_f32_16x16x32_bf16 v[88:91], a[32:35], a[76:79], v[88:91]
    ds_read_b64_tr_b16 a[74:75], v12 offset:1280
    v_mfma_f32_16x16x32_bf16 v[92:95], a[36:39], a[76:79], v[92:95]
    ds_read_b128 a[24:27], v8 offset:12288
    v_mfma_f32_16x16x32_bf16 v[96:99], a[40:43], a[76:79], v[96:99]
    buffer_load_dwordx4 v1, s[28:31], s75 offen offset:3072 sc1 lds
    v_add_u32 v1, 128, v1
    v_mfma_f32_16x16x32_bf16 v[100:103], a[44:47], a[76:79], v[100:103]
    ds_read_b128 a[28:31], v8 offset:14336
    v_mfma_f32_16x16x32_bf16 v[104:107], a[48:51], a[76:79], v[104:107]
    s_add_u32 m0, s78, 43008
    v_mfma_f32_16x16x32_bf16 v[108:111], a[52:55], a[76:79], v[108:111]
    buffer_load_dwordx4 v2, s[28:31], s68 offen offset:0 sc1 lds
    v_mfma_f32_16x16x32_bf16 v[112:115], a[56:59], a[76:79], v[112:115]
    v_mfma_f32_16x16x32_bf16 v[116:119], a[60:63], a[76:79], v[116:119]
    ds_read_b128 a[112:115], v10 offset:0
    v_mfma_f32_16x16x32_bf16 v[84:87], a[116:119], a[76:79], v[84:87]
    ds_read_b64_tr_b16 a[76:77], v14 offset:1024
    v_mfma_f32_16x16x32_bf16 a[192:195], a[80:83], a[32:35], a[192:195]
    ds_read_b64_tr_b16 a[78:79], v14 offset:1280
    v_mfma_f32_16x16x32_bf16 a[200:203], a[80:83], a[36:39], a[200:203]
    buffer_load_dwordx4 v2, s[28:31], s69 offen offset:1024 sc1 lds
    v_mfma_f32_16x16x32_bf16 a[208:211], a[80:83], a[40:43], a[208:211]
    ds_read_b64_tr_b16 a[96:97], v12 offset:4096
    v_mfma_f32_16x16x32_bf16 a[216:219], a[80:83], a[44:47], a[216:219]
    buffer_load_dwordx4 v2, s[28:31], s70 offen offset:2048 sc1 lds
    v_mfma_f32_16x16x32_bf16 a[224:227], a[80:83], a[48:51], a[224:227]
    v_mfma_f32_16x16x32_bf16 a[232:235], a[80:83], a[52:55], a[232:235]
    v_mfma_f32_16x16x32_bf16 a[240:243], a[80:83], a[56:59], a[240:243]
    ds_read_b64_tr_b16 a[98:99], v12 offset:4352
    v_mfma_f32_16x16x32_bf16 a[248:251], a[80:83], a[60:63], a[248:251]
    ds_read_b64_tr_b16 a[80:81], v12 offset:2048
    v_mfma_f32_16x16x32_bf16 a[196:199], a[84:87], a[32:35], a[196:199]
    ds_read_b64_tr_b16 a[82:83], v12 offset:2304
    v_mfma_f32_16x16x32_bf16 a[204:207], a[84:87], a[36:39], a[204:207]
    buffer_load_dwordx4 v2, s[28:31], s71 offen offset:3072 sc1 lds
    v_mfma_f32_16x16x32_bf16 a[212:215], a[84:87], a[40:43], a[212:215]
    ds_read_b64_tr_b16 a[100:101], v14 offset:4096
    s_add_u32 m0, s78, 47104
    v_mfma_f32_16x16x32_bf16 a[220:223], a[84:87], a[44:47], a[220:223]
    buffer_load_dwordx4 v2, s[28:31], s72 offen offset:0 sc1 lds
    v_mfma_f32_16x16x32_bf16 a[228:231], a[84:87], a[48:51], a[228:231]
    v_mfma_f32_16x16x32_bf16 a[236:239], a[84:87], a[52:55], a[236:239]
    v_mfma_f32_16x16x32_bf16 a[244:247], a[84:87], a[56:59], a[244:247]
    ds_read_b64_tr_b16 a[102:103], v14 offset:4352
    v_mfma_f32_16x16x32_bf16 a[252:255], a[84:87], a[60:63], a[252:255]
    ds_read_b64_tr_b16 a[84:85], v14 offset:2048
    v_mfma_f32_16x16x32_bf16 v[128:131], a[88:91], a[32:35], v[128:131]
    ds_read_b64_tr_b16 a[86:87], v14 offset:2304
    v_mfma_f32_16x16x32_bf16 v[144:147], a[88:91], a[36:39], v[144:147]
    buffer_load_dwordx4 v2, s[28:31], s73 offen offset:1024 sc1 lds
    v_mfma_f32_16x16x32_bf16 v[160:163], a[88:91], a[40:43], v[160:163]
    v_mfma_f32_16x16x32_bf16 v[176:179], a[88:91], a[44:47], v[176:179]
    buffer_load_dwordx4 v2, s[28:31], s74 offen offset:2048 sc1 lds
    v_mfma_f32_16x16x32_bf16 v[192:195], a[88:91], a[48:51], v[192:195]
    v_mfma_f32_16x16x32_bf16 v[208:211], a[88:91], a[52:55], v[208:211]
    v_mfma_f32_16x16x32_bf16 v[224:227], a[88:91], a[56:59], v[224:227]
    v_mfma_f32_16x16x32_bf16 v[240:243], a[88:91], a[60:63], v[240:243]
    ds_read_b64_tr_b16 a[88:89], v12 offset:3072
    v_mfma_f32_16x16x32_bf16 v[132:135], a[92:95], a[32:35], v[132:135]
    ds_read_b64_tr_b16 a[90:91], v12 offset:3328
    v_mfma_f32_16x16x32_bf16 v[148:151], a[92:95], a[36:39], v[148:151]
    buffer_load_dwordx4 v2, s[28:31], s75 offen offset:3072 sc1 lds
    v_add_u32 v2, 128, v2
    v_mfma_f32_16x16x32_bf16 v[164:167], a[92:95], a[40:43], v[164:167]
    v_mfma_f32_16x16x32_bf16 v[180:183], a[92:95], a[44:47], v[180:183]
    v_mfma_f32_16x16x32_bf16 v[196:199], a[92:95], a[48:51], v[196:199]
    v_mfma_f32_16x16x32_bf16 v[212:215], a[92:95], a[52:55], v[212:215]
    v_mfma_f32_16x16x32_bf16 v[228:231], a[92:95], a[56:59], v[228:231]
    v_mfma_f32_16x16x32_bf16 v[244:247], a[92:95], a[60:63], v[244:247]
    ds_read_b64_tr_b16 a[92:93], v14 offset:3072
    v_mfma_f32_16x16x32_bf16 v[136:139], a[104:107], a[32:35], v[136:139]
    ds_read_b64_tr_b16 a[94:95], v14 offset:3328
    v_mfma_f32_16x16x32_bf16 v[152:155], a[104:107], a[36:39], v[152:155]
    v_mfma_f32_16x16x32_bf16 v[168:171], a[104:107], a[40:43], v[168:171]
    v_mfma_f32_16x16x32_bf16 v[184:187], a[104:107], a[44:47], v[184:187]
    v_mfma_f32_16x16x32_bf16 v[200:203], a[104:107], a[48:51], v[200:203]
    v_mfma_f32_16x16x32_bf16 v[216:219], a[104:107], a[52:55], v[216:219]
    v_mfma_f32_16x16x32_bf16 v[232:235], a[104:107], a[56:59], v[232:235]
    v_mfma_f32_16x16x32_bf16 v[248:251], a[104:107], a[60:63], v[248:251]
    v_mfma_f32_16x16x32_bf16 v[140:143], a[108:111], a[32:35], v[140:143]
    v_mfma_f32_16x16x32_bf16 v[156:159], a[108:111], a[36:39], v[156:159]
    v_mfma_f32_16x16x32_bf16 v[172:175], a[108:111], a[40:43], v[172:175]
    v_mfma_f32_16x16x32_bf16 v[188:191], a[108:111], a[44:47], v[188:191]
    v_mfma_f32_16x16x32_bf16 v[204:207], a[108:111], a[48:51], v[204:207]
    v_mfma_f32_16x16x32_bf16 v[220:223], a[108:111], a[52:55], v[220:223]
    v_mfma_f32_16x16x32_bf16 v[236:239], a[108:111], a[56:59], v[236:239]
    v_mfma_f32_16x16x32_bf16 v[252:255], a[108:111], a[60:63], v[252:255]
    s_sub_u32 s67, s67, 1
    s_cmp_lg_u32 s67, 0
    s_cbranch_scc1 L_loop0
L_tail0:
    s_waitcnt lgkmcnt(0)
    s_barrier
    v_mfma_f32_16x16x32_bf16 a[128:131], a[64:67], a[0:3], a[128:131]
    s_getpc_b64 s[86:87]
L_pc0:
    s_sub_u32 s86, s86, L_pc0-L_tail0
    s_subb_u32 s87, s87, 0
    s_lshr_b32 s82, s2, 3
    s_lshl_b32 s82, s82, 2
    s_add_u32 s82, s82, s60
    s_lshl_b32 s82, s82, 10
    v_add_u32 v34, s82, v16
    v_min_u32 v34, L_code_end-L_tail0-4, v34
    global_load_dword v7, v34, s[86:87]
    v_mfma_f32_16x16x32_bf16 a[136:139], a[64:67], a[4:7], a[136:139]
    v_mfma_f32_16x16x32_bf16 a[144:147], a[64:67], a[8:11], a[144:147]
    ds_read_b128 a[32:35], v9 offset:0
    v_mfma_f32_16x16x32_bf16 a[152:155], a[64:67], a[12:15], a[152:155]
    v_mfma_f32_16x16x32_bf16 a[160:163], a[64:67], a[16:19], a[160:163]
    s_mul_i32 s82, s65, 1835008
    s_lshl_b32 s83, s66, 8
    v_mfma_f32_16x16x32_bf16 a[168:171], a[64:67], a[20:23], a[168:171]
    s_add_u32 s82, s82, s83
    s_add_u32 s48, s20, s82
    v_mfma_f32_16x16x32_bf16 a[176:179], a[64:67], a[24:27], a[176:179]
    ds_read_b128 a[36:39], v9 offset:2048
    s_addc_u32 s49, s21, 0
    s_and_b32 s49, s49, 0xffff
    v_mfma_f32_16x16x32_bf16 a[184:187], a[64:67], a[28:31], a[184:187]
    s_sub_u32 s50, 7340032, s82
    s_mov_b32 s51, 0x20000
    v_mfma_f32_16x16x32_bf16 v[120:123], a[64:67], a[112:115], v[120:123]
    ds_read_b64_tr_b16 a[64:65], v12 offset:20480
    s_add_u32 s52, s12, s83
    s_addc_u32 s53, s13, 0
    v_mfma_f32_16x16x32_bf16 a[132:135], a[68:71], a[0:3], a[132:135]
    ds_read_b64_tr_b16 a[66:67], v12 offset:20736
    s_and_b32 s53, s53, 0xffff
    s_sub_u32 s54, 2097152, s83
    v_mfma_f32_16x16x32_bf16 a[140:143], a[68:71], a[4:7], a[140:143]
    ds_read_b128 a[40:43], v9 offset:4096
    s_mov_b32 s55, 0x20000
    s_lshl_b32 s3, s60, 11
    v_mfma_f32_16x16x32_bf16 a[148:151], a[68:71], a[8:11], a[148:151]
    v_lshrrev_b32 v34, 4, v0
    v_and_b32 v35, 15, v0
    v_mfma_f32_16x16x32_bf16 a[156:159], a[68:71], a[12:15], a[156:159]
    v_lshlrev_b32 v36, 1, v34
    v_add_u32 v36, 0, v36
    v_mfma_f32_16x16x32_bf16 a[164:167], a[68:71], a[16:19], a[164:167]
    v_xor_b32 v36, v36, v35
    v_lshlrev_b32 v36, 4, v36
    v_mfma_f32_16x16x32_bf16 a[172:175], a[68:71], a[20:23], a[172:175]
    ds_read_b128 a[44:47], v9 offset:6144
    v_lshl_add_u32 v36, v34, 11, v36
    s_lshl_b32 s82, s60, 14
    v_mfma_f32_16x16x32_bf16 a[180:183], a[68:71], a[24:27], a[180:183]
    s_add_u32 s82, s82, 0
    v_add_u32 v17, s82, v36
    v_mfma_f32_16x16x32_bf16 a[188:191], a[68:71], a[28:31], a[188:191]
    s_lshl_b32 s82, s62, 1
    s_add_u32 s82, s82, 0
    v_mfma_f32_16x16x32_bf16 v[124:127], a[68:71], a[112:115], v[124:127]
    ds_read_b64_tr_b16 a[68:69], v14 offset:20480
    s_lshl_b32 s82, s82, 3
    s_lshl_b32 s83, s61, 2
    v_mfma_f32_16x16x32_bf16 v[52:55], a[0:3], a[72:75], v[52:55]
    ds_read_b64_tr_b16 a[70:71], v14 offset:20736
    s_add_u32 s82, s82, s83
    s_mul_i32 s83, s62, 96
    v_mfma_f32_16x16x32_bf16 v[56:59], a[4:7], a[72:75], v[56:59]
    s_add_u32 s82, s82, s83
    s_lshl_b32 s82, s82, 11
    v_mfma_f32_16x16x32_bf16 v[60:63], a[8:11], a[72:75], v[60:63]
    ds_read_b128 a[48:51], v9 offset:8192
    s_sub_u32 s82, s82, 0
    v_add_u32 v19, s82, v36
    v_mfma_f32_16x16x32_bf16 v[64:67], a[12:15], a[72:75], v[64:67]
    v_lshlrev_b32 v36, 1, v34
    v_add_u32 v36, 8, v36
    v_mfma_f32_16x16x32_bf16 v[68:71], a[16:19], a[72:75], v[68:71]
    ds_read_b128 a[52:55], v9 offset:10240
    v_xor_b32 v36, v36, v35
    v_lshlrev_b32 v36, 4, v36
    v_mfma_f32_16x16x32_bf16 v[72:75], a[20:23], a[72:75], v[72:75]
    v_lshl_add_u32 v36, v34, 11, v36
    s_lshl_b32 s82, s60, 14
    v_mfma_f32_16x16x32_bf16 v[76:79], a[24:27], a[72:75], v[76:79]
    s_add_u32 s82, s82, 7168
    v_add_u32 v18, s82, v36
    v_mfma_f32_16x16x32_bf16 v[80:83], a[28:31], a[72:75], v[80:83]
    s_lshl_b32 s82, s62, 1
    s_add_u32 s82, s82, 1
    v_mfma_f32_16x16x32_bf16 v[48:51], a[112:115], a[72:75], v[48:51]
    ds_read_b64_tr_b16 a[72:73], v12 offset:21504
    s_lshl_b32 s82, s82, 3
    s_lshl_b32 s83, s61, 2
    v_mfma_f32_16x16x32_bf16 v[88:91], a[0:3], a[76:79], v[88:91]
    ds_read_b64_tr_b16 a[74:75], v12 offset:21760
    s_add_u32 s82, s82, s83
    s_mul_i32 s83, s62, 96
    v_mfma_f32_16x16x32_bf16 v[92:95], a[4:7], a[76:79], v[92:95]
    ds_read_b128 a[56:59], v9 offset:12288
    s_add_u32 s82, s82, s83
    s_lshl_b32 s82, s82, 11
    v_mfma_f32_16x16x32_bf16 v[96:99], a[8:11], a[76:79], v[96:99]
    s_sub_u32 s82, s82, 1024
    v_add_u32 v20, s82, v36
    v_mfma_f32_16x16x32_bf16 v[100:103], a[12:15], a[76:79], v[100:103]
    ds_read_b128 a[60:63], v9 offset:14336
    v_mfma_f32_16x16x32_bf16 v[104:107], a[16:19], a[76:79], v[104:107]
    v_mfma_f32_16x16x32_bf16 v[108:111], a[20:23], a[76:79], v[108:111]
    v_mfma_f32_16x16x32_bf16 v[112:115], a[24:27], a[76:79], v[112:115]
    v_mfma_f32_16x16x32_bf16 v[116:119], a[28:31], a[76:79], v[116:119]
    ds_read_b128 a[116:119], v11 offset:0
    v_mfma_f32_16x16x32_bf16 v[84:87], a[112:115], a[76:79], v[84:87]
    ds_read_b64_tr_b16 a[76:77], v14 offset:21504
    v_mfma_f32_16x16x32_bf16 a[192:195], a[80:83], a[0:3], a[192:195]
    ds_read_b64_tr_b16 a[78:79], v14 offset:21760
    v_mfma_f32_16x16x32_bf16 a[200:203], a[80:83], a[4:7], a[200:203]
    v_mfma_f32_16x16x32_bf16 a[208:211], a[80:83], a[8:11], a[208:211]
    ds_read_b64_tr_b16 a[104:105], v12 offset:24576
    v_mfma_f32_16x16x32_bf16 a[216:219], a[80:83], a[12:15], a[216:219]
    v_mfma_f32_16x16x32_bf16 a[224:227], a[80:83], a[16:19], a[224:227]
    v_mfma_f32_16x16x32_bf16 a[232:235], a[80:83], a[20:23], a[232:235]
    v_mfma_f32_16x16x32_bf16 a[240:243], a[80:83], a[24:27], a[240:243]
    ds_read_b64_tr_b16 a[106:107], v12 offset:24832
    v_mfma_f32_16x16x32_bf16 a[248:251], a[80:83], a[28:31], a[248:251]
    ds_read_b64_tr_b16 a[80:81], v12 offset:22528
    v_mfma_f32_16x16x32_bf16 a[196:199], a[84:87], a[0:3], a[196:199]
    ds_read_b64_tr_b16 a[82:83], v12 offset:22784
    s_mov_b32 s81, 294912
    s_add_u32 m0, s3, 73728
    v_mfma_f32_16x16x32_bf16 a[204:207], a[84:87], a[4:7], a[204:207]
    buffer_load_dwordx4 v17, s[48:51], s81 offen lds
    v_mfma_f32_16x16x32_bf16 a[212:215], a[84:87], a[8:11], a[212:215]
    ds_read_b64_tr_b16 a[108:109], v14 offset:24576
    v_mfma_f32_16x16x32_bf16 a[220:223], a[84:87], a[12:15], a[220:223]
    v_mfma_f32_16x16x32_bf16 a[228:231], a[84:87], a[16:19], a[228:231]
    v_mfma_f32_16x16x32_bf16 a[236:239], a[84:87], a[20:23], a[236:239]
    v_mfma_f32_16x16x32_bf16 a[244:247], a[84:87], a[24:27], a[244:247]
    ds_read_b64_tr_b16 a[110:111], v14 offset:24832
    buffer_load_dwordx4 v18, s[48:51], s81 offen offset:1024 lds
    v_mfma_f32_16x16x32_bf16 a[252:255], a[84:87], a[28:31], a[252:255]
    ds_read_b64_tr_b16 a[84:85], v14 offset:22528
    v_mfma_f32_16x16x32_bf16 v[128:131], a[88:91], a[0:3], v[128:131]
    ds_read_b64_tr_b16 a[86:87], v14 offset:22784
    v_mfma_f32_16x16x32_bf16 v[144:147], a[88:91], a[4:7], v[144:147]
    v_mfma_f32_16x16x32_bf16 v[160:163], a[88:91], a[8:11], v[160:163]
    s_mov_b32 s80, 524288
    s_add_u32 m0, s3, 81920
    v_mfma_f32_16x16x32_bf16 v[176:179], a[88:91], a[12:15], v[176:179]
    buffer_load_dwordx4 v17, s[48:51], s80 offen lds
    v_mfma_f32_16x16x32_bf16 v[192:195], a[88:91], a[16:19], v[192:195]
    v_mfma_f32_16x16x32_bf16 v[208:211], a[88:91], a[20:23], v[208:211]
    v_mfma_f32_16x16x32_bf16 v[224:227], a[88:91], a[24:27], v[224:227]
    v_mfma_f32_16x16x32_bf16 v[240:243], a[88:91], a[28:31], v[240:243]
    ds_read_b64_tr_b16 a[88:89], v12 offset:23552
    v_mfma_f32_16x16x32_bf16 v[132:135], a[92:95], a[0:3], v[132:135]
    ds_read_b64_tr_b16 a[90:91], v12 offset:23808
    buffer_load_dwordx4 v18, s[48:51], s80 offen offset:1024 lds
    v_mfma_f32_16x16x32_bf16 v[148:151], a[92:95], a[4:7], v[148:151]
    v_mfma_f32_16x16x32_bf16 v[164:167], a[92:95], a[8:11], v[164:167]
    v_mfma_f32_16x16x32_bf16 v[180:183], a[92:95], a[12:15], v[180:183]
    v_mfma_f32_16x16x32_bf16 v[196:199], a[92:95], a[16:19], v[196:199]
    s_mov_b32 s81, 819200
    s_add_u32 m0, s3, 155648
    v_mfma_f32_16x16x32_bf16 v[212:215], a[92:95], a[20:23], v[212:215]
    buffer_load_dwordx4 v17, s[48:51], s81 offen lds
    v_mfma_f32_16x16x32_bf16 v[228:231], a[92:95], a[24:27], v[228:231]
    v_mfma_f32_16x16x32_bf16 v[244:247], a[92:95], a[28:31], v[244:247]
    ds_read_b64_tr_b16 a[92:93], v14 offset:23552
    v_mfma_f32_16x16x32_bf16 v[136:139], a[96:99], a[0:3], v[136:139]
    ds_read_b64_tr_b16 a[94:95], v14 offset:23808
    v_mfma_f32_16x16x32_bf16 v[152:155], a[96:99], a[4:7], v[152:155]
    v_mfma_f32_16x16x32_bf16 v[168:171], a[96:99], a[8:11], v[168:171]
    buffer_load_dwordx4 v18, s[48:51], s81 offen offset:1024 lds
    v_mfma_f32_16x16x32_bf16 v[184:187], a[96:99], a[12:15], v[184:187]
    v_mfma_f32_16x16x32_bf16 v[200:203], a[96:99], a[16:19], v[200:203]
    v_mfma_f32_16x16x32_bf16 v[216:219], a[96:99], a[20:23], v[216:219]
    v_mfma_f32_16x16x32_bf16 v[232:235], a[96:99], a[24:27], v[232:235]
    v_mfma_f32_16x16x32_bf16 v[248:251], a[96:99], a[28:31], v[248:251]
    v_mfma_f32_16x16x32_bf16 v[140:143], a[100:103], a[0:3], v[140:143]
    v_mfma_f32_16x16x32_bf16 v[156:159], a[100:103], a[4:7], v[156:159]
    v_mfma_f32_16x16x32_bf16 v[172:175], a[100:103], a[8:11], v[172:175]
    v_mfma_f32_16x16x32_bf16 v[188:191], a[100:103], a[12:15], v[188:191]
    v_mfma_f32_16x16x32_bf16 v[204:207], a[100:103], a[16:19], v[204:207]
    v_mfma_f32_16x16x32_bf16 v[220:223], a[100:103], a[20:23], v[220:223]
    v_mfma_f32_16x16x32_bf16 v[236:239], a[100:103], a[24:27], v[236:239]
    v_mfma_f32_16x16x32_bf16 v[252:255], a[100:103], a[28:31], v[252:255]
    s_waitcnt vmcnt(7) lgkmcnt(0)
    s_barrier
    v_mfma_f32_16x16x32_bf16 a[128:131], a[64:67], a[32:35], a[128:131]
    v_mfma_f32_16x16x32_bf16 a[136:139], a[64:67], a[36:39], a[136:139]
    v_mfma_f32_16x16x32_bf16 a[144:147], a[64:67], a[40:43], a[144:147]
    ds_read_b128 a[0:3], v8 offset:34816
    s_mov_b32 s80, 0
    s_add_u32 m0, s3, 0
    v_mfma_f32_16x16x32_bf16 a[152:155], a[64:67], a[44:47], a[152:155]
    buffer_load_dwordx4 v17, s[48:51], s80 offen lds
    v_mfma_f32_16x16x32_bf16 a[160:163], a[64:67], a[48:51], a[160:163]
    s_xor_b32 s82, s65, 0
    v_mfma_f32_16x16x32_bf16 a[168:171], a[64:67], a[52:55], a[168:171]
    s_lshl_b32 s82, s82, 10
    v_mfma_f32_16x16x32_bf16 a[176:179], a[64:67], a[56:59], a[176:179]
    ds_read_b128 a[4:7], v8 offset:36864
    v_add_u32 v21, s82, v16
    v_mfma_f32_16x16x32_bf16 a[184:187], a[64:67], a[60:63], a[184:187]
    s_xor_b32 s82, s65, 1
    v_mfma_f32_16x16x32_bf16 v[120:123], a[64:67], a[116:119], v[120:123]
    ds_read_b64_tr_b16 a[64:65], v13 offset:0
    s_lshl_b32 s82, s82, 10
    v_mfma_f32_16x16x32_bf16 a[132:135], a[68:71], a[32:35], a[132:135]
    ds_read_b64_tr_b16 a[66:67], v13 offset:256
    v_add_u32 v22, s82, v16
    buffer_load_dwordx4 v18, s[48:51], s80 offen offset:1024 lds
    v_mfma_f32_16x16x32_bf16 a[140:143], a[68:71], a[36:39], a[140:143]
    ds_read_b128 a[8:11], v8 offset:38912
    s_xor_b32 s82, s65, 2
    v_mfma_f32_16x16x32_bf16 a[148:151], a[68:71], a[40:43], a[148:151]
    s_lshl_b32 s82, s82, 10
    v_mfma_f32_16x16x32_bf16 a[156:159], a[68:71], a[44:47], a[156:159]
    v_add_u32 v23, s82, v16
    v_mfma_f32_16x16x32_bf16 a[164:167], a[68:71], a[48:51], a[164:167]
    s_xor_b32 s82, s65, 3
    v_mfma_f32_16x16x32_bf16 a[172:175], a[68:71], a[52:55], a[172:175]
    ds_read_b128 a[12:15], v8 offset:40960
    s_lshl_b32 s82, s82, 10
    s_mov_b32 s81, 229376
    s_add_u32 m0, s3, 8192
    v_mfma_f32_16x16x32_bf16 a[180:183], a[68:71], a[56:59], a[180:183]
    v_add_u32 v24, s82, v16
    buffer_load_dwordx4 v17, s[48:51], s81 offen lds
    v_mfma_f32_16x16x32_bf16 a[188:191], a[68:71], a[60:63], a[188:191]
    s_mov_b32 s94, 0xbdd2d3e8
    v_mfma_f32_16x16x32_bf16 v[124:127], a[68:71], a[116:119], v[124:127]
    ds_read_b64_tr_b16 a[68:69], v15 offset:0
    s_mov_b32 s95, 0xbdd2d3e8
    v_mfma_f32_16x16x32_bf16 v[52:55], a[32:35], a[72:75], v[52:55]
    ds_read_b64_tr_b16 a[70:71], v15 offset:256
    v_mov_b32 v26, 0xc0135761
    v_mfma_f32_16x16x32_bf16 v[56:59], a[36:39], a[72:75], v[56:59]
    v_mov_b32 v27, 0xc0135761
    v_mfma_f32_16x16x32_bf16 v[60:63], a[40:43], a[72:75], v[60:63]
    ds_read_b128 a[16:19], v8 offset:43008
    v_mov_b32 v25, 1
    v_mfma_f32_16x16x32_bf16 v[64:67], a[44:47], a[72:75], v[64:67]
    s_lshl_b32 s82, s60, 12
    buffer_load_dwordx4 v18, s[48:51], s81 offen offset:1024 lds
    v_mfma_f32_16x16x32_bf16 v[68:71], a[48:51], a[72:75], v[68:71]
    ds_read_b128 a[20:23], v8 offset:45056
    s_add_u32 s68, s88, s82
    v_mfma_f32_16x16x32_bf16 v[72:75], a[52:55], a[72:75], v[72:75]
    s_lshl_b32 s82, s61, 13
    v_mfma_f32_16x16x32_bf16 v[76:79], a[56:59], a[72:75], v[76:79]
    s_add_u32 s88, s88, s82
    v_mfma_f32_16x16x32_bf16 v[80:83], a[60:63], a[72:75], v[80:83]
    s_lshr_b32 s82, s66, 1
    v_mfma_f32_16x16x32_bf16 v[48:51], a[116:119], a[72:75], v[48:51]
    ds_read_b64_tr_b16 a[72:73], v13 offset:1024
    s_add_u32 s82, s82, 24
    s_mov_b32 s80, 458752
    s_add_u32 m0, s3, 16384
    v_mfma_f32_16x16x32_bf16 v[88:91], a[32:35], a[76:79], v[88:91]
    ds_read_b64_tr_b16 a[74:75], v13 offset:1280
    s_lshl_b32 s82, s82, 14
    buffer_load_dwordx4 v17, s[48:51], s80 offen lds
    v_mfma_f32_16x16x32_bf16 v[92:95], a[36:39], a[76:79], v[92:95]
    ds_read_b128 a[24:27], v8 offset:47104
    s_add_u32 s90, s88, s82
    v_mfma_f32_16x16x32_bf16 v[96:99], a[40:43], a[76:79], v[96:99]
    s_lshl_b32 s82, s66, 14
    v_mfma_f32_16x16x32_bf16 v[100:103], a[44:47], a[76:79], v[100:103]
    ds_read_b128 a[28:31], v8 offset:49152
    s_add_u32 s88, s88, s82
    v_mfma_f32_16x16x32_bf16 v[104:107], a[48:51], a[76:79], v[104:107]
    s_add_u32 s89, s88, 262144
    v_mfma_f32_16x16x32_bf16 v[108:111], a[52:55], a[76:79], v[108:111]
    s_mov_b32 s76, s93
    v_mfma_f32_16x16x32_bf16 v[112:115], a[56:59], a[76:79], v[112:115]
    s_lshl_b32 s82, s63, 4
    buffer_load_dwordx4 v18, s[48:51], s80 offen offset:1024 lds
    v_mfma_f32_16x16x32_bf16 v[116:119], a[60:63], a[76:79], v[116:119]
    ds_read_b128 a[112:115], v10 offset:34816
    s_lshl_b32 s83, s61, 3
    v_mfma_f32_16x16x32_bf16 v[84:87], a[116:119], a[76:79], v[84:87]
    ds_read_b64_tr_b16 a[76:77], v15 offset:1024
    s_add_u32 s83, s83, s82
    v_mfma_f32_16x16x32_bf16 a[192:195], a[80:83], a[32:35], a[192:195]
    ds_read_b64_tr_b16 a[78:79], v15 offset:1280
    s_add_u32 s83, s83, s65
    v_mfma_f32_16x16x32_bf16 a[200:203], a[80:83], a[36:39], a[200:203]
    s_lshl_b32 s83, s83, 15
    v_mfma_f32_16x16x32_bf16 a[208:211], a[80:83], a[40:43], a[208:211]
    ds_read_b64_tr_b16 a[96:97], v13 offset:4096
    s_add_u32 s69, s83, 4194304
    s_mov_b32 s81, 688128
    s_add_u32 m0, s3, 24576
    v_mfma_f32_16x16x32_bf16 a[216:219], a[80:83], a[44:47], a[216:219]
    s_lshl_b32 s84, s63, 3
    buffer_load_dwordx4 v17, s[48:51], s81 offen lds
    v_mfma_f32_16x16x32_bf16 a[224:227], a[80:83], a[48:51], a[224:227]
    s_add_u32 s84, s84, s66
    v_mfma_f32_16x16x32_bf16 a[232:235], a[80:83], a[52:55], a[232:235]
    s_lshl_b32 s85, s84, 2
    v_mfma_f32_16x16x32_bf16 a[240:243], a[80:83], a[56:59], a[240:243]
    ds_read_b64_tr_b16 a[98:99], v13 offset:4352
    s_add_u32 s85, s85, s60
    v_mfma_f32_16x16x32_bf16 a[248:251], a[80:83], a[60:63], a[248:251]
    ds_read_b64_tr_b16 a[80:81], v13 offset:2048
    s_lshl_b32 s85, s85, 8
    v_mfma_f32_16x16x32_bf16 a[196:199], a[84:87], a[32:35], a[196:199]
    ds_read_b64_tr_b16 a[82:83], v13 offset:2304
    s_add_u32 s77, s85, 39862272
    v_mfma_f32_16x16x32_bf16 a[204:207], a[84:87], a[36:39], a[204:207]
    s_lshl_b32 s84, s84, 18
    buffer_load_dwordx4 v18, s[48:51], s81 offen offset:1024 lds
    v_mfma_f32_16x16x32_bf16 a[212:215], a[84:87], a[40:43], a[212:215]
    ds_read_b64_tr_b16 a[100:101], v15 offset:4096
    s_lshl_b32 s85, s60, 12
    v_mfma_f32_16x16x32_bf16 a[220:223], a[84:87], a[44:47], a[220:223]
    s_add_u32 s84, s84, s85
    v_mfma_f32_16x16x32_bf16 a[228:231], a[84:87], a[48:51], a[228:231]
    s_add_u32 s84, s84, 23068672
    v_mfma_f32_16x16x32_bf16 a[236:239], a[84:87], a[52:55], a[236:239]
    s_xor_b32 s85, s65, 1
    v_mfma_f32_16x16x32_bf16 a[244:247], a[84:87], a[56:59], a[244:247]
    ds_read_b64_tr_b16 a[102:103], v15 offset:4352
    s_lshl_b32 s85, s85, 16
    s_mov_b32 s81, 753664
    s_add_u32 m0, s3, 90112
    v_mfma_f32_16x16x32_bf16 a[252:255], a[84:87], a[60:63], a[252:255]
    ds_read_b64_tr_b16 a[84:85], v15 offset:2048
    s_add_u32 s70, s84, s85
    buffer_load_dwordx4 v17, s[48:51], s81 offen lds
    v_mfma_f32_16x16x32_bf16 v[128:131], a[88:91], a[32:35], v[128:131]
    ds_read_b64_tr_b16 a[86:87], v15 offset:2304
    s_add_u32 s70, s70, 16384
    v_mfma_f32_16x16x32_bf16 v[144:147], a[88:91], a[36:39], v[144:147]
    s_lshl_b32 s85, s65, 16
    v_mfma_f32_16x16x32_bf16 v[160:163], a[88:91], a[40:43], v[160:163]
    s_add_u32 s73, s84, s85
    v_mfma_f32_16x16x32_bf16 v[176:179], a[88:91], a[44:47], v[176:179]
    v_mfma_f32_16x16x32_bf16 v[192:195], a[88:91], a[48:51], v[192:195]
    v_mfma_f32_16x16x32_bf16 v[208:211], a[88:91], a[52:55], v[208:211]
    buffer_load_dwordx4 v18, s[48:51], s81 offen offset:1024 lds
    v_mfma_f32_16x16x32_bf16 v[224:227], a[88:91], a[56:59], v[224:227]
    v_mfma_f32_16x16x32_bf16 v[240:243], a[88:91], a[60:63], v[240:243]
    ds_read_b64_tr_b16 a[88:89], v13 offset:3072
    v_mfma_f32_16x16x32_bf16 v[132:135], a[92:95], a[32:35], v[132:135]
    ds_read_b64_tr_b16 a[90:91], v13 offset:3328
    v_mfma_f32_16x16x32_bf16 v[148:151], a[92:95], a[36:39], v[148:151]
    v_mfma_f32_16x16x32_bf16 v[164:167], a[92:95], a[40:43], v[164:167]
    s_mov_b32 s80, 983040
    s_add_u32 m0, s3, 98304
    v_mfma_f32_16x16x32_bf16 v[180:183], a[92:95], a[44:47], v[180:183]
    buffer_load_dwordx4 v17, s[48:51], s80 offen lds
    v_mfma_f32_16x16x32_bf16 v[196:199], a[92:95], a[48:51], v[196:199]
    v_mfma_f32_16x16x32_bf16 v[212:215], a[92:95], a[52:55], v[212:215]
    v_mfma_f32_16x16x32_bf16 v[228:231], a[92:95], a[56:59], v[228:231]
    v_mfma_f32_16x16x32_bf16 v[244:247], a[92:95], a[60:63], v[244:247]
    ds_read_b64_tr_b16 a[92:93], v15 offset:3072
    v_mfma_f32_16x16x32_bf16 v[136:139], a[104:107], a[32:35], v[136:139]
    ds_read_b64_tr_b16 a[94:95], v15 offset:3328
    v_mfma_f32_16x16x32_bf16 v[152:155], a[104:107], a[36:39], v[152:155]
    buffer_load_dwordx4 v18, s[48:51], s80 offen offset:1024 lds
    v_mfma_f32_16x16x32_bf16 v[168:171], a[104:107], a[40:43], v[168:171]
    v_mfma_f32_16x16x32_bf16 v[184:187], a[104:107], a[44:47], v[184:187]
    v_mfma_f32_16x16x32_bf16 v[200:203], a[104:107], a[48:51], v[200:203]
    v_mfma_f32_16x16x32_bf16 v[216:219], a[104:107], a[52:55], v[216:219]
    v_mfma_f32_16x16x32_bf16 v[232:235], a[104:107], a[56:59], v[232:235]
    v_mfma_f32_16x16x32_bf16 v[248:251], a[104:107], a[60:63], v[248:251]
    v_mfma_f32_16x16x32_bf16 v[140:143], a[108:111], a[32:35], v[140:143]
    v_mfma_f32_16x16x32_bf16 v[156:159], a[108:111], a[36:39], v[156:159]
    v_mfma_f32_16x16x32_bf16 v[172:175], a[108:111], a[40:43], v[172:175]
    v_mfma_f32_16x16x32_bf16 v[188:191], a[108:111], a[44:47], v[188:191]
    v_mfma_f32_16x16x32_bf16 v[204:207], a[108:111], a[48:51], v[204:207]
    v_mfma_f32_16x16x32_bf16 v[220:223], a[108:111], a[52:55], v[220:223]
    v_mfma_f32_16x16x32_bf16 v[236:239], a[108:111], a[56:59], v[236:239]
    v_mfma_f32_16x16x32_bf16 v[252:255], a[108:111], a[60:63], v[252:255]
    s_waitcnt lgkmcnt(0)
    s_barrier
    v_mfma_f32_16x16x32_bf16 a[128:131], a[64:67], a[0:3], a[128:131]
    v_mfma_f32_16x16x32_bf16 a[136:139], a[64:67], a[4:7], a[136:139]
    v_mfma_f32_16x16x32_bf16 a[144:147], a[64:67], a[8:11], a[144:147]
    ds_read_b128 a[32:35], v9 offset:34816
    s_mov_b32 s81, 1212416
    s_add_u32 m0, s3, 106496
    v_mfma_f32_16x16x32_bf16 a[152:155], a[64:67], a[12:15], a[152:155]
    buffer_load_dwordx4 v17, s[48:51], s81 offen lds
    v_mfma_f32_16x16x32_bf16 a[160:163], a[64:67], a[16:19], a[160:163]
    s_add_u32 s73, s73, 16384
    v_mfma_f32_16x16x32_bf16 a[168:171], a[64:67], a[20:23], a[168:171]
    s_xor_b32 s85, s65, 2
    v_mfma_f32_16x16x32_bf16 a[176:179], a[64:67], a[24:27], a[176:179]
    ds_read_b128 a[36:39], v9 offset:36864
    s_lshl_b32 s85, s85, 16
    v_mfma_f32_16x16x32_bf16 a[184:187], a[64:67], a[28:31], a[184:187]
    s_add_u32 s71, s84, s85
    v_mfma_f32_16x16x32_bf16 v[120:123], a[64:67], a[112:115], v[120:123]
    ds_read_b64_tr_b16 a[64:65], v13 offset:20480
    s_add_u32 s71, s71, 32768
    v_mfma_f32_16x16x32_bf16 a[132:135], a[68:71], a[0:3], a[132:135]
    ds_read_b64_tr_b16 a[66:67], v13 offset:20736
    s_lshl_b32 s85, s65, 16
    v_mfma_f32_16x16x32_bf16 a[140:143], a[68:71], a[4:7], a[140:143]
    ds_read_b128 a[40:43], v9 offset:38912
    s_add_u32 s74, s84, s85
    v_mfma_f32_16x16x32_bf16 a[148:151], a[68:71], a[8:11], a[148:151]
    s_add_u32 s74, s74, 32768
    v_mfma_f32_16x16x32_bf16 a[156:159], a[68:71], a[12:15], a[156:159]
    s_xor_b32 s85, s65, 3
    v_mfma_f32_16x16x32_bf16 a[164:167], a[68:71], a[16:19], a[164:167]
    s_lshl_b32 s85, s85, 16
    v_mfma_f32_16x16x32_bf16 a[172:175], a[68:71], a[20:23], a[172:175]
    ds_read_b128 a[44:47], v9 offset:40960
    s_add_u32 s72, s84, s85
    v_mfma_f32_16x16x32_bf16 a[180:183], a[68:71], a[24:27], a[180:183]
    s_add_u32 s72, s72, 49152
    buffer_load_dwordx4 v18, s[48:51], s81 offen offset:1024 lds
    v_mfma_f32_16x16x32_bf16 a[188:191], a[68:71], a[28:31], a[188:191]
    s_lshl_b32 s85, s65, 16
    v_mfma_f32_16x16x32_bf16 v[124:127], a[68:71], a[112:115], v[124:127]
    ds_read_b64_tr_b16 a[68:69], v15 offset:20480
    s_add_u32 s75, s84, s85
    v_mfma_f32_16x16x32_bf16 v[52:55], a[0:3], a[72:75], v[52:55]
    ds_read_b64_tr_b16 a[70:71], v15 offset:20736
    s_add_u32 s75, s75, 49152
    v_mfma_f32_16x16x32_bf16 v[56:59], a[4:7], a[72:75], v[56:59]
    s_lshl_b32 s83, s61, 3
    v_mfma_f32_16x16x32_bf16 v[60:63], a[8:11], a[72:75], v[60:63]
    ds_read_b128 a[48:51], v9 offset:43008
    s_add_u32 s82, s82, s83
    v_mfma_f32_16x16x32_bf16 v[64:67], a[12:15], a[72:75], v[64:67]
    s_lshl_b32 s82, s82, 5
    v_mfma_f32_16x16x32_bf16 v[68:71], a[16:19], a[72:75], v[68:71]
    ds_read_b128 a[52:55], v9 offset:45056
    s_add_u32 s82, s82, s64
    v_mfma_f32_16x16x32_bf16 v[72:75], a[20:23], a[72:75], v[72:75]
    s_lshl_b32 s82, s82, 10
    v_mfma_f32_16x16x32_bf16 v[76:79], a[24:27], a[72:75], v[76:79]
    s_add_u32 s91, s82, 4194304
    v_mfma_f32_16x16x32_bf16 v[80:83], a[28:31], a[72:75], v[80:83]
    v_mov_b32 v42, 1
    v_mfma_f32_16x16x32_bf16 v[48:51], a[112:115], a[72:75], v[48:51]
    ds_read_b64_tr_b16 a[72:73], v13 offset:21504
    v_and_b32 v37, 1, v35
    s_mov_b32 s80, 1441792
    s_add_u32 m0, s3, 114688
    v_mfma_f32_16x16x32_bf16 v[88:91], a[0:3], a[76:79], v[88:91]
    ds_read_b64_tr_b16 a[74:75], v13 offset:21760
    v_lshl_add_u32 v36, v34, 2, v37
    buffer_load_dwordx4 v17, s[48:51], s80 offen lds
    v_mfma_f32_16x16x32_bf16 v[92:95], a[4:7], a[76:79], v[92:95]
    ds_read_b128 a[56:59], v9 offset:47104
    v_cmp_le_u32 s[4:5], v36, v35
    v_mfma_f32_16x16x32_bf16 v[96:99], a[8:11], a[76:79], v[96:99]
    v_add_u32 v36, 2, v36
    v_mfma_f32_16x16x32_bf16 v[100:103], a[12:15], a[76:79], v[100:103]
    ds_read_b128 a[60:63], v9 offset:49152
    v_cmp_le_u32 s[6:7], v36, v35
    v_mfma_f32_16x16x32_bf16 v[104:107], a[16:19], a[76:79], v[104:107]
    v_mul_u32_u24 v36, 0x0202, v37
    v_mfma_f32_16x16x32_bf16 v[108:111], a[20:23], a[76:79], v[108:111]
    v_lshlrev_b32 v36, 16, v36
    v_mfma_f32_16x16x32_bf16 v[112:115], a[24:27], a[76:79], v[112:115]
    v_add_u32 v36, 0x01000c0c, v36
    v_mfma_f32_16x16x32_bf16 v[116:119], a[28:31], a[76:79], v[116:119]
    ds_read_b128 a[116:119], v11 offset:34816
    v_add_u32 v38, 0x04040000, v36
    v_mfma_f32_16x16x32_bf16 v[84:87], a[112:115], a[76:79], v[84:87]
    ds_read_b64_tr_b16 a[76:77], v15 offset:21504
    v_cndmask_b32 v28, v36, v38, s[4:5]
    v_mfma_f32_16x16x32_bf16 a[192:195], a[80:83], a[0:3], a[192:195]
    ds_read_b64_tr_b16 a[78:79], v15 offset:21760
    v_cndmask_b32 v29, v36, v38, s[6:7]
    v_mfma_f32_16x16x32_bf16 a[200:203], a[80:83], a[4:7], a[200:203]
    v_cmp_eq_u32 vcc, 1, v37
    v_mfma_f32_16x16x32_bf16 a[208:211], a[80:83], a[8:11], a[208:211]
    ds_read_b64_tr_b16 a[104:105], v13 offset:24576
    v_mov_b32 v36, 0x0c0c0100
    v_mfma_f32_16x16x32_bf16 a[216:219], a[80:83], a[12:15], a[216:219]
    v_mov_b32 v38, 0x01000c0c
    buffer_load_dwordx4 v18, s[48:51], s80 offen offset:1024 lds
    v_mfma_f32_16x16x32_bf16 a[224:227], a[80:83], a[16:19], a[224:227]
    v_cndmask_b32 v36, v36, v38, vcc
    v_mfma_f32_16x16x32_bf16 a[232:235], a[80:83], a[20:23], a[232:235]
    v_mov_b32 v38, 0x0c0c0302
    v_mfma_f32_16x16x32_bf16 a[240:243], a[80:83], a[24:27], a[240:243]
    ds_read_b64_tr_b16 a[106:107], v13 offset:24832
    v_mov_b32 v39, 0x03020c0c
    v_mfma_f32_16x16x32_bf16 a[248:251], a[80:83], a[28:31], a[248:251]
    ds_read_b64_tr_b16 a[80:81], v13 offset:22528
    v_cndmask_b32 v38, v38, v39, vcc
    v_mfma_f32_16x16x32_bf16 a[196:199], a[84:87], a[0:3], a[196:199]
    ds_read_b64_tr_b16 a[82:83], v13 offset:22784
    v_mov_b32 v39, 0x0c0c0c0c
    v_mfma_f32_16x16x32_bf16 a[204:207], a[84:87], a[4:7], a[204:207]
    s_branch L_over1
L_stub1:
    s_branch L_stub5
L_over1:
    v_cndmask_b32 v30, v36, v39, s[4:5]
    v_mfma_f32_16x16x32_bf16 a[212:215], a[84:87], a[8:11], a[212:215]
    ds_read_b64_tr_b16 a[108:109], v15 offset:24576
    v_cndmask_b32 v31, v38, v39, s[6:7]
    v_mfma_f32_16x16x32_bf16 a[220:223], a[84:87], a[12:15], a[220:223]
    v_cndmask_b32 v32, v39, v36, s[4:5]
    v_mfma_f32_16x16x32_bf16 a[228:231], a[84:87], a[16:19], a[228:231]
    v_cndmask_b32 v33, v39, v38, s[6:7]
    v_mfma_f32_16x16x32_bf16 a[236:239], a[84:87], a[20:23], a[236:239]
    s_or_b32 s82, s63, s61
    v_mfma_f32_16x16x32_bf16 a[244:247], a[84:87], a[24:27], a[244:247]
    ds_read_b64_tr_b16 a[110:111], v15 offset:24832
    s_cmp_eq_u32 s82, 0
    s_cselect_b64 s[4:5], s[4:5], -1
    s_cselect_b64 s[6:7], s[6:7], -1
    s_mov_b32 s81, 1671168
    s_add_u32 m0, s3, 122880
    v_mfma_f32_16x16x32_bf16 a[252:255], a[84:87], a[28:31], a[252:255]
    ds_read_b64_tr_b16 a[84:85], v15 offset:22528
    s_mov_b32 s14, 0x3e3504f3
    buffer_load_dwordx4 v17, s[48:51], s81 offen lds
    v_mfma_f32_16x16x32_bf16 v[128:131], a[88:91], a[0:3], v[128:131]
    ds_read_b64_tr_b16 a[86:87], v15 offset:22784
    s_mov_b32 s15, 0x3e3504f3
    v_mfma_f32_16x16x32_bf16 v[144:147], a[88:91], a[4:7], v[144:147]
    s_mov_b32 s98, 0x3fb8aa3b
    v_mfma_f32_16x16x32_bf16 v[160:163], a[88:91], a[8:11], v[160:163]
    s_mov_b32 s99, 0x3fb8aa3b
    v_mfma_f32_16x16x32_bf16 v[176:179], a[88:91], a[12:15], v[176:179]
    v_mfma_f32_16x16x32_bf16 v[192:195], a[88:91], a[16:19], v[192:195]
    v_mfma_f32_16x16x32_bf16 v[208:211], a[88:91], a[20:23], v[208:211]
    v_mfma_f32_16x16x32_bf16 v[224:227], a[88:91], a[24:27], v[224:227]
    v_mfma_f32_16x16x32_bf16 v[240:243], a[88:91], a[28:31], v[240:243]
    ds_read_b64_tr_b16 a[88:89], v13 offset:23552
    v_mfma_f32_16x16x32_bf16 v[132:135], a[92:95], a[0:3], v[132:135]
    ds_read_b64_tr_b16 a[90:91], v13 offset:23808
    v_mfma_f32_16x16x32_bf16 v[148:151], a[92:95], a[4:7], v[148:151]
    v_mfma_f32_16x16x32_bf16 v[164:167], a[92:95], a[8:11], v[164:167]
    v_mfma_f32_16x16x32_bf16 v[180:183], a[92:95], a[12:15], v[180:183]
    buffer_load_dwordx4 v18, s[48:51], s81 offen offset:1024 lds
    v_mfma_f32_16x16x32_bf16 v[196:199], a[92:95], a[16:19], v[196:199]
    v_mfma_f32_16x16x32_bf16 v[212:215], a[92:95], a[20:23], v[212:215]
    v_mfma_f32_16x16x32_bf16 v[228:231], a[92:95], a[24:27], v[228:231]
    v_mfma_f32_16x16x32_bf16 v[244:247], a[92:95], a[28:31], v[244:247]
    ds_read_b64_tr_b16 a[92:93], v15 offset:23552
    v_mfma_f32_16x16x32_bf16 v[136:139], a[96:99], a[0:3], v[136:139]
    ds_read_b64_tr_b16 a[94:95], v15 offset:23808
    v_mfma_f32_16x16x32_bf16 v[152:155], a[96:99], a[4:7], v[152:155]
    v_mfma_f32_16x16x32_bf16 v[168:171], a[96:99], a[8:11], v[168:171]
    v_mfma_f32_16x16x32_bf16 v[184:187], a[96:99], a[12:15], v[184:187]
    v_mfma_f32_16x16x32_bf16 v[200:203], a[96:99], a[16:19], v[200:203]
    v_mfma_f32_16x16x32_bf16 v[216:219], a[96:99], a[20:23], v[216:219]
    v_mfma_f32_16x16x32_bf16 v[232:235], a[96:99], a[24:27], v[232:235]
    v_mfma_f32_16x16x32_bf16 v[248:251], a[96:99], a[28:31], v[248:251]
    v_mfma_f32_16x16x32_bf16 v[140:143], a[100:103], a[0:3], v[140:143]
    v_mfma_f32_16x16x32_bf16 v[156:159], a[100:103], a[4:7], v[156:159]
    v_mfma_f32_16x16x32_bf16 v[172:175], a[100:103], a[8:11], v[172:175]
    v_mfma_f32_16x16x32_bf16 v[188:191], a[100:103], a[12:15], v[188:191]
    v_mfma_f32_16x16x32_bf16 v[204:207], a[100:103], a[16:19], v[204:207]
    v_mfma_f32_16x16x32_bf16 v[220:223], a[100:103], a[20:23], v[220:223]
    v_mfma_f32_16x16x32_bf16 v[236:239], a[100:103], a[24:27], v[236:239]
    v_mfma_f32_16x16x32_bf16 v[252:255], a[100:103], a[28:31], v[252:255]
    s_waitcnt lgkmcnt(0)
    s_barrier
    v_mfma_f32_16x16x32_bf16 a[128:131], a[64:67], a[32:35], a[128:131]
    v_mfma_f32_16x16x32_bf16 a[136:139], a[64:67], a[36:39], a[136:139]
    v_mfma_f32_16x16x32_bf16 a[144:147], a[64:67], a[40:43], a[144:147]
    s_mov_b32 s80, 917504
    s_add_u32 m0, s3, 32768
    v_mfma_f32_16x16x32_bf16 a[152:155], a[64:67], a[44:47], a[152:155]
    buffer_load_dwordx4 v17, s[48:51], s80 offen lds
    v_mfma_f32_16x16x32_bf16 a[160:163], a[64:67], a[48:51], a[160:163]
    v_lshrrev_b32 v34, 2, v0
    v_mfma_f32_16x16x32_bf16 a[168:171], a[64:67], a[52:55], a[168:171]
    v_and_b32 v35, 3, v0
    v_mfma_f32_16x16x32_bf16 a[176:179], a[64:67], a[56:59], a[176:179]
    v_lshlrev_b32 v35, 3, v35
    v_mfma_f32_16x16x32_bf16 a[184:187], a[64:67], a[60:63], a[184:187]
    buffer_load_dwordx4 v18, s[48:51], s80 offen offset:1024 lds
    v_lshl_add_u32 v35, v34, 8, v35
    v_mfma_f32_16x16x32_bf16 v[120:123], a[64:67], a[116:119], v[120:123]
    v_and_b32 v34, 7, v34
    v_mfma_f32_16x16x32_bf16 a[132:135], a[68:71], a[32:35], a[132:135]
    v_xor_b32 v36, 0, v34
    v_mfma_f32_16x16x32_bf16 a[140:143], a[68:71], a[36:39], a[140:143]
    v_lshl_add_u32 v8, v36, 5, v35
    v_mfma_f32_16x16x32_bf16 a[148:151], a[68:71], a[40:43], a[148:151]
    s_mov_b32 s81, 1146880
    s_add_u32 m0, s3, 40960
    v_xor_b32 v36, 1, v34
    v_mfma_f32_16x16x32_bf16 a[156:159], a[68:71], a[44:47], a[156:159]
    buffer_load_dwordx4 v17, s[48:51], s81 offen lds
    v_lshl_add_u32 v9, v36, 5, v35
    v_mfma_f32_16x16x32_bf16 a[164:167], a[68:71], a[48:51], a[164:167]
    v_xor_b32 v36, 2, v34
    v_mfma_f32_16x16x32_bf16 a[172:175], a[68:71], a[52:55], a[172:175]
    v_lshl_add_u32 v10, v36, 5, v35
    v_mfma_f32_16x16x32_bf16 a[180:183], a[68:71], a[56:59], a[180:183]
    v_xor_b32 v36, 3, v34
    v_mfma_f32_16x16x32_bf16 a[188:191], a[68:71], a[60:63], a[188:191]
    buffer_load_dwordx4 v18, s[48:51], s81 offen offset:1024 lds
    v_lshl_add_u32 v11, v36, 5, v35
    v_mfma_f32_16x16x32_bf16 v[124:127], a[68:71], a[116:119], v[124:127]
    v_xor_b32 v36, 4, v34
    v_mfma_f32_16x16x32_bf16 v[52:55], a[32:35], a[72:75], v[52:55]
    v_lshl_add_u32 v12, v36, 5, v35
    v_mfma_f32_16x16x32_bf16 v[56:59], a[36:39], a[72:75], v[56:59]
    v_xor_b32 v36, 5, v34
    v_mfma_f32_16x16x32_bf16 v[60:63], a[40:43], a[72:75], v[60:63]
    s_mov_b32 s80, 1376256
    s_add_u32 m0, s3, 49152
    v_lshl_add_u32 v13, v36, 5, v35
    v_mfma_f32_16x16x32_bf16 v[64:67], a[44:47], a[72:75], v[64:67]
    buffer_load_dwordx4 v17, s[48:51], s80 offen lds
    v_xor_b32 v36, 6, v34
    v_mfma_f32_16x16x32_bf16 v[68:71], a[48:51], a[72:75], v[68:71]
    v_lshl_add_u32 v14, v36, 5, v35
    v_mfma_f32_16x16x32_bf16 v[72:75], a[52:55], a[72:75], v[72:75]
    v_xor_b32 v36, 7, v34
    v_mfma_f32_16x16x32_bf16 v[76:79], a[56:59], a[72:75], v[76:79]
    v_lshl_add_u32 v15, v36, 5, v35
    v_mfma_f32_16x16x32_bf16 v[80:83], a[60:63], a[72:75], v[80:83]
    buffer_load_dwordx4 v18, s[48:51], s80 offen offset:1024 lds
    v_mfma_f32_16x16x32_bf16 v[48:51], a[116:119], a[72:75], v[48:51]
    v_mfma_f32_16x16x32_bf16 v[88:91], a[32:35], a[76:79], v[88:91]
    v_mfma_f32_16x16x32_bf16 v[92:95], a[36:39], a[76:79], v[92:95]
    v_mfma_f32_16x16x32_bf16 v[96:99], a[40:43], a[76:79], v[96:99]
    s_mov_b32 s81, 1605632
    s_add_u32 m0, s3, 57344
    v_mfma_f32_16x16x32_bf16 v[100:103], a[44:47], a[76:79], v[100:103]
    buffer_load_dwordx4 v17, s[48:51], s81 offen lds
    v_mfma_f32_16x16x32_bf16 v[104:107], a[48:51], a[76:79], v[104:107]
    v_mfma_f32_16x16x32_bf16 v[108:111], a[52:55], a[76:79], v[108:111]
    v_mfma_f32_16x16x32_bf16 v[112:115], a[56:59], a[76:79], v[112:115]
    v_mfma_f32_16x16x32_bf16 v[116:119], a[60:63], a[76:79], v[116:119]
    buffer_load_dwordx4 v18, s[48:51], s81 offen offset:1024 lds
    v_mfma_f32_16x16x32_bf16 v[84:87], a[116:119], a[76:79], v[84:87]
    v_mfma_f32_16x16x32_bf16 a[192:195], a[80:83], a[32:35], a[192:195]
    v_mfma_f32_16x16x32_bf16 a[200:203], a[80:83], a[36:39], a[200:203]
    v_mfma_f32_16x16x32_bf16 a[208:211], a[80:83], a[40:43], a[208:211]
    s_mov_b32 s80, 65536
    s_add_u32 m0, s3, 65536
    v_mfma_f32_16x16x32_bf16 a[216:219], a[80:83], a[44:47], a[216:219]
    buffer_load_dwordx4 v17, s[48:51], s80 offen lds
    v_mfma_f32_16x16x32_bf16 a[224:227], a[80:83], a[48:51], a[224:227]
    v_mfma_f32_16x16x32_bf16 a[232:235], a[80:83], a[52:55], a[232:235]
    v_mfma_f32_16x16x32_bf16 a[240:243], a[80:83], a[56:59], a[240:243]
    v_mfma_f32_16x16x32_bf16 a[248:251], a[80:83], a[60:63], a[248:251]
    buffer_load_dwordx4 v18, s[48:51], s80 offen offset:1024 lds
    v_mfma_f32_16x16x32_bf16 a[196:199], a[84:87], a[32:35], a[196:199]
    v_mfma_f32_16x16x32_bf16 a[204:207], a[84:87], a[36:39], a[204:207]
    v_mfma_f32_16x16x32_bf16 a[212:215], a[84:87], a[40:43], a[212:215]
    v_mfma_f32_16x16x32_bf16 a[220:223], a[84:87], a[44:47], a[220:223]
    s_mov_b32 s80, 131072
    s_add_u32 m0, s3, 131072
    v_mfma_f32_16x16x32_bf16 a[228:231], a[84:87], a[48:51], a[228:231]
    buffer_load_dwordx4 v17, s[48:51], s80 offen lds
    v_mfma_f32_16x16x32_bf16 a[236:239], a[84:87], a[52:55], a[236:239]
    v_mfma_f32_16x16x32_bf16 a[244:247], a[84:87], a[56:59], a[244:247]
    v_mfma_f32_16x16x32_bf16 a[252:255], a[84:87], a[60:63], a[252:255]
    v_mfma_f32_16x16x32_bf16 v[128:131], a[88:91], a[32:35], v[128:131]
    buffer_load_dwordx4 v18, s[48:51], s80 offen offset:1024 lds
    v_mfma_f32_16x16x32_bf16 v[144:147], a[88:91], a[36:39], v[144:147]
    v_mfma_f32_16x16x32_bf16 v[160:163], a[88:91], a[40:43], v[160:163]
    v_mfma_f32_16x16x32_bf16 v[176:179], a[88:91], a[44:47], v[176:179]
    v_mfma_f32_16x16x32_bf16 v[192:195], a[88:91], a[48:51], v[192:195]
    s_mov_b32 s81, 360448
    s_add_u32 m0, s3, 139264
    v_mfma_f32_16x16x32_bf16 v[208:211], a[88:91], a[52:55], v[208:211]
    buffer_load_dwordx4 v17, s[48:51], s81 offen lds
    v_mfma_f32_16x16x32_bf16 v[224:227], a[88:91], a[56:59], v[224:227]
    v_mfma_f32_16x16x32_bf16 v[240:243], a[88:91], a[60:63], v[240:243]
    v_mfma_f32_16x16x32_bf16 v[132:135], a[92:95], a[32:35], v[132:135]
    v_mfma_f32_16x16x32_bf16 v[148:151], a[92:95], a[36:39], v[148:151]
    buffer_load_dwordx4 v18, s[48:51], s81 offen offset:1024 lds
    v_mfma_f32_16x16x32_bf16 v[164:167], a[92:95], a[40:43], v[164:167]
    v_mfma_f32_16x16x32_bf16 v[180:183], a[92:95], a[44:47], v[180:183]
    v_mfma_f32_16x16x32_bf16 v[196:199], a[92:95], a[48:51], v[196:199]
    v_mfma_f32_16x16x32_bf16 v[212:215], a[92:95], a[52:55], v[212:215]
    s_mov_b32 s80, 589824
    s_add_u32 m0, s3, 147456
    v_mfma_f32_16x16x32_bf16 v[228:231], a[92:95], a[56:59], v[228:231]
    buffer_load_dwordx4 v17, s[48:51], s80 offen lds
    v_mfma_f32_16x16x32_bf16 v[244:247], a[92:95], a[60:63], v[244:247]
    v_mfma_f32_16x16x32_bf16 v[136:139], a[104:107], a[32:35], v[136:139]
    v_mfma_f32_16x16x32_bf16 v[152:155], a[104:107], a[36:39], v[152:155]
    v_mfma_f32_16x16x32_bf16 v[168:171], a[104:107], a[40:43], v[168:171]
    buffer_load_dwordx4 v18, s[48:51], s80 offen offset:1024 lds
    v_mfma_f32_16x16x32_bf16 v[184:187], a[104:107], a[44:47], v[184:187]
    v_mfma_f32_16x16x32_bf16 v[200:203], a[104:107], a[48:51], v[200:203]
    v_mfma_f32_16x16x32_bf16 v[216:219], a[104:107], a[52:55], v[216:219]
    v_mfma_f32_16x16x32_bf16 v[232:235], a[104:107], a[56:59], v[232:235]
    v_mfma_f32_16x16x32_bf16 v[248:251], a[104:107], a[60:63], v[248:251]
    v_mfma_f32_16x16x32_bf16 v[140:143], a[108:111], a[32:35], v[140:143]
    v_mfma_f32_16x16x32_bf16 v[156:159], a[108:111], a[36:39], v[156:159]
    v_mfma_f32_16x16x32_bf16 v[172:175], a[108:111], a[40:43], v[172:175]
    v_mfma_f32_16x16x32_bf16 v[188:191], a[108:111], a[44:47], v[188:191]
    v_mfma_f32_16x16x32_bf16 v[204:207], a[108:111], a[48:51], v[204:207]
    v_mfma_f32_16x16x32_bf16 v[220:223], a[108:111], a[52:55], v[220:223]
    v_mfma_f32_16x16x32_bf16 v[236:239], a[108:111], a[56:59], v[236:239]
    v_mfma_f32_16x16x32_bf16 v[252:255], a[108:111], a[60:63], v[252:255]
    s_branch L_epi
L_stub2:
    s_branch L_stub6
L_g1_1:
    s_mov_b32 m0, s14
    s_mov_b32 s77, 4096
    buffer_load_dwordx4 v1, s[28:31], s77 offen sc1 lds
    s_mov_b32 s77, 19456
    buffer_load_dwordx4 v1, s[28:31], s77 offen offset:1024 sc1 lds
    v_add_u32 v1, 128, v1
    s_mov_b32 m0, s15
    s_mov_b32 s77, 4096
    buffer_load_dwordx4 v1, s[28:31], s77 offen sc1 lds
    s_mov_b32 s77, 19456
    buffer_load_dwordx4 v1, s[28:31], s77 offen offset:1024 sc1 lds
    v_add_u32 v1, 128, v1
    s_waitcnt vmcnt(2)
    s_barrier
    ds_read_b64_tr_b16 a[64:65], v12 offset:0
    ds_read_b64_tr_b16 a[66:67], v12 offset:256
    ds_read_b64_tr_b16 a[68:69], v14 offset:0
    ds_read_b64_tr_b16 a[70:71], v14 offset:256
    ds_read_b64_tr_b16 a[72:73], v12 offset:1024
    ds_read_b64_tr_b16 a[74:75], v12 offset:1280
    ds_read_b64_tr_b16 a[76:77], v14 offset:1024
    ds_read_b64_tr_b16 a[78:79], v14 offset:1280
    ds_read_b64_tr_b16 a[80:81], v12 offset:2048
    ds_read_b64_tr_b16 a[82:83], v12 offset:2304
    ds_read_b64_tr_b16 a[84:85], v14 offset:2048
    ds_read_b64_tr_b16 a[86:87], v14 offset:2304
    ds_read_b64_tr_b16 a[88:89], v12 offset:3072
    ds_read_b64_tr_b16 a[90:91], v12 offset:3328
    ds_read_b64_tr_b16 a[92:93], v14 offset:3072
    ds_read_b64_tr_b16 a[94:95], v14 offset:3328
    ds_read_b64_tr_b16 a[96:97], v12 offset:4096
    ds_read_b64_tr_b16 a[98:99], v12 offset:4352
    ds_read_b64_tr_b16 a[100:101], v14 offset:4096
    ds_read_b64_tr_b16 a[102:103], v14 offset:4352
    ds_read_b128 a[0:3], v8 offset:0
    ds_read_b128 a[4:7], v8 offset:2048
    ds_read_b128 a[8:11], v8 offset:4096
    ds_read_b128 a[12:15], v8 offset:6144
    ds_read_b128 a[16:19], v8 offset:8192
    ds_read_b128 a[20:23], v8 offset:10240
    ds_read_b128 a[24:27], v8 offset:12288
    ds_read_b128 a[28:31], v8 offset:14336
    s_add_u32 m0, s78, 40960
    s_nop 0
    buffer_load_dwordx4 v2, s[32:35], s68 offen offset:0 lds
    buffer_load_dwordx4 v2, s[32:35], s69 offen offset:1024 lds
    buffer_load_dwordx4 v2, s[32:35], s70 offen offset:2048 lds
    v_add_u32 v2, 196608, v2
    buffer_load_dwordx4 v3, s[36:39], s71 offen offset:3072 lds
    s_add_u32 m0, s78, 45056
    s_nop 0
    buffer_load_dwordx4 v3, s[40:43], s72 offen offset:0 lds
    buffer_load_dwordx4 v3, s[36:39], s73 offen offset:1024 lds
    buffer_load_dwordx4 v3, s[40:43], s74 offen offset:2048 lds
    buffer_load_dwordx4 v3, s[36:39], s75 offen offset:3072 lds
    s_add_u32 m0, s78, 49152
    s_nop 0
    buffer_load_dwordx4 v3, s[40:43], s76 offen offset:0 lds
    v_add_u32 v3, 229376, v3
    global_load_lds_dwordx4 v[4:5], off offset:1024
    v_lshl_add_u64 v[4:5], v[4:5], 0, s[80:81]
    s_add_u32 m0, s78, 61440
    s_nop 0
    buffer_load_dwordx4 v2, s[32:35], s68 offen offset:0 lds
    buffer_load_dwordx4 v2, s[32:35], s69 offen offset:1024 lds
    buffer_load_dwordx4 v2, s[32:35], s70 offen offset:2048 lds
    v_add_u32 v2, 196608, v2
    buffer_load_dwordx4 v3, s[36:39], s71 offen offset:3072 lds
    s_add_u32 m0, s78, 65536
    s_nop 0
    buffer_load_dwordx4 v3, s[40:43], s72 offen offset:0 lds
    buffer_load_dwordx4 v3, s[36:39], s73 offen offset:1024 lds
    buffer_load_dwordx4 v3, s[40:43], s74 offen offset:2048 lds
    buffer_load_dwordx4 v3, s[36:39], s75 offen offset:3072 lds
    s_add_u32 m0, s78, 69632
    s_nop 0
    buffer_load_dwordx4 v3, s[40:43], s76 offen offset:0 lds
    v_add_u32 v3, 229376, v3
    global_load_lds_dwordx4 v[4:5], off offset:1024
    v_lshl_add_u64 v[4:5], v[4:5], 0, s[80:81]
    s_mov_b32 s67, 7
    v_mov_b32 v20, 0x7ff00000
.p2align 3
L_loop1:
    s_waitcnt vmcnt(24) lgkmcnt(0)
    s_barrier
    v_mfma_f32_16x16x32_bf16 v[128:131], a[64:67], a[0:3], v[128:131]
    s_add_u32 m0, s78, 0
    buffer_load_dword v7, v6, s[44:47], s4 offen
    v_add_u32_e64 v6, s79, v6
    v_mfma_f32_16x16x32_bf16 v[144:147], a[64:67], a[4:7], v[144:147]
    buffer_load_dwordx4 v2, s[32:35], s68 offen offset:0 lds
    buffer_load_dword v7, v33, s[48:51], 0 offen
    v_add_u32_e64 v33, s52, v33
    v_mfma_f32_16x16x32_bf16 v[160:163], a[64:67], a[8:11], v[160:163]
    ds_read_b128 a[32:35], v9 offset:0
    v_mfma_f32_16x16x32_bf16 v[176:179], a[64:67], a[12:15], v[176:179]
    v_mfma_f32_16x16x32_bf16 v[192:195], a[64:67], a[16:19], v[192:195]
    v_mfma_f32_16x16x32_bf16 v[208:211], a[64:67], a[20:23], v[208:211]
    v_mfma_f32_16x16x32_bf16 v[224:227], a[64:67], a[24:27], v[224:227]
    ds_read_b128 a[36:39], v9 offset:2048
    v_mfma_f32_16x16x32_bf16 v[240:243], a[64:67], a[28:31], v[240:243]
    ds_read_b64_tr_b16 a[64:65], v12 offset:20480
    v_mfma_f32_16x16x32_bf16 v[132:135], a[68:71], a[0:3], v[132:135]
    ds_read_b64_tr_b16 a[66:67], v12 offset:20736
    v_mfma_f32_16x16x32_bf16 v[148:151], a[68:71], a[4:7], v[148:151]
    buffer_load_dwordx4 v2, s[32:35], s69 offen offset:1024 lds
    v_mfma_f32_16x16x32_bf16 v[164:167], a[68:71], a[8:11], v[164:167]
    ds_read_b128 a[40:43], v9 offset:4096
    v_mfma_f32_16x16x32_bf16 v[180:183], a[68:71], a[12:15], v[180:183]
    v_mfma_f32_16x16x32_bf16 v[196:199], a[68:71], a[16:19], v[196:199]
    v_mfma_f32_16x16x32_bf16 v[212:215], a[68:71], a[20:23], v[212:215]
    buffer_load_dwordx4 v2, s[32:35], s70 offen offset:2048 lds
    v_add_u32 v2, 196608, v2
    v_mfma_f32_16x16x32_bf16 v[228:231], a[68:71], a[24:27], v[228:231]
    ds_read_b128 a[44:47], v9 offset:6144
    v_mfma_f32_16x16x32_bf16 v[244:247], a[68:71], a[28:31], v[244:247]
    ds_read_b64_tr_b16 a[68:69], v14 offset:20480
    v_mfma_f32_16x16x32_bf16 v[136:139], a[72:75], a[0:3], v[136:139]
    ds_read_b64_tr_b16 a[70:71], v14 offset:20736
    v_mfma_f32_16x16x32_bf16 v[152:155], a[72:75], a[4:7], v[152:155]
    v_mfma_f32_16x16x32_bf16 v[168:171], a[72:75], a[8:11], v[168:171]
    ds_read_b128 a[48:51], v9 offset:8192
    v_mfma_f32_16x16x32_bf16 v[184:187], a[72:75], a[12:15], v[184:187]
    buffer_load_dwordx4 v3, s[36:39], s71 offen offset:3072 lds
    v_mfma_f32_16x16x32_bf16 v[200:203], a[72:75], a[16:19], v[200:203]
    v_mfma_f32_16x16x32_bf16 v[216:219], a[72:75], a[20:23], v[216:219]
    v_mfma_f32_16x16x32_bf16 v[232:235], a[72:75], a[24:27], v[232:235]
    ds_read_b128 a[52:55], v9 offset:10240
    v_mfma_f32_16x16x32_bf16 v[248:251], a[72:75], a[28:31], v[248:251]
    ds_read_b64_tr_b16 a[72:73], v12 offset:21504
    v_mfma_f32_16x16x32_bf16 v[140:143], a[76:79], a[0:3], v[140:143]
    ds_read_b64_tr_b16 a[74:75], v12 offset:21760
    s_add_u32 m0, s78, 4096
    v_mfma_f32_16x16x32_bf16 v[156:159], a[76:79], a[4:7], v[156:159]
    buffer_load_dwordx4 v3, s[40:43], s72 offen offset:0 lds
    v_mfma_f32_16x16x32_bf16 v[172:175], a[76:79], a[8:11], v[172:175]
    ds_read_b128 a[56:59], v9 offset:12288
    v_mfma_f32_16x16x32_bf16 v[188:191], a[76:79], a[12:15], v[188:191]
    v_mfma_f32_16x16x32_bf16 v[204:207], a[76:79], a[16:19], v[204:207]
    v_mfma_f32_16x16x32_bf16 v[220:223], a[76:79], a[20:23], v[220:223]
    v_mfma_f32_16x16x32_bf16 v[236:239], a[76:79], a[24:27], v[236:239]
    ds_read_b128 a[60:63], v9 offset:14336
    v_mfma_f32_16x16x32_bf16 v[252:255], a[76:79], a[28:31], v[252:255]
    ds_read_b64_tr_b16 a[76:77], v14 offset:21504
    v_mfma_f32_16x16x32_bf16 a[128:131], a[80:83], a[0:3], a[128:131]
    ds_read_b64_tr_b16 a[78:79], v14 offset:21760
    v_mfma_f32_16x16x32_bf16 a[144:147], a[80:83], a[4:7], a[144:147]
    buffer_load_dwordx4 v3, s[36:39], s73 offen offset:1024 lds
    v_mfma_f32_16x16x32_bf16 a[160:163], a[80:83], a[8:11], a[160:163]
    ds_read_b64_tr_b16 a[104:105], v12 offset:24576
    v_mfma_f32_16x16x32_bf16 a[176:179], a[80:83], a[12:15], a[176:179]
    v_mfma_f32_16x16x32_bf16 a[192:195], a[80:83], a[16:19], a[192:195]
    v_mfma_f32_16x16x32_bf16 a[208:211], a[80:83], a[20:23], a[208:211]
    v_mfma_f32_16x16x32_bf16 a[224:227], a[80:83], a[24:27], a[224:227]
    ds_read_b64_tr_b16 a[106:107], v12 offset:24832
    v_mfma_f32_16x16x32_bf16 a[240:243], a[80:83], a[28:31], a[240:243]
    ds_read_b64_tr_b16 a[80:81], v12 offset:22528
    v_mfma_f32_16x16x32_bf16 a[132:135], a[84:87], a[0:3], a[132:135]
    ds_read_b64_tr_b16 a[82:83], v12 offset:22784
    v_mfma_f32_16x16x32_bf16 a[148:151], a[84:87], a[4:7], a[148:151]
    buffer_load_dwordx4 v3, s[40:43], s74 offen offset:2048 lds
    v_mfma_f32_16x16x32_bf16 a[164:167], a[84:87], a[8:11], a[164:167]
    ds_read_b64_tr_b16 a[108:109], v14 offset:24576
    v_mfma_f32_16x16x32_bf16 a[180:183], a[84:87], a[12:15], a[180:183]
    v_mfma_f32_16x16x32_bf16 a[196:199], a[84:87], a[16:19], a[196:199]
    buffer_load_dwordx4 v3, s[36:39], s75 offen offset:3072 lds
    v_mfma_f32_16x16x32_bf16 a[212:215], a[84:87], a[20:23], a[212:215]
    v_mfma_f32_16x16x32_bf16 a[228:231], a[84:87], a[24:27], a[228:231]
    ds_read_b64_tr_b16 a[110:111], v14 offset:24832
    v_mfma_f32_16x16x32_bf16 a[244:247], a[84:87], a[28:31], a[244:247]
    ds_read_b64_tr_b16 a[84:85], v14 offset:22528
    v_mfma_f32_16x16x32_bf16 a[136:139], a[88:91], a[0:3], a[136:139]
    ds_read_b64_tr_b16 a[86:87], v14 offset:22784
    v_mfma_f32_16x16x32_bf16 a[152:155], a[88:91], a[4:7], a[152:155]
    s_add_u32 m0, s78, 8192
    v_mfma_f32_16x16x32_bf16 a[168:171], a[88:91], a[8:11], a[168:171]
    buffer_load_dwordx4 v3, s[40:43], s76 offen offset:0 lds
    v_add_u32 v3, 229376, v3
    v_mfma_f32_16x16x32_bf16 a[184:187], a[88:91], a[12:15], a[184:187]
    v_mfma_f32_16x16x32_bf16 a[200:203], a[88:91], a[16:19], a[200:203]
    v_mfma_f32_16x16x32_bf16 a[216:219], a[88:91], a[20:23], a[216:219]
    v_mfma_f32_16x16x32_bf16 a[232:235], a[88:91], a[24:27], a[232:235]
    v_mfma_f32_16x16x32_bf16 a[248:251], a[88:91], a[28:31], a[248:251]
    ds_read_b64_tr_b16 a[88:89], v12 offset:23552
    v_mfma_f32_16x16x32_bf16 a[140:143], a[92:95], a[0:3], a[140:143]
    ds_read_b64_tr_b16 a[90:91], v12 offset:23808
    v_mfma_f32_16x16x32_bf16 a[156:159], a[92:95], a[4:7], a[156:159]
    global_load_lds_dwordx4 v[4:5], off offset:1024
    v_lshl_add_u64 v[4:5], v[4:5], 0, s[80:81]
    v_mfma_f32_16x16x32_bf16 a[172:175], a[92:95], a[8:11], a[172:175]
    v_mfma_f32_16x16x32_bf16 a[188:191], a[92:95], a[12:15], a[188:191]
    v_mfma_f32_16x16x32_bf16 a[204:207], a[92:95], a[16:19], a[204:207]
    v_mfma_f32_16x16x32_bf16 a[220:223], a[92:95], a[20:23], a[220:223]
    v_mfma_f32_16x16x32_bf16 a[236:239], a[92:95], a[24:27], a[236:239]
    v_mfma_f32_16x16x32_bf16 a[252:255], a[92:95], a[28:31], a[252:255]
    ds_read_b64_tr_b16 a[92:93], v14 offset:23552
    v_mfma_f32_16x16x32_bf16 v[48:51], a[96:99], a[0:3], v[48:51]
    ds_read_b64_tr_b16 a[94:95], v14 offset:23808
    v_mfma_f32_16x16x32_bf16 v[52:55], a[96:99], a[4:7], v[52:55]
    v_mfma_f32_16x16x32_bf16 v[64:67], a[96:99], a[8:11], v[64:67]
    v_mfma_f32_16x16x32_bf16 v[68:71], a[96:99], a[12:15], v[68:71]
    v_mfma_f32_16x16x32_bf16 v[80:83], a[96:99], a[16:19], v[80:83]
    v_mfma_f32_16x16x32_bf16 v[84:87], a[96:99], a[20:23], v[84:87]
    v_mfma_f32_16x16x32_bf16 v[96:99], a[96:99], a[24:27], v[96:99]
    v_mfma_f32_16x16x32_bf16 v[100:103], a[96:99], a[28:31], v[100:103]
    v_mfma_f32_16x16x32_bf16 v[56:59], a[100:103], a[0:3], v[56:59]
    v_mfma_f32_16x16x32_bf16 v[60:63], a[100:103], a[4:7], v[60:63]
    v_mfma_f32_16x16x32_bf16 v[72:75], a[100:103], a[8:11], v[72:75]
    v_mfma_f32_16x16x32_bf16 v[76:79], a[100:103], a[12:15], v[76:79]
    v_mfma_f32_16x16x32_bf16 v[88:91], a[100:103], a[16:19], v[88:91]
    v_mfma_f32_16x16x32_bf16 v[92:95], a[100:103], a[20:23], v[92:95]
    v_mfma_f32_16x16x32_bf16 v[104:107], a[100:103], a[24:27], v[104:107]
    v_mfma_f32_16x16x32_bf16 v[108:111], a[100:103], a[28:31], v[108:111]
    s_waitcnt vmcnt(22) lgkmcnt(0)
    s_barrier
    v_mfma_f32_16x16x32_bf16 v[128:131], a[64:67], a[32:35], v[128:131]
    s_mov_b32 m0, s14
    s_mov_b32 s77, 4096
    v_mfma_f32_16x16x32_bf16 v[144:147], a[64:67], a[36:39], v[144:147]
    buffer_load_dwordx4 v1, s[28:31], s77 offen sc1 lds
    v_mfma_f32_16x16x32_bf16 v[160:163], a[64:67], a[40:43], v[160:163]
    ds_read_b128 a[0:3], v8 offset:34816
    v_mfma_f32_16x16x32_bf16 v[176:179], a[64:67], a[44:47], v[176:179]
    v_mfma_f32_16x16x32_bf16 v[192:195], a[64:67], a[48:51], v[192:195]
    v_mfma_f32_16x16x32_bf16 v[208:211], a[64:67], a[52:55], v[208:211]
    v_mfma_f32_16x16x32_bf16 v[224:227], a[64:67], a[56:59], v[224:227]
    ds_read_b128 a[4:7], v8 offset:36864
    v_mfma_f32_16x16x32_bf16 v[240:243], a[64:67], a[60:63], v[240:243]
    ds_read_b64_tr_b16 a[64:65], v13 offset:0
    v_mfma_f32_16x16x32_bf16 v[132:135], a[68:71], a[32:35], v[132:135]
    ds_read_b64_tr_b16 a[66:67], v13 offset:256
    s_mov_b32 s77, 19456
    v_mfma_f32_16x16x32_bf16 v[148:151], a[68:71], a[36:39], v[148:151]
    buffer_load_dwordx4 v1, s[28:31], s77 offen offset:1024 sc1 lds
    v_add_u32 v1, 128, v1
    v_mfma_f32_16x16x32_bf16 v[164:167], a[68:71], a[40:43], v[164:167]
    ds_read_b128 a[8:11], v8 offset:38912
    s_add_u32 m0, s78, 20480
    v_mfma_f32_16x16x32_bf16 v[180:183], a[68:71], a[44:47], v[180:183]
    buffer_load_dwordx4 v2, s[32:35], s68 offen offset:0 lds
    v_mfma_f32_16x16x32_bf16 v[196:199], a[68:71], a[48:51], v[196:199]
    v_mfma_f32_16x16x32_bf16 v[212:215], a[68:71], a[52:55], v[212:215]
    v_mfma_f32_16x16x32_bf16 v[228:231], a[68:71], a[56:59], v[228:231]
    ds_read_b128 a[12:15], v8 offset:40960
    v_mfma_f32_16x16x32_bf16 v[244:247], a[68:71], a[60:63], v[244:247]
    ds_read_b64_tr_b16 a[68:69], v15 offset:0
    v_mfma_f32_16x16x32_bf16 v[136:139], a[72:75], a[32:35], v[136:139]
    ds_read_b64_tr_b16 a[70:71], v15 offset:256
    v_mfma_f32_16x16x32_bf16 v[152:155], a[72:75], a[36:39], v[152:155]
    buffer_load_dwordx4 v2, s[32:35], s69 offen offset:1024 lds
    v_mfma_f32_16x16x32_bf16 v[168:171], a[72:75], a[40:43], v[168:171]
    ds_read_b128 a[16:19], v8 offset:43008
    v_mfma_f32_16x16x32_bf16 v[184:187], a[72:75], a[44:47], v[184:187]
    v_mfma_f32_16x16x32_bf16 v[200:203], a[72:75], a[48:51], v[200:203]
    v_mfma_f32_16x16x32_bf16 v[216:219], a[72:75], a[52:55], v[216:219]
    buffer_load_dwordx4 v2, s[32:35], s70 offen offset:2048 lds
    v_add_u32 v2, 196608, v2
    v_mfma_f32_16x16x32_bf16 v[232:235], a[72:75], a[56:59], v[232:235]
    ds_read_b128 a[20:23], v8 offset:45056
    v_mfma_f32_16x16x32_bf16 v[248:251], a[72:75], a[60:63], v[248:251]
    ds_read_b64_tr_b16 a[72:73], v13 offset:1024
    v_mfma_f32_16x16x32_bf16 v[140:143], a[76:79], a[32:35], v[140:143]
    ds_read_b64_tr_b16 a[74:75], v13 offset:1280
    v_mfma_f32_16x16x32_bf16 v[156:159], a[76:79], a[36:39], v[156:159]
    v_mfma_f32_16x16x32_bf16 v[172:175], a[76:79], a[40:43], v[172:175]
    ds_read_b128 a[24:27], v8 offset:47104
    v_mfma_f32_16x16x32_bf16 v[188:191], a[76:79], a[44:47], v[188:191]
    buffer_load_dwordx4 v3, s[36:39], s71 offen offset:3072 lds
    v_mfma_f32_16x16x32_bf16 v[204:207], a[76:79], a[48:51], v[204:207]
    v_mfma_f32_16x16x32_bf16 v[220:223], a[76:79], a[52:55], v[220:223]
    v_mfma_f32_16x16x32_bf16 v[236:239], a[76:79], a[56:59], v[236:239]
    ds_read_b128 a[28:31], v8 offset:49152
    v_mfma_f32_16x16x32_bf16 v[252:255], a[76:79], a[60:63], v[252:255]
    ds_read_b64_tr_b16 a[76:77], v15 offset:1024
    v_mfma_f32_16x16x32_bf16 a[128:131], a[80:83], a[32:35], a[128:131]
    ds_read_b64_tr_b16 a[78:79], v15 offset:1280
    s_add_u32 m0, s78, 24576
    v_mfma_f32_16x16x32_bf16 a[144:147], a[80:83], a[36:39], a[144:147]
    buffer_load_dwordx4 v3, s[40:43], s72 offen offset:0 lds
    v_mfma_f32_16x16x32_bf16 a[160:163], a[80:83], a[40:43], a[160:163]
    ds_read_b64_tr_b16 a[96:97], v13 offset:4096
    v_mfma_f32_16x16x32_bf16 a[176:179], a[80:83], a[44:47], a[176:179]
    v_mfma_f32_16x16x32_bf16 a[192:195], a[80:83], a[48:51], a[192:195]
    v_mfma_f32_16x16x32_bf16 a[208:211], a[80:83], a[52:55], a[208:211]
    buffer_load_dwordx4 v3, s[36:39], s73 offen offset:1024 lds
    v_mfma_f32_16x16x32_bf16 a[224:227], a[80:83], a[56:59], a[224:227]
    ds_read_b64_tr_b16 a[98:99], v13 offset:4352
    v_mfma_f32_16x16x32_bf16 a[240:243], a[80:83], a[60:63], a[240:243]
    ds_read_b64_tr_b16 a[80:81], v13 offset:2048
    v_mfma_f32_16x16x32_bf16 a[132:135], a[84:87], a[32:35], a[132:135]
    ds_read_b64_tr_b16 a[82:83], v13 offset:2304
    v_mfma_f32_16x16x32_bf16 a[148:151], a[84:87], a[36:39], a[148:151]
    v_mfma_f32_16x16x32_bf16 a[164:167], a[84:87], a[40:43], a[164:167]
    ds_read_b64_tr_b16 a[100:101], v15 offset:4096
    v_mfma_f32_16x16x32_bf16 a[180:183], a[84:87], a[44:47], a[180:183]
    buffer_load_dwordx4 v3, s[40:43], s74 offen offset:2048 lds
    v_mfma_f32_16x16x32_bf16 a[196:199], a[84:87], a[48:51], a[196:199]
    v_mfma_f32_16x16x32_bf16 a[212:215], a[84:87], a[52:55], a[212:215]
    v_mfma_f32_16x16x32_bf16 a[228:231], a[84:87], a[56:59], a[228:231]
    ds_read_b64_tr_b16 a[102:103], v15 offset:4352
    v_mfma_f32_16x16x32_bf16 a[244:247], a[84:87], a[60:63], a[244:247]
    ds_read_b64_tr_b16 a[84:85], v15 offset:2048
    v_mfma_f32_16x16x32_bf16 a[136:139], a[88:91], a[32:35], a[136:139]
    ds_read_b64_tr_b16 a[86:87], v15 offset:2304
    v_mfma_f32_16x16x32_bf16 a[152:155], a[88:91], a[36:39], a[152:155]
    buffer_load_dwordx4 v3, s[36:39], s75 offen offset:3072 lds
    v_mfma_f32_16x16x32_bf16 a[168:171], a[88:91], a[40:43], a[168:171]
    v_mfma_f32_16x16x32_bf16 a[184:187], a[88:91], a[44:47], a[184:187]
    s_add_u32 m0, s78, 28672
    v_mfma_f32_16x16x32_bf16 a[200:203], a[88:91], a[48:51], a[200:203]
    buffer_load_dwordx4 v3, s[40:43], s76 offen offset:0 lds
    v_add_u32 v3, 229376, v3
    v_mfma_f32_16x16x32_bf16 a[216:219], a[88:91], a[52:55], a[216:219]
    v_mfma_f32_16x16x32_bf16 a[232:235], a[88:91], a[56:59], a[232:235]
    v_mfma_f32_16x16x32_bf16 a[248:251], a[88:91], a[60:63], a[248:251]
    ds_read_b64_tr_b16 a[88:89], v13 offset:3072
    v_mfma_f32_16x16x32_bf16 a[140:143], a[92:95], a[32:35], a[140:143]
    ds_read_b64_tr_b16 a[90:91], v13 offset:3328
    v_mfma_f32_16x16x32_bf16 a[156:159], a[92:95], a[36:39], a[156:159]
    global_load_lds_dwordx4 v[4:5], off offset:1024
    v_lshl_add_u64 v[4:5], v[4:5], 0, s[80:81]
    v_mfma_f32_16x16x32_bf16 a[172:175], a[92:95], a[40:43], a[172:175]
    v_mfma_f32_16x16x32_bf16 a[188:191], a[92:95], a[44:47], a[188:191]
    v_mfma_f32_16x16x32_bf16 a[204:207], a[92:95], a[48:51], a[204:207]
    v_mfma_f32_16x16x32_bf16 a[220:223], a[92:95], a[52:55], a[220:223]
    v_mfma_f32_16x16x32_bf16 a[236:239], a[92:95], a[56:59], a[236:239]
    v_mfma_f32_16x16x32_bf16 a[252:255], a[92:95], a[60:63], a[252:255]
    ds_read_b64_tr_b16 a[92:93], v15 offset:3072
    v_mfma_f32_16x16x32_bf16 v[48:51], a[104:107], a[32:35], v[48:51]
    ds_read_b64_tr_b16 a[94:95], v15 offset:3328
    v_mfma_f32_16x16x32_bf16 v[52:55], a[104:107], a[36:39], v[52:55]
    v_mfma_f32_16x16x32_bf16 v[64:67], a[104:107], a[40:43], v[64:67]
    v_mfma_f32_16x16x32_bf16 v[68:71], a[104:107], a[44:47], v[68:71]
    v_mfma_f32_16x16x32_bf16 v[80:83], a[104:107], a[48:51], v[80:83]
    v_mfma_f32_16x16x32_bf16 v[84:87], a[104:107], a[52:55], v[84:87]
    v_mfma_f32_16x16x32_bf16 v[96:99], a[104:107], a[56:59], v[96:99]
    v_mfma_f32_16x16x32_bf16 v[100:103], a[104:107], a[60:63], v[100:103]
    v_mfma_f32_16x16x32_bf16 v[56:59], a[108:111], a[32:35], v[56:59]
    v_mfma_f32_16x16x32_bf16 v[60:63], a[108:111], a[36:39], v[60:63]
    v_mfma_f32_16x16x32_bf16 v[72:75], a[108:111], a[40:43], v[72:75]
    v_mfma_f32_16x16x32_bf16 v[76:79], a[108:111], a[44:47], v[76:79]
    v_mfma_f32_16x16x32_bf16 v[88:91], a[108:111], a[48:51], v[88:91]
    v_mfma_f32_16x16x32_bf16 v[92:95], a[108:111], a[52:55], v[92:95]
    v_mfma_f32_16x16x32_bf16 v[104:107], a[108:111], a[56:59], v[104:107]
    v_mfma_f32_16x16x32_bf16 v[108:111], a[108:111], a[60:63], v[108:111]
    s_waitcnt vmcnt(24) lgkmcnt(0)
    s_barrier
    v_mfma_f32_16x16x32_bf16 v[128:131], a[64:67], a[0:3], v[128:131]
    s_add_u32 m0, s78, 40960
    buffer_load_dword v7, v6, s[44:47], s4 offen
    v_add_u32_e64 v6, s79, v6
    v_mfma_f32_16x16x32_bf16 v[144:147], a[64:67], a[4:7], v[144:147]
    buffer_load_dwordx4 v2, s[32:35], s68 offen offset:0 lds
    buffer_load_dword v7, v33, s[48:51], 0 offen
    v_add_u32_e64 v33, s52, v33
    v_mfma_f32_16x16x32_bf16 v[160:163], a[64:67], a[8:11], v[160:163]
    ds_read_b128 a[32:35], v9 offset:34816
    v_mfma_f32_16x16x32_bf16 v[176:179], a[64:67], a[12:15], v[176:179]
    v_mfma_f32_16x16x32_bf16 v[192:195], a[64:67], a[16:19], v[192:195]
    v_mfma_f32_16x16x32_bf16 v[208:211], a[64:67], a[20:23], v[208:211]
    v_mfma_f32_16x16x32_bf16 v[224:227], a[64:67], a[24:27], v[224:227]
    ds_read_b128 a[36:39], v9 offset:36864
    v_mfma_f32_16x16x32_bf16 v[240:243], a[64:67], a[28:31], v[240:243]
    ds_read_b64_tr_b16 a[64:65], v13 offset:20480
    v_mfma_f32_16x16x32_bf16 v[132:135], a[68:71], a[0:3], v[132:135]
    ds_read_b64_tr_b16 a[66:67], v13 offset:20736
    v_mfma_f32_16x16x32_bf16 v[148:151], a[68:71], a[4:7], v[148:151]
    buffer_load_dwordx4 v2, s[32:35], s69 offen offset:1024 lds
    v_mfma_f32_16x16x32_bf16 v[164:167], a[68:71], a[8:11], v[164:167]
    ds_read_b128 a[40:43], v9 offset:38912
    v_mfma_f32_16x16x32_bf16 v[180:183], a[68:71], a[12:15], v[180:183]
    v_mfma_f32_16x16x32_bf16 v[196:199], a[68:71], a[16:19], v[196:199]
    v_mfma_f32_16x16x32_bf16 v[212:215], a[68:71], a[20:23], v[212:215]
    buffer_load_dwordx4 v2, s[32:35], s70 offen offset:2048 lds
    v_add_u32 v2, 196608, v2
    v_mfma_f32_16x16x32_bf16 v[228:231], a[68:71], a[24:27], v[228:231]
    ds_read_b128 a[44:47], v9 offset:40960
    v_mfma_f32_16x16x32_bf16 v[244:247], a[68:71], a[28:31], v[244:247]
    ds_read_b64_tr_b16 a[68:69], v15 offset:20480
    v_mfma_f32_16x16x32_bf16 v[136:139], a[72:75], a[0:3], v[136:139]
    ds_read_b64_tr_b16 a[70:71], v15 offset:20736
    v_mfma_f32_16x16x32_bf16 v[152:155], a[72:75], a[4:7], v[152:155]
    v_mfma_f32_16x16x32_bf16 v[168:171], a[72:75], a[8:11], v[168:171]
    ds_read_b128 a[48:51], v9 offset:43008
    v_mfma_f32_16x16x32_bf16 v[184:187], a[72:75], a[12:15], v[184:187]
    buffer_load_dwordx4 v3, s[36:39], s71 offen offset:3072 lds
    v_mfma_f32_16x16x32_bf16 v[200:203], a[72:75], a[16:19], v[200:203]
    v_mfma_f32_16x16x32_bf16 v[216:219], a[72:75], a[20:23], v[216:219]
    v_mfma_f32_16x16x32_bf16 v[232:235], a[72:75], a[24:27], v[232:235]
    ds_read_b128 a[52:55], v9 offset:45056
    v_mfma_f32_16x16x32_bf16 v[248:251], a[72:75], a[28:31], v[248:251]
    ds_read_b64_tr_b16 a[72:73], v13 offset:21504
    v_mfma_f32_16x16x32_bf16 v[140:143], a[76:79], a[0:3], v[140:143]
    ds_read_b64_tr_b16 a[74:75], v13 offset:21760
    s_add_u32 m0, s78, 45056
    v_mfma_f32_16x16x32_bf16 v[156:159], a[76:79], a[4:7], v[156:159]
    buffer_load_dwordx4 v3, s[40:43], s72 offen offset:0 lds
    v_mfma_f32_16x16x32_bf16 v[172:175], a[76:79], a[8:11], v[172:175]
    ds_read_b128 a[56:59], v9 offset:47104
    v_mfma_f32_16x16x32_bf16 v[188:191], a[76:79], a[12:15], v[188:191]
    v_mfma_f32_16x16x32_bf16 v[204:207], a[76:79], a[16:19], v[204:207]
    v_mfma_f32_16x16x32_bf16 v[220:223], a[76:79], a[20:23], v[220:223]
    v_mfma_f32_16x16x32_bf16 v[236:239], a[76:79], a[24:27], v[236:239]
    ds_read_b128 a[60:63], v9 offset:49152
    v_mfma_f32_16x16x32_bf16 v[252:255], a[76:79], a[28:31], v[252:255]
    ds_read_b64_tr_b16 a[76:77], v15 offset:21504
    v_mfma_f32_16x16x32_bf16 a[128:131], a[80:83], a[0:3], a[128:131]
    ds_read_b64_tr_b16 a[78:79], v15 offset:21760
    v_mfma_f32_16x16x32_bf16 a[144:147], a[80:83], a[4:7], a[144:147]
    buffer_load_dwordx4 v3, s[36:39], s73 offen offset:1024 lds
    v_mfma_f32_16x16x32_bf16 a[160:163], a[80:83], a[8:11], a[160:163]
    ds_read_b64_tr_b16 a[104:105], v13 offset:24576
    v_mfma_f32_16x16x32_bf16 a[176:179], a[80:83], a[12:15], a[176:179]
    v_mfma_f32_16x16x32_bf16 a[192:195], a[80:83], a[16:19], a[192:195]
    v_mfma_f32_16x16x32_bf16 a[208:211], a[80:83], a[20:23], a[208:211]
    v_mfma_f32_16x16x32_bf16 a[224:227], a[80:83], a[24:27], a[224:227]
    ds_read_b64_tr_b16 a[106:107], v13 offset:24832
    v_mfma_f32_16x16x32_bf16 a[240:243], a[80:83], a[28:31], a[240:243]
    ds_read_b64_tr_b16 a[80:81], v13 offset:22528
    v_mfma_f32_16x16x32_bf16 a[132:135], a[84:87], a[0:3], a[132:135]
    ds_read_b64_tr_b16 a[82:83], v13 offset:22784
    v_mfma_f32_16x16x32_bf16 a[148:151], a[84:87], a[4:7], a[148:151]
    buffer_load_dwordx4 v3, s[40:43], s74 offen offset:2048 lds
    v_mfma_f32_16x16x32_bf16 a[164:167], a[84:87], a[8:11], a[164:167]
    ds_read_b64_tr_b16 a[108:109], v15 offset:24576
    v_mfma_f32_16x16x32_bf16 a[180:183], a[84:87], a[12:15], a[180:183]
    v_mfma_f32_16x16x32_bf16 a[196:199], a[84:87], a[16:19], a[196:199]
    buffer_load_dwordx4 v3, s[36:39], s75 offen offset:3072 lds
    v_mfma_f32_16x16x32_bf16 a[212:215], a[84:87], a[20:23], a[212:215]
    v_mfma_f32_16x16x32_bf16 a[228:231], a[84:87], a[24:27], a[228:231]
    ds_read_b64_tr_b16 a[110:111], v15 offset:24832
    v_mfma_f32_16x16x32_bf16 a[244:247], a[84:87], a[28:31], a[244:247]
    ds_read_b64_tr_b16 a[84:85], v15 offset:22528
    v_mfma_f32_16x16x32_bf16 a[136:139], a[88:91], a[0:3], a[136:139]
    ds_read_b64_tr_b16 a[86:87], v15 offset:22784
    v_mfma_f32_16x16x32_bf16 a[152:155], a[88:91], a[4:7], a[152:155]
    s_add_u32 m0, s78, 49152
    v_mfma_f32_16x16x32_bf16 a[168:171], a[88:91], a[8:11], a[168:171]
    buffer_load_dwordx4 v3, s[40:43], s76 offen offset:0 lds
    v_add_u32 v3, 229376, v3
    v_mfma_f32_16x16x32_bf16 a[184:187], a[88:91], a[12:15], a[184:187]
    v_mfma_f32_16x16x32_bf16 a[200:203], a[88:91], a[16:19], a[200:203]
    v_mfma_f32_16x16x32_bf16 a[216:219], a[88:91], a[20:23], a[216:219]
    v_mfma_f32_16x16x32_bf16 a[232:235], a[88:91], a[24:27], a[232:235]
    v_mfma_f32_16x16x32_bf16 a[248:251], a[88:91], a[28:31], a[248:251]
    ds_read_b64_tr_b16 a[88:89], v13 offset:23552
    v_mfma_f32_16x16x32_bf16 a[140:143], a[92:95], a[0:3], a[140:143]
    ds_read_b64_tr_b16 a[90:91], v13 offset:23808
    v_mfma_f32_16x16x32_bf16 a[156:159], a[92:95], a[4:7], a[156:159]
    global_load_lds_dwordx4 v[4:5], off offset:1024
    v_lshl_add_u64 v[4:5], v[4:5], 0, s[80:81]
    v_mfma_f32_16x16x32_bf16 a[172:175], a[92:95], a[8:11], a[172:175]
    v_mfma_f32_16x16x32_bf16 a[188:191], a[92:95], a[12:15], a[188:191]
    v_mfma_f32_16x16x32_bf16 a[204:207], a[92:95], a[16:19], a[204:207]
    v_mfma_f32_16x16x32_bf16 a[220:223], a[92:95], a[20:23], a[220:223]
    v_mfma_f32_16x16x32_bf16 a[236:239], a[92:95], a[24:27], a[236:239]
    v_mfma_f32_16x16x32_bf16 a[252:255], a[92:95], a[28:31], a[252:255]
    ds_read_b64_tr_b16 a[92:93], v15 offset:23552
    v_mfma_f32_16x16x32_bf16 v[48:51], a[96:99], a[0:3], v[48:51]
    ds_read_b64_tr_b16 a[94:95], v15 offset:23808
    v_mfma_f32_16x16x32_bf16 v[52:55], a[96:99], a[4:7], v[52:55]
    v_mfma_f32_16x16x32_bf16 v[64:67], a[96:99], a[8:11], v[64:67]
    v_mfma_f32_16x16x32_bf16 v[68:71], a[96:99], a[12:15], v[68:71]
    v_mfma_f32_16x16x32_bf16 v[80:83], a[96:99], a[16:19], v[80:83]
    v_mfma_f32_16x16x32_bf16 v[84:87], a[96:99], a[20:23], v[84:87]
    v_mfma_f32_16x16x32_bf16 v[96:99], a[96:99], a[24:27], v[96:99]
    v_mfma_f32_16x16x32_bf16 v[100:103], a[96:99], a[28:31], v[100:103]
    v_mfma_f32_16x16x32_bf16 v[56:59], a[100:103], a[0:3], v[56:59]
    v_mfma_f32_16x16x32_bf16 v[60:63], a[100:103], a[4:7], v[60:63]
    v_mfma_f32_16x16x32_bf16 v[72:75], a[100:103], a[8:11], v[72:75]
    v_mfma_f32_16x16x32_bf16 v[76:79], a[100:103], a[12:15], v[76:79]
    v_mfma_f32_16x16x32_bf16 v[88:91], a[100:103], a[16:19], v[88:91]
    v_mfma_f32_16x16x32_bf16 v[92:95], a[100:103], a[20:23], v[92:95]
    v_mfma_f32_16x16x32_bf16 v[104:107], a[100:103], a[24:27], v[104:107]
    v_mfma_f32_16x16x32_bf16 v[108:111], a[100:103], a[28:31], v[108:111]
    s_waitcnt vmcnt(22) lgkmcnt(0)
    s_barrier
    v_mfma_f32_16x16x32_bf16 v[128:131], a[64:67], a[32:35], v[128:131]
    s_mov_b32 m0, s15
    s_mov_b32 s77, 4096
    v_mfma_f32_16x16x32_bf16 v[144:147], a[64:67], a[36:39], v[144:147]
    buffer_load_dwordx4 v1, s[28:31], s77 offen sc1 lds
    v_mfma_f32_16x16x32_bf16 v[160:163], a[64:67], a[40:43], v[160:163]
    ds_read_b128 a[0:3], v8 offset:0
    v_mfma_f32_16x16x32_bf16 v[176:179], a[64:67], a[44:47], v[176:179]
    v_mfma_f32_16x16x32_bf16 v[192:195], a[64:67], a[48:51], v[192:195]
    v_mfma_f32_16x16x32_bf16 v[208:211], a[64:67], a[52:55], v[208:211]
    v_mfma_f32_16x16x32_bf16 v[224:227], a[64:67], a[56:59], v[224:227]
    ds_read_b128 a[4:7], v8 offset:2048
    v_mfma_f32_16x16x32_bf16 v[240:243], a[64:67], a[60:63], v[240:243]
    ds_read_b64_tr_b16 a[64:65], v12 offset:0
    v_mfma_f32_16x16x32_bf16 v[132:135], a[68:71], a[32:35], v[132:135]
    ds_read_b64_tr_b16 a[66:67], v12 offset:256
    s_mov_b32 s77, 19456
    v_mfma_f32_16x16x32_bf16 v[148:151], a[68:71], a[36:39], v[148:151]
    buffer_load_dwordx4 v1, s[28:31], s77 offen offset:1024 sc1 lds
    v_add_u32 v1, 128, v1
    v_mfma_f32_16x16x32_bf16 v[164:167], a[68:71], a[40:43], v[164:167]
    ds_read_b128 a[8:11], v8 offset:4096
    s_add_u32 m0, s78, 61440
    v_mfma_f32_16x16x32_bf16 v[180:183], a[68:71], a[44:47], v[180:183]
    buffer_load_dwordx4 v2, s[32:35], s68 offen offset:0 lds
    v_mfma_f32_16x16x32_bf16 v[196:199], a[68:71], a[48:51], v[196:199]
    v_mfma_f32_16x16x32_bf16 v[212:215], a[68:71], a[52:55], v[212:215]
    v_mfma_f32_16x16x32_bf16 v[228:231], a[68:71], a[56:59], v[228:231]
    ds_read_b128 a[12:15], v8 offset:6144
    v_mfma_f32_16x16x32_bf16 v[244:247], a[68:71], a[60:63], v[244:247]
    ds_read_b64_tr_b16 a[68:69], v14 offset:0
    v_mfma_f32_16x16x32_bf16 v[136:139], a[72:75], a[32:35], v[136:139]
    ds_read_b64_tr_b16 a[70:71], v14 offset:256
    v_mfma_f32_16x16x32_bf16 v[152:155], a[72:75], a[36:39], v[152:155]
    buffer_load_dwordx4 v2, s[32:35], s69 offen offset:1024 lds
    v_mfma_f32_16x16x32_bf16 v[168:171], a[72:75], a[40:43], v[168:171]
    ds_read_b128 a[16:19], v8 offset:8192
    v_mfma_f32_16x16x32_bf16 v[184:187], a[72:75], a[44:47], v[184:187]
    v_mfma_f32_16x16x32_bf16 v[200:203], a[72:75], a[48:51], v[200:203]
    v_mfma_f32_16x16x32_bf16 v[216:219], a[72:75], a[52:55], v[216:219]
    buffer_load_dwordx4 v2, s[32:35], s70 offen offset:2048 lds
    v_add_u32 v2, 196608, v2
    v_mfma_f32_16x16x32_bf16 v[232:235], a[72:75], a[56:59], v[232:235]
    ds_read_b128 a[20:23], v8 offset:10240
    v_mfma_f32_16x16x32_bf16 v[248:251], a[72:75], a[60:63], v[248:251]
    ds_read_b64_tr_b16 a[72:73], v12 offset:1024
    v_mfma_f32_16x16x32_bf16 v[140:143], a[76:79], a[32:35], v[140:143]
    ds_read_b64_tr_b16 a[74:75], v12 offset:1280
    v_mfma_f32_16x16x32_bf16 v[156:159], a[76:79], a[36:39], v[156:159]
    v_mfma_f32_16x16x32_bf16 v[172:175], a[76:79], a[40:43], v[172:175]
    ds_read_b128 a[24:27], v8 offset:12288
    v_mfma_f32_16x16x32_bf16 v[188:191], a[76:79], a[44:47], v[188:191]
    buffer_load_dwordx4 v3, s[36:39], s71 offen offset:3072 lds
    v_mfma_f32_16x16x32_bf16 v[204:207], a[76:79], a[48:51], v[204:207]
    v_mfma_f32_16x16x32_bf16 v[220:223], a[76:79], a[52:55], v[220:223]
    v_mfma_f32_16x16x32_bf16 v[236:239], a[76:79], a[56:59], v[236:239]
    ds_read_b128 a[28:31], v8 offset:14336
    v_mfma_f32_16x16x32_bf16 v[252:255], a[76:79], a[60:63], v[252:255]
    ds_read_b64_tr_b16 a[76:77], v14 offset:1024
    v_mfma_f32_16x16x32_bf16 a[128:131], a[80:83], a[32:35], a[128:131]
    ds_read_b64_tr_b16 a[78:79], v14 offset:1280
    s_add_u32 m0, s78, 65536
    v_mfma_f32_16x16x32_bf16 a[144:147], a[80:83], a[36:39], a[144:147]
    buffer_load_dwordx4 v3, s[40:43], s72 offen offset:0 lds
    v_mfma_f32_16x16x32_bf16 a[160:163], a[80:83], a[40:43], a[160:163]
    ds_read_b64_tr_b16 a[96:97], v12 offset:4096
    v_mfma_f32_16x16x32_bf16 a[176:179], a[80:83], a[44:47], a[176:179]
    v_mfma_f32_16x16x32_bf16 a[192:195], a[80:83], a[48:51], a[192:195]
    v_mfma_f32_16x16x32_bf16 a[208:211], a[80:83], a[52:55], a[208:211]
    buffer_load_dwordx4 v3, s[36:39], s73 offen offset:1024 lds
    v_mfma_f32_16x16x32_bf16 a[224:227], a[80:83], a[56:59], a[224:227]
    ds_read_b64_tr_b16 a[98:99], v12 offset:4352
    v_mfma_f32_16x16x32_bf16 a[240:243], a[80:83], a[60:63], a[240:243]
    ds_read_b64_tr_b16 a[80:81], v12 offset:2048
    v_mfma_f32_16x16x32_bf16 a[132:135], a[84:87], a[32:35], a[132:135]
    ds_read_b64_tr_b16 a[82:83], v12 offset:2304
    v_mfma_f32_16x16x32_bf16 a[148:151], a[84:87], a[36:39], a[148:151]
    v_mfma_f32_16x16x32_bf16 a[164:167], a[84:87], a[40:43], a[164:167]
    ds_read_b64_tr_b16 a[100:101], v14 offset:4096
    v_mfma_f32_16x16x32_bf16 a[180:183], a[84:87], a[44:47], a[180:183]
    buffer_load_dwordx4 v3, s[40:43], s74 offen offset:2048 lds
    v_mfma_f32_16x16x32_bf16 a[196:199], a[84:87], a[48:51], a[196:199]
    v_mfma_f32_16x16x32_bf16 a[212:215], a[84:87], a[52:55], a[212:215]
    v_mfma_f32_16x16x32_bf16 a[228:231], a[84:87], a[56:59], a[228:231]
    ds_read_b64_tr_b16 a[102:103], v14 offset:4352
    v_mfma_f32_16x16x32_bf16 a[244:247], a[84:87], a[60:63], a[244:247]
    ds_read_b64_tr_b16 a[84:85], v14 offset:2048
    v_mfma_f32_16x16x32_bf16 a[136:139], a[88:91], a[32:35], a[136:139]
    ds_read_b64_tr_b16 a[86:87], v14 offset:2304
    v_mfma_f32_16x16x32_bf16 a[152:155], a[88:91], a[36:39], a[152:155]
    buffer_load_dwordx4 v3, s[36:39], s75 offen offset:3072 lds
    v_mfma_f32_16x16x32_bf16 a[168:171], a[88:91], a[40:43], a[168:171]
    v_mfma_f32_16x16x32_bf16 a[184:187], a[88:91], a[44:47], a[184:187]
    s_add_u32 m0, s78, 69632
    v_mfma_f32_16x16x32_bf16 a[200:203], a[88:91], a[48:51], a[200:203]
    buffer_load_dwordx4 v3, s[40:43], s76 offen offset:0 lds
    v_add_u32 v3, 229376, v3
    v_mfma_f32_16x16x32_bf16 a[216:219], a[88:91], a[52:55], a[216:219]
    v_mfma_f32_16x16x32_bf16 a[232:235], a[88:91], a[56:59], a[232:235]
    v_mfma_f32_16x16x32_bf16 a[248:251], a[88:91], a[60:63], a[248:251]
    ds_read_b64_tr_b16 a[88:89], v12 offset:3072
    v_mfma_f32_16x16x32_bf16 a[140:143], a[92:95], a[32:35], a[140:143]
    ds_read_b64_tr_b16 a[90:91], v12 offset:3328
    v_mfma_f32_16x16x32_bf16 a[156:159], a[92:95], a[36:39], a[156:159]
    global_load_lds_dwordx4 v[4:5], off offset:1024
    v_lshl_add_u64 v[4:5], v[4:5], 0, s[80:81]
    v_mfma_f32_16x16x32_bf16 a[172:175], a[92:95], a[40:43], a[172:175]
    v_mfma_f32_16x16x32_bf16 a[188:191], a[92:95], a[44:47], a[188:191]
    v_mfma_f32_16x16x32_bf16 a[204:207], a[92:95], a[48:51], a[204:207]
    v_mfma_f32_16x16x32_bf16 a[220:223], a[92:95], a[52:55], a[220:223]
    v_mfma_f32_16x16x32_bf16 a[236:239], a[92:95], a[56:59], a[236:239]
    v_mfma_f32_16x16x32_bf16 a[252:255], a[92:95], a[60:63], a[252:255]
    ds_read_b64_tr_b16 a[92:93], v14 offset:3072
    v_mfma_f32_16x16x32_bf16 v[48:51], a[104:107], a[32:35], v[48:51]
    ds_read_b64_tr_b16 a[94:95], v14 offset:3328
    v_mfma_f32_16x16x32_bf16 v[52:55], a[104:107], a[36:39], v[52:55]
    v_mfma_f32_16x16x32_bf16 v[64:67], a[104:107], a[40:43], v[64:67]
    v_mfma_f32_16x16x32_bf16 v[68:71], a[104:107], a[44:47], v[68:71]
    v_mfma_f32_16x16x32_bf16 v[80:83], a[104:107], a[48:51], v[80:83]
    v_mfma_f32_16x16x32_bf16 v[84:87], a[104:107], a[52:55], v[84:87]
    v_mfma_f32_16x16x32_bf16 v[96:99], a[104:107], a[56:59], v[96:99]
    v_mfma_f32_16x16x32_bf16 v[100:103], a[104:107], a[60:63], v[100:103]
    v_mfma_f32_16x16x32_bf16 v[56:59], a[108:111], a[32:35], v[56:59]
    v_mfma_f32_16x16x32_bf16 v[60:63], a[108:111], a[36:39], v[60:63]
    v_mfma_f32_16x16x32_bf16 v[72:75], a[108:111], a[40:43], v[72:75]
    v_mfma_f32_16x16x32_bf16 v[76:79], a[108:111], a[44:47], v[76:79]
    v_mfma_f32_16x16x32_bf16 v[88:91], a[108:111], a[48:51], v[88:91]
    v_mfma_f32_16x16x32_bf16 v[92:95], a[108:111], a[52:55], v[92:95]
    v_mfma_f32_16x16x32_bf16 v[104:107], a[108:111], a[56:59], v[104:107]
    v_mfma_f32_16x16x32_bf16 v[108:111], a[108:111], a[60:63], v[108:111]
    s_sub_u32 s67, s67, 1
    s_cmp_lg_u32 s67, 0
    s_cbranch_scc1 L_loop1
L_tail1:
    s_waitcnt vmcnt(24) lgkmcnt(0)
    s_barrier
    v_mfma_f32_16x16x32_bf16 v[128:131], a[64:67], a[0:3], v[128:131]
    s_getpc_b64 s[86:87]
L_pc1:
    s_sub_u32 s86, s86, L_pc1-L_tail0
    s_subb_u32 s87, s87, 0
    s_lshr_b32 s82, s2, 3
    s_lshl_b32 s82, s82, 2
    s_add_u32 s82, s82, s60
    s_lshl_b32 s82, s82, 10
    v_add_u32 v34, s82, v16
    v_min_u32 v34, L_code_end-L_tail0-4, v34
    global_load_dword v7, v34, s[86:87]
    v_mfma_f32_16x16x32_bf16 v[144:147], a[64:67], a[4:7], v[144:147]
    v_mfma_f32_16x16x32_bf16 v[160:163], a[64:67], a[8:11], v[160:163]
    ds_read_b128 a[32:35], v9 offset:0
    v_mfma_f32_16x16x32_bf16 v[176:179], a[64:67], a[12:15], v[176:179]
    v_mfma_f32_16x16x32_bf16 v[192:195], a[64:67], a[16:19], v[192:195]
    s_mul_i32 s82, s65, 1835008
    s_lshl_b32 s83, s66, 8
    v_mfma_f32_16x16x32_bf16 v[208:211], a[64:67], a[20:23], v[208:211]
    s_add_u32 s82, s82, s83
    s_add_u32 s48, s20, s82
    v_mfma_f32_16x16x32_bf16 v[224:227], a[64:67], a[24:27], v[224:227]
    ds_read_b128 a[36:39], v9 offset:2048
    s_addc_u32 s49, s21, 0
    s_and_b32 s49, s49, 0xffff
    v_mfma_f32_16x16x32_bf16 v[240:243], a[64:67], a[28:31], v[240:243]
    ds_read_b64_tr_b16 a[64:65], v12 offset:20480
    s_sub_u32 s50, 7340032, s82
    s_mov_b32 s51, 0x20000
    v_mfma_f32_16x16x32_bf16 v[132:135], a[68:71], a[0:3], v[132:135]
    ds_read_b64_tr_b16 a[66:67], v12 offset:20736
    s_add_u32 s52, s12, s83
    s_addc_u32 s53, s13, 0
    v_mfma_f32_16x16x32_bf16 v[148:151], a[68:71], a[4:7], v[148:151]
    s_and_b32 s53, s53, 0xffff
    s_sub_u32 s54, 2097152, s83
    v_mfma_f32_16x16x32_bf16 v[164:167], a[68:71], a[8:11], v[164:167]
    ds_read_b128 a[40:43], v9 offset:4096
    s_mov_b32 s55, 0x20000
    s_lshl_b32 s3, s60, 11
    v_mfma_f32_16x16x32_bf16 v[180:183], a[68:71], a[12:15], v[180:183]
    v_lshrrev_b32 v34, 4, v0
    v_and_b32 v35, 15, v0
    v_mfma_f32_16x16x32_bf16 v[196:199], a[68:71], a[16:19], v[196:199]
    v_lshlrev_b32 v36, 1, v34
    v_add_u32 v36, 0, v36
    v_mfma_f32_16x16x32_bf16 v[212:215], a[68:71], a[20:23], v[212:215]
    v_xor_b32 v36, v36, v35
    v_lshlrev_b32 v36, 4, v36
    v_mfma_f32_16x16x32_bf16 v[228:231], a[68:71], a[24:27], v[228:231]
    ds_read_b128 a[44:47], v9 offset:6144
    v_lshl_add_u32 v36, v34, 11, v36
    s_lshl_b32 s82, s60, 14
    v_mfma_f32_16x16x32_bf16 v[244:247], a[68:71], a[28:31], v[244:247]
    ds_read_b64_tr_b16 a[68:69], v14 offset:20480
    s_add_u32 s82, s82, 0
    v_add_u32 v17, s82, v36
    v_mfma_f32_16x16x32_bf16 v[136:139], a[72:75], a[0:3], v[136:139]
    ds_read_b64_tr_b16 a[70:71], v14 offset:20736
    s_lshl_b32 s82, s62, 1
    s_add_u32 s82, s82, 0
    v_mfma_f32_16x16x32_bf16 v[152:155], a[72:75], a[4:7], v[152:155]
    s_lshl_b32 s82, s82, 3
    s_lshl_b32 s83, s61, 2
    v_mfma_f32_16x16x32_bf16 v[168:171], a[72:75], a[8:11], v[168:171]
    ds_read_b128 a[48:51], v9 offset:8192
    s_add_u32 s82, s82, s83
    s_mul_i32 s83, s62, 96
    v_mfma_f32_16x16x32_bf16 v[184:187], a[72:75], a[12:15], v[184:187]
    s_add_u32 s82, s82, s83
    s_lshl_b32 s82, s82, 11
    v_mfma_f32_16x16x32_bf16 v[200:203], a[72:75], a[16:19], v[200:203]
    s_sub_u32 s82, s82, 0
    v_add_u32 v19, s82, v36
    v_mfma_f32_16x16x32_bf16 v[216:219], a[72:75], a[20:23], v[216:219]
    v_lshlrev_b32 v36, 1, v34
    v_add_u32 v36, 8, v36
    v_mfma_f32_16x16x32_bf16 v[232:235], a[72:75], a[24:27], v[232:235]
    ds_read_b128 a[52:55], v9 offset:10240
    v_xor_b32 v36, v36, v35
    v_lshlrev_b32 v36, 4, v36
    v_mfma_f32_16x16x32_bf16 v[248:251], a[72:75], a[28:31], v[248:251]
    ds_read_b64_tr_b16 a[72:73], v12 offset:21504
    v_lshl_add_u32 v36, v34, 11, v36
    s_lshl_b32 s82, s60, 14
    v_mfma_f32_16x16x32_bf16 v[140:143], a[76:79], a[0:3], v[140:143]
    ds_read_b64_tr_b16 a[74:75], v12 offset:21760
    s_add_u32 s82, s82, 7168
    v_add_u32 v18, s82, v36
    v_mfma_f32_16x16x32_bf16 v[156:159], a[76:79], a[4:7], v[156:159]
    s_lshl_b32 s82, s62, 1
    s_add_u32 s82, s82, 1
    v_mfma_f32_16x16x32_bf16 v[172:175], a[76:79], a[8:11], v[172:175]
    ds_read_b128 a[56:59], v9 offset:12288
    s_lshl_b32 s82, s82, 3
    s_lshl_b32 s83, s61, 2
    v_mfma_f32_16x16x32_bf16 v[188:191], a[76:79], a[12:15], v[188:191]
    s_add_u32 s82, s82, s83
    s_mul_i32 s83, s62, 96
    v_mfma_f32_16x16x32_bf16 v[204:207], a[76:79], a[16:19], v[204:207]
    s_add_u32 s82, s82, s83
    s_lshl_b32 s82, s82, 11
    v_mfma_f32_16x16x32_bf16 v[220:223], a[76:79], a[20:23], v[220:223]
    s_sub_u32 s82, s82, 1024
    v_add_u32 v20, s82, v36
    v_mfma_f32_16x16x32_bf16 v[236:239], a[76:79], a[24:27], v[236:239]
    ds_read_b128 a[60:63], v9 offset:14336
    v_mfma_f32_16x16x32_bf16 v[252:255], a[76:79], a[28:31], v[252:255]
    ds_read_b64_tr_b16 a[76:77], v14 offset:21504
    v_mfma_f32_16x16x32_bf16 a[128:131], a[80:83], a[0:3], a[128:131]
    ds_read_b64_tr_b16 a[78:79], v14 offset:21760
    v_mfma_f32_16x16x32_bf16 a[144:147], a[80:83], a[4:7], a[144:147]
    v_mfma_f32_16x16x32_bf16 a[160:163], a[80:83], a[8:11], a[160:163]
    ds_read_b64_tr_b16 a[104:105], v12 offset:24576
    v_mfma_f32_16x16x32_bf16 a[176:179], a[80:83], a[12:15], a[176:179]
    v_mfma_f32_16x16x32_bf16 a[192:195], a[80:83], a[16:19], a[192:195]
    v_mfma_f32_16x16x32_bf16 a[208:211], a[80:83], a[20:23], a[208:211]
    v_mfma_f32_16x16x32_bf16 a[224:227], a[80:83], a[24:27], a[224:227]
    ds_read_b64_tr_b16 a[106:107], v12 offset:24832
    v_mfma_f32_16x16x32_bf16 a[240:243], a[80:83], a[28:31], a[240:243]
    ds_read_b64_tr_b16 a[80:81], v12 offset:22528
    v_mfma_f32_16x16x32_bf16 a[132:135], a[84:87], a[0:3], a[132:135]
    ds_read_b64_tr_b16 a[82:83], v12 offset:22784
    v_mfma_f32_16x16x32_bf16 a[148:151], a[84:87], a[4:7], a[148:151]
    v_mfma_f32_16x16x32_bf16 a[164:167], a[84:87], a[8:11], a[164:167]
    ds_read_b64_tr_b16 a[108:109], v14 offset:24576
    v_mfma_f32_16x16x32_bf16 a[180:183], a[84:87], a[12:15], a[180:183]
    v_mfma_f32_16x16x32_bf16 a[196:199], a[84:87], a[16:19], a[196:199]
    s_mov_b32 s81, 294912
    s_add_u32 m0, s3, 73728
    v_mfma_f32_16x16x32_bf16 a[212:215], a[84:87], a[20:23], a[212:215]
    buffer_load_dwordx4 v17, s[48:51], s81 offen lds
    v_mfma_f32_16x16x32_bf16 a[228:231], a[84:87], a[24:27], a[228:231]
    ds_read_b64_tr_b16 a[110:111], v14 offset:24832
    v_mfma_f32_16x16x32_bf16 a[244:247], a[84:87], a[28:31], a[244:247]
    ds_read_b64_tr_b16 a[84:85], v14 offset:22528
    v_mfma_f32_16x16x32_bf16 a[136:139], a[88:91], a[0:3], a[136:139]
    ds_read_b64_tr_b16 a[86:87], v14 offset:22784
    v_mfma_f32_16x16x32_bf16 a[152:155], a[88:91], a[4:7], a[152:155]
    v_mfma_f32_16x16x32_bf16 a[168:171], a[88:91], a[8:11], a[168:171]
    buffer_load_dwordx4 v18, s[48:51], s81 offen offset:1024 lds
    v_mfma_f32_16x16x32_bf16 a[184:187], a[88:91], a[12:15], a[184:187]
    v_mfma_f32_16x16x32_bf16 a[200:203], a[88:91], a[16:19], a[200:203]
    v_mfma_f32_16x16x32_bf16 a[216:219], a[88:91], a[20:23], a[216:219]
    v_mfma_f32_16x16x32_bf16 a[232:235], a[88:91], a[24:27], a[232:235]
    s_mov_b32 s80, 524288
    s_add_u32 m0, s3, 81920
    v_mfma_f32_16x16x32_bf16 a[248:251], a[88:91], a[28:31], a[248:251]
    ds_read_b64_tr_b16 a[88:89], v12 offset:23552
    buffer_load_dwordx4 v17, s[48:51], s80 offen lds
    v_mfma_f32_16x16x32_bf16 a[140:143], a[92:95], a[0:3], a[140:143]
    ds_read_b64_tr_b16 a[90:91], v12 offset:23808
    v_mfma_f32_16x16x32_bf16 a[156:159], a[92:95], a[4:7], a[156:159]
    v_mfma_f32_16x16x32_bf16 a[172:175], a[92:95], a[8:11], a[172:175]
    v_mfma_f32_16x16x32_bf16 a[188:191], a[92:95], a[12:15], a[188:191]
    v_mfma_f32_16x16x32_bf16 a[204:207], a[92:95], a[16:19], a[204:207]
    buffer_load_dwordx4 v18, s[48:51], s80 offen offset:1024 lds
    v_mfma_f32_16x16x32_bf16 a[220:223], a[92:95], a[20:23], a[220:223]
    v_mfma_f32_16x16x32_bf16 a[236:239], a[92:95], a[24:27], a[236:239]
    v_mfma_f32_16x16x32_bf16 a[252:255], a[92:95], a[28:31], a[252:255]
    ds_read_b64_tr_b16 a[92:93], v14 offset:23552
    v_mfma_f32_16x16x32_bf16 v[48:51], a[96:99], a[0:3], v[48:51]
    ds_read_b64_tr_b16 a[94:95], v14 offset:23808
    s_mov_b32 s81, 819200
    s_add_u32 m0, s3, 155648
    v_mfma_f32_16x16x32_bf16 v[52:55], a[96:99], a[4:7], v[52:55]
    buffer_load_dwordx4 v17, s[48:51], s81 offen lds
    v_mfma_f32_16x16x32_bf16 v[64:67], a[96:99], a[8:11], v[64:67]
    v_mfma_f32_16x16x32_bf16 v[68:71], a[96:99], a[12:15], v[68:71]
    v_mfma_f32_16x16x32_bf16 v[80:83], a[96:99], a[16:19], v[80:83]
    v_mfma_f32_16x16x32_bf16 v[84:87], a[96:99], a[20:23], v[84:87]
    v_mfma_f32_16x16x32_bf16 v[96:99], a[96:99], a[24:27], v[96:99]
    buffer_load_dwordx4 v18, s[48:51], s81 offen offset:1024 lds
    v_mfma_f32_16x16x32_bf16 v[100:103], a[96:99], a[28:31], v[100:103]
    v_mfma_f32_16x16x32_bf16 v[56:59], a[100:103], a[0:3], v[56:59]
    v_mfma_f32_16x16x32_bf16 v[60:63], a[100:103], a[4:7], v[60:63]
    v_mfma_f32_16x16x32_bf16 v[72:75], a[100:103], a[8:11], v[72:75]
    v_mfma_f32_16x16x32_bf16 v[76:79], a[100:103], a[12:15], v[76:79]
    v_mfma_f32_16x16x32_bf16 v[88:91], a[100:103], a[16:19], v[88:91]
    v_mfma_f32_16x16x32_bf16 v[92:95], a[100:103], a[20:23], v[92:95]
    v_mfma_f32_16x16x32_bf16 v[104:107], a[100:103], a[24:27], v[104:107]
    v_mfma_f32_16x16x32_bf16 v[108:111], a[100:103], a[28:31], v[108:111]
    s_waitcnt vmcnt(17) lgkmcnt(0)
    s_barrier
    v_mfma_f32_16x16x32_bf16 v[128:131], a[64:67], a[32:35], v[128:131]
    v_mfma_f32_16x16x32_bf16 v[144:147], a[64:67], a[36:39], v[144:147]
    v_mfma_f32_16x16x32_bf16 v[160:163], a[64:67], a[40:43], v[160:163]
    ds_read_b128 a[0:3], v8 offset:34816
    s_mov_b32 s80, 0
    s_add_u32 m0, s3, 0
    v_mfma_f32_16x16x32_bf16 v[176:179], a[64:67], a[44:47], v[176:179]
    buffer_load_dwordx4 v17, s[48:51], s80 offen lds
    v_mfma_f32_16x16x32_bf16 v[192:195], a[64:67], a[48:51], v[192:195]
    s_xor_b32 s82, s65, 0
    v_mfma_f32_16x16x32_bf16 v[208:211], a[64:67], a[52:55], v[208:211]
    s_lshl_b32 s82, s82, 10
    v_mfma_f32_16x16x32_bf16 v[224:227], a[64:67], a[56:59], v[224:227]
    ds_read_b128 a[4:7], v8 offset:36864
    v_add_u32 v21, s82, v16
    v_mfma_f32_16x16x32_bf16 v[240:243], a[64:67], a[60:63], v[240:243]
    ds_read_b64_tr_b16 a[64:65], v13 offset:0
    s_xor_b32 s82, s65, 1
    v_mfma_f32_16x16x32_bf16 v[132:135], a[68:71], a[32:35], v[132:135]
    ds_read_b64_tr_b16 a[66:67], v13 offset:256
    s_lshl_b32 s82, s82, 10
    v_mfma_f32_16x16x32_bf16 v[148:151], a[68:71], a[36:39], v[148:151]
    v_add_u32 v22, s82, v16
    buffer_load_dwordx4 v18, s[48:51], s80 offen offset:1024 lds
    v_mfma_f32_16x16x32_bf16 v[164:167], a[68:71], a[40:43], v[164:167]
    ds_read_b128 a[8:11], v8 offset:38912
    s_xor_b32 s82, s65, 2
    v_mfma_f32_16x16x32_bf16 v[180:183], a[68:71], a[44:47], v[180:183]
    s_lshl_b32 s82, s82, 10
    v_mfma_f32_16x16x32_bf16 v[196:199], a[68:71], a[48:51], v[196:199]
    v_add_u32 v23, s82, v16
    v_mfma_f32_16x16x32_bf16 v[212:215], a[68:71], a[52:55], v[212:215]
    s_xor_b32 s82, s65, 3
    v_mfma_f32_16x16x32_bf16 v[228:231], a[68:71], a[56:59], v[228:231]
    ds_read_b128 a[12:15], v8 offset:40960
    s_lshl_b32 s82, s82, 10
    s_mov_b32 s81, 229376
    s_add_u32 m0, s3, 8192
    v_mfma_f32_16x16x32_bf16 v[244:247], a[68:71], a[60:63], v[244:247]
    ds_read_b64_tr_b16 a[68:69], v15 offset:0
    v_add_u32 v24, s82, v16
    buffer_load_dwordx4 v17, s[48:51], s81 offen lds
    v_mfma_f32_16x16x32_bf16 v[136:139], a[72:75], a[32:35], v[136:139]
    ds_read_b64_tr_b16 a[70:71], v15 offset:256
    s_mov_b32 s94, 0xbdd2d3e8
    v_mfma_f32_16x16x32_bf16 v[152:155], a[72:75], a[36:39], v[152:155]
    s_mov_b32 s95, 0xbdd2d3e8
    v_mfma_f32_16x16x32_bf16 v[168:171], a[72:75], a[40:43], v[168:171]
    ds_read_b128 a[16:19], v8 offset:43008
    v_mov_b32 v26, 0xc0135761
    v_mfma_f32_16x16x32_bf16 v[184:187], a[72:75], a[44:47], v[184:187]
    v_mov_b32 v27, 0xc0135761
    v_mfma_f32_16x16x32_bf16 v[200:203], a[72:75], a[48:51], v[200:203]
    v_mov_b32 v25, 1
    v_mfma_f32_16x16x32_bf16 v[216:219], a[72:75], a[52:55], v[216:219]
    s_lshl_b32 s82, s60, 12
    buffer_load_dwordx4 v18, s[48:51], s81 offen offset:1024 lds
    v_mfma_f32_16x16x32_bf16 v[232:235], a[72:75], a[56:59], v[232:235]
    ds_read_b128 a[20:23], v8 offset:45056
    s_add_u32 s68, s88, s82
    v_mfma_f32_16x16x32_bf16 v[248:251], a[72:75], a[60:63], v[248:251]
    ds_read_b64_tr_b16 a[72:73], v13 offset:1024
    s_lshl_b32 s82, s61, 13
    v_mfma_f32_16x16x32_bf16 v[140:143], a[76:79], a[32:35], v[140:143]
    ds_read_b64_tr_b16 a[74:75], v13 offset:1280
    s_add_u32 s88, s88, s82
    v_mfma_f32_16x16x32_bf16 v[156:159], a[76:79], a[36:39], v[156:159]
    s_lshr_b32 s82, s66, 1
    v_mfma_f32_16x16x32_bf16 v[172:175], a[76:79], a[40:43], v[172:175]
    ds_read_b128 a[24:27], v8 offset:47104
    s_add_u32 s82, s82, 24
    s_mov_b32 s80, 458752
    s_add_u32 m0, s3, 16384
    v_mfma_f32_16x16x32_bf16 v[188:191], a[76:79], a[44:47], v[188:191]
    s_lshl_b32 s82, s82, 14
    buffer_load_dwordx4 v17, s[48:51], s80 offen lds
    v_mfma_f32_16x16x32_bf16 v[204:207], a[76:79], a[48:51], v[204:207]
    s_add_u32 s90, s88, s82
    v_mfma_f32_16x16x32_bf16 v[220:223], a[76:79], a[52:55], v[220:223]
    s_lshl_b32 s82, s66, 14
    v_mfma_f32_16x16x32_bf16 v[236:239], a[76:79], a[56:59], v[236:239]
    ds_read_b128 a[28:31], v8 offset:49152
    s_add_u32 s88, s88, s82
    v_mfma_f32_16x16x32_bf16 v[252:255], a[76:79], a[60:63], v[252:255]
    ds_read_b64_tr_b16 a[76:77], v15 offset:1024
    s_branch L_over3
L_stub3:
    s_branch L_stub7
L_over3:
    s_add_u32 s89, s88, 262144
    v_mfma_f32_16x16x32_bf16 a[128:131], a[80:83], a[32:35], a[128:131]
    ds_read_b64_tr_b16 a[78:79], v15 offset:1280
    s_add_u32 s88, s88, 131072
    v_mfma_f32_16x16x32_bf16 a[144:147], a[80:83], a[36:39], a[144:147]
    s_mov_b32 s76, s93
    buffer_load_dwordx4 v18, s[48:51], s80 offen offset:1024 lds
    v_mfma_f32_16x16x32_bf16 a[160:163], a[80:83], a[40:43], a[160:163]
    ds_read_b64_tr_b16 a[96:97], v13 offset:4096
    s_lshl_b32 s82, s63, 4
    v_mfma_f32_16x16x32_bf16 a[176:179], a[80:83], a[44:47], a[176:179]
    s_lshl_b32 s83, s61, 3
    v_mfma_f32_16x16x32_bf16 a[192:195], a[80:83], a[48:51], a[192:195]
    s_add_u32 s83, s83, s82
    v_mfma_f32_16x16x32_bf16 a[208:211], a[80:83], a[52:55], a[208:211]
    s_add_u32 s83, s83, s65
    v_mfma_f32_16x16x32_bf16 a[224:227], a[80:83], a[56:59], a[224:227]
    ds_read_b64_tr_b16 a[98:99], v13 offset:4352
    s_lshl_b32 s83, s83, 15
    s_mov_b32 s81, 688128
    s_add_u32 m0, s3, 24576
    v_mfma_f32_16x16x32_bf16 a[240:243], a[80:83], a[60:63], a[240:243]
    ds_read_b64_tr_b16 a[80:81], v13 offset:2048
    s_add_u32 s69, s83, 4194304
    buffer_load_dwordx4 v17, s[48:51], s81 offen lds
    v_mfma_f32_16x16x32_bf16 a[132:135], a[84:87], a[32:35], a[132:135]
    ds_read_b64_tr_b16 a[82:83], v13 offset:2304
    s_lshl_b32 s84, s63, 3
    v_mfma_f32_16x16x32_bf16 a[148:151], a[84:87], a[36:39], a[148:151]
    s_add_u32 s84, s84, s66
    v_mfma_f32_16x16x32_bf16 a[164:167], a[84:87], a[40:43], a[164:167]
    ds_read_b64_tr_b16 a[100:101], v15 offset:4096
    s_lshl_b32 s85, s84, 2
    v_mfma_f32_16x16x32_bf16 a[180:183], a[84:87], a[44:47], a[180:183]
    v_mfma_f32_16x16x32_bf16 a[196:199], a[84:87], a[48:51], a[196:199]
    v_mfma_f32_16x16x32_bf16 a[212:215], a[84:87], a[52:55], a[212:215]
    buffer_load_dwordx4 v18, s[48:51], s81 offen offset:1024 lds
    v_mfma_f32_16x16x32_bf16 a[228:231], a[84:87], a[56:59], a[228:231]
    ds_read_b64_tr_b16 a[102:103], v15 offset:4352
    v_mfma_f32_16x16x32_bf16 a[244:247], a[84:87], a[60:63], a[244:247]
    ds_read_b64_tr_b16 a[84:85], v15 offset:2048
    v_mfma_f32_16x16x32_bf16 a[136:139], a[88:91], a[32:35], a[136:139]
    ds_read_b64_tr_b16 a[86:87], v15 offset:2304
    v_mfma_f32_16x16x32_bf16 a[152:155], a[88:91], a[36:39], a[152:155]
    v_mfma_f32_16x16x32_bf16 a[168:171], a[88:91], a[40:43], a[168:171]
    s_mov_b32 s81, 753664
    s_add_u32 m0, s3, 90112
    v_mfma_f32_16x16x32_bf16 a[184:187], a[88:91], a[44:47], a[184:187]
    buffer_load_dwordx4 v17, s[48:51], s81 offen lds
    v_mfma_f32_16x16x32_bf16 a[200:203], a[88:91], a[48:51], a[200:203]
    v_mfma_f32_16x16x32_bf16 a[216:219], a[88:91], a[52:55], a[216:219]
    v_mfma_f32_16x16x32_bf16 a[232:235], a[88:91], a[56:59], a[232:235]
    v_mfma_f32_16x16x32_bf16 a[248:251], a[88:91], a[60:63], a[248:251]
    ds_read_b64_tr_b16 a[88:89], v13 offset:3072
    v_mfma_f32_16x16x32_bf16 a[140:143], a[92:95], a[32:35], a[140:143]
    ds_read_b64_tr_b16 a[90:91], v13 offset:3328
    v_mfma_f32_16x16x32_bf16 a[156:159], a[92:95], a[36:39], a[156:159]
    buffer_load_dwordx4 v18, s[48:51], s81 offen offset:1024 lds
    v_mfma_f32_16x16x32_bf16 a[172:175], a[92:95], a[40:43], a[172:175]
    v_mfma_f32_16x16x32_bf16 a[188:191], a[92:95], a[44:47], a[188:191]
    v_mfma_f32_16x16x32_bf16 a[204:207], a[92:95], a[48:51], a[204:207]
    v_mfma_f32_16x16x32_bf16 a[220:223], a[92:95], a[52:55], a[220:223]
    v_mfma_f32_16x16x32_bf16 a[236:239], a[92:95], a[56:59], a[236:239]
    s_mov_b32 s80, 983040
    s_add_u32 m0, s3, 98304
    v_mfma_f32_16x16x32_bf16 a[252:255], a[92:95], a[60:63], a[252:255]
    ds_read_b64_tr_b16 a[92:93], v15 offset:3072
    buffer_load_dwordx4 v17, s[48:51], s80 offen lds
    v_mfma_f32_16x16x32_bf16 v[48:51], a[104:107], a[32:35], v[48:51]
    ds_read_b64_tr_b16 a[94:95], v15 offset:3328
    v_mfma_f32_16x16x32_bf16 v[52:55], a[104:107], a[36:39], v[52:55]
    v_mfma_f32_16x16x32_bf16 v[64:67], a[104:107], a[40:43], v[64:67]
    v_mfma_f32_16x16x32_bf16 v[68:71], a[104:107], a[44:47], v[68:71]
    v_mfma_f32_16x16x32_bf16 v[80:83], a[104:107], a[48:51], v[80:83]
    v_mfma_f32_16x16x32_bf16 v[84:87], a[104:107], a[52:55], v[84:87]
    buffer_load_dwordx4 v18, s[48:51], s80 offen offset:1024 lds
    v_mfma_f32_16x16x32_bf16 v[96:99], a[104:107], a[56:59], v[96:99]
    v_mfma_f32_16x16x32_bf16 v[100:103], a[104:107], a[60:63], v[100:103]
    v_mfma_f32_16x16x32_bf16 v[56:59], a[108:111], a[32:35], v[56:59]
    v_mfma_f32_16x16x32_bf16 v[60:63], a[108:111], a[36:39], v[60:63]
    v_mfma_f32_16x16x32_bf16 v[72:75], a[108:111], a[40:43], v[72:75]
    v_mfma_f32_16x16x32_bf16 v[76:79], a[108:111], a[44:47], v[76:79]
    v_mfma_f32_16x16x32_bf16 v[88:91], a[108:111], a[48:51], v[88:91]
    v_mfma_f32_16x16x32_bf16 v[92:95], a[108:111], a[52:55], v[92:95]
    v_mfma_f32_16x16x32_bf16 v[104:107], a[108:111], a[56:59], v[104:107]
    v_mfma_f32_16x16x32_bf16 v[108:111], a[108:111], a[60:63], v[108:111]
    s_waitcnt vmcnt(19) lgkmcnt(0)
    s_barrier
    v_mfma_f32_16x16x32_bf16 v[128:131], a[64:67], a[0:3], v[128:131]
    v_mfma_f32_16x16x32_bf16 v[144:147], a[64:67], a[4:7], v[144:147]
    v_mfma_f32_16x16x32_bf16 v[160:163], a[64:67], a[8:11], v[160:163]
    ds_read_b128 a[32:35], v9 offset:34816
    s_mov_b32 s81, 1212416
    s_add_u32 m0, s3, 106496
    v_mfma_f32_16x16x32_bf16 v[176:179], a[64:67], a[12:15], v[176:179]
    buffer_load_dwordx4 v17, s[48:51], s81 offen lds
    v_mfma_f32_16x16x32_bf16 v[192:195], a[64:67], a[16:19], v[192:195]
    s_add_u32 s85, s85, s60
    v_mfma_f32_16x16x32_bf16 v[208:211], a[64:67], a[20:23], v[208:211]
    s_lshl_b32 s85, s85, 8
    v_mfma_f32_16x16x32_bf16 v[224:227], a[64:67], a[24:27], v[224:227]
    ds_read_b128 a[36:39], v9 offset:36864
    s_add_u32 s77, s85, 39862272
    v_mfma_f32_16x16x32_bf16 v[240:243], a[64:67], a[28:31], v[240:243]
    ds_read_b64_tr_b16 a[64:65], v13 offset:20480
    s_lshl_b32 s84, s84, 18
    v_mfma_f32_16x16x32_bf16 v[132:135], a[68:71], a[0:3], v[132:135]
    ds_read_b64_tr_b16 a[66:67], v13 offset:20736
    s_lshl_b32 s85, s60, 12
    v_mfma_f32_16x16x32_bf16 v[148:151], a[68:71], a[4:7], v[148:151]
    s_add_u32 s84, s84, s85
    v_mfma_f32_16x16x32_bf16 v[164:167], a[68:71], a[8:11], v[164:167]
    ds_read_b128 a[40:43], v9 offset:38912
    s_add_u32 s84, s84, 23068672
    v_mfma_f32_16x16x32_bf16 v[180:183], a[68:71], a[12:15], v[180:183]
    s_xor_b32 s85, s65, 1
    v_mfma_f32_16x16x32_bf16 v[196:199], a[68:71], a[16:19], v[196:199]
    s_lshl_b32 s85, s85, 16
    v_mfma_f32_16x16x32_bf16 v[212:215], a[68:71], a[20:23], v[212:215]
    s_add_u32 s70, s84, s85
    v_mfma_f32_16x16x32_bf16 v[228:231], a[68:71], a[24:27], v[228:231]
    ds_read_b128 a[44:47], v9 offset:40960
    s_add_u32 s70, s70, 16384
    v_mfma_f32_16x16x32_bf16 v[244:247], a[68:71], a[28:31], v[244:247]
    ds_read_b64_tr_b16 a[68:69], v15 offset:20480
    s_lshl_b32 s85, s65, 16
    buffer_load_dwordx4 v18, s[48:51], s81 offen offset:1024 lds
    v_mfma_f32_16x16x32_bf16 v[136:139], a[72:75], a[0:3], v[136:139]
    ds_read_b64_tr_b16 a[70:71], v15 offset:20736
    s_add_u32 s73, s84, s85
    v_mfma_f32_16x16x32_bf16 v[152:155], a[72:75], a[4:7], v[152:155]
    s_add_u32 s73, s73, 16384
    v_mfma_f32_16x16x32_bf16 v[168:171], a[72:75], a[8:11], v[168:171]
    ds_read_b128 a[48:51], v9 offset:43008
    s_xor_b32 s85, s65, 2
    v_mfma_f32_16x16x32_bf16 v[184:187], a[72:75], a[12:15], v[184:187]
    s_lshl_b32 s85, s85, 16
    v_mfma_f32_16x16x32_bf16 v[200:203], a[72:75], a[16:19], v[200:203]
    s_add_u32 s71, s84, s85
    v_mfma_f32_16x16x32_bf16 v[216:219], a[72:75], a[20:23], v[216:219]
    s_add_u32 s71, s71, 32768
    v_mfma_f32_16x16x32_bf16 v[232:235], a[72:75], a[24:27], v[232:235]
    ds_read_b128 a[52:55], v9 offset:45056
    s_lshl_b32 s85, s65, 16
    v_mfma_f32_16x16x32_bf16 v[248:251], a[72:75], a[28:31], v[248:251]
    ds_read_b64_tr_b16 a[72:73], v13 offset:21504
    s_add_u32 s74, s84, s85
    v_mfma_f32_16x16x32_bf16 v[140:143], a[76:79], a[0:3], v[140:143]
    ds_read_b64_tr_b16 a[74:75], v13 offset:21760
    s_add_u32 s74, s74, 32768
    v_mfma_f32_16x16x32_bf16 v[156:159], a[76:79], a[4:7], v[156:159]
    s_xor_b32 s85, s65, 3
    v_mfma_f32_16x16x32_bf16 v[172:175], a[76:79], a[8:11], v[172:175]
    ds_read_b128 a[56:59], v9 offset:47104
    s_lshl_b32 s85, s85, 16
    s_mov_b32 s80, 1441792
    s_add_u32 m0, s3, 114688
    v_mfma_f32_16x16x32_bf16 v[188:191], a[76:79], a[12:15], v[188:191]
    s_add_u32 s72, s84, s85
    buffer_load_dwordx4 v17, s[48:51], s80 offen lds
    v_mfma_f32_16x16x32_bf16 v[204:207], a[76:79], a[16:19], v[204:207]
    s_add_u32 s72, s72, 49152
    v_mfma_f32_16x16x32_bf16 v[220:223], a[76:79], a[20:23], v[220:223]
    s_lshl_b32 s85, s65, 16
    v_mfma_f32_16x16x32_bf16 v[236:239], a[76:79], a[24:27], v[236:239]
    ds_read_b128 a[60:63], v9 offset:49152
    s_add_u32 s75, s84, s85
    v_mfma_f32_16x16x32_bf16 v[252:255], a[76:79], a[28:31], v[252:255]
    ds_read_b64_tr_b16 a[76:77], v15 offset:21504
    s_add_u32 s75, s75, 49152
    v_mfma_f32_16x16x32_bf16 a[128:131], a[80:83], a[0:3], a[128:131]
    ds_read_b64_tr_b16 a[78:79], v15 offset:21760
    v_and_b32 v36, 1, v34
    v_mfma_f32_16x16x32_bf16 a[144:147], a[80:83], a[4:7], a[144:147]
    v_lshlrev_b32 v36, 10, v36
    v_mfma_f32_16x16x32_bf16 a[160:163], a[80:83], a[8:11], a[160:163]
    ds_read_b64_tr_b16 a[104:105], v13 offset:24576
    v_lshrrev_b32 v34, 1, v34
    v_mfma_f32_16x16x32_bf16 a[176:179], a[80:83], a[12:15], a[176:179]
    v_lshl_add_u32 v36, v34, 8, v36
    v_mfma_f32_16x16x32_bf16 a[192:195], a[80:83], a[16:19], a[192:195]
    v_lshl_add_u32 v36, v35, 4, v36
    v_mfma_f32_16x16x32_bf16 a[208:211], a[80:83], a[20:23], a[208:211]
    s_and_b32 s82, s66, 1
    v_mfma_f32_16x16x32_bf16 a[224:227], a[80:83], a[24:27], a[224:227]
    ds_read_b64_tr_b16 a[106:107], v13 offset:24832
    s_lshl_b32 s82, s82, 9
    v_mfma_f32_16x16x32_bf16 a[240:243], a[80:83], a[28:31], a[240:243]
    ds_read_b64_tr_b16 a[80:81], v13 offset:22528
    v_add_u32 v28, s82, v36
    buffer_load_dwordx4 v18, s[48:51], s80 offen offset:1024 lds
    v_mfma_f32_16x16x32_bf16 a[132:135], a[84:87], a[0:3], a[132:135]
    ds_read_b64_tr_b16 a[82:83], v13 offset:22784
    v_mov_b32 v29, 0x100
    v_mfma_f32_16x16x32_bf16 a[148:151], a[84:87], a[4:7], a[148:151]
    v_mov_b32 v42, 0x10000
    v_mfma_f32_16x16x32_bf16 a[164:167], a[84:87], a[8:11], a[164:167]
    ds_read_b64_tr_b16 a[108:109], v15 offset:24576
    s_mov_b32 s93, s92
    v_mfma_f32_16x16x32_bf16 a[180:183], a[84:87], a[12:15], a[180:183]
    v_mfma_f32_16x16x32_bf16 a[196:199], a[84:87], a[16:19], a[196:199]
    v_mfma_f32_16x16x32_bf16 a[212:215], a[84:87], a[20:23], a[212:215]
    v_mfma_f32_16x16x32_bf16 a[228:231], a[84:87], a[24:27], a[228:231]
    ds_read_b64_tr_b16 a[110:111], v15 offset:24832
    v_mfma_f32_16x16x32_bf16 a[244:247], a[84:87], a[28:31], a[244:247]
    ds_read_b64_tr_b16 a[84:85], v15 offset:22528
    v_mfma_f32_16x16x32_bf16 a[136:139], a[88:91], a[0:3], a[136:139]
    ds_read_b64_tr_b16 a[86:87], v15 offset:22784
    v_mfma_f32_16x16x32_bf16 a[152:155], a[88:91], a[4:7], a[152:155]
    v_mfma_f32_16x16x32_bf16 a[168:171], a[88:91], a[8:11], a[168:171]
    s_mov_b32 s81, 1671168
    s_add_u32 m0, s3, 122880
    v_mfma_f32_16x16x32_bf16 a[184:187], a[88:91], a[12:15], a[184:187]
    buffer_load_dwordx4 v17, s[48:51], s81 offen lds
    v_mfma_f32_16x16x32_bf16 a[200:203], a[88:91], a[16:19], a[200:203]
    v_mfma_f32_16x16x32_bf16 a[216:219], a[88:91], a[20:23], a[216:219]
    v_mfma_f32_16x16x32_bf16 a[232:235], a[88:91], a[24:27], a[232:235]
    v_mfma_f32_16x16x32_bf16 a[248:251], a[88:91], a[28:31], a[248:251]
    ds_read_b64_tr_b16 a[88:89], v13 offset:23552
    v_mfma_f32_16x16x32_bf16 a[140:143], a[92:95], a[0:3], a[140:143]
    ds_read_b64_tr_b16 a[90:91], v13 offset:23808
    v_mfma_f32_16x16x32_bf16 a[156:159], a[92:95], a[4:7], a[156:159]
    v_mfma_f32_16x16x32_bf16 a[172:175], a[92:95], a[8:11], a[172:175]
    v_mfma_f32_16x16x32_bf16 a[188:191], a[92:95], a[12:15], a[188:191]
    v_mfma_f32_16x16x32_bf16 a[204:207], a[92:95], a[16:19], a[204:207]
    v_mfma_f32_16x16x32_bf16 a[220:223], a[92:95], a[20:23], a[220:223]
    v_mfma_f32_16x16x32_bf16 a[236:239], a[92:95], a[24:27], a[236:239]
    v_mfma_f32_16x16x32_bf16 a[252:255], a[92:95], a[28:31], a[252:255]
    ds_read_b64_tr_b16 a[92:93], v15 offset:23552
    buffer_load_dwordx4 v18, s[48:51], s81 offen offset:1024 lds
    v_mfma_f32_16x16x32_bf16 v[48:51], a[96:99], a[0:3], v[48:51]
    ds_read_b64_tr_b16 a[94:95], v15 offset:23808
    v_mfma_f32_16x16x32_bf16 v[52:55], a[96:99], a[4:7], v[52:55]
    v_mfma_f32_16x16x32_bf16 v[64:67], a[96:99], a[8:11], v[64:67]
    v_mfma_f32_16x16x32_bf16 v[68:71], a[96:99], a[12:15], v[68:71]
    v_mfma_f32_16x16x32_bf16 v[80:83], a[96:99], a[16:19], v[80:83]
    v_mfma_f32_16x16x32_bf16 v[84:87], a[96:99], a[20:23], v[84:87]
    v_mfma_f32_16x16x32_bf16 v[96:99], a[96:99], a[24:27], v[96:99]
    v_mfma_f32_16x16x32_bf16 v[100:103], a[96:99], a[28:31], v[100:103]
    v_mfma_f32_16x16x32_bf16 v[56:59], a[100:103], a[0:3], v[56:59]
    v_mfma_f32_16x16x32_bf16 v[60:63], a[100:103], a[4:7], v[60:63]
    v_mfma_f32_16x16x32_bf16 v[72:75], a[100:103], a[8:11], v[72:75]
    v_mfma_f32_16x16x32_bf16 v[76:79], a[100:103], a[12:15], v[76:79]
    v_mfma_f32_16x16x32_bf16 v[88:91], a[100:103], a[16:19], v[88:91]
    v_mfma_f32_16x16x32_bf16 v[92:95], a[100:103], a[20:23], v[92:95]
    v_mfma_f32_16x16x32_bf16 v[104:107], a[100:103], a[24:27], v[104:107]
    v_mfma_f32_16x16x32_bf16 v[108:111], a[100:103], a[28:31], v[108:111]
    s_waitcnt lgkmcnt(0)
    s_barrier
    v_mfma_f32_16x16x32_bf16 v[128:131], a[64:67], a[32:35], v[128:131]
    v_mfma_f32_16x16x32_bf16 v[144:147], a[64:67], a[36:39], v[144:147]
    v_mfma_f32_16x16x32_bf16 v[160:163], a[64:67], a[40:43], v[160:163]
    s_mov_b32 s80, 917504
    s_add_u32 m0, s3, 32768
    v_mfma_f32_16x16x32_bf16 v[176:179], a[64:67], a[44:47], v[176:179]
    buffer_load_dwordx4 v17, s[48:51], s80 offen lds
    v_mfma_f32_16x16x32_bf16 v[192:195], a[64:67], a[48:51], v[192:195]
    v_lshrrev_b32 v34, 2, v0
    v_mfma_f32_16x16x32_bf16 v[208:211], a[64:67], a[52:55], v[208:211]
    v_and_b32 v35, 3, v0
    v_mfma_f32_16x16x32_bf16 v[224:227], a[64:67], a[56:59], v[224:227]
    v_lshlrev_b32 v35, 3, v35
    v_mfma_f32_16x16x32_bf16 v[240:243], a[64:67], a[60:63], v[240:243]
    buffer_load_dwordx4 v18, s[48:51], s80 offen offset:1024 lds
    v_lshl_add_u32 v35, v34, 8, v35
    v_mfma_f32_16x16x32_bf16 v[132:135], a[68:71], a[32:35], v[132:135]
    v_and_b32 v34, 7, v34
    v_mfma_f32_16x16x32_bf16 v[148:151], a[68:71], a[36:39], v[148:151]
    v_xor_b32 v36, 0, v34
    v_mfma_f32_16x16x32_bf16 v[164:167], a[68:71], a[40:43], v[164:167]
    v_lshl_add_u32 v8, v36, 5, v35
    v_mfma_f32_16x16x32_bf16 v[180:183], a[68:71], a[44:47], v[180:183]
    s_mov_b32 s81, 1146880
    s_add_u32 m0, s3, 40960
    v_xor_b32 v36, 1, v34
    v_mfma_f32_16x16x32_bf16 v[196:199], a[68:71], a[48:51], v[196:199]
    buffer_load_dwordx4 v17, s[48:51], s81 offen lds
    v_lshl_add_u32 v9, v36, 5, v35
    v_mfma_f32_16x16x32_bf16 v[212:215], a[68:71], a[52:55], v[212:215]
    v_xor_b32 v36, 2, v34
    v_mfma_f32_16x16x32_bf16 v[228:231], a[68:71], a[56:59], v[228:231]
    v_lshl_add_u32 v10, v36, 5, v35
    v_mfma_f32_16x16x32_bf16 v[244:247], a[68:71], a[60:63], v[244:247]
    v_xor_b32 v36, 3, v34
    v_mfma_f32_16x16x32_bf16 v[136:139], a[72:75], a[32:35], v[136:139]
    buffer_load_dwordx4 v18, s[48:51], s81 offen offset:1024 lds
    v_lshl_add_u32 v11, v36, 5, v35
    v_mfma_f32_16x16x32_bf16 v[152:155], a[72:75], a[36:39], v[152:155]
    v_xor_b32 v36, 4, v34
    v_mfma_f32_16x16x32_bf16 v[168:171], a[72:75], a[40:43], v[168:171]
    v_lshl_add_u32 v12, v36, 5, v35
    v_mfma_f32_16x16x32_bf16 v[184:187], a[72:75], a[44:47], v[184:187]
    v_xor_b32 v36, 5, v34
    v_mfma_f32_16x16x32_bf16 v[200:203], a[72:75], a[48:51], v[200:203]
    s_mov_b32 s80, 1376256
    s_add_u32 m0, s3, 49152
    v_lshl_add_u32 v13, v36, 5, v35
    v_mfma_f32_16x16x32_bf16 v[216:219], a[72:75], a[52:55], v[216:219]
    buffer_load_dwordx4 v17, s[48:51], s80 offen lds
    v_xor_b32 v36, 6, v34
    v_mfma_f32_16x16x32_bf16 v[232:235], a[72:75], a[56:59], v[232:235]
    v_lshl_add_u32 v14, v36, 5, v35
    v_mfma_f32_16x16x32_bf16 v[248:251], a[72:75], a[60:63], v[248:251]
    v_xor_b32 v36, 7, v34
    v_mfma_f32_16x16x32_bf16 v[140:143], a[76:79], a[32:35], v[140:143]
    v_lshl_add_u32 v15, v36, 5, v35
    v_mfma_f32_16x16x32_bf16 v[156:159], a[76:79], a[36:39], v[156:159]
    buffer_load_dwordx4 v18, s[48:51], s80 offen offset:1024 lds
    v_mfma_f32_16x16x32_bf16 v[172:175], a[76:79], a[40:43], v[172:175]
    v_mfma_f32_16x16x32_bf16 v[188:191], a[76:79], a[44:47], v[188:191]
    v_mfma_f32_16x16x32_bf16 v[204:207], a[76:79], a[48:51], v[204:207]
    v_mfma_f32_16x16x32_bf16 v[220:223], a[76:79], a[52:55], v[220:223]
    s_mov_b32 s81, 1605632
    s_add_u32 m0, s3, 57344
    v_mfma_f32_16x16x32_bf16 v[236:239], a[76:79], a[56:59], v[236:239]
    buffer_load_dwordx4 v17, s[48:51], s81 offen lds
    v_mfma_f32_16x16x32_bf16 v[252:255], a[76:79], a[60:63], v[252:255]
    v_mfma_f32_16x16x32_bf16 a[128:131], a[80:83], a[32:35], a[128:131]
    v_mfma_f32_16x16x32_bf16 a[144:147], a[80:83], a[36:39], a[144:147]
    v_mfma_f32_16x16x32_bf16 a[160:163], a[80:83], a[40:43], a[160:163]
    buffer_load_dwordx4 v18, s[48:51], s81 offen offset:1024 lds
    v_mfma_f32_16x16x32_bf16 a[176:179], a[80:83], a[44:47], a[176:179]
    v_mfma_f32_16x16x32_bf16 a[192:195], a[80:83], a[48:51], a[192:195]
    v_mfma_f32_16x16x32_bf16 a[208:211], a[80:83], a[52:55], a[208:211]
    v_mfma_f32_16x16x32_bf16 a[224:227], a[80:83], a[56:59], a[224:227]
    s_mov_b32 s80, 65536
    s_add_u32 m0, s3, 65536
    v_mfma_f32_16x16x32_bf16 a[240:243], a[80:83], a[60:63], a[240:243]
    buffer_load_dwordx4 v17, s[48:51], s80 offen lds
    v_mfma_f32_16x16x32_bf16 a[132:135], a[84:87], a[32:35], a[132:135]
    v_mfma_f32_16x16x32_bf16 a[148:151], a[84:87], a[36:39], a[148:151]
    v_mfma_f32_16x16x32_bf16 a[164:167], a[84:87], a[40:43], a[164:167]
    v_mfma_f32_16x16x32_bf16 a[180:183], a[84:87], a[44:47], a[180:183]
    buffer_load_dwordx4 v18, s[48:51], s80 offen offset:1024 lds
    v_mfma_f32_16x16x32_bf16 a[196:199], a[84:87], a[48:51], a[196:199]
    v_mfma_f32_16x16x32_bf16 a[212:215], a[84:87], a[52:55], a[212:215]
    v_mfma_f32_16x16x32_bf16 a[228:231], a[84:87], a[56:59], a[228:231]
    v_mfma_f32_16x16x32_bf16 a[244:247], a[84:87], a[60:63], a[244:247]
    s_mov_b32 s80, 131072
    s_add_u32 m0, s3, 131072
    v_mfma_f32_16x16x32_bf16 a[136:139], a[88:91], a[32:35], a[136:139]
    buffer_load_dwordx4 v17, s[48:51], s80 offen lds
    v_mfma_f32_16x16x32_bf16 a[152:155], a[88:91], a[36:39], a[152:155]
    v_mfma_f32_16x16x32_bf16 a[168:171], a[88:91], a[40:43], a[168:171]
    v_mfma_f32_16x16x32_bf16 a[184:187], a[88:91], a[44:47], a[184:187]
    v_mfma_f32_16x16x32_bf16 a[200:203], a[88:91], a[48:51], a[200:203]
    buffer_load_dwordx4 v18, s[48:51], s80 offen offset:1024 lds
    v_mfma_f32_16x16x32_bf16 a[216:219], a[88:91], a[52:55], a[216:219]
    v_mfma_f32_16x16x32_bf16 a[232:235], a[88:91], a[56:59], a[232:235]
    v_mfma_f32_16x16x32_bf16 a[248:251], a[88:91], a[60:63], a[248:251]
    v_mfma_f32_16x16x32_bf16 a[140:143], a[92:95], a[32:35], a[140:143]
    s_mov_b32 s81, 360448
    s_add_u32 m0, s3, 139264
    v_mfma_f32_16x16x32_bf16 a[156:159], a[92:95], a[36:39], a[156:159]
    buffer_load_dwordx4 v17, s[48:51], s81 offen lds
    v_mfma_f32_16x16x32_bf16 a[172:175], a[92:95], a[40:43], a[172:175]
    v_mfma_f32_16x16x32_bf16 a[188:191], a[92:95], a[44:47], a[188:191]
    v_mfma_f32_16x16x32_bf16 a[204:207], a[92:95], a[48:51], a[204:207]
    v_mfma_f32_16x16x32_bf16 a[220:223], a[92:95], a[52:55], a[220:223]
    buffer_load_dwordx4 v18, s[48:51], s81 offen offset:1024 lds
    v_mfma_f32_16x16x32_bf16 a[236:239], a[92:95], a[56:59], a[236:239]
    v_mfma_f32_16x16x32_bf16 a[252:255], a[92:95], a[60:63], a[252:255]
    v_mfma_f32_16x16x32_bf16 v[48:51], a[104:107], a[32:35], v[48:51]
    v_mfma_f32_16x16x32_bf16 v[52:55], a[104:107], a[36:39], v[52:55]
    s_mov_b32 s80, 589824
    s_add_u32 m0, s3, 147456
    v_mfma_f32_16x16x32_bf16 v[64:67], a[104:107], a[40:43], v[64:67]
    buffer_load_dwordx4 v17, s[48:51], s80 offen lds
    v_mfma_f32_16x16x32_bf16 v[68:71], a[104:107], a[44:47], v[68:71]
    v_mfma_f32_16x16x32_bf16 v[80:83], a[104:107], a[48:51], v[80:83]
    v_mfma_f32_16x16x32_bf16 v[84:87], a[104:107], a[52:55], v[84:87]
    v_mfma_f32_16x16x32_bf16 v[96:99], a[104:107], a[56:59], v[96:99]
    buffer_load_dwordx4 v18, s[48:51], s80 offen offset:1024 lds
    v_mfma_f32_16x16x32_bf16 v[100:103], a[104:107], a[60:63], v[100:103]
    v_mfma_f32_16x16x32_bf16 v[56:59], a[108:111], a[32:35], v[56:59]
    v_mfma_f32_16x16x32_bf16 v[60:63], a[108:111], a[36:39], v[60:63]
    v_mfma_f32_16x16x32_bf16 v[72:75], a[108:111], a[40:43], v[72:75]
    v_mfma_f32_16x16x32_bf16 v[76:79], a[108:111], a[44:47], v[76:79]
    v_mfma_f32_16x16x32_bf16 v[88:91], a[108:111], a[48:51], v[88:91]
    v_mfma_f32_16x16x32_bf16 v[92:95], a[108:111], a[52:55], v[92:95]
    v_mfma_f32_16x16x32_bf16 v[104:107], a[108:111], a[56:59], v[104:107]
    v_mfma_f32_16x16x32_bf16 v[108:111], a[108:111], a[60:63], v[108:111]
L_epi:
    v_pk_mul_f32 v[34:35], v[128:129], v[128:129]
    v_pk_mul_f32 v[36:37], v[130:131], v[130:131]
    v_pk_mul_f32 v[38:39], v[132:133], v[132:133]
    v_pk_mul_f32 v[40:41], v[134:135], v[134:135]
    v_pk_fma_f32 v[34:35], v[34:35], s[94:95], v[26:27]
    v_pk_fma_f32 v[36:37], v[36:37], s[94:95], v[26:27]
    v_pk_fma_f32 v[38:39], v[38:39], s[94:95], v[26:27]
    v_pk_fma_f32 v[40:41], v[40:41], s[94:95], v[26:27]
    v_pk_mul_f32 v[34:35], v[34:35], v[128:129]
    v_pk_mul_f32 v[36:37], v[36:37], v[130:131]
    v_pk_mul_f32 v[38:39], v[38:39], v[132:133]
    v_pk_mul_f32 v[40:41], v[40:41], v[134:135]
    v_exp_f32 v34, v34
    v_exp_f32 v35, v35
    v_exp_f32 v36, v36
    v_exp_f32 v37, v37
    v_exp_f32 v38, v38
    v_exp_f32 v39, v39
    v_exp_f32 v40, v40
    v_exp_f32 v41, v41
    v_pk_mul_f32 v[136:137], v[136:137], v[128:129]
    v_pk_mul_f32 v[138:139], v[138:139], v[130:131]
    v_pk_mul_f32 v[140:141], v[140:141], v[132:133]
    v_pk_mul_f32 v[142:143], v[142:143], v[134:135]
    v_pk_add_f32 v[34:35], v[34:35], 1.0 op_sel_hi:[1,0]
    v_pk_add_f32 v[36:37], v[36:37], 1.0 op_sel_hi:[1,0]
    v_pk_add_f32 v[38:39], v[38:39], 1.0 op_sel_hi:[1,0]
    v_pk_add_f32 v[40:41], v[40:41], 1.0 op_sel_hi:[1,0]
    v_rcp_f32 v34, v34
    v_rcp_f32 v35, v35
    v_rcp_f32 v36, v36
    v_rcp_f32 v37, v37
    v_rcp_f32 v38, v38
    v_rcp_f32 v39, v39
    v_rcp_f32 v40, v40
    v_rcp_f32 v41, v41
    v_pk_mul_f32 v[136:137], v[136:137], v[34:35]
    v_pk_mul_f32 v[138:139], v[138:139], v[36:37]
    v_pk_mul_f32 v[140:141], v[140:141], v[38:39]
    v_pk_mul_f32 v[142:143], v[142:143], v[40:41]
    v_cvt_pk_bf16_f32 v128, v136, v137
    v_cvt_pk_bf16_f32 v129, v138, v139
    v_cvt_pk_bf16_f32 v130, v140, v141
    v_cvt_pk_bf16_f32 v131, v142, v143
    buffer_store_dwordx4 v[128:131], v16, s[56:59], s88 offen offset:0 sc1
    v_pk_mul_f32 v[34:35], v[144:145], v[144:145]
    v_pk_mul_f32 v[36:37], v[146:147], v[146:147]
    v_pk_mul_f32 v[38:39], v[148:149], v[148:149]
    v_pk_mul_f32 v[40:41], v[150:151], v[150:151]
    v_pk_fma_f32 v[34:35], v[34:35], s[94:95], v[26:27]
    v_pk_fma_f32 v[36:37], v[36:37], s[94:95], v[26:27]
    v_pk_fma_f32 v[38:39], v[38:39], s[94:95], v[26:27]
    v_pk_fma_f32 v[40:41], v[40:41], s[94:95], v[26:27]
    v_pk_mul_f32 v[34:35], v[34:35], v[144:145]
    v_pk_mul_f32 v[36:37], v[36:37], v[146:147]
    v_pk_mul_f32 v[38:39], v[38:39], v[148:149]
    v_pk_mul_f32 v[40:41], v[40:41], v[150:151]
    v_exp_f32 v34, v34
    v_exp_f32 v35, v35
    v_exp_f32 v36, v36
    v_exp_f32 v37, v37
    v_exp_f32 v38, v38
    v_exp_f32 v39, v39
    v_exp_f32 v40, v40
    v_exp_f32 v41, v41
    v_pk_mul_f32 v[152:153], v[152:153], v[144:145]
    v_pk_mul_f32 v[154:155], v[154:155], v[146:147]
    v_pk_mul_f32 v[156:157], v[156:157], v[148:149]
    v_pk_mul_f32 v[158:159], v[158:159], v[150:151]
    v_pk_add_f32 v[34:35], v[34:35], 1.0 op_sel_hi:[1,0]
    v_pk_add_f32 v[36:37], v[36:37], 1.0 op_sel_hi:[1,0]
    v_pk_add_f32 v[38:39], v[38:39], 1.0 op_sel_hi:[1,0]
    v_pk_add_f32 v[40:41], v[40:41], 1.0 op_sel_hi:[1,0]
    v_rcp_f32 v34, v34
    v_rcp_f32 v35, v35
    v_rcp_f32 v36, v36
    v_rcp_f32 v37, v37
    v_rcp_f32 v38, v38
    v_rcp_f32 v39, v39
    v_rcp_f32 v40, v40
    v_rcp_f32 v41, v41
    v_pk_mul_f32 v[152:153], v[152:153], v[34:35]
    v_pk_mul_f32 v[154:155], v[154:155], v[36:37]
    v_pk_mul_f32 v[156:157], v[156:157], v[38:39]
    v_pk_mul_f32 v[158:159], v[158:159], v[40:41]
    v_cvt_pk_bf16_f32 v144, v152, v153
    v_cvt_pk_bf16_f32 v145, v154, v155
    v_cvt_pk_bf16_f32 v146, v156, v157
    v_cvt_pk_bf16_f32 v147, v158, v159
    buffer_store_dwordx4 v[144:147], v16, s[56:59], s88 offen offset:1024 sc1
    v_pk_mul_f32 v[34:35], v[160:161], v[160:161]
    v_pk_mul_f32 v[36:37], v[162:163], v[162:163]
    v_pk_mul_f32 v[38:39], v[164:165], v[164:165]
    v_pk_mul_f32 v[40:41], v[166:167], v[166:167]
    v_pk_fma_f32 v[34:35], v[34:35], s[94:95], v[26:27]
    v_pk_fma_f32 v[36:37], v[36:37], s[94:95], v[26:27]
    v_pk_fma_f32 v[38:39], v[38:39], s[94:95], v[26:27]
    v_pk_fma_f32 v[40:41], v[40:41], s[94:95], v[26:27]
    v_pk_mul_f32 v[34:35], v[34:35], v[160:161]
    v_pk_mul_f32 v[36:37], v[36:37], v[162:163]
    v_pk_mul_f32 v[38:39], v[38:39], v[164:165]
    v_pk_mul_f32 v[40:41], v[40:41], v[166:167]
    v_exp_f32 v34, v34
    v_exp_f32 v35, v35
    v_exp_f32 v36, v36
    v_exp_f32 v37, v37
    v_exp_f32 v38, v38
    v_exp_f32 v39, v39
    v_exp_f32 v40, v40
    v_exp_f32 v41, v41
    v_pk_mul_f32 v[168:169], v[168:169], v[160:161]
    v_pk_mul_f32 v[170:171], v[170:171], v[162:163]
    v_pk_mul_f32 v[172:173], v[172:173], v[164:165]
    v_pk_mul_f32 v[174:175], v[174:175], v[166:167]
    v_pk_add_f32 v[34:35], v[34:35], 1.0 op_sel_hi:[1,0]
    v_pk_add_f32 v[36:37], v[36:37], 1.0 op_sel_hi:[1,0]
    v_pk_add_f32 v[38:39], v[38:39], 1.0 op_sel_hi:[1,0]
    v_pk_add_f32 v[40:41], v[40:41], 1.0 op_sel_hi:[1,0]
    v_rcp_f32 v34, v34
    v_rcp_f32 v35, v35
    v_rcp_f32 v36, v36
    v_rcp_f32 v37, v37
    v_rcp_f32 v38, v38
    v_rcp_f32 v39, v39
    v_rcp_f32 v40, v40
    v_rcp_f32 v41, v41
    v_pk_mul_f32 v[168:169], v[168:169], v[34:35]
    v_pk_mul_f32 v[170:171], v[170:171], v[36:37]
    v_pk_mul_f32 v[172:173], v[172:173], v[38:39]
    v_pk_mul_f32 v[174:175], v[174:175], v[40:41]
    v_cvt_pk_bf16_f32 v160, v168, v169
    v_cvt_pk_bf16_f32 v161, v170, v171
    v_cvt_pk_bf16_f32 v162, v172, v173
    v_cvt_pk_bf16_f32 v163, v174, v175
    buffer_store_dwordx4 v[160:163], v16, s[56:59], s88 offen offset:2048 sc1
    v_pk_mul_f32 v[34:35], v[176:177], v[176:177]
    v_pk_mul_f32 v[36:37], v[178:179], v[178:179]
    v_pk_mul_f32 v[38:39], v[180:181], v[180:181]
    v_pk_mul_f32 v[40:41], v[182:183], v[182:183]
    v_pk_fma_f32 v[34:35], v[34:35], s[94:95], v[26:27]
    v_pk_fma_f32 v[36:37], v[36:37], s[94:95], v[26:27]
    v_pk_fma_f32 v[38:39], v[38:39], s[94:95], v[26:27]
    v_pk_fma_f32 v[40:41], v[40:41], s[94:95], v[26:27]
    v_pk_mul_f32 v[34:35], v[34:35], v[176:177]
    v_pk_mul_f32 v[36:37], v[36:37], v[178:179]
    v_pk_mul_f32 v[38:39], v[38:39], v[180:181]
    v_pk_mul_f32 v[40:41], v[40:41], v[182:183]
    v_exp_f32 v34, v34
    v_exp_f32 v35, v35
    v_exp_f32 v36, v36
    v_exp_f32 v37, v37
    v_exp_f32 v38, v38
    v_exp_f32 v39, v39
    v_exp_f32 v40, v40
    v_exp_f32 v41, v41
    v_pk_mul_f32 v[184:185], v[184:185], v[176:177]
    v_pk_mul_f32 v[186:187], v[186:187], v[178:179]
    v_pk_mul_f32 v[188:189], v[188:189], v[180:181]
    v_pk_mul_f32 v[190:191], v[190:191], v[182:183]
    v_pk_add_f32 v[34:35], v[34:35], 1.0 op_sel_hi:[1,0]
    v_pk_add_f32 v[36:37], v[36:37], 1.0 op_sel_hi:[1,0]
    v_pk_add_f32 v[38:39], v[38:39], 1.0 op_sel_hi:[1,0]
    v_pk_add_f32 v[40:41], v[40:41], 1.0 op_sel_hi:[1,0]
    v_rcp_f32 v34, v34
    v_rcp_f32 v35, v35
    v_rcp_f32 v36, v36
    v_rcp_f32 v37, v37
    v_rcp_f32 v38, v38
    v_rcp_f32 v39, v39
    v_rcp_f32 v40, v40
    v_rcp_f32 v41, v41
    v_pk_mul_f32 v[184:185], v[184:185], v[34:35]
    v_pk_mul_f32 v[186:187], v[186:187], v[36:37]
    v_pk_mul_f32 v[188:189], v[188:189], v[38:39]
    v_pk_mul_f32 v[190:191], v[190:191], v[40:41]
    v_cvt_pk_bf16_f32 v176, v184, v185
    v_cvt_pk_bf16_f32 v177, v186, v187
    v_cvt_pk_bf16_f32 v178, v188, v189
    v_cvt_pk_bf16_f32 v179, v190, v191
    buffer_store_dwordx4 v[176:179], v16, s[56:59], s88 offen offset:3072 sc1
    v_pk_mul_f32 v[34:35], v[192:193], v[192:193]
    v_pk_mul_f32 v[36:37], v[194:195], v[194:195]
    v_pk_mul_f32 v[38:39], v[196:197], v[196:197]
    v_pk_mul_f32 v[40:41], v[198:199], v[198:199]
    v_pk_fma_f32 v[34:35], v[34:35], s[94:95], v[26:27]
    v_pk_fma_f32 v[36:37], v[36:37], s[94:95], v[26:27]
    v_pk_fma_f32 v[38:39], v[38:39], s[94:95], v[26:27]
    s_branch L_over4
L_stub4:
    s_branch L_stub8
L_over4:
    v_pk_fma_f32 v[40:41], v[40:41], s[94:95], v[26:27]
    v_pk_mul_f32 v[34:35], v[34:35], v[192:193]
    v_pk_mul_f32 v[36:37], v[36:37], v[194:195]
    v_pk_mul_f32 v[38:39], v[38:39], v[196:197]
    v_pk_mul_f32 v[40:41], v[40:41], v[198:199]
    v_exp_f32 v34, v34
    v_exp_f32 v35, v35
    v_exp_f32 v36, v36
    v_exp_f32 v37, v37
    v_exp_f32 v38, v38
    v_exp_f32 v39, v39
    v_exp_f32 v40, v40
    v_exp_f32 v41, v41
    v_pk_mul_f32 v[200:201], v[200:201], v[192:193]
    v_pk_mul_f32 v[202:203], v[202:203], v[194:195]
    v_pk_mul_f32 v[204:205], v[204:205], v[196:197]
    v_pk_mul_f32 v[206:207], v[206:207], v[198:199]
    v_pk_add_f32 v[34:35], v[34:35], 1.0 op_sel_hi:[1,0]
    v_pk_add_f32 v[36:37], v[36:37], 1.0 op_sel_hi:[1,0]
    v_pk_add_f32 v[38:39], v[38:39], 1.0 op_sel_hi:[1,0]
    v_pk_add_f32 v[40:41], v[40:41], 1.0 op_sel_hi:[1,0]
    v_rcp_f32 v34, v34
    v_rcp_f32 v35, v35
    v_rcp_f32 v36, v36
    v_rcp_f32 v37, v37
    v_rcp_f32 v38, v38
    v_rcp_f32 v39, v39
    v_rcp_f32 v40, v40
    v_rcp_f32 v41, v41
    v_pk_mul_f32 v[200:201], v[200:201], v[34:35]
    v_pk_mul_f32 v[202:203], v[202:203], v[36:37]
    v_pk_mul_f32 v[204:205], v[204:205], v[38:39]
    v_pk_mul_f32 v[206:207], v[206:207], v[40:41]
    v_cvt_pk_bf16_f32 v192, v200, v201
    v_cvt_pk_bf16_f32 v193, v202, v203
    v_cvt_pk_bf16_f32 v194, v204, v205
    v_cvt_pk_bf16_f32 v195, v206, v207
    s_add_u32 s88, s88, 4096
    buffer_store_dwordx4 v[192:195], v16, s[56:59], s88 offen offset:0 sc1
    v_pk_mul_f32 v[34:35], v[208:209], v[208:209]
    v_pk_mul_f32 v[36:37], v[210:211], v[210:211]
    v_pk_mul_f32 v[38:39], v[212:213], v[212:213]
    v_pk_mul_f32 v[40:41], v[214:215], v[214:215]
    v_pk_fma_f32 v[34:35], v[34:35], s[94:95], v[26:27]
    v_pk_fma_f32 v[36:37], v[36:37], s[94:95], v[26:27]
    v_pk_fma_f32 v[38:39], v[38:39], s[94:95], v[26:27]
    v_pk_fma_f32 v[40:41], v[40:41], s[94:95], v[26:27]
    v_pk_mul_f32 v[34:35], v[34:35], v[208:209]
    v_pk_mul_f32 v[36:37], v[36:37], v[210:211]
    v_pk_mul_f32 v[38:39], v[38:39], v[212:213]
    v_pk_mul_f32 v[40:41], v[40:41], v[214:215]
    v_exp_f32 v34, v34
    v_exp_f32 v35, v35
    v_exp_f32 v36, v36
    v_exp_f32 v37, v37
    v_exp_f32 v38, v38
    v_exp_f32 v39, v39
    v_exp_f32 v40, v40
    v_exp_f32 v41, v41
    v_pk_mul_f32 v[216:217], v[216:217], v[208:209]
    v_pk_mul_f32 v[218:219], v[218:219], v[210:211]
    v_pk_mul_f32 v[220:221], v[220:221], v[212:213]
    v_pk_mul_f32 v[222:223], v[222:223], v[214:215]
    v_pk_add_f32 v[34:35], v[34:35], 1.0 op_sel_hi:[1,0]
    v_pk_add_f32 v[36:37], v[36:37], 1.0 op_sel_hi:[1,0]
    v_pk_add_f32 v[38:39], v[38:39], 1.0 op_sel_hi:[1,0]
    v_pk_add_f32 v[40:41], v[40:41], 1.0 op_sel_hi:[1,0]
    v_rcp_f32 v34, v34
    v_rcp_f32 v35, v35
    v_rcp_f32 v36, v36
    v_rcp_f32 v37, v37
    v_rcp_f32 v38, v38
    v_rcp_f32 v39, v39
    v_rcp_f32 v40, v40
    v_rcp_f32 v41, v41
    v_pk_mul_f32 v[216:217], v[216:217], v[34:35]
    v_pk_mul_f32 v[218:219], v[218:219], v[36:37]
    v_pk_mul_f32 v[220:221], v[220:221], v[38:39]
    v_pk_mul_f32 v[222:223], v[222:223], v[40:41]
    v_cvt_pk_bf16_f32 v208, v216, v217
    v_cvt_pk_bf16_f32 v209, v218, v219
    v_cvt_pk_bf16_f32 v210, v220, v221
    v_cvt_pk_bf16_f32 v211, v222, v223
    buffer_store_dwordx4 v[208:211], v16, s[56:59], s88 offen offset:1024 sc1
    v_pk_mul_f32 v[34:35], v[224:225], v[224:225]
    v_pk_mul_f32 v[36:37], v[226:227], v[226:227]
    v_pk_mul_f32 v[38:39], v[228:229], v[228:229]
    v_pk_mul_f32 v[40:41], v[230:231], v[230:231]
    v_pk_fma_f32 v[34:35], v[34:35], s[94:95], v[26:27]
    v_pk_fma_f32 v[36:37], v[36:37], s[94:95], v[26:27]
    v_pk_fma_f32 v[38:39], v[38:39], s[94:95], v[26:27]
    v_pk_fma_f32 v[40:41], v[40:41], s[94:95], v[26:27]
    v_pk_mul_f32 v[34:35], v[34:35], v[224:225]
    v_pk_mul_f32 v[36:37], v[36:37], v[226:227]
    v_pk_mul_f32 v[38:39], v[38:39], v[228:229]
    v_pk_mul_f32 v[40:41], v[40:41], v[230:231]
    v_exp_f32 v34, v34
    v_exp_f32 v35, v35
    v_exp_f32 v36, v36
    v_exp_f32 v37, v37
    v_exp_f32 v38, v38
    v_exp_f32 v39, v39
    v_exp_f32 v40, v40
    v_exp_f32 v41, v41
    v_pk_mul_f32 v[232:233], v[232:233], v[224:225]
    v_pk_mul_f32 v[234:235], v[234:235], v[226:227]
    v_pk_mul_f32 v[236:237], v[236:237], v[228:229]
    v_pk_mul_f32 v[238:239], v[238:239], v[230:231]
    v_pk_add_f32 v[34:35], v[34:35], 1.0 op_sel_hi:[1,0]
    v_pk_add_f32 v[36:37], v[36:37], 1.0 op_sel_hi:[1,0]
    v_pk_add_f32 v[38:39], v[38:39], 1.0 op_sel_hi:[1,0]
    v_pk_add_f32 v[40:41], v[40:41], 1.0 op_sel_hi:[1,0]
    v_rcp_f32 v34, v34
    v_rcp_f32 v35, v35
    v_rcp_f32 v36, v36
    v_rcp_f32 v37, v37
    v_rcp_f32 v38, v38
    v_rcp_f32 v39, v39
    v_rcp_f32 v40, v40
    v_rcp_f32 v41, v41
    v_pk_mul_f32 v[232:233], v[232:233], v[34:35]
    v_pk_mul_f32 v[234:235], v[234:235], v[36:37]
    v_pk_mul_f32 v[236:237], v[236:237], v[38:39]
    v_pk_mul_f32 v[238:239], v[238:239], v[40:41]
    v_cvt_pk_bf16_f32 v224, v232, v233
    v_cvt_pk_bf16_f32 v225, v234, v235
    v_cvt_pk_bf16_f32 v226, v236, v237
    v_cvt_pk_bf16_f32 v227, v238, v239
    buffer_store_dwordx4 v[224:227], v16, s[56:59], s88 offen offset:2048 sc1
    v_pk_mul_f32 v[34:35], v[240:241], v[240:241]
    v_pk_mul_f32 v[36:37], v[242:243], v[242:243]
    v_pk_mul_f32 v[38:39], v[244:245], v[244:245]
    v_pk_mul_f32 v[40:41], v[246:247], v[246:247]
    v_pk_fma_f32 v[34:35], v[34:35], s[94:95], v[26:27]
    v_pk_fma_f32 v[36:37], v[36:37], s[94:95], v[26:27]
    v_pk_fma_f32 v[38:39], v[38:39], s[94:95], v[26:27]
    v_pk_fma_f32 v[40:41], v[40:41], s[94:95], v[26:27]
    v_pk_mul_f32 v[34:35], v[34:35], v[240:241]
    v_pk_mul_f32 v[36:37], v[36:37], v[242:243]
    v_pk_mul_f32 v[38:39], v[38:39], v[244:245]
    v_pk_mul_f32 v[40:41], v[40:41], v[246:247]
    v_exp_f32 v34, v34
    v_exp_f32 v35, v35
    v_exp_f32 v36, v36
    v_exp_f32 v37, v37
    v_exp_f32 v38, v38
    v_exp_f32 v39, v39
    v_exp_f32 v40, v40
    v_exp_f32 v41, v41
    v_pk_mul_f32 v[248:249], v[248:249], v[240:241]
    v_pk_mul_f32 v[250:251], v[250:251], v[242:243]
    v_pk_mul_f32 v[252:253], v[252:253], v[244:245]
    v_pk_mul_f32 v[254:255], v[254:255], v[246:247]
    v_pk_add_f32 v[34:35], v[34:35], 1.0 op_sel_hi:[1,0]
    v_pk_add_f32 v[36:37], v[36:37], 1.0 op_sel_hi:[1,0]
    v_pk_add_f32 v[38:39], v[38:39], 1.0 op_sel_hi:[1,0]
    v_pk_add_f32 v[40:41], v[40:41], 1.0 op_sel_hi:[1,0]
    v_rcp_f32 v34, v34
    v_rcp_f32 v35, v35
    v_rcp_f32 v36, v36
    v_rcp_f32 v37, v37
    v_rcp_f32 v38, v38
    v_rcp_f32 v39, v39
    v_rcp_f32 v40, v40
    v_rcp_f32 v41, v41
    v_pk_mul_f32 v[248:249], v[248:249], v[34:35]
    v_pk_mul_f32 v[250:251], v[250:251], v[36:37]
    v_pk_mul_f32 v[252:253], v[252:253], v[38:39]
    v_pk_mul_f32 v[254:255], v[254:255], v[40:41]
    v_cvt_pk_bf16_f32 v240, v248, v249
    v_cvt_pk_bf16_f32 v241, v250, v251
    v_cvt_pk_bf16_f32 v242, v252, v253
    v_cvt_pk_bf16_f32 v243, v254, v255
    buffer_store_dwordx4 v[240:243], v16, s[56:59], s88 offen offset:3072 sc1
    s_cmp_eq_u32 s62, 1
    s_cbranch_scc1 L_epi1
    v_mov_b32 v244, 0xce6e6b28
    v_cvt_pk_bf16_f32 v128, v120, v121
    v_cvt_pk_bf16_f32 v129, v122, v123
    v_cvt_pk_bf16_f32 v130, v124, v125
    v_cvt_pk_bf16_f32 v131, v126, v127
    v_accvgpr_read_b32 v34, a128
    v_accvgpr_read_b32 v35, a129
    v_accvgpr_read_b32 v36, a130
    v_accvgpr_read_b32 v37, a131
    v_accvgpr_read_b32 v38, a132
    v_accvgpr_read_b32 v39, a133
    v_accvgpr_read_b32 v40, a134
    v_accvgpr_read_b32 v41, a135
    v_cvt_pk_bf16_f32 v132, v34, v35
    v_cvt_pk_bf16_f32 v133, v36, v37
    v_cvt_pk_bf16_f32 v134, v38, v39
    v_cvt_pk_bf16_f32 v135, v40, v41
    v_accvgpr_read_b32 v246, a192
    v_accvgpr_read_b32 v247, a193
    v_accvgpr_read_b32 v248, a194
    v_accvgpr_read_b32 v249, a195
    v_accvgpr_read_b32 v250, a196
    v_accvgpr_read_b32 v251, a197
    v_accvgpr_read_b32 v252, a198
    v_accvgpr_read_b32 v253, a199
    v_cvt_pk_bf16_f32 v164, v246, v247
    v_cvt_pk_bf16_f32 v165, v248, v249
    v_cvt_pk_bf16_f32 v166, v250, v251
    v_cvt_pk_bf16_f32 v167, v252, v253
    v_accvgpr_read_b32 v34, a136
    v_accvgpr_read_b32 v35, a137
    v_accvgpr_read_b32 v36, a138
    v_accvgpr_read_b32 v37, a139
    v_accvgpr_read_b32 v38, a140
    v_accvgpr_read_b32 v39, a141
    v_accvgpr_read_b32 v40, a142
    v_accvgpr_read_b32 v41, a143
    v_cvt_pk_bf16_f32 v136, v34, v35
    v_cvt_pk_bf16_f32 v137, v36, v37
    v_cvt_pk_bf16_f32 v138, v38, v39
    v_cvt_pk_bf16_f32 v139, v40, v41
    v_accvgpr_read_b32 v246, a200
    v_accvgpr_read_b32 v247, a201
    v_accvgpr_read_b32 v248, a202
    v_accvgpr_read_b32 v249, a203
    v_accvgpr_read_b32 v250, a204
    v_accvgpr_read_b32 v251, a205
    v_accvgpr_read_b32 v252, a206
    v_accvgpr_read_b32 v253, a207
    v_cvt_pk_bf16_f32 v168, v246, v247
    v_cvt_pk_bf16_f32 v169, v248, v249
    v_cvt_pk_bf16_f32 v170, v250, v251
    v_cvt_pk_bf16_f32 v171, v252, v253
    v_accvgpr_read_b32 v34, a144
    v_accvgpr_read_b32 v35, a145
    v_accvgpr_read_b32 v36, a146
    v_accvgpr_read_b32 v37, a147
    v_accvgpr_read_b32 v38, a148
    v_accvgpr_read_b32 v39, a149
    v_accvgpr_read_b32 v40, a150
    v_accvgpr_read_b32 v41, a151
    v_cvt_pk_bf16_f32 v140, v34, v35
    v_cvt_pk_bf16_f32 v141, v36, v37
    v_cvt_pk_bf16_f32 v142, v38, v39
    v_cvt_pk_bf16_f32 v143, v40, v41
    v_accvgpr_read_b32 v246, a208
    v_accvgpr_read_b32 v247, a209
    v_accvgpr_read_b32 v248, a210
    v_accvgpr_read_b32 v249, a211
    v_accvgpr_read_b32 v250, a212
    v_accvgpr_read_b32 v251, a213
    v_accvgpr_read_b32 v252, a214
    v_accvgpr_read_b32 v253, a215
    v_cvt_pk_bf16_f32 v172, v246, v247
    v_cvt_pk_bf16_f32 v173, v248, v249
    v_cvt_pk_bf16_f32 v174, v250, v251
    v_cvt_pk_bf16_f32 v175, v252, v253
    v_accvgpr_read_b32 v34, a152
    v_accvgpr_read_b32 v35, a153
    v_accvgpr_read_b32 v36, a154
    v_accvgpr_read_b32 v37, a155
    v_accvgpr_read_b32 v38, a156
    v_accvgpr_read_b32 v39, a157
    v_accvgpr_read_b32 v40, a158
    v_accvgpr_read_b32 v41, a159
    v_cvt_pk_bf16_f32 v144, v34, v35
    v_cvt_pk_bf16_f32 v145, v36, v37
    v_cvt_pk_bf16_f32 v146, v38, v39
    v_cvt_pk_bf16_f32 v147, v40, v41
    v_accvgpr_read_b32 v246, a216
    v_accvgpr_read_b32 v247, a217
    v_accvgpr_read_b32 v248, a218
    v_accvgpr_read_b32 v249, a219
    v_accvgpr_read_b32 v250, a220
    v_accvgpr_read_b32 v251, a221
    v_accvgpr_read_b32 v252, a222
    v_accvgpr_read_b32 v253, a223
    v_cvt_pk_bf16_f32 v176, v246, v247
    v_cvt_pk_bf16_f32 v177, v248, v249
    v_cvt_pk_bf16_f32 v178, v250, v251
    v_cvt_pk_bf16_f32 v179, v252, v253
    v_mfma_f32_16x16x32_bf16 v[196:199], v[128:131], v[164:167], 0
    v_mfma_f32_16x16x32_bf16 v[200:203], v[132:135], v[164:167], 0
    v_mfma_f32_16x16x32_bf16 v[204:207], v[132:135], v[168:171], 0
    v_mfma_f32_16x16x32_bf16 v[208:211], v[136:139], v[168:171], 0
    v_mfma_f32_16x16x32_bf16 v[212:215], v[136:139], v[172:175], 0
    v_mfma_f32_16x16x32_bf16 v[216:219], v[140:143], v[172:175], 0
    v_mfma_f32_16x16x32_bf16 v[220:223], v[140:143], v[176:179], 0
    v_mfma_f32_16x16x32_bf16 v[224:227], v[144:147], v[176:179], 0
    s_waitcnt vmcnt(0)
    s_mov_b64 exec, 1
    buffer_atomic_add v25, off, s[56:59], s92 sc1
    s_mov_b64 exec, -1
    v_cvt_pk_bf16_f32 v48, v48, v49
    v_cvt_pk_bf16_f32 v49, v50, v51
    v_cvt_pk_bf16_f32 v84, v84, v85
    v_cvt_pk_bf16_f32 v85, v86, v87
    v_cvt_pk_bf16_f32 v50, v52, v53
    v_cvt_pk_bf16_f32 v51, v54, v55
    v_cvt_pk_bf16_f32 v86, v88, v89
    v_cvt_pk_bf16_f32 v87, v90, v91
    v_cvt_pk_bf16_f32 v52, v56, v57
    v_cvt_pk_bf16_f32 v53, v58, v59
    v_cvt_pk_bf16_f32 v88, v92, v93
    v_cvt_pk_bf16_f32 v89, v94, v95
    v_cvt_pk_bf16_f32 v54, v60, v61
    v_cvt_pk_bf16_f32 v55, v62, v63
    v_cvt_pk_bf16_f32 v90, v96, v97
    v_cvt_pk_bf16_f32 v91, v98, v99
    v_cvt_pk_bf16_f32 v56, v64, v65
    v_cvt_pk_bf16_f32 v57, v66, v67
    v_cvt_pk_bf16_f32 v92, v100, v101
    v_cvt_pk_bf16_f32 v93, v102, v103
    v_cvt_pk_bf16_f32 v58, v68, v69
    v_cvt_pk_bf16_f32 v59, v70, v71
    v_cvt_pk_bf16_f32 v94, v104, v105
    v_cvt_pk_bf16_f32 v95, v106, v107
    v_cvt_pk_bf16_f32 v60, v72, v73
    v_cvt_pk_bf16_f32 v61, v74, v75
    v_cvt_pk_bf16_f32 v96, v108, v109
    v_cvt_pk_bf16_f32 v97, v110, v111
    v_cvt_pk_bf16_f32 v62, v76, v77
    v_cvt_pk_bf16_f32 v63, v78, v79
    v_cvt_pk_bf16_f32 v98, v112, v113
    v_cvt_pk_bf16_f32 v99, v114, v115
    v_cvt_pk_bf16_f32 v64, v80, v81
    v_cvt_pk_bf16_f32 v65, v82, v83
    v_cvt_pk_bf16_f32 v100, v116, v117
    v_cvt_pk_bf16_f32 v101, v118, v119
    v_cvt_pk_bf16_f32 v196, v196, v197
    v_cvt_pk_bf16_f32 v198, v198, v199
    v_cvt_pk_bf16_f32 v200, v200, v201
    v_cvt_pk_bf16_f32 v202, v202, v203
    v_cvt_pk_bf16_f32 v204, v204, v205
    v_cvt_pk_bf16_f32 v206, v206, v207
    v_cvt_pk_bf16_f32 v208, v208, v209
    v_cvt_pk_bf16_f32 v210, v210, v211
    v_cvt_pk_bf16_f32 v212, v212, v213
    v_cvt_pk_bf16_f32 v214, v214, v215
    v_cvt_pk_bf16_f32 v216, v216, v217
    v_cvt_pk_bf16_f32 v218, v218, v219
    v_cvt_pk_bf16_f32 v220, v220, v221
    v_cvt_pk_bf16_f32 v222, v222, v223
    v_cvt_pk_bf16_f32 v224, v224, v225
    v_cvt_pk_bf16_f32 v226, v226, v227
    v_perm_b32 v228, v200, v196, v28
    v_perm_b32 v229, v202, v198, v29
    v_perm_b32 v230, v208, v204, v28
    v_perm_b32 v231, v210, v206, v29
    v_perm_b32 v232, v216, v212, v28
    v_perm_b32 v233, v218, v214, v29
    v_perm_b32 v234, v224, v220, v28
    v_perm_b32 v235, v226, v222, v29
    v_pk_mul_f32 v[228:229], v[228:229], s[14:15]
    v_pk_mul_f32 v[230:231], v[230:231], s[14:15]
    v_pk_mul_f32 v[232:233], v[232:233], s[14:15]
    v_pk_mul_f32 v[234:235], v[234:235], s[14:15]
    v_cvt_pk_bf16_f32 v229, v228, v229
    v_cvt_pk_bf16_f32 v231, v230, v231
    v_cvt_pk_bf16_f32 v233, v232, v233
    v_cvt_pk_bf16_f32 v235, v234, v235
    v_lshlrev_b32 v228, 16, v229
    v_and_b32 v229, 0xffff0000, v229
    v_lshlrev_b32 v230, 16, v231
    v_and_b32 v231, 0xffff0000, v231
    v_lshlrev_b32 v232, 16, v233
    v_and_b32 v233, 0xffff0000, v233
    v_lshlrev_b32 v234, 16, v235
    v_and_b32 v235, 0xffff0000, v235
    v_cndmask_b32 v228, v244, v228, s[4:5]
    v_cndmask_b32 v229, v244, v229, s[6:7]
    v_max_f32 v236, v228, v229
    v_max_f32 v238, v230, v231
    v_max_f32 v240, v232, v233
    v_max_f32 v242, v234, v235
    v_permlane16_swap_b32 v236, v238
    s_nop 0
    v_permlane16_swap_b32 v240, v242
    v_max_f32 v236, v236, v238
    v_max_f32 v240, v240, v242
    s_nop 1
    v_permlane32_swap_b32 v236, v240
    v_max_f32 v236, v236, v240
    v_mul_f32 v236, 0xbfb8aa3b, v236
    v_mov_b32 v240, v236
    s_nop 1
    v_permlane32_swap_b32 v236, v240
    v_mov_b32 v238, v236
    v_mov_b32 v242, v240
    s_nop 0
    v_permlane16_swap_b32 v236, v238
    v_permlane16_swap_b32 v240, v242
    v_pk_fma_f32 v[228:229], v[228:229], s[98:99], v[236:237] op_sel_hi:[1,1,0]
    v_pk_fma_f32 v[230:231], v[230:231], s[98:99], v[238:239] op_sel_hi:[1,1,0]
    v_pk_fma_f32 v[232:233], v[232:233], s[98:99], v[240:241] op_sel_hi:[1,1,0]
    v_pk_fma_f32 v[234:235], v[234:235], s[98:99], v[242:243] op_sel_hi:[1,1,0]
    v_exp_f32 v228, v228
    v_exp_f32 v229, v229
    v_exp_f32 v230, v230
    v_exp_f32 v231, v231
    v_exp_f32 v232, v232
    v_exp_f32 v233, v233
    v_exp_f32 v234, v234
    v_exp_f32 v235, v235
    v_add_f32 v236, v228, v229
    v_add_f32 v238, v230, v231
    v_add_f32 v240, v232, v233
    v_add_f32 v242, v234, v235
    v_permlane16_swap_b32 v236, v238
    s_nop 0
    v_permlane16_swap_b32 v240, v242
    v_add_f32 v236, v236, v238
    v_add_f32 v240, v240, v242
    s_nop 1
    v_permlane32_swap_b32 v236, v240
    v_add_f32 v236, v236, v240
    v_rcp_f32 v236, v236
    s_nop 0
    v_mov_b32 v240, v236
    s_nop 1
    v_permlane32_swap_b32 v236, v240
    v_mov_b32 v238, v236
    v_mov_b32 v242, v240
    s_nop 0
    v_permlane16_swap_b32 v236, v238
    v_permlane16_swap_b32 v240, v242
    v_pk_mul_f32 v[228:229], v[228:229], v[236:237] op_sel_hi:[1,0]
    v_pk_mul_f32 v[230:231], v[230:231], v[238:239] op_sel_hi:[1,0]
    v_pk_mul_f32 v[232:233], v[232:233], v[240:241] op_sel_hi:[1,0]
    v_pk_mul_f32 v[234:235], v[234:235], v[242:243] op_sel_hi:[1,0]
    v_cvt_pk_bf16_f32 v228, v228, v229
    v_cvt_pk_bf16_f32 v230, v230, v231
    v_cvt_pk_bf16_f32 v232, v232, v233
    v_cvt_pk_bf16_f32 v234, v234, v235
    v_perm_b32 v164, v228, v228, v30
    v_perm_b32 v165, v228, v228, v31
    v_perm_b32 v166, v228, v228, v32
    v_perm_b32 v167, v228, v228, v33
    v_perm_b32 v168, v230, v230, v30
    v_perm_b32 v169, v230, v230, v31
    v_perm_b32 v170, v230, v230, v32
    v_perm_b32 v171, v230, v230, v33
    v_perm_b32 v172, v232, v232, v30
    v_perm_b32 v173, v232, v232, v31
    v_perm_b32 v174, v232, v232, v32
    v_perm_b32 v175, v232, v232, v33
    v_perm_b32 v176, v234, v234, v30
    v_perm_b32 v177, v234, v234, v31
    v_perm_b32 v178, v234, v234, v32
    v_perm_b32 v179, v234, v234, v33
    v_mfma_f32_16x16x32_bf16 v[196:199], v[48:51], v[164:167], 0
    v_mfma_f32_16x16x32_bf16 v[200:203], v[84:87], v[164:167], 0
    v_mfma_f32_16x16x32_bf16 v[204:207], v[50:53], v[168:171], 0
    v_mfma_f32_16x16x32_bf16 v[208:211], v[86:89], v[168:171], 0
    v_mfma_f32_16x16x32_bf16 v[212:215], v[52:55], v[172:175], 0
    v_mfma_f32_16x16x32_bf16 v[216:219], v[88:91], v[172:175], 0
    v_mfma_f32_16x16x32_bf16 v[220:223], v[54:57], v[176:179], 0
    v_mfma_f32_16x16x32_bf16 v[224:227], v[90:93], v[176:179], 0
    v_accvgpr_read_b32 v34, a160
    v_accvgpr_read_b32 v35, a161
    v_accvgpr_read_b32 v36, a162
    v_accvgpr_read_b32 v37, a163
    v_accvgpr_read_b32 v38, a164
    v_accvgpr_read_b32 v39, a165
    v_accvgpr_read_b32 v40, a166
    v_accvgpr_read_b32 v41, a167
    v_cvt_pk_bf16_f32 v148, v34, v35
    v_cvt_pk_bf16_f32 v149, v36, v37
    v_cvt_pk_bf16_f32 v150, v38, v39
    v_cvt_pk_bf16_f32 v151, v40, v41
    v_accvgpr_read_b32 v246, a224
    v_accvgpr_read_b32 v247, a225
    v_accvgpr_read_b32 v248, a226
    v_accvgpr_read_b32 v249, a227
    v_accvgpr_read_b32 v250, a228
    v_accvgpr_read_b32 v251, a229
    v_accvgpr_read_b32 v252, a230
    v_accvgpr_read_b32 v253, a231
    v_cvt_pk_bf16_f32 v180, v246, v247
    v_cvt_pk_bf16_f32 v181, v248, v249
    v_cvt_pk_bf16_f32 v182, v250, v251
    v_cvt_pk_bf16_f32 v183, v252, v253
    v_accvgpr_read_b32 v34, a168
    v_accvgpr_read_b32 v35, a169
    v_accvgpr_read_b32 v36, a170
    v_accvgpr_read_b32 v37, a171
    v_accvgpr_read_b32 v38, a172
    v_accvgpr_read_b32 v39, a173
    v_accvgpr_read_b32 v40, a174
    v_accvgpr_read_b32 v41, a175
    v_cvt_pk_bf16_f32 v152, v34, v35
    v_cvt_pk_bf16_f32 v153, v36, v37
    v_cvt_pk_bf16_f32 v154, v38, v39
    v_cvt_pk_bf16_f32 v155, v40, v41
    v_accvgpr_read_b32 v246, a232
    v_accvgpr_read_b32 v247, a233
    v_accvgpr_read_b32 v248, a234
    v_accvgpr_read_b32 v249, a235
    v_accvgpr_read_b32 v250, a236
    v_accvgpr_read_b32 v251, a237
    v_accvgpr_read_b32 v252, a238
    v_accvgpr_read_b32 v253, a239
    v_cvt_pk_bf16_f32 v184, v246, v247
    v_cvt_pk_bf16_f32 v185, v248, v249
    v_cvt_pk_bf16_f32 v186, v250, v251
    v_cvt_pk_bf16_f32 v187, v252, v253
    v_accvgpr_read_b32 v34, a176
    v_accvgpr_read_b32 v35, a177
    v_accvgpr_read_b32 v36, a178
    v_accvgpr_read_b32 v37, a179
    v_accvgpr_read_b32 v38, a180
    v_accvgpr_read_b32 v39, a181
    v_accvgpr_read_b32 v40, a182
    v_accvgpr_read_b32 v41, a183
    v_cvt_pk_bf16_f32 v156, v34, v35
    v_cvt_pk_bf16_f32 v157, v36, v37
    v_cvt_pk_bf16_f32 v158, v38, v39
    v_cvt_pk_bf16_f32 v159, v40, v41
    v_accvgpr_read_b32 v246, a240
    v_accvgpr_read_b32 v247, a241
    v_accvgpr_read_b32 v248, a242
    v_accvgpr_read_b32 v249, a243
    v_accvgpr_read_b32 v250, a244
    v_accvgpr_read_b32 v251, a245
    v_accvgpr_read_b32 v252, a246
    v_accvgpr_read_b32 v253, a247
    v_cvt_pk_bf16_f32 v188, v246, v247
    v_cvt_pk_bf16_f32 v189, v248, v249
    v_cvt_pk_bf16_f32 v190, v250, v251
    v_cvt_pk_bf16_f32 v191, v252, v253
    v_accvgpr_read_b32 v34, a184
    v_accvgpr_read_b32 v35, a185
    v_accvgpr_read_b32 v36, a186
    v_accvgpr_read_b32 v37, a187
    v_accvgpr_read_b32 v38, a188
    v_accvgpr_read_b32 v39, a189
    v_accvgpr_read_b32 v40, a190
    v_accvgpr_read_b32 v41, a191
    v_cvt_pk_bf16_f32 v160, v34, v35
    v_cvt_pk_bf16_f32 v161, v36, v37
    v_cvt_pk_bf16_f32 v162, v38, v39
    v_cvt_pk_bf16_f32 v163, v40, v41
    v_accvgpr_read_b32 v246, a248
    v_accvgpr_read_b32 v247, a249
    v_accvgpr_read_b32 v248, a250
    v_accvgpr_read_b32 v249, a251
    v_accvgpr_read_b32 v250, a252
    v_accvgpr_read_b32 v251, a253
    v_accvgpr_read_b32 v252, a254
    v_accvgpr_read_b32 v253, a255
    v_cvt_pk_bf16_f32 v192, v246, v247
    v_cvt_pk_bf16_f32 v193, v248, v249
    v_cvt_pk_bf16_f32 v194, v250, v251
    v_cvt_pk_bf16_f32 v195, v252, v253
    v_cvt_pk_bf16_f32 v196, v196, v197
    v_cvt_pk_bf16_f32 v197, v198, v199
    v_cvt_pk_bf16_f32 v198, v200, v201
    v_cvt_pk_bf16_f32 v199, v202, v203
    buffer_store_dwordx4 v[196:199], v16, s[56:59], s91 offen offset:0 sc1
    s_add_u32 s91, s91, 32768
    v_cvt_pk_bf16_f32 v204, v204, v205
    v_cvt_pk_bf16_f32 v205, v206, v207
    v_cvt_pk_bf16_f32 v206, v208, v209
    v_cvt_pk_bf16_f32 v207, v210, v211
    buffer_store_dwordx4 v[204:207], v16, s[56:59], s91 offen offset:0 sc1
    s_add_u32 s91, s91, 32768
    v_cvt_pk_bf16_f32 v212, v212, v213
    v_cvt_pk_bf16_f32 v213, v214, v215
    v_cvt_pk_bf16_f32 v214, v216, v217
    v_cvt_pk_bf16_f32 v215, v218, v219
    buffer_store_dwordx4 v[212:215], v16, s[56:59], s91 offen offset:0 sc1
    s_add_u32 s91, s91, 32768
    v_cvt_pk_bf16_f32 v220, v220, v221
    v_cvt_pk_bf16_f32 v221, v222, v223
    v_cvt_pk_bf16_f32 v222, v224, v225
    v_cvt_pk_bf16_f32 v223, v226, v227
    s_branch L_over5
L_stub5:
    s_branch L_stub9
L_over5:
    buffer_store_dwordx4 v[220:223], v16, s[56:59], s91 offen offset:0 sc1
    s_add_u32 s91, s91, 32768
    s_mov_b32 s67, 0
    v_mfma_f32_16x16x32_bf16 v[196:199], v[144:147], v[180:183], 0
    v_mfma_f32_16x16x32_bf16 v[200:203], v[148:151], v[180:183], 0
    v_mfma_f32_16x16x32_bf16 v[204:207], v[148:151], v[184:187], 0
    v_mfma_f32_16x16x32_bf16 v[208:211], v[152:155], v[184:187], 0
    v_mfma_f32_16x16x32_bf16 v[212:215], v[152:155], v[188:191], 0
    v_mfma_f32_16x16x32_bf16 v[216:219], v[156:159], v[188:191], 0
    v_mfma_f32_16x16x32_bf16 v[220:223], v[156:159], v[192:195], 0
    v_mfma_f32_16x16x32_bf16 v[224:227], v[160:163], v[192:195], 0
    s_nop 0
    v_cvt_pk_bf16_f32 v196, v196, v197
    v_cvt_pk_bf16_f32 v198, v198, v199
    v_cvt_pk_bf16_f32 v200, v200, v201
    v_cvt_pk_bf16_f32 v202, v202, v203
    v_cvt_pk_bf16_f32 v204, v204, v205
    v_cvt_pk_bf16_f32 v206, v206, v207
    v_cvt_pk_bf16_f32 v208, v208, v209
    v_cvt_pk_bf16_f32 v210, v210, v211
    v_cvt_pk_bf16_f32 v212, v212, v213
    v_cvt_pk_bf16_f32 v214, v214, v215
    v_cvt_pk_bf16_f32 v216, v216, v217
    v_cvt_pk_bf16_f32 v218, v218, v219
    v_cvt_pk_bf16_f32 v220, v220, v221
    v_cvt_pk_bf16_f32 v222, v222, v223
    v_cvt_pk_bf16_f32 v224, v224, v225
    v_cvt_pk_bf16_f32 v226, v226, v227
    v_perm_b32 v228, v200, v196, v28
    v_perm_b32 v229, v202, v198, v29
    v_perm_b32 v230, v208, v204, v28
    v_perm_b32 v231, v210, v206, v29
    v_perm_b32 v232, v216, v212, v28
    v_perm_b32 v233, v218, v214, v29
    v_perm_b32 v234, v224, v220, v28
    v_perm_b32 v235, v226, v222, v29
    v_pk_mul_f32 v[228:229], v[228:229], s[14:15]
    v_pk_mul_f32 v[230:231], v[230:231], s[14:15]
    v_pk_mul_f32 v[232:233], v[232:233], s[14:15]
    v_pk_mul_f32 v[234:235], v[234:235], s[14:15]
    v_cvt_pk_bf16_f32 v229, v228, v229
    v_cvt_pk_bf16_f32 v231, v230, v231
    v_cvt_pk_bf16_f32 v233, v232, v233
    v_cvt_pk_bf16_f32 v235, v234, v235
    v_lshlrev_b32 v228, 16, v229
    v_and_b32 v229, 0xffff0000, v229
    v_lshlrev_b32 v230, 16, v231
    v_and_b32 v231, 0xffff0000, v231
    v_lshlrev_b32 v232, 16, v233
    v_and_b32 v233, 0xffff0000, v233
    v_lshlrev_b32 v234, 16, v235
    v_and_b32 v235, 0xffff0000, v235
    buffer_load_dword v43, off, s[56:59], s92 sc1
    v_max_f32 v236, v228, v229
    v_max_f32 v238, v230, v231
    v_max_f32 v240, v232, v233
    v_max_f32 v242, v234, v235
    v_permlane16_swap_b32 v236, v238
    s_nop 0
    v_permlane16_swap_b32 v240, v242
    v_max_f32 v236, v236, v238
    v_max_f32 v240, v240, v242
    s_nop 1
    v_permlane32_swap_b32 v236, v240
    v_max_f32 v236, v236, v240
    v_mul_f32 v236, 0xbfb8aa3b, v236
    v_mov_b32 v240, v236
    s_nop 1
    v_permlane32_swap_b32 v236, v240
    v_mov_b32 v238, v236
    v_mov_b32 v242, v240
    s_nop 0
    v_permlane16_swap_b32 v236, v238
    v_permlane16_swap_b32 v240, v242
    v_pk_fma_f32 v[228:229], v[228:229], s[98:99], v[236:237] op_sel_hi:[1,1,0]
    v_pk_fma_f32 v[230:231], v[230:231], s[98:99], v[238:239] op_sel_hi:[1,1,0]
    v_pk_fma_f32 v[232:233], v[232:233], s[98:99], v[240:241] op_sel_hi:[1,1,0]
    v_pk_fma_f32 v[234:235], v[234:235], s[98:99], v[242:243] op_sel_hi:[1,1,0]
    v_exp_f32 v228, v228
    v_exp_f32 v229, v229
    v_exp_f32 v230, v230
    v_exp_f32 v231, v231
    v_exp_f32 v232, v232
    v_exp_f32 v233, v233
    v_exp_f32 v234, v234
    v_exp_f32 v235, v235
    v_add_f32 v236, v228, v229
    v_add_f32 v238, v230, v231
    v_add_f32 v240, v232, v233
    v_add_f32 v242, v234, v235
    v_permlane16_swap_b32 v236, v238
    s_nop 0
    v_permlane16_swap_b32 v240, v242
    v_add_f32 v236, v236, v238
    v_add_f32 v240, v240, v242
    s_nop 1
    v_permlane32_swap_b32 v236, v240
    v_add_f32 v236, v236, v240
    v_rcp_f32 v236, v236
    s_nop 0
    v_mov_b32 v240, v236
    s_nop 1
    v_permlane32_swap_b32 v236, v240
    v_mov_b32 v238, v236
    v_mov_b32 v242, v240
    s_nop 0
    v_permlane16_swap_b32 v236, v238
    v_permlane16_swap_b32 v240, v242
    v_pk_mul_f32 v[228:229], v[228:229], v[236:237] op_sel_hi:[1,0]
    v_pk_mul_f32 v[230:231], v[230:231], v[238:239] op_sel_hi:[1,0]
    v_pk_mul_f32 v[232:233], v[232:233], v[240:241] op_sel_hi:[1,0]
    v_pk_mul_f32 v[234:235], v[234:235], v[242:243] op_sel_hi:[1,0]
    v_cvt_pk_bf16_f32 v228, v228, v229
    v_cvt_pk_bf16_f32 v230, v230, v231
    v_cvt_pk_bf16_f32 v232, v232, v233
    v_cvt_pk_bf16_f32 v234, v234, v235
    v_perm_b32 v180, v228, v228, v30
    v_perm_b32 v181, v228, v228, v31
    v_perm_b32 v182, v228, v228, v32
    v_perm_b32 v183, v228, v228, v33
    v_perm_b32 v184, v230, v230, v30
    v_perm_b32 v185, v230, v230, v31
    v_perm_b32 v186, v230, v230, v32
    v_perm_b32 v187, v230, v230, v33
    v_perm_b32 v188, v232, v232, v30
    v_perm_b32 v189, v232, v232, v31
    v_perm_b32 v190, v232, v232, v32
    v_perm_b32 v191, v232, v232, v33
    v_perm_b32 v192, v234, v234, v30
    v_perm_b32 v193, v234, v234, v31
    v_perm_b32 v194, v234, v234, v32
    v_perm_b32 v195, v234, v234, v33
    v_mfma_f32_16x16x32_bf16 v[196:199], v[56:59], v[180:183], 0
    v_mfma_f32_16x16x32_bf16 v[200:203], v[92:95], v[180:183], 0
    v_mfma_f32_16x16x32_bf16 v[204:207], v[58:61], v[184:187], 0
    v_mfma_f32_16x16x32_bf16 v[208:211], v[94:97], v[184:187], 0
    v_mfma_f32_16x16x32_bf16 v[212:215], v[60:63], v[188:191], 0
    v_mfma_f32_16x16x32_bf16 v[216:219], v[96:99], v[188:191], 0
    v_mfma_f32_16x16x32_bf16 v[220:223], v[62:65], v[192:195], 0
    v_mfma_f32_16x16x32_bf16 v[224:227], v[98:101], v[192:195], 0
    s_nop 0
    v_cvt_pk_bf16_f32 v196, v196, v197
    v_cvt_pk_bf16_f32 v197, v198, v199
    v_cvt_pk_bf16_f32 v198, v200, v201
    v_cvt_pk_bf16_f32 v199, v202, v203
    buffer_store_dwordx4 v[196:199], v16, s[56:59], s91 offen offset:0 sc1
    s_add_u32 s91, s91, 32768
    v_cvt_pk_bf16_f32 v204, v204, v205
    v_cvt_pk_bf16_f32 v205, v206, v207
    v_cvt_pk_bf16_f32 v206, v208, v209
    v_cvt_pk_bf16_f32 v207, v210, v211
    buffer_store_dwordx4 v[204:207], v16, s[56:59], s91 offen offset:0 sc1
    s_add_u32 s91, s91, 32768
    v_cvt_pk_bf16_f32 v212, v212, v213
    v_cvt_pk_bf16_f32 v213, v214, v215
    v_cvt_pk_bf16_f32 v214, v216, v217
    v_cvt_pk_bf16_f32 v215, v218, v219
    buffer_store_dwordx4 v[212:215], v16, s[56:59], s91 offen offset:0 sc1
    s_add_u32 s91, s91, 32768
    v_cvt_pk_bf16_f32 v220, v220, v221
    v_cvt_pk_bf16_f32 v221, v222, v223
    v_cvt_pk_bf16_f32 v222, v224, v225
    v_cvt_pk_bf16_f32 v223, v226, v227
    buffer_store_dwordx4 v[220:223], v16, s[56:59], s91 offen offset:0 sc1
    s_add_u32 s91, s91, 32768
    s_waitcnt vmcnt(4)
    v_readfirstlane_b32 s86, v43
    s_bfe_u32 s86, s86, 0x80000
    s_cmp_eq_u32 s86, 32
    s_cbranch_scc0 L_spA0
L_okA0:
    buffer_load_dwordx4 a[0:3], v21, s[56:59], s68 offen sc1
    buffer_load_dwordx4 a[4:7], v22, s[56:59], s68 offen sc1
    buffer_load_dwordx4 a[8:11], v23, s[56:59], s68 offen sc1
    buffer_load_dwordx4 a[12:15], v24, s[56:59], s68 offen sc1
    s_add_u32 s68, s68, 16384
    buffer_load_dwordx4 a[16:19], v21, s[56:59], s68 offen sc1
    buffer_load_dwordx4 a[20:23], v22, s[56:59], s68 offen sc1
    buffer_load_dwordx4 a[24:27], v23, s[56:59], s68 offen sc1
    buffer_load_dwordx4 a[28:31], v24, s[56:59], s68 offen sc1
    s_add_u32 s68, s68, 16384
    buffer_load_dwordx4 a[32:35], v21, s[56:59], s68 offen sc1
    buffer_load_dwordx4 a[36:39], v22, s[56:59], s68 offen sc1
    buffer_load_dwordx4 a[40:43], v23, s[56:59], s68 offen sc1
    buffer_load_dwordx4 a[44:47], v24, s[56:59], s68 offen sc1
    s_add_u32 s68, s68, 16384
    buffer_load_dwordx4 a[48:51], v21, s[56:59], s68 offen sc1
    buffer_load_dwordx4 a[52:55], v22, s[56:59], s68 offen sc1
    buffer_load_dwordx4 a[56:59], v23, s[56:59], s68 offen sc1
    buffer_load_dwordx4 a[60:63], v24, s[56:59], s68 offen sc1
    s_add_u32 s68, s68, 16384
    s_barrier
    s_branch L_D
L_stub6:
    s_branch L_stub10
L_epi1:
    s_mov_b32 s67, 0
    v_accvgpr_read_b32 v128, a128
    v_accvgpr_read_b32 v129, a129
    v_accvgpr_read_b32 v130, a130
    v_accvgpr_read_b32 v131, a131
    v_accvgpr_read_b32 v132, a132
    v_accvgpr_read_b32 v133, a133
    v_accvgpr_read_b32 v134, a134
    v_accvgpr_read_b32 v135, a135
    v_accvgpr_read_b32 v136, a136
    v_accvgpr_read_b32 v137, a137
    v_accvgpr_read_b32 v138, a138
    v_accvgpr_read_b32 v139, a139
    v_accvgpr_read_b32 v140, a140
    v_accvgpr_read_b32 v141, a141
    v_accvgpr_read_b32 v142, a142
    v_accvgpr_read_b32 v143, a143
    v_pk_mul_f32 v[34:35], v[128:129], v[128:129]
    v_pk_mul_f32 v[36:37], v[130:131], v[130:131]
    v_pk_mul_f32 v[38:39], v[132:133], v[132:133]
    v_pk_mul_f32 v[40:41], v[134:135], v[134:135]
    v_pk_fma_f32 v[34:35], v[34:35], s[94:95], v[26:27]
    v_pk_fma_f32 v[36:37], v[36:37], s[94:95], v[26:27]
    v_pk_fma_f32 v[38:39], v[38:39], s[94:95], v[26:27]
    v_pk_fma_f32 v[40:41], v[40:41], s[94:95], v[26:27]
    v_pk_mul_f32 v[34:35], v[34:35], v[128:129]
    v_pk_mul_f32 v[36:37], v[36:37], v[130:131]
    v_pk_mul_f32 v[38:39], v[38:39], v[132:133]
    v_pk_mul_f32 v[40:41], v[40:41], v[134:135]
    v_exp_f32 v34, v34
    v_exp_f32 v35, v35
    v_exp_f32 v36, v36
    v_exp_f32 v37, v37
    v_exp_f32 v38, v38
    v_exp_f32 v39, v39
    v_exp_f32 v40, v40
    v_exp_f32 v41, v41
    v_pk_mul_f32 v[136:137], v[136:137], v[128:129]
    v_pk_mul_f32 v[138:139], v[138:139], v[130:131]
    v_pk_mul_f32 v[140:141], v[140:141], v[132:133]
    v_pk_mul_f32 v[142:143], v[142:143], v[134:135]
    v_pk_add_f32 v[34:35], v[34:35], 1.0 op_sel_hi:[1,0]
    v_pk_add_f32 v[36:37], v[36:37], 1.0 op_sel_hi:[1,0]
    v_pk_add_f32 v[38:39], v[38:39], 1.0 op_sel_hi:[1,0]
    v_pk_add_f32 v[40:41], v[40:41], 1.0 op_sel_hi:[1,0]
    v_rcp_f32 v34, v34
    v_rcp_f32 v35, v35
    v_rcp_f32 v36, v36
    v_rcp_f32 v37, v37
    v_rcp_f32 v38, v38
    v_rcp_f32 v39, v39
    v_rcp_f32 v40, v40
    v_rcp_f32 v41, v41
    v_pk_mul_f32 v[136:137], v[136:137], v[34:35]
    v_pk_mul_f32 v[138:139], v[138:139], v[36:37]
    v_pk_mul_f32 v[140:141], v[140:141], v[38:39]
    v_pk_mul_f32 v[142:143], v[142:143], v[40:41]
    v_cvt_pk_bf16_f32 v128, v136, v137
    v_cvt_pk_bf16_f32 v129, v138, v139
    v_cvt_pk_bf16_f32 v130, v140, v141
    v_cvt_pk_bf16_f32 v131, v142, v143
    buffer_store_dwordx4 v[128:131], v16, s[56:59], s89 offen offset:0 sc1
    s_waitcnt vmcnt(1)
    s_mov_b64 exec, 1
    buffer_atomic_add v25, off, s[56:59], s92 sc1
    s_mov_b64 exec, -1
    v_accvgpr_read_b32 v144, a144
    v_accvgpr_read_b32 v145, a145
    v_accvgpr_read_b32 v146, a146
    v_accvgpr_read_b32 v147, a147
    v_accvgpr_read_b32 v148, a148
    v_accvgpr_read_b32 v149, a149
    v_accvgpr_read_b32 v150, a150
    v_accvgpr_read_b32 v151, a151
    v_accvgpr_read_b32 v152, a152
    v_accvgpr_read_b32 v153, a153
    v_accvgpr_read_b32 v154, a154
    v_accvgpr_read_b32 v155, a155
    v_accvgpr_read_b32 v156, a156
    v_accvgpr_read_b32 v157, a157
    v_accvgpr_read_b32 v158, a158
    v_accvgpr_read_b32 v159, a159
    v_pk_mul_f32 v[34:35], v[144:145], v[144:145]
    v_pk_mul_f32 v[36:37], v[146:147], v[146:147]
    v_pk_mul_f32 v[38:39], v[148:149], v[148:149]
    v_pk_mul_f32 v[40:41], v[150:151], v[150:151]
    v_pk_fma_f32 v[34:35], v[34:35], s[94:95], v[26:27]
    v_pk_fma_f32 v[36:37], v[36:37], s[94:95], v[26:27]
    v_pk_fma_f32 v[38:39], v[38:39], s[94:95], v[26:27]
    v_pk_fma_f32 v[40:41], v[40:41], s[94:95], v[26:27]
    v_pk_mul_f32 v[34:35], v[34:35], v[144:145]
    v_pk_mul_f32 v[36:37], v[36:37], v[146:147]
    v_pk_mul_f32 v[38:39], v[38:39], v[148:149]
    v_pk_mul_f32 v[40:41], v[40:41], v[150:151]
    v_exp_f32 v34, v34
    v_exp_f32 v35, v35
    v_exp_f32 v36, v36
    v_exp_f32 v37, v37
    v_exp_f32 v38, v38
    v_exp_f32 v39, v39
    v_exp_f32 v40, v40
    v_exp_f32 v41, v41
    v_pk_mul_f32 v[152:153], v[152:153], v[144:145]
    v_pk_mul_f32 v[154:155], v[154:155], v[146:147]
    v_pk_mul_f32 v[156:157], v[156:157], v[148:149]
    v_pk_mul_f32 v[158:159], v[158:159], v[150:151]
    v_pk_add_f32 v[34:35], v[34:35], 1.0 op_sel_hi:[1,0]
    v_pk_add_f32 v[36:37], v[36:37], 1.0 op_sel_hi:[1,0]
    v_pk_add_f32 v[38:39], v[38:39], 1.0 op_sel_hi:[1,0]
    v_pk_add_f32 v[40:41], v[40:41], 1.0 op_sel_hi:[1,0]
    v_rcp_f32 v34, v34
    v_rcp_f32 v35, v35
    v_rcp_f32 v36, v36
    v_rcp_f32 v37, v37
    v_rcp_f32 v38, v38
    v_rcp_f32 v39, v39
    v_rcp_f32 v40, v40
    v_rcp_f32 v41, v41
    v_pk_mul_f32 v[152:153], v[152:153], v[34:35]
    v_pk_mul_f32 v[154:155], v[154:155], v[36:37]
    v_pk_mul_f32 v[156:157], v[156:157], v[38:39]
    v_pk_mul_f32 v[158:159], v[158:159], v[40:41]
    v_cvt_pk_bf16_f32 v144, v152, v153
    v_cvt_pk_bf16_f32 v145, v154, v155
    v_cvt_pk_bf16_f32 v146, v156, v157
    v_cvt_pk_bf16_f32 v147, v158, v159
    buffer_store_dwordx4 v[144:147], v16, s[56:59], s89 offen offset:1024 sc1
    v_accvgpr_read_b32 v160, a160
    v_accvgpr_read_b32 v161, a161
    v_accvgpr_read_b32 v162, a162
    v_accvgpr_read_b32 v163, a163
    v_accvgpr_read_b32 v164, a164
    v_accvgpr_read_b32 v165, a165
    v_accvgpr_read_b32 v166, a166
    v_accvgpr_read_b32 v167, a167
    v_accvgpr_read_b32 v168, a168
    v_accvgpr_read_b32 v169, a169
    v_accvgpr_read_b32 v170, a170
    v_accvgpr_read_b32 v171, a171
    v_accvgpr_read_b32 v172, a172
    v_accvgpr_read_b32 v173, a173
    v_accvgpr_read_b32 v174, a174
    v_accvgpr_read_b32 v175, a175
    v_pk_mul_f32 v[34:35], v[160:161], v[160:161]
    v_pk_mul_f32 v[36:37], v[162:163], v[162:163]
    v_pk_mul_f32 v[38:39], v[164:165], v[164:165]
    v_pk_mul_f32 v[40:41], v[166:167], v[166:167]
    v_pk_fma_f32 v[34:35], v[34:35], s[94:95], v[26:27]
    v_pk_fma_f32 v[36:37], v[36:37], s[94:95], v[26:27]
    v_pk_fma_f32 v[38:39], v[38:39], s[94:95], v[26:27]
    v_pk_fma_f32 v[40:41], v[40:41], s[94:95], v[26:27]
    v_pk_mul_f32 v[34:35], v[34:35], v[160:161]
    v_pk_mul_f32 v[36:37], v[36:37], v[162:163]
    v_pk_mul_f32 v[38:39], v[38:39], v[164:165]
    v_pk_mul_f32 v[40:41], v[40:41], v[166:167]
    v_exp_f32 v34, v34
    v_exp_f32 v35, v35
    v_exp_f32 v36, v36
    v_exp_f32 v37, v37
    v_exp_f32 v38, v38
    v_exp_f32 v39, v39
    v_exp_f32 v40, v40
    v_exp_f32 v41, v41
    v_pk_mul_f32 v[168:169], v[168:169], v[160:161]
    v_pk_mul_f32 v[170:171], v[170:171], v[162:163]
    v_pk_mul_f32 v[172:173], v[172:173], v[164:165]
    v_pk_mul_f32 v[174:175], v[174:175], v[166:167]
    v_pk_add_f32 v[34:35], v[34:35], 1.0 op_sel_hi:[1,0]
    v_pk_add_f32 v[36:37], v[36:37], 1.0 op_sel_hi:[1,0]
    v_pk_add_f32 v[38:39], v[38:39], 1.0 op_sel_hi:[1,0]
    v_pk_add_f32 v[40:41], v[40:41], 1.0 op_sel_hi:[1,0]
    v_rcp_f32 v34, v34
    v_rcp_f32 v35, v35
    v_rcp_f32 v36, v36
    v_rcp_f32 v37, v37
    v_rcp_f32 v38, v38
    v_rcp_f32 v39, v39
    v_rcp_f32 v40, v40
    v_rcp_f32 v41, v41
    v_pk_mul_f32 v[168:169], v[168:169], v[34:35]
    v_pk_mul_f32 v[170:171], v[170:171], v[36:37]
    v_pk_mul_f32 v[172:173], v[172:173], v[38:39]
    v_pk_mul_f32 v[174:175], v[174:175], v[40:41]
    v_cvt_pk_bf16_f32 v160, v168, v169
    v_cvt_pk_bf16_f32 v161, v170, v171
    v_cvt_pk_bf16_f32 v162, v172, v173
    v_cvt_pk_bf16_f32 v163, v174, v175
    buffer_store_dwordx4 v[160:163], v16, s[56:59], s89 offen offset:2048 sc1
    v_accvgpr_read_b32 v176, a176
    v_accvgpr_read_b32 v177, a177
    v_accvgpr_read_b32 v178, a178
    v_accvgpr_read_b32 v179, a179
    v_accvgpr_read_b32 v180, a180
    v_accvgpr_read_b32 v181, a181
    v_accvgpr_read_b32 v182, a182
    v_accvgpr_read_b32 v183, a183
    v_accvgpr_read_b32 v184, a184
    v_accvgpr_read_b32 v185, a185
    v_accvgpr_read_b32 v186, a186
    v_accvgpr_read_b32 v187, a187
    v_accvgpr_read_b32 v188, a188
    v_accvgpr_read_b32 v189, a189
    v_accvgpr_read_b32 v190, a190
    v_accvgpr_read_b32 v191, a191
    v_pk_mul_f32 v[34:35], v[176:177], v[176:177]
    v_pk_mul_f32 v[36:37], v[178:179], v[178:179]
    v_pk_mul_f32 v[38:39], v[180:181], v[180:181]
    v_pk_mul_f32 v[40:41], v[182:183], v[182:183]
    v_pk_fma_f32 v[34:35], v[34:35], s[94:95], v[26:27]
    v_pk_fma_f32 v[36:37], v[36:37], s[94:95], v[26:27]
    v_pk_fma_f32 v[38:39], v[38:39], s[94:95], v[26:27]
    v_pk_fma_f32 v[40:41], v[40:41], s[94:95], v[26:27]
    v_pk_mul_f32 v[34:35], v[34:35], v[176:177]
    v_pk_mul_f32 v[36:37], v[36:37], v[178:179]
    v_pk_mul_f32 v[38:39], v[38:39], v[180:181]
    v_pk_mul_f32 v[40:41], v[40:41], v[182:183]
    v_exp_f32 v34, v34
    v_exp_f32 v35, v35
    v_exp_f32 v36, v36
    v_exp_f32 v37, v37
    v_exp_f32 v38, v38
    v_exp_f32 v39, v39
    v_exp_f32 v40, v40
    v_exp_f32 v41, v41
    v_pk_mul_f32 v[184:185], v[184:185], v[176:177]
    v_pk_mul_f32 v[186:187], v[186:187], v[178:179]
    v_pk_mul_f32 v[188:189], v[188:189], v[180:181]
    v_pk_mul_f32 v[190:191], v[190:191], v[182:183]
    v_pk_add_f32 v[34:35], v[34:35], 1.0 op_sel_hi:[1,0]
    v_pk_add_f32 v[36:37], v[36:37], 1.0 op_sel_hi:[1,0]
    v_pk_add_f32 v[38:39], v[38:39], 1.0 op_sel_hi:[1,0]
    v_pk_add_f32 v[40:41], v[40:41], 1.0 op_sel_hi:[1,0]
    v_rcp_f32 v34, v34
    v_rcp_f32 v35, v35
    v_rcp_f32 v36, v36
    v_rcp_f32 v37, v37
    v_rcp_f32 v38, v38
    v_rcp_f32 v39, v39
    v_rcp_f32 v40, v40
    v_rcp_f32 v41, v41
    v_pk_mul_f32 v[184:185], v[184:185], v[34:35]
    v_pk_mul_f32 v[186:187], v[186:187], v[36:37]
    v_pk_mul_f32 v[188:189], v[188:189], v[38:39]
    v_pk_mul_f32 v[190:191], v[190:191], v[40:41]
    v_cvt_pk_bf16_f32 v176, v184, v185
    v_cvt_pk_bf16_f32 v177, v186, v187
    v_cvt_pk_bf16_f32 v178, v188, v189
    v_cvt_pk_bf16_f32 v179, v190, v191
    buffer_store_dwordx4 v[176:179], v16, s[56:59], s89 offen offset:3072 sc1
    v_accvgpr_read_b32 v128, a192
    v_accvgpr_read_b32 v129, a193
    v_accvgpr_read_b32 v130, a194
    v_accvgpr_read_b32 v131, a195
    v_accvgpr_read_b32 v132, a196
    v_accvgpr_read_b32 v133, a197
    v_accvgpr_read_b32 v134, a198
    v_accvgpr_read_b32 v135, a199
    v_accvgpr_read_b32 v136, a200
    v_accvgpr_read_b32 v137, a201
    v_accvgpr_read_b32 v138, a202
    v_accvgpr_read_b32 v139, a203
    v_accvgpr_read_b32 v140, a204
    v_accvgpr_read_b32 v141, a205
    v_accvgpr_read_b32 v142, a206
    v_accvgpr_read_b32 v143, a207
    v_pk_mul_f32 v[34:35], v[128:129], v[128:129]
    v_pk_mul_f32 v[36:37], v[130:131], v[130:131]
    v_pk_mul_f32 v[38:39], v[132:133], v[132:133]
    v_pk_mul_f32 v[40:41], v[134:135], v[134:135]
    v_pk_fma_f32 v[34:35], v[34:35], s[94:95], v[26:27]
    v_pk_fma_f32 v[36:37], v[36:37], s[94:95], v[26:27]
    v_pk_fma_f32 v[38:39], v[38:39], s[94:95], v[26:27]
    v_pk_fma_f32 v[40:41], v[40:41], s[94:95], v[26:27]
    v_pk_mul_f32 v[34:35], v[34:35], v[128:129]
    v_pk_mul_f32 v[36:37], v[36:37], v[130:131]
    v_pk_mul_f32 v[38:39], v[38:39], v[132:133]
    v_pk_mul_f32 v[40:41], v[40:41], v[134:135]
    v_exp_f32 v34, v34
    v_exp_f32 v35, v35
    v_exp_f32 v36, v36
    v_exp_f32 v37, v37
    v_exp_f32 v38, v38
    v_exp_f32 v39, v39
    v_exp_f32 v40, v40
    v_exp_f32 v41, v41
    v_pk_mul_f32 v[136:137], v[136:137], v[128:129]
    v_pk_mul_f32 v[138:139], v[138:139], v[130:131]
    v_pk_mul_f32 v[140:141], v[140:141], v[132:133]
    v_pk_mul_f32 v[142:143], v[142:143], v[134:135]
    v_pk_add_f32 v[34:35], v[34:35], 1.0 op_sel_hi:[1,0]
    v_pk_add_f32 v[36:37], v[36:37], 1.0 op_sel_hi:[1,0]
    v_pk_add_f32 v[38:39], v[38:39], 1.0 op_sel_hi:[1,0]
    v_pk_add_f32 v[40:41], v[40:41], 1.0 op_sel_hi:[1,0]
    v_rcp_f32 v34, v34
    v_rcp_f32 v35, v35
    v_rcp_f32 v36, v36
    v_rcp_f32 v37, v37
    v_rcp_f32 v38, v38
    v_rcp_f32 v39, v39
    v_rcp_f32 v40, v40
    v_rcp_f32 v41, v41
    v_pk_mul_f32 v[136:137], v[136:137], v[34:35]
    v_pk_mul_f32 v[138:139], v[138:139], v[36:37]
    v_pk_mul_f32 v[140:141], v[140:141], v[38:39]
    v_pk_mul_f32 v[142:143], v[142:143], v[40:41]
    v_cvt_pk_bf16_f32 v128, v136, v137
    v_cvt_pk_bf16_f32 v129, v138, v139
    v_cvt_pk_bf16_f32 v130, v140, v141
    v_cvt_pk_bf16_f32 v131, v142, v143
    s_add_u32 s89, s89, 4096
    buffer_store_dwordx4 v[128:131], v16, s[56:59], s89 offen offset:0 sc1
    v_accvgpr_read_b32 v144, a208
    v_accvgpr_read_b32 v145, a209
    v_accvgpr_read_b32 v146, a210
    v_accvgpr_read_b32 v147, a211
    v_accvgpr_read_b32 v148, a212
    v_accvgpr_read_b32 v149, a213
    v_accvgpr_read_b32 v150, a214
    v_accvgpr_read_b32 v151, a215
    v_accvgpr_read_b32 v152, a216
    v_accvgpr_read_b32 v153, a217
    v_accvgpr_read_b32 v154, a218
    v_accvgpr_read_b32 v155, a219
    v_accvgpr_read_b32 v156, a220
    v_accvgpr_read_b32 v157, a221
    v_accvgpr_read_b32 v158, a222
    v_accvgpr_read_b32 v159, a223
    v_pk_mul_f32 v[34:35], v[144:145], v[144:145]
    v_pk_mul_f32 v[36:37], v[146:147], v[146:147]
    v_pk_mul_f32 v[38:39], v[148:149], v[148:149]
    v_pk_mul_f32 v[40:41], v[150:151], v[150:151]
    v_pk_fma_f32 v[34:35], v[34:35], s[94:95], v[26:27]
    v_pk_fma_f32 v[36:37], v[36:37], s[94:95], v[26:27]
    v_pk_fma_f32 v[38:39], v[38:39], s[94:95], v[26:27]
    v_pk_fma_f32 v[40:41], v[40:41], s[94:95], v[26:27]
    v_pk_mul_f32 v[34:35], v[34:35], v[144:145]
    v_pk_mul_f32 v[36:37], v[36:37], v[146:147]
    v_pk_mul_f32 v[38:39], v[38:39], v[148:149]
    v_pk_mul_f32 v[40:41], v[40:41], v[150:151]
    v_exp_f32 v34, v34
    v_exp_f32 v35, v35
    v_exp_f32 v36, v36
    v_exp_f32 v37, v37
    v_exp_f32 v38, v38
    v_exp_f32 v39, v39
    v_exp_f32 v40, v40
    v_exp_f32 v41, v41
    v_pk_mul_f32 v[152:153], v[152:153], v[144:145]
    v_pk_mul_f32 v[154:155], v[154:155], v[146:147]
    v_pk_mul_f32 v[156:157], v[156:157], v[148:149]
    v_pk_mul_f32 v[158:159], v[158:159], v[150:151]
    v_pk_add_f32 v[34:35], v[34:35], 1.0 op_sel_hi:[1,0]
    v_pk_add_f32 v[36:37], v[36:37], 1.0 op_sel_hi:[1,0]
    v_pk_add_f32 v[38:39], v[38:39], 1.0 op_sel_hi:[1,0]
    v_pk_add_f32 v[40:41], v[40:41], 1.0 op_sel_hi:[1,0]
    v_rcp_f32 v34, v34
    v_rcp_f32 v35, v35
    v_rcp_f32 v36, v36
    v_rcp_f32 v37, v37
    v_rcp_f32 v38, v38
    v_rcp_f32 v39, v39
    v_rcp_f32 v40, v40
    v_rcp_f32 v41, v41
    v_pk_mul_f32 v[152:153], v[152:153], v[34:35]
    v_pk_mul_f32 v[154:155], v[154:155], v[36:37]
    v_pk_mul_f32 v[156:157], v[156:157], v[38:39]
    v_pk_mul_f32 v[158:159], v[158:159], v[40:41]
    v_cvt_pk_bf16_f32 v144, v152, v153
    v_cvt_pk_bf16_f32 v145, v154, v155
    v_cvt_pk_bf16_f32 v146, v156, v157
    v_cvt_pk_bf16_f32 v147, v158, v159
    buffer_store_dwordx4 v[144:147], v16, s[56:59], s89 offen offset:1024 sc1
    v_accvgpr_read_b32 v160, a224
    v_accvgpr_read_b32 v161, a225
    v_accvgpr_read_b32 v162, a226
    v_accvgpr_read_b32 v163, a227
    v_accvgpr_read_b32 v164, a228
    v_accvgpr_read_b32 v165, a229
    v_accvgpr_read_b32 v166, a230
    v_accvgpr_read_b32 v167, a231
    v_accvgpr_read_b32 v168, a232
    v_accvgpr_read_b32 v169, a233
    v_accvgpr_read_b32 v170, a234
    v_accvgpr_read_b32 v171, a235
    v_accvgpr_read_b32 v172, a236
    v_accvgpr_read_b32 v173, a237
    v_accvgpr_read_b32 v174, a238
    v_accvgpr_read_b32 v175, a239
    v_pk_mul_f32 v[34:35], v[160:161], v[160:161]
    v_pk_mul_f32 v[36:37], v[162:163], v[162:163]
    v_pk_mul_f32 v[38:39], v[164:165], v[164:165]
    v_pk_mul_f32 v[40:41], v[166:167], v[166:167]
    v_pk_fma_f32 v[34:35], v[34:35], s[94:95], v[26:27]
    v_pk_fma_f32 v[36:37], v[36:37], s[94:95], v[26:27]
    v_pk_fma_f32 v[38:39], v[38:39], s[94:95], v[26:27]
    v_pk_fma_f32 v[40:41], v[40:41], s[94:95], v[26:27]
    v_pk_mul_f32 v[34:35], v[34:35], v[160:161]
    v_pk_mul_f32 v[36:37], v[36:37], v[162:163]
    v_pk_mul_f32 v[38:39], v[38:39], v[164:165]
    v_pk_mul_f32 v[40:41], v[40:41], v[166:167]
    s_branch L_over7
L_stub7:
    s_branch L_stub11
L_over7:
    v_exp_f32 v34, v34
    v_exp_f32 v35, v35
    v_exp_f32 v36, v36
    v_exp_f32 v37, v37
    v_exp_f32 v38, v38
    v_exp_f32 v39, v39
    v_exp_f32 v40, v40
    v_exp_f32 v41, v41
    v_pk_mul_f32 v[168:169], v[168:169], v[160:161]
    v_pk_mul_f32 v[170:171], v[170:171], v[162:163]
    v_pk_mul_f32 v[172:173], v[172:173], v[164:165]
    v_pk_mul_f32 v[174:175], v[174:175], v[166:167]
    v_pk_add_f32 v[34:35], v[34:35], 1.0 op_sel_hi:[1,0]
    v_pk_add_f32 v[36:37], v[36:37], 1.0 op_sel_hi:[1,0]
    v_pk_add_f32 v[38:39], v[38:39], 1.0 op_sel_hi:[1,0]
    v_pk_add_f32 v[40:41], v[40:41], 1.0 op_sel_hi:[1,0]
    v_rcp_f32 v34, v34
    v_rcp_f32 v35, v35
    v_rcp_f32 v36, v36
    v_rcp_f32 v37, v37
    v_rcp_f32 v38, v38
    v_rcp_f32 v39, v39
    v_rcp_f32 v40, v40
    v_rcp_f32 v41, v41
    v_pk_mul_f32 v[168:169], v[168:169], v[34:35]
    v_pk_mul_f32 v[170:171], v[170:171], v[36:37]
    v_pk_mul_f32 v[172:173], v[172:173], v[38:39]
    v_pk_mul_f32 v[174:175], v[174:175], v[40:41]
    v_cvt_pk_bf16_f32 v160, v168, v169
    v_cvt_pk_bf16_f32 v161, v170, v171
    v_cvt_pk_bf16_f32 v162, v172, v173
    v_cvt_pk_bf16_f32 v163, v174, v175
    buffer_store_dwordx4 v[160:163], v16, s[56:59], s89 offen offset:2048 sc1
    buffer_load_dword v43, off, s[56:59], s92 sc1
    v_accvgpr_read_b32 v176, a240
    v_accvgpr_read_b32 v177, a241
    v_accvgpr_read_b32 v178, a242
    v_accvgpr_read_b32 v179, a243
    v_accvgpr_read_b32 v180, a244
    v_accvgpr_read_b32 v181, a245
    v_accvgpr_read_b32 v182, a246
    v_accvgpr_read_b32 v183, a247
    v_accvgpr_read_b32 v184, a248
    v_accvgpr_read_b32 v185, a249
    v_accvgpr_read_b32 v186, a250
    v_accvgpr_read_b32 v187, a251
    v_accvgpr_read_b32 v188, a252
    v_accvgpr_read_b32 v189, a253
    v_accvgpr_read_b32 v190, a254
    v_accvgpr_read_b32 v191, a255
    v_pk_mul_f32 v[34:35], v[176:177], v[176:177]
    v_pk_mul_f32 v[36:37], v[178:179], v[178:179]
    v_pk_mul_f32 v[38:39], v[180:181], v[180:181]
    v_pk_mul_f32 v[40:41], v[182:183], v[182:183]
    v_pk_fma_f32 v[34:35], v[34:35], s[94:95], v[26:27]
    v_pk_fma_f32 v[36:37], v[36:37], s[94:95], v[26:27]
    v_pk_fma_f32 v[38:39], v[38:39], s[94:95], v[26:27]
    v_pk_fma_f32 v[40:41], v[40:41], s[94:95], v[26:27]
    v_pk_mul_f32 v[34:35], v[34:35], v[176:177]
    v_pk_mul_f32 v[36:37], v[36:37], v[178:179]
    v_pk_mul_f32 v[38:39], v[38:39], v[180:181]
    v_pk_mul_f32 v[40:41], v[40:41], v[182:183]
    v_exp_f32 v34, v34
    v_exp_f32 v35, v35
    v_exp_f32 v36, v36
    v_exp_f32 v37, v37
    v_exp_f32 v38, v38
    v_exp_f32 v39, v39
    v_exp_f32 v40, v40
    v_exp_f32 v41, v41
    v_pk_mul_f32 v[184:185], v[184:185], v[176:177]
    v_pk_mul_f32 v[186:187], v[186:187], v[178:179]
    v_pk_mul_f32 v[188:189], v[188:189], v[180:181]
    v_pk_mul_f32 v[190:191], v[190:191], v[182:183]
    v_pk_add_f32 v[34:35], v[34:35], 1.0 op_sel_hi:[1,0]
    v_pk_add_f32 v[36:37], v[36:37], 1.0 op_sel_hi:[1,0]
    v_pk_add_f32 v[38:39], v[38:39], 1.0 op_sel_hi:[1,0]
    v_pk_add_f32 v[40:41], v[40:41], 1.0 op_sel_hi:[1,0]
    v_rcp_f32 v34, v34
    v_rcp_f32 v35, v35
    v_rcp_f32 v36, v36
    v_rcp_f32 v37, v37
    v_rcp_f32 v38, v38
    v_rcp_f32 v39, v39
    v_rcp_f32 v40, v40
    v_rcp_f32 v41, v41
    v_pk_mul_f32 v[184:185], v[184:185], v[34:35]
    v_pk_mul_f32 v[186:187], v[186:187], v[36:37]
    v_pk_mul_f32 v[188:189], v[188:189], v[38:39]
    v_pk_mul_f32 v[190:191], v[190:191], v[40:41]
    v_cvt_pk_bf16_f32 v176, v184, v185
    v_cvt_pk_bf16_f32 v177, v186, v187
    v_cvt_pk_bf16_f32 v178, v188, v189
    v_cvt_pk_bf16_f32 v179, v190, v191
    buffer_store_dwordx4 v[176:179], v16, s[56:59], s89 offen offset:3072 sc1
    s_waitcnt vmcnt(1)
    v_readfirstlane_b32 s86, v43
    s_bfe_u32 s86, s86, 0x80000
    s_cmp_eq_u32 s86, 32
    s_cbranch_scc0 L_spA1
L_okA1:
    v_pk_mul_f32 v[34:35], v[48:49], v[48:49]
    buffer_load_dwordx4 a[0:3], v21, s[56:59], s68 offen sc1
    v_pk_mul_f32 v[36:37], v[50:51], v[50:51]
    v_pk_mul_f32 v[38:39], v[52:53], v[52:53]
    v_pk_mul_f32 v[40:41], v[54:55], v[54:55]
    v_pk_fma_f32 v[34:35], v[34:35], s[94:95], v[26:27]
    v_pk_fma_f32 v[36:37], v[36:37], s[94:95], v[26:27]
    v_pk_fma_f32 v[38:39], v[38:39], s[94:95], v[26:27]
    v_pk_fma_f32 v[40:41], v[40:41], s[94:95], v[26:27]
    v_pk_mul_f32 v[34:35], v[34:35], v[48:49]
    buffer_load_dwordx4 a[4:7], v22, s[56:59], s68 offen sc1
    v_pk_mul_f32 v[36:37], v[36:37], v[50:51]
    v_pk_mul_f32 v[38:39], v[38:39], v[52:53]
    v_pk_mul_f32 v[40:41], v[40:41], v[54:55]
    v_exp_f32 v34, v34
    v_exp_f32 v35, v35
    v_exp_f32 v36, v36
    v_exp_f32 v37, v37
    v_exp_f32 v38, v38
    buffer_load_dwordx4 a[8:11], v23, s[56:59], s68 offen sc1
    v_exp_f32 v39, v39
    v_exp_f32 v40, v40
    v_exp_f32 v41, v41
    v_pk_mul_f32 v[56:57], v[56:57], v[48:49]
    v_pk_mul_f32 v[58:59], v[58:59], v[50:51]
    v_pk_mul_f32 v[60:61], v[60:61], v[52:53]
    v_pk_mul_f32 v[62:63], v[62:63], v[54:55]
    v_pk_add_f32 v[34:35], v[34:35], 1.0 op_sel_hi:[1,0]
    buffer_load_dwordx4 a[12:15], v24, s[56:59], s68 offen sc1
    v_pk_add_f32 v[36:37], v[36:37], 1.0 op_sel_hi:[1,0]
    v_pk_add_f32 v[38:39], v[38:39], 1.0 op_sel_hi:[1,0]
    v_pk_add_f32 v[40:41], v[40:41], 1.0 op_sel_hi:[1,0]
    v_rcp_f32 v34, v34
    v_rcp_f32 v35, v35
    v_rcp_f32 v36, v36
    v_rcp_f32 v37, v37
    v_rcp_f32 v38, v38
    s_add_u32 s68, s68, 16384
    v_rcp_f32 v39, v39
    v_rcp_f32 v40, v40
    v_rcp_f32 v41, v41
    v_pk_mul_f32 v[56:57], v[56:57], v[34:35]
    v_pk_mul_f32 v[58:59], v[58:59], v[36:37]
    v_pk_mul_f32 v[60:61], v[60:61], v[38:39]
    v_pk_mul_f32 v[62:63], v[62:63], v[40:41]
    v_cvt_pk_bf16_f32 v48, v56, v57
    v_cvt_pk_bf16_f32 v49, v58, v59
    v_cvt_pk_bf16_f32 v50, v60, v61
    v_cvt_pk_bf16_f32 v51, v62, v63
    s_nop 0
    v_permlane16_swap_b32 v48, v50
    v_permlane16_swap_b32 v49, v51
    buffer_store_dwordx4 v[48:51], v28, s[56:59], s90 offen offset:0 sc1
    v_pk_mul_f32 v[34:35], v[64:65], v[64:65]
    buffer_load_dwordx4 a[16:19], v21, s[56:59], s68 offen sc1
    v_pk_mul_f32 v[36:37], v[66:67], v[66:67]
    v_pk_mul_f32 v[38:39], v[68:69], v[68:69]
    v_pk_mul_f32 v[40:41], v[70:71], v[70:71]
    v_pk_fma_f32 v[34:35], v[34:35], s[94:95], v[26:27]
    v_pk_fma_f32 v[36:37], v[36:37], s[94:95], v[26:27]
    v_pk_fma_f32 v[38:39], v[38:39], s[94:95], v[26:27]
    v_pk_fma_f32 v[40:41], v[40:41], s[94:95], v[26:27]
    v_pk_mul_f32 v[34:35], v[34:35], v[64:65]
    buffer_load_dwordx4 a[20:23], v22, s[56:59], s68 offen sc1
    v_pk_mul_f32 v[36:37], v[36:37], v[66:67]
    v_pk_mul_f32 v[38:39], v[38:39], v[68:69]
    v_pk_mul_f32 v[40:41], v[40:41], v[70:71]
    v_exp_f32 v34, v34
    v_exp_f32 v35, v35
    v_exp_f32 v36, v36
    v_exp_f32 v37, v37
    v_exp_f32 v38, v38
    buffer_load_dwordx4 a[24:27], v23, s[56:59], s68 offen sc1
    v_exp_f32 v39, v39
    v_exp_f32 v40, v40
    v_exp_f32 v41, v41
    v_pk_mul_f32 v[72:73], v[72:73], v[64:65]
    v_pk_mul_f32 v[74:75], v[74:75], v[66:67]
    v_pk_mul_f32 v[76:77], v[76:77], v[68:69]
    v_pk_mul_f32 v[78:79], v[78:79], v[70:71]
    v_pk_add_f32 v[34:35], v[34:35], 1.0 op_sel_hi:[1,0]
    buffer_load_dwordx4 a[28:31], v24, s[56:59], s68 offen sc1
    v_pk_add_f32 v[36:37], v[36:37], 1.0 op_sel_hi:[1,0]
    v_pk_add_f32 v[38:39], v[38:39], 1.0 op_sel_hi:[1,0]
    v_pk_add_f32 v[40:41], v[40:41], 1.0 op_sel_hi:[1,0]
    v_rcp_f32 v34, v34
    v_rcp_f32 v35, v35
    v_rcp_f32 v36, v36
    v_rcp_f32 v37, v37
    v_rcp_f32 v38, v38
    s_add_u32 s68, s68, 16384
    v_rcp_f32 v39, v39
    v_rcp_f32 v40, v40
    v_rcp_f32 v41, v41
    v_pk_mul_f32 v[72:73], v[72:73], v[34:35]
    v_pk_mul_f32 v[74:75], v[74:75], v[36:37]
    v_pk_mul_f32 v[76:77], v[76:77], v[38:39]
    v_pk_mul_f32 v[78:79], v[78:79], v[40:41]
    v_cvt_pk_bf16_f32 v64, v72, v73
    v_cvt_pk_bf16_f32 v65, v74, v75
    v_cvt_pk_bf16_f32 v66, v76, v77
    v_cvt_pk_bf16_f32 v67, v78, v79
    s_nop 0
    v_permlane16_swap_b32 v64, v66
    v_permlane16_swap_b32 v65, v67
    buffer_store_dwordx4 v[64:67], v28, s[56:59], s90 offen offset:2048 sc1
    s_waitcnt vmcnt(10)
    s_mov_b64 exec, 1
    buffer_atomic_add v29, off, s[56:59], s92 sc1
    s_mov_b64 exec, -1
    v_pk_mul_f32 v[34:35], v[80:81], v[80:81]
    buffer_load_dwordx4 a[32:35], v21, s[56:59], s68 offen sc1
    v_pk_mul_f32 v[36:37], v[82:83], v[82:83]
    v_pk_mul_f32 v[38:39], v[84:85], v[84:85]
    v_pk_mul_f32 v[40:41], v[86:87], v[86:87]
    v_pk_fma_f32 v[34:35], v[34:35], s[94:95], v[26:27]
    v_pk_fma_f32 v[36:37], v[36:37], s[94:95], v[26:27]
    v_pk_fma_f32 v[38:39], v[38:39], s[94:95], v[26:27]
    v_pk_fma_f32 v[40:41], v[40:41], s[94:95], v[26:27]
    v_pk_mul_f32 v[34:35], v[34:35], v[80:81]
    buffer_load_dwordx4 a[36:39], v22, s[56:59], s68 offen sc1
    v_pk_mul_f32 v[36:37], v[36:37], v[82:83]
    v_pk_mul_f32 v[38:39], v[38:39], v[84:85]
    v_pk_mul_f32 v[40:41], v[40:41], v[86:87]
    v_exp_f32 v34, v34
    v_exp_f32 v35, v35
    v_exp_f32 v36, v36
    v_exp_f32 v37, v37
    v_exp_f32 v38, v38
    buffer_load_dwordx4 a[40:43], v23, s[56:59], s68 offen sc1
    v_exp_f32 v39, v39
    v_exp_f32 v40, v40
    v_exp_f32 v41, v41
    v_pk_mul_f32 v[88:89], v[88:89], v[80:81]
    v_pk_mul_f32 v[90:91], v[90:91], v[82:83]
    v_pk_mul_f32 v[92:93], v[92:93], v[84:85]
    v_pk_mul_f32 v[94:95], v[94:95], v[86:87]
    v_pk_add_f32 v[34:35], v[34:35], 1.0 op_sel_hi:[1,0]
    buffer_load_dwordx4 a[44:47], v24, s[56:59], s68 offen sc1
    v_pk_add_f32 v[36:37], v[36:37], 1.0 op_sel_hi:[1,0]
    v_pk_add_f32 v[38:39], v[38:39], 1.0 op_sel_hi:[1,0]
    v_pk_add_f32 v[40:41], v[40:41], 1.0 op_sel_hi:[1,0]
    v_rcp_f32 v34, v34
    v_rcp_f32 v35, v35
    v_rcp_f32 v36, v36
    v_rcp_f32 v37, v37
    v_rcp_f32 v38, v38
    s_add_u32 s68, s68, 16384
    v_rcp_f32 v39, v39
    v_rcp_f32 v40, v40
    v_rcp_f32 v41, v41
    v_pk_mul_f32 v[88:89], v[88:89], v[34:35]
    v_pk_mul_f32 v[90:91], v[90:91], v[36:37]
    v_pk_mul_f32 v[92:93], v[92:93], v[38:39]
    v_pk_mul_f32 v[94:95], v[94:95], v[40:41]
    v_cvt_pk_bf16_f32 v80, v88, v89
    v_cvt_pk_bf16_f32 v81, v90, v91
    v_cvt_pk_bf16_f32 v82, v92, v93
    v_cvt_pk_bf16_f32 v83, v94, v95
    s_nop 0
    v_permlane16_swap_b32 v80, v82
    v_permlane16_swap_b32 v81, v83
    s_add_u32 s90, s90, 4096
    buffer_store_dwordx4 v[80:83], v28, s[56:59], s90 offen offset:0 sc1
    v_pk_mul_f32 v[34:35], v[96:97], v[96:97]
    buffer_load_dwordx4 a[48:51], v21, s[56:59], s68 offen sc1
    v_pk_mul_f32 v[36:37], v[98:99], v[98:99]
    v_pk_mul_f32 v[38:39], v[100:101], v[100:101]
    v_pk_mul_f32 v[40:41], v[102:103], v[102:103]
    v_pk_fma_f32 v[34:35], v[34:35], s[94:95], v[26:27]
    v_pk_fma_f32 v[36:37], v[36:37], s[94:95], v[26:27]
    v_pk_fma_f32 v[38:39], v[38:39], s[94:95], v[26:27]
    v_pk_fma_f32 v[40:41], v[40:41], s[94:95], v[26:27]
    v_pk_mul_f32 v[34:35], v[34:35], v[96:97]
    buffer_load_dwordx4 a[52:55], v22, s[56:59], s68 offen sc1
    v_pk_mul_f32 v[36:37], v[36:37], v[98:99]
    v_pk_mul_f32 v[38:39], v[38:39], v[100:101]
    v_pk_mul_f32 v[40:41], v[40:41], v[102:103]
    v_exp_f32 v34, v34
    v_exp_f32 v35, v35
    v_exp_f32 v36, v36
    v_exp_f32 v37, v37
    v_exp_f32 v38, v38
    buffer_load_dwordx4 a[56:59], v23, s[56:59], s68 offen sc1
    v_exp_f32 v39, v39
    v_exp_f32 v40, v40
    v_exp_f32 v41, v41
    v_pk_mul_f32 v[104:105], v[104:105], v[96:97]
    v_pk_mul_f32 v[106:107], v[106:107], v[98:99]
    v_pk_mul_f32 v[108:109], v[108:109], v[100:101]
    v_pk_mul_f32 v[110:111], v[110:111], v[102:103]
    v_pk_add_f32 v[34:35], v[34:35], 1.0 op_sel_hi:[1,0]
    buffer_load_dwordx4 a[60:63], v24, s[56:59], s68 offen sc1
    v_pk_add_f32 v[36:37], v[36:37], 1.0 op_sel_hi:[1,0]
    v_pk_add_f32 v[38:39], v[38:39], 1.0 op_sel_hi:[1,0]
    v_pk_add_f32 v[40:41], v[40:41], 1.0 op_sel_hi:[1,0]
    v_rcp_f32 v34, v34
    v_rcp_f32 v35, v35
    v_rcp_f32 v36, v36
    v_rcp_f32 v37, v37
    v_rcp_f32 v38, v38
    s_add_u32 s68, s68, 16384
    v_rcp_f32 v39, v39
    v_rcp_f32 v40, v40
    v_rcp_f32 v41, v41
    v_pk_mul_f32 v[104:105], v[104:105], v[34:35]
    v_pk_mul_f32 v[106:107], v[106:107], v[36:37]
    v_pk_mul_f32 v[108:109], v[108:109], v[38:39]
    v_pk_mul_f32 v[110:111], v[110:111], v[40:41]
    v_cvt_pk_bf16_f32 v96, v104, v105
    v_cvt_pk_bf16_f32 v97, v106, v107
    v_cvt_pk_bf16_f32 v98, v108, v109
    v_cvt_pk_bf16_f32 v99, v110, v111
    s_nop 0
    v_permlane16_swap_b32 v96, v98
    v_permlane16_swap_b32 v97, v99
    buffer_store_dwordx4 v[96:99], v28, s[56:59], s90 offen offset:2048 sc1
    s_barrier
L_D:
    ds_read_b64_tr_b16 a[128:129], v8 offset:0
    ds_read_b64_tr_b16 a[130:131], v8 offset:4096
    ds_read_b64_tr_b16 a[132:133], v9 offset:0
    ds_read_b64_tr_b16 a[134:135], v9 offset:4096
    ds_read_b64_tr_b16 a[136:137], v10 offset:0
    ds_read_b64_tr_b16 a[138:139], v10 offset:4096
    ds_read_b64_tr_b16 a[140:141], v11 offset:0
    ds_read_b64_tr_b16 a[142:143], v11 offset:4096
    ds_read_b64_tr_b16 a[144:145], v12 offset:0
    ds_read_b64_tr_b16 a[146:147], v12 offset:4096
    ds_read_b64_tr_b16 a[148:149], v13 offset:0
    ds_read_b64_tr_b16 a[150:151], v13 offset:4096
    ds_read_b64_tr_b16 a[152:153], v14 offset:0
    ds_read_b64_tr_b16 a[154:155], v14 offset:4096
    ds_read_b64_tr_b16 a[156:157], v15 offset:0
    ds_read_b64_tr_b16 a[158:159], v15 offset:4096
    s_waitcnt vmcnt(15) lgkmcnt(14)
    v_mfma_f32_16x16x32_bf16 v[128:131], a[128:131], a[0:3], 0
    buffer_load_dwordx4 a[64:67], v21, s[56:59], s68 offen sc1
    s_waitcnt vmcnt(15)
    v_mfma_f32_16x16x32_bf16 v[160:163], a[128:131], a[4:7], 0
    ds_read_b64_tr_b16 a[160:161], v8 offset:8192
    s_waitcnt vmcnt(14)
    v_mfma_f32_16x16x32_bf16 v[192:195], a[128:131], a[8:11], 0
    ds_read_b64_tr_b16 a[162:163], v8 offset:12288
    s_waitcnt vmcnt(13)
    v_mfma_f32_16x16x32_bf16 v[224:227], a[128:131], a[12:15], 0
    buffer_load_dwordx4 a[68:71], v22, s[56:59], s68 offen sc1
    s_waitcnt lgkmcnt(14)
    v_mfma_f32_16x16x32_bf16 v[132:135], a[132:135], a[0:3], 0
    ds_read_b64_tr_b16 a[164:165], v9 offset:8192
    v_mfma_f32_16x16x32_bf16 v[164:167], a[132:135], a[4:7], 0
    ds_read_b64_tr_b16 a[166:167], v9 offset:12288
    v_mfma_f32_16x16x32_bf16 v[196:199], a[132:135], a[8:11], 0
    buffer_load_dwordx4 a[72:75], v23, s[56:59], s68 offen sc1
    v_mfma_f32_16x16x32_bf16 v[228:231], a[132:135], a[12:15], 0
    ds_read_b64_tr_b16 a[168:169], v10 offset:8192
    s_waitcnt lgkmcnt(15)
    v_mfma_f32_16x16x32_bf16 v[136:139], a[136:139], a[0:3], 0
    ds_read_b64_tr_b16 a[170:171], v10 offset:12288
    v_mfma_f32_16x16x32_bf16 v[168:171], a[136:139], a[4:7], 0
    buffer_load_dwordx4 a[76:79], v24, s[56:59], s68 offen sc1
    v_mfma_f32_16x16x32_bf16 v[200:203], a[136:139], a[8:11], 0
    ds_read_b64_tr_b16 a[172:173], v11 offset:8192
    v_mfma_f32_16x16x32_bf16 v[232:235], a[136:139], a[12:15], 0
    ds_read_b64_tr_b16 a[174:175], v11 offset:12288
    s_waitcnt lgkmcnt(15)
    v_mfma_f32_16x16x32_bf16 v[140:143], a[140:143], a[0:3], 0
    s_add_u32 s68, s68, 16384
    v_mfma_f32_16x16x32_bf16 v[172:175], a[140:143], a[4:7], 0
    ds_read_b64_tr_b16 a[176:177], v12 offset:8192
    v_mfma_f32_16x16x32_bf16 v[204:207], a[140:143], a[8:11], 0
    ds_read_b64_tr_b16 a[178:179], v12 offset:12288
    v_mfma_f32_16x16x32_bf16 v[236:239], a[140:143], a[12:15], 0
    buffer_load_dwordx4 a[80:83], v21, s[56:59], s68 offen sc1
    s_waitcnt lgkmcnt(15)
    v_mfma_f32_16x16x32_bf16 v[144:147], a[144:147], a[0:3], 0
    ds_read_b64_tr_b16 a[180:181], v13 offset:8192
    v_mfma_f32_16x16x32_bf16 v[176:179], a[144:147], a[4:7], 0
    ds_read_b64_tr_b16 a[182:183], v13 offset:12288
    v_mfma_f32_16x16x32_bf16 v[208:211], a[144:147], a[8:11], 0
    buffer_load_dwordx4 a[84:87], v22, s[56:59], s68 offen sc1
    v_mfma_f32_16x16x32_bf16 v[240:243], a[144:147], a[12:15], 0
    ds_read_b64_tr_b16 a[184:185], v14 offset:8192
    s_waitcnt lgkmcnt(15)
    v_mfma_f32_16x16x32_bf16 v[148:151], a[148:151], a[0:3], 0
    ds_read_b64_tr_b16 a[186:187], v14 offset:12288
    s_waitcnt vmcnt(6)
    s_mov_b64 exec, 1
    buffer_atomic_add v42, off, s[56:59], s93 sc1
    s_mov_b64 exec, -1
    v_mfma_f32_16x16x32_bf16 v[180:183], a[148:151], a[4:7], 0
    buffer_load_dwordx4 a[88:91], v23, s[56:59], s68 offen sc1
    v_mfma_f32_16x16x32_bf16 v[212:215], a[148:151], a[8:11], 0
    ds_read_b64_tr_b16 a[188:189], v15 offset:8192
    v_mfma_f32_16x16x32_bf16 v[244:247], a[148:151], a[12:15], 0
    ds_read_b64_tr_b16 a[190:191], v15 offset:12288
    v_mfma_f32_16x16x32_bf16 v[152:155], a[152:155], a[0:3], 0
    v_mfma_f32_16x16x32_bf16 v[184:187], a[152:155], a[4:7], 0
    v_mfma_f32_16x16x32_bf16 v[216:219], a[152:155], a[8:11], 0
    v_mfma_f32_16x16x32_bf16 v[248:251], a[152:155], a[12:15], 0
    s_waitcnt lgkmcnt(15)
    v_mfma_f32_16x16x32_bf16 v[156:159], a[156:159], a[0:3], 0
    v_mfma_f32_16x16x32_bf16 v[188:191], a[156:159], a[4:7], 0
    v_mfma_f32_16x16x32_bf16 v[220:223], a[156:159], a[8:11], 0
    v_mfma_f32_16x16x32_bf16 v[252:255], a[156:159], a[12:15], 0
    s_waitcnt lgkmcnt(14)
    v_mfma_f32_16x16x32_bf16 v[128:131], a[160:163], a[16:19], v[128:131]
    buffer_load_dwordx4 a[92:95], v24, s[56:59], s68 offen sc1
    v_mfma_f32_16x16x32_bf16 v[160:163], a[160:163], a[20:23], v[160:163]
    ds_read_b64_tr_b16 a[128:129], v8 offset:16384
    v_mfma_f32_16x16x32_bf16 v[192:195], a[160:163], a[24:27], v[192:195]
    ds_read_b64_tr_b16 a[130:131], v8 offset:20480
    v_add_u32 v48, 0x10000, v8
    v_add_u32 v56, 0x20000, v8
    v_mfma_f32_16x16x32_bf16 v[224:227], a[160:163], a[28:31], v[224:227]
    s_add_u32 s68, s68, 16384
    v_add_u32 v49, 0x10000, v9
    s_waitcnt lgkmcnt(14)
    v_mfma_f32_16x16x32_bf16 v[132:135], a[164:167], a[16:19], v[132:135]
    ds_read_b64_tr_b16 a[132:133], v9 offset:16384
    v_add_u32 v57, 0x20000, v9
    v_mfma_f32_16x16x32_bf16 v[164:167], a[164:167], a[20:23], v[164:167]
    ds_read_b64_tr_b16 a[134:135], v9 offset:20480
    v_add_u32 v50, 0x10000, v10
    v_mfma_f32_16x16x32_bf16 v[196:199], a[164:167], a[24:27], v[196:199]
    buffer_load_dwordx4 a[96:99], v21, s[56:59], s68 offen sc1
    v_add_u32 v58, 0x20000, v10
    v_mfma_f32_16x16x32_bf16 v[228:231], a[164:167], a[28:31], v[228:231]
    ds_read_b64_tr_b16 a[136:137], v10 offset:16384
    v_add_u32 v51, 0x10000, v11
    s_waitcnt lgkmcnt(15)
    v_mfma_f32_16x16x32_bf16 v[136:139], a[168:171], a[16:19], v[136:139]
    ds_read_b64_tr_b16 a[138:139], v10 offset:20480
    v_add_u32 v59, 0x20000, v11
    v_mfma_f32_16x16x32_bf16 v[168:171], a[168:171], a[20:23], v[168:171]
    buffer_load_dwordx4 a[100:103], v22, s[56:59], s68 offen sc1
    v_add_u32 v52, 0x10000, v12
    v_mfma_f32_16x16x32_bf16 v[200:203], a[168:171], a[24:27], v[200:203]
    ds_read_b64_tr_b16 a[140:141], v11 offset:16384
    v_add_u32 v60, 0x20000, v12
    v_mfma_f32_16x16x32_bf16 v[232:235], a[168:171], a[28:31], v[232:235]
    ds_read_b64_tr_b16 a[142:143], v11 offset:20480
    v_add_u32 v53, 0x10000, v13
    v_add_u32 v61, 0x20000, v13
    s_waitcnt lgkmcnt(15)
    v_mfma_f32_16x16x32_bf16 v[140:143], a[172:175], a[16:19], v[140:143]
    buffer_load_dwordx4 a[104:107], v23, s[56:59], s68 offen sc1
    v_add_u32 v54, 0x10000, v14
    v_mfma_f32_16x16x32_bf16 v[172:175], a[172:175], a[20:23], v[172:175]
    ds_read_b64_tr_b16 a[144:145], v12 offset:16384
    v_add_u32 v62, 0x20000, v14
    v_mfma_f32_16x16x32_bf16 v[204:207], a[172:175], a[24:27], v[204:207]
    ds_read_b64_tr_b16 a[146:147], v12 offset:20480
    v_add_u32 v55, 0x10000, v15
    v_mfma_f32_16x16x32_bf16 v[236:239], a[172:175], a[28:31], v[236:239]
    buffer_load_dwordx4 a[108:111], v24, s[56:59], s68 offen sc1
    v_add_u32 v63, 0x20000, v15
    s_waitcnt lgkmcnt(15)
    v_mfma_f32_16x16x32_bf16 v[144:147], a[176:179], a[16:19], v[144:147]
    ds_read_b64_tr_b16 a[148:149], v13 offset:16384
    s_lshl_b32 s84, s63, 2
    v_mfma_f32_16x16x32_bf16 v[176:179], a[176:179], a[20:23], v[176:179]
    ds_read_b64_tr_b16 a[150:151], v13 offset:20480
    s_add_u32 s84, s84, s60
    v_mfma_f32_16x16x32_bf16 v[208:211], a[176:179], a[24:27], v[208:211]
    s_add_u32 s68, s68, 16384
    s_lshl_b32 s84, s84, 2
    v_mfma_f32_16x16x32_bf16 v[240:243], a[176:179], a[28:31], v[240:243]
    ds_read_b64_tr_b16 a[152:153], v14 offset:16384
    s_add_u32 s84, s84, s65
    s_waitcnt lgkmcnt(15)
    v_mfma_f32_16x16x32_bf16 v[148:151], a[180:183], a[16:19], v[148:151]
    ds_read_b64_tr_b16 a[154:155], v14 offset:20480
    s_lshl_b32 s84, s84, 15
    s_lshl_b32 s85, s66, 8
    v_mfma_f32_16x16x32_bf16 v[180:183], a[180:183], a[20:23], v[180:183]
    buffer_load_dwordx4 a[112:115], v21, s[56:59], s68 offen sc1
    s_add_u32 s84, s84, s85
    v_mfma_f32_16x16x32_bf16 v[212:215], a[180:183], a[24:27], v[212:215]
    ds_read_b64_tr_b16 a[156:157], v15 offset:16384
    v_and_b32 v34, 15, v0
    v_mfma_f32_16x16x32_bf16 v[244:247], a[180:183], a[28:31], v[244:247]
    ds_read_b64_tr_b16 a[158:159], v15 offset:20480
    v_lshrrev_b32 v35, 4, v0
    v_mfma_f32_16x16x32_bf16 v[152:155], a[184:187], a[16:19], v[152:155]
    buffer_load_dwordx4 a[116:119], v22, s[56:59], s68 offen sc1
    v_lshlrev_b32 v36, 11, v34
    v_mfma_f32_16x16x32_bf16 v[184:187], a[184:187], a[20:23], v[184:187]
    v_add_u32 v36, s84, v36
    v_mfma_f32_16x16x32_bf16 v[216:219], a[184:187], a[24:27], v[216:219]
    v_lshl_add_u32 v1, v35, 3, v36
    v_mfma_f32_16x16x32_bf16 v[248:251], a[184:187], a[28:31], v[248:251]
    v_and_b32 v2, 1, v35
    s_waitcnt lgkmcnt(15)
    v_mfma_f32_16x16x32_bf16 v[156:159], a[188:191], a[16:19], v[156:159]
    v_lshl_add_u32 v36, v2, 5, v36
    v_mfma_f32_16x16x32_bf16 v[188:191], a[188:191], a[20:23], v[188:191]
    v_lshrrev_b32 v2, 1, v35
    v_mfma_f32_16x16x32_bf16 v[220:223], a[188:191], a[24:27], v[220:223]
    v_mfma_f32_16x16x32_bf16 v[252:255], a[188:191], a[28:31], v[252:255]
    s_waitcnt lgkmcnt(14)
    v_mfma_f32_16x16x32_bf16 v[128:131], a[128:131], a[32:35], v[128:131]
    buffer_load_dwordx4 a[120:123], v23, s[56:59], s68 offen sc1
    v_mfma_f32_16x16x32_bf16 v[160:163], a[128:131], a[36:39], v[160:163]
    ds_read_b64_tr_b16 a[160:161], v8 offset:24576
    v_mfma_f32_16x16x32_bf16 v[192:195], a[128:131], a[40:43], v[192:195]
    ds_read_b64_tr_b16 a[162:163], v8 offset:28672
    v_lshl_add_u32 v2, v2, 4, v36
    v_lshrrev_b32 v36, 3, v34
    v_mfma_f32_16x16x32_bf16 v[224:227], a[128:131], a[44:47], v[224:227]
    buffer_load_dwordx4 a[124:127], v24, s[56:59], s68 offen sc1
    v_mul_u32_u24 v36, 16320, v36
    s_waitcnt lgkmcnt(14)
    v_mfma_f32_16x16x32_bf16 v[132:135], a[132:135], a[32:35], v[132:135]
    ds_read_b64_tr_b16 a[164:165], v9 offset:24576
    v_sub_u32 v1, v2, v36
    v_mfma_f32_16x16x32_bf16 v[164:167], a[132:135], a[36:39], v[164:167]
    ds_read_b64_tr_b16 a[166:167], v9 offset:28672
    v_xor_b32 v5, 64, v1
    v_mfma_f32_16x16x32_bf16 v[196:199], a[132:135], a[40:43], v[196:199]
    s_add_u32 s68, s68, 16384
    v_add_u32 v5, 16384, v5
    v_mfma_f32_16x16x32_bf16 v[228:231], a[132:135], a[44:47], v[228:231]
    ds_read_b64_tr_b16 a[168:169], v10 offset:24576
    v_cmp_gt_u32 s[4:5], 8, v34
    s_waitcnt lgkmcnt(15)
    v_mfma_f32_16x16x32_bf16 v[136:139], a[136:139], a[32:35], v[136:139]
    ds_read_b64_tr_b16 a[170:171], v10 offset:28672
    s_mul_i32 s84, s62, 132096
    v_mfma_f32_16x16x32_bf16 v[168:171], a[136:139], a[36:39], v[168:171]
    buffer_load_dwordx4 a[0:3], v21, s[56:59], s68 offen sc1
    v_add_u32 v3, s84, v16
    v_mfma_f32_16x16x32_bf16 v[200:203], a[136:139], a[40:43], v[200:203]
    ds_read_b64_tr_b16 a[172:173], v11 offset:24576
    s_mul_i32 s84, s62, 130048
    v_mfma_f32_16x16x32_bf16 v[232:235], a[136:139], a[44:47], v[232:235]
    ds_read_b64_tr_b16 a[174:175], v11 offset:28672
    s_sub_u32 s84, 131072, s84
    v_add_u32 v4, s84, v16
    s_waitcnt lgkmcnt(15)
    v_mfma_f32_16x16x32_bf16 v[140:143], a[140:143], a[32:35], v[140:143]
    buffer_load_dwordx4 a[4:7], v22, s[56:59], s68 offen sc1
    v_lshlrev_b32 v35, 2, v35
    v_mfma_f32_16x16x32_bf16 v[172:175], a[140:143], a[36:39], v[172:175]
    ds_read_b64_tr_b16 a[176:177], v12 offset:24576
    v_sub_u32 v34, v34, v35
    v_mfma_f32_16x16x32_bf16 v[204:207], a[140:143], a[40:43], v[204:207]
    ds_read_b64_tr_b16 a[178:179], v12 offset:28672
    v_mov_b32 v26, 0
    v_mfma_f32_16x16x32_bf16 v[236:239], a[140:143], a[44:47], v[236:239]
    buffer_load_dwordx4 a[8:11], v23, s[56:59], s68 offen sc1
    v_mov_b32 v27, 0
    s_waitcnt lgkmcnt(15)
    v_mfma_f32_16x16x32_bf16 v[144:147], a[144:147], a[32:35], v[144:147]
    ds_read_b64_tr_b16 a[180:181], v13 offset:24576
    v_mov_b32 v30, 0
    v_mfma_f32_16x16x32_bf16 v[176:179], a[144:147], a[36:39], v[176:179]
    ds_read_b64_tr_b16 a[182:183], v13 offset:28672
    v_mov_b32 v31, 0
    v_mfma_f32_16x16x32_bf16 v[208:211], a[144:147], a[40:43], v[208:211]
    buffer_load_dwordx4 a[12:15], v24, s[56:59], s68 offen sc1
    v_mov_b32 v35, 0x3f80
    v_mfma_f32_16x16x32_bf16 v[240:243], a[144:147], a[44:47], v[240:243]
    ds_read_b64_tr_b16 a[184:185], v14 offset:24576
    v_mov_b32 v36, 0x3f800000
    s_waitcnt lgkmcnt(15)
    v_mfma_f32_16x16x32_bf16 v[148:151], a[148:151], a[32:35], v[148:151]
    ds_read_b64_tr_b16 a[186:187], v14 offset:28672
    v_cmp_eq_u32 vcc, 0, v34
    s_nop 1
    v_cndmask_b32 v28, v26, v35, vcc
    v_mfma_f32_16x16x32_bf16 v[180:183], a[148:151], a[36:39], v[180:183]
    s_add_u32 s68, s68, 16384
    v_cmp_eq_u32 vcc, 1, v34
    v_mfma_f32_16x16x32_bf16 v[212:215], a[148:151], a[40:43], v[212:215]
    ds_read_b64_tr_b16 a[188:189], v15 offset:24576
    v_cndmask_b32 v28, v28, v36, vcc
    v_mfma_f32_16x16x32_bf16 v[244:247], a[148:151], a[44:47], v[244:247]
    ds_read_b64_tr_b16 a[190:191], v15 offset:28672
    v_cmp_eq_u32 vcc, 2, v34
    v_mfma_f32_16x16x32_bf16 v[152:155], a[152:155], a[32:35], v[152:155]
    buffer_load_dwordx4 a[16:19], v21, s[56:59], s68 offen sc1
    v_cndmask_b32 v29, v26, v35, vcc
    v_mfma_f32_16x16x32_bf16 v[184:187], a[152:155], a[36:39], v[184:187]
    v_cmp_eq_u32 vcc, 3, v34
    v_mfma_f32_16x16x32_bf16 v[216:219], a[152:155], a[40:43], v[216:219]
    s_nop 0
    v_cndmask_b32 v29, v29, v36, vcc
    v_mfma_f32_16x16x32_bf16 v[248:251], a[152:155], a[44:47], v[248:251]
    s_mov_b32 s14, 0xbfb8aa3b
    s_waitcnt lgkmcnt(15)
    v_mfma_f32_16x16x32_bf16 v[156:159], a[156:159], a[32:35], v[156:159]
    s_mov_b32 s15, 0xbfb8aa3b
    v_mfma_f32_16x16x32_bf16 v[188:191], a[156:159], a[36:39], v[188:191]
    v_mfma_f32_16x16x32_bf16 v[220:223], a[156:159], a[40:43], v[220:223]
    v_mfma_f32_16x16x32_bf16 v[252:255], a[156:159], a[44:47], v[252:255]
    s_waitcnt lgkmcnt(14)
    v_mfma_f32_16x16x32_bf16 v[128:131], a[160:163], a[48:51], v[128:131]
    buffer_load_dwordx4 a[20:23], v22, s[56:59], s68 offen sc1
    v_mfma_f32_16x16x32_bf16 v[160:163], a[160:163], a[52:55], v[160:163]
    ds_read_b64_tr_b16 a[128:129], v8 offset:32768
    v_mfma_f32_16x16x32_bf16 v[192:195], a[160:163], a[56:59], v[192:195]
    s_branch L_over8
L_stub8:
    s_branch L_stub12
L_over8:
    ds_read_b64_tr_b16 a[130:131], v8 offset:36864
    v_mfma_f32_16x16x32_bf16 v[224:227], a[160:163], a[60:63], v[224:227]
    buffer_load_dwordx4 a[24:27], v23, s[56:59], s68 offen sc1
    s_waitcnt lgkmcnt(14)
    v_mfma_f32_16x16x32_bf16 v[132:135], a[164:167], a[48:51], v[132:135]
    ds_read_b64_tr_b16 a[132:133], v9 offset:32768
    v_mfma_f32_16x16x32_bf16 v[164:167], a[164:167], a[52:55], v[164:167]
    ds_read_b64_tr_b16 a[134:135], v9 offset:36864
    v_mfma_f32_16x16x32_bf16 v[196:199], a[164:167], a[56:59], v[196:199]
    buffer_load_dwordx4 a[28:31], v24, s[56:59], s68 offen sc1
    v_mfma_f32_16x16x32_bf16 v[228:231], a[164:167], a[60:63], v[228:231]
    ds_read_b64_tr_b16 a[136:137], v10 offset:32768
    s_waitcnt lgkmcnt(15)
    v_mfma_f32_16x16x32_bf16 v[136:139], a[168:171], a[48:51], v[136:139]
    ds_read_b64_tr_b16 a[138:139], v10 offset:36864
    v_mfma_f32_16x16x32_bf16 v[168:171], a[168:171], a[52:55], v[168:171]
    s_add_u32 s68, s68, 16384
    v_mfma_f32_16x16x32_bf16 v[200:203], a[168:171], a[56:59], v[200:203]
    ds_read_b64_tr_b16 a[140:141], v11 offset:32768
    global_load_dwordx4 v[64:67], v1, s[8:9] offset:0
    v_mfma_f32_16x16x32_bf16 v[232:235], a[168:171], a[60:63], v[232:235]
    ds_read_b64_tr_b16 a[142:143], v11 offset:36864
    s_waitcnt lgkmcnt(15)
    v_mfma_f32_16x16x32_bf16 v[140:143], a[172:175], a[48:51], v[140:143]
    buffer_load_dwordx4 a[32:35], v21, s[56:59], s68 offen sc1
    v_mfma_f32_16x16x32_bf16 v[172:175], a[172:175], a[52:55], v[172:175]
    ds_read_b64_tr_b16 a[144:145], v12 offset:32768
    v_mfma_f32_16x16x32_bf16 v[204:207], a[172:175], a[56:59], v[204:207]
    ds_read_b64_tr_b16 a[146:147], v12 offset:36864
    global_load_dwordx4 v[68:71], v5, s[8:9] offset:0
    v_mfma_f32_16x16x32_bf16 v[236:239], a[172:175], a[60:63], v[236:239]
    buffer_load_dwordx4 a[36:39], v22, s[56:59], s68 offen sc1
    s_waitcnt lgkmcnt(15)
    v_mfma_f32_16x16x32_bf16 v[144:147], a[176:179], a[48:51], v[144:147]
    ds_read_b64_tr_b16 a[148:149], v13 offset:32768
    v_mfma_f32_16x16x32_bf16 v[176:179], a[176:179], a[52:55], v[176:179]
    ds_read_b64_tr_b16 a[150:151], v13 offset:36864
    v_mfma_f32_16x16x32_bf16 v[208:211], a[176:179], a[56:59], v[208:211]
    buffer_load_dwordx4 a[40:43], v23, s[56:59], s68 offen sc1
    global_load_dwordx4 v[80:83], v1, s[8:9] offset:128
    v_mfma_f32_16x16x32_bf16 v[240:243], a[176:179], a[60:63], v[240:243]
    ds_read_b64_tr_b16 a[152:153], v14 offset:32768
    s_waitcnt lgkmcnt(15)
    v_mfma_f32_16x16x32_bf16 v[148:151], a[180:183], a[48:51], v[148:151]
    ds_read_b64_tr_b16 a[154:155], v14 offset:36864
    v_mfma_f32_16x16x32_bf16 v[180:183], a[180:183], a[52:55], v[180:183]
    buffer_load_dwordx4 a[44:47], v24, s[56:59], s68 offen sc1
    v_mfma_f32_16x16x32_bf16 v[212:215], a[180:183], a[56:59], v[212:215]
    ds_read_b64_tr_b16 a[156:157], v15 offset:32768
    global_load_dwordx4 v[84:87], v5, s[8:9] offset:128
    v_mfma_f32_16x16x32_bf16 v[244:247], a[180:183], a[60:63], v[244:247]
    ds_read_b64_tr_b16 a[158:159], v15 offset:36864
    v_mfma_f32_16x16x32_bf16 v[152:155], a[184:187], a[48:51], v[152:155]
    s_add_u32 s68, s68, 16384
    v_mfma_f32_16x16x32_bf16 v[184:187], a[184:187], a[52:55], v[184:187]
    v_mfma_f32_16x16x32_bf16 v[216:219], a[184:187], a[56:59], v[216:219]
    v_mfma_f32_16x16x32_bf16 v[248:251], a[184:187], a[60:63], v[248:251]
    s_waitcnt lgkmcnt(15)
    v_mfma_f32_16x16x32_bf16 v[156:159], a[188:191], a[48:51], v[156:159]
    buffer_load_dword v43, off, s[56:59], s92 sc1
    v_mfma_f32_16x16x32_bf16 v[188:191], a[188:191], a[52:55], v[188:191]
    v_mfma_f32_16x16x32_bf16 v[220:223], a[188:191], a[56:59], v[220:223]
    v_mfma_f32_16x16x32_bf16 v[252:255], a[188:191], a[60:63], v[252:255]
    s_barrier
    s_waitcnt vmcnt(33) lgkmcnt(14)
    v_mfma_f32_16x16x32_bf16 v[128:131], a[128:131], a[64:67], v[128:131]
    buffer_load_dwordx4 a[48:51], v21, s[56:59], s68 offen sc1
    s_waitcnt vmcnt(33)
    v_mfma_f32_16x16x32_bf16 v[160:163], a[128:131], a[68:71], v[160:163]
    ds_read_b64_tr_b16 a[160:161], v8 offset:40960
    s_waitcnt vmcnt(32)
    v_mfma_f32_16x16x32_bf16 v[192:195], a[128:131], a[72:75], v[192:195]
    ds_read_b64_tr_b16 a[162:163], v8 offset:45056
    buffer_load_dwordx4 a[52:55], v22, s[56:59], s68 offen sc1
    s_waitcnt vmcnt(32)
    v_mfma_f32_16x16x32_bf16 v[224:227], a[128:131], a[76:79], v[224:227]
    s_waitcnt lgkmcnt(14)
    v_mfma_f32_16x16x32_bf16 v[132:135], a[132:135], a[64:67], v[132:135]
    ds_read_b64_tr_b16 a[164:165], v9 offset:40960
    buffer_load_dwordx4 a[56:59], v23, s[56:59], s68 offen sc1
    v_mfma_f32_16x16x32_bf16 v[164:167], a[132:135], a[68:71], v[164:167]
    ds_read_b64_tr_b16 a[166:167], v9 offset:45056
    v_mfma_f32_16x16x32_bf16 v[196:199], a[132:135], a[72:75], v[196:199]
    buffer_load_dwordx4 a[60:63], v24, s[56:59], s68 offen sc1
    v_mfma_f32_16x16x32_bf16 v[228:231], a[132:135], a[76:79], v[228:231]
    ds_read_b64_tr_b16 a[168:169], v10 offset:40960
    s_waitcnt lgkmcnt(15)
    v_mfma_f32_16x16x32_bf16 v[136:139], a[136:139], a[64:67], v[136:139]
    ds_read_b64_tr_b16 a[170:171], v10 offset:45056
    s_add_u32 s68, s68, 16384
    v_mfma_f32_16x16x32_bf16 v[168:171], a[136:139], a[68:71], v[168:171]
    v_mfma_f32_16x16x32_bf16 v[200:203], a[136:139], a[72:75], v[200:203]
    ds_read_b64_tr_b16 a[172:173], v11 offset:40960
    v_mfma_f32_16x16x32_bf16 v[232:235], a[136:139], a[76:79], v[232:235]
    ds_read_b64_tr_b16 a[174:175], v11 offset:45056
    s_mov_b32 s82, 1048576
    s_add_u32 m0, s3, 0
    s_waitcnt lgkmcnt(15)
    v_mfma_f32_16x16x32_bf16 v[140:143], a[140:143], a[64:67], v[140:143]
    buffer_load_dwordx4 v17, s[48:51], s82 offen lds
    v_mfma_f32_16x16x32_bf16 v[172:175], a[140:143], a[68:71], v[172:175]
    ds_read_b64_tr_b16 a[176:177], v12 offset:40960
    v_mfma_f32_16x16x32_bf16 v[204:207], a[140:143], a[72:75], v[204:207]
    ds_read_b64_tr_b16 a[178:179], v12 offset:45056
    v_mfma_f32_16x16x32_bf16 v[236:239], a[140:143], a[76:79], v[236:239]
    s_waitcnt lgkmcnt(15)
    v_mfma_f32_16x16x32_bf16 v[144:147], a[144:147], a[64:67], v[144:147]
    ds_read_b64_tr_b16 a[180:181], v13 offset:40960
    buffer_load_dwordx4 v18, s[48:51], s82 offen offset:1024 lds
    v_mfma_f32_16x16x32_bf16 v[176:179], a[144:147], a[68:71], v[176:179]
    ds_read_b64_tr_b16 a[182:183], v13 offset:45056
    v_mfma_f32_16x16x32_bf16 v[208:211], a[144:147], a[72:75], v[208:211]
    v_mfma_f32_16x16x32_bf16 v[240:243], a[144:147], a[76:79], v[240:243]
    ds_read_b64_tr_b16 a[184:185], v14 offset:40960
    s_waitcnt lgkmcnt(15)
    v_mfma_f32_16x16x32_bf16 v[148:151], a[148:151], a[64:67], v[148:151]
    ds_read_b64_tr_b16 a[186:187], v14 offset:45056
    v_mfma_f32_16x16x32_bf16 v[180:183], a[148:151], a[68:71], v[180:183]
    v_mfma_f32_16x16x32_bf16 v[212:215], a[148:151], a[72:75], v[212:215]
    ds_read_b64_tr_b16 a[188:189], v15 offset:40960
    v_mfma_f32_16x16x32_bf16 v[244:247], a[148:151], a[76:79], v[244:247]
    ds_read_b64_tr_b16 a[190:191], v15 offset:45056
    v_mfma_f32_16x16x32_bf16 v[152:155], a[152:155], a[64:67], v[152:155]
    v_mfma_f32_16x16x32_bf16 v[184:187], a[152:155], a[68:71], v[184:187]
    v_mfma_f32_16x16x32_bf16 v[216:219], a[152:155], a[72:75], v[216:219]
    v_mfma_f32_16x16x32_bf16 v[248:251], a[152:155], a[76:79], v[248:251]
    s_waitcnt lgkmcnt(15)
    v_mfma_f32_16x16x32_bf16 v[156:159], a[156:159], a[64:67], v[156:159]
    v_mfma_f32_16x16x32_bf16 v[188:191], a[156:159], a[68:71], v[188:191]
    v_mfma_f32_16x16x32_bf16 v[220:223], a[156:159], a[72:75], v[220:223]
    v_mfma_f32_16x16x32_bf16 v[252:255], a[156:159], a[76:79], v[252:255]
    s_waitcnt vmcnt(35) lgkmcnt(14)
    v_mfma_f32_16x16x32_bf16 v[128:131], a[160:163], a[80:83], v[128:131]
    buffer_load_dwordx4 a[64:67], v21, s[56:59], s68 offen sc1
    s_waitcnt vmcnt(35)
    v_mfma_f32_16x16x32_bf16 v[160:163], a[160:163], a[84:87], v[160:163]
    ds_read_b64_tr_b16 a[128:129], v8 offset:49152
    s_waitcnt vmcnt(33)
    v_mfma_f32_16x16x32_bf16 v[192:195], a[160:163], a[88:91], v[192:195]
    ds_read_b64_tr_b16 a[130:131], v8 offset:53248
    buffer_load_dwordx4 a[68:71], v22, s[56:59], s68 offen sc1
    s_waitcnt vmcnt(33)
    v_mfma_f32_16x16x32_bf16 v[224:227], a[160:163], a[92:95], v[224:227]
    s_waitcnt lgkmcnt(14)
    v_mfma_f32_16x16x32_bf16 v[132:135], a[164:167], a[80:83], v[132:135]
    ds_read_b64_tr_b16 a[132:133], v9 offset:49152
    buffer_load_dwordx4 a[72:75], v23, s[56:59], s68 offen sc1
    v_mfma_f32_16x16x32_bf16 v[164:167], a[164:167], a[84:87], v[164:167]
    ds_read_b64_tr_b16 a[134:135], v9 offset:53248
    v_mfma_f32_16x16x32_bf16 v[196:199], a[164:167], a[88:91], v[196:199]
    buffer_load_dwordx4 a[76:79], v24, s[56:59], s68 offen sc1
    v_mfma_f32_16x16x32_bf16 v[228:231], a[164:167], a[92:95], v[228:231]
    ds_read_b64_tr_b16 a[136:137], v10 offset:49152
    s_waitcnt lgkmcnt(15)
    v_mfma_f32_16x16x32_bf16 v[136:139], a[168:171], a[80:83], v[136:139]
    ds_read_b64_tr_b16 a[138:139], v10 offset:53248
    s_add_u32 s68, s68, 16384
    v_mfma_f32_16x16x32_bf16 v[168:171], a[168:171], a[84:87], v[168:171]
    v_mfma_f32_16x16x32_bf16 v[200:203], a[168:171], a[88:91], v[200:203]
    ds_read_b64_tr_b16 a[140:141], v11 offset:49152
    v_mfma_f32_16x16x32_bf16 v[232:235], a[168:171], a[92:95], v[232:235]
    ds_read_b64_tr_b16 a[142:143], v11 offset:53248
    s_mov_b32 s83, 1277952
    s_add_u32 m0, s3, 8192
    s_waitcnt lgkmcnt(15)
    v_mfma_f32_16x16x32_bf16 v[140:143], a[172:175], a[80:83], v[140:143]
    buffer_load_dwordx4 v17, s[48:51], s83 offen lds
    v_mfma_f32_16x16x32_bf16 v[172:175], a[172:175], a[84:87], v[172:175]
    ds_read_b64_tr_b16 a[144:145], v12 offset:49152
    v_mfma_f32_16x16x32_bf16 v[204:207], a[172:175], a[88:91], v[204:207]
    ds_read_b64_tr_b16 a[146:147], v12 offset:53248
    v_mfma_f32_16x16x32_bf16 v[236:239], a[172:175], a[92:95], v[236:239]
    s_waitcnt lgkmcnt(15)
    v_mfma_f32_16x16x32_bf16 v[144:147], a[176:179], a[80:83], v[144:147]
    ds_read_b64_tr_b16 a[148:149], v13 offset:49152
    buffer_load_dwordx4 v18, s[48:51], s83 offen offset:1024 lds
    v_mfma_f32_16x16x32_bf16 v[176:179], a[176:179], a[84:87], v[176:179]
    ds_read_b64_tr_b16 a[150:151], v13 offset:53248
    v_mfma_f32_16x16x32_bf16 v[208:211], a[176:179], a[88:91], v[208:211]
    v_mfma_f32_16x16x32_bf16 v[240:243], a[176:179], a[92:95], v[240:243]
    ds_read_b64_tr_b16 a[152:153], v14 offset:49152
    s_waitcnt lgkmcnt(15)
    v_mfma_f32_16x16x32_bf16 v[148:151], a[180:183], a[80:83], v[148:151]
    ds_read_b64_tr_b16 a[154:155], v14 offset:53248
    v_mfma_f32_16x16x32_bf16 v[180:183], a[180:183], a[84:87], v[180:183]
    v_mfma_f32_16x16x32_bf16 v[212:215], a[180:183], a[88:91], v[212:215]
    ds_read_b64_tr_b16 a[156:157], v15 offset:49152
    v_mfma_f32_16x16x32_bf16 v[244:247], a[180:183], a[92:95], v[244:247]
    ds_read_b64_tr_b16 a[158:159], v15 offset:53248
    v_mfma_f32_16x16x32_bf16 v[152:155], a[184:187], a[80:83], v[152:155]
    v_mfma_f32_16x16x32_bf16 v[184:187], a[184:187], a[84:87], v[184:187]
    v_mfma_f32_16x16x32_bf16 v[216:219], a[184:187], a[88:91], v[216:219]
    v_mfma_f32_16x16x32_bf16 v[248:251], a[184:187], a[92:95], v[248:251]
    s_waitcnt lgkmcnt(15)
    v_mfma_f32_16x16x32_bf16 v[156:159], a[188:191], a[80:83], v[156:159]
    v_mfma_f32_16x16x32_bf16 v[188:191], a[188:191], a[84:87], v[188:191]
    v_mfma_f32_16x16x32_bf16 v[220:223], a[188:191], a[88:91], v[220:223]
    v_mfma_f32_16x16x32_bf16 v[252:255], a[188:191], a[92:95], v[252:255]
    s_waitcnt vmcnt(36) lgkmcnt(14)
    v_mfma_f32_16x16x32_bf16 v[128:131], a[128:131], a[96:99], v[128:131]
    buffer_load_dwordx4 a[80:83], v21, s[56:59], s68 offen sc1
    s_waitcnt vmcnt(36)
    v_mfma_f32_16x16x32_bf16 v[160:163], a[128:131], a[100:103], v[160:163]
    ds_read_b64_tr_b16 a[160:161], v8 offset:57344
    s_waitcnt vmcnt(35)
    v_mfma_f32_16x16x32_bf16 v[192:195], a[128:131], a[104:107], v[192:195]
    ds_read_b64_tr_b16 a[162:163], v8 offset:61440
    buffer_load_dwordx4 a[84:87], v22, s[56:59], s68 offen sc1
    s_waitcnt vmcnt(35)
    v_mfma_f32_16x16x32_bf16 v[224:227], a[128:131], a[108:111], v[224:227]
    s_waitcnt lgkmcnt(14)
    v_mfma_f32_16x16x32_bf16 v[132:135], a[132:135], a[96:99], v[132:135]
    ds_read_b64_tr_b16 a[164:165], v9 offset:57344
    buffer_load_dwordx4 a[88:91], v23, s[56:59], s68 offen sc1
    v_mfma_f32_16x16x32_bf16 v[164:167], a[132:135], a[100:103], v[164:167]
    ds_read_b64_tr_b16 a[166:167], v9 offset:61440
    v_mfma_f32_16x16x32_bf16 v[196:199], a[132:135], a[104:107], v[196:199]
    buffer_load_dwordx4 a[92:95], v24, s[56:59], s68 offen sc1
    v_mfma_f32_16x16x32_bf16 v[228:231], a[132:135], a[108:111], v[228:231]
    ds_read_b64_tr_b16 a[168:169], v10 offset:57344
    s_waitcnt lgkmcnt(15)
    v_mfma_f32_16x16x32_bf16 v[136:139], a[136:139], a[96:99], v[136:139]
    ds_read_b64_tr_b16 a[170:171], v10 offset:61440
    s_add_u32 s68, s68, 16384
    v_mfma_f32_16x16x32_bf16 v[168:171], a[136:139], a[100:103], v[168:171]
    v_mfma_f32_16x16x32_bf16 v[200:203], a[136:139], a[104:107], v[200:203]
    ds_read_b64_tr_b16 a[172:173], v11 offset:57344
    v_mfma_f32_16x16x32_bf16 v[232:235], a[136:139], a[108:111], v[232:235]
    ds_read_b64_tr_b16 a[174:175], v11 offset:61440
    s_mov_b32 s82, 1507328
    s_add_u32 m0, s3, 16384
    s_waitcnt lgkmcnt(15)
    v_mfma_f32_16x16x32_bf16 v[140:143], a[140:143], a[96:99], v[140:143]
    buffer_load_dwordx4 v17, s[48:51], s82 offen lds
    v_mfma_f32_16x16x32_bf16 v[172:175], a[140:143], a[100:103], v[172:175]
    ds_read_b64_tr_b16 a[176:177], v12 offset:57344
    v_mfma_f32_16x16x32_bf16 v[204:207], a[140:143], a[104:107], v[204:207]
    ds_read_b64_tr_b16 a[178:179], v12 offset:61440
    v_mfma_f32_16x16x32_bf16 v[236:239], a[140:143], a[108:111], v[236:239]
    s_waitcnt lgkmcnt(15)
    v_mfma_f32_16x16x32_bf16 v[144:147], a[144:147], a[96:99], v[144:147]
    ds_read_b64_tr_b16 a[180:181], v13 offset:57344
    buffer_load_dwordx4 v18, s[48:51], s82 offen offset:1024 lds
    v_mfma_f32_16x16x32_bf16 v[176:179], a[144:147], a[100:103], v[176:179]
    ds_read_b64_tr_b16 a[182:183], v13 offset:61440
    v_mfma_f32_16x16x32_bf16 v[208:211], a[144:147], a[104:107], v[208:211]
    v_mfma_f32_16x16x32_bf16 v[240:243], a[144:147], a[108:111], v[240:243]
    ds_read_b64_tr_b16 a[184:185], v14 offset:57344
    s_waitcnt lgkmcnt(15)
    v_mfma_f32_16x16x32_bf16 v[148:151], a[148:151], a[96:99], v[148:151]
    ds_read_b64_tr_b16 a[186:187], v14 offset:61440
    v_mfma_f32_16x16x32_bf16 v[180:183], a[148:151], a[100:103], v[180:183]
    v_mfma_f32_16x16x32_bf16 v[212:215], a[148:151], a[104:107], v[212:215]
    ds_read_b64_tr_b16 a[188:189], v15 offset:57344
    v_mfma_f32_16x16x32_bf16 v[244:247], a[148:151], a[108:111], v[244:247]
    ds_read_b64_tr_b16 a[190:191], v15 offset:61440
    v_mfma_f32_16x16x32_bf16 v[152:155], a[152:155], a[96:99], v[152:155]
    v_mfma_f32_16x16x32_bf16 v[184:187], a[152:155], a[100:103], v[184:187]
    v_mfma_f32_16x16x32_bf16 v[216:219], a[152:155], a[104:107], v[216:219]
    v_mfma_f32_16x16x32_bf16 v[248:251], a[152:155], a[108:111], v[248:251]
    s_waitcnt lgkmcnt(15)
    v_mfma_f32_16x16x32_bf16 v[156:159], a[156:159], a[96:99], v[156:159]
    v_mfma_f32_16x16x32_bf16 v[188:191], a[156:159], a[100:103], v[188:191]
    v_mfma_f32_16x16x32_bf16 v[220:223], a[156:159], a[104:107], v[220:223]
    v_mfma_f32_16x16x32_bf16 v[252:255], a[156:159], a[108:111], v[252:255]
    s_waitcnt vmcnt(38) lgkmcnt(14)
    v_mfma_f32_16x16x32_bf16 v[128:131], a[160:163], a[112:115], v[128:131]
    buffer_load_dwordx4 a[96:99], v21, s[56:59], s68 offen sc1
    s_waitcnt vmcnt(38)
    v_mfma_f32_16x16x32_bf16 v[160:163], a[160:163], a[116:119], v[160:163]
    ds_read_b64_tr_b16 a[128:129], v48 offset:0
    s_waitcnt vmcnt(37)
    v_mfma_f32_16x16x32_bf16 v[192:195], a[160:163], a[120:123], v[192:195]
    ds_read_b64_tr_b16 a[130:131], v48 offset:4096
    buffer_load_dwordx4 a[100:103], v22, s[56:59], s68 offen sc1
    s_waitcnt vmcnt(37)
    v_mfma_f32_16x16x32_bf16 v[224:227], a[160:163], a[124:127], v[224:227]
    s_waitcnt lgkmcnt(14)
    v_mfma_f32_16x16x32_bf16 v[132:135], a[164:167], a[112:115], v[132:135]
    ds_read_b64_tr_b16 a[132:133], v49 offset:0
    buffer_load_dwordx4 a[104:107], v23, s[56:59], s68 offen sc1
    v_mfma_f32_16x16x32_bf16 v[164:167], a[164:167], a[116:119], v[164:167]
    ds_read_b64_tr_b16 a[134:135], v49 offset:4096
    v_mfma_f32_16x16x32_bf16 v[196:199], a[164:167], a[120:123], v[196:199]
    buffer_load_dwordx4 a[108:111], v24, s[56:59], s68 offen sc1
    v_mfma_f32_16x16x32_bf16 v[228:231], a[164:167], a[124:127], v[228:231]
    ds_read_b64_tr_b16 a[136:137], v50 offset:0
    s_waitcnt lgkmcnt(15)
    v_mfma_f32_16x16x32_bf16 v[136:139], a[168:171], a[112:115], v[136:139]
    ds_read_b64_tr_b16 a[138:139], v50 offset:4096
    s_add_u32 s68, s68, 16384
    v_mfma_f32_16x16x32_bf16 v[168:171], a[168:171], a[116:119], v[168:171]
    v_mfma_f32_16x16x32_bf16 v[200:203], a[168:171], a[120:123], v[200:203]
    ds_read_b64_tr_b16 a[140:141], v51 offset:0
    v_mfma_f32_16x16x32_bf16 v[232:235], a[168:171], a[124:127], v[232:235]
    ds_read_b64_tr_b16 a[142:143], v51 offset:4096
    s_mov_b32 s83, 1736704
    s_add_u32 m0, s3, 24576
    s_waitcnt lgkmcnt(15)
    v_mfma_f32_16x16x32_bf16 v[140:143], a[172:175], a[112:115], v[140:143]
    buffer_load_dwordx4 v17, s[48:51], s83 offen lds
    v_mfma_f32_16x16x32_bf16 v[172:175], a[172:175], a[116:119], v[172:175]
    ds_read_b64_tr_b16 a[144:145], v52 offset:0
    v_mfma_f32_16x16x32_bf16 v[204:207], a[172:175], a[120:123], v[204:207]
    ds_read_b64_tr_b16 a[146:147], v52 offset:4096
    v_mfma_f32_16x16x32_bf16 v[236:239], a[172:175], a[124:127], v[236:239]
    s_waitcnt lgkmcnt(15)
    v_mfma_f32_16x16x32_bf16 v[144:147], a[176:179], a[112:115], v[144:147]
    ds_read_b64_tr_b16 a[148:149], v53 offset:0
    buffer_load_dwordx4 v18, s[48:51], s83 offen offset:1024 lds
    v_mfma_f32_16x16x32_bf16 v[176:179], a[176:179], a[116:119], v[176:179]
    ds_read_b64_tr_b16 a[150:151], v53 offset:4096
    v_mfma_f32_16x16x32_bf16 v[208:211], a[176:179], a[120:123], v[208:211]
    v_mfma_f32_16x16x32_bf16 v[240:243], a[176:179], a[124:127], v[240:243]
    ds_read_b64_tr_b16 a[152:153], v54 offset:0
    s_waitcnt lgkmcnt(15)
    v_mfma_f32_16x16x32_bf16 v[148:151], a[180:183], a[112:115], v[148:151]
    ds_read_b64_tr_b16 a[154:155], v54 offset:4096
    v_mfma_f32_16x16x32_bf16 v[180:183], a[180:183], a[116:119], v[180:183]
    v_mfma_f32_16x16x32_bf16 v[212:215], a[180:183], a[120:123], v[212:215]
    ds_read_b64_tr_b16 a[156:157], v55 offset:0
    v_mfma_f32_16x16x32_bf16 v[244:247], a[180:183], a[124:127], v[244:247]
    ds_read_b64_tr_b16 a[158:159], v55 offset:4096
    v_mfma_f32_16x16x32_bf16 v[152:155], a[184:187], a[112:115], v[152:155]
    v_mfma_f32_16x16x32_bf16 v[184:187], a[184:187], a[116:119], v[184:187]
    v_mfma_f32_16x16x32_bf16 v[216:219], a[184:187], a[120:123], v[216:219]
    v_mfma_f32_16x16x32_bf16 v[248:251], a[184:187], a[124:127], v[248:251]
    s_waitcnt lgkmcnt(15)
    v_mfma_f32_16x16x32_bf16 v[156:159], a[188:191], a[112:115], v[156:159]
    v_mfma_f32_16x16x32_bf16 v[188:191], a[188:191], a[116:119], v[188:191]
    v_mfma_f32_16x16x32_bf16 v[220:223], a[188:191], a[120:123], v[220:223]
    v_mfma_f32_16x16x32_bf16 v[252:255], a[188:191], a[124:127], v[252:255]
    s_waitcnt lgkmcnt(0)
    s_barrier
    s_waitcnt vmcnt(40)
    v_mfma_f32_16x16x32_bf16 v[128:131], a[128:131], a[0:3], v[128:131]
    buffer_load_dwordx4 a[112:115], v21, s[56:59], s68 offen sc1
    s_waitcnt vmcnt(40)
    v_mfma_f32_16x16x32_bf16 v[160:163], a[128:131], a[4:7], v[160:163]
    ds_read_b64_tr_b16 a[160:161], v48 offset:8192
    s_waitcnt vmcnt(39)
    v_mfma_f32_16x16x32_bf16 v[192:195], a[128:131], a[8:11], v[192:195]
    ds_read_b64_tr_b16 a[162:163], v48 offset:12288
    buffer_load_dwordx4 a[116:119], v22, s[56:59], s68 offen sc1
    s_waitcnt vmcnt(39)
    v_mfma_f32_16x16x32_bf16 v[224:227], a[128:131], a[12:15], v[224:227]
    v_mfma_f32_16x16x32_bf16 v[132:135], a[132:135], a[0:3], v[132:135]
    ds_read_b64_tr_b16 a[164:165], v49 offset:8192
    buffer_load_dwordx4 a[120:123], v23, s[56:59], s68 offen sc1
    v_mfma_f32_16x16x32_bf16 v[164:167], a[132:135], a[4:7], v[164:167]
    ds_read_b64_tr_b16 a[166:167], v49 offset:12288
    v_mfma_f32_16x16x32_bf16 v[196:199], a[132:135], a[8:11], v[196:199]
    buffer_load_dwordx4 a[124:127], v24, s[56:59], s68 offen sc1
    v_mfma_f32_16x16x32_bf16 v[228:231], a[132:135], a[12:15], v[228:231]
    ds_read_b64_tr_b16 a[168:169], v50 offset:8192
    v_mfma_f32_16x16x32_bf16 v[136:139], a[136:139], a[0:3], v[136:139]
    ds_read_b64_tr_b16 a[170:171], v50 offset:12288
    s_add_u32 s68, s68, 16384
    v_mfma_f32_16x16x32_bf16 v[168:171], a[136:139], a[4:7], v[168:171]
    v_mfma_f32_16x16x32_bf16 v[200:203], a[136:139], a[8:11], v[200:203]
    ds_read_b64_tr_b16 a[172:173], v51 offset:8192
    v_mfma_f32_16x16x32_bf16 v[232:235], a[136:139], a[12:15], v[232:235]
    ds_read_b64_tr_b16 a[174:175], v51 offset:12288
    s_mov_b32 s82, 196608
    s_add_u32 m0, s3, 32768
    v_mfma_f32_16x16x32_bf16 v[140:143], a[140:143], a[0:3], v[140:143]
    buffer_load_dwordx4 v19, s[48:51], s82 offen lds
    v_mfma_f32_16x16x32_bf16 v[172:175], a[140:143], a[4:7], v[172:175]
    ds_read_b64_tr_b16 a[176:177], v52 offset:8192
    v_mfma_f32_16x16x32_bf16 v[204:207], a[140:143], a[8:11], v[204:207]
    ds_read_b64_tr_b16 a[178:179], v52 offset:12288
    v_mfma_f32_16x16x32_bf16 v[236:239], a[140:143], a[12:15], v[236:239]
    v_mfma_f32_16x16x32_bf16 v[144:147], a[144:147], a[0:3], v[144:147]
    ds_read_b64_tr_b16 a[180:181], v53 offset:8192
    buffer_load_dwordx4 v20, s[48:51], s82 offen offset:1024 lds
    v_mfma_f32_16x16x32_bf16 v[176:179], a[144:147], a[4:7], v[176:179]
    ds_read_b64_tr_b16 a[182:183], v53 offset:12288
    v_mfma_f32_16x16x32_bf16 v[208:211], a[144:147], a[8:11], v[208:211]
    v_mfma_f32_16x16x32_bf16 v[240:243], a[144:147], a[12:15], v[240:243]
    ds_read_b64_tr_b16 a[184:185], v54 offset:8192
    v_mfma_f32_16x16x32_bf16 v[148:151], a[148:151], a[0:3], v[148:151]
    ds_read_b64_tr_b16 a[186:187], v54 offset:12288
    v_mfma_f32_16x16x32_bf16 v[180:183], a[148:151], a[4:7], v[180:183]
    s_mov_b32 s83, 655360
    s_add_u32 m0, s3, 40960
    v_mfma_f32_16x16x32_bf16 v[212:215], a[148:151], a[8:11], v[212:215]
    ds_read_b64_tr_b16 a[188:189], v55 offset:8192
    buffer_load_dwordx4 v19, s[48:51], s83 offen lds
    v_mfma_f32_16x16x32_bf16 v[244:247], a[148:151], a[12:15], v[244:247]
    ds_read_b64_tr_b16 a[190:191], v55 offset:12288
    v_mfma_f32_16x16x32_bf16 v[152:155], a[152:155], a[0:3], v[152:155]
    v_mfma_f32_16x16x32_bf16 v[184:187], a[152:155], a[4:7], v[184:187]
    v_mfma_f32_16x16x32_bf16 v[216:219], a[152:155], a[8:11], v[216:219]
    buffer_load_dwordx4 v20, s[48:51], s83 offen offset:1024 lds
    v_mfma_f32_16x16x32_bf16 v[248:251], a[152:155], a[12:15], v[248:251]
    v_mfma_f32_16x16x32_bf16 v[156:159], a[156:159], a[0:3], v[156:159]
    v_mfma_f32_16x16x32_bf16 v[188:191], a[156:159], a[4:7], v[188:191]
    v_mfma_f32_16x16x32_bf16 v[220:223], a[156:159], a[8:11], v[220:223]
    v_mfma_f32_16x16x32_bf16 v[252:255], a[156:159], a[12:15], v[252:255]
    s_waitcnt vmcnt(44) lgkmcnt(14)
    v_mfma_f32_16x16x32_bf16 v[128:131], a[160:163], a[16:19], v[128:131]
    s_waitcnt vmcnt(32)
    v_readfirstlane_b32 s86, v43
    s_bfe_u32 s86, s86, 0x80008
    s_cmp_eq_u32 s86, 16
    s_cbranch_scc0 L_spB
L_okB:
    buffer_load_dwordx4 a[0:3], v21, s[56:59], s68 offen sc1
    v_mfma_f32_16x16x32_bf16 v[160:163], a[160:163], a[20:23], v[160:163]
    ds_read_b64_tr_b16 a[128:129], v48 offset:16384
    v_mfma_f32_16x16x32_bf16 v[192:195], a[160:163], a[24:27], v[192:195]
    ds_read_b64_tr_b16 a[130:131], v48 offset:20480
    buffer_load_dwordx4 a[4:7], v22, s[56:59], s68 offen sc1
    v_mfma_f32_16x16x32_bf16 v[224:227], a[160:163], a[28:31], v[224:227]
    s_waitcnt lgkmcnt(14)
    v_mfma_f32_16x16x32_bf16 v[132:135], a[164:167], a[16:19], v[132:135]
    ds_read_b64_tr_b16 a[132:133], v49 offset:16384
    buffer_load_dwordx4 a[8:11], v23, s[56:59], s68 offen sc1
    v_mfma_f32_16x16x32_bf16 v[164:167], a[164:167], a[20:23], v[164:167]
    ds_read_b64_tr_b16 a[134:135], v49 offset:20480
    v_mfma_f32_16x16x32_bf16 v[196:199], a[164:167], a[24:27], v[196:199]
    buffer_load_dwordx4 a[12:15], v24, s[56:59], s68 offen sc1
    v_mfma_f32_16x16x32_bf16 v[228:231], a[164:167], a[28:31], v[228:231]
    ds_read_b64_tr_b16 a[136:137], v50 offset:16384
    s_waitcnt lgkmcnt(15)
    v_mfma_f32_16x16x32_bf16 v[136:139], a[168:171], a[16:19], v[136:139]
    ds_read_b64_tr_b16 a[138:139], v50 offset:20480
    s_add_u32 s68, s68, 16384
    v_mfma_f32_16x16x32_bf16 v[168:171], a[168:171], a[20:23], v[168:171]
    v_mfma_f32_16x16x32_bf16 v[200:203], a[168:171], a[24:27], v[200:203]
    ds_read_b64_tr_b16 a[140:141], v51 offset:16384
    v_mfma_f32_16x16x32_bf16 v[232:235], a[168:171], a[28:31], v[232:235]
    ds_read_b64_tr_b16 a[142:143], v51 offset:20480
    s_mov_b32 s82, 1114112
    s_add_u32 m0, s3, 49152
    s_waitcnt lgkmcnt(15)
    v_mfma_f32_16x16x32_bf16 v[140:143], a[172:175], a[16:19], v[140:143]
    buffer_load_dwordx4 v19, s[48:51], s82 offen lds
    v_mfma_f32_16x16x32_bf16 v[172:175], a[172:175], a[20:23], v[172:175]
    ds_read_b64_tr_b16 a[144:145], v52 offset:16384
    v_mfma_f32_16x16x32_bf16 v[204:207], a[172:175], a[24:27], v[204:207]
    ds_read_b64_tr_b16 a[146:147], v52 offset:20480
    v_mfma_f32_16x16x32_bf16 v[236:239], a[172:175], a[28:31], v[236:239]
    s_waitcnt lgkmcnt(15)
    v_mfma_f32_16x16x32_bf16 v[144:147], a[176:179], a[16:19], v[144:147]
    ds_read_b64_tr_b16 a[148:149], v53 offset:16384
    buffer_load_dwordx4 v20, s[48:51], s82 offen offset:1024 lds
    v_mfma_f32_16x16x32_bf16 v[176:179], a[176:179], a[20:23], v[176:179]
    ds_read_b64_tr_b16 a[150:151], v53 offset:20480
    v_mfma_f32_16x16x32_bf16 v[208:211], a[176:179], a[24:27], v[208:211]
    v_mfma_f32_16x16x32_bf16 v[240:243], a[176:179], a[28:31], v[240:243]
    ds_read_b64_tr_b16 a[152:153], v54 offset:16384
    s_waitcnt lgkmcnt(15)
    v_mfma_f32_16x16x32_bf16 v[148:151], a[180:183], a[16:19], v[148:151]
    ds_read_b64_tr_b16 a[154:155], v54 offset:20480
    v_mfma_f32_16x16x32_bf16 v[180:183], a[180:183], a[20:23], v[180:183]
    v_mfma_f32_16x16x32_bf16 v[212:215], a[180:183], a[24:27], v[212:215]
    ds_read_b64_tr_b16 a[156:157], v55 offset:16384
    v_mfma_f32_16x16x32_bf16 v[244:247], a[180:183], a[28:31], v[244:247]
    ds_read_b64_tr_b16 a[158:159], v55 offset:20480
    v_mfma_f32_16x16x32_bf16 v[152:155], a[184:187], a[16:19], v[152:155]
    v_mfma_f32_16x16x32_bf16 v[184:187], a[184:187], a[20:23], v[184:187]
    v_mfma_f32_16x16x32_bf16 v[216:219], a[184:187], a[24:27], v[216:219]
    v_mfma_f32_16x16x32_bf16 v[248:251], a[184:187], a[28:31], v[248:251]
    s_waitcnt lgkmcnt(15)
    v_mfma_f32_16x16x32_bf16 v[156:159], a[188:191], a[16:19], v[156:159]
    v_mfma_f32_16x16x32_bf16 v[188:191], a[188:191], a[20:23], v[188:191]
    v_mfma_f32_16x16x32_bf16 v[220:223], a[188:191], a[24:27], v[220:223]
    v_mfma_f32_16x16x32_bf16 v[252:255], a[188:191], a[28:31], v[252:255]
    s_waitcnt lgkmcnt(14)
    v_mfma_f32_16x16x32_bf16 v[128:131], a[128:131], a[32:35], v[128:131]
    buffer_load_dwordx4 a[16:19], v21, s[56:59], s68 offen sc1
    v_mfma_f32_16x16x32_bf16 v[160:163], a[128:131], a[36:39], v[160:163]
    ds_read_b64_tr_b16 a[160:161], v48 offset:24576
    v_mfma_f32_16x16x32_bf16 v[192:195], a[128:131], a[40:43], v[192:195]
    ds_read_b64_tr_b16 a[162:163], v48 offset:28672
    buffer_load_dwordx4 a[20:23], v22, s[56:59], s68 offen sc1
    v_mfma_f32_16x16x32_bf16 v[224:227], a[128:131], a[44:47], v[224:227]
    s_waitcnt lgkmcnt(14)
    v_mfma_f32_16x16x32_bf16 v[132:135], a[132:135], a[32:35], v[132:135]
    ds_read_b64_tr_b16 a[164:165], v49 offset:24576
    buffer_load_dwordx4 a[24:27], v23, s[56:59], s68 offen sc1
    v_mfma_f32_16x16x32_bf16 v[164:167], a[132:135], a[36:39], v[164:167]
    ds_read_b64_tr_b16 a[166:167], v49 offset:28672
    v_mfma_f32_16x16x32_bf16 v[196:199], a[132:135], a[40:43], v[196:199]
    buffer_load_dwordx4 a[28:31], v24, s[56:59], s68 offen sc1
    v_mfma_f32_16x16x32_bf16 v[228:231], a[132:135], a[44:47], v[228:231]
    ds_read_b64_tr_b16 a[168:169], v50 offset:24576
    s_waitcnt lgkmcnt(15)
    v_mfma_f32_16x16x32_bf16 v[136:139], a[136:139], a[32:35], v[136:139]
    ds_read_b64_tr_b16 a[170:171], v50 offset:28672
    s_add_u32 s68, s68, 16384
    v_mfma_f32_16x16x32_bf16 v[168:171], a[136:139], a[36:39], v[168:171]
    v_mfma_f32_16x16x32_bf16 v[200:203], a[136:139], a[40:43], v[200:203]
    ds_read_b64_tr_b16 a[172:173], v51 offset:24576
    v_mfma_f32_16x16x32_bf16 v[232:235], a[136:139], a[44:47], v[232:235]
    ds_read_b64_tr_b16 a[174:175], v51 offset:28672
    s_mov_b32 s83, 1572864
    s_add_u32 m0, s3, 57344
    s_waitcnt lgkmcnt(15)
    v_mfma_f32_16x16x32_bf16 v[140:143], a[140:143], a[32:35], v[140:143]
    buffer_load_dwordx4 v19, s[48:51], s83 offen lds
    v_mfma_f32_16x16x32_bf16 v[172:175], a[140:143], a[36:39], v[172:175]
    ds_read_b64_tr_b16 a[176:177], v52 offset:24576
    v_mfma_f32_16x16x32_bf16 v[204:207], a[140:143], a[40:43], v[204:207]
    ds_read_b64_tr_b16 a[178:179], v52 offset:28672
    v_mfma_f32_16x16x32_bf16 v[236:239], a[140:143], a[44:47], v[236:239]
    s_waitcnt lgkmcnt(15)
    v_mfma_f32_16x16x32_bf16 v[144:147], a[144:147], a[32:35], v[144:147]
    ds_read_b64_tr_b16 a[180:181], v53 offset:24576
    buffer_load_dwordx4 v20, s[48:51], s83 offen offset:1024 lds
    v_mfma_f32_16x16x32_bf16 v[176:179], a[144:147], a[36:39], v[176:179]
    ds_read_b64_tr_b16 a[182:183], v53 offset:28672
    v_mfma_f32_16x16x32_bf16 v[208:211], a[144:147], a[40:43], v[208:211]
    v_mfma_f32_16x16x32_bf16 v[240:243], a[144:147], a[44:47], v[240:243]
    ds_read_b64_tr_b16 a[184:185], v54 offset:24576
    s_waitcnt lgkmcnt(15)
    v_mfma_f32_16x16x32_bf16 v[148:151], a[148:151], a[32:35], v[148:151]
    ds_read_b64_tr_b16 a[186:187], v54 offset:28672
    v_mfma_f32_16x16x32_bf16 v[180:183], a[148:151], a[36:39], v[180:183]
    v_mfma_f32_16x16x32_bf16 v[212:215], a[148:151], a[40:43], v[212:215]
    ds_read_b64_tr_b16 a[188:189], v55 offset:24576
    v_mfma_f32_16x16x32_bf16 v[244:247], a[148:151], a[44:47], v[244:247]
    ds_read_b64_tr_b16 a[190:191], v55 offset:28672
    v_mfma_f32_16x16x32_bf16 v[152:155], a[152:155], a[32:35], v[152:155]
    v_mfma_f32_16x16x32_bf16 v[184:187], a[152:155], a[36:39], v[184:187]
    v_mfma_f32_16x16x32_bf16 v[216:219], a[152:155], a[40:43], v[216:219]
    v_mfma_f32_16x16x32_bf16 v[248:251], a[152:155], a[44:47], v[248:251]
    s_waitcnt lgkmcnt(15)
    v_mfma_f32_16x16x32_bf16 v[156:159], a[156:159], a[32:35], v[156:159]
    buffer_load_dword v43, off, s[56:59], s92 sc1
    v_mfma_f32_16x16x32_bf16 v[188:191], a[156:159], a[36:39], v[188:191]
    v_mfma_f32_16x16x32_bf16 v[220:223], a[156:159], a[40:43], v[220:223]
    v_mfma_f32_16x16x32_bf16 v[252:255], a[156:159], a[44:47], v[252:255]
    s_waitcnt vmcnt(44) lgkmcnt(14)
    v_mfma_f32_16x16x32_bf16 v[128:131], a[160:163], a[48:51], v[128:131]
    buffer_load_dwordx4 a[32:35], v21, s[56:59], s68 offen sc1
    s_waitcnt vmcnt(44)
    v_mfma_f32_16x16x32_bf16 v[160:163], a[160:163], a[52:55], v[160:163]
    ds_read_b64_tr_b16 a[128:129], v48 offset:32768
    s_waitcnt vmcnt(43)
    v_mfma_f32_16x16x32_bf16 v[192:195], a[160:163], a[56:59], v[192:195]
    ds_read_b64_tr_b16 a[130:131], v48 offset:36864
    buffer_load_dwordx4 a[36:39], v22, s[56:59], s68 offen sc1
    s_waitcnt vmcnt(43)
    v_mfma_f32_16x16x32_bf16 v[224:227], a[160:163], a[60:63], v[224:227]
    s_waitcnt lgkmcnt(14)
    v_mfma_f32_16x16x32_bf16 v[132:135], a[164:167], a[48:51], v[132:135]
    ds_read_b64_tr_b16 a[132:133], v49 offset:32768
    buffer_load_dwordx4 a[40:43], v23, s[56:59], s68 offen sc1
    s_branch L_over9
L_stub9:
    s_branch L_stubret
L_over9:
    v_mfma_f32_16x16x32_bf16 v[164:167], a[164:167], a[52:55], v[164:167]
    ds_read_b64_tr_b16 a[134:135], v49 offset:36864
    v_mfma_f32_16x16x32_bf16 v[196:199], a[164:167], a[56:59], v[196:199]
    buffer_load_dwordx4 a[44:47], v24, s[56:59], s68 offen sc1
    v_mfma_f32_16x16x32_bf16 v[228:231], a[164:167], a[60:63], v[228:231]
    ds_read_b64_tr_b16 a[136:137], v50 offset:32768
    s_waitcnt lgkmcnt(15)
    v_mfma_f32_16x16x32_bf16 v[136:139], a[168:171], a[48:51], v[136:139]
    ds_read_b64_tr_b16 a[138:139], v50 offset:36864
    s_add_u32 s68, s68, 16384
    v_mfma_f32_16x16x32_bf16 v[168:171], a[168:171], a[52:55], v[168:171]
    v_mfma_f32_16x16x32_bf16 v[200:203], a[168:171], a[56:59], v[200:203]
    ds_read_b64_tr_b16 a[140:141], v51 offset:32768
    v_mfma_f32_16x16x32_bf16 v[232:235], a[168:171], a[60:63], v[232:235]
    ds_read_b64_tr_b16 a[142:143], v51 offset:36864
    s_mov_b32 s82, 0
    s_add_u32 m0, s3, 65536
    s_waitcnt lgkmcnt(15)
    v_mfma_f32_16x16x32_bf16 v[140:143], a[172:175], a[48:51], v[140:143]
    buffer_load_dwordx4 v17, s[52:55], s82 offen lds
    v_mfma_f32_16x16x32_bf16 v[172:175], a[172:175], a[52:55], v[172:175]
    ds_read_b64_tr_b16 a[144:145], v52 offset:32768
    v_mfma_f32_16x16x32_bf16 v[204:207], a[172:175], a[56:59], v[204:207]
    ds_read_b64_tr_b16 a[146:147], v52 offset:36864
    v_mfma_f32_16x16x32_bf16 v[236:239], a[172:175], a[60:63], v[236:239]
    s_waitcnt lgkmcnt(15)
    v_mfma_f32_16x16x32_bf16 v[144:147], a[176:179], a[48:51], v[144:147]
    ds_read_b64_tr_b16 a[148:149], v53 offset:32768
    buffer_load_dwordx4 v18, s[52:55], s82 offen offset:1024 lds
    v_mfma_f32_16x16x32_bf16 v[176:179], a[176:179], a[52:55], v[176:179]
    ds_read_b64_tr_b16 a[150:151], v53 offset:36864
    v_mfma_f32_16x16x32_bf16 v[208:211], a[176:179], a[56:59], v[208:211]
    v_mfma_f32_16x16x32_bf16 v[240:243], a[176:179], a[60:63], v[240:243]
    ds_read_b64_tr_b16 a[152:153], v54 offset:32768
    s_waitcnt lgkmcnt(15)
    v_mfma_f32_16x16x32_bf16 v[148:151], a[180:183], a[48:51], v[148:151]
    ds_read_b64_tr_b16 a[154:155], v54 offset:36864
    v_mfma_f32_16x16x32_bf16 v[180:183], a[180:183], a[52:55], v[180:183]
    v_mfma_f32_16x16x32_bf16 v[212:215], a[180:183], a[56:59], v[212:215]
    ds_read_b64_tr_b16 a[156:157], v55 offset:32768
    v_mfma_f32_16x16x32_bf16 v[244:247], a[180:183], a[60:63], v[244:247]
    ds_read_b64_tr_b16 a[158:159], v55 offset:36864
    v_mfma_f32_16x16x32_bf16 v[152:155], a[184:187], a[48:51], v[152:155]
    v_mfma_f32_16x16x32_bf16 v[184:187], a[184:187], a[52:55], v[184:187]
    v_mfma_f32_16x16x32_bf16 v[216:219], a[184:187], a[56:59], v[216:219]
    v_mfma_f32_16x16x32_bf16 v[248:251], a[184:187], a[60:63], v[248:251]
    s_waitcnt lgkmcnt(15)
    v_mfma_f32_16x16x32_bf16 v[156:159], a[188:191], a[48:51], v[156:159]
    v_mfma_f32_16x16x32_bf16 v[188:191], a[188:191], a[52:55], v[188:191]
    v_mfma_f32_16x16x32_bf16 v[220:223], a[188:191], a[56:59], v[220:223]
    v_mfma_f32_16x16x32_bf16 v[252:255], a[188:191], a[60:63], v[252:255]
    s_waitcnt lgkmcnt(0)
    s_barrier
    s_waitcnt vmcnt(44)
    v_mfma_f32_16x16x32_bf16 v[128:131], a[128:131], a[64:67], v[128:131]
    buffer_load_dwordx4 a[48:51], v21, s[56:59], s68 offen sc1
    s_waitcnt vmcnt(44)
    v_mfma_f32_16x16x32_bf16 v[160:163], a[128:131], a[68:71], v[160:163]
    ds_read_b64_tr_b16 a[160:161], v48 offset:40960
    s_waitcnt vmcnt(43)
    v_mfma_f32_16x16x32_bf16 v[192:195], a[128:131], a[72:75], v[192:195]
    ds_read_b64_tr_b16 a[162:163], v48 offset:45056
    buffer_load_dwordx4 a[52:55], v22, s[56:59], s68 offen sc1
    s_waitcnt vmcnt(43)
    v_mfma_f32_16x16x32_bf16 v[224:227], a[128:131], a[76:79], v[224:227]
    v_mfma_f32_16x16x32_bf16 v[132:135], a[132:135], a[64:67], v[132:135]
    ds_read_b64_tr_b16 a[164:165], v49 offset:40960
    buffer_load_dwordx4 a[56:59], v23, s[56:59], s68 offen sc1
    v_mfma_f32_16x16x32_bf16 v[164:167], a[132:135], a[68:71], v[164:167]
    ds_read_b64_tr_b16 a[166:167], v49 offset:45056
    v_mfma_f32_16x16x32_bf16 v[196:199], a[132:135], a[72:75], v[196:199]
    buffer_load_dwordx4 a[60:63], v24, s[56:59], s68 offen sc1
    v_mfma_f32_16x16x32_bf16 v[228:231], a[132:135], a[76:79], v[228:231]
    ds_read_b64_tr_b16 a[168:169], v50 offset:40960
    v_mfma_f32_16x16x32_bf16 v[136:139], a[136:139], a[64:67], v[136:139]
    ds_read_b64_tr_b16 a[170:171], v50 offset:45056
    s_add_u32 s68, s68, 16384
    v_mfma_f32_16x16x32_bf16 v[168:171], a[136:139], a[68:71], v[168:171]
    v_mfma_f32_16x16x32_bf16 v[200:203], a[136:139], a[72:75], v[200:203]
    ds_read_b64_tr_b16 a[172:173], v51 offset:40960
    v_cndmask_b32 v72, v64, v68, s[4:5]
    v_mfma_f32_16x16x32_bf16 v[232:235], a[136:139], a[76:79], v[232:235]
    ds_read_b64_tr_b16 a[174:175], v51 offset:45056
    s_mov_b32 s83, 65536
    s_add_u32 m0, s3, 73728
    v_cndmask_b32 v73, v65, v69, s[4:5]
    v_mfma_f32_16x16x32_bf16 v[140:143], a[140:143], a[64:67], v[140:143]
    buffer_load_dwordx4 v17, s[52:55], s83 offen lds
    v_cndmask_b32 v74, v66, v70, s[4:5]
    v_mfma_f32_16x16x32_bf16 v[172:175], a[140:143], a[68:71], v[172:175]
    ds_read_b64_tr_b16 a[176:177], v52 offset:40960
    v_cndmask_b32 v75, v67, v71, s[4:5]
    v_mfma_f32_16x16x32_bf16 v[204:207], a[140:143], a[72:75], v[204:207]
    ds_read_b64_tr_b16 a[178:179], v52 offset:45056
    v_cndmask_b32 v64, v68, v64, s[4:5]
    v_mfma_f32_16x16x32_bf16 v[236:239], a[140:143], a[76:79], v[236:239]
    v_cndmask_b32 v65, v69, v65, s[4:5]
    v_mfma_f32_16x16x32_bf16 v[144:147], a[144:147], a[64:67], v[144:147]
    ds_read_b64_tr_b16 a[180:181], v53 offset:40960
    buffer_load_dwordx4 v18, s[52:55], s83 offen offset:1024 lds
    v_cndmask_b32 v66, v70, v66, s[4:5]
    v_mfma_f32_16x16x32_bf16 v[176:179], a[144:147], a[68:71], v[176:179]
    ds_read_b64_tr_b16 a[182:183], v53 offset:45056
    v_cndmask_b32 v67, v71, v67, s[4:5]
    v_mfma_f32_16x16x32_bf16 v[208:211], a[144:147], a[72:75], v[208:211]
    v_mov_b32_dpp v76, v72 row_ror:8 row_mask:0xf bank_mask:0xf
    v_mfma_f32_16x16x32_bf16 v[240:243], a[144:147], a[76:79], v[240:243]
    ds_read_b64_tr_b16 a[184:185], v54 offset:40960
    v_mov_b32_dpp v77, v73 row_ror:8 row_mask:0xf bank_mask:0xf
    v_mfma_f32_16x16x32_bf16 v[148:151], a[148:151], a[64:67], v[148:151]
    ds_read_b64_tr_b16 a[186:187], v54 offset:45056
    v_mov_b32_dpp v78, v74 row_ror:8 row_mask:0xf bank_mask:0xf
    v_mfma_f32_16x16x32_bf16 v[180:183], a[148:151], a[68:71], v[180:183]
    s_mov_b32 s82, 131072
    s_add_u32 m0, s3, 81920
    v_mov_b32_dpp v79, v75 row_ror:8 row_mask:0xf bank_mask:0xf
    v_mfma_f32_16x16x32_bf16 v[212:215], a[148:151], a[72:75], v[212:215]
    ds_read_b64_tr_b16 a[188:189], v55 offset:40960
    buffer_load_dwordx4 v17, s[52:55], s82 offen lds
    v_permlane16_swap_b32 v64, v66
    v_mfma_f32_16x16x32_bf16 v[244:247], a[148:151], a[76:79], v[244:247]
    ds_read_b64_tr_b16 a[190:191], v55 offset:45056
    v_permlane16_swap_b32 v65, v67
    v_mfma_f32_16x16x32_bf16 v[152:155], a[152:155], a[64:67], v[152:155]
    v_permlane16_swap_b32 v76, v78
    v_mfma_f32_16x16x32_bf16 v[184:187], a[152:155], a[68:71], v[184:187]
    v_permlane16_swap_b32 v77, v79
    v_mfma_f32_16x16x32_bf16 v[216:219], a[152:155], a[72:75], v[216:219]
    buffer_load_dwordx4 v18, s[52:55], s82 offen offset:1024 lds
    v_mfma_f32_16x16x32_bf16 v[248:251], a[152:155], a[76:79], v[248:251]
    v_mfma_f32_16x16x32_bf16 v[156:159], a[156:159], a[64:67], v[156:159]
    v_mfma_f32_16x16x32_bf16 v[188:191], a[156:159], a[68:71], v[188:191]
    v_mfma_f32_16x16x32_bf16 v[220:223], a[156:159], a[72:75], v[220:223]
    v_mfma_f32_16x16x32_bf16 v[252:255], a[156:159], a[76:79], v[252:255]
    s_waitcnt vmcnt(46) lgkmcnt(14)
    v_mfma_f32_16x16x32_bf16 v[128:131], a[160:163], a[80:83], v[128:131]
    buffer_load_dwordx4 a[64:67], v21, s[56:59], s68 offen sc1
    s_waitcnt vmcnt(46)
    v_mfma_f32_16x16x32_bf16 v[160:163], a[160:163], a[84:87], v[160:163]
    ds_read_b64_tr_b16 a[128:129], v48 offset:49152
    s_waitcnt vmcnt(45)
    v_mfma_f32_16x16x32_bf16 v[192:195], a[160:163], a[88:91], v[192:195]
    ds_read_b64_tr_b16 a[130:131], v48 offset:53248
    buffer_load_dwordx4 a[68:71], v22, s[56:59], s68 offen sc1
    s_waitcnt vmcnt(45)
    v_mfma_f32_16x16x32_bf16 v[224:227], a[160:163], a[92:95], v[224:227]
    s_waitcnt lgkmcnt(14)
    v_mfma_f32_16x16x32_bf16 v[132:135], a[164:167], a[80:83], v[132:135]
    ds_read_b64_tr_b16 a[132:133], v49 offset:49152
    buffer_load_dwordx4 a[72:75], v23, s[56:59], s68 offen sc1
    v_mfma_f32_16x16x32_bf16 v[164:167], a[164:167], a[84:87], v[164:167]
    ds_read_b64_tr_b16 a[134:135], v49 offset:53248
    v_mfma_f32_16x16x32_bf16 v[196:199], a[164:167], a[88:91], v[196:199]
    buffer_load_dwordx4 a[76:79], v24, s[56:59], s68 offen sc1
    v_mfma_f32_16x16x32_bf16 v[228:231], a[164:167], a[92:95], v[228:231]
    ds_read_b64_tr_b16 a[136:137], v50 offset:49152
    s_waitcnt lgkmcnt(15)
    v_mfma_f32_16x16x32_bf16 v[136:139], a[168:171], a[80:83], v[136:139]
    ds_read_b64_tr_b16 a[138:139], v50 offset:53248
    s_add_u32 s68, s68, 16384
    v_mfma_f32_16x16x32_bf16 v[168:171], a[168:171], a[84:87], v[168:171]
    v_mfma_f32_16x16x32_bf16 v[200:203], a[168:171], a[88:91], v[200:203]
    ds_read_b64_tr_b16 a[140:141], v51 offset:49152
    v_and_b32 v71, 0xffff0000, v67
    v_mfma_f32_16x16x32_bf16 v[232:235], a[168:171], a[92:95], v[232:235]
    ds_read_b64_tr_b16 a[142:143], v51 offset:53248
    s_mov_b32 s83, 196608
    s_add_u32 m0, s3, 90112
    v_lshlrev_b32 v70, 16, v67
    s_waitcnt lgkmcnt(15)
    v_mfma_f32_16x16x32_bf16 v[140:143], a[172:175], a[80:83], v[140:143]
    buffer_load_dwordx4 v17, s[52:55], s83 offen lds
    v_and_b32 v69, 0xffff0000, v66
    v_mfma_f32_16x16x32_bf16 v[172:175], a[172:175], a[84:87], v[172:175]
    ds_read_b64_tr_b16 a[144:145], v52 offset:49152
    v_lshlrev_b32 v68, 16, v66
    v_mfma_f32_16x16x32_bf16 v[204:207], a[172:175], a[88:91], v[204:207]
    ds_read_b64_tr_b16 a[146:147], v52 offset:53248
    v_and_b32 v67, 0xffff0000, v65
    v_mfma_f32_16x16x32_bf16 v[236:239], a[172:175], a[92:95], v[236:239]
    v_lshlrev_b32 v66, 16, v65
    s_waitcnt lgkmcnt(15)
    v_mfma_f32_16x16x32_bf16 v[144:147], a[176:179], a[80:83], v[144:147]
    ds_read_b64_tr_b16 a[148:149], v53 offset:49152
    buffer_load_dwordx4 v18, s[52:55], s83 offen offset:1024 lds
    v_and_b32 v65, 0xffff0000, v64
    v_mfma_f32_16x16x32_bf16 v[176:179], a[176:179], a[84:87], v[176:179]
    ds_read_b64_tr_b16 a[150:151], v53 offset:53248
    v_lshlrev_b32 v64, 16, v64
    v_mfma_f32_16x16x32_bf16 v[208:211], a[176:179], a[88:91], v[208:211]
    v_lshlrev_b32 v72, 16, v76
    v_mfma_f32_16x16x32_bf16 v[240:243], a[176:179], a[92:95], v[240:243]
    ds_read_b64_tr_b16 a[152:153], v54 offset:49152
    v_and_b32 v73, 0xffff0000, v76
    s_waitcnt lgkmcnt(15)
    v_mfma_f32_16x16x32_bf16 v[148:151], a[180:183], a[80:83], v[148:151]
    ds_read_b64_tr_b16 a[154:155], v54 offset:53248
    v_lshlrev_b32 v74, 16, v77
    v_mfma_f32_16x16x32_bf16 v[180:183], a[180:183], a[84:87], v[180:183]
    v_and_b32 v75, 0xffff0000, v77
    v_mfma_f32_16x16x32_bf16 v[212:215], a[180:183], a[88:91], v[212:215]
    ds_read_b64_tr_b16 a[156:157], v55 offset:49152
    v_lshlrev_b32 v76, 16, v78
    v_mfma_f32_16x16x32_bf16 v[244:247], a[180:183], a[92:95], v[244:247]
    ds_read_b64_tr_b16 a[158:159], v55 offset:53248
    v_and_b32 v77, 0xffff0000, v78
    v_mfma_f32_16x16x32_bf16 v[152:155], a[184:187], a[80:83], v[152:155]
    v_lshlrev_b32 v78, 16, v79
    v_mfma_f32_16x16x32_bf16 v[184:187], a[184:187], a[84:87], v[184:187]
    v_and_b32 v79, 0xffff0000, v79
    v_mfma_f32_16x16x32_bf16 v[216:219], a[184:187], a[88:91], v[216:219]
    v_mfma_f32_16x16x32_bf16 v[248:251], a[184:187], a[92:95], v[248:251]
    s_waitcnt lgkmcnt(15)
    v_mfma_f32_16x16x32_bf16 v[156:159], a[188:191], a[80:83], v[156:159]
    buffer_load_dword v44, off, s[56:59], s76 sc1
    v_mfma_f32_16x16x32_bf16 v[188:191], a[188:191], a[84:87], v[188:191]
    v_mfma_f32_16x16x32_bf16 v[220:223], a[188:191], a[88:91], v[220:223]
    v_mfma_f32_16x16x32_bf16 v[252:255], a[188:191], a[92:95], v[252:255]
    s_waitcnt lgkmcnt(0)
    s_barrier
    s_waitcnt vmcnt(47)
    v_mfma_f32_16x16x32_bf16 v[128:131], a[128:131], a[96:99], v[128:131]
    buffer_load_dwordx4 a[80:83], v21, s[56:59], s68 offen sc1
    s_waitcnt vmcnt(47)
    v_mfma_f32_16x16x32_bf16 v[160:163], a[128:131], a[100:103], v[160:163]
    ds_read_b64_tr_b16 a[160:161], v48 offset:57344
    s_waitcnt vmcnt(46)
    v_mfma_f32_16x16x32_bf16 v[192:195], a[128:131], a[104:107], v[192:195]
    ds_read_b64_tr_b16 a[162:163], v48 offset:61440
    buffer_load_dwordx4 a[84:87], v22, s[56:59], s68 offen sc1
    s_waitcnt vmcnt(46)
    v_mfma_f32_16x16x32_bf16 v[224:227], a[128:131], a[108:111], v[224:227]
    v_mfma_f32_16x16x32_bf16 v[132:135], a[132:135], a[96:99], v[132:135]
    ds_read_b64_tr_b16 a[164:165], v49 offset:57344
    buffer_load_dwordx4 a[88:91], v23, s[56:59], s68 offen sc1
    v_mfma_f32_16x16x32_bf16 v[164:167], a[132:135], a[100:103], v[164:167]
    ds_read_b64_tr_b16 a[166:167], v49 offset:61440
    v_mfma_f32_16x16x32_bf16 v[196:199], a[132:135], a[104:107], v[196:199]
    buffer_load_dwordx4 a[92:95], v24, s[56:59], s68 offen sc1
    v_mfma_f32_16x16x32_bf16 v[228:231], a[132:135], a[108:111], v[228:231]
    ds_read_b64_tr_b16 a[168:169], v50 offset:57344
    v_mfma_f32_16x16x32_bf16 v[136:139], a[136:139], a[96:99], v[136:139]
    ds_read_b64_tr_b16 a[170:171], v50 offset:61440
    s_add_u32 s68, s68, 16384
    v_mfma_f32_16x16x32_bf16 v[168:171], a[136:139], a[100:103], v[168:171]
    v_mfma_f32_16x16x32_bf16 v[200:203], a[136:139], a[104:107], v[200:203]
    ds_read_b64_tr_b16 a[172:173], v51 offset:57344
    v_cndmask_b32 v88, v80, v84, s[4:5]
    v_mfma_f32_16x16x32_bf16 v[232:235], a[136:139], a[108:111], v[232:235]
    ds_read_b64_tr_b16 a[174:175], v51 offset:61440
    s_mov_b32 s82, 262144
    s_add_u32 m0, s3, 98304
    v_cndmask_b32 v89, v81, v85, s[4:5]
    v_mfma_f32_16x16x32_bf16 v[140:143], a[140:143], a[96:99], v[140:143]
    buffer_load_dwordx4 v17, s[52:55], s82 offen lds
    v_cndmask_b32 v90, v82, v86, s[4:5]
    v_mfma_f32_16x16x32_bf16 v[172:175], a[140:143], a[100:103], v[172:175]
    ds_read_b64_tr_b16 a[176:177], v52 offset:57344
    v_cndmask_b32 v91, v83, v87, s[4:5]
    v_mfma_f32_16x16x32_bf16 v[204:207], a[140:143], a[104:107], v[204:207]
    ds_read_b64_tr_b16 a[178:179], v52 offset:61440
    v_cndmask_b32 v80, v84, v80, s[4:5]
    v_mfma_f32_16x16x32_bf16 v[236:239], a[140:143], a[108:111], v[236:239]
    v_cndmask_b32 v81, v85, v81, s[4:5]
    v_mfma_f32_16x16x32_bf16 v[144:147], a[144:147], a[96:99], v[144:147]
    ds_read_b64_tr_b16 a[180:181], v53 offset:57344
    buffer_load_dwordx4 v18, s[52:55], s82 offen offset:1024 lds
    v_cndmask_b32 v82, v86, v82, s[4:5]
    v_mfma_f32_16x16x32_bf16 v[176:179], a[144:147], a[100:103], v[176:179]
    ds_read_b64_tr_b16 a[182:183], v53 offset:61440
    v_cndmask_b32 v83, v87, v83, s[4:5]
    v_mfma_f32_16x16x32_bf16 v[208:211], a[144:147], a[104:107], v[208:211]
    v_mov_b32_dpp v92, v88 row_ror:8 row_mask:0xf bank_mask:0xf
    v_mfma_f32_16x16x32_bf16 v[240:243], a[144:147], a[108:111], v[240:243]
    ds_read_b64_tr_b16 a[184:185], v54 offset:57344
    v_mov_b32_dpp v93, v89 row_ror:8 row_mask:0xf bank_mask:0xf
    v_mfma_f32_16x16x32_bf16 v[148:151], a[148:151], a[96:99], v[148:151]
    ds_read_b64_tr_b16 a[186:187], v54 offset:61440
    v_mov_b32_dpp v94, v90 row_ror:8 row_mask:0xf bank_mask:0xf
    v_mfma_f32_16x16x32_bf16 v[180:183], a[148:151], a[100:103], v[180:183]
    s_mov_b32 s83, 327680
    s_add_u32 m0, s3, 106496
    v_mov_b32_dpp v95, v91 row_ror:8 row_mask:0xf bank_mask:0xf
    v_mfma_f32_16x16x32_bf16 v[212:215], a[148:151], a[104:107], v[212:215]
    ds_read_b64_tr_b16 a[188:189], v55 offset:57344
    buffer_load_dwordx4 v17, s[52:55], s83 offen lds
    v_permlane16_swap_b32 v80, v82
    v_mfma_f32_16x16x32_bf16 v[244:247], a[148:151], a[108:111], v[244:247]
    ds_read_b64_tr_b16 a[190:191], v55 offset:61440
    v_permlane16_swap_b32 v81, v83
    v_mfma_f32_16x16x32_bf16 v[152:155], a[152:155], a[96:99], v[152:155]
    v_permlane16_swap_b32 v92, v94
    v_mfma_f32_16x16x32_bf16 v[184:187], a[152:155], a[100:103], v[184:187]
    v_permlane16_swap_b32 v93, v95
    v_mfma_f32_16x16x32_bf16 v[216:219], a[152:155], a[104:107], v[216:219]
    buffer_load_dwordx4 v18, s[52:55], s83 offen offset:1024 lds
    v_mfma_f32_16x16x32_bf16 v[248:251], a[152:155], a[108:111], v[248:251]
    v_mfma_f32_16x16x32_bf16 v[156:159], a[156:159], a[96:99], v[156:159]
    v_mfma_f32_16x16x32_bf16 v[188:191], a[156:159], a[100:103], v[188:191]
    v_mfma_f32_16x16x32_bf16 v[220:223], a[156:159], a[104:107], v[220:223]
    v_mfma_f32_16x16x32_bf16 v[252:255], a[156:159], a[108:111], v[252:255]
    s_waitcnt vmcnt(49) lgkmcnt(14)
    v_mfma_f32_16x16x32_bf16 v[128:131], a[160:163], a[112:115], v[128:131]
    buffer_load_dwordx4 a[96:99], v21, s[56:59], s68 offen sc1
    s_waitcnt vmcnt(49)
    v_mfma_f32_16x16x32_bf16 v[160:163], a[160:163], a[116:119], v[160:163]
    ds_read_b64_tr_b16 a[128:129], v56 offset:0
    s_waitcnt vmcnt(48)
    v_mfma_f32_16x16x32_bf16 v[192:195], a[160:163], a[120:123], v[192:195]
    ds_read_b64_tr_b16 a[130:131], v56 offset:4096
    buffer_load_dwordx4 a[100:103], v22, s[56:59], s68 offen sc1
    s_waitcnt vmcnt(48)
    v_mfma_f32_16x16x32_bf16 v[224:227], a[160:163], a[124:127], v[224:227]
    s_waitcnt lgkmcnt(14)
    v_mfma_f32_16x16x32_bf16 v[132:135], a[164:167], a[112:115], v[132:135]
    ds_read_b64_tr_b16 a[132:133], v57 offset:0
    buffer_load_dwordx4 a[104:107], v23, s[56:59], s68 offen sc1
    v_mfma_f32_16x16x32_bf16 v[164:167], a[164:167], a[116:119], v[164:167]
    ds_read_b64_tr_b16 a[134:135], v57 offset:4096
    v_mfma_f32_16x16x32_bf16 v[196:199], a[164:167], a[120:123], v[196:199]
    buffer_load_dwordx4 a[108:111], v24, s[56:59], s68 offen sc1
    v_mfma_f32_16x16x32_bf16 v[228:231], a[164:167], a[124:127], v[228:231]
    ds_read_b64_tr_b16 a[136:137], v58 offset:0
    s_waitcnt lgkmcnt(15)
    v_mfma_f32_16x16x32_bf16 v[136:139], a[168:171], a[112:115], v[136:139]
    ds_read_b64_tr_b16 a[138:139], v58 offset:4096
    s_add_u32 s68, s68, 16384
    v_mfma_f32_16x16x32_bf16 v[168:171], a[168:171], a[116:119], v[168:171]
    v_mfma_f32_16x16x32_bf16 v[200:203], a[168:171], a[120:123], v[200:203]
    ds_read_b64_tr_b16 a[140:141], v59 offset:0
    v_and_b32 v87, 0xffff0000, v83
    v_mfma_f32_16x16x32_bf16 v[232:235], a[168:171], a[124:127], v[232:235]
    ds_read_b64_tr_b16 a[142:143], v59 offset:4096
    s_mov_b32 s82, 393216
    s_add_u32 m0, s3, 114688
    v_lshlrev_b32 v86, 16, v83
    s_waitcnt lgkmcnt(15)
    v_mfma_f32_16x16x32_bf16 v[140:143], a[172:175], a[112:115], v[140:143]
    buffer_load_dwordx4 v17, s[52:55], s82 offen lds
    v_and_b32 v85, 0xffff0000, v82
    v_mfma_f32_16x16x32_bf16 v[172:175], a[172:175], a[116:119], v[172:175]
    ds_read_b64_tr_b16 a[144:145], v60 offset:0
    v_lshlrev_b32 v84, 16, v82
    v_mfma_f32_16x16x32_bf16 v[204:207], a[172:175], a[120:123], v[204:207]
    ds_read_b64_tr_b16 a[146:147], v60 offset:4096
    v_and_b32 v83, 0xffff0000, v81
    v_mfma_f32_16x16x32_bf16 v[236:239], a[172:175], a[124:127], v[236:239]
    v_lshlrev_b32 v82, 16, v81
    s_waitcnt lgkmcnt(15)
    v_mfma_f32_16x16x32_bf16 v[144:147], a[176:179], a[112:115], v[144:147]
    ds_read_b64_tr_b16 a[148:149], v61 offset:0
    buffer_load_dwordx4 v18, s[52:55], s82 offen offset:1024 lds
    v_and_b32 v81, 0xffff0000, v80
    v_mfma_f32_16x16x32_bf16 v[176:179], a[176:179], a[116:119], v[176:179]
    ds_read_b64_tr_b16 a[150:151], v61 offset:4096
    v_lshlrev_b32 v80, 16, v80
    v_mfma_f32_16x16x32_bf16 v[208:211], a[176:179], a[120:123], v[208:211]
    v_lshlrev_b32 v88, 16, v92
    v_mfma_f32_16x16x32_bf16 v[240:243], a[176:179], a[124:127], v[240:243]
    ds_read_b64_tr_b16 a[152:153], v62 offset:0
    v_and_b32 v89, 0xffff0000, v92
    s_waitcnt lgkmcnt(15)
    v_mfma_f32_16x16x32_bf16 v[148:151], a[180:183], a[112:115], v[148:151]
    ds_read_b64_tr_b16 a[154:155], v62 offset:4096
    v_lshlrev_b32 v90, 16, v93
    v_mfma_f32_16x16x32_bf16 v[180:183], a[180:183], a[116:119], v[180:183]
    v_and_b32 v91, 0xffff0000, v93
    v_mfma_f32_16x16x32_bf16 v[212:215], a[180:183], a[120:123], v[212:215]
    ds_read_b64_tr_b16 a[156:157], v63 offset:0
    v_lshlrev_b32 v92, 16, v94
    v_mfma_f32_16x16x32_bf16 v[244:247], a[180:183], a[124:127], v[244:247]
    ds_read_b64_tr_b16 a[158:159], v63 offset:4096
    v_and_b32 v93, 0xffff0000, v94
    v_mfma_f32_16x16x32_bf16 v[152:155], a[184:187], a[112:115], v[152:155]
    v_lshlrev_b32 v94, 16, v95
    v_mfma_f32_16x16x32_bf16 v[184:187], a[184:187], a[116:119], v[184:187]
    v_and_b32 v95, 0xffff0000, v95
    v_mfma_f32_16x16x32_bf16 v[216:219], a[184:187], a[120:123], v[216:219]
    v_mfma_f32_16x16x32_bf16 v[248:251], a[184:187], a[124:127], v[248:251]
    s_waitcnt lgkmcnt(15)
    v_mfma_f32_16x16x32_bf16 v[156:159], a[188:191], a[112:115], v[156:159]
    v_mfma_f32_16x16x32_bf16 v[188:191], a[188:191], a[116:119], v[188:191]
    v_mfma_f32_16x16x32_bf16 v[220:223], a[188:191], a[120:123], v[220:223]
    v_mfma_f32_16x16x32_bf16 v[252:255], a[188:191], a[124:127], v[252:255]
    s_waitcnt lgkmcnt(0)
    s_barrier
    s_waitcnt vmcnt(47)
    v_mfma_f32_16x16x32_bf16 v[128:131], a[128:131], a[0:3], v[128:131]
    buffer_load_dwordx4 a[112:115], v21, s[56:59], s68 offen sc1
    s_waitcnt vmcnt(47)
    v_mfma_f32_16x16x32_bf16 v[160:163], a[128:131], a[4:7], v[160:163]
    ds_read_b64_tr_b16 a[160:161], v56 offset:8192
    s_waitcnt vmcnt(46)
    v_mfma_f32_16x16x32_bf16 v[192:195], a[128:131], a[8:11], v[192:195]
    ds_read_b64_tr_b16 a[162:163], v56 offset:12288
    buffer_load_dwordx4 a[116:119], v22, s[56:59], s68 offen sc1
    s_waitcnt vmcnt(46)
    v_mfma_f32_16x16x32_bf16 v[224:227], a[128:131], a[12:15], v[224:227]
    v_mfma_f32_16x16x32_bf16 v[132:135], a[132:135], a[0:3], v[132:135]
    ds_read_b64_tr_b16 a[164:165], v57 offset:8192
    buffer_load_dwordx4 a[120:123], v23, s[56:59], s68 offen sc1
    v_mfma_f32_16x16x32_bf16 v[164:167], a[132:135], a[4:7], v[164:167]
    ds_read_b64_tr_b16 a[166:167], v57 offset:12288
    v_mfma_f32_16x16x32_bf16 v[196:199], a[132:135], a[8:11], v[196:199]
    buffer_load_dwordx4 a[124:127], v24, s[56:59], s68 offen sc1
    v_mfma_f32_16x16x32_bf16 v[228:231], a[132:135], a[12:15], v[228:231]
    ds_read_b64_tr_b16 a[168:169], v58 offset:8192
    v_mfma_f32_16x16x32_bf16 v[136:139], a[136:139], a[0:3], v[136:139]
    ds_read_b64_tr_b16 a[170:171], v58 offset:12288
    s_add_u32 s68, s68, 16384
    v_mfma_f32_16x16x32_bf16 v[168:171], a[136:139], a[4:7], v[168:171]
    v_mfma_f32_16x16x32_bf16 v[200:203], a[136:139], a[8:11], v[200:203]
    ds_read_b64_tr_b16 a[172:173], v59 offset:8192
    v_mfma_f32_16x16x32_bf16 v[232:235], a[136:139], a[12:15], v[232:235]
    ds_read_b64_tr_b16 a[174:175], v59 offset:12288
    s_mov_b32 s83, 458752
    s_add_u32 m0, s3, 122880
    v_mfma_f32_16x16x32_bf16 v[140:143], a[140:143], a[0:3], v[140:143]
    buffer_load_dwordx4 v17, s[52:55], s83 offen lds
    v_mfma_f32_16x16x32_bf16 v[172:175], a[140:143], a[4:7], v[172:175]
    ds_read_b64_tr_b16 a[176:177], v60 offset:8192
    v_mfma_f32_16x16x32_bf16 v[204:207], a[140:143], a[8:11], v[204:207]
    ds_read_b64_tr_b16 a[178:179], v60 offset:12288
    v_mfma_f32_16x16x32_bf16 v[236:239], a[140:143], a[12:15], v[236:239]
    v_mfma_f32_16x16x32_bf16 v[144:147], a[144:147], a[0:3], v[144:147]
    ds_read_b64_tr_b16 a[180:181], v61 offset:8192
    buffer_load_dwordx4 v18, s[52:55], s83 offen offset:1024 lds
    v_mfma_f32_16x16x32_bf16 v[176:179], a[144:147], a[4:7], v[176:179]
    ds_read_b64_tr_b16 a[182:183], v61 offset:12288
    v_mfma_f32_16x16x32_bf16 v[208:211], a[144:147], a[8:11], v[208:211]
    v_mfma_f32_16x16x32_bf16 v[240:243], a[144:147], a[12:15], v[240:243]
    ds_read_b64_tr_b16 a[184:185], v62 offset:8192
    v_mfma_f32_16x16x32_bf16 v[148:151], a[148:151], a[0:3], v[148:151]
    ds_read_b64_tr_b16 a[186:187], v62 offset:12288
    v_mfma_f32_16x16x32_bf16 v[180:183], a[148:151], a[4:7], v[180:183]
    v_mfma_f32_16x16x32_bf16 v[212:215], a[148:151], a[8:11], v[212:215]
    ds_read_b64_tr_b16 a[188:189], v63 offset:8192
    v_mfma_f32_16x16x32_bf16 v[244:247], a[148:151], a[12:15], v[244:247]
    ds_read_b64_tr_b16 a[190:191], v63 offset:12288
    v_mfma_f32_16x16x32_bf16 v[152:155], a[152:155], a[0:3], v[152:155]
    v_mfma_f32_16x16x32_bf16 v[184:187], a[152:155], a[4:7], v[184:187]
    v_mfma_f32_16x16x32_bf16 v[216:219], a[152:155], a[8:11], v[216:219]
    v_mfma_f32_16x16x32_bf16 v[248:251], a[152:155], a[12:15], v[248:251]
    v_mfma_f32_16x16x32_bf16 v[156:159], a[156:159], a[0:3], v[156:159]
    v_mfma_f32_16x16x32_bf16 v[188:191], a[156:159], a[4:7], v[188:191]
    v_mfma_f32_16x16x32_bf16 v[220:223], a[156:159], a[8:11], v[220:223]
    v_mfma_f32_16x16x32_bf16 v[252:255], a[156:159], a[12:15], v[252:255]
    s_waitcnt vmcnt(47) lgkmcnt(14)
    v_mfma_f32_16x16x32_bf16 v[128:131], a[160:163], a[16:19], v[128:131]
    s_waitcnt vmcnt(41)
    v_readfirstlane_b32 s86, v43
    s_bfe_u32 s86, s86, 0x80010
    s_cmp_eq_u32 s86, 16
    s_cbranch_scc0 L_spC
L_okC:
    buffer_load_dwordx4 a[0:3], v21, s[56:59], s68 offen sc1
    v_mfma_f32_16x16x32_bf16 v[160:163], a[160:163], a[20:23], v[160:163]
    ds_read_b64_tr_b16 a[128:129], v56 offset:16384
    v_mfma_f32_16x16x32_bf16 v[192:195], a[160:163], a[24:27], v[192:195]
    ds_read_b64_tr_b16 a[130:131], v56 offset:20480
    buffer_load_dwordx4 a[4:7], v22, s[56:59], s68 offen sc1
    v_mfma_f32_16x16x32_bf16 v[224:227], a[160:163], a[28:31], v[224:227]
    s_waitcnt lgkmcnt(14)
    v_mfma_f32_16x16x32_bf16 v[132:135], a[164:167], a[16:19], v[132:135]
    ds_read_b64_tr_b16 a[132:133], v57 offset:16384
    buffer_load_dwordx4 a[8:11], v23, s[56:59], s68 offen sc1
    v_mfma_f32_16x16x32_bf16 v[164:167], a[164:167], a[20:23], v[164:167]
    ds_read_b64_tr_b16 a[134:135], v57 offset:20480
    v_mfma_f32_16x16x32_bf16 v[196:199], a[164:167], a[24:27], v[196:199]
    buffer_load_dwordx4 a[12:15], v24, s[56:59], s68 offen sc1
    v_mfma_f32_16x16x32_bf16 v[228:231], a[164:167], a[28:31], v[228:231]
    ds_read_b64_tr_b16 a[136:137], v58 offset:16384
    s_waitcnt lgkmcnt(15)
    v_mfma_f32_16x16x32_bf16 v[136:139], a[168:171], a[16:19], v[136:139]
    ds_read_b64_tr_b16 a[138:139], v58 offset:20480
    s_add_u32 s68, s68, 16384
    v_mfma_f32_16x16x32_bf16 v[168:171], a[168:171], a[20:23], v[168:171]
    v_mfma_f32_16x16x32_bf16 v[200:203], a[168:171], a[24:27], v[200:203]
    ds_read_b64_tr_b16 a[140:141], v59 offset:16384
    v_mfma_f32_16x16x32_bf16 v[232:235], a[168:171], a[28:31], v[232:235]
    ds_read_b64_tr_b16 a[142:143], v59 offset:20480
    s_mov_b32 s82, 524288
    s_add_u32 m0, s3, 131072
    s_waitcnt lgkmcnt(15)
    v_mfma_f32_16x16x32_bf16 v[140:143], a[172:175], a[16:19], v[140:143]
    buffer_load_dwordx4 v17, s[52:55], s82 offen lds
    v_mfma_f32_16x16x32_bf16 v[172:175], a[172:175], a[20:23], v[172:175]
    ds_read_b64_tr_b16 a[144:145], v60 offset:16384
    v_mfma_f32_16x16x32_bf16 v[204:207], a[172:175], a[24:27], v[204:207]
    ds_read_b64_tr_b16 a[146:147], v60 offset:20480
    v_mfma_f32_16x16x32_bf16 v[236:239], a[172:175], a[28:31], v[236:239]
    s_waitcnt lgkmcnt(15)
    v_mfma_f32_16x16x32_bf16 v[144:147], a[176:179], a[16:19], v[144:147]
    ds_read_b64_tr_b16 a[148:149], v61 offset:16384
    buffer_load_dwordx4 v18, s[52:55], s82 offen offset:1024 lds
    v_mfma_f32_16x16x32_bf16 v[176:179], a[176:179], a[20:23], v[176:179]
    ds_read_b64_tr_b16 a[150:151], v61 offset:20480
    v_mfma_f32_16x16x32_bf16 v[208:211], a[176:179], a[24:27], v[208:211]
    v_mfma_f32_16x16x32_bf16 v[240:243], a[176:179], a[28:31], v[240:243]
    ds_read_b64_tr_b16 a[152:153], v62 offset:16384
    s_waitcnt lgkmcnt(15)
    v_mfma_f32_16x16x32_bf16 v[148:151], a[180:183], a[16:19], v[148:151]
    ds_read_b64_tr_b16 a[154:155], v62 offset:20480
    v_mfma_f32_16x16x32_bf16 v[180:183], a[180:183], a[20:23], v[180:183]
    v_mfma_f32_16x16x32_bf16 v[212:215], a[180:183], a[24:27], v[212:215]
    ds_read_b64_tr_b16 a[156:157], v63 offset:16384
    v_mfma_f32_16x16x32_bf16 v[244:247], a[180:183], a[28:31], v[244:247]
    ds_read_b64_tr_b16 a[158:159], v63 offset:20480
    v_mfma_f32_16x16x32_bf16 v[152:155], a[184:187], a[16:19], v[152:155]
    v_mfma_f32_16x16x32_bf16 v[184:187], a[184:187], a[20:23], v[184:187]
    v_mfma_f32_16x16x32_bf16 v[216:219], a[184:187], a[24:27], v[216:219]
    v_mfma_f32_16x16x32_bf16 v[248:251], a[184:187], a[28:31], v[248:251]
    s_waitcnt lgkmcnt(15)
    v_mfma_f32_16x16x32_bf16 v[156:159], a[188:191], a[16:19], v[156:159]
    v_mfma_f32_16x16x32_bf16 v[188:191], a[188:191], a[20:23], v[188:191]
    v_mfma_f32_16x16x32_bf16 v[220:223], a[188:191], a[24:27], v[220:223]
    v_mfma_f32_16x16x32_bf16 v[252:255], a[188:191], a[28:31], v[252:255]
    s_waitcnt lgkmcnt(0)
    s_barrier
    s_waitcnt vmcnt(46)
    v_mfma_f32_16x16x32_bf16 v[128:131], a[128:131], a[32:35], v[128:131]
    buffer_load_dwordx4 a[16:19], v21, s[56:59], s68 offen sc1
    s_waitcnt vmcnt(46)
    v_mfma_f32_16x16x32_bf16 v[160:163], a[128:131], a[36:39], v[160:163]
    ds_read_b64_tr_b16 a[160:161], v56 offset:24576
    s_waitcnt vmcnt(45)
    v_mfma_f32_16x16x32_bf16 v[192:195], a[128:131], a[40:43], v[192:195]
    ds_read_b64_tr_b16 a[162:163], v56 offset:28672
    buffer_load_dwordx4 a[20:23], v22, s[56:59], s68 offen sc1
    s_waitcnt vmcnt(45)
    v_mfma_f32_16x16x32_bf16 v[224:227], a[128:131], a[44:47], v[224:227]
    v_mfma_f32_16x16x32_bf16 v[132:135], a[132:135], a[32:35], v[132:135]
    ds_read_b64_tr_b16 a[164:165], v57 offset:24576
    buffer_load_dwordx4 a[24:27], v23, s[56:59], s68 offen sc1
    v_mfma_f32_16x16x32_bf16 v[164:167], a[132:135], a[36:39], v[164:167]
    ds_read_b64_tr_b16 a[166:167], v57 offset:28672
    v_mfma_f32_16x16x32_bf16 v[196:199], a[132:135], a[40:43], v[196:199]
    buffer_load_dwordx4 a[28:31], v24, s[56:59], s68 offen sc1
    v_mfma_f32_16x16x32_bf16 v[228:231], a[132:135], a[44:47], v[228:231]
    ds_read_b64_tr_b16 a[168:169], v58 offset:24576
    v_mfma_f32_16x16x32_bf16 v[136:139], a[136:139], a[32:35], v[136:139]
    ds_read_b64_tr_b16 a[170:171], v58 offset:28672
    s_add_u32 s68, s68, 16384
    v_mfma_f32_16x16x32_bf16 v[168:171], a[136:139], a[36:39], v[168:171]
    v_mfma_f32_16x16x32_bf16 v[200:203], a[136:139], a[40:43], v[200:203]
    ds_read_b64_tr_b16 a[172:173], v59 offset:24576
    v_mfma_f32_16x16x32_bf16 v[232:235], a[136:139], a[44:47], v[232:235]
    ds_read_b64_tr_b16 a[174:175], v59 offset:28672
    s_mov_b32 s83, 589824
    s_add_u32 m0, s3, 139264
    v_mfma_f32_16x16x32_bf16 v[140:143], a[140:143], a[32:35], v[140:143]
    buffer_load_dwordx4 v17, s[52:55], s83 offen lds
    v_mfma_f32_16x16x32_bf16 v[172:175], a[140:143], a[36:39], v[172:175]
    ds_read_b64_tr_b16 a[176:177], v60 offset:24576
    v_mfma_f32_16x16x32_bf16 v[204:207], a[140:143], a[40:43], v[204:207]
    s_branch L_over10
L_stub10:
    s_branch L_stubret
L_over10:
    ds_read_b64_tr_b16 a[178:179], v60 offset:28672
    v_mfma_f32_16x16x32_bf16 v[236:239], a[140:143], a[44:47], v[236:239]
    v_mfma_f32_16x16x32_bf16 v[144:147], a[144:147], a[32:35], v[144:147]
    ds_read_b64_tr_b16 a[180:181], v61 offset:24576
    buffer_load_dwordx4 v18, s[52:55], s83 offen offset:1024 lds
    v_mfma_f32_16x16x32_bf16 v[176:179], a[144:147], a[36:39], v[176:179]
    ds_read_b64_tr_b16 a[182:183], v61 offset:28672
    v_mfma_f32_16x16x32_bf16 v[208:211], a[144:147], a[40:43], v[208:211]
    v_mfma_f32_16x16x32_bf16 v[240:243], a[144:147], a[44:47], v[240:243]
    ds_read_b64_tr_b16 a[184:185], v62 offset:24576
    v_mfma_f32_16x16x32_bf16 v[148:151], a[148:151], a[32:35], v[148:151]
    ds_read_b64_tr_b16 a[186:187], v62 offset:28672
    v_mfma_f32_16x16x32_bf16 v[180:183], a[148:151], a[36:39], v[180:183]
    v_mfma_f32_16x16x32_bf16 v[212:215], a[148:151], a[40:43], v[212:215]
    ds_read_b64_tr_b16 a[188:189], v63 offset:24576
    v_mfma_f32_16x16x32_bf16 v[244:247], a[148:151], a[44:47], v[244:247]
    ds_read_b64_tr_b16 a[190:191], v63 offset:28672
    v_mfma_f32_16x16x32_bf16 v[152:155], a[152:155], a[32:35], v[152:155]
    v_mfma_f32_16x16x32_bf16 v[184:187], a[152:155], a[36:39], v[184:187]
    v_mfma_f32_16x16x32_bf16 v[216:219], a[152:155], a[40:43], v[216:219]
    v_mfma_f32_16x16x32_bf16 v[248:251], a[152:155], a[44:47], v[248:251]
    v_mfma_f32_16x16x32_bf16 v[156:159], a[156:159], a[32:35], v[156:159]
    v_mfma_f32_16x16x32_bf16 v[188:191], a[156:159], a[36:39], v[188:191]
    v_mfma_f32_16x16x32_bf16 v[220:223], a[156:159], a[40:43], v[220:223]
    v_mfma_f32_16x16x32_bf16 v[252:255], a[156:159], a[44:47], v[252:255]
    s_waitcnt vmcnt(46) lgkmcnt(14)
    v_mfma_f32_16x16x32_bf16 v[128:131], a[160:163], a[48:51], v[128:131]
    buffer_load_dwordx4 a[32:35], v21, s[56:59], s68 offen sc1
    s_waitcnt vmcnt(46)
    v_mfma_f32_16x16x32_bf16 v[160:163], a[160:163], a[52:55], v[160:163]
    ds_read_b64_tr_b16 a[128:129], v8 offset:0
    s_waitcnt vmcnt(45)
    v_mfma_f32_16x16x32_bf16 v[192:195], a[160:163], a[56:59], v[192:195]
    ds_read_b64_tr_b16 a[130:131], v8 offset:4096
    buffer_load_dwordx4 a[36:39], v22, s[56:59], s68 offen sc1
    s_waitcnt vmcnt(45)
    v_mfma_f32_16x16x32_bf16 v[224:227], a[160:163], a[60:63], v[224:227]
    s_waitcnt lgkmcnt(14)
    v_mfma_f32_16x16x32_bf16 v[132:135], a[164:167], a[48:51], v[132:135]
    ds_read_b64_tr_b16 a[132:133], v9 offset:0
    buffer_load_dwordx4 a[40:43], v23, s[56:59], s68 offen sc1
    v_mfma_f32_16x16x32_bf16 v[164:167], a[164:167], a[52:55], v[164:167]
    ds_read_b64_tr_b16 a[134:135], v9 offset:4096
    v_mfma_f32_16x16x32_bf16 v[196:199], a[164:167], a[56:59], v[196:199]
    buffer_load_dwordx4 a[44:47], v24, s[56:59], s68 offen sc1
    v_mfma_f32_16x16x32_bf16 v[228:231], a[164:167], a[60:63], v[228:231]
    ds_read_b64_tr_b16 a[136:137], v10 offset:0
    s_waitcnt lgkmcnt(15)
    v_mfma_f32_16x16x32_bf16 v[136:139], a[168:171], a[48:51], v[136:139]
    ds_read_b64_tr_b16 a[138:139], v10 offset:4096
    s_add_u32 s68, s68, 16384
    v_mfma_f32_16x16x32_bf16 v[168:171], a[168:171], a[52:55], v[168:171]
    v_mfma_f32_16x16x32_bf16 v[200:203], a[168:171], a[56:59], v[200:203]
    ds_read_b64_tr_b16 a[140:141], v11 offset:0
    v_mfma_f32_16x16x32_bf16 v[232:235], a[168:171], a[60:63], v[232:235]
    ds_read_b64_tr_b16 a[142:143], v11 offset:4096
    s_mov_b32 s82, 655360
    s_add_u32 m0, s3, 147456
    s_waitcnt lgkmcnt(15)
    v_mfma_f32_16x16x32_bf16 v[140:143], a[172:175], a[48:51], v[140:143]
    buffer_load_dwordx4 v17, s[52:55], s82 offen lds
    v_mfma_f32_16x16x32_bf16 v[172:175], a[172:175], a[52:55], v[172:175]
    ds_read_b64_tr_b16 a[144:145], v12 offset:0
    v_mfma_f32_16x16x32_bf16 v[204:207], a[172:175], a[56:59], v[204:207]
    ds_read_b64_tr_b16 a[146:147], v12 offset:4096
    v_mfma_f32_16x16x32_bf16 v[236:239], a[172:175], a[60:63], v[236:239]
    s_waitcnt lgkmcnt(15)
    v_mfma_f32_16x16x32_bf16 v[144:147], a[176:179], a[48:51], v[144:147]
    ds_read_b64_tr_b16 a[148:149], v13 offset:0
    buffer_load_dwordx4 v18, s[52:55], s82 offen offset:1024 lds
    v_mfma_f32_16x16x32_bf16 v[176:179], a[176:179], a[52:55], v[176:179]
    ds_read_b64_tr_b16 a[150:151], v13 offset:4096
    v_mfma_f32_16x16x32_bf16 v[208:211], a[176:179], a[56:59], v[208:211]
    s_lshl_b32 s88, s62, 13
    v_mfma_f32_16x16x32_bf16 v[240:243], a[176:179], a[60:63], v[240:243]
    ds_read_b64_tr_b16 a[152:153], v14 offset:0
    v_add_u32 v48, s88, v48
    s_waitcnt lgkmcnt(15)
    v_mfma_f32_16x16x32_bf16 v[148:151], a[180:183], a[48:51], v[148:151]
    ds_read_b64_tr_b16 a[154:155], v14 offset:4096
    v_add_u32 v49, s88, v49
    v_mfma_f32_16x16x32_bf16 v[180:183], a[180:183], a[52:55], v[180:183]
    v_add_u32 v50, s88, v50
    v_mfma_f32_16x16x32_bf16 v[212:215], a[180:183], a[56:59], v[212:215]
    ds_read_b64_tr_b16 a[156:157], v15 offset:0
    v_add_u32 v51, s88, v51
    v_mfma_f32_16x16x32_bf16 v[244:247], a[180:183], a[60:63], v[244:247]
    ds_read_b64_tr_b16 a[158:159], v15 offset:4096
    v_add_u32 v52, s88, v52
    v_mfma_f32_16x16x32_bf16 v[152:155], a[184:187], a[48:51], v[152:155]
    v_add_u32 v53, s88, v53
    v_mfma_f32_16x16x32_bf16 v[184:187], a[184:187], a[52:55], v[184:187]
    v_add_u32 v54, s88, v54
    v_mfma_f32_16x16x32_bf16 v[216:219], a[184:187], a[56:59], v[216:219]
    v_add_u32 v55, s88, v55
    v_mfma_f32_16x16x32_bf16 v[248:251], a[184:187], a[60:63], v[248:251]
    s_lshl_b32 s84, s65, 3
    s_waitcnt lgkmcnt(15)
    v_mfma_f32_16x16x32_bf16 v[156:159], a[188:191], a[48:51], v[156:159]
    s_lshl_b32 s90, 1, s84
    v_mfma_f32_16x16x32_bf16 v[188:191], a[188:191], a[52:55], v[188:191]
    v_mov_b32 v25, s90
    v_mfma_f32_16x16x32_bf16 v[220:223], a[188:191], a[56:59], v[220:223]
    v_mfma_f32_16x16x32_bf16 v[252:255], a[188:191], a[60:63], v[252:255]
    s_waitcnt lgkmcnt(0)
    s_barrier
    s_waitcnt vmcnt(44)
    v_mfma_f32_16x16x32_bf16 v[128:131], a[128:131], a[64:67], v[128:131]
    buffer_load_dwordx4 a[48:51], v21, s[56:59], s68 offen sc1
    s_waitcnt vmcnt(44)
    v_mfma_f32_16x16x32_bf16 v[160:163], a[128:131], a[68:71], v[160:163]
    ds_read_b64_tr_b16 a[160:161], v8 offset:8192
    s_waitcnt vmcnt(43)
    v_mfma_f32_16x16x32_bf16 v[192:195], a[128:131], a[72:75], v[192:195]
    ds_read_b64_tr_b16 a[162:163], v8 offset:12288
    buffer_load_dwordx4 a[52:55], v22, s[56:59], s68 offen sc1
    s_waitcnt vmcnt(43)
    v_mfma_f32_16x16x32_bf16 v[224:227], a[128:131], a[76:79], v[224:227]
    v_mfma_f32_16x16x32_bf16 v[132:135], a[132:135], a[64:67], v[132:135]
    ds_read_b64_tr_b16 a[164:165], v9 offset:8192
    buffer_load_dwordx4 a[56:59], v23, s[56:59], s68 offen sc1
    v_mfma_f32_16x16x32_bf16 v[164:167], a[132:135], a[68:71], v[164:167]
    ds_read_b64_tr_b16 a[166:167], v9 offset:12288
    v_mfma_f32_16x16x32_bf16 v[196:199], a[132:135], a[72:75], v[196:199]
    buffer_load_dwordx4 a[60:63], v24, s[56:59], s68 offen sc1
    v_mfma_f32_16x16x32_bf16 v[228:231], a[132:135], a[76:79], v[228:231]
    ds_read_b64_tr_b16 a[168:169], v10 offset:8192
    v_mfma_f32_16x16x32_bf16 v[136:139], a[136:139], a[64:67], v[136:139]
    ds_read_b64_tr_b16 a[170:171], v10 offset:12288
    s_add_u32 s68, s68, 16384
    v_mfma_f32_16x16x32_bf16 v[168:171], a[136:139], a[68:71], v[168:171]
    v_mfma_f32_16x16x32_bf16 v[200:203], a[136:139], a[72:75], v[200:203]
    ds_read_b64_tr_b16 a[172:173], v11 offset:8192
    v_mfma_f32_16x16x32_bf16 v[232:235], a[136:139], a[76:79], v[232:235]
    ds_read_b64_tr_b16 a[174:175], v11 offset:12288
    s_mov_b32 s83, 720896
    s_add_u32 m0, s3, 155648
    v_mfma_f32_16x16x32_bf16 v[140:143], a[140:143], a[64:67], v[140:143]
    buffer_load_dwordx4 v17, s[52:55], s83 offen lds
    v_mfma_f32_16x16x32_bf16 v[172:175], a[140:143], a[68:71], v[172:175]
    ds_read_b64_tr_b16 a[176:177], v12 offset:8192
    v_mfma_f32_16x16x32_bf16 v[204:207], a[140:143], a[72:75], v[204:207]
    ds_read_b64_tr_b16 a[178:179], v12 offset:12288
    v_mfma_f32_16x16x32_bf16 v[236:239], a[140:143], a[76:79], v[236:239]
    v_mfma_f32_16x16x32_bf16 v[144:147], a[144:147], a[64:67], v[144:147]
    ds_read_b64_tr_b16 a[180:181], v13 offset:8192
    buffer_load_dwordx4 v18, s[52:55], s83 offen offset:1024 lds
    v_mfma_f32_16x16x32_bf16 v[176:179], a[144:147], a[68:71], v[176:179]
    ds_read_b64_tr_b16 a[182:183], v13 offset:12288
    v_mfma_f32_16x16x32_bf16 v[208:211], a[144:147], a[72:75], v[208:211]
    v_add_u32 v56, s88, v56
    v_mfma_f32_16x16x32_bf16 v[240:243], a[144:147], a[76:79], v[240:243]
    ds_read_b64_tr_b16 a[184:185], v14 offset:8192
    v_add_u32 v57, s88, v57
    v_mfma_f32_16x16x32_bf16 v[148:151], a[148:151], a[64:67], v[148:151]
    ds_read_b64_tr_b16 a[186:187], v14 offset:12288
    v_add_u32 v58, s88, v58
    v_mfma_f32_16x16x32_bf16 v[180:183], a[148:151], a[68:71], v[180:183]
    v_add_u32 v59, s88, v59
    v_mfma_f32_16x16x32_bf16 v[212:215], a[148:151], a[72:75], v[212:215]
    ds_read_b64_tr_b16 a[188:189], v15 offset:8192
    v_add_u32 v60, s88, v60
    v_mfma_f32_16x16x32_bf16 v[244:247], a[148:151], a[76:79], v[244:247]
    ds_read_b64_tr_b16 a[190:191], v15 offset:12288
    v_add_u32 v61, s88, v61
    v_mfma_f32_16x16x32_bf16 v[152:155], a[152:155], a[64:67], v[152:155]
    v_add_u32 v62, s88, v62
    v_mfma_f32_16x16x32_bf16 v[184:187], a[152:155], a[68:71], v[184:187]
    v_add_u32 v63, s88, v63
    v_mfma_f32_16x16x32_bf16 v[216:219], a[152:155], a[72:75], v[216:219]
    s_lshl_b32 s84, s60, 13
    v_mfma_f32_16x16x32_bf16 v[248:251], a[152:155], a[76:79], v[248:251]
    v_add_u32 v19, s84, v16
    v_mfma_f32_16x16x32_bf16 v[156:159], a[156:159], a[64:67], v[156:159]
    v_xor_b32 v20, 0x2000, v19
    v_mfma_f32_16x16x32_bf16 v[188:191], a[156:159], a[68:71], v[188:191]
    v_mfma_f32_16x16x32_bf16 v[220:223], a[156:159], a[72:75], v[220:223]
    v_mfma_f32_16x16x32_bf16 v[252:255], a[156:159], a[76:79], v[252:255]
    s_waitcnt vmcnt(43) lgkmcnt(14)
    v_mfma_f32_16x16x32_bf16 v[128:131], a[160:163], a[80:83], v[128:131]
    v_readfirstlane_b32 s86, v44
    s_cmp_eq_u32 s86, 64
    s_cbranch_scc0 L_spO
L_okO:
    s_add_u32 s89, s69, 24576
    s_waitcnt vmcnt(42)
    v_mfma_f32_16x16x32_bf16 v[160:163], a[160:163], a[84:87], v[160:163]
    ds_read_b64_tr_b16 a[128:129], v8 offset:16384
    s_waitcnt vmcnt(41)
    v_mfma_f32_16x16x32_bf16 v[192:195], a[160:163], a[88:91], v[192:195]
    ds_read_b64_tr_b16 a[130:131], v8 offset:20480
    s_waitcnt vmcnt(40)
    v_mfma_f32_16x16x32_bf16 v[224:227], a[160:163], a[92:95], v[224:227]
    buffer_load_dwordx4 a[64:67], v3, s[56:59], s69 offen offset:0 sc1
    s_waitcnt lgkmcnt(14)
    v_mfma_f32_16x16x32_bf16 v[132:135], a[164:167], a[80:83], v[132:135]
    ds_read_b64_tr_b16 a[132:133], v9 offset:16384
    v_mfma_f32_16x16x32_bf16 v[164:167], a[164:167], a[84:87], v[164:167]
    ds_read_b64_tr_b16 a[134:135], v9 offset:20480
    v_mfma_f32_16x16x32_bf16 v[196:199], a[164:167], a[88:91], v[196:199]
    buffer_load_dwordx4 a[68:71], v4, s[56:59], s69 offen offset:0 sc1
    v_mfma_f32_16x16x32_bf16 v[228:231], a[164:167], a[92:95], v[228:231]
    ds_read_b64_tr_b16 a[136:137], v10 offset:16384
    s_waitcnt lgkmcnt(15)
    v_mfma_f32_16x16x32_bf16 v[136:139], a[168:171], a[80:83], v[136:139]
    ds_read_b64_tr_b16 a[138:139], v10 offset:20480
    v_mfma_f32_16x16x32_bf16 v[168:171], a[168:171], a[84:87], v[168:171]
    buffer_load_dwordx4 a[72:75], v3, s[56:59], s69 offen offset:2048 sc1
    v_mfma_f32_16x16x32_bf16 v[200:203], a[168:171], a[88:91], v[200:203]
    ds_read_b64_tr_b16 a[140:141], v11 offset:16384
    v_mfma_f32_16x16x32_bf16 v[232:235], a[168:171], a[92:95], v[232:235]
    ds_read_b64_tr_b16 a[142:143], v11 offset:20480
    s_mov_b32 s82, 786432
    s_add_u32 m0, s3, 0
    s_waitcnt lgkmcnt(15)
    v_mfma_f32_16x16x32_bf16 v[140:143], a[172:175], a[80:83], v[140:143]
    buffer_load_dwordx4 a[76:79], v4, s[56:59], s69 offen offset:2048 sc1
    buffer_load_dwordx4 v17, s[52:55], s82 offen lds
    v_mfma_f32_16x16x32_bf16 v[172:175], a[172:175], a[84:87], v[172:175]
    ds_read_b64_tr_b16 a[144:145], v12 offset:16384
    v_mfma_f32_16x16x32_bf16 v[204:207], a[172:175], a[88:91], v[204:207]
    ds_read_b64_tr_b16 a[146:147], v12 offset:20480
    v_mfma_f32_16x16x32_bf16 v[236:239], a[172:175], a[92:95], v[236:239]
    s_add_u32 s69, s69, 4096
    s_waitcnt lgkmcnt(15)
    v_mfma_f32_16x16x32_bf16 v[144:147], a[176:179], a[80:83], v[144:147]
    ds_read_b64_tr_b16 a[148:149], v13 offset:16384
    buffer_load_dwordx4 v18, s[52:55], s82 offen offset:1024 lds
    v_mfma_f32_16x16x32_bf16 v[176:179], a[176:179], a[84:87], v[176:179]
    ds_read_b64_tr_b16 a[150:151], v13 offset:20480
    v_mfma_f32_16x16x32_bf16 v[208:211], a[176:179], a[88:91], v[208:211]
    buffer_load_dwordx4 a[224:227], v3, s[56:59], s89 offen offset:0 sc1
    v_mfma_f32_16x16x32_bf16 v[240:243], a[176:179], a[92:95], v[240:243]
    ds_read_b64_tr_b16 a[152:153], v14 offset:16384
    s_waitcnt lgkmcnt(15)
    v_mfma_f32_16x16x32_bf16 v[148:151], a[180:183], a[80:83], v[148:151]
    ds_read_b64_tr_b16 a[154:155], v14 offset:20480
    v_mfma_f32_16x16x32_bf16 v[180:183], a[180:183], a[84:87], v[180:183]
    buffer_load_dwordx4 a[228:231], v4, s[56:59], s89 offen offset:0 sc1
    v_mfma_f32_16x16x32_bf16 v[212:215], a[180:183], a[88:91], v[212:215]
    ds_read_b64_tr_b16 a[156:157], v15 offset:16384
    v_mfma_f32_16x16x32_bf16 v[244:247], a[180:183], a[92:95], v[244:247]
    ds_read_b64_tr_b16 a[158:159], v15 offset:20480
    v_mfma_f32_16x16x32_bf16 v[152:155], a[184:187], a[80:83], v[152:155]
    v_mfma_f32_16x16x32_bf16 v[184:187], a[184:187], a[84:87], v[184:187]
    v_mfma_f32_16x16x32_bf16 v[216:219], a[184:187], a[88:91], v[216:219]
    v_mfma_f32_16x16x32_bf16 v[248:251], a[184:187], a[92:95], v[248:251]
    s_waitcnt lgkmcnt(15)
    v_mfma_f32_16x16x32_bf16 v[156:159], a[188:191], a[80:83], v[156:159]
    v_mfma_f32_16x16x32_bf16 v[188:191], a[188:191], a[84:87], v[188:191]
    v_mfma_f32_16x16x32_bf16 v[220:223], a[188:191], a[88:91], v[220:223]
    v_mfma_f32_16x16x32_bf16 v[252:255], a[188:191], a[92:95], v[252:255]
    s_waitcnt lgkmcnt(0)
    s_barrier
    s_waitcnt vmcnt(43)
    v_mfma_f32_16x16x32_bf16 v[128:131], a[128:131], a[96:99], v[128:131]
    buffer_load_dwordx4 a[80:83], v3, s[56:59], s69 offen offset:0 sc1
    s_waitcnt vmcnt(43)
    v_mfma_f32_16x16x32_bf16 v[160:163], a[128:131], a[100:103], v[160:163]
    ds_read_b64_tr_b16 a[160:161], v8 offset:24576
    s_waitcnt vmcnt(42)
    v_mfma_f32_16x16x32_bf16 v[192:195], a[128:131], a[104:107], v[192:195]
    ds_read_b64_tr_b16 a[162:163], v8 offset:28672
    s_waitcnt vmcnt(41)
    v_mfma_f32_16x16x32_bf16 v[224:227], a[128:131], a[108:111], v[224:227]
    buffer_load_dwordx4 a[84:87], v4, s[56:59], s69 offen offset:0 sc1
    v_mfma_f32_16x16x32_bf16 v[132:135], a[132:135], a[96:99], v[132:135]
    ds_read_b64_tr_b16 a[164:165], v9 offset:24576
    v_mfma_f32_16x16x32_bf16 v[164:167], a[132:135], a[100:103], v[164:167]
    ds_read_b64_tr_b16 a[166:167], v9 offset:28672
    v_mfma_f32_16x16x32_bf16 v[196:199], a[132:135], a[104:107], v[196:199]
    buffer_load_dwordx4 a[88:91], v3, s[56:59], s69 offen offset:2048 sc1
    v_mfma_f32_16x16x32_bf16 v[228:231], a[132:135], a[108:111], v[228:231]
    ds_read_b64_tr_b16 a[168:169], v10 offset:24576
    v_mfma_f32_16x16x32_bf16 v[136:139], a[136:139], a[96:99], v[136:139]
    ds_read_b64_tr_b16 a[170:171], v10 offset:28672
    v_mfma_f32_16x16x32_bf16 v[168:171], a[136:139], a[100:103], v[168:171]
    buffer_load_dwordx4 a[92:95], v4, s[56:59], s69 offen offset:2048 sc1
    v_mfma_f32_16x16x32_bf16 v[200:203], a[136:139], a[104:107], v[200:203]
    ds_read_b64_tr_b16 a[172:173], v11 offset:24576
    v_mfma_f32_16x16x32_bf16 v[232:235], a[136:139], a[108:111], v[232:235]
    ds_read_b64_tr_b16 a[174:175], v11 offset:28672
    s_mov_b32 s83, 851968
    s_add_u32 m0, s3, 8192
    v_mfma_f32_16x16x32_bf16 v[140:143], a[140:143], a[96:99], v[140:143]
    s_add_u32 s69, s69, 4096
    buffer_load_dwordx4 v17, s[52:55], s83 offen lds
    v_mfma_f32_16x16x32_bf16 v[172:175], a[140:143], a[100:103], v[172:175]
    ds_read_b64_tr_b16 a[176:177], v12 offset:24576
    v_mfma_f32_16x16x32_bf16 v[204:207], a[140:143], a[104:107], v[204:207]
    ds_read_b64_tr_b16 a[178:179], v12 offset:28672
    v_mfma_f32_16x16x32_bf16 v[236:239], a[140:143], a[108:111], v[236:239]
    buffer_load_dwordx4 a[232:235], v3, s[56:59], s89 offen offset:2048 sc1
    v_mfma_f32_16x16x32_bf16 v[144:147], a[144:147], a[96:99], v[144:147]
    ds_read_b64_tr_b16 a[180:181], v13 offset:24576
    buffer_load_dwordx4 v18, s[52:55], s83 offen offset:1024 lds
    v_mfma_f32_16x16x32_bf16 v[176:179], a[144:147], a[100:103], v[176:179]
    ds_read_b64_tr_b16 a[182:183], v13 offset:28672
    v_mfma_f32_16x16x32_bf16 v[208:211], a[144:147], a[104:107], v[208:211]
    v_mfma_f32_16x16x32_bf16 v[240:243], a[144:147], a[108:111], v[240:243]
    ds_read_b64_tr_b16 a[184:185], v14 offset:24576
    v_mfma_f32_16x16x32_bf16 v[148:151], a[148:151], a[96:99], v[148:151]
    ds_read_b64_tr_b16 a[186:187], v14 offset:28672
    v_mfma_f32_16x16x32_bf16 v[180:183], a[148:151], a[100:103], v[180:183]
    v_mfma_f32_16x16x32_bf16 v[212:215], a[148:151], a[104:107], v[212:215]
    ds_read_b64_tr_b16 a[188:189], v15 offset:24576
    v_mfma_f32_16x16x32_bf16 v[244:247], a[148:151], a[108:111], v[244:247]
    ds_read_b64_tr_b16 a[190:191], v15 offset:28672
    v_mfma_f32_16x16x32_bf16 v[152:155], a[152:155], a[96:99], v[152:155]
    v_mfma_f32_16x16x32_bf16 v[184:187], a[152:155], a[100:103], v[184:187]
    v_mfma_f32_16x16x32_bf16 v[216:219], a[152:155], a[104:107], v[216:219]
    v_mfma_f32_16x16x32_bf16 v[248:251], a[152:155], a[108:111], v[248:251]
    v_mfma_f32_16x16x32_bf16 v[156:159], a[156:159], a[96:99], v[156:159]
    v_mfma_f32_16x16x32_bf16 v[188:191], a[156:159], a[100:103], v[188:191]
    v_mfma_f32_16x16x32_bf16 v[220:223], a[156:159], a[104:107], v[220:223]
    v_mfma_f32_16x16x32_bf16 v[252:255], a[156:159], a[108:111], v[252:255]
    s_waitcnt vmcnt(44) lgkmcnt(14)
    v_mfma_f32_16x16x32_bf16 v[128:131], a[160:163], a[112:115], v[128:131]
    buffer_load_dwordx4 a[96:99], v3, s[56:59], s69 offen offset:0 sc1
    s_waitcnt vmcnt(44)
    v_mfma_f32_16x16x32_bf16 v[160:163], a[160:163], a[116:119], v[160:163]
    ds_read_b64_tr_b16 a[128:129], v8 offset:32768
    s_waitcnt vmcnt(43)
    v_mfma_f32_16x16x32_bf16 v[192:195], a[160:163], a[120:123], v[192:195]
    ds_read_b64_tr_b16 a[130:131], v8 offset:36864
    s_waitcnt vmcnt(42)
    v_mfma_f32_16x16x32_bf16 v[224:227], a[160:163], a[124:127], v[224:227]
    buffer_load_dwordx4 a[100:103], v4, s[56:59], s69 offen offset:0 sc1
    s_waitcnt lgkmcnt(14)
    v_mfma_f32_16x16x32_bf16 v[132:135], a[164:167], a[112:115], v[132:135]
    ds_read_b64_tr_b16 a[132:133], v9 offset:32768
    v_mfma_f32_16x16x32_bf16 v[164:167], a[164:167], a[116:119], v[164:167]
    ds_read_b64_tr_b16 a[134:135], v9 offset:36864
    v_mfma_f32_16x16x32_bf16 v[196:199], a[164:167], a[120:123], v[196:199]
    buffer_load_dwordx4 a[104:107], v3, s[56:59], s69 offen offset:2048 sc1
    v_mfma_f32_16x16x32_bf16 v[228:231], a[164:167], a[124:127], v[228:231]
    ds_read_b64_tr_b16 a[136:137], v10 offset:32768
    s_waitcnt lgkmcnt(15)
    v_mfma_f32_16x16x32_bf16 v[136:139], a[168:171], a[112:115], v[136:139]
    ds_read_b64_tr_b16 a[138:139], v10 offset:36864
    v_mfma_f32_16x16x32_bf16 v[168:171], a[168:171], a[116:119], v[168:171]
    buffer_load_dwordx4 a[108:111], v4, s[56:59], s69 offen offset:2048 sc1
    v_mfma_f32_16x16x32_bf16 v[200:203], a[168:171], a[120:123], v[200:203]
    ds_read_b64_tr_b16 a[140:141], v11 offset:32768
    v_mfma_f32_16x16x32_bf16 v[232:235], a[168:171], a[124:127], v[232:235]
    ds_read_b64_tr_b16 a[142:143], v11 offset:36864
    s_mov_b32 s82, 917504
    s_add_u32 m0, s3, 16384
    s_waitcnt lgkmcnt(15)
    v_mfma_f32_16x16x32_bf16 v[140:143], a[172:175], a[112:115], v[140:143]
    s_add_u32 s69, s69, 4096
    buffer_load_dwordx4 v17, s[52:55], s82 offen lds
    v_mfma_f32_16x16x32_bf16 v[172:175], a[172:175], a[116:119], v[172:175]
    ds_read_b64_tr_b16 a[144:145], v12 offset:32768
    v_mfma_f32_16x16x32_bf16 v[204:207], a[172:175], a[120:123], v[204:207]
    ds_read_b64_tr_b16 a[146:147], v12 offset:36864
    v_mfma_f32_16x16x32_bf16 v[236:239], a[172:175], a[124:127], v[236:239]
    buffer_load_dwordx4 a[236:239], v4, s[56:59], s89 offen offset:2048 sc1
    s_waitcnt lgkmcnt(15)
    v_mfma_f32_16x16x32_bf16 v[144:147], a[176:179], a[112:115], v[144:147]
    ds_read_b64_tr_b16 a[148:149], v13 offset:32768
    buffer_load_dwordx4 v18, s[52:55], s82 offen offset:1024 lds
    v_mfma_f32_16x16x32_bf16 v[176:179], a[176:179], a[116:119], v[176:179]
    ds_read_b64_tr_b16 a[150:151], v13 offset:36864
    v_mfma_f32_16x16x32_bf16 v[208:211], a[176:179], a[120:123], v[208:211]
    s_add_u32 s89, s89, 4096
    v_mfma_f32_16x16x32_bf16 v[240:243], a[176:179], a[124:127], v[240:243]
    ds_read_b64_tr_b16 a[152:153], v14 offset:32768
    s_waitcnt lgkmcnt(15)
    v_mfma_f32_16x16x32_bf16 v[148:151], a[180:183], a[112:115], v[148:151]
    ds_read_b64_tr_b16 a[154:155], v14 offset:36864
    v_mfma_f32_16x16x32_bf16 v[180:183], a[180:183], a[116:119], v[180:183]
    v_mfma_f32_16x16x32_bf16 v[212:215], a[180:183], a[120:123], v[212:215]
    ds_read_b64_tr_b16 a[156:157], v15 offset:32768
    v_mfma_f32_16x16x32_bf16 v[244:247], a[180:183], a[124:127], v[244:247]
    ds_read_b64_tr_b16 a[158:159], v15 offset:36864
    v_mfma_f32_16x16x32_bf16 v[152:155], a[184:187], a[112:115], v[152:155]
    v_mfma_f32_16x16x32_bf16 v[184:187], a[184:187], a[116:119], v[184:187]
    v_mfma_f32_16x16x32_bf16 v[216:219], a[184:187], a[120:123], v[216:219]
    v_mfma_f32_16x16x32_bf16 v[248:251], a[184:187], a[124:127], v[248:251]
    s_waitcnt lgkmcnt(15)
    v_mfma_f32_16x16x32_bf16 v[156:159], a[188:191], a[112:115], v[156:159]
    v_mfma_f32_16x16x32_bf16 v[188:191], a[188:191], a[116:119], v[188:191]
    v_mfma_f32_16x16x32_bf16 v[220:223], a[188:191], a[120:123], v[220:223]
    v_mfma_f32_16x16x32_bf16 v[252:255], a[188:191], a[124:127], v[252:255]
    s_waitcnt lgkmcnt(0)
    s_barrier
    s_waitcnt vmcnt(45)
    v_mfma_f32_16x16x32_bf16 v[128:131], a[128:131], a[0:3], v[128:131]
    buffer_load_dwordx4 a[112:115], v3, s[56:59], s69 offen offset:0 sc1
    s_waitcnt vmcnt(45)
    v_mfma_f32_16x16x32_bf16 v[160:163], a[128:131], a[4:7], v[160:163]
    ds_read_b64_tr_b16 a[160:161], v8 offset:40960
    s_waitcnt vmcnt(44)
    v_mfma_f32_16x16x32_bf16 v[192:195], a[128:131], a[8:11], v[192:195]
    ds_read_b64_tr_b16 a[162:163], v8 offset:45056
    s_waitcnt vmcnt(43)
    v_mfma_f32_16x16x32_bf16 v[224:227], a[128:131], a[12:15], v[224:227]
    buffer_load_dwordx4 a[116:119], v4, s[56:59], s69 offen offset:0 sc1
    v_mfma_f32_16x16x32_bf16 v[132:135], a[132:135], a[0:3], v[132:135]
    ds_read_b64_tr_b16 a[164:165], v9 offset:40960
    v_mfma_f32_16x16x32_bf16 v[164:167], a[132:135], a[4:7], v[164:167]
    ds_read_b64_tr_b16 a[166:167], v9 offset:45056
    v_mfma_f32_16x16x32_bf16 v[196:199], a[132:135], a[8:11], v[196:199]
    buffer_load_dwordx4 a[120:123], v3, s[56:59], s69 offen offset:2048 sc1
    v_mfma_f32_16x16x32_bf16 v[228:231], a[132:135], a[12:15], v[228:231]
    ds_read_b64_tr_b16 a[168:169], v10 offset:40960
    v_mfma_f32_16x16x32_bf16 v[136:139], a[136:139], a[0:3], v[136:139]
    ds_read_b64_tr_b16 a[170:171], v10 offset:45056
    v_mfma_f32_16x16x32_bf16 v[168:171], a[136:139], a[4:7], v[168:171]
    buffer_load_dwordx4 a[124:127], v4, s[56:59], s69 offen offset:2048 sc1
    v_mfma_f32_16x16x32_bf16 v[200:203], a[136:139], a[8:11], v[200:203]
    ds_read_b64_tr_b16 a[172:173], v11 offset:40960
    v_mfma_f32_16x16x32_bf16 v[232:235], a[136:139], a[12:15], v[232:235]
    ds_read_b64_tr_b16 a[174:175], v11 offset:45056
    s_mov_b32 s83, 983040
    s_add_u32 m0, s3, 24576
    v_mfma_f32_16x16x32_bf16 v[140:143], a[140:143], a[0:3], v[140:143]
    s_add_u32 s69, s69, 4096
    buffer_load_dwordx4 v17, s[52:55], s83 offen lds
    v_mfma_f32_16x16x32_bf16 v[172:175], a[140:143], a[4:7], v[172:175]
    ds_read_b64_tr_b16 a[176:177], v12 offset:40960
    v_mfma_f32_16x16x32_bf16 v[204:207], a[140:143], a[8:11], v[204:207]
    ds_read_b64_tr_b16 a[178:179], v12 offset:45056
    v_mfma_f32_16x16x32_bf16 v[236:239], a[140:143], a[12:15], v[236:239]
    buffer_load_dwordx4 a[240:243], v3, s[56:59], s89 offen offset:0 sc1
    v_mfma_f32_16x16x32_bf16 v[144:147], a[144:147], a[0:3], v[144:147]
    ds_read_b64_tr_b16 a[180:181], v13 offset:40960
    buffer_load_dwordx4 v18, s[52:55], s83 offen offset:1024 lds
    v_mfma_f32_16x16x32_bf16 v[176:179], a[144:147], a[4:7], v[176:179]
    ds_read_b64_tr_b16 a[182:183], v13 offset:45056
    v_mfma_f32_16x16x32_bf16 v[208:211], a[144:147], a[8:11], v[208:211]
    buffer_load_dwordx4 a[244:247], v4, s[56:59], s89 offen offset:0 sc1
    v_mfma_f32_16x16x32_bf16 v[240:243], a[144:147], a[12:15], v[240:243]
    ds_read_b64_tr_b16 a[184:185], v14 offset:40960
    v_mfma_f32_16x16x32_bf16 v[148:151], a[148:151], a[0:3], v[148:151]
    ds_read_b64_tr_b16 a[186:187], v14 offset:45056
    v_mfma_f32_16x16x32_bf16 v[180:183], a[148:151], a[4:7], v[180:183]
    v_mfma_f32_16x16x32_bf16 v[212:215], a[148:151], a[8:11], v[212:215]
    ds_read_b64_tr_b16 a[188:189], v15 offset:40960
    v_mfma_f32_16x16x32_bf16 v[244:247], a[148:151], a[12:15], v[244:247]
    ds_read_b64_tr_b16 a[190:191], v15 offset:45056
    v_mfma_f32_16x16x32_bf16 v[152:155], a[152:155], a[0:3], v[152:155]
    v_mfma_f32_16x16x32_bf16 v[184:187], a[152:155], a[4:7], v[184:187]
    v_mfma_f32_16x16x32_bf16 v[216:219], a[152:155], a[8:11], v[216:219]
    v_mfma_f32_16x16x32_bf16 v[248:251], a[152:155], a[12:15], v[248:251]
    v_mfma_f32_16x16x32_bf16 v[156:159], a[156:159], a[0:3], v[156:159]
    v_mfma_f32_16x16x32_bf16 v[188:191], a[156:159], a[4:7], v[188:191]
    v_mfma_f32_16x16x32_bf16 v[220:223], a[156:159], a[8:11], v[220:223]
    v_mfma_f32_16x16x32_bf16 v[252:255], a[156:159], a[12:15], v[252:255]
    s_waitcnt vmcnt(47) lgkmcnt(14)
    v_mfma_f32_16x16x32_bf16 v[128:131], a[160:163], a[16:19], v[128:131]
    buffer_load_dwordx4 a[0:3], v3, s[56:59], s69 offen offset:0 sc1
    s_waitcnt vmcnt(47)
    v_mfma_f32_16x16x32_bf16 v[160:163], a[160:163], a[20:23], v[160:163]
    ds_read_b64_tr_b16 a[128:129], v8 offset:49152
    s_waitcnt vmcnt(46)
    v_mfma_f32_16x16x32_bf16 v[192:195], a[160:163], a[24:27], v[192:195]
    ds_read_b64_tr_b16 a[130:131], v8 offset:53248
    s_waitcnt vmcnt(45)
    v_mfma_f32_16x16x32_bf16 v[224:227], a[160:163], a[28:31], v[224:227]
    buffer_load_dwordx4 a[4:7], v4, s[56:59], s69 offen offset:0 sc1
    s_waitcnt lgkmcnt(14)
    v_mfma_f32_16x16x32_bf16 v[132:135], a[164:167], a[16:19], v[132:135]
    ds_read_b64_tr_b16 a[132:133], v9 offset:49152
    v_mfma_f32_16x16x32_bf16 v[164:167], a[164:167], a[20:23], v[164:167]
    ds_read_b64_tr_b16 a[134:135], v9 offset:53248
    v_mfma_f32_16x16x32_bf16 v[196:199], a[164:167], a[24:27], v[196:199]
    buffer_load_dwordx4 a[8:11], v3, s[56:59], s69 offen offset:2048 sc1
    v_mfma_f32_16x16x32_bf16 v[228:231], a[164:167], a[28:31], v[228:231]
    ds_read_b64_tr_b16 a[136:137], v10 offset:49152
    s_waitcnt lgkmcnt(15)
    v_mfma_f32_16x16x32_bf16 v[136:139], a[168:171], a[16:19], v[136:139]
    ds_read_b64_tr_b16 a[138:139], v10 offset:53248
    v_mfma_f32_16x16x32_bf16 v[168:171], a[168:171], a[20:23], v[168:171]
    buffer_load_dwordx4 a[12:15], v4, s[56:59], s69 offen offset:2048 sc1
    v_mfma_f32_16x16x32_bf16 v[200:203], a[168:171], a[24:27], v[200:203]
    ds_read_b64_tr_b16 a[140:141], v11 offset:49152
    v_mfma_f32_16x16x32_bf16 v[232:235], a[168:171], a[28:31], v[232:235]
    ds_read_b64_tr_b16 a[142:143], v11 offset:53248
    s_mov_b32 s82, 1048576
    s_add_u32 m0, s3, 32768
    s_waitcnt lgkmcnt(15)
    v_mfma_f32_16x16x32_bf16 v[140:143], a[172:175], a[16:19], v[140:143]
    s_add_u32 s69, s69, 4096
    buffer_load_dwordx4 v17, s[52:55], s82 offen lds
    v_mfma_f32_16x16x32_bf16 v[172:175], a[172:175], a[20:23], v[172:175]
    ds_read_b64_tr_b16 a[144:145], v12 offset:49152
    v_mfma_f32_16x16x32_bf16 v[204:207], a[172:175], a[24:27], v[204:207]
    ds_read_b64_tr_b16 a[146:147], v12 offset:53248
    v_mfma_f32_16x16x32_bf16 v[236:239], a[172:175], a[28:31], v[236:239]
    buffer_load_dwordx4 a[248:251], v3, s[56:59], s89 offen offset:2048 sc1
    s_waitcnt lgkmcnt(15)
    v_mfma_f32_16x16x32_bf16 v[144:147], a[176:179], a[16:19], v[144:147]
    ds_read_b64_tr_b16 a[148:149], v13 offset:49152
    buffer_load_dwordx4 v18, s[52:55], s82 offen offset:1024 lds
    v_mfma_f32_16x16x32_bf16 v[176:179], a[176:179], a[20:23], v[176:179]
    ds_read_b64_tr_b16 a[150:151], v13 offset:53248
    v_mfma_f32_16x16x32_bf16 v[208:211], a[176:179], a[24:27], v[208:211]
    v_mfma_f32_16x16x32_bf16 v[240:243], a[176:179], a[28:31], v[240:243]
    ds_read_b64_tr_b16 a[152:153], v14 offset:49152
    s_waitcnt lgkmcnt(15)
    v_mfma_f32_16x16x32_bf16 v[148:151], a[180:183], a[16:19], v[148:151]
    ds_read_b64_tr_b16 a[154:155], v14 offset:53248
    v_mfma_f32_16x16x32_bf16 v[180:183], a[180:183], a[20:23], v[180:183]
    v_mfma_f32_16x16x32_bf16 v[212:215], a[180:183], a[24:27], v[212:215]
    ds_read_b64_tr_b16 a[156:157], v15 offset:49152
    v_mfma_f32_16x16x32_bf16 v[244:247], a[180:183], a[28:31], v[244:247]
    ds_read_b64_tr_b16 a[158:159], v15 offset:53248
    v_mfma_f32_16x16x32_bf16 v[152:155], a[184:187], a[16:19], v[152:155]
    v_mfma_f32_16x16x32_bf16 v[184:187], a[184:187], a[20:23], v[184:187]
    v_mfma_f32_16x16x32_bf16 v[216:219], a[184:187], a[24:27], v[216:219]
    v_mfma_f32_16x16x32_bf16 v[248:251], a[184:187], a[28:31], v[248:251]
    s_waitcnt lgkmcnt(15)
    v_mfma_f32_16x16x32_bf16 v[156:159], a[188:191], a[16:19], v[156:159]
    v_mfma_f32_16x16x32_bf16 v[188:191], a[188:191], a[20:23], v[188:191]
    v_mfma_f32_16x16x32_bf16 v[220:223], a[188:191], a[24:27], v[220:223]
    v_mfma_f32_16x16x32_bf16 v[252:255], a[188:191], a[28:31], v[252:255]
    s_waitcnt lgkmcnt(0)
    s_barrier
    s_waitcnt vmcnt(48)
    v_mfma_f32_16x16x32_bf16 v[128:131], a[128:131], a[32:35], v[128:131]
    buffer_load_dwordx4 a[16:19], v3, s[56:59], s69 offen offset:0 sc1
    s_waitcnt vmcnt(48)
    v_mfma_f32_16x16x32_bf16 v[160:163], a[128:131], a[36:39], v[160:163]
    ds_read_b64_tr_b16 a[160:161], v8 offset:57344
    s_waitcnt vmcnt(47)
    v_mfma_f32_16x16x32_bf16 v[192:195], a[128:131], a[40:43], v[192:195]
    ds_read_b64_tr_b16 a[162:163], v8 offset:61440
    s_waitcnt vmcnt(46)
    v_mfma_f32_16x16x32_bf16 v[224:227], a[128:131], a[44:47], v[224:227]
    buffer_load_dwordx4 a[20:23], v4, s[56:59], s69 offen offset:0 sc1
    v_mfma_f32_16x16x32_bf16 v[132:135], a[132:135], a[32:35], v[132:135]
    ds_read_b64_tr_b16 a[164:165], v9 offset:57344
    v_mfma_f32_16x16x32_bf16 v[164:167], a[132:135], a[36:39], v[164:167]
    ds_read_b64_tr_b16 a[166:167], v9 offset:61440
    v_mfma_f32_16x16x32_bf16 v[196:199], a[132:135], a[40:43], v[196:199]
    buffer_load_dwordx4 a[24:27], v3, s[56:59], s69 offen offset:2048 sc1
    v_mfma_f32_16x16x32_bf16 v[228:231], a[132:135], a[44:47], v[228:231]
    ds_read_b64_tr_b16 a[168:169], v10 offset:57344
    v_mfma_f32_16x16x32_bf16 v[136:139], a[136:139], a[32:35], v[136:139]
    ds_read_b64_tr_b16 a[170:171], v10 offset:61440
    v_mfma_f32_16x16x32_bf16 v[168:171], a[136:139], a[36:39], v[168:171]
    buffer_load_dwordx4 a[28:31], v4, s[56:59], s69 offen offset:2048 sc1
    v_mfma_f32_16x16x32_bf16 v[200:203], a[136:139], a[40:43], v[200:203]
    ds_read_b64_tr_b16 a[172:173], v11 offset:57344
    v_mfma_f32_16x16x32_bf16 v[232:235], a[136:139], a[44:47], v[232:235]
    ds_read_b64_tr_b16 a[174:175], v11 offset:61440
    s_mov_b32 s83, 1114112
    s_add_u32 m0, s3, 40960
    v_mfma_f32_16x16x32_bf16 v[140:143], a[140:143], a[32:35], v[140:143]
    s_add_u32 s69, s69, 4096
    buffer_load_dwordx4 v17, s[52:55], s83 offen lds
    v_mfma_f32_16x16x32_bf16 v[172:175], a[140:143], a[36:39], v[172:175]
    ds_read_b64_tr_b16 a[176:177], v12 offset:57344
    v_mfma_f32_16x16x32_bf16 v[204:207], a[140:143], a[40:43], v[204:207]
    ds_read_b64_tr_b16 a[178:179], v12 offset:61440
    s_branch L_over11
L_stub11:
    s_branch L_stubret
L_over11:
    v_mfma_f32_16x16x32_bf16 v[236:239], a[140:143], a[44:47], v[236:239]
    buffer_load_dwordx4 a[252:255], v4, s[56:59], s89 offen offset:2048 sc1
    v_mfma_f32_16x16x32_bf16 v[144:147], a[144:147], a[32:35], v[144:147]
    ds_read_b64_tr_b16 a[180:181], v13 offset:57344
    buffer_load_dwordx4 v18, s[52:55], s83 offen offset:1024 lds
    v_mfma_f32_16x16x32_bf16 v[176:179], a[144:147], a[36:39], v[176:179]
    ds_read_b64_tr_b16 a[182:183], v13 offset:61440
    v_mfma_f32_16x16x32_bf16 v[208:211], a[144:147], a[40:43], v[208:211]
    s_add_u32 s89, s89, 4096
    v_mfma_f32_16x16x32_bf16 v[240:243], a[144:147], a[44:47], v[240:243]
    ds_read_b64_tr_b16 a[184:185], v14 offset:57344
    v_mfma_f32_16x16x32_bf16 v[148:151], a[148:151], a[32:35], v[148:151]
    ds_read_b64_tr_b16 a[186:187], v14 offset:61440
    v_mfma_f32_16x16x32_bf16 v[180:183], a[148:151], a[36:39], v[180:183]
    s_mov_b32 s82, 1179648
    s_add_u32 m0, s3, 49152
    v_mfma_f32_16x16x32_bf16 v[212:215], a[148:151], a[40:43], v[212:215]
    ds_read_b64_tr_b16 a[188:189], v15 offset:57344
    buffer_load_dwordx4 v17, s[52:55], s82 offen lds
    v_mfma_f32_16x16x32_bf16 v[244:247], a[148:151], a[44:47], v[244:247]
    ds_read_b64_tr_b16 a[190:191], v15 offset:61440
    v_mfma_f32_16x16x32_bf16 v[152:155], a[152:155], a[32:35], v[152:155]
    v_mfma_f32_16x16x32_bf16 v[184:187], a[152:155], a[36:39], v[184:187]
    v_mfma_f32_16x16x32_bf16 v[216:219], a[152:155], a[40:43], v[216:219]
    buffer_load_dwordx4 v18, s[52:55], s82 offen offset:1024 lds
    v_mfma_f32_16x16x32_bf16 v[248:251], a[152:155], a[44:47], v[248:251]
    v_mfma_f32_16x16x32_bf16 v[156:159], a[156:159], a[32:35], v[156:159]
    v_mfma_f32_16x16x32_bf16 v[188:191], a[156:159], a[36:39], v[188:191]
    v_mfma_f32_16x16x32_bf16 v[220:223], a[156:159], a[40:43], v[220:223]
    v_mfma_f32_16x16x32_bf16 v[252:255], a[156:159], a[44:47], v[252:255]
    s_waitcnt lgkmcnt(0)
    s_barrier
    s_waitcnt vmcnt(50)
    v_mfma_f32_16x16x32_bf16 v[160:163], a[160:163], a[52:55], v[160:163]
    s_mov_b32 s83, 1245184
    s_add_u32 m0, s3, 57344
    v_mfma_f32_16x16x32_bf16 v[164:167], a[164:167], a[52:55], v[164:167]
    ds_read_b64_tr_b16 a[128:129], v48 offset:0
    buffer_load_dwordx4 v17, s[52:55], s83 offen lds
    v_mfma_f32_16x16x32_bf16 v[168:171], a[168:171], a[52:55], v[168:171]
    ds_read_b64_tr_b16 a[130:131], v48 offset:4096
    v_mfma_f32_16x16x32_bf16 v[172:175], a[172:175], a[52:55], v[172:175]
    ds_read_b64_tr_b16 a[132:133], v49 offset:0
    v_mfma_f32_16x16x32_bf16 v[176:179], a[176:179], a[52:55], v[176:179]
    ds_read_b64_tr_b16 a[134:135], v49 offset:4096
    v_mfma_f32_16x16x32_bf16 v[180:183], a[180:183], a[52:55], v[180:183]
    ds_read_b64_tr_b16 a[136:137], v50 offset:0
    buffer_load_dwordx4 v18, s[52:55], s83 offen offset:1024 lds
    v_mfma_f32_16x16x32_bf16 v[184:187], a[184:187], a[52:55], v[184:187]
    ds_read_b64_tr_b16 a[138:139], v50 offset:4096
    v_mfma_f32_16x16x32_bf16 v[188:191], a[188:191], a[52:55], v[188:191]
    ds_read_b64_tr_b16 a[140:141], v51 offset:0
    s_waitcnt vmcnt(51)
    v_mfma_f32_16x16x32_bf16 v[192:195], a[160:163], a[56:59], v[192:195]
    ds_read_b64_tr_b16 a[142:143], v51 offset:4096
    v_mfma_f32_16x16x32_bf16 v[196:199], a[164:167], a[56:59], v[196:199]
    ds_read_b64_tr_b16 a[144:145], v52 offset:0
    v_mfma_f32_16x16x32_bf16 v[200:203], a[168:171], a[56:59], v[200:203]
    ds_read_b64_tr_b16 a[146:147], v52 offset:4096
    v_mfma_f32_16x16x32_bf16 v[204:207], a[172:175], a[56:59], v[204:207]
    ds_read_b64_tr_b16 a[148:149], v53 offset:0
    v_mfma_f32_16x16x32_bf16 v[208:211], a[176:179], a[56:59], v[208:211]
    ds_read_b64_tr_b16 a[150:151], v53 offset:4096
    v_cvt_pk_bf16_f32 v160, v160, v161
    v_cvt_pk_bf16_f32 v161, v162, v163
    v_mfma_f32_16x16x32_bf16 v[212:215], a[180:183], a[56:59], v[212:215]
    ds_read_b64_tr_b16 a[152:153], v54 offset:0
    v_cvt_pk_bf16_f32 v162, v164, v165
    v_cvt_pk_bf16_f32 v163, v166, v167
    v_mfma_f32_16x16x32_bf16 v[216:219], a[184:187], a[56:59], v[216:219]
    ds_read_b64_tr_b16 a[154:155], v54 offset:4096
    buffer_store_dwordx4 v[160:163], v16, s[56:59], s70 offen offset:0 sc1
    v_mfma_f32_16x16x32_bf16 v[220:223], a[188:191], a[56:59], v[220:223]
    s_waitcnt vmcnt(51)
    v_mfma_f32_16x16x32_bf16 v[224:227], a[160:163], a[60:63], v[224:227]
    v_mfma_f32_16x16x32_bf16 v[228:231], a[164:167], a[60:63], v[228:231]
    v_cvt_pk_bf16_f32 v168, v168, v169
    v_cvt_pk_bf16_f32 v169, v170, v171
    v_mfma_f32_16x16x32_bf16 v[232:235], a[168:171], a[60:63], v[232:235]
    v_add_u32 v8, s88, v8
    v_cvt_pk_bf16_f32 v170, v172, v173
    v_cvt_pk_bf16_f32 v171, v174, v175
    v_mfma_f32_16x16x32_bf16 v[236:239], a[172:175], a[60:63], v[236:239]
    v_add_u32 v9, s88, v9
    buffer_store_dwordx4 v[168:171], v16, s[56:59], s70 offen offset:1024 sc1
    v_mfma_f32_16x16x32_bf16 v[240:243], a[176:179], a[60:63], v[240:243]
    v_add_u32 v10, s88, v10
    v_mfma_f32_16x16x32_bf16 v[244:247], a[180:183], a[60:63], v[244:247]
    v_add_u32 v11, s88, v11
    v_mfma_f32_16x16x32_bf16 v[248:251], a[184:187], a[60:63], v[248:251]
    v_add_u32 v12, s88, v12
    v_cvt_pk_bf16_f32 v176, v176, v177
    v_cvt_pk_bf16_f32 v177, v178, v179
    v_mfma_f32_16x16x32_bf16 v[252:255], a[188:191], a[60:63], v[252:255]
    v_add_u32 v13, s88, v13
    v_cvt_pk_bf16_f32 v178, v180, v181
    v_cvt_pk_bf16_f32 v179, v182, v183
    v_mfma_f32_16x16x32_bf16 v[128:131], a[160:163], a[48:51], v[128:131]
    v_add_u32 v14, s88, v14
    buffer_store_dwordx4 v[176:179], v16, s[56:59], s70 offen offset:2048 sc1
    v_mfma_f32_16x16x32_bf16 v[132:135], a[164:167], a[48:51], v[132:135]
    v_add_u32 v15, s88, v15
    v_mfma_f32_16x16x32_bf16 v[136:139], a[168:171], a[48:51], v[136:139]
    v_mfma_f32_16x16x32_bf16 v[140:143], a[172:175], a[48:51], v[140:143]
    v_cvt_pk_bf16_f32 v184, v184, v185
    v_cvt_pk_bf16_f32 v185, v186, v187
    v_mfma_f32_16x16x32_bf16 v[144:147], a[176:179], a[48:51], v[144:147]
    v_cvt_pk_bf16_f32 v186, v188, v189
    v_cvt_pk_bf16_f32 v187, v190, v191
    v_mfma_f32_16x16x32_bf16 v[148:151], a[180:183], a[48:51], v[148:151]
    buffer_store_dwordx4 v[184:187], v16, s[56:59], s70 offen offset:3072 sc1
    v_mfma_f32_16x16x32_bf16 v[152:155], a[184:187], a[48:51], v[152:155]
    v_mfma_f32_16x16x32_bf16 v[156:159], a[188:191], a[48:51], v[156:159]
    s_waitcnt vmcnt(51) lgkmcnt(12)
    v_mfma_f32_16x16x32_bf16 v[96:99], a[128:131], a[64:67], 0
    ds_read_b64_tr_b16 a[156:157], v55 offset:0
    v_cvt_pk_bf16_f32 v192, v192, v193
    v_cvt_pk_bf16_f32 v193, v194, v195
    s_waitcnt vmcnt(50)
    v_mfma_f32_16x16x32_bf16 a[192:195], a[128:131], a[68:71], 0
    ds_read_b64_tr_b16 a[158:159], v55 offset:4096
    v_cvt_pk_bf16_f32 v194, v196, v197
    v_cvt_pk_bf16_f32 v195, v198, v199
    s_waitcnt lgkmcnt(12)
    v_mfma_f32_16x16x32_bf16 v[100:103], a[132:135], a[64:67], 0
    ds_read_b64_tr_b16 a[160:161], v48 offset:16384
    buffer_store_dwordx4 v[192:195], v16, s[56:59], s71 offen offset:0 sc1
    v_mfma_f32_16x16x32_bf16 a[196:199], a[132:135], a[68:71], 0
    ds_read_b64_tr_b16 a[162:163], v48 offset:20480
    s_waitcnt lgkmcnt(12)
    v_mfma_f32_16x16x32_bf16 v[104:107], a[136:139], a[64:67], 0
    ds_read_b64_tr_b16 a[164:165], v49 offset:16384
    v_mfma_f32_16x16x32_bf16 a[200:203], a[136:139], a[68:71], 0
    ds_read_b64_tr_b16 a[166:167], v49 offset:20480
    v_cvt_pk_bf16_f32 v200, v200, v201
    v_cvt_pk_bf16_f32 v201, v202, v203
    s_waitcnt lgkmcnt(12)
    v_mfma_f32_16x16x32_bf16 v[108:111], a[140:143], a[64:67], 0
    ds_read_b64_tr_b16 a[168:169], v50 offset:16384
    v_cvt_pk_bf16_f32 v202, v204, v205
    v_cvt_pk_bf16_f32 v203, v206, v207
    v_mfma_f32_16x16x32_bf16 a[204:207], a[140:143], a[68:71], 0
    ds_read_b64_tr_b16 a[170:171], v50 offset:20480
    buffer_store_dwordx4 v[200:203], v16, s[56:59], s71 offen offset:1024 sc1
    s_waitcnt lgkmcnt(12)
    v_mfma_f32_16x16x32_bf16 v[112:115], a[144:147], a[64:67], 0
    ds_read_b64_tr_b16 a[172:173], v51 offset:16384
    v_mfma_f32_16x16x32_bf16 a[208:211], a[144:147], a[68:71], 0
    ds_read_b64_tr_b16 a[174:175], v51 offset:20480
    s_waitcnt lgkmcnt(12)
    v_mfma_f32_16x16x32_bf16 v[116:119], a[148:151], a[64:67], 0
    ds_read_b64_tr_b16 a[176:177], v52 offset:16384
    v_cvt_pk_bf16_f32 v208, v208, v209
    v_cvt_pk_bf16_f32 v209, v210, v211
    v_mfma_f32_16x16x32_bf16 a[212:215], a[148:151], a[68:71], 0
    ds_read_b64_tr_b16 a[178:179], v52 offset:20480
    v_cvt_pk_bf16_f32 v210, v212, v213
    v_cvt_pk_bf16_f32 v211, v214, v215
    s_waitcnt lgkmcnt(12)
    v_mfma_f32_16x16x32_bf16 v[120:123], a[152:155], a[64:67], 0
    ds_read_b64_tr_b16 a[180:181], v53 offset:16384
    buffer_store_dwordx4 v[208:211], v16, s[56:59], s71 offen offset:2048 sc1
    v_mfma_f32_16x16x32_bf16 a[216:219], a[152:155], a[68:71], 0
    ds_read_b64_tr_b16 a[182:183], v53 offset:20480
    s_waitcnt lgkmcnt(12)
    v_mfma_f32_16x16x32_bf16 v[124:127], a[156:159], a[64:67], 0
    ds_read_b64_tr_b16 a[184:185], v54 offset:16384
    v_mfma_f32_16x16x32_bf16 a[220:223], a[156:159], a[68:71], 0
    ds_read_b64_tr_b16 a[186:187], v54 offset:20480
    v_cvt_pk_bf16_f32 v216, v216, v217
    v_cvt_pk_bf16_f32 v217, v218, v219
    s_waitcnt vmcnt(52) lgkmcnt(12)
    v_mfma_f32_16x16x32_bf16 v[96:99], a[160:163], a[72:75], v[96:99]
    ds_read_b64_tr_b16 a[188:189], v55 offset:16384
    v_cvt_pk_bf16_f32 v218, v220, v221
    v_cvt_pk_bf16_f32 v219, v222, v223
    s_waitcnt vmcnt(51)
    v_mfma_f32_16x16x32_bf16 a[192:195], a[160:163], a[76:79], a[192:195]
    ds_read_b64_tr_b16 a[190:191], v55 offset:20480
    buffer_store_dwordx4 v[216:219], v16, s[56:59], s71 offen offset:3072 sc1
    s_waitcnt lgkmcnt(12)
    v_mfma_f32_16x16x32_bf16 v[100:103], a[164:167], a[72:75], v[100:103]
    ds_read_b64_tr_b16 a[128:129], v48 offset:32768
    v_mfma_f32_16x16x32_bf16 a[196:199], a[164:167], a[76:79], a[196:199]
    ds_read_b64_tr_b16 a[130:131], v48 offset:36864
    s_waitcnt lgkmcnt(12)
    v_mfma_f32_16x16x32_bf16 v[104:107], a[168:171], a[72:75], v[104:107]
    ds_read_b64_tr_b16 a[132:133], v49 offset:32768
    v_mfma_f32_16x16x32_bf16 a[200:203], a[168:171], a[76:79], a[200:203]
    ds_read_b64_tr_b16 a[134:135], v49 offset:36864
    s_waitcnt lgkmcnt(12)
    v_mfma_f32_16x16x32_bf16 v[108:111], a[172:175], a[72:75], v[108:111]
    ds_read_b64_tr_b16 a[136:137], v50 offset:32768
    v_mfma_f32_16x16x32_bf16 a[204:207], a[172:175], a[76:79], a[204:207]
    ds_read_b64_tr_b16 a[138:139], v50 offset:36864
    s_waitcnt lgkmcnt(12)
    v_mfma_f32_16x16x32_bf16 v[112:115], a[176:179], a[72:75], v[112:115]
    ds_read_b64_tr_b16 a[140:141], v51 offset:32768
    v_mfma_f32_16x16x32_bf16 a[208:211], a[176:179], a[76:79], a[208:211]
    ds_read_b64_tr_b16 a[142:143], v51 offset:36864
    v_cvt_pk_bf16_f32 v224, v224, v225
    v_cvt_pk_bf16_f32 v225, v226, v227
    s_waitcnt lgkmcnt(12)
    v_mfma_f32_16x16x32_bf16 v[116:119], a[180:183], a[72:75], v[116:119]
    ds_read_b64_tr_b16 a[144:145], v52 offset:32768
    v_cvt_pk_bf16_f32 v226, v228, v229
    v_cvt_pk_bf16_f32 v227, v230, v231
    v_mfma_f32_16x16x32_bf16 a[212:215], a[180:183], a[76:79], a[212:215]
    ds_read_b64_tr_b16 a[146:147], v52 offset:36864
    buffer_store_dwordx4 v[224:227], v16, s[56:59], s72 offen offset:0 sc1
    s_waitcnt lgkmcnt(12)
    v_mfma_f32_16x16x32_bf16 v[120:123], a[184:187], a[72:75], v[120:123]
    ds_read_b64_tr_b16 a[148:149], v53 offset:32768
    v_mfma_f32_16x16x32_bf16 a[216:219], a[184:187], a[76:79], a[216:219]
    ds_read_b64_tr_b16 a[150:151], v53 offset:36864
    s_waitcnt lgkmcnt(12)
    v_mfma_f32_16x16x32_bf16 v[124:127], a[188:191], a[72:75], v[124:127]
    ds_read_b64_tr_b16 a[152:153], v54 offset:32768
    v_mfma_f32_16x16x32_bf16 a[220:223], a[188:191], a[76:79], a[220:223]
    ds_read_b64_tr_b16 a[154:155], v54 offset:36864
    s_waitcnt vmcnt(28)
    s_barrier
    s_waitcnt lgkmcnt(12)
    v_mfma_f32_16x16x32_bf16 v[96:99], a[128:131], a[80:83], v[96:99]
    ds_read_b64_tr_b16 a[156:157], v55 offset:32768
    v_mfma_f32_16x16x32_bf16 a[192:195], a[128:131], a[84:87], a[192:195]
    ds_read_b64_tr_b16 a[158:159], v55 offset:36864
    s_waitcnt lgkmcnt(12)
    v_mfma_f32_16x16x32_bf16 v[100:103], a[132:135], a[80:83], v[100:103]
    ds_read_b64_tr_b16 a[160:161], v48 offset:49152
    v_mfma_f32_16x16x32_bf16 a[196:199], a[132:135], a[84:87], a[196:199]
    ds_read_b64_tr_b16 a[162:163], v48 offset:53248
    v_cvt_pk_bf16_f32 v232, v232, v233
    v_cvt_pk_bf16_f32 v233, v234, v235
    s_waitcnt lgkmcnt(12)
    v_mfma_f32_16x16x32_bf16 v[104:107], a[136:139], a[80:83], v[104:107]
    ds_read_b64_tr_b16 a[164:165], v49 offset:49152
    v_cvt_pk_bf16_f32 v234, v236, v237
    v_cvt_pk_bf16_f32 v235, v238, v239
    v_mfma_f32_16x16x32_bf16 a[200:203], a[136:139], a[84:87], a[200:203]
    ds_read_b64_tr_b16 a[166:167], v49 offset:53248
    buffer_store_dwordx4 v[232:235], v16, s[56:59], s72 offen offset:1024 sc1
    s_waitcnt lgkmcnt(12)
    v_mfma_f32_16x16x32_bf16 v[108:111], a[140:143], a[80:83], v[108:111]
    ds_read_b64_tr_b16 a[168:169], v50 offset:49152
    v_mfma_f32_16x16x32_bf16 a[204:207], a[140:143], a[84:87], a[204:207]
    ds_read_b64_tr_b16 a[170:171], v50 offset:53248
    s_waitcnt lgkmcnt(12)
    v_mfma_f32_16x16x32_bf16 v[112:115], a[144:147], a[80:83], v[112:115]
    ds_read_b64_tr_b16 a[172:173], v51 offset:49152
    v_mfma_f32_16x16x32_bf16 a[208:211], a[144:147], a[84:87], a[208:211]
    ds_read_b64_tr_b16 a[174:175], v51 offset:53248
    s_waitcnt lgkmcnt(12)
    v_mfma_f32_16x16x32_bf16 v[116:119], a[148:151], a[80:83], v[116:119]
    ds_read_b64_tr_b16 a[176:177], v52 offset:49152
    v_mfma_f32_16x16x32_bf16 a[212:215], a[148:151], a[84:87], a[212:215]
    ds_read_b64_tr_b16 a[178:179], v52 offset:53248
    s_waitcnt lgkmcnt(12)
    v_mfma_f32_16x16x32_bf16 v[120:123], a[152:155], a[80:83], v[120:123]
    ds_read_b64_tr_b16 a[180:181], v53 offset:49152
    v_mfma_f32_16x16x32_bf16 a[216:219], a[152:155], a[84:87], a[216:219]
    ds_read_b64_tr_b16 a[182:183], v53 offset:53248
    v_cvt_pk_bf16_f32 v240, v240, v241
    v_cvt_pk_bf16_f32 v241, v242, v243
    s_waitcnt lgkmcnt(12)
    v_mfma_f32_16x16x32_bf16 v[124:127], a[156:159], a[80:83], v[124:127]
    ds_read_b64_tr_b16 a[184:185], v54 offset:49152
    v_cvt_pk_bf16_f32 v242, v244, v245
    v_cvt_pk_bf16_f32 v243, v246, v247
    v_mfma_f32_16x16x32_bf16 a[220:223], a[156:159], a[84:87], a[220:223]
    ds_read_b64_tr_b16 a[186:187], v54 offset:53248
    buffer_store_dwordx4 v[240:243], v16, s[56:59], s72 offen offset:2048 sc1
    s_waitcnt lgkmcnt(12)
    v_mfma_f32_16x16x32_bf16 v[96:99], a[160:163], a[88:91], v[96:99]
    ds_read_b64_tr_b16 a[188:189], v55 offset:49152
    v_mfma_f32_16x16x32_bf16 a[192:195], a[160:163], a[92:95], a[192:195]
    ds_read_b64_tr_b16 a[190:191], v55 offset:53248
    s_waitcnt lgkmcnt(12)
    v_mfma_f32_16x16x32_bf16 v[100:103], a[164:167], a[88:91], v[100:103]
    ds_read_b64_tr_b16 a[128:129], v56 offset:0
    v_mfma_f32_16x16x32_bf16 a[196:199], a[164:167], a[92:95], a[196:199]
    ds_read_b64_tr_b16 a[130:131], v56 offset:4096
    s_waitcnt lgkmcnt(12)
    v_mfma_f32_16x16x32_bf16 v[104:107], a[168:171], a[88:91], v[104:107]
    ds_read_b64_tr_b16 a[132:133], v57 offset:0
    v_mfma_f32_16x16x32_bf16 a[200:203], a[168:171], a[92:95], a[200:203]
    ds_read_b64_tr_b16 a[134:135], v57 offset:4096
    s_waitcnt lgkmcnt(12)
    v_mfma_f32_16x16x32_bf16 v[108:111], a[172:175], a[88:91], v[108:111]
    ds_read_b64_tr_b16 a[136:137], v58 offset:0
    v_mfma_f32_16x16x32_bf16 a[204:207], a[172:175], a[92:95], a[204:207]
    ds_read_b64_tr_b16 a[138:139], v58 offset:4096
    v_cvt_pk_bf16_f32 v248, v248, v249
    v_cvt_pk_bf16_f32 v249, v250, v251
    s_waitcnt lgkmcnt(12)
    v_mfma_f32_16x16x32_bf16 v[112:115], a[176:179], a[88:91], v[112:115]
    ds_read_b64_tr_b16 a[140:141], v59 offset:0
    v_cvt_pk_bf16_f32 v250, v252, v253
    v_cvt_pk_bf16_f32 v251, v254, v255
    s_mov_b32 s82, 1310720
    s_add_u32 m0, s3, 65536
    s_nop 0
    buffer_load_dwordx4 v17, s[52:55], s82 offen lds
    v_mfma_f32_16x16x32_bf16 a[208:211], a[176:179], a[92:95], a[208:211]
    ds_read_b64_tr_b16 a[142:143], v59 offset:4096
    buffer_store_dwordx4 v[248:251], v16, s[56:59], s72 offen offset:3072 sc1
    s_waitcnt lgkmcnt(12)
    v_mfma_f32_16x16x32_bf16 v[116:119], a[180:183], a[88:91], v[116:119]
    ds_read_b64_tr_b16 a[144:145], v60 offset:0
    v_mfma_f32_16x16x32_bf16 a[212:215], a[180:183], a[92:95], a[212:215]
    ds_read_b64_tr_b16 a[146:147], v60 offset:4096
    s_waitcnt lgkmcnt(12)
    v_mfma_f32_16x16x32_bf16 v[120:123], a[184:187], a[88:91], v[120:123]
    ds_read_b64_tr_b16 a[148:149], v61 offset:0
    v_mfma_f32_16x16x32_bf16 a[216:219], a[184:187], a[92:95], a[216:219]
    ds_read_b64_tr_b16 a[150:151], v61 offset:4096
    buffer_load_dwordx4 v18, s[52:55], s82 offen offset:1024 lds
    s_waitcnt lgkmcnt(12)
    v_mfma_f32_16x16x32_bf16 v[124:127], a[188:191], a[88:91], v[124:127]
    ds_read_b64_tr_b16 a[152:153], v62 offset:0
    v_mfma_f32_16x16x32_bf16 a[220:223], a[188:191], a[92:95], a[220:223]
    ds_read_b64_tr_b16 a[154:155], v62 offset:4096
    s_barrier
    s_waitcnt lgkmcnt(12)
    v_mfma_f32_16x16x32_bf16 v[96:99], a[128:131], a[96:99], v[96:99]
    ds_read_b64_tr_b16 a[156:157], v63 offset:0
    v_mfma_f32_16x16x32_bf16 a[192:195], a[128:131], a[100:103], a[192:195]
    ds_read_b64_tr_b16 a[158:159], v63 offset:4096
    s_waitcnt lgkmcnt(12)
    v_mfma_f32_16x16x32_bf16 v[100:103], a[132:135], a[96:99], v[100:103]
    ds_read_b64_tr_b16 a[160:161], v56 offset:16384
    s_mov_b32 s83, 1376256
    s_add_u32 m0, s3, 73728
    s_nop 0
    buffer_load_dwordx4 v17, s[52:55], s83 offen lds
    v_mfma_f32_16x16x32_bf16 a[196:199], a[132:135], a[100:103], a[196:199]
    ds_read_b64_tr_b16 a[162:163], v56 offset:20480
    s_waitcnt lgkmcnt(12)
    v_mfma_f32_16x16x32_bf16 v[104:107], a[136:139], a[96:99], v[104:107]
    ds_read_b64_tr_b16 a[164:165], v57 offset:16384
    v_mfma_f32_16x16x32_bf16 a[200:203], a[136:139], a[100:103], a[200:203]
    ds_read_b64_tr_b16 a[166:167], v57 offset:20480
    s_waitcnt lgkmcnt(12)
    v_mfma_f32_16x16x32_bf16 v[108:111], a[140:143], a[96:99], v[108:111]
    ds_read_b64_tr_b16 a[168:169], v58 offset:16384
    v_mfma_f32_16x16x32_bf16 a[204:207], a[140:143], a[100:103], a[204:207]
    ds_read_b64_tr_b16 a[170:171], v58 offset:20480
    buffer_load_dwordx4 v18, s[52:55], s83 offen offset:1024 lds
    s_waitcnt lgkmcnt(12)
    v_mfma_f32_16x16x32_bf16 v[112:115], a[144:147], a[96:99], v[112:115]
    ds_read_b64_tr_b16 a[172:173], v59 offset:16384
    v_mfma_f32_16x16x32_bf16 a[208:211], a[144:147], a[100:103], a[208:211]
    ds_read_b64_tr_b16 a[174:175], v59 offset:20480
    s_waitcnt lgkmcnt(12)
    v_mfma_f32_16x16x32_bf16 v[116:119], a[148:151], a[96:99], v[116:119]
    ds_read_b64_tr_b16 a[176:177], v60 offset:16384
    v_mfma_f32_16x16x32_bf16 a[212:215], a[148:151], a[100:103], a[212:215]
    ds_read_b64_tr_b16 a[178:179], v60 offset:20480
    s_waitcnt lgkmcnt(12)
    v_mfma_f32_16x16x32_bf16 v[120:123], a[152:155], a[96:99], v[120:123]
    ds_read_b64_tr_b16 a[180:181], v61 offset:16384
    s_mov_b32 s82, 1441792
    s_add_u32 m0, s3, 81920
    s_nop 0
    buffer_load_dwordx4 v17, s[52:55], s82 offen lds
    v_mfma_f32_16x16x32_bf16 a[216:219], a[152:155], a[100:103], a[216:219]
    ds_read_b64_tr_b16 a[182:183], v61 offset:20480
    s_waitcnt lgkmcnt(12)
    v_mfma_f32_16x16x32_bf16 v[124:127], a[156:159], a[96:99], v[124:127]
    ds_read_b64_tr_b16 a[184:185], v62 offset:16384
    v_mfma_f32_16x16x32_bf16 a[220:223], a[156:159], a[100:103], a[220:223]
    ds_read_b64_tr_b16 a[186:187], v62 offset:20480
    s_waitcnt lgkmcnt(12)
    v_mfma_f32_16x16x32_bf16 v[96:99], a[160:163], a[104:107], v[96:99]
    ds_read_b64_tr_b16 a[188:189], v63 offset:16384
    v_mfma_f32_16x16x32_bf16 a[192:195], a[160:163], a[108:111], a[192:195]
    ds_read_b64_tr_b16 a[190:191], v63 offset:20480
    buffer_load_dwordx4 v18, s[52:55], s82 offen offset:1024 lds
    s_waitcnt lgkmcnt(12)
    v_mfma_f32_16x16x32_bf16 v[100:103], a[164:167], a[104:107], v[100:103]
    ds_read_b64_tr_b16 a[128:129], v8 offset:0
    v_mfma_f32_16x16x32_bf16 a[196:199], a[164:167], a[108:111], a[196:199]
    ds_read_b64_tr_b16 a[130:131], v8 offset:4096
    s_waitcnt lgkmcnt(12)
    v_mfma_f32_16x16x32_bf16 v[104:107], a[168:171], a[104:107], v[104:107]
    ds_read_b64_tr_b16 a[132:133], v9 offset:0
    v_mfma_f32_16x16x32_bf16 a[200:203], a[168:171], a[108:111], a[200:203]
    ds_read_b64_tr_b16 a[134:135], v9 offset:4096
    s_waitcnt lgkmcnt(12)
    v_mfma_f32_16x16x32_bf16 v[108:111], a[172:175], a[104:107], v[108:111]
    ds_read_b64_tr_b16 a[136:137], v10 offset:0
    s_mov_b32 s83, 1507328
    s_add_u32 m0, s3, 90112
    s_nop 0
    buffer_load_dwordx4 v17, s[52:55], s83 offen lds
    v_mfma_f32_16x16x32_bf16 a[204:207], a[172:175], a[108:111], a[204:207]
    ds_read_b64_tr_b16 a[138:139], v10 offset:4096
    s_waitcnt lgkmcnt(12)
    v_mfma_f32_16x16x32_bf16 v[112:115], a[176:179], a[104:107], v[112:115]
    ds_read_b64_tr_b16 a[140:141], v11 offset:0
    v_mfma_f32_16x16x32_bf16 a[208:211], a[176:179], a[108:111], a[208:211]
    ds_read_b64_tr_b16 a[142:143], v11 offset:4096
    s_waitcnt lgkmcnt(12)
    v_mfma_f32_16x16x32_bf16 v[116:119], a[180:183], a[104:107], v[116:119]
    ds_read_b64_tr_b16 a[144:145], v12 offset:0
    v_mfma_f32_16x16x32_bf16 a[212:215], a[180:183], a[108:111], a[212:215]
    ds_read_b64_tr_b16 a[146:147], v12 offset:4096
    buffer_load_dwordx4 v18, s[52:55], s83 offen offset:1024 lds
    s_waitcnt lgkmcnt(12)
    v_mfma_f32_16x16x32_bf16 v[120:123], a[184:187], a[104:107], v[120:123]
    ds_read_b64_tr_b16 a[148:149], v13 offset:0
    v_mfma_f32_16x16x32_bf16 a[216:219], a[184:187], a[108:111], a[216:219]
    ds_read_b64_tr_b16 a[150:151], v13 offset:4096
    s_waitcnt lgkmcnt(12)
    v_mfma_f32_16x16x32_bf16 v[124:127], a[188:191], a[104:107], v[124:127]
    ds_read_b64_tr_b16 a[152:153], v14 offset:0
    v_mfma_f32_16x16x32_bf16 a[220:223], a[188:191], a[108:111], a[220:223]
    ds_read_b64_tr_b16 a[154:155], v14 offset:4096
    s_waitcnt vmcnt(20)
    s_barrier
    s_waitcnt lgkmcnt(12)
    v_mfma_f32_16x16x32_bf16 v[96:99], a[128:131], a[112:115], v[96:99]
    ds_read_b64_tr_b16 a[156:157], v15 offset:0
    s_mov_b32 s82, 1572864
    s_add_u32 m0, s3, 98304
    s_nop 0
    buffer_load_dwordx4 v17, s[52:55], s82 offen lds
    v_mfma_f32_16x16x32_bf16 a[192:195], a[128:131], a[116:119], a[192:195]
    ds_read_b64_tr_b16 a[158:159], v15 offset:4096
    s_waitcnt lgkmcnt(12)
    v_mfma_f32_16x16x32_bf16 v[100:103], a[132:135], a[112:115], v[100:103]
    ds_read_b64_tr_b16 a[160:161], v8 offset:16384
    v_mfma_f32_16x16x32_bf16 a[196:199], a[132:135], a[116:119], a[196:199]
    ds_read_b64_tr_b16 a[162:163], v8 offset:20480
    s_waitcnt lgkmcnt(12)
    v_mfma_f32_16x16x32_bf16 v[104:107], a[136:139], a[112:115], v[104:107]
    ds_read_b64_tr_b16 a[164:165], v9 offset:16384
    v_mfma_f32_16x16x32_bf16 a[200:203], a[136:139], a[116:119], a[200:203]
    ds_read_b64_tr_b16 a[166:167], v9 offset:20480
    buffer_load_dwordx4 v18, s[52:55], s82 offen offset:1024 lds
    s_waitcnt lgkmcnt(12)
    v_mfma_f32_16x16x32_bf16 v[108:111], a[140:143], a[112:115], v[108:111]
    ds_read_b64_tr_b16 a[168:169], v10 offset:16384
    v_mfma_f32_16x16x32_bf16 a[204:207], a[140:143], a[116:119], a[204:207]
    ds_read_b64_tr_b16 a[170:171], v10 offset:20480
    s_waitcnt lgkmcnt(12)
    v_mfma_f32_16x16x32_bf16 v[112:115], a[144:147], a[112:115], v[112:115]
    ds_read_b64_tr_b16 a[172:173], v11 offset:16384
    v_mfma_f32_16x16x32_bf16 a[208:211], a[144:147], a[116:119], a[208:211]
    ds_read_b64_tr_b16 a[174:175], v11 offset:20480
    s_waitcnt lgkmcnt(12)
    v_mfma_f32_16x16x32_bf16 v[116:119], a[148:151], a[112:115], v[116:119]
    ds_read_b64_tr_b16 a[176:177], v12 offset:16384
    s_mov_b32 s83, 1638400
    s_add_u32 m0, s3, 106496
    s_nop 0
    buffer_load_dwordx4 v17, s[52:55], s83 offen lds
    v_mfma_f32_16x16x32_bf16 a[212:215], a[148:151], a[116:119], a[212:215]
    ds_read_b64_tr_b16 a[178:179], v12 offset:20480
    s_waitcnt lgkmcnt(12)
    v_mfma_f32_16x16x32_bf16 v[120:123], a[152:155], a[112:115], v[120:123]
    ds_read_b64_tr_b16 a[180:181], v13 offset:16384
    v_mfma_f32_16x16x32_bf16 a[216:219], a[152:155], a[116:119], a[216:219]
    ds_read_b64_tr_b16 a[182:183], v13 offset:20480
    s_waitcnt lgkmcnt(12)
    v_mfma_f32_16x16x32_bf16 v[124:127], a[156:159], a[112:115], v[124:127]
    ds_read_b64_tr_b16 a[184:185], v14 offset:16384
    v_mfma_f32_16x16x32_bf16 a[220:223], a[156:159], a[116:119], a[220:223]
    ds_read_b64_tr_b16 a[186:187], v14 offset:20480
    buffer_load_dwordx4 v18, s[52:55], s83 offen offset:1024 lds
    s_waitcnt lgkmcnt(12)
    v_mfma_f32_16x16x32_bf16 v[96:99], a[160:163], a[120:123], v[96:99]
    ds_read_b64_tr_b16 a[188:189], v15 offset:16384
    v_mfma_f32_16x16x32_bf16 a[192:195], a[160:163], a[124:127], a[192:195]
    ds_read_b64_tr_b16 a[190:191], v15 offset:20480
    s_waitcnt lgkmcnt(12)
    v_mfma_f32_16x16x32_bf16 v[100:103], a[164:167], a[120:123], v[100:103]
    ds_read_b64_tr_b16 a[128:129], v8 offset:32768
    v_mfma_f32_16x16x32_bf16 a[196:199], a[164:167], a[124:127], a[196:199]
    ds_read_b64_tr_b16 a[130:131], v8 offset:36864
    s_waitcnt lgkmcnt(12)
    v_mfma_f32_16x16x32_bf16 v[104:107], a[168:171], a[120:123], v[104:107]
    ds_read_b64_tr_b16 a[132:133], v9 offset:32768
    s_mov_b32 s82, 1703936
    s_add_u32 m0, s3, 114688
    s_nop 0
    buffer_load_dwordx4 v17, s[52:55], s82 offen lds
    v_mfma_f32_16x16x32_bf16 a[200:203], a[168:171], a[124:127], a[200:203]
    ds_read_b64_tr_b16 a[134:135], v9 offset:36864
    s_waitcnt lgkmcnt(12)
    v_mfma_f32_16x16x32_bf16 v[108:111], a[172:175], a[120:123], v[108:111]
    ds_read_b64_tr_b16 a[136:137], v10 offset:32768
    v_mfma_f32_16x16x32_bf16 a[204:207], a[172:175], a[124:127], a[204:207]
    ds_read_b64_tr_b16 a[138:139], v10 offset:36864
    s_waitcnt lgkmcnt(12)
    v_mfma_f32_16x16x32_bf16 v[112:115], a[176:179], a[120:123], v[112:115]
    ds_read_b64_tr_b16 a[140:141], v11 offset:32768
    v_mfma_f32_16x16x32_bf16 a[208:211], a[176:179], a[124:127], a[208:211]
    ds_read_b64_tr_b16 a[142:143], v11 offset:36864
    buffer_load_dwordx4 v18, s[52:55], s82 offen offset:1024 lds
    s_waitcnt lgkmcnt(12)
    v_mfma_f32_16x16x32_bf16 v[116:119], a[180:183], a[120:123], v[116:119]
    ds_read_b64_tr_b16 a[144:145], v12 offset:32768
    v_mfma_f32_16x16x32_bf16 a[212:215], a[180:183], a[124:127], a[212:215]
    ds_read_b64_tr_b16 a[146:147], v12 offset:36864
    s_waitcnt lgkmcnt(12)
    v_mfma_f32_16x16x32_bf16 v[120:123], a[184:187], a[120:123], v[120:123]
    ds_read_b64_tr_b16 a[148:149], v13 offset:32768
    v_mfma_f32_16x16x32_bf16 a[216:219], a[184:187], a[124:127], a[216:219]
    ds_read_b64_tr_b16 a[150:151], v13 offset:36864
    s_waitcnt lgkmcnt(12)
    v_mfma_f32_16x16x32_bf16 v[124:127], a[188:191], a[120:123], v[124:127]
    ds_read_b64_tr_b16 a[152:153], v14 offset:32768
    s_mov_b32 s83, 1769472
    s_add_u32 m0, s3, 122880
    s_nop 0
    buffer_load_dwordx4 v17, s[52:55], s83 offen lds
    v_mfma_f32_16x16x32_bf16 a[220:223], a[188:191], a[124:127], a[220:223]
    ds_read_b64_tr_b16 a[154:155], v14 offset:36864
    s_waitcnt lgkmcnt(12)
    v_mfma_f32_16x16x32_bf16 v[96:99], a[128:131], a[0:3], v[96:99]
    ds_read_b64_tr_b16 a[156:157], v15 offset:32768
    v_mfma_f32_16x16x32_bf16 a[192:195], a[128:131], a[4:7], a[192:195]
    ds_read_b64_tr_b16 a[158:159], v15 offset:36864
    s_waitcnt lgkmcnt(12)
    v_mfma_f32_16x16x32_bf16 v[100:103], a[132:135], a[0:3], v[100:103]
    ds_read_b64_tr_b16 a[160:161], v8 offset:49152
    s_waitcnt vmcnt(14)
    s_mov_b64 exec, 1
    buffer_atomic_add v25, off, s[56:59], s77 sc1
    s_mov_b64 exec, -1
    v_mfma_f32_16x16x32_bf16 a[196:199], a[132:135], a[4:7], a[196:199]
    ds_read_b64_tr_b16 a[162:163], v8 offset:53248
    buffer_load_dwordx4 v18, s[52:55], s83 offen offset:1024 lds
    s_waitcnt lgkmcnt(12)
    v_mfma_f32_16x16x32_bf16 v[104:107], a[136:139], a[0:3], v[104:107]
    ds_read_b64_tr_b16 a[164:165], v9 offset:49152
    v_mfma_f32_16x16x32_bf16 a[200:203], a[136:139], a[4:7], a[200:203]
    ds_read_b64_tr_b16 a[166:167], v9 offset:53248
    s_waitcnt lgkmcnt(12)
    v_mfma_f32_16x16x32_bf16 v[108:111], a[140:143], a[0:3], v[108:111]
    ds_read_b64_tr_b16 a[168:169], v10 offset:49152
    v_mfma_f32_16x16x32_bf16 a[204:207], a[140:143], a[4:7], a[204:207]
    ds_read_b64_tr_b16 a[170:171], v10 offset:53248
    s_waitcnt lgkmcnt(12)
    v_mfma_f32_16x16x32_bf16 v[112:115], a[144:147], a[0:3], v[112:115]
    ds_read_b64_tr_b16 a[172:173], v11 offset:49152
    s_mov_b32 s82, 1835008
    s_add_u32 m0, s3, 131072
    s_nop 0
    buffer_load_dwordx4 v17, s[52:55], s82 offen lds
    v_mfma_f32_16x16x32_bf16 a[208:211], a[144:147], a[4:7], a[208:211]
    ds_read_b64_tr_b16 a[174:175], v11 offset:53248
    s_waitcnt lgkmcnt(12)
    v_mfma_f32_16x16x32_bf16 v[116:119], a[148:151], a[0:3], v[116:119]
    ds_read_b64_tr_b16 a[176:177], v12 offset:49152
    v_mfma_f32_16x16x32_bf16 a[212:215], a[148:151], a[4:7], a[212:215]
    ds_read_b64_tr_b16 a[178:179], v12 offset:53248
    s_waitcnt lgkmcnt(12)
    v_mfma_f32_16x16x32_bf16 v[120:123], a[152:155], a[0:3], v[120:123]
    ds_read_b64_tr_b16 a[180:181], v13 offset:49152
    v_mfma_f32_16x16x32_bf16 a[216:219], a[152:155], a[4:7], a[216:219]
    s_branch L_over12
L_stub12:
    s_branch L_stubret
L_over12:
    ds_read_b64_tr_b16 a[182:183], v13 offset:53248
    buffer_load_dwordx4 v18, s[52:55], s82 offen offset:1024 lds
    s_waitcnt lgkmcnt(12)
    v_mfma_f32_16x16x32_bf16 v[124:127], a[156:159], a[0:3], v[124:127]
    ds_read_b64_tr_b16 a[184:185], v14 offset:49152
    v_mfma_f32_16x16x32_bf16 a[220:223], a[156:159], a[4:7], a[220:223]
    ds_read_b64_tr_b16 a[186:187], v14 offset:53248
    s_waitcnt vmcnt(11)
    s_barrier
    s_waitcnt lgkmcnt(12)
    v_mfma_f32_16x16x32_bf16 v[96:99], a[160:163], a[8:11], v[96:99]
    ds_read_b64_tr_b16 a[188:189], v15 offset:49152
    v_mfma_f32_16x16x32_bf16 a[192:195], a[160:163], a[12:15], a[192:195]
    ds_read_b64_tr_b16 a[190:191], v15 offset:53248
    s_waitcnt lgkmcnt(12)
    v_mfma_f32_16x16x32_bf16 v[100:103], a[164:167], a[8:11], v[100:103]
    ds_read_b64_tr_b16 a[128:129], v48 offset:0
    s_mov_b32 s83, 1900544
    s_add_u32 m0, s3, 139264
    s_nop 0
    buffer_load_dwordx4 v17, s[52:55], s83 offen lds
    v_mfma_f32_16x16x32_bf16 a[196:199], a[164:167], a[12:15], a[196:199]
    ds_read_b64_tr_b16 a[130:131], v48 offset:4096
    s_waitcnt lgkmcnt(12)
    v_mfma_f32_16x16x32_bf16 v[104:107], a[168:171], a[8:11], v[104:107]
    ds_read_b64_tr_b16 a[132:133], v49 offset:0
    v_mfma_f32_16x16x32_bf16 a[200:203], a[168:171], a[12:15], a[200:203]
    ds_read_b64_tr_b16 a[134:135], v49 offset:4096
    s_waitcnt lgkmcnt(12)
    v_mfma_f32_16x16x32_bf16 v[108:111], a[172:175], a[8:11], v[108:111]
    ds_read_b64_tr_b16 a[136:137], v50 offset:0
    v_mfma_f32_16x16x32_bf16 a[204:207], a[172:175], a[12:15], a[204:207]
    ds_read_b64_tr_b16 a[138:139], v50 offset:4096
    buffer_load_dwordx4 v18, s[52:55], s83 offen offset:1024 lds
    s_waitcnt lgkmcnt(12)
    v_mfma_f32_16x16x32_bf16 v[112:115], a[176:179], a[8:11], v[112:115]
    ds_read_b64_tr_b16 a[140:141], v51 offset:0
    v_mfma_f32_16x16x32_bf16 a[208:211], a[176:179], a[12:15], a[208:211]
    ds_read_b64_tr_b16 a[142:143], v51 offset:4096
    s_waitcnt lgkmcnt(12)
    v_mfma_f32_16x16x32_bf16 v[116:119], a[180:183], a[8:11], v[116:119]
    ds_read_b64_tr_b16 a[144:145], v52 offset:0
    v_mfma_f32_16x16x32_bf16 a[212:215], a[180:183], a[12:15], a[212:215]
    ds_read_b64_tr_b16 a[146:147], v52 offset:4096
    s_waitcnt lgkmcnt(12)
    v_mfma_f32_16x16x32_bf16 v[120:123], a[184:187], a[8:11], v[120:123]
    ds_read_b64_tr_b16 a[148:149], v53 offset:0
    s_mov_b32 s82, 1966080
    s_add_u32 m0, s3, 147456
    s_nop 0
    buffer_load_dwordx4 v17, s[52:55], s82 offen lds
    v_mfma_f32_16x16x32_bf16 a[216:219], a[184:187], a[12:15], a[216:219]
    ds_read_b64_tr_b16 a[150:151], v53 offset:4096
    s_waitcnt lgkmcnt(12)
    v_mfma_f32_16x16x32_bf16 v[124:127], a[188:191], a[8:11], v[124:127]
    ds_read_b64_tr_b16 a[152:153], v54 offset:0
    v_mfma_f32_16x16x32_bf16 a[220:223], a[188:191], a[12:15], a[220:223]
    ds_read_b64_tr_b16 a[154:155], v54 offset:4096
    s_waitcnt lgkmcnt(12)
    v_mfma_f32_16x16x32_bf16 v[96:99], a[128:131], a[16:19], v[96:99]
    ds_read_b64_tr_b16 a[156:157], v55 offset:0
    buffer_load_dword v43, off, s[56:59], s77 sc1
    v_mfma_f32_16x16x32_bf16 a[192:195], a[128:131], a[20:23], a[192:195]
    ds_read_b64_tr_b16 a[158:159], v55 offset:4096
    buffer_load_dwordx4 v18, s[52:55], s82 offen offset:1024 lds
    s_waitcnt lgkmcnt(12)
    v_mfma_f32_16x16x32_bf16 v[100:103], a[132:135], a[16:19], v[100:103]
    ds_read_b64_tr_b16 a[160:161], v48 offset:16384
    v_mfma_f32_16x16x32_bf16 a[196:199], a[132:135], a[20:23], a[196:199]
    ds_read_b64_tr_b16 a[162:163], v48 offset:20480
    s_waitcnt lgkmcnt(12)
    v_mfma_f32_16x16x32_bf16 v[104:107], a[136:139], a[16:19], v[104:107]
    ds_read_b64_tr_b16 a[164:165], v49 offset:16384
    v_mfma_f32_16x16x32_bf16 a[200:203], a[136:139], a[20:23], a[200:203]
    ds_read_b64_tr_b16 a[166:167], v49 offset:20480
    s_waitcnt lgkmcnt(12)
    v_mfma_f32_16x16x32_bf16 v[108:111], a[140:143], a[16:19], v[108:111]
    ds_read_b64_tr_b16 a[168:169], v50 offset:16384
    s_mov_b32 s83, 2031616
    s_add_u32 m0, s3, 155648
    s_nop 0
    buffer_load_dwordx4 v17, s[52:55], s83 offen lds
    v_mfma_f32_16x16x32_bf16 a[204:207], a[140:143], a[20:23], a[204:207]
    ds_read_b64_tr_b16 a[170:171], v50 offset:20480
    s_waitcnt lgkmcnt(12)
    v_mfma_f32_16x16x32_bf16 v[112:115], a[144:147], a[16:19], v[112:115]
    ds_read_b64_tr_b16 a[172:173], v51 offset:16384
    v_mfma_f32_16x16x32_bf16 a[208:211], a[144:147], a[20:23], a[208:211]
    ds_read_b64_tr_b16 a[174:175], v51 offset:20480
    buffer_load_dwordx4 v18, s[52:55], s83 offen offset:1024 lds
    s_waitcnt lgkmcnt(12)
    v_mfma_f32_16x16x32_bf16 v[116:119], a[148:151], a[16:19], v[116:119]
    ds_read_b64_tr_b16 a[176:177], v52 offset:16384
    v_mfma_f32_16x16x32_bf16 a[212:215], a[148:151], a[20:23], a[212:215]
    ds_read_b64_tr_b16 a[178:179], v52 offset:20480
    s_waitcnt lgkmcnt(12)
    v_mfma_f32_16x16x32_bf16 v[120:123], a[152:155], a[16:19], v[120:123]
    ds_read_b64_tr_b16 a[180:181], v53 offset:16384
    v_mfma_f32_16x16x32_bf16 a[216:219], a[152:155], a[20:23], a[216:219]
    ds_read_b64_tr_b16 a[182:183], v53 offset:20480
    s_waitcnt lgkmcnt(12)
    v_mfma_f32_16x16x32_bf16 v[124:127], a[156:159], a[16:19], v[124:127]
    ds_read_b64_tr_b16 a[184:185], v54 offset:16384
    v_mfma_f32_16x16x32_bf16 a[220:223], a[156:159], a[20:23], a[220:223]
    ds_read_b64_tr_b16 a[186:187], v54 offset:20480
    s_waitcnt vmcnt(9)
    s_barrier
    s_waitcnt lgkmcnt(12)
    v_mfma_f32_16x16x32_bf16 v[96:99], a[160:163], a[24:27], v[96:99]
    ds_read_b64_tr_b16 a[188:189], v55 offset:16384
    v_mfma_f32_16x16x32_bf16 a[192:195], a[160:163], a[28:31], a[192:195]
    ds_read_b64_tr_b16 a[190:191], v55 offset:20480
    s_waitcnt lgkmcnt(12)
    v_mfma_f32_16x16x32_bf16 v[100:103], a[164:167], a[24:27], v[100:103]
    ds_read_b64_tr_b16 a[128:129], v48 offset:32768
    v_mfma_f32_16x16x32_bf16 a[196:199], a[164:167], a[28:31], a[196:199]
    ds_read_b64_tr_b16 a[130:131], v48 offset:36864
    s_waitcnt lgkmcnt(12)
    v_mfma_f32_16x16x32_bf16 v[104:107], a[168:171], a[24:27], v[104:107]
    ds_read_b64_tr_b16 a[132:133], v49 offset:32768
    v_mfma_f32_16x16x32_bf16 a[200:203], a[168:171], a[28:31], a[200:203]
    ds_read_b64_tr_b16 a[134:135], v49 offset:36864
    s_waitcnt lgkmcnt(12)
    v_mfma_f32_16x16x32_bf16 v[108:111], a[172:175], a[24:27], v[108:111]
    ds_read_b64_tr_b16 a[136:137], v50 offset:32768
    v_mfma_f32_16x16x32_bf16 a[204:207], a[172:175], a[28:31], a[204:207]
    ds_read_b64_tr_b16 a[138:139], v50 offset:36864
    s_waitcnt lgkmcnt(12)
    v_mfma_f32_16x16x32_bf16 v[112:115], a[176:179], a[24:27], v[112:115]
    ds_read_b64_tr_b16 a[140:141], v51 offset:32768
    v_mfma_f32_16x16x32_bf16 a[208:211], a[176:179], a[28:31], a[208:211]
    ds_read_b64_tr_b16 a[142:143], v51 offset:36864
    s_waitcnt lgkmcnt(12)
    v_mfma_f32_16x16x32_bf16 v[116:119], a[180:183], a[24:27], v[116:119]
    ds_read_b64_tr_b16 a[144:145], v52 offset:32768
    v_mfma_f32_16x16x32_bf16 a[212:215], a[180:183], a[28:31], a[212:215]
    ds_read_b64_tr_b16 a[146:147], v52 offset:36864
    s_waitcnt lgkmcnt(12)
    v_mfma_f32_16x16x32_bf16 v[120:123], a[184:187], a[24:27], v[120:123]
    ds_read_b64_tr_b16 a[148:149], v53 offset:32768
    v_mfma_f32_16x16x32_bf16 a[216:219], a[184:187], a[28:31], a[216:219]
    ds_read_b64_tr_b16 a[150:151], v53 offset:36864
    s_waitcnt lgkmcnt(12)
    v_mfma_f32_16x16x32_bf16 v[124:127], a[188:191], a[24:27], v[124:127]
    ds_read_b64_tr_b16 a[152:153], v54 offset:32768
    v_mfma_f32_16x16x32_bf16 a[220:223], a[188:191], a[28:31], a[220:223]
    ds_read_b64_tr_b16 a[154:155], v54 offset:36864
    s_waitcnt lgkmcnt(12)
    v_mfma_f32_16x16x32_bf16 v[96:99], a[128:131], a[224:227], v[96:99]
    ds_read_b64_tr_b16 a[156:157], v55 offset:32768
    v_mfma_f32_16x16x32_bf16 a[192:195], a[128:131], a[228:231], a[192:195]
    ds_read_b64_tr_b16 a[158:159], v55 offset:36864
    s_waitcnt lgkmcnt(12)
    v_mfma_f32_16x16x32_bf16 v[100:103], a[132:135], a[224:227], v[100:103]
    ds_read_b64_tr_b16 a[160:161], v48 offset:49152
    v_mfma_f32_16x16x32_bf16 a[196:199], a[132:135], a[228:231], a[196:199]
    ds_read_b64_tr_b16 a[162:163], v48 offset:53248
    s_waitcnt vmcnt(3)
    v_readfirstlane_b32 s86, v43
    s_or_b32 s86, s86, s90
    s_cmp_eq_u32 s86, 0x01010101
    s_cbranch_scc0 L_spP
L_okP:
    buffer_load_dwordx4 v[164:167], v16, s[56:59], s73 offen offset:0 sc1
    s_waitcnt lgkmcnt(12)
    v_mfma_f32_16x16x32_bf16 v[104:107], a[136:139], a[224:227], v[104:107]
    ds_read_b64_tr_b16 a[164:165], v49 offset:49152
    v_mfma_f32_16x16x32_bf16 a[200:203], a[136:139], a[228:231], a[200:203]
    ds_read_b64_tr_b16 a[166:167], v49 offset:53248
    s_waitcnt lgkmcnt(12)
    v_mfma_f32_16x16x32_bf16 v[108:111], a[140:143], a[224:227], v[108:111]
    ds_read_b64_tr_b16 a[168:169], v50 offset:49152
    buffer_load_dwordx4 v[172:175], v16, s[56:59], s73 offen offset:1024 sc1
    v_mfma_f32_16x16x32_bf16 a[204:207], a[140:143], a[228:231], a[204:207]
    ds_read_b64_tr_b16 a[170:171], v50 offset:53248
    s_waitcnt lgkmcnt(12)
    v_mfma_f32_16x16x32_bf16 v[112:115], a[144:147], a[224:227], v[112:115]
    ds_read_b64_tr_b16 a[172:173], v51 offset:49152
    v_mfma_f32_16x16x32_bf16 a[208:211], a[144:147], a[228:231], a[208:211]
    ds_read_b64_tr_b16 a[174:175], v51 offset:53248
    buffer_load_dwordx4 v[180:183], v16, s[56:59], s73 offen offset:2048 sc1
    s_waitcnt lgkmcnt(12)
    v_mfma_f32_16x16x32_bf16 v[116:119], a[148:151], a[224:227], v[116:119]
    ds_read_b64_tr_b16 a[176:177], v52 offset:49152
    v_mfma_f32_16x16x32_bf16 a[212:215], a[148:151], a[228:231], a[212:215]
    ds_read_b64_tr_b16 a[178:179], v52 offset:53248
    s_waitcnt lgkmcnt(12)
    v_mfma_f32_16x16x32_bf16 v[120:123], a[152:155], a[224:227], v[120:123]
    ds_read_b64_tr_b16 a[180:181], v53 offset:49152
    buffer_load_dwordx4 v[188:191], v16, s[56:59], s73 offen offset:3072 sc1
    v_mfma_f32_16x16x32_bf16 a[216:219], a[152:155], a[228:231], a[216:219]
    ds_read_b64_tr_b16 a[182:183], v53 offset:53248
    s_waitcnt lgkmcnt(12)
    v_mfma_f32_16x16x32_bf16 v[124:127], a[156:159], a[224:227], v[124:127]
    ds_read_b64_tr_b16 a[184:185], v54 offset:49152
    v_mfma_f32_16x16x32_bf16 a[220:223], a[156:159], a[228:231], a[220:223]
    ds_read_b64_tr_b16 a[186:187], v54 offset:53248
    buffer_load_dwordx4 v[196:199], v16, s[56:59], s74 offen offset:0 sc1
    s_waitcnt vmcnt(5)
    s_barrier
    s_waitcnt lgkmcnt(12)
    v_mfma_f32_16x16x32_bf16 v[96:99], a[160:163], a[232:235], v[96:99]
    ds_read_b64_tr_b16 a[188:189], v55 offset:49152
    v_mfma_f32_16x16x32_bf16 a[192:195], a[160:163], a[236:239], a[192:195]
    ds_read_b64_tr_b16 a[190:191], v55 offset:53248
    s_waitcnt lgkmcnt(12)
    v_mfma_f32_16x16x32_bf16 v[100:103], a[164:167], a[232:235], v[100:103]
    ds_read_b64_tr_b16 a[128:129], v56 offset:0
    buffer_load_dwordx4 v[204:207], v16, s[56:59], s74 offen offset:1024 sc1
    v_mfma_f32_16x16x32_bf16 a[196:199], a[164:167], a[236:239], a[196:199]
    ds_read_b64_tr_b16 a[130:131], v56 offset:4096
    s_waitcnt lgkmcnt(12)
    v_mfma_f32_16x16x32_bf16 v[104:107], a[168:171], a[232:235], v[104:107]
    ds_read_b64_tr_b16 a[132:133], v57 offset:0
    v_mfma_f32_16x16x32_bf16 a[200:203], a[168:171], a[236:239], a[200:203]
    ds_read_b64_tr_b16 a[134:135], v57 offset:4096
    buffer_load_dwordx4 v[212:215], v16, s[56:59], s74 offen offset:2048 sc1
    s_waitcnt lgkmcnt(12)
    v_mfma_f32_16x16x32_bf16 v[108:111], a[172:175], a[232:235], v[108:111]
    ds_read_b64_tr_b16 a[136:137], v58 offset:0
    v_mfma_f32_16x16x32_bf16 a[204:207], a[172:175], a[236:239], a[204:207]
    ds_read_b64_tr_b16 a[138:139], v58 offset:4096
    s_waitcnt lgkmcnt(12)
    v_mfma_f32_16x16x32_bf16 v[112:115], a[176:179], a[232:235], v[112:115]
    ds_read_b64_tr_b16 a[140:141], v59 offset:0
    buffer_load_dwordx4 v[220:223], v16, s[56:59], s74 offen offset:3072 sc1
    v_mfma_f32_16x16x32_bf16 a[208:211], a[176:179], a[236:239], a[208:211]
    ds_read_b64_tr_b16 a[142:143], v59 offset:4096
    s_waitcnt lgkmcnt(12)
    v_mfma_f32_16x16x32_bf16 v[116:119], a[180:183], a[232:235], v[116:119]
    ds_read_b64_tr_b16 a[144:145], v60 offset:0
    v_mfma_f32_16x16x32_bf16 a[212:215], a[180:183], a[236:239], a[212:215]
    ds_read_b64_tr_b16 a[146:147], v60 offset:4096
    buffer_load_dwordx4 v[228:231], v16, s[56:59], s75 offen offset:0 sc1
    s_waitcnt lgkmcnt(12)
    v_mfma_f32_16x16x32_bf16 v[120:123], a[184:187], a[232:235], v[120:123]
    ds_read_b64_tr_b16 a[148:149], v61 offset:0
    v_mfma_f32_16x16x32_bf16 a[216:219], a[184:187], a[236:239], a[216:219]
    ds_read_b64_tr_b16 a[150:151], v61 offset:4096
    s_waitcnt lgkmcnt(12)
    v_mfma_f32_16x16x32_bf16 v[124:127], a[188:191], a[232:235], v[124:127]
    ds_read_b64_tr_b16 a[152:153], v62 offset:0
    buffer_load_dwordx4 v[236:239], v16, s[56:59], s75 offen offset:1024 sc1
    v_mfma_f32_16x16x32_bf16 a[220:223], a[188:191], a[236:239], a[220:223]
    ds_read_b64_tr_b16 a[154:155], v62 offset:4096
    s_waitcnt lgkmcnt(12)
    v_mfma_f32_16x16x32_bf16 v[96:99], a[128:131], a[240:243], v[96:99]
    ds_read_b64_tr_b16 a[156:157], v63 offset:0
    v_mfma_f32_16x16x32_bf16 a[192:195], a[128:131], a[244:247], a[192:195]
    ds_read_b64_tr_b16 a[158:159], v63 offset:4096
    buffer_load_dwordx4 v[244:247], v16, s[56:59], s75 offen offset:2048 sc1
    s_waitcnt lgkmcnt(12)
    v_mfma_f32_16x16x32_bf16 v[100:103], a[132:135], a[240:243], v[100:103]
    ds_read_b64_tr_b16 a[160:161], v56 offset:16384
    v_mfma_f32_16x16x32_bf16 a[196:199], a[132:135], a[244:247], a[196:199]
    ds_read_b64_tr_b16 a[162:163], v56 offset:20480
    s_waitcnt lgkmcnt(12)
    v_mfma_f32_16x16x32_bf16 v[104:107], a[136:139], a[240:243], v[104:107]
    ds_read_b64_tr_b16 a[164:165], v57 offset:16384
    buffer_load_dwordx4 v[252:255], v16, s[56:59], s75 offen offset:3072 sc1
    v_mfma_f32_16x16x32_bf16 a[200:203], a[136:139], a[244:247], a[200:203]
    ds_read_b64_tr_b16 a[166:167], v57 offset:20480
    s_waitcnt lgkmcnt(12)
    v_mfma_f32_16x16x32_bf16 v[108:111], a[140:143], a[240:243], v[108:111]
    ds_read_b64_tr_b16 a[168:169], v58 offset:16384
    v_mfma_f32_16x16x32_bf16 a[204:207], a[140:143], a[244:247], a[204:207]
    ds_read_b64_tr_b16 a[170:171], v58 offset:20480
    s_waitcnt lgkmcnt(12)
    v_mfma_f32_16x16x32_bf16 v[112:115], a[144:147], a[240:243], v[112:115]
    ds_read_b64_tr_b16 a[172:173], v59 offset:16384
    v_mfma_f32_16x16x32_bf16 a[208:211], a[144:147], a[244:247], a[208:211]
    ds_read_b64_tr_b16 a[174:175], v59 offset:20480
    s_waitcnt lgkmcnt(12)
    v_mfma_f32_16x16x32_bf16 v[116:119], a[148:151], a[240:243], v[116:119]
    ds_read_b64_tr_b16 a[176:177], v60 offset:16384
    v_mfma_f32_16x16x32_bf16 a[212:215], a[148:151], a[244:247], a[212:215]
    ds_read_b64_tr_b16 a[178:179], v60 offset:20480
    s_waitcnt lgkmcnt(12)
    v_mfma_f32_16x16x32_bf16 v[120:123], a[152:155], a[240:243], v[120:123]
    ds_read_b64_tr_b16 a[180:181], v61 offset:16384
    v_mfma_f32_16x16x32_bf16 a[216:219], a[152:155], a[244:247], a[216:219]
    ds_read_b64_tr_b16 a[182:183], v61 offset:20480
    s_waitcnt lgkmcnt(12)
    v_mfma_f32_16x16x32_bf16 v[124:127], a[156:159], a[240:243], v[124:127]
    ds_read_b64_tr_b16 a[184:185], v62 offset:16384
    v_mfma_f32_16x16x32_bf16 a[220:223], a[156:159], a[244:247], a[220:223]
    ds_read_b64_tr_b16 a[186:187], v62 offset:20480
    s_waitcnt lgkmcnt(12)
    v_mfma_f32_16x16x32_bf16 a[192:195], a[160:163], a[252:255], a[192:195]
    ds_read_b64_tr_b16 a[188:189], v63 offset:16384
    s_waitcnt lgkmcnt(11)
    v_mfma_f32_16x16x32_bf16 a[196:199], a[164:167], a[252:255], a[196:199]
    ds_read_b64_tr_b16 a[190:191], v63 offset:20480
    s_waitcnt lgkmcnt(10)
    v_mfma_f32_16x16x32_bf16 a[200:203], a[168:171], a[252:255], a[200:203]
    s_waitcnt lgkmcnt(8)
    v_mfma_f32_16x16x32_bf16 a[204:207], a[172:175], a[252:255], a[204:207]
    s_waitcnt lgkmcnt(6)
    v_mfma_f32_16x16x32_bf16 a[208:211], a[176:179], a[252:255], a[208:211]
    s_waitcnt lgkmcnt(4)
    v_mfma_f32_16x16x32_bf16 a[212:215], a[180:183], a[252:255], a[212:215]
    s_waitcnt lgkmcnt(2)
    v_mfma_f32_16x16x32_bf16 a[216:219], a[184:187], a[252:255], a[216:219]
    s_waitcnt lgkmcnt(0)
    v_mfma_f32_16x16x32_bf16 a[220:223], a[188:191], a[252:255], a[220:223]
    v_mfma_f32_16x16x32_bf16 v[96:99], a[160:163], a[248:251], v[96:99]
    ds_write_b128 v19, a[192:195] offset:0
    v_mfma_f32_16x16x32_bf16 v[100:103], a[164:167], a[248:251], v[100:103]
    ds_write_b128 v19, a[196:199] offset:1024
    v_mfma_f32_16x16x32_bf16 v[104:107], a[168:171], a[248:251], v[104:107]
    ds_write_b128 v19, a[200:203] offset:2048
    v_mfma_f32_16x16x32_bf16 v[108:111], a[172:175], a[248:251], v[108:111]
    ds_write_b128 v19, a[204:207] offset:3072
    v_mfma_f32_16x16x32_bf16 v[112:115], a[176:179], a[248:251], v[112:115]
    ds_write_b128 v19, a[208:211] offset:4096
    v_mfma_f32_16x16x32_bf16 v[116:119], a[180:183], a[248:251], v[116:119]
    ds_write_b128 v19, a[212:215] offset:5120
    v_mfma_f32_16x16x32_bf16 v[120:123], a[184:187], a[248:251], v[120:123]
    ds_write_b128 v19, a[216:219] offset:6144
    v_mfma_f32_16x16x32_bf16 v[124:127], a[188:191], a[248:251], v[124:127]
    ds_write_b128 v19, a[220:223] offset:7168
    s_waitcnt vmcnt(11)
    v_mfma_f32_16x16x32_bf16 v[128:131], v[28:31], v[164:167], v[128:131]
    v_mfma_f32_16x16x32_bf16 v[132:135], v[26:29], v[164:167], v[132:135]
    s_waitcnt vmcnt(10)
    v_mfma_f32_16x16x32_bf16 v[136:139], v[28:31], v[172:175], v[136:139]
    v_mfma_f32_16x16x32_bf16 v[140:143], v[26:29], v[172:175], v[140:143]
    s_waitcnt lgkmcnt(0)
    s_barrier
    ds_read_b128 v[160:163], v20 offset:0
    ds_read_b128 v[168:171], v20 offset:1024
    ds_read_b128 v[176:179], v20 offset:2048
    ds_read_b128 v[184:187], v20 offset:3072
    ds_read_b128 v[192:195], v20 offset:4096
    ds_read_b128 v[200:203], v20 offset:5120
    ds_read_b128 v[208:211], v20 offset:6144
    ds_read_b128 v[216:219], v20 offset:7168
    s_waitcnt vmcnt(9)
    v_mfma_f32_16x16x32_bf16 v[144:147], v[28:31], v[180:183], v[144:147]
    v_mfma_f32_16x16x32_bf16 v[148:151], v[26:29], v[180:183], v[148:151]
    s_waitcnt vmcnt(8)
    v_mfma_f32_16x16x32_bf16 v[152:155], v[28:31], v[188:191], v[152:155]
    v_mfma_f32_16x16x32_bf16 v[156:159], v[26:29], v[188:191], v[156:159]
    s_waitcnt vmcnt(7)
    v_mfma_f32_16x16x32_bf16 v[128:131], v[28:31], v[196:199], v[128:131]
    v_mfma_f32_16x16x32_bf16 v[132:135], v[26:29], v[196:199], v[132:135]
    s_waitcnt vmcnt(6)
    v_mfma_f32_16x16x32_bf16 v[136:139], v[28:31], v[204:207], v[136:139]
    v_mfma_f32_16x16x32_bf16 v[140:143], v[26:29], v[204:207], v[140:143]
    s_waitcnt vmcnt(5)
    v_mfma_f32_16x16x32_bf16 v[144:147], v[28:31], v[212:215], v[144:147]
    v_mfma_f32_16x16x32_bf16 v[148:151], v[26:29], v[212:215], v[148:151]
    s_waitcnt vmcnt(4)
    v_mfma_f32_16x16x32_bf16 v[152:155], v[28:31], v[220:223], v[152:155]
    v_mfma_f32_16x16x32_bf16 v[156:159], v[26:29], v[220:223], v[156:159]
    s_waitcnt vmcnt(3)
    v_mfma_f32_16x16x32_bf16 v[128:131], v[28:31], v[228:231], v[128:131]
    v_mfma_f32_16x16x32_bf16 v[132:135], v[26:29], v[228:231], v[132:135]
    s_waitcnt vmcnt(2)
    v_mfma_f32_16x16x32_bf16 v[136:139], v[28:31], v[236:239], v[136:139]
    v_mfma_f32_16x16x32_bf16 v[140:143], v[26:29], v[236:239], v[140:143]
    s_waitcnt vmcnt(1)
    v_mfma_f32_16x16x32_bf16 v[144:147], v[28:31], v[244:247], v[144:147]
    v_mfma_f32_16x16x32_bf16 v[148:151], v[26:29], v[244:247], v[148:151]
    s_waitcnt vmcnt(0)
    v_mfma_f32_16x16x32_bf16 v[152:155], v[28:31], v[252:255], v[152:155]
    v_mfma_f32_16x16x32_bf16 v[156:159], v[26:29], v[252:255], v[156:159]
    s_waitcnt lgkmcnt(7)
    v_pk_add_f32 v[96:97], v[96:97], v[160:161]
    v_pk_add_f32 v[98:99], v[98:99], v[162:163]
    s_waitcnt lgkmcnt(6)
    v_pk_add_f32 v[100:101], v[100:101], v[168:169]
    v_pk_add_f32 v[102:103], v[102:103], v[170:171]
    v_pk_mul_f32 v[34:35], v[128:129], s[14:15]
    v_pk_mul_f32 v[36:37], v[130:131], s[14:15]
    v_pk_mul_f32 v[38:39], v[132:133], s[14:15]
    v_pk_mul_f32 v[40:41], v[134:135], s[14:15]
    v_exp_f32 v34, v34
    v_exp_f32 v35, v35
    v_exp_f32 v36, v36
    v_exp_f32 v37, v37
    v_exp_f32 v38, v38
    v_exp_f32 v39, v39
    v_exp_f32 v40, v40
    v_exp_f32 v41, v41
    v_pk_mul_f32 v[96:97], v[96:97], v[128:129]
    v_pk_mul_f32 v[98:99], v[98:99], v[130:131]
    v_pk_mul_f32 v[100:101], v[100:101], v[132:133]
    v_pk_mul_f32 v[102:103], v[102:103], v[134:135]
    v_pk_add_f32 v[34:35], v[34:35], 1.0 op_sel_hi:[1,0]
    v_pk_add_f32 v[36:37], v[36:37], 1.0 op_sel_hi:[1,0]
    v_pk_add_f32 v[38:39], v[38:39], 1.0 op_sel_hi:[1,0]
    v_pk_add_f32 v[40:41], v[40:41], 1.0 op_sel_hi:[1,0]
    v_rcp_f32 v34, v34
    v_rcp_f32 v35, v35
    v_rcp_f32 v36, v36
    v_rcp_f32 v37, v37
    v_rcp_f32 v38, v38
    v_rcp_f32 v39, v39
    v_rcp_f32 v40, v40
    v_rcp_f32 v41, v41
    v_pk_fma_f32 v[96:97], v[96:97], v[34:35], v[64:65]
    v_pk_fma_f32 v[98:99], v[98:99], v[36:37], v[66:67]
    v_pk_fma_f32 v[100:101], v[100:101], v[38:39], v[68:69]
    v_pk_fma_f32 v[102:103], v[102:103], v[40:41], v[70:71]
    v_cvt_pk_bf16_f32 v96, v96, v97
    v_cvt_pk_bf16_f32 v97, v98, v99
    v_cvt_pk_bf16_f32 v98, v100, v101
    v_cvt_pk_bf16_f32 v99, v102, v103
    s_nop 0
    v_permlane16_swap_b32 v96, v98
    v_permlane16_swap_b32 v97, v99
    global_store_dwordx4 v2, v[96:99], s[22:23] offset:0 sc1
    s_waitcnt lgkmcnt(5)
    v_pk_add_f32 v[104:105], v[104:105], v[176:177]
    v_pk_add_f32 v[106:107], v[106:107], v[178:179]
    s_waitcnt lgkmcnt(4)
    v_pk_add_f32 v[108:109], v[108:109], v[184:185]
    v_pk_add_f32 v[110:111], v[110:111], v[186:187]
    v_pk_mul_f32 v[34:35], v[136:137], s[14:15]
    v_pk_mul_f32 v[36:37], v[138:139], s[14:15]
    v_pk_mul_f32 v[38:39], v[140:141], s[14:15]
    v_pk_mul_f32 v[40:41], v[142:143], s[14:15]
    v_exp_f32 v34, v34
    v_exp_f32 v35, v35
    v_exp_f32 v36, v36
    v_exp_f32 v37, v37
    v_exp_f32 v38, v38
    v_exp_f32 v39, v39
    v_exp_f32 v40, v40
    v_exp_f32 v41, v41
    v_pk_mul_f32 v[104:105], v[104:105], v[136:137]
    v_pk_mul_f32 v[106:107], v[106:107], v[138:139]
    v_pk_mul_f32 v[108:109], v[108:109], v[140:141]
    v_pk_mul_f32 v[110:111], v[110:111], v[142:143]
    v_pk_add_f32 v[34:35], v[34:35], 1.0 op_sel_hi:[1,0]
    v_pk_add_f32 v[36:37], v[36:37], 1.0 op_sel_hi:[1,0]
    v_pk_add_f32 v[38:39], v[38:39], 1.0 op_sel_hi:[1,0]
    v_pk_add_f32 v[40:41], v[40:41], 1.0 op_sel_hi:[1,0]
    v_rcp_f32 v34, v34
    v_rcp_f32 v35, v35
    v_rcp_f32 v36, v36
    v_rcp_f32 v37, v37
    v_rcp_f32 v38, v38
    v_rcp_f32 v39, v39
    v_rcp_f32 v40, v40
    v_rcp_f32 v41, v41
    v_pk_fma_f32 v[104:105], v[104:105], v[34:35], v[72:73]
    v_pk_fma_f32 v[106:107], v[106:107], v[36:37], v[74:75]
    v_pk_fma_f32 v[108:109], v[108:109], v[38:39], v[76:77]
    v_pk_fma_f32 v[110:111], v[110:111], v[40:41], v[78:79]
    v_cvt_pk_bf16_f32 v104, v104, v105
    v_cvt_pk_bf16_f32 v105, v106, v107
    v_cvt_pk_bf16_f32 v106, v108, v109
    v_cvt_pk_bf16_f32 v107, v110, v111
    s_nop 0
    v_permlane16_swap_b32 v104, v106
    v_permlane16_swap_b32 v105, v107
    global_store_dwordx4 v2, v[104:107], s[22:23] offset:64 sc1
    s_waitcnt lgkmcnt(3)
    v_pk_add_f32 v[112:113], v[112:113], v[192:193]
    v_pk_add_f32 v[114:115], v[114:115], v[194:195]
    s_waitcnt lgkmcnt(2)
    v_pk_add_f32 v[116:117], v[116:117], v[200:201]
    v_pk_add_f32 v[118:119], v[118:119], v[202:203]
    v_pk_mul_f32 v[34:35], v[144:145], s[14:15]
    v_pk_mul_f32 v[36:37], v[146:147], s[14:15]
    v_pk_mul_f32 v[38:39], v[148:149], s[14:15]
    v_pk_mul_f32 v[40:41], v[150:151], s[14:15]
    v_exp_f32 v34, v34
    v_exp_f32 v35, v35
    v_exp_f32 v36, v36
    v_exp_f32 v37, v37
    v_exp_f32 v38, v38
    v_exp_f32 v39, v39
    v_exp_f32 v40, v40
    v_exp_f32 v41, v41
    v_pk_mul_f32 v[112:113], v[112:113], v[144:145]
    v_pk_mul_f32 v[114:115], v[114:115], v[146:147]
    v_pk_mul_f32 v[116:117], v[116:117], v[148:149]
    v_pk_mul_f32 v[118:119], v[118:119], v[150:151]
    v_pk_add_f32 v[34:35], v[34:35], 1.0 op_sel_hi:[1,0]
    v_pk_add_f32 v[36:37], v[36:37], 1.0 op_sel_hi:[1,0]
    v_pk_add_f32 v[38:39], v[38:39], 1.0 op_sel_hi:[1,0]
    v_pk_add_f32 v[40:41], v[40:41], 1.0 op_sel_hi:[1,0]
    v_rcp_f32 v34, v34
    v_rcp_f32 v35, v35
    v_rcp_f32 v36, v36
    v_rcp_f32 v37, v37
    v_rcp_f32 v38, v38
    v_rcp_f32 v39, v39
    v_rcp_f32 v40, v40
    v_rcp_f32 v41, v41
    v_pk_fma_f32 v[112:113], v[112:113], v[34:35], v[80:81]
    v_pk_fma_f32 v[114:115], v[114:115], v[36:37], v[82:83]
    v_pk_fma_f32 v[116:117], v[116:117], v[38:39], v[84:85]
    v_pk_fma_f32 v[118:119], v[118:119], v[40:41], v[86:87]
    v_cvt_pk_bf16_f32 v112, v112, v113
    v_cvt_pk_bf16_f32 v113, v114, v115
    v_cvt_pk_bf16_f32 v114, v116, v117
    v_cvt_pk_bf16_f32 v115, v118, v119
    s_nop 0
    v_permlane16_swap_b32 v112, v114
    v_permlane16_swap_b32 v113, v115
    global_store_dwordx4 v2, v[112:115], s[22:23] offset:128 sc1
    s_waitcnt lgkmcnt(1)
    v_pk_add_f32 v[120:121], v[120:121], v[208:209]
    v_pk_add_f32 v[122:123], v[122:123], v[210:211]
    s_waitcnt lgkmcnt(0)
    v_pk_add_f32 v[124:125], v[124:125], v[216:217]
    v_pk_add_f32 v[126:127], v[126:127], v[218:219]
    v_pk_mul_f32 v[34:35], v[152:153], s[14:15]
    v_pk_mul_f32 v[36:37], v[154:155], s[14:15]
    v_pk_mul_f32 v[38:39], v[156:157], s[14:15]
    v_pk_mul_f32 v[40:41], v[158:159], s[14:15]
    v_exp_f32 v34, v34
    v_exp_f32 v35, v35
    v_exp_f32 v36, v36
    v_exp_f32 v37, v37
    v_exp_f32 v38, v38
    v_exp_f32 v39, v39
    v_exp_f32 v40, v40
    v_exp_f32 v41, v41
    v_pk_mul_f32 v[120:121], v[120:121], v[152:153]
    v_pk_mul_f32 v[122:123], v[122:123], v[154:155]
    v_pk_mul_f32 v[124:125], v[124:125], v[156:157]
    v_pk_mul_f32 v[126:127], v[126:127], v[158:159]
    v_pk_add_f32 v[34:35], v[34:35], 1.0 op_sel_hi:[1,0]
    v_pk_add_f32 v[36:37], v[36:37], 1.0 op_sel_hi:[1,0]
    v_pk_add_f32 v[38:39], v[38:39], 1.0 op_sel_hi:[1,0]
    v_pk_add_f32 v[40:41], v[40:41], 1.0 op_sel_hi:[1,0]
    v_rcp_f32 v34, v34
    v_rcp_f32 v35, v35
    v_rcp_f32 v36, v36
    v_rcp_f32 v37, v37
    v_rcp_f32 v38, v38
    v_rcp_f32 v39, v39
    v_rcp_f32 v40, v40
    v_rcp_f32 v41, v41
    v_pk_fma_f32 v[120:121], v[120:121], v[34:35], v[88:89]
    v_pk_fma_f32 v[122:123], v[122:123], v[36:37], v[90:91]
    v_pk_fma_f32 v[124:125], v[124:125], v[38:39], v[92:93]
    v_pk_fma_f32 v[126:127], v[126:127], v[40:41], v[94:95]
    v_cvt_pk_bf16_f32 v120, v120, v121
    v_cvt_pk_bf16_f32 v121, v122, v123
    v_cvt_pk_bf16_f32 v122, v124, v125
    v_cvt_pk_bf16_f32 v123, v126, v127
    s_nop 0
    v_permlane16_swap_b32 v120, v122
    v_permlane16_swap_b32 v121, v123
    global_store_dwordx4 v2, v[120:123], s[22:23] offset:192 sc1
L_end:
    s_endpgm
L_spA0:
    buffer_load_dword v43, off, s[56:59], s92 sc1
    s_waitcnt vmcnt(0)
    v_readfirstlane_b32 s86, v43
    s_bfe_u32 s86, s86, 0x80000
    s_cmp_eq_u32 s86, 32
    s_cbranch_scc1 L_okA0
    s_add_u32 s67, s67, 1
    s_cmp_lt_u32 s67, 0x40000
    s_cbranch_scc1 L_spA0
    s_branch L_okA0
L_spA1:
    buffer_load_dword v43, off, s[56:59], s92 sc1
    s_waitcnt vmcnt(0)
    v_readfirstlane_b32 s86, v43
    s_bfe_u32 s86, s86, 0x80000
    s_cmp_eq_u32 s86, 32
    s_cbranch_scc1 L_okA1
    s_add_u32 s67, s67, 1
    s_cmp_lt_u32 s67, 0x40000
    s_cbranch_scc1 L_spA1
    s_branch L_okA1
L_spB:
    buffer_load_dword v43, off, s[56:59], s92 sc1
    s_waitcnt vmcnt(0)
    v_readfirstlane_b32 s86, v43
    s_bfe_u32 s86, s86, 0x80008
    s_cmp_eq_u32 s86, 16
    s_cbranch_scc1 L_okB
    s_add_u32 s67, s67, 1
    s_cmp_lt_u32 s67, 0x40000
    s_cbranch_scc1 L_spB
    s_branch L_okB
L_spC:
    buffer_load_dword v43, off, s[56:59], s92 sc1
    s_waitcnt vmcnt(0)
    v_readfirstlane_b32 s86, v43
    s_bfe_u32 s86, s86, 0x80010
    s_cmp_eq_u32 s86, 16
    s_cbranch_scc1 L_okC
    s_add_u32 s67, s67, 1
    s_cmp_lt_u32 s67, 0x40000
    s_cbranch_scc1 L_spC
    s_branch L_okC
L_spO:
    buffer_load_dword v43, off, s[56:59], s76 sc1
    s_waitcnt vmcnt(0)
    v_readfirstlane_b32 s86, v43
    s_cmp_eq_u32 s86, 64
    s_cbranch_scc1 L_okO
    s_add_u32 s67, s67, 1
    s_cmp_lt_u32 s67, 0x40000
    s_cbranch_scc1 L_spO
    s_branch L_okO
L_spP:
    buffer_load_dword v43, off, s[56:59], s77 sc1
    s_waitcnt vmcnt(0)
    v_readfirstlane_b32 s86, v43
    s_or_b32 s86, s86, s90
    s_cmp_eq_u32 s86, 0x01010101
    s_cbranch_scc1 L_okP
    s_add_u32 s67, s67, 1
    s_cmp_lt_u32 s67, 0x40000
    s_cbranch_scc1 L_spP
    s_branch L_okP
L_code_end:
.section .rodata,"a"
.p2align 6
.amdhsa_kernel recurrent_scan__sliding_local_dilated__glu_gated_geglu__prompt_kernel
  .amdhsa_next_free_vgpr 512
  .amdhsa_next_free_sgpr 102
  .amdhsa_accum_offset 256
  .amdhsa_group_segment_fixed_size 0
  .amdhsa_kernarg_size 80
  .amdhsa_user_sgpr_count 2
  .amdhsa_user_sgpr_kernarg_segment_ptr 1
  .amdhsa_system_sgpr_workgroup_id_x 1
.end_amdhsa_kernel
```

```asm
; @launch grid=(256,1,1) block=(256,1,1) lds=163840
.amdgcn_target "amdgcn-amd-amdhsa--gfx950"
.text
.p2align 8
.globl recurrent_scan__sliding_local_dilated__glu_gated_geglu__prompt_kernel
.type recurrent_scan__sliding_local_dilated__glu_gated_geglu__prompt_kernel,@function
recurrent_scan__sliding_local_dilated__glu_gated_geglu__prompt_kernel:
    s_cmp_ge_u32 s2, 256
    s_cbranch_scc1 L_end
    s_load_dwordx16 s[8:23], s[0:1], 0
    s_load_dwordx4 s[24:27], s[0:1], 64
    v_lshrrev_b32 v1, 6, v0
    v_and_b32 v0, 63, v0
    v_readfirstlane_b32 s60, v1
    s_getpc_b64 s[86:87]
L_pc:
    s_lshr_b32 s82, s2, 3
    s_lshl_b32 s82, s82, 2
    s_add_u32 s82, s82, s60
    s_lshl_b32 s82, s82, 10
    v_lshl_add_u32 v2, v0, 4, s82
    v_min_u32 v2, L_code_end-L_pc-4, v2
    global_load_dword v7, v2, s[86:87]
    s_and_b32 s82, s2, 7
    s_lshr_b32 s83, s2, 3
    s_lshr_b32 s65, s82, 1
    s_and_b32 s63, s82, 1
    s_lshl_b32 s63, s63, 2
    s_and_b32 s84, s83, 3
    s_add_u32 s63, s63, s84
    s_lshr_b32 s66, s83, 2
    s_lshl_b32 s64, s65, 3
    s_add_u32 s64, s64, s66
    s_lshr_b32 s61, s60, 1
    s_and_b32 s62, s60, 1
    v_lshlrev_b32 v16, 4, v0
    s_lshl_b32 s84, s64, 2
    s_add_u32 s84, s84, s60
    s_lshl_b32 s85, s63, 7
    s_add_u32 s84, s84, s85
    s_lshl_b32 s85, s84, 12
    v_add_u32 v36, s85, v16
    s_lshl_b32 s84, s84, 2
    s_add_u32 s84, s84, 39845888
    v_mov_b32 v37, s84
    s_waitcnt lgkmcnt(0)
    global_load_dwordx4 v[48:51], v36, s[8:9] offset:0 nt
    global_load_dwordx4 v[52:55], v36, s[8:9] offset:1024 nt
    global_load_dwordx4 v[56:59], v36, s[8:9] offset:2048 nt
    global_load_dwordx4 v[60:63], v36, s[8:9] offset:3072 nt
    s_lshl_b32 s84, s63, 9
    s_lshl_b32 s85, s61, 8
    s_add_u32 s85, s85, s84
    s_sub_u32 s84, s84, 32
    s_max_i32 s84, s84, 0
    s_cmp_eq_u32 s62, 0
    s_cselect_b32 s85, s85, s84
    s_cselect_b32 s84, 63, 7
    s_add_u32 s85, s85, 39845888
    v_and_b32 v38, s84, v0
    v_lshlrev_b32 v38, 2, v38
    v_add_u32 v38, s85, v38
    global_load_dword v39, v38, s[26:27] sc1
    global_load_dword v40, v37, s[26:27] sc1
    v_lshlrev_b32 v2, 6, v0
    v_sub_u32 v2, v2, v16
    v_add_u32 v2, v2, v36
    s_sub_u32 s84, s63, s62
    s_max_i32 s84, s84, 0
    s_lshl_b32 s84, s84, 5
    v_mov_b32 v41, s84
    s_mov_b32 s56, s26
    s_and_b32 s57, s27, 0xffff
    s_mov_b32 s58, 0x10000000
    s_mov_b32 s59, 0x20000
    s_lshl_b32 s84, s63, 2
    s_add_u32 s84, s84, s65
    s_lshl_b32 s92, s84, 8
    s_add_u32 s92, s92, 39849984
    s_mul_i32 s88, s84, 458752
    s_add_u32 s88, s88, 8388608
    s_lshl_b32 s93, s63, 8
    s_add_u32 s93, s93, 39858176
    s_cmp_lg_u32 s60, 3
    s_cbranch_scc1 L_nozero
    s_lshl_b32 s84, s63, 3
    s_add_u32 s84, s84, s66
    s_lshl_b32 s84, s84, 2
    s_add_u32 s84, s84, s65
    s_lshl_b32 s84, s84, 8
    s_add_u32 s84, s84, 39862272
    v_mov_b32 v2, s84
    v_writelane_b32 v2, s92, 1
    v_writelane_b32 v2, s93, 2
    s_cmp_eq_u32 s66, 0
    s_cselect_b32 s84, 3, 1
    s_cmp_eq_u32 s64, 0
    s_cselect_b32 s84, 7, s84
    v_mov_b32 v3, 0
    s_mov_b32 exec_hi, 0
    s_mov_b32 exec_lo, s84
    global_store_dword v2, v3, s[26:27] sc1
    s_mov_b64 exec, -1
L_nozero:
    v_lshrrev_b32 v20, 2, v0
    v_and_b32 v21, 3, v0
    v_lshrrev_b32 v22, 4, v0
    v_and_b32 v23, 15, v0
    v_lshrrev_b32 v24, 3, v20
    v_lshlrev_b32 v24, 1, v24
    v_xor_b32 v24, v21, v24
    v_mul_u32_u24 v2, 6144, v20
    v_lshl_add_u32 v2, v24, 4, v2
    v_mul_u32_u24 v25, 7168, v20
    v_lshl_add_u32 v3, v24, 4, v25
    s_mul_i32 s84, s61, 98304
    s_lshl_b32 s85, s64, 6
    s_add_u32 s84, s84, s85
    s_add_u32 s32, s10, s84
    s_addc_u32 s33, s11, 0
    s_sub_u32 s32, s32, 4096
    s_subb_u32 s33, s33, 0
    s_and_b32 s33, s33, 0xffff
    s_sub_u32 s34, 6295552, s84
    s_mov_b32 s35, 0x20000
    s_mul_i32 s84, s61, 114688
    s_mul_i32 s85, s64, 224
    s_add_u32 s84, s84, s85
    s_add_u32 s36, s16, s84
    s_addc_u32 s37, s17, 0
    s_sub_u32 s36, s36, 4096
    s_subb_u32 s37, s37, 0
    s_and_b32 s37, s37, 0xffff
    s_sub_u32 s38, 7344128, s84
    s_mov_b32 s39, 0x20000
    s_add_u32 s40, s18, s84
    s_addc_u32 s41, s19, 0
    s_sub_u32 s40, s40, 4096
    s_subb_u32 s41, s41, 0
    s_and_b32 s41, s41, 0xffff
    s_sub_u32 s42, 7344128, s84
    s_mov_b32 s43, 0x20000
    v_cmp_lt_u32 vcc, 1, v24
    v_and_b32 v24, 1, v24
    v_lshl_add_u32 v24, v24, 4, v25
    v_add_u32 v24, 3264, v24
    v_mov_b32 v25, 0
    s_add_u32 s82, s16, s84
    s_addc_u32 s83, s17, 0
    s_sub_u32 s82, s82, 4096
    s_subb_u32 s83, s83, 0
    v_lshl_add_u64 v[4:5], v[24:25], 0, s[82:83]
    s_add_u32 s82, s18, s84
    s_addc_u32 s83, s19, 0
    s_sub_u32 s82, s82, 4096
    s_subb_u32 s83, s83, 0
    v_lshl_add_u64 v[24:25], v[24:25], 0, s[82:83]
    v_cndmask_b32 v4, v4, v24, vcc
    v_cndmask_b32 v5, v5, v25, vcc
    s_mov_b32 s80, 229376
    s_mov_b32 s81, 0
    s_cmp_eq_u32 s62, 1
    s_cbranch_scc1 L_init1
    s_lshl_b32 s78, s61, 14
    s_mov_b32 s68, 4096
    s_mov_b32 s69, 19456
    s_mov_b32 s70, 34816
    s_mov_b32 s71, 50176
    s_mov_b32 s72, 69632
    s_mov_b32 s73, 84992
    s_mov_b32 s74, 100352
    s_mov_b32 s75, 115712
    s_lshl_b32 s84, s63, 1
    s_add_u32 s84, s84, s61
    s_lshl_b32 s84, s84, 18
    s_branch L_init2
L_init1:
    s_mul_i32 s78, s61, 10240
    s_add_u32 s78, s78, 69632
    s_mov_b32 s68, 6144
    s_mov_b32 s69, 7168
    s_mov_b32 s70, 2048
    s_mov_b32 s71, 1024
    s_mov_b32 s72, 4096
    s_mov_b32 s73, 3136
    s_mov_b32 s74, 2112
    s_mov_b32 s75, 1152
    s_mov_b32 s76, 4224
    s_mov_b32 s14, 151552
    s_cmp_eq_u32 s61, 0
    s_cselect_b32 s15, 67584, s14
    s_cselect_b32 s14, 32768, s14
    s_lshl_b32 s84, s63, 19
    s_sub_u32 s84, s84, 32768
    s_max_i32 s84, s84, 0
L_init2:
    s_add_u32 s28, s26, s84
    s_addc_u32 s29, s27, 0
    s_sub_u32 s28, s28, 4096
    s_subb_u32 s29, s29, 0
    s_and_b32 s29, s29, 0xffff
    s_sub_u32 s30, 4198400, s84
    s_mov_b32 s31, 0x20000
    v_lshrrev_b32 v24, 3, v0
    v_and_b32 v25, 6, v24
    v_and_b32 v1, 7, v0
    v_xor_b32 v25, v25, v1
    v_lshlrev_b32 v25, 4, v25
    v_lshl_add_u32 v1, v24, 11, v25
    s_cmp_eq_u32 s63, 0
    s_cselect_b32 s84, 1, 3
    s_and_b32 s85, s60, s84
    s_cmp_eq_u32 s85, s84
    s_cselect_b32 s85, 0x40000000, 0
    s_cselect_b32 s87, 1, 0
    v_add_u32 v1, s85, v1
    s_lshr_b32 s83, s2, 3
    v_lshrrev_b32 v24, 3, v0
    v_and_b32 v25, 7, v0
    s_lshr_b32 s84, s63, 2
    s_lshl_b32 s84, s84, 4
    s_lshr_b32 s85, s83, 1
    s_add_u32 s84, s84, s85
    s_and_b32 s83, s83, 1
    s_cmp_eq_u32 s60, 0
    s_cbranch_scc1 L_pf0
    s_cmp_eq_u32 s60, 1
    s_cselect_b32 s44, s16, s18
    s_cselect_b32 s45, s17, s19
    s_cmp_eq_u32 s60, 3
    s_cselect_b32 s46, 0, 7340032
    s_mov_b32 s79, 229376
    s_mul_i32 s84, s84, 7168
    s_lshl_b32 s85, s65, 1
    s_add_u32 s85, s85, s83
    s_mul_i32 s85, s85, 896
    s_add_u32 s84, s84, s85
    v_cmp_gt_u32 vcc, 7, v25
    v_lshlrev_b32 v25, 7, v25
    s_branch L_pfd
L_pf0:
    s_mov_b32 s44, s10
    s_mov_b32 s45, s11
    s_mov_b32 s46, 6291456
    s_mov_b32 s79, 196608
    s_mul_i32 s84, s84, 6144
    s_lshl_b32 s85, s65, 1
    s_add_u32 s85, s85, s83
    s_lshl_b32 s85, s85, 8
    s_add_u32 s84, s84, s85
    v_cmp_gt_u32 vcc, 6, v25
    v_and_b32 v6, 1, v25
    v_lshrrev_b32 v25, 1, v25
    v_lshlrev_b32 v25, 11, v25
    v_lshl_add_u32 v25, v6, 7, v25
L_pfd:
    v_add_u32 v25, s84, v25
    v_mov_b32 v6, 0x40000000
    v_cndmask_b32 v25, v6, v25, vcc
    v_mul_lo_u32 v42, v24, s79
    v_add_u32 v42, v42, v25
    s_lshr_b32 s84, s79, 1
    s_sub_u32 s85, 0, s84
    s_cmp_lt_u32 s63, 4
    s_cselect_b32 s84, s84, s85
    s_mul_i32 s85, s79, 6
    s_sub_u32 s84, s84, s85
    v_add_u32 v25, s84, v42
    v_cmp_gt_u32 vcc, 4, v24
    s_nop 1
    v_cndmask_b32 v6, v6, v25, vcc
    v_cmp_gt_u32 vcc, 2, v24
    s_nop 1
    v_cndmask_b32 v6, v6, v42, vcc
    s_mul_i32 s84, s79, 8
    v_add_u32 v6, s84, v6
    s_lshl_b32 s86, s79, 3
    s_mul_i32 s79, s79, 2
    s_lshr_b32 s84, s2, 3
    s_and_b32 s84, s84, 0
    s_cmp_eq_u32 s84, 0
    s_cselect_b32 s4, 0, 0x40000000
    s_lshl_b32 s84, s63, 4
    s_add_u32 s84, s84, s65
    s_lshl_b32 s84, s84, 15
    s_lshl_b32 s85, s66, 8
    s_add_u32 s84, s84, s85
    s_add_u32 s48, s8, s84
    s_addc_u32 s49, s9, 0
    s_mov_b32 s50, 424192
    s_mov_b32 s52, 131072
    v_lshrrev_b32 v33, 1, v0
    v_and_b32 v24, 1, v0
    v_lshlrev_b32 v24, 7, v24
    v_lshl_add_u32 v33, v33, 11, v24
    v_subrev_u32 v33, 524288, v33
    v_mov_b32 v24, 0x40000000
    v_cmp_gt_u32 vcc, 32, v0
    s_nop 1
    v_cndmask_b32 v33, v24, v33, vcc
    s_cmp_lg_u32 s60, 3
    s_cbranch_scc1 L_pf3d
    s_lshl_b32 s84, s2, 13
    s_add_u32 s48, s12, s84
    s_addc_u32 s49, s13, 0
    s_mov_b32 s50, 8192
    s_mov_b32 s52, 2048
    v_lshlrev_b32 v25, 7, v0
    v_subrev_u32 v33, 16384, v25
    v_cmp_gt_u32 vcc, 16, v0
    s_nop 1
    v_cndmask_b32 v33, v24, v33, vcc
    s_and_b32 s84, s2, 7
    s_lshl_b32 s84, s84, 5
    s_lshr_b32 s85, s2, 3
    s_add_u32 s84, s84, s85
    s_mul_i32 s84, s84, 28672
    s_add_u32 s44, s20, s84
    s_addc_u32 s45, s21, 0
    s_mov_b32 s46, 28672
    s_mov_b32 s79, 7168
    v_subrev_u32 v6, 71680, v25
    v_mov_b32 v42, 0x40000000
    v_cmp_gt_u32 vcc, 56, v0
    s_nop 1
    v_cndmask_b32 v6, v42, v6, vcc
L_pf3d:
    s_and_b32 s49, s49, 0xffff
    s_mov_b32 s51, 0x20000
    s_and_b32 s45, s45, 0xffff
    s_mov_b32 s47, 0x20000
    v_and_b32 v24, 6, v23
    v_xor_b32 v24, v24, v22
    v_lshlrev_b32 v24, 4, v24
    v_lshl_add_u32 v24, v23, 7, v24
    v_xor_b32 v25, 64, v24
    s_lshl_b32 s84, s61, 14
    v_add_u32 v8, s84, v24
    v_add_u32 v9, s84, v25
    s_mul_i32 s84, s61, 0
    s_add_u32 s84, s84, 32768
    v_add_u32 v10, s84, v24
    v_add_u32 v11, s84, v25
    v_lshrrev_b32 v24, 5, v0
    v_mul_u32_u24 v24, 10240, v24
    v_and_b32 v26, 1, v22
    v_bfe_u32 v25, v0, 2, 2
    v_lshl_add_u32 v25, v26, 3, v25
    v_lshl_add_u32 v24, v25, 6, v24
    v_and_b32 v25, 1, v0
    v_lshl_add_u32 v24, v25, 3, v24
    v_bfe_u32 v27, v0, 1, 1
    v_lshlrev_b32 v26, 1, v26
    s_mul_i32 s84, s62, 5120
    s_add_u32 s84, s84, 69632
    v_add_u32 v24, s84, v24
    v_add_u32 v25, 0, v27
    v_xor_b32 v25, v25, v26
    v_lshl_add_u32 v12, v25, 4, v24
    v_add_u32 v13, 40960, v12
    v_add_u32 v25, 2, v27
    v_xor_b32 v25, v25, v26
    v_lshl_add_u32 v14, v25, 4, v24
    v_add_u32 v15, 40960, v14
    s_cmp_eq_u32 s61, 1
    s_cselect_b64 vcc, -1, 0
    v_cndmask_b32 v44, v12, v14, vcc
    s_lshl_b32 s84, s62, 12
    v_subrev_u32 v44, s84, v44
    v_add_u32 v45, 40960, v44
    v_mov_b32 v28, 0
    v_mov_b32 v29, 0
    v_mov_b32 v30, 0
    v_mov_b32 v31, 0
    s_cmp_eq_u32 s62, 1
    s_cbranch_scc1 L_early1
    s_mov_b32 exec_lo, 0xffffffff
    s_mov_b32 exec_hi, 0x0
    buffer_load_dword v7, v42, s[44:47], 0 offen
    s_mov_b64 exec, -1
    v_mfma_f32_32x32x16_bf16 a[128:143], v[28:31], v[28:31], 0
    v_mfma_f32_32x32x16_bf16 a[144:159], v[28:31], v[28:31], 0
    v_mfma_f32_32x32x16_bf16 a[160:175], v[28:31], v[28:31], 0
    v_mfma_f32_32x32x16_bf16 a[176:191], v[28:31], v[28:31], 0
    v_mfma_f32_32x32x16_bf16 a[192:207], v[28:31], v[28:31], 0
    v_mfma_f32_32x32x16_bf16 a[208:223], v[28:31], v[28:31], 0
    v_mfma_f32_32x32x16_bf16 a[224:239], v[28:31], v[28:31], 0
    v_mfma_f32_32x32x16_bf16 a[240:255], v[28:31], v[28:31], 0
    v_mfma_f32_32x32x16_bf16 v[128:143], v[28:31], v[28:31], 0
    v_mfma_f32_32x32x16_bf16 v[144:159], v[28:31], v[28:31], 0
    v_mfma_f32_32x32x16_bf16 v[160:175], v[28:31], v[28:31], 0
    v_mfma_f32_32x32x16_bf16 v[176:191], v[28:31], v[28:31], 0
    v_mfma_f32_32x32x16_bf16 v[192:207], v[28:31], v[28:31], 0
    v_mfma_f32_32x32x16_bf16 v[208:223], v[28:31], v[28:31], 0
    v_mfma_f32_32x32x16_bf16 v[224:239], v[28:31], v[28:31], 0
    v_mfma_f32_32x32x16_bf16 v[240:255], v[28:31], v[28:31], 0
    s_waitcnt vmcnt(3)
    s_branch L_ln
L_early1:
    s_mov_b32 exec_lo, 0xffffffff
    s_mov_b32 exec_hi, 0x0
    buffer_load_dword v7, v42, s[44:47], 0 offen
    s_mov_b64 exec, -1
    v_mfma_f32_32x32x16_bf16 a[128:143], v[28:31], v[28:31], 0
    v_mfma_f32_32x32x16_bf16 a[144:159], v[28:31], v[28:31], 0
    v_mfma_f32_32x32x16_bf16 a[160:175], v[28:31], v[28:31], 0
    v_mfma_f32_32x32x16_bf16 a[176:191], v[28:31], v[28:31], 0
    v_mfma_f32_32x32x16_bf16 a[192:207], v[28:31], v[28:31], 0
    v_mfma_f32_32x32x16_bf16 a[208:223], v[28:31], v[28:31], 0
    v_mfma_f32_32x32x16_bf16 a[224:239], v[28:31], v[28:31], 0
    v_mfma_f32_32x32x16_bf16 a[240:255], v[28:31], v[28:31], 0
    v_mfma_f32_32x32x16_bf16 v[128:143], v[28:31], v[28:31], 0
    v_mfma_f32_32x32x16_bf16 v[144:159], v[28:31], v[28:31], 0
    v_mfma_f32_32x32x16_bf16 v[160:175], v[28:31], v[28:31], 0
    v_mfma_f32_32x32x16_bf16 v[176:191], v[28:31], v[28:31], 0
    v_mfma_f32_32x32x16_bf16 v[192:207], v[28:31], v[28:31], 0
    v_mfma_f32_32x32x16_bf16 v[208:223], v[28:31], v[28:31], 0
    v_mfma_f32_32x32x16_bf16 v[224:239], v[28:31], v[28:31], 0
    v_mfma_f32_32x32x16_bf16 v[240:255], v[28:31], v[28:31], 0
    s_waitcnt vmcnt(3)
L_ln:
    v_lshlrev_b32 v64, 16, v48
    v_and_b32 v65, 0xffff0000, v48
    v_lshlrev_b32 v66, 16, v49
    v_and_b32 v67, 0xffff0000, v49
    v_lshlrev_b32 v68, 16, v50
    v_and_b32 v69, 0xffff0000, v50
    v_lshlrev_b32 v70, 16, v51
    v_and_b32 v71, 0xffff0000, v51
    v_lshlrev_b32 v72, 16, v52
    v_and_b32 v73, 0xffff0000, v52
    v_lshlrev_b32 v74, 16, v53
    v_and_b32 v75, 0xffff0000, v53
    v_lshlrev_b32 v76, 16, v54
    v_and_b32 v77, 0xffff0000, v54
    v_lshlrev_b32 v78, 16, v55
    v_and_b32 v79, 0xffff0000, v55
    v_lshlrev_b32 v80, 16, v56
    v_and_b32 v81, 0xffff0000, v56
    v_lshlrev_b32 v82, 16, v57
    v_and_b32 v83, 0xffff0000, v57
    v_lshlrev_b32 v84, 16, v58
    v_and_b32 v85, 0xffff0000, v58
    v_lshlrev_b32 v86, 16, v59
    v_and_b32 v87, 0xffff0000, v59
    v_lshlrev_b32 v88, 16, v60
    v_and_b32 v89, 0xffff0000, v60
    v_lshlrev_b32 v90, 16, v61
    v_and_b32 v91, 0xffff0000, v61
    v_lshlrev_b32 v92, 16, v62
    v_and_b32 v93, 0xffff0000, v62
    v_lshlrev_b32 v94, 16, v63
    v_and_b32 v95, 0xffff0000, v63
    v_pk_add_f32 v[96:97], v[64:65], v[66:67]
    v_pk_add_f32 v[98:99], v[80:81], v[82:83]
    v_pk_add_f32 v[96:97], v[96:97], v[68:69]
    v_pk_add_f32 v[98:99], v[98:99], v[84:85]
    v_pk_add_f32 v[96:97], v[96:97], v[70:71]
    v_pk_add_f32 v[98:99], v[98:99], v[86:87]
    v_pk_add_f32 v[96:97], v[96:97], v[72:73]
    v_pk_add_f32 v[98:99], v[98:99], v[88:89]
    v_pk_add_f32 v[96:97], v[96:97], v[74:75]
    v_pk_add_f32 v[98:99], v[98:99], v[90:91]
    v_pk_add_f32 v[96:97], v[96:97], v[76:77]
    v_pk_add_f32 v[98:99], v[98:99], v[92:93]
    v_pk_add_f32 v[96:97], v[96:97], v[78:79]
    v_pk_add_f32 v[98:99], v[98:99], v[94:95]
    v_add_f32 v102, v96, v97
    v_add_f32 v103, v98, v99
    s_nop 1
    v_permlane32_swap_b32 v102, v103
    v_add_f32 v102, v102, v103
    v_mov_b32 v100, v102
    s_nop 1
    v_permlane16_swap_b32 v102, v100
    v_add_f32 v102, v102, v100
    s_nop 1
    v_add_f32_dpp v102, v102, v102 quad_perm:[1,0,3,2] row_mask:0xf bank_mask:0xf
    s_nop 1
    v_add_f32_dpp v102, v102, v102 quad_perm:[2,3,0,1] row_mask:0xf bank_mask:0xf
    s_nop 1
    v_add_f32_dpp v102, v102, v102 row_half_mirror row_mask:0xf bank_mask:0xf
    s_nop 1
    v_add_f32_dpp v102, v102, v102 row_mirror row_mask:0xf bank_mask:0xf
    v_mul_f32 v102, 0xba800000, v102
    v_cvt_pk_bf16_f32 v106, v102, v102
    v_lshlrev_b32 v106, 16, v106
    v_mov_b32 v103, v102
    s_nop 1
    v_permlane32_swap_b32 v102, v103
    v_mov_b32 v107, v106
    s_nop 1
    v_permlane32_swap_b32 v106, v107
    v_pk_add_f32 v[108:109], v[64:65], v[102:103] op_sel_hi:[1,0]
    v_pk_add_f32 v[110:111], v[80:81], v[102:103] op_sel:[0,1] op_sel_hi:[1,1]
    v_pk_mul_f32 v[96:97], v[108:109], v[108:109]
    v_pk_mul_f32 v[98:99], v[110:111], v[110:111]
    v_pk_add_f32 v[108:109], v[66:67], v[102:103] op_sel_hi:[1,0]
    v_pk_add_f32 v[110:111], v[82:83], v[102:103] op_sel:[0,1] op_sel_hi:[1,1]
    v_pk_fma_f32 v[96:97], v[108:109], v[108:109], v[96:97]
    v_pk_fma_f32 v[98:99], v[110:111], v[110:111], v[98:99]
    v_pk_add_f32 v[108:109], v[68:69], v[102:103] op_sel_hi:[1,0]
    v_pk_add_f32 v[110:111], v[84:85], v[102:103] op_sel:[0,1] op_sel_hi:[1,1]
    v_pk_fma_f32 v[96:97], v[108:109], v[108:109], v[96:97]
    v_pk_fma_f32 v[98:99], v[110:111], v[110:111], v[98:99]
    v_pk_add_f32 v[108:109], v[70:71], v[102:103] op_sel_hi:[1,0]
    v_pk_add_f32 v[110:111], v[86:87], v[102:103] op_sel:[0,1] op_sel_hi:[1,1]
    v_pk_fma_f32 v[96:97], v[108:109], v[108:109], v[96:97]
    v_pk_fma_f32 v[98:99], v[110:111], v[110:111], v[98:99]
    v_pk_add_f32 v[108:109], v[72:73], v[102:103] op_sel_hi:[1,0]
    v_pk_add_f32 v[110:111], v[88:89], v[102:103] op_sel:[0,1] op_sel_hi:[1,1]
    v_pk_fma_f32 v[96:97], v[108:109], v[108:109], v[96:97]
    v_pk_fma_f32 v[98:99], v[110:111], v[110:111], v[98:99]
    v_pk_add_f32 v[108:109], v[74:75], v[102:103] op_sel_hi:[1,0]
    v_pk_add_f32 v[110:111], v[90:91], v[102:103] op_sel:[0,1] op_sel_hi:[1,1]
    v_pk_fma_f32 v[96:97], v[108:109], v[108:109], v[96:97]
    v_pk_fma_f32 v[98:99], v[110:111], v[110:111], v[98:99]
    v_pk_add_f32 v[108:109], v[76:77], v[102:103] op_sel_hi:[1,0]
    v_pk_add_f32 v[110:111], v[92:93], v[102:103] op_sel:[0,1] op_sel_hi:[1,1]
    v_pk_fma_f32 v[96:97], v[108:109], v[108:109], v[96:97]
    v_pk_fma_f32 v[98:99], v[110:111], v[110:111], v[98:99]
    v_pk_add_f32 v[108:109], v[78:79], v[102:103] op_sel_hi:[1,0]
    v_pk_add_f32 v[110:111], v[94:95], v[102:103] op_sel:[0,1] op_sel_hi:[1,1]
    v_pk_fma_f32 v[96:97], v[108:109], v[108:109], v[96:97]
    v_pk_fma_f32 v[98:99], v[110:111], v[110:111], v[98:99]
    v_add_f32 v104, v96, v97
    v_add_f32 v105, v98, v99
    s_nop 1
    v_permlane32_swap_b32 v104, v105
    v_add_f32 v104, v104, v105
    v_mov_b32 v100, v104
    s_nop 1
    v_permlane16_swap_b32 v104, v100
    v_add_f32 v104, v104, v100
    s_nop 1
    v_add_f32_dpp v104, v104, v104 quad_perm:[1,0,3,2] row_mask:0xf bank_mask:0xf
    s_nop 1
    v_add_f32_dpp v104, v104, v104 quad_perm:[2,3,0,1] row_mask:0xf bank_mask:0xf
    s_nop 1
    v_add_f32_dpp v104, v104, v104 row_half_mirror row_mask:0xf bank_mask:0xf
    s_nop 1
    v_add_f32_dpp v104, v104, v104 row_mirror row_mask:0xf bank_mask:0xf
    v_mul_f32 v104, 0x3a800000, v104
    v_cvt_pk_bf16_f32 v104, v104, v104
    v_lshlrev_b32 v104, 16, v104
    v_add_f32 v104, 0x3727c5ac, v104
    v_cvt_pk_bf16_f32 v104, v104, v104
    v_lshlrev_b32 v104, 16, v104
    v_sqrt_f32 v104, v104
    s_nop 0
    v_cvt_pk_bf16_f32 v104, v104, v104
    v_lshlrev_b32 v104, 16, v104
    v_rcp_f32 v100, v104
    s_nop 0
    v_fma_f32 v104, -v104, v100, 1.0
    v_fma_f32 v104, v104, v100, v100
    v_mov_b32 v105, v104
    s_nop 1
    v_permlane32_swap_b32 v104, v105
    v_pk_add_f32 v[64:65], v[64:65], v[106:107] op_sel_hi:[1,0]
    v_pk_add_f32 v[66:67], v[66:67], v[106:107] op_sel_hi:[1,0]
    v_pk_add_f32 v[68:69], v[68:69], v[106:107] op_sel_hi:[1,0]
    v_pk_add_f32 v[70:71], v[70:71], v[106:107] op_sel_hi:[1,0]
    v_cvt_pk_bf16_f32 v65, v64, v65
    v_cvt_pk_bf16_f32 v67, v66, v67
    v_cvt_pk_bf16_f32 v69, v68, v69
    v_cvt_pk_bf16_f32 v71, v70, v71
    v_lshlrev_b32 v64, 16, v65
    v_and_b32 v65, 0xffff0000, v65
    v_lshlrev_b32 v66, 16, v67
    v_and_b32 v67, 0xffff0000, v67
    v_lshlrev_b32 v68, 16, v69
    v_and_b32 v69, 0xffff0000, v69
    v_lshlrev_b32 v70, 16, v71
    v_and_b32 v71, 0xffff0000, v71
    v_pk_mul_f32 v[64:65], v[64:65], v[104:105] op_sel_hi:[1,0]
    v_pk_mul_f32 v[66:67], v[66:67], v[104:105] op_sel_hi:[1,0]
    v_pk_mul_f32 v[68:69], v[68:69], v[104:105] op_sel_hi:[1,0]
    v_pk_mul_f32 v[70:71], v[70:71], v[104:105] op_sel_hi:[1,0]
    v_cvt_pk_bf16_f32 v48, v64, v65
    v_cvt_pk_bf16_f32 v49, v66, v67
    v_cvt_pk_bf16_f32 v50, v68, v69
    v_cvt_pk_bf16_f32 v51, v70, v71
    global_store_dwordx4 v36, v[48:51], s[26:27] offset:0 sc1
    v_pk_add_f32 v[72:73], v[72:73], v[106:107] op_sel_hi:[1,0]
    v_pk_add_f32 v[74:75], v[74:75], v[106:107] op_sel_hi:[1,0]
    v_pk_add_f32 v[76:77], v[76:77], v[106:107] op_sel_hi:[1,0]
    v_pk_add_f32 v[78:79], v[78:79], v[106:107] op_sel_hi:[1,0]
    v_cvt_pk_bf16_f32 v73, v72, v73
    v_cvt_pk_bf16_f32 v75, v74, v75
    v_cvt_pk_bf16_f32 v77, v76, v77
    v_cvt_pk_bf16_f32 v79, v78, v79
    v_lshlrev_b32 v72, 16, v73
    v_and_b32 v73, 0xffff0000, v73
    v_lshlrev_b32 v74, 16, v75
    v_and_b32 v75, 0xffff0000, v75
    v_lshlrev_b32 v76, 16, v77
    v_and_b32 v77, 0xffff0000, v77
    v_lshlrev_b32 v78, 16, v79
    v_and_b32 v79, 0xffff0000, v79
    v_pk_mul_f32 v[72:73], v[72:73], v[104:105] op_sel_hi:[1,0]
    v_pk_mul_f32 v[74:75], v[74:75], v[104:105] op_sel_hi:[1,0]
    v_pk_mul_f32 v[76:77], v[76:77], v[104:105] op_sel_hi:[1,0]
    v_pk_mul_f32 v[78:79], v[78:79], v[104:105] op_sel_hi:[1,0]
    v_cvt_pk_bf16_f32 v52, v72, v73
    v_cvt_pk_bf16_f32 v53, v74, v75
    v_cvt_pk_bf16_f32 v54, v76, v77
    v_cvt_pk_bf16_f32 v55, v78, v79
    global_store_dwordx4 v36, v[52:55], s[26:27] offset:1024 sc1
    v_pk_add_f32 v[80:81], v[80:81], v[106:107] op_sel:[0,1] op_sel_hi:[1,1]
    v_pk_add_f32 v[82:83], v[82:83], v[106:107] op_sel:[0,1] op_sel_hi:[1,1]
    v_pk_add_f32 v[84:85], v[84:85], v[106:107] op_sel:[0,1] op_sel_hi:[1,1]
    v_pk_add_f32 v[86:87], v[86:87], v[106:107] op_sel:[0,1] op_sel_hi:[1,1]
    v_cvt_pk_bf16_f32 v81, v80, v81
    v_cvt_pk_bf16_f32 v83, v82, v83
    v_cvt_pk_bf16_f32 v85, v84, v85
    v_cvt_pk_bf16_f32 v87, v86, v87
    v_lshlrev_b32 v80, 16, v81
    v_and_b32 v81, 0xffff0000, v81
    v_lshlrev_b32 v82, 16, v83
    v_and_b32 v83, 0xffff0000, v83
    v_lshlrev_b32 v84, 16, v85
    v_and_b32 v85, 0xffff0000, v85
    v_lshlrev_b32 v86, 16, v87
    v_and_b32 v87, 0xffff0000, v87
    v_pk_mul_f32 v[80:81], v[80:81], v[104:105] op_sel:[0,1] op_sel_hi:[1,1]
    v_pk_mul_f32 v[82:83], v[82:83], v[104:105] op_sel:[0,1] op_sel_hi:[1,1]
    v_pk_mul_f32 v[84:85], v[84:85], v[104:105] op_sel:[0,1] op_sel_hi:[1,1]
    v_pk_mul_f32 v[86:87], v[86:87], v[104:105] op_sel:[0,1] op_sel_hi:[1,1]
    v_cvt_pk_bf16_f32 v56, v80, v81
    v_cvt_pk_bf16_f32 v57, v82, v83
    v_cvt_pk_bf16_f32 v58, v84, v85
    v_cvt_pk_bf16_f32 v59, v86, v87
    global_store_dwordx4 v36, v[56:59], s[26:27] offset:2048 sc1
    v_pk_add_f32 v[88:89], v[88:89], v[106:107] op_sel:[0,1] op_sel_hi:[1,1]
    v_pk_add_f32 v[90:91], v[90:91], v[106:107] op_sel:[0,1] op_sel_hi:[1,1]
    v_pk_add_f32 v[92:93], v[92:93], v[106:107] op_sel:[0,1] op_sel_hi:[1,1]
    v_pk_add_f32 v[94:95], v[94:95], v[106:107] op_sel:[0,1] op_sel_hi:[1,1]
    v_cvt_pk_bf16_f32 v89, v88, v89
    v_cvt_pk_bf16_f32 v91, v90, v91
    v_cvt_pk_bf16_f32 v93, v92, v93
    v_cvt_pk_bf16_f32 v95, v94, v95
    v_lshlrev_b32 v88, 16, v89
    v_and_b32 v89, 0xffff0000, v89
    v_lshlrev_b32 v90, 16, v91
    v_and_b32 v91, 0xffff0000, v91
    v_lshlrev_b32 v92, 16, v93
    v_and_b32 v93, 0xffff0000, v93
    v_lshlrev_b32 v94, 16, v95
    v_and_b32 v95, 0xffff0000, v95
    v_pk_mul_f32 v[88:89], v[88:89], v[104:105] op_sel:[0,1] op_sel_hi:[1,1]
    v_pk_mul_f32 v[90:91], v[90:91], v[104:105] op_sel:[0,1] op_sel_hi:[1,1]
    v_pk_mul_f32 v[92:93], v[92:93], v[104:105] op_sel:[0,1] op_sel_hi:[1,1]
    v_pk_mul_f32 v[94:95], v[94:95], v[104:105] op_sel:[0,1] op_sel_hi:[1,1]
    v_cvt_pk_bf16_f32 v60, v88, v89
    v_cvt_pk_bf16_f32 v61, v90, v91
    v_cvt_pk_bf16_f32 v62, v92, v93
    v_cvt_pk_bf16_f32 v63, v94, v95
    global_store_dwordx4 v36, v[60:63], s[26:27] offset:3072 sc1
    s_waitcnt vmcnt(5)
    v_add_u32 v40, 1, v40
    s_waitcnt vmcnt(0)
    s_mov_b64 exec, 1
    global_store_dword v37, v40, s[26:27] sc1
    s_mov_b64 exec, -1
    buffer_load_dword v7, v42, s[44:47], 0 offen
    v_add_u32_e64 v42, s86, v42
    s_barrier
    v_mfma_f32_32x32x16_bf16 v[48:63], v[28:31], v[28:31], 0
    v_mfma_f32_32x32x16_bf16 v[64:79], v[28:31], v[28:31], 0
    v_mfma_f32_32x32x16_bf16 v[80:95], v[28:31], v[28:31], 0
    v_mfma_f32_32x32x16_bf16 v[96:111], v[28:31], v[28:31], 0
    v_mfma_f32_32x32x16_bf16 v[112:127], v[28:31], v[28:31], 0
    s_mov_b32 s67, 0
    s_cmp_lg_u32 s60, 3
    s_cbranch_scc1 L_noarr
    s_lshl_b32 s84, s63, 5
    v_mov_b32 v20, s84
    v_mov_b32 v21, 1
    s_mov_b64 exec, 1
    global_atomic_add v20, v21, s[24:25] sc1
    s_mov_b64 exec, -1
L_noarr:
    s_cmp_eq_u32 s62, 0
    s_cbranch_scc1 L_now
    s_add_u32 m0, s78, 0
    s_nop 0
    buffer_load_dwordx4 v2, s[32:35], s68 offen offset:0 lds
    buffer_load_dwordx4 v2, s[32:35], s69 offen offset:1024 lds
    buffer_load_dwordx4 v2, s[32:35], s70 offen offset:2048 lds
    v_add_u32 v2, 196608, v2
    buffer_load_dwordx4 v3, s[36:39], s71 offen offset:3072 lds
    s_add_u32 m0, s78, 4096
    s_nop 0
    buffer_load_dwordx4 v3, s[40:43], s72 offen offset:0 lds
    buffer_load_dwordx4 v3, s[36:39], s73 offen offset:1024 lds
    buffer_load_dwordx4 v3, s[40:43], s74 offen offset:2048 lds
    buffer_load_dwordx4 v3, s[36:39], s75 offen offset:3072 lds
    s_add_u32 m0, s78, 8192
    s_nop 0
    buffer_load_dwordx4 v3, s[40:43], s76 offen offset:0 lds
    v_add_u32 v3, 229376, v3
    global_load_lds_dwordx4 v[4:5], off offset:1024
    v_lshl_add_u64 v[4:5], v[4:5], 0, s[80:81]
    s_add_u32 m0, s78, 20480
    s_nop 0
    buffer_load_dwordx4 v2, s[32:35], s68 offen offset:0 lds
    buffer_load_dwordx4 v2, s[32:35], s69 offen offset:1024 lds
    buffer_load_dwordx4 v2, s[32:35], s70 offen offset:2048 lds
    v_add_u32 v2, 196608, v2
    buffer_load_dwordx4 v3, s[36:39], s71 offen offset:3072 lds
    s_add_u32 m0, s78, 24576
    s_nop 0
    buffer_load_dwordx4 v3, s[40:43], s72 offen offset:0 lds
    buffer_load_dwordx4 v3, s[36:39], s73 offen offset:1024 lds
    buffer_load_dwordx4 v3, s[40:43], s74 offen offset:2048 lds
    buffer_load_dwordx4 v3, s[36:39], s75 offen offset:3072 lds
    s_add_u32 m0, s78, 28672
    s_nop 0
    buffer_load_dwordx4 v3, s[40:43], s76 offen offset:0 lds
    v_add_u32 v3, 229376, v3
    global_load_lds_dwordx4 v[4:5], off offset:1024
    v_lshl_add_u64 v[4:5], v[4:5], 0, s[80:81]
L_now:
    s_cmp_eq_u32 s60, 3
    s_cbranch_scc1 L_stub0
    s_cmp_eq_u32 s60, 2
    s_cbranch_scc1 L_stub1
    s_cmp_eq_u32 s60, 1
    s_cbranch_scc1 L_stub2
    s_cmp_eq_u32 s60, 0
    s_cbranch_scc1 L_stub3
L_stubret:
    s_cmp_eq_u32 s87, 1
    s_cbranch_scc1 L_lnok
L_lnpoll:
    global_load_dword v20, v38, s[26:27] sc1
    s_waitcnt vmcnt(0)
    v_cmp_ne_u32 vcc, v20, v39
    s_cmp_eq_u64 vcc, -1
    s_cbranch_scc1 L_lnok
    s_add_u32 s67, s67, 1
    s_and_b32 s84, s67, 3
    s_cbranch_scc1 L_lnpoll
    global_load_dword v20, v41, s[24:25] sc1
    s_waitcnt vmcnt(0)
    v_readfirstlane_b32 s84, v20
    s_cmp_ge_u32 s84, 32
    s_cbranch_scc1 L_lnok
    s_cmp_lt_u32 s67, 0x40000
    s_cbranch_scc1 L_lnpoll
L_lnok:
    s_cmp_eq_u32 s62, 1
    s_cbranch_scc1 L_g1_1
    s_branch L_g1_0
.p2align 12
L_stub0:
    s_branch L_stub4
L_g1_0:
    v_add_u32 v2, 131072, v1
    s_add_u32 m0, s78, 0
    s_nop 0
    buffer_load_dwordx4 v1, s[28:31], s68 offen offset:0 sc1 lds
    buffer_load_dwordx4 v1, s[28:31], s69 offen offset:1024 sc1 lds
    buffer_load_dwordx4 v1, s[28:31], s70 offen offset:2048 sc1 lds
    buffer_load_dwordx4 v1, s[28:31], s71 offen offset:3072 sc1 lds
    s_add_u32 m0, s78, 4096
    s_nop 0
    buffer_load_dwordx4 v1, s[28:31], s72 offen offset:0 sc1 lds
    buffer_load_dwordx4 v1, s[28:31], s73 offen offset:1024 sc1 lds
    buffer_load_dwordx4 v1, s[28:31], s74 offen offset:2048 sc1 lds
    buffer_load_dwordx4 v1, s[28:31], s75 offen offset:3072 sc1 lds
    v_add_u32 v1, 128, v1
    s_add_u32 m0, s78, 8192
    s_nop 0
    buffer_load_dwordx4 v2, s[28:31], s68 offen offset:0 sc1 lds
    buffer_load_dwordx4 v2, s[28:31], s69 offen offset:1024 sc1 lds
    buffer_load_dwordx4 v2, s[28:31], s70 offen offset:2048 sc1 lds
    buffer_load_dwordx4 v2, s[28:31], s71 offen offset:3072 sc1 lds
    s_add_u32 m0, s78, 12288
    s_nop 0
    buffer_load_dwordx4 v2, s[28:31], s72 offen offset:0 sc1 lds
    buffer_load_dwordx4 v2, s[28:31], s73 offen offset:1024 sc1 lds
    buffer_load_dwordx4 v2, s[28:31], s74 offen offset:2048 sc1 lds
    buffer_load_dwordx4 v2, s[28:31], s75 offen offset:3072 sc1 lds
    v_add_u32 v2, 128, v2
    s_add_u32 m0, s78, 34816
    s_nop 0
    buffer_load_dwordx4 v1, s[28:31], s68 offen offset:0 sc1 lds
    buffer_load_dwordx4 v1, s[28:31], s69 offen offset:1024 sc1 lds
    buffer_load_dwordx4 v1, s[28:31], s70 offen offset:2048 sc1 lds
    buffer_load_dwordx4 v1, s[28:31], s71 offen offset:3072 sc1 lds
    s_add_u32 m0, s78, 38912
    s_nop 0
    buffer_load_dwordx4 v1, s[28:31], s72 offen offset:0 sc1 lds
    buffer_load_dwordx4 v1, s[28:31], s73 offen offset:1024 sc1 lds
    buffer_load_dwordx4 v1, s[28:31], s74 offen offset:2048 sc1 lds
    buffer_load_dwordx4 v1, s[28:31], s75 offen offset:3072 sc1 lds
    v_add_u32 v1, 128, v1
    s_add_u32 m0, s78, 43008
    s_nop 0
    buffer_load_dwordx4 v2, s[28:31], s68 offen offset:0 sc1 lds
    buffer_load_dwordx4 v2, s[28:31], s69 offen offset:1024 sc1 lds
    buffer_load_dwordx4 v2, s[28:31], s70 offen offset:2048 sc1 lds
    buffer_load_dwordx4 v2, s[28:31], s71 offen offset:3072 sc1 lds
    s_add_u32 m0, s78, 47104
    s_nop 0
    buffer_load_dwordx4 v2, s[28:31], s72 offen offset:0 sc1 lds
    buffer_load_dwordx4 v2, s[28:31], s73 offen offset:1024 sc1 lds
    buffer_load_dwordx4 v2, s[28:31], s74 offen offset:2048 sc1 lds
    buffer_load_dwordx4 v2, s[28:31], s75 offen offset:3072 sc1 lds
    v_add_u32 v2, 128, v2
    s_barrier
    s_waitcnt vmcnt(16)
    s_barrier
    ds_read_b64_tr_b16 a[64:65], v12 offset:0
    ds_read_b64_tr_b16 a[66:67], v12 offset:256
    ds_read_b64_tr_b16 a[68:69], v14 offset:0
    ds_read_b64_tr_b16 a[70:71], v14 offset:256
    ds_read_b64_tr_b16 a[72:73], v12 offset:1024
    ds_read_b64_tr_b16 a[74:75], v12 offset:1280
    ds_read_b64_tr_b16 a[76:77], v14 offset:1024
    ds_read_b64_tr_b16 a[78:79], v14 offset:1280
    ds_read_b64_tr_b16 a[80:81], v12 offset:2048
    ds_read_b64_tr_b16 a[82:83], v12 offset:2304
    ds_read_b64_tr_b16 a[84:85], v14 offset:2048
    ds_read_b64_tr_b16 a[86:87], v14 offset:2304
    ds_read_b64_tr_b16 a[88:89], v12 offset:3072
    ds_read_b64_tr_b16 a[90:91], v12 offset:3328
    ds_read_b64_tr_b16 a[92:93], v14 offset:3072
    ds_read_b64_tr_b16 a[94:95], v14 offset:3328
    ds_read_b64_tr_b16 a[96:97], v12 offset:4096
    ds_read_b64_tr_b16 a[98:99], v12 offset:4352
    ds_read_b64_tr_b16 a[100:101], v14 offset:4096
    ds_read_b64_tr_b16 a[102:103], v14 offset:4352
    ds_read_b128 a[0:3], v8 offset:0
    ds_read_b128 a[4:7], v8 offset:2048
    ds_read_b128 a[8:11], v8 offset:4096
    ds_read_b128 a[12:15], v8 offset:6144
    ds_read_b128 a[16:19], v8 offset:8192
    ds_read_b128 a[20:23], v8 offset:10240
    ds_read_b128 a[24:27], v8 offset:12288
    ds_read_b128 a[28:31], v8 offset:14336
    ds_read_b128 a[112:115], v10 offset:0
    ds_read_b64_tr_b16 a[120:121], v44 offset:0
    ds_read_b64_tr_b16 a[122:123], v44 offset:256
    s_mov_b32 s67, 7
    v_mov_b32 v20, 0x7ff00000
.p2align 3
L_loop0:
    s_waitcnt lgkmcnt(0)
    s_barrier
    v_mfma_f32_16x16x32_bf16 v[120:123], a[120:123], a[112:115], v[120:123]
    buffer_load_dword v7, v6, s[44:47], s4 offen
    v_add_u32_e64 v6, s79, v6
    v_mfma_f32_16x16x32_bf16 a[128:131], a[64:67], a[0:3], a[128:131]
    v_mfma_f32_16x16x32_bf16 a[136:139], a[64:67], a[4:7], a[136:139]
    v_mfma_f32_16x16x32_bf16 a[144:147], a[64:67], a[8:11], a[144:147]
    ds_read_b128 a[32:35], v9 offset:0
    v_mfma_f32_16x16x32_bf16 a[152:155], a[64:67], a[12:15], a[152:155]
    v_mfma_f32_16x16x32_bf16 a[160:163], a[64:67], a[16:19], a[160:163]
    v_mfma_f32_16x16x32_bf16 a[168:171], a[64:67], a[20:23], a[168:171]
    v_mfma_f32_16x16x32_bf16 a[176:179], a[64:67], a[24:27], a[176:179]
    ds_read_b128 a[36:39], v9 offset:2048
    v_mfma_f32_16x16x32_bf16 a[184:187], a[64:67], a[28:31], a[184:187]
    ds_read_b64_tr_b16 a[64:65], v12 offset:20480
    v_mfma_f32_16x16x32_bf16 a[132:135], a[68:71], a[0:3], a[132:135]
    ds_read_b64_tr_b16 a[66:67], v12 offset:20736
    v_mfma_f32_16x16x32_bf16 a[140:143], a[68:71], a[4:7], a[140:143]
    v_mfma_f32_16x16x32_bf16 a[148:151], a[68:71], a[8:11], a[148:151]
    ds_read_b128 a[40:43], v9 offset:4096
    v_mfma_f32_16x16x32_bf16 a[156:159], a[68:71], a[12:15], a[156:159]
    v_mfma_f32_16x16x32_bf16 a[164:167], a[68:71], a[16:19], a[164:167]
    v_mfma_f32_16x16x32_bf16 a[172:175], a[68:71], a[20:23], a[172:175]
    v_mfma_f32_16x16x32_bf16 a[180:183], a[68:71], a[24:27], a[180:183]
    ds_read_b128 a[44:47], v9 offset:6144
    v_mfma_f32_16x16x32_bf16 a[188:191], a[68:71], a[28:31], a[188:191]
    ds_read_b64_tr_b16 a[68:69], v14 offset:20480
    v_mfma_f32_16x16x32_bf16 v[52:55], a[0:3], a[72:75], v[52:55]
    ds_read_b64_tr_b16 a[70:71], v14 offset:20736
    v_mfma_f32_16x16x32_bf16 v[56:59], a[4:7], a[72:75], v[56:59]
    v_mfma_f32_16x16x32_bf16 v[60:63], a[8:11], a[72:75], v[60:63]
    ds_read_b128 a[48:51], v9 offset:8192
    v_mfma_f32_16x16x32_bf16 v[64:67], a[12:15], a[72:75], v[64:67]
    v_mfma_f32_16x16x32_bf16 v[68:71], a[16:19], a[72:75], v[68:71]
    v_mfma_f32_16x16x32_bf16 v[72:75], a[20:23], a[72:75], v[72:75]
    v_mfma_f32_16x16x32_bf16 v[76:79], a[24:27], a[72:75], v[76:79]
    ds_read_b128 a[52:55], v9 offset:10240
    v_mfma_f32_16x16x32_bf16 v[80:83], a[28:31], a[72:75], v[80:83]
    ds_read_b64_tr_b16 a[72:73], v12 offset:21504
    v_mfma_f32_16x16x32_bf16 v[88:91], a[0:3], a[76:79], v[88:91]
    ds_read_b64_tr_b16 a[74:75], v12 offset:21760
    v_mfma_f32_16x16x32_bf16 v[92:95], a[4:7], a[76:79], v[92:95]
    v_mfma_f32_16x16x32_bf16 v[96:99], a[8:11], a[76:79], v[96:99]
    ds_read_b128 a[56:59], v9 offset:12288
    v_mfma_f32_16x16x32_bf16 v[100:103], a[12:15], a[76:79], v[100:103]
    v_mfma_f32_16x16x32_bf16 v[104:107], a[16:19], a[76:79], v[104:107]
    v_mfma_f32_16x16x32_bf16 v[108:111], a[20:23], a[76:79], v[108:111]
    v_mfma_f32_16x16x32_bf16 v[112:115], a[24:27], a[76:79], v[112:115]
    ds_read_b128 a[60:63], v9 offset:14336
    v_mfma_f32_16x16x32_bf16 v[116:119], a[28:31], a[76:79], v[116:119]
    ds_read_b64_tr_b16 a[76:77], v14 offset:21504
    v_mfma_f32_16x16x32_bf16 a[192:195], a[80:83], a[0:3], a[192:195]
    ds_read_b64_tr_b16 a[78:79], v14 offset:21760
    v_mfma_f32_16x16x32_bf16 a[200:203], a[80:83], a[4:7], a[200:203]
    v_mfma_f32_16x16x32_bf16 a[208:211], a[80:83], a[8:11], a[208:211]
    ds_read_b128 a[116:119], v11 offset:0
    v_mfma_f32_16x16x32_bf16 a[216:219], a[80:83], a[12:15], a[216:219]
    v_mfma_f32_16x16x32_bf16 a[224:227], a[80:83], a[16:19], a[224:227]
    v_mfma_f32_16x16x32_bf16 a[232:235], a[80:83], a[20:23], a[232:235]
    v_mfma_f32_16x16x32_bf16 a[240:243], a[80:83], a[24:27], a[240:243]
    ds_read_b64_tr_b16 a[104:105], v12 offset:24576
    v_mfma_f32_16x16x32_bf16 a[248:251], a[80:83], a[28:31], a[248:251]
    ds_read_b64_tr_b16 a[80:81], v12 offset:22528
    v_mfma_f32_16x16x32_bf16 a[196:199], a[84:87], a[0:3], a[196:199]
    ds_read_b64_tr_b16 a[82:83], v12 offset:22784
    v_mfma_f32_16x16x32_bf16 a[204:207], a[84:87], a[4:7], a[204:207]
    v_mfma_f32_16x16x32_bf16 a[212:215], a[84:87], a[8:11], a[212:215]
    ds_read_b64_tr_b16 a[106:107], v12 offset:24832
    v_mfma_f32_16x16x32_bf16 a[220:223], a[84:87], a[12:15], a[220:223]
    v_mfma_f32_16x16x32_bf16 a[228:231], a[84:87], a[16:19], a[228:231]
    v_mfma_f32_16x16x32_bf16 a[236:239], a[84:87], a[20:23], a[236:239]
    v_mfma_f32_16x16x32_bf16 a[244:247], a[84:87], a[24:27], a[244:247]
    ds_read_b64_tr_b16 a[108:109], v14 offset:24576
    v_mfma_f32_16x16x32_bf16 a[252:255], a[84:87], a[28:31], a[252:255]
    ds_read_b64_tr_b16 a[84:85], v14 offset:22528
    v_mfma_f32_16x16x32_bf16 v[128:131], a[88:91], a[0:3], v[128:131]
    ds_read_b64_tr_b16 a[86:87], v14 offset:22784
    v_mfma_f32_16x16x32_bf16 v[144:147], a[88:91], a[4:7], v[144:147]
    v_mfma_f32_16x16x32_bf16 v[160:163], a[88:91], a[8:11], v[160:163]
    ds_read_b64_tr_b16 a[110:111], v14 offset:24832
    v_mfma_f32_16x16x32_bf16 v[176:179], a[88:91], a[12:15], v[176:179]
    v_mfma_f32_16x16x32_bf16 v[192:195], a[88:91], a[16:19], v[192:195]
    v_mfma_f32_16x16x32_bf16 v[208:211], a[88:91], a[20:23], v[208:211]
    v_mfma_f32_16x16x32_bf16 v[224:227], a[88:91], a[24:27], v[224:227]
    ds_read_b64_tr_b16 a[124:125], v44 offset:20480
    v_mfma_f32_16x16x32_bf16 v[240:243], a[88:91], a[28:31], v[240:243]
    ds_read_b64_tr_b16 a[88:89], v12 offset:23552
    v_mfma_f32_16x16x32_bf16 v[132:135], a[92:95], a[0:3], v[132:135]
    ds_read_b64_tr_b16 a[90:91], v12 offset:23808
    v_mfma_f32_16x16x32_bf16 v[148:151], a[92:95], a[4:7], v[148:151]
    v_mfma_f32_16x16x32_bf16 v[164:167], a[92:95], a[8:11], v[164:167]
    ds_read_b64_tr_b16 a[126:127], v44 offset:20736
    v_mfma_f32_16x16x32_bf16 v[180:183], a[92:95], a[12:15], v[180:183]
    v_mfma_f32_16x16x32_bf16 v[196:199], a[92:95], a[16:19], v[196:199]
    v_mfma_f32_16x16x32_bf16 v[212:215], a[92:95], a[20:23], v[212:215]
    v_mfma_f32_16x16x32_bf16 v[228:231], a[92:95], a[24:27], v[228:231]
    v_mfma_f32_16x16x32_bf16 v[244:247], a[92:95], a[28:31], v[244:247]
    ds_read_b64_tr_b16 a[92:93], v14 offset:23552
    v_mfma_f32_16x16x32_bf16 v[136:139], a[96:99], a[0:3], v[136:139]
    ds_read_b64_tr_b16 a[94:95], v14 offset:23808
    v_mfma_f32_16x16x32_bf16 v[152:155], a[96:99], a[4:7], v[152:155]
    v_mfma_f32_16x16x32_bf16 v[168:171], a[96:99], a[8:11], v[168:171]
    v_mfma_f32_16x16x32_bf16 v[184:187], a[96:99], a[12:15], v[184:187]
    v_mfma_f32_16x16x32_bf16 v[200:203], a[96:99], a[16:19], v[200:203]
    v_mfma_f32_16x16x32_bf16 v[216:219], a[96:99], a[20:23], v[216:219]
    v_mfma_f32_16x16x32_bf16 v[232:235], a[96:99], a[24:27], v[232:235]
    v_mfma_f32_16x16x32_bf16 v[248:251], a[96:99], a[28:31], v[248:251]
    v_mfma_f32_16x16x32_bf16 v[140:143], a[100:103], a[0:3], v[140:143]
    v_mfma_f32_16x16x32_bf16 v[156:159], a[100:103], a[4:7], v[156:159]
    v_mfma_f32_16x16x32_bf16 v[172:175], a[100:103], a[8:11], v[172:175]
    v_mfma_f32_16x16x32_bf16 v[188:191], a[100:103], a[12:15], v[188:191]
    v_mfma_f32_16x16x32_bf16 v[204:207], a[100:103], a[16:19], v[204:207]
    v_mfma_f32_16x16x32_bf16 v[220:223], a[100:103], a[20:23], v[220:223]
    v_mfma_f32_16x16x32_bf16 v[236:239], a[100:103], a[24:27], v[236:239]
    v_mfma_f32_16x16x32_bf16 v[252:255], a[100:103], a[28:31], v[252:255]
    s_waitcnt vmcnt(1) lgkmcnt(0)
    s_barrier
    v_mfma_f32_16x16x32_bf16 v[120:123], a[124:127], a[116:119], v[120:123]
    s_add_u32 m0, s78, 0
    v_mfma_f32_16x16x32_bf16 a[128:131], a[64:67], a[32:35], a[128:131]
    buffer_load_dwordx4 v1, s[28:31], s68 offen offset:0 sc1 lds
    v_mfma_f32_16x16x32_bf16 a[136:139], a[64:67], a[36:39], a[136:139]
    v_mfma_f32_16x16x32_bf16 a[144:147], a[64:67], a[40:43], a[144:147]
    ds_read_b128 a[0:3], v8 offset:34816
    v_mfma_f32_16x16x32_bf16 a[152:155], a[64:67], a[44:47], a[152:155]
    buffer_load_dwordx4 v1, s[28:31], s69 offen offset:1024 sc1 lds
    v_mfma_f32_16x16x32_bf16 a[160:163], a[64:67], a[48:51], a[160:163]
    v_mfma_f32_16x16x32_bf16 a[168:171], a[64:67], a[52:55], a[168:171]
    v_mfma_f32_16x16x32_bf16 a[176:179], a[64:67], a[56:59], a[176:179]
    ds_read_b128 a[4:7], v8 offset:36864
    v_mfma_f32_16x16x32_bf16 a[184:187], a[64:67], a[60:63], a[184:187]
    ds_read_b64_tr_b16 a[64:65], v13 offset:0
    v_mfma_f32_16x16x32_bf16 a[132:135], a[68:71], a[32:35], a[132:135]
    ds_read_b64_tr_b16 a[66:67], v13 offset:256
    v_mfma_f32_16x16x32_bf16 a[140:143], a[68:71], a[36:39], a[140:143]
    buffer_load_dwordx4 v1, s[28:31], s70 offen offset:2048 sc1 lds
    v_mfma_f32_16x16x32_bf16 a[148:151], a[68:71], a[40:43], a[148:151]
    ds_read_b128 a[8:11], v8 offset:38912
    v_mfma_f32_16x16x32_bf16 a[156:159], a[68:71], a[44:47], a[156:159]
    buffer_load_dwordx4 v1, s[28:31], s71 offen offset:3072 sc1 lds
    v_mfma_f32_16x16x32_bf16 a[164:167], a[68:71], a[48:51], a[164:167]
    v_mfma_f32_16x16x32_bf16 a[172:175], a[68:71], a[52:55], a[172:175]
    v_mfma_f32_16x16x32_bf16 a[180:183], a[68:71], a[56:59], a[180:183]
    ds_read_b128 a[12:15], v8 offset:40960
    v_mfma_f32_16x16x32_bf16 a[188:191], a[68:71], a[60:63], a[188:191]
    ds_read_b64_tr_b16 a[68:69], v15 offset:0
    v_mfma_f32_16x16x32_bf16 v[52:55], a[32:35], a[72:75], v[52:55]
    ds_read_b64_tr_b16 a[70:71], v15 offset:256
    s_add_u32 m0, s78, 4096
    v_mfma_f32_16x16x32_bf16 v[56:59], a[36:39], a[72:75], v[56:59]
    buffer_load_dwordx4 v1, s[28:31], s72 offen offset:0 sc1 lds
    v_mfma_f32_16x16x32_bf16 v[60:63], a[40:43], a[72:75], v[60:63]
    ds_read_b128 a[16:19], v8 offset:43008
    v_mfma_f32_16x16x32_bf16 v[64:67], a[44:47], a[72:75], v[64:67]
    buffer_load_dwordx4 v1, s[28:31], s73 offen offset:1024 sc1 lds
    v_mfma_f32_16x16x32_bf16 v[68:71], a[48:51], a[72:75], v[68:71]
    v_mfma_f32_16x16x32_bf16 v[72:75], a[52:55], a[72:75], v[72:75]
    v_mfma_f32_16x16x32_bf16 v[76:79], a[56:59], a[72:75], v[76:79]
    ds_read_b128 a[20:23], v8 offset:45056
    v_mfma_f32_16x16x32_bf16 v[80:83], a[60:63], a[72:75], v[80:83]
    ds_read_b64_tr_b16 a[72:73], v13 offset:1024
    v_mfma_f32_16x16x32_bf16 v[88:91], a[32:35], a[76:79], v[88:91]
    ds_read_b64_tr_b16 a[74:75], v13 offset:1280
    v_mfma_f32_16x16x32_bf16 v[92:95], a[36:39], a[76:79], v[92:95]
    buffer_load_dwordx4 v1, s[28:31], s74 offen offset:2048 sc1 lds
    v_mfma_f32_16x16x32_bf16 v[96:99], a[40:43], a[76:79], v[96:99]
    ds_read_b128 a[24:27], v8 offset:47104
    v_mfma_f32_16x16x32_bf16 v[100:103], a[44:47], a[76:79], v[100:103]
    buffer_load_dwordx4 v1, s[28:31], s75 offen offset:3072 sc1 lds
    v_add_u32 v1, 128, v1
    v_mfma_f32_16x16x32_bf16 v[104:107], a[48:51], a[76:79], v[104:107]
    v_mfma_f32_16x16x32_bf16 v[108:111], a[52:55], a[76:79], v[108:111]
    v_mfma_f32_16x16x32_bf16 v[112:115], a[56:59], a[76:79], v[112:115]
    ds_read_b128 a[28:31], v8 offset:49152
    v_mfma_f32_16x16x32_bf16 v[116:119], a[60:63], a[76:79], v[116:119]
    ds_read_b64_tr_b16 a[76:77], v15 offset:1024
    v_mfma_f32_16x16x32_bf16 a[192:195], a[80:83], a[32:35], a[192:195]
    ds_read_b64_tr_b16 a[78:79], v15 offset:1280
    s_add_u32 m0, s78, 8192
    v_mfma_f32_16x16x32_bf16 a[200:203], a[80:83], a[36:39], a[200:203]
    buffer_load_dwordx4 v2, s[28:31], s68 offen offset:0 sc1 lds
    v_mfma_f32_16x16x32_bf16 a[208:211], a[80:83], a[40:43], a[208:211]
    ds_read_b128 a[112:115], v10 offset:34816
    v_mfma_f32_16x16x32_bf16 a[216:219], a[80:83], a[44:47], a[216:219]
    buffer_load_dwordx4 v2, s[28:31], s69 offen offset:1024 sc1 lds
    v_mfma_f32_16x16x32_bf16 a[224:227], a[80:83], a[48:51], a[224:227]
    v_mfma_f32_16x16x32_bf16 a[232:235], a[80:83], a[52:55], a[232:235]
    v_mfma_f32_16x16x32_bf16 a[240:243], a[80:83], a[56:59], a[240:243]
    ds_read_b64_tr_b16 a[96:97], v13 offset:4096
    v_mfma_f32_16x16x32_bf16 a[248:251], a[80:83], a[60:63], a[248:251]
    ds_read_b64_tr_b16 a[80:81], v13 offset:2048
    v_mfma_f32_16x16x32_bf16 a[196:199], a[84:87], a[32:35], a[196:199]
    ds_read_b64_tr_b16 a[82:83], v13 offset:2304
    v_mfma_f32_16x16x32_bf16 a[204:207], a[84:87], a[36:39], a[204:207]
    buffer_load_dwordx4 v2, s[28:31], s70 offen offset:2048 sc1 lds
    v_mfma_f32_16x16x32_bf16 a[212:215], a[84:87], a[40:43], a[212:215]
    ds_read_b64_tr_b16 a[98:99], v13 offset:4352
    v_mfma_f32_16x16x32_bf16 a[220:223], a[84:87], a[44:47], a[220:223]
    buffer_load_dwordx4 v2, s[28:31], s71 offen offset:3072 sc1 lds
    v_mfma_f32_16x16x32_bf16 a[228:231], a[84:87], a[48:51], a[228:231]
    v_mfma_f32_16x16x32_bf16 a[236:239], a[84:87], a[52:55], a[236:239]
    v_mfma_f32_16x16x32_bf16 a[244:247], a[84:87], a[56:59], a[244:247]
    ds_read_b64_tr_b16 a[100:101], v15 offset:4096
    v_mfma_f32_16x16x32_bf16 a[252:255], a[84:87], a[60:63], a[252:255]
    ds_read_b64_tr_b16 a[84:85], v15 offset:2048
    v_mfma_f32_16x16x32_bf16 v[128:131], a[88:91], a[32:35], v[128:131]
    ds_read_b64_tr_b16 a[86:87], v15 offset:2304
    s_add_u32 m0, s78, 12288
    v_mfma_f32_16x16x32_bf16 v[144:147], a[88:91], a[36:39], v[144:147]
    buffer_load_dwordx4 v2, s[28:31], s72 offen offset:0 sc1 lds
    v_mfma_f32_16x16x32_bf16 v[160:163], a[88:91], a[40:43], v[160:163]
    ds_read_b64_tr_b16 a[102:103], v15 offset:4352
    v_mfma_f32_16x16x32_bf16 v[176:179], a[88:91], a[44:47], v[176:179]
    buffer_load_dwordx4 v2, s[28:31], s73 offen offset:1024 sc1 lds
    v_mfma_f32_16x16x32_bf16 v[192:195], a[88:91], a[48:51], v[192:195]
    v_mfma_f32_16x16x32_bf16 v[208:211], a[88:91], a[52:55], v[208:211]
    v_mfma_f32_16x16x32_bf16 v[224:227], a[88:91], a[56:59], v[224:227]
    ds_read_b64_tr_b16 a[120:121], v45 offset:0
    v_mfma_f32_16x16x32_bf16 v[240:243], a[88:91], a[60:63], v[240:243]
    ds_read_b64_tr_b16 a[88:89], v13 offset:3072
    v_mfma_f32_16x16x32_bf16 v[132:135], a[92:95], a[32:35], v[132:135]
    ds_read_b64_tr_b16 a[90:91], v13 offset:3328
    v_mfma_f32_16x16x32_bf16 v[148:151], a[92:95], a[36:39], v[148:151]
    buffer_load_dwordx4 v2, s[28:31], s74 offen offset:2048 sc1 lds
    v_mfma_f32_16x16x32_bf16 v[164:167], a[92:95], a[40:43], v[164:167]
    ds_read_b64_tr_b16 a[122:123], v45 offset:256
    v_mfma_f32_16x16x32_bf16 v[180:183], a[92:95], a[44:47], v[180:183]
    buffer_load_dwordx4 v2, s[28:31], s75 offen offset:3072 sc1 lds
    v_add_u32 v2, 128, v2
    v_mfma_f32_16x16x32_bf16 v[196:199], a[92:95], a[48:51], v[196:199]
    v_mfma_f32_16x16x32_bf16 v[212:215], a[92:95], a[52:55], v[212:215]
    v_mfma_f32_16x16x32_bf16 v[228:231], a[92:95], a[56:59], v[228:231]
    v_mfma_f32_16x16x32_bf16 v[244:247], a[92:95], a[60:63], v[244:247]
    ds_read_b64_tr_b16 a[92:93], v15 offset:3072
    v_mfma_f32_16x16x32_bf16 v[136:139], a[104:107], a[32:35], v[136:139]
    ds_read_b64_tr_b16 a[94:95], v15 offset:3328
    v_mfma_f32_16x16x32_bf16 v[152:155], a[104:107], a[36:39], v[152:155]
    v_mfma_f32_16x16x32_bf16 v[168:171], a[104:107], a[40:43], v[168:171]
    v_mfma_f32_16x16x32_bf16 v[184:187], a[104:107], a[44:47], v[184:187]
    v_mfma_f32_16x16x32_bf16 v[200:203], a[104:107], a[48:51], v[200:203]
    v_mfma_f32_16x16x32_bf16 v[216:219], a[104:107], a[52:55], v[216:219]
    v_mfma_f32_16x16x32_bf16 v[232:235], a[104:107], a[56:59], v[232:235]
    v_mfma_f32_16x16x32_bf16 v[248:251], a[104:107], a[60:63], v[248:251]
    v_mfma_f32_16x16x32_bf16 v[140:143], a[108:111], a[32:35], v[140:143]
    v_mfma_f32_16x16x32_bf16 v[156:159], a[108:111], a[36:39], v[156:159]
    v_mfma_f32_16x16x32_bf16 v[172:175], a[108:111], a[40:43], v[172:175]
    v_mfma_f32_16x16x32_bf16 v[188:191], a[108:111], a[44:47], v[188:191]
    v_mfma_f32_16x16x32_bf16 v[204:207], a[108:111], a[48:51], v[204:207]
    v_mfma_f32_16x16x32_bf16 v[220:223], a[108:111], a[52:55], v[220:223]
    v_mfma_f32_16x16x32_bf16 v[236:239], a[108:111], a[56:59], v[236:239]
    v_mfma_f32_16x16x32_bf16 v[252:255], a[108:111], a[60:63], v[252:255]
    s_waitcnt lgkmcnt(0)
    s_barrier
    v_mfma_f32_16x16x32_bf16 v[120:123], a[120:123], a[112:115], v[120:123]
    buffer_load_dword v7, v6, s[44:47], s4 offen
    v_add_u32_e64 v6, s79, v6
    v_mfma_f32_16x16x32_bf16 a[128:131], a[64:67], a[0:3], a[128:131]
    v_mfma_f32_16x16x32_bf16 a[136:139], a[64:67], a[4:7], a[136:139]
    v_mfma_f32_16x16x32_bf16 a[144:147], a[64:67], a[8:11], a[144:147]
    ds_read_b128 a[32:35], v9 offset:34816
    v_mfma_f32_16x16x32_bf16 a[152:155], a[64:67], a[12:15], a[152:155]
    v_mfma_f32_16x16x32_bf16 a[160:163], a[64:67], a[16:19], a[160:163]
    v_mfma_f32_16x16x32_bf16 a[168:171], a[64:67], a[20:23], a[168:171]
    v_mfma_f32_16x16x32_bf16 a[176:179], a[64:67], a[24:27], a[176:179]
    ds_read_b128 a[36:39], v9 offset:36864
    v_mfma_f32_16x16x32_bf16 a[184:187], a[64:67], a[28:31], a[184:187]
    ds_read_b64_tr_b16 a[64:65], v13 offset:20480
    v_mfma_f32_16x16x32_bf16 a[132:135], a[68:71], a[0:3], a[132:135]
    ds_read_b64_tr_b16 a[66:67], v13 offset:20736
    v_mfma_f32_16x16x32_bf16 a[140:143], a[68:71], a[4:7], a[140:143]
    v_mfma_f32_16x16x32_bf16 a[148:151], a[68:71], a[8:11], a[148:151]
    ds_read_b128 a[40:43], v9 offset:38912
    v_mfma_f32_16x16x32_bf16 a[156:159], a[68:71], a[12:15], a[156:159]
    v_mfma_f32_16x16x32_bf16 a[164:167], a[68:71], a[16:19], a[164:167]
    v_mfma_f32_16x16x32_bf16 a[172:175], a[68:71], a[20:23], a[172:175]
    v_mfma_f32_16x16x32_bf16 a[180:183], a[68:71], a[24:27], a[180:183]
    ds_read_b128 a[44:47], v9 offset:40960
    v_mfma_f32_16x16x32_bf16 a[188:191], a[68:71], a[28:31], a[188:191]
    ds_read_b64_tr_b16 a[68:69], v15 offset:20480
    v_mfma_f32_16x16x32_bf16 v[52:55], a[0:3], a[72:75], v[52:55]
    ds_read_b64_tr_b16 a[70:71], v15 offset:20736
    v_mfma_f32_16x16x32_bf16 v[56:59], a[4:7], a[72:75], v[56:59]
    v_mfma_f32_16x16x32_bf16 v[60:63], a[8:11], a[72:75], v[60:63]
    ds_read_b128 a[48:51], v9 offset:43008
    v_mfma_f32_16x16x32_bf16 v[64:67], a[12:15], a[72:75], v[64:67]
    v_mfma_f32_16x16x32_bf16 v[68:71], a[16:19], a[72:75], v[68:71]
    v_mfma_f32_16x16x32_bf16 v[72:75], a[20:23], a[72:75], v[72:75]
    v_mfma_f32_16x16x32_bf16 v[76:79], a[24:27], a[72:75], v[76:79]
    ds_read_b128 a[52:55], v9 offset:45056
    v_mfma_f32_16x16x32_bf16 v[80:83], a[28:31], a[72:75], v[80:83]
    ds_read_b64_tr_b16 a[72:73], v13 offset:21504
    v_mfma_f32_16x16x32_bf16 v[88:91], a[0:3], a[76:79], v[88:91]
    ds_read_b64_tr_b16 a[74:75], v13 offset:21760
    v_mfma_f32_16x16x32_bf16 v[92:95], a[4:7], a[76:79], v[92:95]
    v_mfma_f32_16x16x32_bf16 v[96:99], a[8:11], a[76:79], v[96:99]
    ds_read_b128 a[56:59], v9 offset:47104
    v_mfma_f32_16x16x32_bf16 v[100:103], a[12:15], a[76:79], v[100:103]
    v_mfma_f32_16x16x32_bf16 v[104:107], a[16:19], a[76:79], v[104:107]
    v_mfma_f32_16x16x32_bf16 v[108:111], a[20:23], a[76:79], v[108:111]
    v_mfma_f32_16x16x32_bf16 v[112:115], a[24:27], a[76:79], v[112:115]
    ds_read_b128 a[60:63], v9 offset:49152
    v_mfma_f32_16x16x32_bf16 v[116:119], a[28:31], a[76:79], v[116:119]
    ds_read_b64_tr_b16 a[76:77], v15 offset:21504
    v_mfma_f32_16x16x32_bf16 a[192:195], a[80:83], a[0:3], a[192:195]
    ds_read_b64_tr_b16 a[78:79], v15 offset:21760
    v_mfma_f32_16x16x32_bf16 a[200:203], a[80:83], a[4:7], a[200:203]
    v_mfma_f32_16x16x32_bf16 a[208:211], a[80:83], a[8:11], a[208:211]
    ds_read_b128 a[116:119], v11 offset:34816
    v_mfma_f32_16x16x32_bf16 a[216:219], a[80:83], a[12:15], a[216:219]
    v_mfma_f32_16x16x32_bf16 a[224:227], a[80:83], a[16:19], a[224:227]
    v_mfma_f32_16x16x32_bf16 a[232:235], a[80:83], a[20:23], a[232:235]
    v_mfma_f32_16x16x32_bf16 a[240:243], a[80:83], a[24:27], a[240:243]
    ds_read_b64_tr_b16 a[104:105], v13 offset:24576
    v_mfma_f32_16x16x32_bf16 a[248:251], a[80:83], a[28:31], a[248:251]
    ds_read_b64_tr_b16 a[80:81], v13 offset:22528
    v_mfma_f32_16x16x32_bf16 a[196:199], a[84:87], a[0:3], a[196:199]
    ds_read_b64_tr_b16 a[82:83], v13 offset:22784
    v_mfma_f32_16x16x32_bf16 a[204:207], a[84:87], a[4:7], a[204:207]
    v_mfma_f32_16x16x32_bf16 a[212:215], a[84:87], a[8:11], a[212:215]
    ds_read_b64_tr_b16 a[106:107], v13 offset:24832
    v_mfma_f32_16x16x32_bf16 a[220:223], a[84:87], a[12:15], a[220:223]
    v_mfma_f32_16x16x32_bf16 a[228:231], a[84:87], a[16:19], a[228:231]
    v_mfma_f32_16x16x32_bf16 a[236:239], a[84:87], a[20:23], a[236:239]
    v_mfma_f32_16x16x32_bf16 a[244:247], a[84:87], a[24:27], a[244:247]
    ds_read_b64_tr_b16 a[108:109], v15 offset:24576
    v_mfma_f32_16x16x32_bf16 a[252:255], a[84:87], a[28:31], a[252:255]
    ds_read_b64_tr_b16 a[84:85], v15 offset:22528
    v_mfma_f32_16x16x32_bf16 v[128:131], a[88:91], a[0:3], v[128:131]
    ds_read_b64_tr_b16 a[86:87], v15 offset:22784
    v_mfma_f32_16x16x32_bf16 v[144:147], a[88:91], a[4:7], v[144:147]
    v_mfma_f32_16x16x32_bf16 v[160:163], a[88:91], a[8:11], v[160:163]
    ds_read_b64_tr_b16 a[110:111], v15 offset:24832
    v_mfma_f32_16x16x32_bf16 v[176:179], a[88:91], a[12:15], v[176:179]
    v_mfma_f32_16x16x32_bf16 v[192:195], a[88:91], a[16:19], v[192:195]
    v_mfma_f32_16x16x32_bf16 v[208:211], a[88:91], a[20:23], v[208:211]
    v_mfma_f32_16x16x32_bf16 v[224:227], a[88:91], a[24:27], v[224:227]
    ds_read_b64_tr_b16 a[124:125], v45 offset:20480
    v_mfma_f32_16x16x32_bf16 v[240:243], a[88:91], a[28:31], v[240:243]
    ds_read_b64_tr_b16 a[88:89], v13 offset:23552
    v_mfma_f32_16x16x32_bf16 v[132:135], a[92:95], a[0:3], v[132:135]
    ds_read_b64_tr_b16 a[90:91], v13 offset:23808
    v_mfma_f32_16x16x32_bf16 v[148:151], a[92:95], a[4:7], v[148:151]
    v_mfma_f32_16x16x32_bf16 v[164:167], a[92:95], a[8:11], v[164:167]
    ds_read_b64_tr_b16 a[126:127], v45 offset:20736
    v_mfma_f32_16x16x32_bf16 v[180:183], a[92:95], a[12:15], v[180:183]
    v_mfma_f32_16x16x32_bf16 v[196:199], a[92:95], a[16:19], v[196:199]
    v_mfma_f32_16x16x32_bf16 v[212:215], a[92:95], a[20:23], v[212:215]
    v_mfma_f32_16x16x32_bf16 v[228:231], a[92:95], a[24:27], v[228:231]
    v_mfma_f32_16x16x32_bf16 v[244:247], a[92:95], a[28:31], v[244:247]
    ds_read_b64_tr_b16 a[92:93], v15 offset:23552
    v_mfma_f32_16x16x32_bf16 v[136:139], a[96:99], a[0:3], v[136:139]
    ds_read_b64_tr_b16 a[94:95], v15 offset:23808
    v_mfma_f32_16x16x32_bf16 v[152:155], a[96:99], a[4:7], v[152:155]
    v_mfma_f32_16x16x32_bf16 v[168:171], a[96:99], a[8:11], v[168:171]
    v_mfma_f32_16x16x32_bf16 v[184:187], a[96:99], a[12:15], v[184:187]
    v_mfma_f32_16x16x32_bf16 v[200:203], a[96:99], a[16:19], v[200:203]
    v_mfma_f32_16x16x32_bf16 v[216:219], a[96:99], a[20:23], v[216:219]
    v_mfma_f32_16x16x32_bf16 v[232:235], a[96:99], a[24:27], v[232:235]
    v_mfma_f32_16x16x32_bf16 v[248:251], a[96:99], a[28:31], v[248:251]
    v_mfma_f32_16x16x32_bf16 v[140:143], a[100:103], a[0:3], v[140:143]
    v_mfma_f32_16x16x32_bf16 v[156:159], a[100:103], a[4:7], v[156:159]
    v_mfma_f32_16x16x32_bf16 v[172:175], a[100:103], a[8:11], v[172:175]
    v_mfma_f32_16x16x32_bf16 v[188:191], a[100:103], a[12:15], v[188:191]
    v_mfma_f32_16x16x32_bf16 v[204:207], a[100:103], a[16:19], v[204:207]
    v_mfma_f32_16x16x32_bf16 v[220:223], a[100:103], a[20:23], v[220:223]
    v_mfma_f32_16x16x32_bf16 v[236:239], a[100:103], a[24:27], v[236:239]
    v_mfma_f32_16x16x32_bf16 v[252:255], a[100:103], a[28:31], v[252:255]
    s_waitcnt vmcnt(1) lgkmcnt(0)
    s_barrier
    v_mfma_f32_16x16x32_bf16 v[120:123], a[124:127], a[116:119], v[120:123]
    s_add_u32 m0, s78, 34816
    v_mfma_f32_16x16x32_bf16 a[128:131], a[64:67], a[32:35], a[128:131]
    buffer_load_dwordx4 v1, s[28:31], s68 offen offset:0 sc1 lds
    v_mfma_f32_16x16x32_bf16 a[136:139], a[64:67], a[36:39], a[136:139]
    v_mfma_f32_16x16x32_bf16 a[144:147], a[64:67], a[40:43], a[144:147]
    ds_read_b128 a[0:3], v8 offset:0
    v_mfma_f32_16x16x32_bf16 a[152:155], a[64:67], a[44:47], a[152:155]
    buffer_load_dwordx4 v1, s[28:31], s69 offen offset:1024 sc1 lds
    v_mfma_f32_16x16x32_bf16 a[160:163], a[64:67], a[48:51], a[160:163]
    v_mfma_f32_16x16x32_bf16 a[168:171], a[64:67], a[52:55], a[168:171]
    v_mfma_f32_16x16x32_bf16 a[176:179], a[64:67], a[56:59], a[176:179]
    ds_read_b128 a[4:7], v8 offset:2048
    v_mfma_f32_16x16x32_bf16 a[184:187], a[64:67], a[60:63], a[184:187]
    ds_read_b64_tr_b16 a[64:65], v12 offset:0
    v_mfma_f32_16x16x32_bf16 a[132:135], a[68:71], a[32:35], a[132:135]
    ds_read_b64_tr_b16 a[66:67], v12 offset:256
    v_mfma_f32_16x16x32_bf16 a[140:143], a[68:71], a[36:39], a[140:143]
    buffer_load_dwordx4 v1, s[28:31], s70 offen offset:2048 sc1 lds
    v_mfma_f32_16x16x32_bf16 a[148:151], a[68:71], a[40:43], a[148:151]
    ds_read_b128 a[8:11], v8 offset:4096
    v_mfma_f32_16x16x32_bf16 a[156:159], a[68:71], a[44:47], a[156:159]
    buffer_load_dwordx4 v1, s[28:31], s71 offen offset:3072 sc1 lds
    v_mfma_f32_16x16x32_bf16 a[164:167], a[68:71], a[48:51], a[164:167]
    v_mfma_f32_16x16x32_bf16 a[172:175], a[68:71], a[52:55], a[172:175]
    v_mfma_f32_16x16x32_bf16 a[180:183], a[68:71], a[56:59], a[180:183]
    ds_read_b128 a[12:15], v8 offset:6144
    v_mfma_f32_16x16x32_bf16 a[188:191], a[68:71], a[60:63], a[188:191]
    ds_read_b64_tr_b16 a[68:69], v14 offset:0
    v_mfma_f32_16x16x32_bf16 v[52:55], a[32:35], a[72:75], v[52:55]
    ds_read_b64_tr_b16 a[70:71], v14 offset:256
    s_add_u32 m0, s78, 38912
    v_mfma_f32_16x16x32_bf16 v[56:59], a[36:39], a[72:75], v[56:59]
    buffer_load_dwordx4 v1, s[28:31], s72 offen offset:0 sc1 lds
    v_mfma_f32_16x16x32_bf16 v[60:63], a[40:43], a[72:75], v[60:63]
    ds_read_b128 a[16:19], v8 offset:8192
    v_mfma_f32_16x16x32_bf16 v[64:67], a[44:47], a[72:75], v[64:67]
    buffer_load_dwordx4 v1, s[28:31], s73 offen offset:1024 sc1 lds
    v_mfma_f32_16x16x32_bf16 v[68:71], a[48:51], a[72:75], v[68:71]
    v_mfma_f32_16x16x32_bf16 v[72:75], a[52:55], a[72:75], v[72:75]
    v_mfma_f32_16x16x32_bf16 v[76:79], a[56:59], a[72:75], v[76:79]
    ds_read_b128 a[20:23], v8 offset:10240
    v_mfma_f32_16x16x32_bf16 v[80:83], a[60:63], a[72:75], v[80:83]
    ds_read_b64_tr_b16 a[72:73], v12 offset:1024
    v_mfma_f32_16x16x32_bf16 v[88:91], a[32:35], a[76:79], v[88:91]
    ds_read_b64_tr_b16 a[74:75], v12 offset:1280
    v_mfma_f32_16x16x32_bf16 v[92:95], a[36:39], a[76:79], v[92:95]
    buffer_load_dwordx4 v1, s[28:31], s74 offen offset:2048 sc1 lds
    v_mfma_f32_16x16x32_bf16 v[96:99], a[40:43], a[76:79], v[96:99]
    ds_read_b128 a[24:27], v8 offset:12288
    v_mfma_f32_16x16x32_bf16 v[100:103], a[44:47], a[76:79], v[100:103]
    buffer_load_dwordx4 v1, s[28:31], s75 offen offset:3072 sc1 lds
    v_add_u32 v1, 128, v1
    v_mfma_f32_16x16x32_bf16 v[104:107], a[48:51], a[76:79], v[104:107]
    v_mfma_f32_16x16x32_bf16 v[108:111], a[52:55], a[76:79], v[108:111]
    v_mfma_f32_16x16x32_bf16 v[112:115], a[56:59], a[76:79], v[112:115]
    ds_read_b128 a[28:31], v8 offset:14336
    v_mfma_f32_16x16x32_bf16 v[116:119], a[60:63], a[76:79], v[116:119]
    ds_read_b64_tr_b16 a[76:77], v14 offset:1024
    v_mfma_f32_16x16x32_bf16 a[192:195], a[80:83], a[32:35], a[192:195]
    ds_read_b64_tr_b16 a[78:79], v14 offset:1280
    s_add_u32 m0, s78, 43008
    v_mfma_f32_16x16x32_bf16 a[200:203], a[80:83], a[36:39], a[200:203]
    buffer_load_dwordx4 v2, s[28:31], s68 offen offset:0 sc1 lds
    v_mfma_f32_16x16x32_bf16 a[208:211], a[80:83], a[40:43], a[208:211]
    ds_read_b128 a[112:115], v10 offset:0
    v_mfma_f32_16x16x32_bf16 a[216:219], a[80:83], a[44:47], a[216:219]
    buffer_load_dwordx4 v2, s[28:31], s69 offen offset:1024 sc1 lds
    v_mfma_f32_16x16x32_bf16 a[224:227], a[80:83], a[48:51], a[224:227]
    v_mfma_f32_16x16x32_bf16 a[232:235], a[80:83], a[52:55], a[232:235]
    v_mfma_f32_16x16x32_bf16 a[240:243], a[80:83], a[56:59], a[240:243]
    ds_read_b64_tr_b16 a[96:97], v12 offset:4096
    v_mfma_f32_16x16x32_bf16 a[248:251], a[80:83], a[60:63], a[248:251]
    ds_read_b64_tr_b16 a[80:81], v12 offset:2048
    v_mfma_f32_16x16x32_bf16 a[196:199], a[84:87], a[32:35], a[196:199]
    ds_read_b64_tr_b16 a[82:83], v12 offset:2304
    v_mfma_f32_16x16x32_bf16 a[204:207], a[84:87], a[36:39], a[204:207]
    buffer_load_dwordx4 v2, s[28:31], s70 offen offset:2048 sc1 lds
    v_mfma_f32_16x16x32_bf16 a[212:215], a[84:87], a[40:43], a[212:215]
    ds_read_b64_tr_b16 a[98:99], v12 offset:4352
    v_mfma_f32_16x16x32_bf16 a[220:223], a[84:87], a[44:47], a[220:223]
    buffer_load_dwordx4 v2, s[28:31], s71 offen offset:3072 sc1 lds
    v_mfma_f32_16x16x32_bf16 a[228:231], a[84:87], a[48:51], a[228:231]
    v_mfma_f32_16x16x32_bf16 a[236:239], a[84:87], a[52:55], a[236:239]
    v_mfma_f32_16x16x32_bf16 a[244:247], a[84:87], a[56:59], a[244:247]
    ds_read_b64_tr_b16 a[100:101], v14 offset:4096
    v_mfma_f32_16x16x32_bf16 a[252:255], a[84:87], a[60:63], a[252:255]
    ds_read_b64_tr_b16 a[84:85], v14 offset:2048
    v_mfma_f32_16x16x32_bf16 v[128:131], a[88:91], a[32:35], v[128:131]
    ds_read_b64_tr_b16 a[86:87], v14 offset:2304
    s_add_u32 m0, s78, 47104
    v_mfma_f32_16x16x32_bf16 v[144:147], a[88:91], a[36:39], v[144:147]
    buffer_load_dwordx4 v2, s[28:31], s72 offen offset:0 sc1 lds
    v_mfma_f32_16x16x32_bf16 v[160:163], a[88:91], a[40:43], v[160:163]
    ds_read_b64_tr_b16 a[102:103], v14 offset:4352
    v_mfma_f32_16x16x32_bf16 v[176:179], a[88:91], a[44:47], v[176:179]
    buffer_load_dwordx4 v2, s[28:31], s73 offen offset:1024 sc1 lds
    v_mfma_f32_16x16x32_bf16 v[192:195], a[88:91], a[48:51], v[192:195]
    v_mfma_f32_16x16x32_bf16 v[208:211], a[88:91], a[52:55], v[208:211]
    v_mfma_f32_16x16x32_bf16 v[224:227], a[88:91], a[56:59], v[224:227]
    ds_read_b64_tr_b16 a[120:121], v44 offset:0
    v_mfma_f32_16x16x32_bf16 v[240:243], a[88:91], a[60:63], v[240:243]
    ds_read_b64_tr_b16 a[88:89], v12 offset:3072
    v_mfma_f32_16x16x32_bf16 v[132:135], a[92:95], a[32:35], v[132:135]
    ds_read_b64_tr_b16 a[90:91], v12 offset:3328
    v_mfma_f32_16x16x32_bf16 v[148:151], a[92:95], a[36:39], v[148:151]
    buffer_load_dwordx4 v2, s[28:31], s74 offen offset:2048 sc1 lds
    v_mfma_f32_16x16x32_bf16 v[164:167], a[92:95], a[40:43], v[164:167]
    ds_read_b64_tr_b16 a[122:123], v44 offset:256
    v_mfma_f32_16x16x32_bf16 v[180:183], a[92:95], a[44:47], v[180:183]
    buffer_load_dwordx4 v2, s[28:31], s75 offen offset:3072 sc1 lds
    v_add_u32 v2, 128, v2
    v_mfma_f32_16x16x32_bf16 v[196:199], a[92:95], a[48:51], v[196:199]
    v_mfma_f32_16x16x32_bf16 v[212:215], a[92:95], a[52:55], v[212:215]
    v_mfma_f32_16x16x32_bf16 v[228:231], a[92:95], a[56:59], v[228:231]
    v_mfma_f32_16x16x32_bf16 v[244:247], a[92:95], a[60:63], v[244:247]
    ds_read_b64_tr_b16 a[92:93], v14 offset:3072
    v_mfma_f32_16x16x32_bf16 v[136:139], a[104:107], a[32:35], v[136:139]
    ds_read_b64_tr_b16 a[94:95], v14 offset:3328
    v_mfma_f32_16x16x32_bf16 v[152:155], a[104:107], a[36:39], v[152:155]
    v_mfma_f32_16x16x32_bf16 v[168:171], a[104:107], a[40:43], v[168:171]
    v_mfma_f32_16x16x32_bf16 v[184:187], a[104:107], a[44:47], v[184:187]
    v_mfma_f32_16x16x32_bf16 v[200:203], a[104:107], a[48:51], v[200:203]
    v_mfma_f32_16x16x32_bf16 v[216:219], a[104:107], a[52:55], v[216:219]
    v_mfma_f32_16x16x32_bf16 v[232:235], a[104:107], a[56:59], v[232:235]
    v_mfma_f32_16x16x32_bf16 v[248:251], a[104:107], a[60:63], v[248:251]
    v_mfma_f32_16x16x32_bf16 v[140:143], a[108:111], a[32:35], v[140:143]
    v_mfma_f32_16x16x32_bf16 v[156:159], a[108:111], a[36:39], v[156:159]
    v_mfma_f32_16x16x32_bf16 v[172:175], a[108:111], a[40:43], v[172:175]
    v_mfma_f32_16x16x32_bf16 v[188:191], a[108:111], a[44:47], v[188:191]
    v_mfma_f32_16x16x32_bf16 v[204:207], a[108:111], a[48:51], v[204:207]
    v_mfma_f32_16x16x32_bf16 v[220:223], a[108:111], a[52:55], v[220:223]
    v_mfma_f32_16x16x32_bf16 v[236:239], a[108:111], a[56:59], v[236:239]
    v_mfma_f32_16x16x32_bf16 v[252:255], a[108:111], a[60:63], v[252:255]
    s_sub_u32 s67, s67, 1
    s_cmp_lg_u32 s67, 0
    s_cbranch_scc1 L_loop0
L_tail0:
    s_waitcnt lgkmcnt(0)
    s_barrier
    v_mfma_f32_16x16x32_bf16 v[120:123], a[120:123], a[112:115], v[120:123]
    s_getpc_b64 s[86:87]
L_pc0:
    s_sub_u32 s86, s86, L_pc0-L_tail0
    s_subb_u32 s87, s87, 0
    s_lshr_b32 s82, s2, 3
    s_lshl_b32 s82, s82, 2
    s_add_u32 s82, s82, s60
    s_lshl_b32 s82, s82, 10
    v_add_u32 v34, s82, v16
    v_min_u32 v34, L_code_end-L_tail0-4, v34
    global_load_dword v7, v34, s[86:87]
    v_mfma_f32_16x16x32_bf16 a[128:131], a[64:67], a[0:3], a[128:131]
    v_mfma_f32_16x16x32_bf16 a[136:139], a[64:67], a[4:7], a[136:139]
    v_mfma_f32_16x16x32_bf16 a[144:147], a[64:67], a[8:11], a[144:147]
    ds_read_b128 a[32:35], v9 offset:0
    v_mfma_f32_16x16x32_bf16 a[152:155], a[64:67], a[12:15], a[152:155]
    s_mul_i32 s82, s65, 1835008
    s_lshl_b32 s83, s66, 8
    v_mfma_f32_16x16x32_bf16 a[160:163], a[64:67], a[16:19], a[160:163]
    s_add_u32 s82, s82, s83
    s_add_u32 s48, s20, s82
    v_mfma_f32_16x16x32_bf16 a[168:171], a[64:67], a[20:23], a[168:171]
    s_addc_u32 s49, s21, 0
    s_and_b32 s49, s49, 0xffff
    v_mfma_f32_16x16x32_bf16 a[176:179], a[64:67], a[24:27], a[176:179]
    ds_read_b128 a[36:39], v9 offset:2048
    s_sub_u32 s50, 7340032, s82
    s_mov_b32 s51, 0x20000
    v_mfma_f32_16x16x32_bf16 a[184:187], a[64:67], a[28:31], a[184:187]
    ds_read_b64_tr_b16 a[64:65], v12 offset:20480
    s_add_u32 s52, s12, s83
    s_addc_u32 s53, s13, 0
    v_mfma_f32_16x16x32_bf16 a[132:135], a[68:71], a[0:3], a[132:135]
    ds_read_b64_tr_b16 a[66:67], v12 offset:20736
    s_and_b32 s53, s53, 0xffff
    s_sub_u32 s54, 2097152, s83
    v_mfma_f32_16x16x32_bf16 a[140:143], a[68:71], a[4:7], a[140:143]
    s_mov_b32 s55, 0x20000
    s_lshl_b32 s3, s60, 11
    v_mfma_f32_16x16x32_bf16 a[148:151], a[68:71], a[8:11], a[148:151]
    ds_read_b128 a[40:43], v9 offset:4096
    v_lshrrev_b32 v34, 4, v0
    v_and_b32 v35, 15, v0
    v_mfma_f32_16x16x32_bf16 a[156:159], a[68:71], a[12:15], a[156:159]
    v_lshlrev_b32 v36, 1, v34
    v_add_u32 v36, 0, v36
    v_mfma_f32_16x16x32_bf16 a[164:167], a[68:71], a[16:19], a[164:167]
    v_xor_b32 v36, v36, v35
    v_lshlrev_b32 v36, 4, v36
    v_mfma_f32_16x16x32_bf16 a[172:175], a[68:71], a[20:23], a[172:175]
    v_lshl_add_u32 v36, v34, 11, v36
    s_lshl_b32 s82, s60, 14
    v_mfma_f32_16x16x32_bf16 a[180:183], a[68:71], a[24:27], a[180:183]
    ds_read_b128 a[44:47], v9 offset:6144
    s_add_u32 s82, s82, 0
    v_add_u32 v17, s82, v36
    v_mfma_f32_16x16x32_bf16 a[188:191], a[68:71], a[28:31], a[188:191]
    ds_read_b64_tr_b16 a[68:69], v14 offset:20480
    s_lshl_b32 s82, s62, 1
    s_add_u32 s82, s82, 0
    v_mfma_f32_16x16x32_bf16 v[52:55], a[0:3], a[72:75], v[52:55]
    ds_read_b64_tr_b16 a[70:71], v14 offset:20736
    s_lshl_b32 s82, s82, 3
    s_lshl_b32 s83, s61, 2
    v_mfma_f32_16x16x32_bf16 v[56:59], a[4:7], a[72:75], v[56:59]
    s_add_u32 s82, s82, s83
    s_mul_i32 s83, s62, 96
    v_mfma_f32_16x16x32_bf16 v[60:63], a[8:11], a[72:75], v[60:63]
    ds_read_b128 a[48:51], v9 offset:8192
    s_add_u32 s82, s82, s83
    s_lshl_b32 s82, s82, 11
    v_mfma_f32_16x16x32_bf16 v[64:67], a[12:15], a[72:75], v[64:67]
    s_sub_u32 s82, s82, 0
    v_add_u32 v19, s82, v36
    v_mfma_f32_16x16x32_bf16 v[68:71], a[16:19], a[72:75], v[68:71]
    v_lshlrev_b32 v36, 1, v34
    v_add_u32 v36, 8, v36
    v_mfma_f32_16x16x32_bf16 v[72:75], a[20:23], a[72:75], v[72:75]
    v_xor_b32 v36, v36, v35
    v_lshlrev_b32 v36, 4, v36
    v_mfma_f32_16x16x32_bf16 v[76:79], a[24:27], a[72:75], v[76:79]
    ds_read_b128 a[52:55], v9 offset:10240
    v_lshl_add_u32 v36, v34, 11, v36
    s_lshl_b32 s82, s60, 14
    v_mfma_f32_16x16x32_bf16 v[80:83], a[28:31], a[72:75], v[80:83]
    ds_read_b64_tr_b16 a[72:73], v12 offset:21504
    s_add_u32 s82, s82, 7168
    v_add_u32 v18, s82, v36
    v_mfma_f32_16x16x32_bf16 v[88:91], a[0:3], a[76:79], v[88:91]
    ds_read_b64_tr_b16 a[74:75], v12 offset:21760
    s_lshl_b32 s82, s62, 1
    s_add_u32 s82, s82, 1
    v_mfma_f32_16x16x32_bf16 v[92:95], a[4:7], a[76:79], v[92:95]
    s_lshl_b32 s82, s82, 3
    s_lshl_b32 s83, s61, 2
    v_mfma_f32_16x16x32_bf16 v[96:99], a[8:11], a[76:79], v[96:99]
    ds_read_b128 a[56:59], v9 offset:12288
    s_add_u32 s82, s82, s83
    s_mul_i32 s83, s62, 96
    v_mfma_f32_16x16x32_bf16 v[100:103], a[12:15], a[76:79], v[100:103]
    s_add_u32 s82, s82, s83
    s_lshl_b32 s82, s82, 11
    v_mfma_f32_16x16x32_bf16 v[104:107], a[16:19], a[76:79], v[104:107]
    s_sub_u32 s82, s82, 1024
    v_add_u32 v20, s82, v36
    v_mfma_f32_16x16x32_bf16 v[108:111], a[20:23], a[76:79], v[108:111]
    v_mfma_f32_16x16x32_bf16 v[112:115], a[24:27], a[76:79], v[112:115]
    ds_read_b128 a[60:63], v9 offset:14336
    v_mfma_f32_16x16x32_bf16 v[116:119], a[28:31], a[76:79], v[116:119]
    ds_read_b64_tr_b16 a[76:77], v14 offset:21504
    v_mfma_f32_16x16x32_bf16 a[192:195], a[80:83], a[0:3], a[192:195]
    ds_read_b64_tr_b16 a[78:79], v14 offset:21760
    v_mfma_f32_16x16x32_bf16 a[200:203], a[80:83], a[4:7], a[200:203]
    v_mfma_f32_16x16x32_bf16 a[208:211], a[80:83], a[8:11], a[208:211]
    ds_read_b128 a[116:119], v11 offset:0
    v_mfma_f32_16x16x32_bf16 a[216:219], a[80:83], a[12:15], a[216:219]
    v_mfma_f32_16x16x32_bf16 a[224:227], a[80:83], a[16:19], a[224:227]
    v_mfma_f32_16x16x32_bf16 a[232:235], a[80:83], a[20:23], a[232:235]
    v_mfma_f32_16x16x32_bf16 a[240:243], a[80:83], a[24:27], a[240:243]
    ds_read_b64_tr_b16 a[104:105], v12 offset:24576
    v_mfma_f32_16x16x32_bf16 a[248:251], a[80:83], a[28:31], a[248:251]
    ds_read_b64_tr_b16 a[80:81], v12 offset:22528
    v_mfma_f32_16x16x32_bf16 a[196:199], a[84:87], a[0:3], a[196:199]
    ds_read_b64_tr_b16 a[82:83], v12 offset:22784
    v_mfma_f32_16x16x32_bf16 a[204:207], a[84:87], a[4:7], a[204:207]
    v_mfma_f32_16x16x32_bf16 a[212:215], a[84:87], a[8:11], a[212:215]
    ds_read_b64_tr_b16 a[106:107], v12 offset:24832
    v_mfma_f32_16x16x32_bf16 a[220:223], a[84:87], a[12:15], a[220:223]
    s_mov_b32 s81, 294912
    s_add_u32 m0, s3, 73728
    v_mfma_f32_16x16x32_bf16 a[228:231], a[84:87], a[16:19], a[228:231]
    buffer_load_dwordx4 v17, s[48:51], s81 offen lds
    v_mfma_f32_16x16x32_bf16 a[236:239], a[84:87], a[20:23], a[236:239]
    v_mfma_f32_16x16x32_bf16 a[244:247], a[84:87], a[24:27], a[244:247]
    ds_read_b64_tr_b16 a[108:109], v14 offset:24576
    v_mfma_f32_16x16x32_bf16 a[252:255], a[84:87], a[28:31], a[252:255]
    ds_read_b64_tr_b16 a[84:85], v14 offset:22528
    v_mfma_f32_16x16x32_bf16 v[128:131], a[88:91], a[0:3], v[128:131]
    ds_read_b64_tr_b16 a[86:87], v14 offset:22784
    v_mfma_f32_16x16x32_bf16 v[144:147], a[88:91], a[4:7], v[144:147]
    buffer_load_dwordx4 v18, s[48:51], s81 offen offset:1024 lds
    v_mfma_f32_16x16x32_bf16 v[160:163], a[88:91], a[8:11], v[160:163]
    ds_read_b64_tr_b16 a[110:111], v14 offset:24832
    v_mfma_f32_16x16x32_bf16 v[176:179], a[88:91], a[12:15], v[176:179]
    v_mfma_f32_16x16x32_bf16 v[192:195], a[88:91], a[16:19], v[192:195]
    v_mfma_f32_16x16x32_bf16 v[208:211], a[88:91], a[20:23], v[208:211]
    s_mov_b32 s80, 524288
    s_add_u32 m0, s3, 81920
    v_mfma_f32_16x16x32_bf16 v[224:227], a[88:91], a[24:27], v[224:227]
    ds_read_b64_tr_b16 a[124:125], v44 offset:20480
    buffer_load_dwordx4 v17, s[48:51], s80 offen lds
    v_mfma_f32_16x16x32_bf16 v[240:243], a[88:91], a[28:31], v[240:243]
    ds_read_b64_tr_b16 a[88:89], v12 offset:23552
    v_mfma_f32_16x16x32_bf16 v[132:135], a[92:95], a[0:3], v[132:135]
    ds_read_b64_tr_b16 a[90:91], v12 offset:23808
    v_mfma_f32_16x16x32_bf16 v[148:151], a[92:95], a[4:7], v[148:151]
    v_mfma_f32_16x16x32_bf16 v[164:167], a[92:95], a[8:11], v[164:167]
    ds_read_b64_tr_b16 a[126:127], v44 offset:20736
    v_mfma_f32_16x16x32_bf16 v[180:183], a[92:95], a[12:15], v[180:183]
    buffer_load_dwordx4 v18, s[48:51], s80 offen offset:1024 lds
    v_mfma_f32_16x16x32_bf16 v[196:199], a[92:95], a[16:19], v[196:199]
    v_mfma_f32_16x16x32_bf16 v[212:215], a[92:95], a[20:23], v[212:215]
    v_mfma_f32_16x16x32_bf16 v[228:231], a[92:95], a[24:27], v[228:231]
    v_mfma_f32_16x16x32_bf16 v[244:247], a[92:95], a[28:31], v[244:247]
    ds_read_b64_tr_b16 a[92:93], v14 offset:23552
    s_mov_b32 s81, 819200
    s_add_u32 m0, s3, 155648
    v_mfma_f32_16x16x32_bf16 v[136:139], a[96:99], a[0:3], v[136:139]
    ds_read_b64_tr_b16 a[94:95], v14 offset:23808
    buffer_load_dwordx4 v17, s[48:51], s81 offen lds
    v_mfma_f32_16x16x32_bf16 v[152:155], a[96:99], a[4:7], v[152:155]
    v_mfma_f32_16x16x32_bf16 v[168:171], a[96:99], a[8:11], v[168:171]
    v_mfma_f32_16x16x32_bf16 v[184:187], a[96:99], a[12:15], v[184:187]
    v_mfma_f32_16x16x32_bf16 v[200:203], a[96:99], a[16:19], v[200:203]
    v_mfma_f32_16x16x32_bf16 v[216:219], a[96:99], a[20:23], v[216:219]
    buffer_load_dwordx4 v18, s[48:51], s81 offen offset:1024 lds
    v_mfma_f32_16x16x32_bf16 v[232:235], a[96:99], a[24:27], v[232:235]
    v_mfma_f32_16x16x32_bf16 v[248:251], a[96:99], a[28:31], v[248:251]
    v_mfma_f32_16x16x32_bf16 v[140:143], a[100:103], a[0:3], v[140:143]
    v_mfma_f32_16x16x32_bf16 v[156:159], a[100:103], a[4:7], v[156:159]
    v_mfma_f32_16x16x32_bf16 v[172:175], a[100:103], a[8:11], v[172:175]
    v_mfma_f32_16x16x32_bf16 v[188:191], a[100:103], a[12:15], v[188:191]
    v_mfma_f32_16x16x32_bf16 v[204:207], a[100:103], a[16:19], v[204:207]
    v_mfma_f32_16x16x32_bf16 v[220:223], a[100:103], a[20:23], v[220:223]
    v_mfma_f32_16x16x32_bf16 v[236:239], a[100:103], a[24:27], v[236:239]
    v_mfma_f32_16x16x32_bf16 v[252:255], a[100:103], a[28:31], v[252:255]
    s_waitcnt vmcnt(7) lgkmcnt(0)
    s_barrier
    v_mfma_f32_16x16x32_bf16 v[120:123], a[124:127], a[116:119], v[120:123]
    v_mfma_f32_16x16x32_bf16 a[128:131], a[64:67], a[32:35], a[128:131]
    v_mfma_f32_16x16x32_bf16 a[136:139], a[64:67], a[36:39], a[136:139]
    s_mov_b32 s80, 0
    s_add_u32 m0, s3, 0
    v_mfma_f32_16x16x32_bf16 a[144:147], a[64:67], a[40:43], a[144:147]
    ds_read_b128 a[0:3], v8 offset:34816
    buffer_load_dwordx4 v17, s[48:51], s80 offen lds
    v_mfma_f32_16x16x32_bf16 a[152:155], a[64:67], a[44:47], a[152:155]
    s_xor_b32 s82, s65, 0
    v_mfma_f32_16x16x32_bf16 a[160:163], a[64:67], a[48:51], a[160:163]
    s_lshl_b32 s82, s82, 10
    v_mfma_f32_16x16x32_bf16 a[168:171], a[64:67], a[52:55], a[168:171]
    v_add_u32 v21, s82, v16
    v_mfma_f32_16x16x32_bf16 a[176:179], a[64:67], a[56:59], a[176:179]
    ds_read_b128 a[4:7], v8 offset:36864
    s_xor_b32 s82, s65, 1
    v_mfma_f32_16x16x32_bf16 a[184:187], a[64:67], a[60:63], a[184:187]
    ds_read_b64_tr_b16 a[64:65], v13 offset:0
    s_lshl_b32 s82, s82, 10
    v_mfma_f32_16x16x32_bf16 a[132:135], a[68:71], a[32:35], a[132:135]
    ds_read_b64_tr_b16 a[66:67], v13 offset:256
    v_add_u32 v22, s82, v16
    buffer_load_dwordx4 v18, s[48:51], s80 offen offset:1024 lds
    v_mfma_f32_16x16x32_bf16 a[140:143], a[68:71], a[36:39], a[140:143]
    s_xor_b32 s82, s65, 2
    v_mfma_f32_16x16x32_bf16 a[148:151], a[68:71], a[40:43], a[148:151]
    ds_read_b128 a[8:11], v8 offset:38912
    s_lshl_b32 s82, s82, 10
    v_mfma_f32_16x16x32_bf16 a[156:159], a[68:71], a[44:47], a[156:159]
    v_add_u32 v23, s82, v16
    v_mfma_f32_16x16x32_bf16 a[164:167], a[68:71], a[48:51], a[164:167]
    s_xor_b32 s82, s65, 3
    v_mfma_f32_16x16x32_bf16 a[172:175], a[68:71], a[52:55], a[172:175]
    s_lshl_b32 s82, s82, 10
    s_mov_b32 s81, 229376
    s_add_u32 m0, s3, 8192
    v_mfma_f32_16x16x32_bf16 a[180:183], a[68:71], a[56:59], a[180:183]
    ds_read_b128 a[12:15], v8 offset:40960
    v_add_u32 v24, s82, v16
    buffer_load_dwordx4 v17, s[48:51], s81 offen lds
    v_mfma_f32_16x16x32_bf16 a[188:191], a[68:71], a[60:63], a[188:191]
    ds_read_b64_tr_b16 a[68:69], v15 offset:0
    s_mov_b32 s94, 0xbdd2d3e8
    v_mfma_f32_16x16x32_bf16 v[52:55], a[32:35], a[72:75], v[52:55]
    ds_read_b64_tr_b16 a[70:71], v15 offset:256
    s_mov_b32 s95, 0xbdd2d3e8
    v_mfma_f32_16x16x32_bf16 v[56:59], a[36:39], a[72:75], v[56:59]
    v_mov_b32 v26, 0xc0135761
    v_mfma_f32_16x16x32_bf16 v[60:63], a[40:43], a[72:75], v[60:63]
    ds_read_b128 a[16:19], v8 offset:43008
    v_mov_b32 v27, 0xc0135761
    v_mfma_f32_16x16x32_bf16 v[64:67], a[44:47], a[72:75], v[64:67]
    v_mov_b32 v25, 1
    v_mfma_f32_16x16x32_bf16 v[68:71], a[48:51], a[72:75], v[68:71]
    s_lshl_b32 s82, s60, 12
    buffer_load_dwordx4 v18, s[48:51], s81 offen offset:1024 lds
    v_mfma_f32_16x16x32_bf16 v[72:75], a[52:55], a[72:75], v[72:75]
    s_add_u32 s68, s88, s82
    v_mfma_f32_16x16x32_bf16 v[76:79], a[56:59], a[72:75], v[76:79]
    ds_read_b128 a[20:23], v8 offset:45056
    s_lshl_b32 s82, s61, 13
    v_mfma_f32_16x16x32_bf16 v[80:83], a[60:63], a[72:75], v[80:83]
    ds_read_b64_tr_b16 a[72:73], v13 offset:1024
    s_add_u32 s88, s88, s82
    v_mfma_f32_16x16x32_bf16 v[88:91], a[32:35], a[76:79], v[88:91]
    ds_read_b64_tr_b16 a[74:75], v13 offset:1280
    s_lshr_b32 s82, s66, 1
    v_mfma_f32_16x16x32_bf16 v[92:95], a[36:39], a[76:79], v[92:95]
    s_add_u32 s82, s82, 24
    s_mov_b32 s80, 458752
    s_add_u32 m0, s3, 16384
    v_mfma_f32_16x16x32_bf16 v[96:99], a[40:43], a[76:79], v[96:99]
    ds_read_b128 a[24:27], v8 offset:47104
    s_lshl_b32 s82, s82, 14
    buffer_load_dwordx4 v17, s[48:51], s80 offen lds
    v_mfma_f32_16x16x32_bf16 v[100:103], a[44:47], a[76:79], v[100:103]
    s_add_u32 s90, s88, s82
    v_mfma_f32_16x16x32_bf16 v[104:107], a[48:51], a[76:79], v[104:107]
    s_lshl_b32 s82, s66, 14
    v_mfma_f32_16x16x32_bf16 v[108:111], a[52:55], a[76:79], v[108:111]
    s_add_u32 s88, s88, s82
    v_mfma_f32_16x16x32_bf16 v[112:115], a[56:59], a[76:79], v[112:115]
    ds_read_b128 a[28:31], v8 offset:49152
    s_add_u32 s89, s88, 262144
    v_mfma_f32_16x16x32_bf16 v[116:119], a[60:63], a[76:79], v[116:119]
    ds_read_b64_tr_b16 a[76:77], v15 offset:1024
    s_mov_b32 s76, s93
    v_mfma_f32_16x16x32_bf16 a[192:195], a[80:83], a[32:35], a[192:195]
    ds_read_b64_tr_b16 a[78:79], v15 offset:1280
    s_lshl_b32 s82, s63, 4
    buffer_load_dwordx4 v18, s[48:51], s80 offen offset:1024 lds
    v_mfma_f32_16x16x32_bf16 a[200:203], a[80:83], a[36:39], a[200:203]
    s_lshl_b32 s83, s61, 3
    v_mfma_f32_16x16x32_bf16 a[208:211], a[80:83], a[40:43], a[208:211]
    ds_read_b128 a[112:115], v10 offset:34816
    s_add_u32 s83, s83, s82
    v_mfma_f32_16x16x32_bf16 a[216:219], a[80:83], a[44:47], a[216:219]
    s_add_u32 s83, s83, s65
    v_mfma_f32_16x16x32_bf16 a[224:227], a[80:83], a[48:51], a[224:227]
    s_lshl_b32 s83, s83, 15
    v_mfma_f32_16x16x32_bf16 a[232:235], a[80:83], a[52:55], a[232:235]
    s_add_u32 s69, s83, 4194304
    s_mov_b32 s81, 688128
    s_add_u32 m0, s3, 24576
    v_mfma_f32_16x16x32_bf16 a[240:243], a[80:83], a[56:59], a[240:243]
    ds_read_b64_tr_b16 a[96:97], v13 offset:4096
    s_lshl_b32 s84, s63, 3
    buffer_load_dwordx4 v17, s[48:51], s81 offen lds
    v_mfma_f32_16x16x32_bf16 a[248:251], a[80:83], a[60:63], a[248:251]
    ds_read_b64_tr_b16 a[80:81], v13 offset:2048
    s_add_u32 s84, s84, s66
    v_mfma_f32_16x16x32_bf16 a[196:199], a[84:87], a[32:35], a[196:199]
    ds_read_b64_tr_b16 a[82:83], v13 offset:2304
    s_lshl_b32 s85, s84, 2
    v_mfma_f32_16x16x32_bf16 a[204:207], a[84:87], a[36:39], a[204:207]
    s_add_u32 s85, s85, s60
    v_mfma_f32_16x16x32_bf16 a[212:215], a[84:87], a[40:43], a[212:215]
    ds_read_b64_tr_b16 a[98:99], v13 offset:4352
    s_lshl_b32 s85, s85, 8
    v_mfma_f32_16x16x32_bf16 a[220:223], a[84:87], a[44:47], a[220:223]
    s_add_u32 s77, s85, 39862272
    v_mfma_f32_16x16x32_bf16 a[228:231], a[84:87], a[48:51], a[228:231]
    s_lshl_b32 s84, s84, 18
    buffer_load_dwordx4 v18, s[48:51], s81 offen offset:1024 lds
    v_mfma_f32_16x16x32_bf16 a[236:239], a[84:87], a[52:55], a[236:239]
    s_lshl_b32 s85, s60, 12
    v_mfma_f32_16x16x32_bf16 a[244:247], a[84:87], a[56:59], a[244:247]
    ds_read_b64_tr_b16 a[100:101], v15 offset:4096
    s_add_u32 s84, s84, s85
    v_mfma_f32_16x16x32_bf16 a[252:255], a[84:87], a[60:63], a[252:255]
    ds_read_b64_tr_b16 a[84:85], v15 offset:2048
    s_add_u32 s84, s84, 23068672
    v_mfma_f32_16x16x32_bf16 v[128:131], a[88:91], a[32:35], v[128:131]
    ds_read_b64_tr_b16 a[86:87], v15 offset:2304
    s_xor_b32 s85, s65, 1
    v_mfma_f32_16x16x32_bf16 v[144:147], a[88:91], a[36:39], v[144:147]
    s_lshl_b32 s85, s85, 16
    s_mov_b32 s81, 753664
    s_add_u32 m0, s3, 90112
    v_mfma_f32_16x16x32_bf16 v[160:163], a[88:91], a[40:43], v[160:163]
    ds_read_b64_tr_b16 a[102:103], v15 offset:4352
    s_add_u32 s70, s84, s85
    buffer_load_dwordx4 v17, s[48:51], s81 offen lds
    v_mfma_f32_16x16x32_bf16 v[176:179], a[88:91], a[44:47], v[176:179]
    s_add_u32 s70, s70, 16384
    v_mfma_f32_16x16x32_bf16 v[192:195], a[88:91], a[48:51], v[192:195]
    s_lshl_b32 s85, s65, 16
    v_mfma_f32_16x16x32_bf16 v[208:211], a[88:91], a[52:55], v[208:211]
    s_add_u32 s73, s84, s85
    v_mfma_f32_16x16x32_bf16 v[224:227], a[88:91], a[56:59], v[224:227]
    ds_read_b64_tr_b16 a[120:121], v45 offset:0
    s_add_u32 s73, s73, 16384
    v_mfma_f32_16x16x32_bf16 v[240:243], a[88:91], a[60:63], v[240:243]
    ds_read_b64_tr_b16 a[88:89], v13 offset:3072
    s_xor_b32 s85, s65, 2
    v_mfma_f32_16x16x32_bf16 v[132:135], a[92:95], a[32:35], v[132:135]
    ds_read_b64_tr_b16 a[90:91], v13 offset:3328
    s_lshl_b32 s85, s85, 16
    buffer_load_dwordx4 v18, s[48:51], s81 offen offset:1024 lds
    v_mfma_f32_16x16x32_bf16 v[148:151], a[92:95], a[36:39], v[148:151]
    s_add_u32 s71, s84, s85
    v_mfma_f32_16x16x32_bf16 v[164:167], a[92:95], a[40:43], v[164:167]
    ds_read_b64_tr_b16 a[122:123], v45 offset:256
    s_add_u32 s71, s71, 32768
    v_mfma_f32_16x16x32_bf16 v[180:183], a[92:95], a[44:47], v[180:183]
    s_lshl_b32 s85, s65, 16
    v_mfma_f32_16x16x32_bf16 v[196:199], a[92:95], a[48:51], v[196:199]
    s_add_u32 s74, s84, s85
    v_mfma_f32_16x16x32_bf16 v[212:215], a[92:95], a[52:55], v[212:215]
    s_add_u32 s74, s74, 32768
    s_mov_b32 s80, 983040
    s_add_u32 m0, s3, 98304
    v_mfma_f32_16x16x32_bf16 v[228:231], a[92:95], a[56:59], v[228:231]
    s_xor_b32 s85, s65, 3
    buffer_load_dwordx4 v17, s[48:51], s80 offen lds
    v_mfma_f32_16x16x32_bf16 v[244:247], a[92:95], a[60:63], v[244:247]
    ds_read_b64_tr_b16 a[92:93], v15 offset:3072
    s_lshl_b32 s85, s85, 16
    v_mfma_f32_16x16x32_bf16 v[136:139], a[104:107], a[32:35], v[136:139]
    ds_read_b64_tr_b16 a[94:95], v15 offset:3328
    v_mfma_f32_16x16x32_bf16 v[152:155], a[104:107], a[36:39], v[152:155]
    v_mfma_f32_16x16x32_bf16 v[168:171], a[104:107], a[40:43], v[168:171]
    v_mfma_f32_16x16x32_bf16 v[184:187], a[104:107], a[44:47], v[184:187]
    v_mfma_f32_16x16x32_bf16 v[200:203], a[104:107], a[48:51], v[200:203]
    buffer_load_dwordx4 v18, s[48:51], s80 offen offset:1024 lds
    v_mfma_f32_16x16x32_bf16 v[216:219], a[104:107], a[52:55], v[216:219]
    v_mfma_f32_16x16x32_bf16 v[232:235], a[104:107], a[56:59], v[232:235]
    v_mfma_f32_16x16x32_bf16 v[248:251], a[104:107], a[60:63], v[248:251]
    v_mfma_f32_16x16x32_bf16 v[140:143], a[108:111], a[32:35], v[140:143]
    v_mfma_f32_16x16x32_bf16 v[156:159], a[108:111], a[36:39], v[156:159]
    v_mfma_f32_16x16x32_bf16 v[172:175], a[108:111], a[40:43], v[172:175]
    v_mfma_f32_16x16x32_bf16 v[188:191], a[108:111], a[44:47], v[188:191]
    v_mfma_f32_16x16x32_bf16 v[204:207], a[108:111], a[48:51], v[204:207]
    v_mfma_f32_16x16x32_bf16 v[220:223], a[108:111], a[52:55], v[220:223]
    v_mfma_f32_16x16x32_bf16 v[236:239], a[108:111], a[56:59], v[236:239]
    v_mfma_f32_16x16x32_bf16 v[252:255], a[108:111], a[60:63], v[252:255]
    s_waitcnt lgkmcnt(0)
    s_barrier
    v_mfma_f32_16x16x32_bf16 v[120:123], a[120:123], a[112:115], v[120:123]
    v_mfma_f32_16x16x32_bf16 a[128:131], a[64:67], a[0:3], a[128:131]
    v_mfma_f32_16x16x32_bf16 a[136:139], a[64:67], a[4:7], a[136:139]
    s_mov_b32 s81, 1212416
    s_add_u32 m0, s3, 106496
    v_mfma_f32_16x16x32_bf16 a[144:147], a[64:67], a[8:11], a[144:147]
    ds_read_b128 a[32:35], v9 offset:34816
    buffer_load_dwordx4 v17, s[48:51], s81 offen lds
    v_mfma_f32_16x16x32_bf16 a[152:155], a[64:67], a[12:15], a[152:155]
    s_add_u32 s72, s84, s85
    v_mfma_f32_16x16x32_bf16 a[160:163], a[64:67], a[16:19], a[160:163]
    s_add_u32 s72, s72, 49152
    v_mfma_f32_16x16x32_bf16 a[168:171], a[64:67], a[20:23], a[168:171]
    s_lshl_b32 s85, s65, 16
    v_mfma_f32_16x16x32_bf16 a[176:179], a[64:67], a[24:27], a[176:179]
    ds_read_b128 a[36:39], v9 offset:36864
    s_add_u32 s75, s84, s85
    v_mfma_f32_16x16x32_bf16 a[184:187], a[64:67], a[28:31], a[184:187]
    ds_read_b64_tr_b16 a[64:65], v13 offset:20480
    s_add_u32 s75, s75, 49152
    v_mfma_f32_16x16x32_bf16 a[132:135], a[68:71], a[0:3], a[132:135]
    ds_read_b64_tr_b16 a[66:67], v13 offset:20736
    s_lshl_b32 s83, s61, 3
    v_mfma_f32_16x16x32_bf16 a[140:143], a[68:71], a[4:7], a[140:143]
    s_add_u32 s82, s82, s83
    v_mfma_f32_16x16x32_bf16 a[148:151], a[68:71], a[8:11], a[148:151]
    ds_read_b128 a[40:43], v9 offset:38912
    s_lshl_b32 s82, s82, 5
    v_mfma_f32_16x16x32_bf16 a[156:159], a[68:71], a[12:15], a[156:159]
    s_add_u32 s82, s82, s64
    v_mfma_f32_16x16x32_bf16 a[164:167], a[68:71], a[16:19], a[164:167]
    s_lshl_b32 s82, s82, 10
    v_mfma_f32_16x16x32_bf16 a[172:175], a[68:71], a[20:23], a[172:175]
    s_add_u32 s91, s82, 4194304
    v_mfma_f32_16x16x32_bf16 a[180:183], a[68:71], a[24:27], a[180:183]
    ds_read_b128 a[44:47], v9 offset:40960
    v_mov_b32 v42, 1
    buffer_load_dwordx4 v18, s[48:51], s81 offen offset:1024 lds
    v_mfma_f32_16x16x32_bf16 a[188:191], a[68:71], a[28:31], a[188:191]
    ds_read_b64_tr_b16 a[68:69], v15 offset:20480
    v_and_b32 v37, 1, v35
    v_mfma_f32_16x16x32_bf16 v[52:55], a[0:3], a[72:75], v[52:55]
    ds_read_b64_tr_b16 a[70:71], v15 offset:20736
    v_lshl_add_u32 v36, v34, 2, v37
    v_mfma_f32_16x16x32_bf16 v[56:59], a[4:7], a[72:75], v[56:59]
    v_cmp_le_u32 s[4:5], v36, v35
    v_mfma_f32_16x16x32_bf16 v[60:63], a[8:11], a[72:75], v[60:63]
    ds_read_b128 a[48:51], v9 offset:43008
    v_add_u32 v36, 2, v36
    v_mfma_f32_16x16x32_bf16 v[64:67], a[12:15], a[72:75], v[64:67]
    v_cmp_le_u32 s[6:7], v36, v35
    v_mfma_f32_16x16x32_bf16 v[68:71], a[16:19], a[72:75], v[68:71]
    v_mul_u32_u24 v36, 0x0202, v37
    v_mfma_f32_16x16x32_bf16 v[72:75], a[20:23], a[72:75], v[72:75]
    v_lshlrev_b32 v36, 16, v36
    v_mfma_f32_16x16x32_bf16 v[76:79], a[24:27], a[72:75], v[76:79]
    ds_read_b128 a[52:55], v9 offset:45056
    v_add_u32 v36, 0x01000c0c, v36
    v_mfma_f32_16x16x32_bf16 v[80:83], a[28:31], a[72:75], v[80:83]
    ds_read_b64_tr_b16 a[72:73], v13 offset:21504
    v_add_u32 v38, 0x04040000, v36
    v_mfma_f32_16x16x32_bf16 v[88:91], a[0:3], a[76:79], v[88:91]
    ds_read_b64_tr_b16 a[74:75], v13 offset:21760
    v_cndmask_b32 v28, v36, v38, s[4:5]
    v_mfma_f32_16x16x32_bf16 v[92:95], a[4:7], a[76:79], v[92:95]
    v_cndmask_b32 v29, v36, v38, s[6:7]
    s_mov_b32 s80, 1441792
    s_add_u32 m0, s3, 114688
    v_mfma_f32_16x16x32_bf16 v[96:99], a[8:11], a[76:79], v[96:99]
    ds_read_b128 a[56:59], v9 offset:47104
    v_cmp_eq_u32 vcc, 1, v37
    buffer_load_dwordx4 v17, s[48:51], s80 offen lds
    v_mfma_f32_16x16x32_bf16 v[100:103], a[12:15], a[76:79], v[100:103]
    v_mov_b32 v36, 0x0c0c0100
    v_mfma_f32_16x16x32_bf16 v[104:107], a[16:19], a[76:79], v[104:107]
    v_mov_b32 v38, 0x01000c0c
    v_mfma_f32_16x16x32_bf16 v[108:111], a[20:23], a[76:79], v[108:111]
    v_cndmask_b32 v36, v36, v38, vcc
    v_mfma_f32_16x16x32_bf16 v[112:115], a[24:27], a[76:79], v[112:115]
    ds_read_b128 a[60:63], v9 offset:49152
    v_mov_b32 v38, 0x0c0c0302
    v_mfma_f32_16x16x32_bf16 v[116:119], a[28:31], a[76:79], v[116:119]
    ds_read_b64_tr_b16 a[76:77], v15 offset:21504
    v_mov_b32 v39, 0x03020c0c
    v_mfma_f32_16x16x32_bf16 a[192:195], a[80:83], a[0:3], a[192:195]
    ds_read_b64_tr_b16 a[78:79], v15 offset:21760
    v_cndmask_b32 v38, v38, v39, vcc
    v_mfma_f32_16x16x32_bf16 a[200:203], a[80:83], a[4:7], a[200:203]
    v_mov_b32 v39, 0x0c0c0c0c
    v_mfma_f32_16x16x32_bf16 a[208:211], a[80:83], a[8:11], a[208:211]
    ds_read_b128 a[116:119], v11 offset:34816
    v_cndmask_b32 v30, v36, v39, s[4:5]
    v_mfma_f32_16x16x32_bf16 a[216:219], a[80:83], a[12:15], a[216:219]
    v_cndmask_b32 v31, v38, v39, s[6:7]
    v_mfma_f32_16x16x32_bf16 a[224:227], a[80:83], a[16:19], a[224:227]
    v_cndmask_b32 v32, v39, v36, s[4:5]
    v_mfma_f32_16x16x32_bf16 a[232:235], a[80:83], a[20:23], a[232:235]
    v_cndmask_b32 v33, v39, v38, s[6:7]
    v_mfma_f32_16x16x32_bf16 a[240:243], a[80:83], a[24:27], a[240:243]
    ds_read_b64_tr_b16 a[104:105], v13 offset:24576
    s_or_b32 s82, s63, s61
    buffer_load_dwordx4 v18, s[48:51], s80 offen offset:1024 lds
    v_mfma_f32_16x16x32_bf16 a[248:251], a[80:83], a[28:31], a[248:251]
    ds_read_b64_tr_b16 a[80:81], v13 offset:22528
    s_cmp_eq_u32 s82, 0
    s_cselect_b64 s[4:5], s[4:5], -1
    s_cselect_b64 s[6:7], s[6:7], -1
    v_mfma_f32_16x16x32_bf16 a[196:199], a[84:87], a[0:3], a[196:199]
    ds_read_b64_tr_b16 a[82:83], v13 offset:22784
    s_mov_b32 s14, 0x3e3504f3
    v_mfma_f32_16x16x32_bf16 a[204:207], a[84:87], a[4:7], a[204:207]
    s_mov_b32 s15, 0x3e3504f3
    s_branch L_over1
L_stub1:
    s_branch L_stub5
L_over1:
    v_mfma_f32_16x16x32_bf16 a[212:215], a[84:87], a[8:11], a[212:215]
    ds_read_b64_tr_b16 a[106:107], v13 offset:24832
    s_mov_b32 s98, 0x3fb8aa3b
    v_mfma_f32_16x16x32_bf16 a[220:223], a[84:87], a[12:15], a[220:223]
    s_mov_b32 s99, 0x3fb8aa3b
    v_mfma_f32_16x16x32_bf16 a[228:231], a[84:87], a[16:19], a[228:231]
    s_lshl_b32 s82, s63, 2
    v_mfma_f32_16x16x32_bf16 a[236:239], a[84:87], a[20:23], a[236:239]
    s_add_u32 s82, s82, s60
    v_mfma_f32_16x16x32_bf16 a[244:247], a[84:87], a[24:27], a[244:247]
    ds_read_b64_tr_b16 a[108:109], v15 offset:24576
    s_lshl_b32 s82, s82, 2
    v_mfma_f32_16x16x32_bf16 a[252:255], a[84:87], a[28:31], a[252:255]
    ds_read_b64_tr_b16 a[84:85], v15 offset:22528
    s_add_u32 s82, s82, s65
    v_mfma_f32_16x16x32_bf16 v[128:131], a[88:91], a[0:3], v[128:131]
    ds_read_b64_tr_b16 a[86:87], v15 offset:22784
    s_lshl_b32 s82, s82, 15
    v_mfma_f32_16x16x32_bf16 v[144:147], a[88:91], a[4:7], v[144:147]
    s_lshl_b32 s83, s66, 8
    s_mov_b32 s81, 1671168
    s_add_u32 m0, s3, 122880
    v_mfma_f32_16x16x32_bf16 v[160:163], a[88:91], a[8:11], v[160:163]
    ds_read_b64_tr_b16 a[110:111], v15 offset:24832
    s_add_u32 s82, s82, s83
    buffer_load_dwordx4 v17, s[48:51], s81 offen lds
    v_mfma_f32_16x16x32_bf16 v[176:179], a[88:91], a[12:15], v[176:179]
    v_and_b32 v34, 15, v0
    v_mfma_f32_16x16x32_bf16 v[192:195], a[88:91], a[16:19], v[192:195]
    v_lshrrev_b32 v35, 4, v0
    v_mfma_f32_16x16x32_bf16 v[208:211], a[88:91], a[20:23], v[208:211]
    v_lshlrev_b32 v36, 11, v34
    v_mfma_f32_16x16x32_bf16 v[224:227], a[88:91], a[24:27], v[224:227]
    ds_read_b64_tr_b16 a[124:125], v45 offset:20480
    v_add_u32 v36, s82, v36
    v_mfma_f32_16x16x32_bf16 v[240:243], a[88:91], a[28:31], v[240:243]
    ds_read_b64_tr_b16 a[88:89], v13 offset:23552
    v_and_b32 v2, 1, v35
    v_mfma_f32_16x16x32_bf16 v[132:135], a[92:95], a[0:3], v[132:135]
    ds_read_b64_tr_b16 a[90:91], v13 offset:23808
    v_lshl_add_u32 v36, v2, 5, v36
    v_mfma_f32_16x16x32_bf16 v[148:151], a[92:95], a[4:7], v[148:151]
    v_lshrrev_b32 v2, 1, v35
    v_mfma_f32_16x16x32_bf16 v[164:167], a[92:95], a[8:11], v[164:167]
    ds_read_b64_tr_b16 a[126:127], v45 offset:20736
    v_lshl_add_u32 v2, v2, 4, v36
    v_mfma_f32_16x16x32_bf16 v[180:183], a[92:95], a[12:15], v[180:183]
    v_lshrrev_b32 v36, 3, v34
    v_mfma_f32_16x16x32_bf16 v[196:199], a[92:95], a[16:19], v[196:199]
    v_mul_u32_u24 v36, 16320, v36
    v_mfma_f32_16x16x32_bf16 v[212:215], a[92:95], a[20:23], v[212:215]
    v_sub_u32 v1, v2, v36
    v_mfma_f32_16x16x32_bf16 v[228:231], a[92:95], a[24:27], v[228:231]
    v_xor_b32 v5, 64, v1
    buffer_load_dwordx4 v18, s[48:51], s81 offen offset:1024 lds
    v_mfma_f32_16x16x32_bf16 v[244:247], a[92:95], a[28:31], v[244:247]
    ds_read_b64_tr_b16 a[92:93], v15 offset:23552
    v_add_u32 v5, 16384, v5
    v_mfma_f32_16x16x32_bf16 v[136:139], a[96:99], a[0:3], v[136:139]
    ds_read_b64_tr_b16 a[94:95], v15 offset:23808
    v_mfma_f32_16x16x32_bf16 v[152:155], a[96:99], a[4:7], v[152:155]
    v_mfma_f32_16x16x32_bf16 v[168:171], a[96:99], a[8:11], v[168:171]
    v_mfma_f32_16x16x32_bf16 v[184:187], a[96:99], a[12:15], v[184:187]
    v_mfma_f32_16x16x32_bf16 v[200:203], a[96:99], a[16:19], v[200:203]
    v_mfma_f32_16x16x32_bf16 v[216:219], a[96:99], a[20:23], v[216:219]
    v_mfma_f32_16x16x32_bf16 v[232:235], a[96:99], a[24:27], v[232:235]
    v_mfma_f32_16x16x32_bf16 v[248:251], a[96:99], a[28:31], v[248:251]
    v_mfma_f32_16x16x32_bf16 v[140:143], a[100:103], a[0:3], v[140:143]
    v_mfma_f32_16x16x32_bf16 v[156:159], a[100:103], a[4:7], v[156:159]
    v_mfma_f32_16x16x32_bf16 v[172:175], a[100:103], a[8:11], v[172:175]
    v_mfma_f32_16x16x32_bf16 v[188:191], a[100:103], a[12:15], v[188:191]
    v_mfma_f32_16x16x32_bf16 v[204:207], a[100:103], a[16:19], v[204:207]
    v_mfma_f32_16x16x32_bf16 v[220:223], a[100:103], a[20:23], v[220:223]
    v_mfma_f32_16x16x32_bf16 v[236:239], a[100:103], a[24:27], v[236:239]
    v_mfma_f32_16x16x32_bf16 v[252:255], a[100:103], a[28:31], v[252:255]
    s_waitcnt lgkmcnt(0)
    s_barrier
    v_mfma_f32_16x16x32_bf16 v[120:123], a[124:127], a[116:119], v[120:123]
    s_lshl_b32 s82, s62, 3
    s_add_u32 s82, s82, s61
    v_mfma_f32_16x16x32_bf16 a[128:131], a[64:67], a[32:35], a[128:131]
    s_lshl_b32 s82, s82, 10
    s_add_u32 s82, s82, 139264
    v_mfma_f32_16x16x32_bf16 a[136:139], a[64:67], a[36:39], a[136:139]
    s_mov_b32 s80, 917504
    s_add_u32 m0, s3, 32768
    v_add_u32 v44, s82, v16
    s_lshl_b32 s82, s61, 12
    v_mfma_f32_16x16x32_bf16 a[144:147], a[64:67], a[40:43], a[144:147]
    buffer_load_dwordx4 v17, s[48:51], s80 offen lds
    s_add_u32 s82, s82, 139264
    v_add_u32 v45, s82, v16
    v_mfma_f32_16x16x32_bf16 a[152:155], a[64:67], a[44:47], a[152:155]
    v_lshrrev_b32 v34, 2, v0
    v_mfma_f32_16x16x32_bf16 a[160:163], a[64:67], a[48:51], a[160:163]
    ds_write_b128 v44, v[120:123]
    v_and_b32 v35, 3, v0
    v_mfma_f32_16x16x32_bf16 a[168:171], a[64:67], a[52:55], a[168:171]
    v_lshlrev_b32 v35, 3, v35
    v_mfma_f32_16x16x32_bf16 a[176:179], a[64:67], a[56:59], a[176:179]
    v_lshl_add_u32 v35, v34, 8, v35
    v_mfma_f32_16x16x32_bf16 a[184:187], a[64:67], a[60:63], a[184:187]
    v_and_b32 v34, 7, v34
    v_mfma_f32_16x16x32_bf16 a[132:135], a[68:71], a[32:35], a[132:135]
    buffer_load_dwordx4 v18, s[48:51], s80 offen offset:1024 lds
    v_xor_b32 v36, 0, v34
    v_mfma_f32_16x16x32_bf16 a[140:143], a[68:71], a[36:39], a[140:143]
    v_lshl_add_u32 v8, v36, 5, v35
    v_mfma_f32_16x16x32_bf16 a[148:151], a[68:71], a[40:43], a[148:151]
    v_xor_b32 v36, 1, v34
    v_mfma_f32_16x16x32_bf16 a[156:159], a[68:71], a[44:47], a[156:159]
    v_lshl_add_u32 v9, v36, 5, v35
    v_mfma_f32_16x16x32_bf16 a[164:167], a[68:71], a[48:51], a[164:167]
    v_xor_b32 v36, 2, v34
    v_mfma_f32_16x16x32_bf16 a[172:175], a[68:71], a[52:55], a[172:175]
    s_mov_b32 s81, 1146880
    s_add_u32 m0, s3, 40960
    v_lshl_add_u32 v10, v36, 5, v35
    v_mfma_f32_16x16x32_bf16 a[180:183], a[68:71], a[56:59], a[180:183]
    buffer_load_dwordx4 v17, s[48:51], s81 offen lds
    v_xor_b32 v36, 3, v34
    v_mfma_f32_16x16x32_bf16 a[188:191], a[68:71], a[60:63], a[188:191]
    v_lshl_add_u32 v11, v36, 5, v35
    v_mfma_f32_16x16x32_bf16 v[52:55], a[32:35], a[72:75], v[52:55]
    v_xor_b32 v36, 4, v34
    v_mfma_f32_16x16x32_bf16 v[56:59], a[36:39], a[72:75], v[56:59]
    v_lshl_add_u32 v12, v36, 5, v35
    v_mfma_f32_16x16x32_bf16 v[60:63], a[40:43], a[72:75], v[60:63]
    v_xor_b32 v36, 5, v34
    v_mfma_f32_16x16x32_bf16 v[64:67], a[44:47], a[72:75], v[64:67]
    v_lshl_add_u32 v13, v36, 5, v35
    v_mfma_f32_16x16x32_bf16 v[68:71], a[48:51], a[72:75], v[68:71]
    buffer_load_dwordx4 v18, s[48:51], s81 offen offset:1024 lds
    v_xor_b32 v36, 6, v34
    v_mfma_f32_16x16x32_bf16 v[72:75], a[52:55], a[72:75], v[72:75]
    v_lshl_add_u32 v14, v36, 5, v35
    v_mfma_f32_16x16x32_bf16 v[76:79], a[56:59], a[72:75], v[76:79]
    v_xor_b32 v36, 7, v34
    v_mfma_f32_16x16x32_bf16 v[80:83], a[60:63], a[72:75], v[80:83]
    v_lshl_add_u32 v15, v36, 5, v35
    v_mfma_f32_16x16x32_bf16 v[88:91], a[32:35], a[76:79], v[88:91]
    v_mfma_f32_16x16x32_bf16 v[92:95], a[36:39], a[76:79], v[92:95]
    s_mov_b32 s80, 1376256
    s_add_u32 m0, s3, 49152
    v_mfma_f32_16x16x32_bf16 v[96:99], a[40:43], a[76:79], v[96:99]
    buffer_load_dwordx4 v17, s[48:51], s80 offen lds
    v_mfma_f32_16x16x32_bf16 v[100:103], a[44:47], a[76:79], v[100:103]
    v_mfma_f32_16x16x32_bf16 v[104:107], a[48:51], a[76:79], v[104:107]
    v_mfma_f32_16x16x32_bf16 v[108:111], a[52:55], a[76:79], v[108:111]
    v_mfma_f32_16x16x32_bf16 v[112:115], a[56:59], a[76:79], v[112:115]
    v_mfma_f32_16x16x32_bf16 v[116:119], a[60:63], a[76:79], v[116:119]
    v_mfma_f32_16x16x32_bf16 a[192:195], a[80:83], a[32:35], a[192:195]
    buffer_load_dwordx4 v18, s[48:51], s80 offen offset:1024 lds
    v_mfma_f32_16x16x32_bf16 a[200:203], a[80:83], a[36:39], a[200:203]
    v_mfma_f32_16x16x32_bf16 a[208:211], a[80:83], a[40:43], a[208:211]
    v_mfma_f32_16x16x32_bf16 a[216:219], a[80:83], a[44:47], a[216:219]
    v_mfma_f32_16x16x32_bf16 a[224:227], a[80:83], a[48:51], a[224:227]
    v_mfma_f32_16x16x32_bf16 a[232:235], a[80:83], a[52:55], a[232:235]
    s_mov_b32 s81, 1605632
    s_add_u32 m0, s3, 57344
    v_mfma_f32_16x16x32_bf16 a[240:243], a[80:83], a[56:59], a[240:243]
    buffer_load_dwordx4 v17, s[48:51], s81 offen lds
    v_mfma_f32_16x16x32_bf16 a[248:251], a[80:83], a[60:63], a[248:251]
    s_cmp_lg_u32 s60, 0
    s_cbranch_scc1 L_noxw
    ds_write_b128 v45, a[184:187] offset:4096
    ds_write_b128 v45, a[188:191] offset:5120
    ds_write_b128 v45, v[80:83] offset:12288
    ds_write_b128 v45, v[116:119] offset:13312
L_noxw:
    v_mfma_f32_16x16x32_bf16 a[196:199], a[84:87], a[32:35], a[196:199]
    v_mfma_f32_16x16x32_bf16 a[204:207], a[84:87], a[36:39], a[204:207]
    v_mfma_f32_16x16x32_bf16 a[212:215], a[84:87], a[40:43], a[212:215]
    v_mfma_f32_16x16x32_bf16 a[220:223], a[84:87], a[44:47], a[220:223]
    v_mfma_f32_16x16x32_bf16 a[228:231], a[84:87], a[48:51], a[228:231]
    buffer_load_dwordx4 v18, s[48:51], s81 offen offset:1024 lds
    v_mfma_f32_16x16x32_bf16 a[236:239], a[84:87], a[52:55], a[236:239]
    v_mfma_f32_16x16x32_bf16 a[244:247], a[84:87], a[56:59], a[244:247]
    v_mfma_f32_16x16x32_bf16 a[252:255], a[84:87], a[60:63], a[252:255]
    v_mfma_f32_16x16x32_bf16 v[128:131], a[88:91], a[32:35], v[128:131]
    v_mfma_f32_16x16x32_bf16 v[144:147], a[88:91], a[36:39], v[144:147]
    s_mov_b32 s80, 65536
    s_add_u32 m0, s3, 65536
    v_mfma_f32_16x16x32_bf16 v[160:163], a[88:91], a[40:43], v[160:163]
    buffer_load_dwordx4 v17, s[48:51], s80 offen lds
    v_mfma_f32_16x16x32_bf16 v[176:179], a[88:91], a[44:47], v[176:179]
    v_mfma_f32_16x16x32_bf16 v[192:195], a[88:91], a[48:51], v[192:195]
    v_mfma_f32_16x16x32_bf16 v[208:211], a[88:91], a[52:55], v[208:211]
    v_mfma_f32_16x16x32_bf16 v[224:227], a[88:91], a[56:59], v[224:227]
    v_mfma_f32_16x16x32_bf16 v[240:243], a[88:91], a[60:63], v[240:243]
    v_mfma_f32_16x16x32_bf16 v[132:135], a[92:95], a[32:35], v[132:135]
    buffer_load_dwordx4 v18, s[48:51], s80 offen offset:1024 lds
    v_mfma_f32_16x16x32_bf16 v[148:151], a[92:95], a[36:39], v[148:151]
    v_mfma_f32_16x16x32_bf16 v[164:167], a[92:95], a[40:43], v[164:167]
    v_mfma_f32_16x16x32_bf16 v[180:183], a[92:95], a[44:47], v[180:183]
    v_mfma_f32_16x16x32_bf16 v[196:199], a[92:95], a[48:51], v[196:199]
    v_mfma_f32_16x16x32_bf16 v[212:215], a[92:95], a[52:55], v[212:215]
    s_mov_b32 s80, 131072
    s_add_u32 m0, s3, 131072
    v_mfma_f32_16x16x32_bf16 v[228:231], a[92:95], a[56:59], v[228:231]
    buffer_load_dwordx4 v17, s[48:51], s80 offen lds
    v_mfma_f32_16x16x32_bf16 v[244:247], a[92:95], a[60:63], v[244:247]
    v_mfma_f32_16x16x32_bf16 v[136:139], a[104:107], a[32:35], v[136:139]
    v_mfma_f32_16x16x32_bf16 v[152:155], a[104:107], a[36:39], v[152:155]
    v_mfma_f32_16x16x32_bf16 v[168:171], a[104:107], a[40:43], v[168:171]
    v_mfma_f32_16x16x32_bf16 v[184:187], a[104:107], a[44:47], v[184:187]
    v_mfma_f32_16x16x32_bf16 v[200:203], a[104:107], a[48:51], v[200:203]
    buffer_load_dwordx4 v18, s[48:51], s80 offen offset:1024 lds
    v_mfma_f32_16x16x32_bf16 v[216:219], a[104:107], a[52:55], v[216:219]
    v_mfma_f32_16x16x32_bf16 v[232:235], a[104:107], a[56:59], v[232:235]
    v_mfma_f32_16x16x32_bf16 v[248:251], a[104:107], a[60:63], v[248:251]
    v_mfma_f32_16x16x32_bf16 v[140:143], a[108:111], a[32:35], v[140:143]
    v_mfma_f32_16x16x32_bf16 v[156:159], a[108:111], a[36:39], v[156:159]
    v_mfma_f32_16x16x32_bf16 v[172:175], a[108:111], a[40:43], v[172:175]
    v_mfma_f32_16x16x32_bf16 v[188:191], a[108:111], a[44:47], v[188:191]
    v_mfma_f32_16x16x32_bf16 v[204:207], a[108:111], a[48:51], v[204:207]
    v_mfma_f32_16x16x32_bf16 v[220:223], a[108:111], a[52:55], v[220:223]
    v_mfma_f32_16x16x32_bf16 v[236:239], a[108:111], a[56:59], v[236:239]
    v_mfma_f32_16x16x32_bf16 v[252:255], a[108:111], a[60:63], v[252:255]
    s_waitcnt lgkmcnt(0)
    s_barrier
    ds_read_b128 v[120:123], v45 offset:0
    ds_read_b128 v[124:127], v45 offset:1024
    ds_read_b128 v[48:51], v45 offset:8192
    ds_read_b128 v[84:87], v45 offset:9216
    s_branch L_epi
L_stub2:
    s_branch L_stub6
L_g1_1:
    s_mov_b32 m0, s14
    s_mov_b32 s77, 4096
    buffer_load_dwordx4 v1, s[28:31], s77 offen sc1 lds
    s_mov_b32 s77, 19456
    buffer_load_dwordx4 v1, s[28:31], s77 offen offset:1024 sc1 lds
    v_add_u32 v1, 128, v1
    s_mov_b32 m0, s15
    s_mov_b32 s77, 4096
    buffer_load_dwordx4 v1, s[28:31], s77 offen sc1 lds
    s_mov_b32 s77, 19456
    buffer_load_dwordx4 v1, s[28:31], s77 offen offset:1024 sc1 lds
    v_add_u32 v1, 128, v1
    s_barrier
    s_add_u32 m0, s78, 40960
    s_nop 0
    buffer_load_dwordx4 v2, s[32:35], s68 offen offset:0 lds
    buffer_load_dwordx4 v2, s[32:35], s69 offen offset:1024 lds
    buffer_load_dwordx4 v2, s[32:35], s70 offen offset:2048 lds
    v_add_u32 v2, 196608, v2
    buffer_load_dwordx4 v3, s[36:39], s71 offen offset:3072 lds
    s_add_u32 m0, s78, 45056
    s_nop 0
    buffer_load_dwordx4 v3, s[40:43], s72 offen offset:0 lds
    buffer_load_dwordx4 v3, s[36:39], s73 offen offset:1024 lds
    buffer_load_dwordx4 v3, s[40:43], s74 offen offset:2048 lds
    buffer_load_dwordx4 v3, s[36:39], s75 offen offset:3072 lds
    s_add_u32 m0, s78, 49152
    s_nop 0
    buffer_load_dwordx4 v3, s[40:43], s76 offen offset:0 lds
    v_add_u32 v3, 229376, v3
    global_load_lds_dwordx4 v[4:5], off offset:1024
    v_lshl_add_u64 v[4:5], v[4:5], 0, s[80:81]
    s_waitcnt vmcnt(12)
    s_barrier
    ds_read_b64_tr_b16 a[64:65], v12 offset:0
    ds_read_b64_tr_b16 a[66:67], v12 offset:256
    ds_read_b64_tr_b16 a[68:69], v14 offset:0
    ds_read_b64_tr_b16 a[70:71], v14 offset:256
    ds_read_b64_tr_b16 a[72:73], v12 offset:1024
    ds_read_b64_tr_b16 a[74:75], v12 offset:1280
    ds_read_b64_tr_b16 a[76:77], v14 offset:1024
    ds_read_b64_tr_b16 a[78:79], v14 offset:1280
    ds_read_b64_tr_b16 a[80:81], v12 offset:2048
    ds_read_b64_tr_b16 a[82:83], v12 offset:2304
    ds_read_b64_tr_b16 a[84:85], v14 offset:2048
    ds_read_b64_tr_b16 a[86:87], v14 offset:2304
    ds_read_b64_tr_b16 a[88:89], v12 offset:3072
    ds_read_b64_tr_b16 a[90:91], v12 offset:3328
    ds_read_b64_tr_b16 a[92:93], v14 offset:3072
    ds_read_b64_tr_b16 a[94:95], v14 offset:3328
    ds_read_b64_tr_b16 a[96:97], v12 offset:4096
    ds_read_b64_tr_b16 a[98:99], v12 offset:4352
    ds_read_b64_tr_b16 a[100:101], v14 offset:4096
    ds_read_b64_tr_b16 a[102:103], v14 offset:4352
    ds_read_b128 a[0:3], v8 offset:0
    ds_read_b128 a[4:7], v8 offset:2048
    ds_read_b128 a[8:11], v8 offset:4096
    ds_read_b128 a[12:15], v8 offset:6144
    ds_read_b128 a[16:19], v8 offset:8192
    ds_read_b128 a[20:23], v8 offset:10240
    ds_read_b128 a[24:27], v8 offset:12288
    ds_read_b128 a[28:31], v8 offset:14336
    ds_read_b128 a[112:115], v10 offset:0
    ds_read_b64_tr_b16 a[120:121], v44 offset:0
    ds_read_b64_tr_b16 a[122:123], v44 offset:256
    s_add_u32 m0, s78, 61440
    s_nop 0
    buffer_load_dwordx4 v2, s[32:35], s68 offen offset:0 lds
    buffer_load_dwordx4 v2, s[32:35], s69 offen offset:1024 lds
    buffer_load_dwordx4 v2, s[32:35], s70 offen offset:2048 lds
    v_add_u32 v2, 196608, v2
    buffer_load_dwordx4 v3, s[36:39], s71 offen offset:3072 lds
    s_add_u32 m0, s78, 65536
    s_nop 0
    buffer_load_dwordx4 v3, s[40:43], s72 offen offset:0 lds
    buffer_load_dwordx4 v3, s[36:39], s73 offen offset:1024 lds
    buffer_load_dwordx4 v3, s[40:43], s74 offen offset:2048 lds
    buffer_load_dwordx4 v3, s[36:39], s75 offen offset:3072 lds
    s_add_u32 m0, s78, 69632
    s_nop 0
    buffer_load_dwordx4 v3, s[40:43], s76 offen offset:0 lds
    v_add_u32 v3, 229376, v3
    global_load_lds_dwordx4 v[4:5], off offset:1024
    v_lshl_add_u64 v[4:5], v[4:5], 0, s[80:81]
    s_mov_b32 s67, 7
    v_mov_b32 v20, 0x7ff00000
.p2align 3
L_loop1:
    s_waitcnt vmcnt(24) lgkmcnt(0)
    s_barrier
    v_mfma_f32_16x16x32_bf16 v[120:123], a[112:115], a[120:123], v[120:123]
    s_add_u32 m0, s78, 0
    buffer_load_dword v7, v6, s[44:47], s4 offen
    v_add_u32_e64 v6, s79, v6
    v_mfma_f32_16x16x32_bf16 v[128:131], a[64:67], a[0:3], v[128:131]
    buffer_load_dwordx4 v2, s[32:35], s68 offen offset:0 lds
    buffer_load_dword v7, v33, s[48:51], 0 offen
    v_add_u32_e64 v33, s52, v33
    v_mfma_f32_16x16x32_bf16 v[144:147], a[64:67], a[4:7], v[144:147]
    v_mfma_f32_16x16x32_bf16 v[160:163], a[64:67], a[8:11], v[160:163]
    ds_read_b128 a[32:35], v9 offset:0
    v_mfma_f32_16x16x32_bf16 v[176:179], a[64:67], a[12:15], v[176:179]
    v_mfma_f32_16x16x32_bf16 v[192:195], a[64:67], a[16:19], v[192:195]
    v_mfma_f32_16x16x32_bf16 v[208:211], a[64:67], a[20:23], v[208:211]
    v_mfma_f32_16x16x32_bf16 v[224:227], a[64:67], a[24:27], v[224:227]
    ds_read_b128 a[36:39], v9 offset:2048
    v_mfma_f32_16x16x32_bf16 v[240:243], a[64:67], a[28:31], v[240:243]
    ds_read_b64_tr_b16 a[64:65], v12 offset:20480
    v_mfma_f32_16x16x32_bf16 v[132:135], a[68:71], a[0:3], v[132:135]
    ds_read_b64_tr_b16 a[66:67], v12 offset:20736
    v_mfma_f32_16x16x32_bf16 v[148:151], a[68:71], a[4:7], v[148:151]
    buffer_load_dwordx4 v2, s[32:35], s69 offen offset:1024 lds
    v_mfma_f32_16x16x32_bf16 v[164:167], a[68:71], a[8:11], v[164:167]
    ds_read_b128 a[40:43], v9 offset:4096
    v_mfma_f32_16x16x32_bf16 v[180:183], a[68:71], a[12:15], v[180:183]
    v_mfma_f32_16x16x32_bf16 v[196:199], a[68:71], a[16:19], v[196:199]
    buffer_load_dwordx4 v2, s[32:35], s70 offen offset:2048 lds
    v_add_u32 v2, 196608, v2
    v_mfma_f32_16x16x32_bf16 v[212:215], a[68:71], a[20:23], v[212:215]
    v_mfma_f32_16x16x32_bf16 v[228:231], a[68:71], a[24:27], v[228:231]
    ds_read_b128 a[44:47], v9 offset:6144
    v_mfma_f32_16x16x32_bf16 v[244:247], a[68:71], a[28:31], v[244:247]
    ds_read_b64_tr_b16 a[68:69], v14 offset:20480
    v_mfma_f32_16x16x32_bf16 v[136:139], a[72:75], a[0:3], v[136:139]
    ds_read_b64_tr_b16 a[70:71], v14 offset:20736
    v_mfma_f32_16x16x32_bf16 v[152:155], a[72:75], a[4:7], v[152:155]
    v_mfma_f32_16x16x32_bf16 v[168:171], a[72:75], a[8:11], v[168:171]
    ds_read_b128 a[48:51], v9 offset:8192
    v_mfma_f32_16x16x32_bf16 v[184:187], a[72:75], a[12:15], v[184:187]
    buffer_load_dwordx4 v3, s[36:39], s71 offen offset:3072 lds
    v_mfma_f32_16x16x32_bf16 v[200:203], a[72:75], a[16:19], v[200:203]
    v_mfma_f32_16x16x32_bf16 v[216:219], a[72:75], a[20:23], v[216:219]
    v_mfma_f32_16x16x32_bf16 v[232:235], a[72:75], a[24:27], v[232:235]
    ds_read_b128 a[52:55], v9 offset:10240
    v_mfma_f32_16x16x32_bf16 v[248:251], a[72:75], a[28:31], v[248:251]
    ds_read_b64_tr_b16 a[72:73], v12 offset:21504
    v_mfma_f32_16x16x32_bf16 v[140:143], a[76:79], a[0:3], v[140:143]
    ds_read_b64_tr_b16 a[74:75], v12 offset:21760
    s_add_u32 m0, s78, 4096
    v_mfma_f32_16x16x32_bf16 v[156:159], a[76:79], a[4:7], v[156:159]
    buffer_load_dwordx4 v3, s[40:43], s72 offen offset:0 lds
    v_mfma_f32_16x16x32_bf16 v[172:175], a[76:79], a[8:11], v[172:175]
    ds_read_b128 a[56:59], v9 offset:12288
    v_mfma_f32_16x16x32_bf16 v[188:191], a[76:79], a[12:15], v[188:191]
    v_mfma_f32_16x16x32_bf16 v[204:207], a[76:79], a[16:19], v[204:207]
    v_mfma_f32_16x16x32_bf16 v[220:223], a[76:79], a[20:23], v[220:223]
    v_mfma_f32_16x16x32_bf16 v[236:239], a[76:79], a[24:27], v[236:239]
    ds_read_b128 a[60:63], v9 offset:14336
    v_mfma_f32_16x16x32_bf16 v[252:255], a[76:79], a[28:31], v[252:255]
    ds_read_b64_tr_b16 a[76:77], v14 offset:21504
    v_mfma_f32_16x16x32_bf16 a[128:131], a[80:83], a[0:3], a[128:131]
    ds_read_b64_tr_b16 a[78:79], v14 offset:21760
    v_mfma_f32_16x16x32_bf16 a[144:147], a[80:83], a[4:7], a[144:147]
    buffer_load_dwordx4 v3, s[36:39], s73 offen offset:1024 lds
    v_mfma_f32_16x16x32_bf16 a[160:163], a[80:83], a[8:11], a[160:163]
    ds_read_b128 a[116:119], v11 offset:0
    v_mfma_f32_16x16x32_bf16 a[176:179], a[80:83], a[12:15], a[176:179]
    v_mfma_f32_16x16x32_bf16 a[192:195], a[80:83], a[16:19], a[192:195]
    v_mfma_f32_16x16x32_bf16 a[208:211], a[80:83], a[20:23], a[208:211]
    buffer_load_dwordx4 v3, s[40:43], s74 offen offset:2048 lds
    v_mfma_f32_16x16x32_bf16 a[224:227], a[80:83], a[24:27], a[224:227]
    ds_read_b64_tr_b16 a[104:105], v12 offset:24576
    v_mfma_f32_16x16x32_bf16 a[240:243], a[80:83], a[28:31], a[240:243]
    ds_read_b64_tr_b16 a[80:81], v12 offset:22528
    v_mfma_f32_16x16x32_bf16 a[132:135], a[84:87], a[0:3], a[132:135]
    ds_read_b64_tr_b16 a[82:83], v12 offset:22784
    v_mfma_f32_16x16x32_bf16 a[148:151], a[84:87], a[4:7], a[148:151]
    v_mfma_f32_16x16x32_bf16 a[164:167], a[84:87], a[8:11], a[164:167]
    ds_read_b64_tr_b16 a[106:107], v12 offset:24832
    v_mfma_f32_16x16x32_bf16 a[180:183], a[84:87], a[12:15], a[180:183]
    buffer_load_dwordx4 v3, s[36:39], s75 offen offset:3072 lds
    v_mfma_f32_16x16x32_bf16 a[196:199], a[84:87], a[16:19], a[196:199]
    v_mfma_f32_16x16x32_bf16 a[212:215], a[84:87], a[20:23], a[212:215]
    v_mfma_f32_16x16x32_bf16 a[228:231], a[84:87], a[24:27], a[228:231]
    ds_read_b64_tr_b16 a[108:109], v14 offset:24576
    v_mfma_f32_16x16x32_bf16 a[244:247], a[84:87], a[28:31], a[244:247]
    ds_read_b64_tr_b16 a[84:85], v14 offset:22528
    v_mfma_f32_16x16x32_bf16 a[136:139], a[88:91], a[0:3], a[136:139]
    ds_read_b64_tr_b16 a[86:87], v14 offset:22784
    s_add_u32 m0, s78, 8192
    v_mfma_f32_16x16x32_bf16 a[152:155], a[88:91], a[4:7], a[152:155]
    buffer_load_dwordx4 v3, s[40:43], s76 offen offset:0 lds
    v_add_u32 v3, 229376, v3
    v_mfma_f32_16x16x32_bf16 a[168:171], a[88:91], a[8:11], a[168:171]
    ds_read_b64_tr_b16 a[110:111], v14 offset:24832
    v_mfma_f32_16x16x32_bf16 a[184:187], a[88:91], a[12:15], a[184:187]
    v_mfma_f32_16x16x32_bf16 a[200:203], a[88:91], a[16:19], a[200:203]
    v_mfma_f32_16x16x32_bf16 a[216:219], a[88:91], a[20:23], a[216:219]
    v_mfma_f32_16x16x32_bf16 a[232:235], a[88:91], a[24:27], a[232:235]
    ds_read_b64_tr_b16 a[124:125], v44 offset:20480
    v_mfma_f32_16x16x32_bf16 a[248:251], a[88:91], a[28:31], a[248:251]
    ds_read_b64_tr_b16 a[88:89], v12 offset:23552
    v_mfma_f32_16x16x32_bf16 a[140:143], a[92:95], a[0:3], a[140:143]
    ds_read_b64_tr_b16 a[90:91], v12 offset:23808
    v_mfma_f32_16x16x32_bf16 a[156:159], a[92:95], a[4:7], a[156:159]
    global_load_lds_dwordx4 v[4:5], off offset:1024
    v_lshl_add_u64 v[4:5], v[4:5], 0, s[80:81]
    v_mfma_f32_16x16x32_bf16 a[172:175], a[92:95], a[8:11], a[172:175]
    ds_read_b64_tr_b16 a[126:127], v44 offset:20736
    v_mfma_f32_16x16x32_bf16 a[188:191], a[92:95], a[12:15], a[188:191]
    v_mfma_f32_16x16x32_bf16 a[204:207], a[92:95], a[16:19], a[204:207]
    v_mfma_f32_16x16x32_bf16 a[220:223], a[92:95], a[20:23], a[220:223]
    v_mfma_f32_16x16x32_bf16 a[236:239], a[92:95], a[24:27], a[236:239]
    v_mfma_f32_16x16x32_bf16 a[252:255], a[92:95], a[28:31], a[252:255]
    ds_read_b64_tr_b16 a[92:93], v14 offset:23552
    v_mfma_f32_16x16x32_bf16 v[48:51], a[96:99], a[0:3], v[48:51]
    ds_read_b64_tr_b16 a[94:95], v14 offset:23808
    v_mfma_f32_16x16x32_bf16 v[52:55], a[96:99], a[4:7], v[52:55]
    v_mfma_f32_16x16x32_bf16 v[64:67], a[96:99], a[8:11], v[64:67]
    v_mfma_f32_16x16x32_bf16 v[68:71], a[96:99], a[12:15], v[68:71]
    v_mfma_f32_16x16x32_bf16 v[80:83], a[96:99], a[16:19], v[80:83]
    v_mfma_f32_16x16x32_bf16 v[84:87], a[96:99], a[20:23], v[84:87]
    v_mfma_f32_16x16x32_bf16 v[96:99], a[96:99], a[24:27], v[96:99]
    v_mfma_f32_16x16x32_bf16 v[100:103], a[96:99], a[28:31], v[100:103]
    v_mfma_f32_16x16x32_bf16 v[56:59], a[100:103], a[0:3], v[56:59]
    v_mfma_f32_16x16x32_bf16 v[60:63], a[100:103], a[4:7], v[60:63]
    v_mfma_f32_16x16x32_bf16 v[72:75], a[100:103], a[8:11], v[72:75]
    v_mfma_f32_16x16x32_bf16 v[76:79], a[100:103], a[12:15], v[76:79]
    v_mfma_f32_16x16x32_bf16 v[88:91], a[100:103], a[16:19], v[88:91]
    v_mfma_f32_16x16x32_bf16 v[92:95], a[100:103], a[20:23], v[92:95]
    v_mfma_f32_16x16x32_bf16 v[104:107], a[100:103], a[24:27], v[104:107]
    v_mfma_f32_16x16x32_bf16 v[108:111], a[100:103], a[28:31], v[108:111]
    s_waitcnt vmcnt(22) lgkmcnt(0)
    s_barrier
    v_mfma_f32_16x16x32_bf16 v[120:123], a[116:119], a[124:127], v[120:123]
    s_mov_b32 m0, s14
    s_mov_b32 s77, 4096
    v_mfma_f32_16x16x32_bf16 v[128:131], a[64:67], a[32:35], v[128:131]
    buffer_load_dwordx4 v1, s[28:31], s77 offen sc1 lds
    v_mfma_f32_16x16x32_bf16 v[144:147], a[64:67], a[36:39], v[144:147]
    v_mfma_f32_16x16x32_bf16 v[160:163], a[64:67], a[40:43], v[160:163]
    ds_read_b128 a[0:3], v8 offset:34816
    v_mfma_f32_16x16x32_bf16 v[176:179], a[64:67], a[44:47], v[176:179]
    v_mfma_f32_16x16x32_bf16 v[192:195], a[64:67], a[48:51], v[192:195]
    s_mov_b32 s77, 19456
    v_mfma_f32_16x16x32_bf16 v[208:211], a[64:67], a[52:55], v[208:211]
    buffer_load_dwordx4 v1, s[28:31], s77 offen offset:1024 sc1 lds
    v_add_u32 v1, 128, v1
    v_mfma_f32_16x16x32_bf16 v[224:227], a[64:67], a[56:59], v[224:227]
    ds_read_b128 a[4:7], v8 offset:36864
    v_mfma_f32_16x16x32_bf16 v[240:243], a[64:67], a[60:63], v[240:243]
    ds_read_b64_tr_b16 a[64:65], v13 offset:0
    v_mfma_f32_16x16x32_bf16 v[132:135], a[68:71], a[32:35], v[132:135]
    ds_read_b64_tr_b16 a[66:67], v13 offset:256
    v_mfma_f32_16x16x32_bf16 v[148:151], a[68:71], a[36:39], v[148:151]
    v_mfma_f32_16x16x32_bf16 v[164:167], a[68:71], a[40:43], v[164:167]
    ds_read_b128 a[8:11], v8 offset:38912
    s_add_u32 m0, s78, 20480
    v_mfma_f32_16x16x32_bf16 v[180:183], a[68:71], a[44:47], v[180:183]
    buffer_load_dwordx4 v2, s[32:35], s68 offen offset:0 lds
    v_mfma_f32_16x16x32_bf16 v[196:199], a[68:71], a[48:51], v[196:199]
    v_mfma_f32_16x16x32_bf16 v[212:215], a[68:71], a[52:55], v[212:215]
    v_mfma_f32_16x16x32_bf16 v[228:231], a[68:71], a[56:59], v[228:231]
    ds_read_b128 a[12:15], v8 offset:40960
    v_mfma_f32_16x16x32_bf16 v[244:247], a[68:71], a[60:63], v[244:247]
    ds_read_b64_tr_b16 a[68:69], v15 offset:0
    v_mfma_f32_16x16x32_bf16 v[136:139], a[72:75], a[32:35], v[136:139]
    ds_read_b64_tr_b16 a[70:71], v15 offset:256
    v_mfma_f32_16x16x32_bf16 v[152:155], a[72:75], a[36:39], v[152:155]
    buffer_load_dwordx4 v2, s[32:35], s69 offen offset:1024 lds
    v_mfma_f32_16x16x32_bf16 v[168:171], a[72:75], a[40:43], v[168:171]
    ds_read_b128 a[16:19], v8 offset:43008
    v_mfma_f32_16x16x32_bf16 v[184:187], a[72:75], a[44:47], v[184:187]
    v_mfma_f32_16x16x32_bf16 v[200:203], a[72:75], a[48:51], v[200:203]
    buffer_load_dwordx4 v2, s[32:35], s70 offen offset:2048 lds
    v_add_u32 v2, 196608, v2
    v_mfma_f32_16x16x32_bf16 v[216:219], a[72:75], a[52:55], v[216:219]
    v_mfma_f32_16x16x32_bf16 v[232:235], a[72:75], a[56:59], v[232:235]
    ds_read_b128 a[20:23], v8 offset:45056
    v_mfma_f32_16x16x32_bf16 v[248:251], a[72:75], a[60:63], v[248:251]
    ds_read_b64_tr_b16 a[72:73], v13 offset:1024
    v_mfma_f32_16x16x32_bf16 v[140:143], a[76:79], a[32:35], v[140:143]
    ds_read_b64_tr_b16 a[74:75], v13 offset:1280
    v_mfma_f32_16x16x32_bf16 v[156:159], a[76:79], a[36:39], v[156:159]
    buffer_load_dwordx4 v3, s[36:39], s71 offen offset:3072 lds
    v_mfma_f32_16x16x32_bf16 v[172:175], a[76:79], a[40:43], v[172:175]
    ds_read_b128 a[24:27], v8 offset:47104
    v_mfma_f32_16x16x32_bf16 v[188:191], a[76:79], a[44:47], v[188:191]
    v_mfma_f32_16x16x32_bf16 v[204:207], a[76:79], a[48:51], v[204:207]
    v_mfma_f32_16x16x32_bf16 v[220:223], a[76:79], a[52:55], v[220:223]
    v_mfma_f32_16x16x32_bf16 v[236:239], a[76:79], a[56:59], v[236:239]
    ds_read_b128 a[28:31], v8 offset:49152
    v_mfma_f32_16x16x32_bf16 v[252:255], a[76:79], a[60:63], v[252:255]
    ds_read_b64_tr_b16 a[76:77], v15 offset:1024
    v_mfma_f32_16x16x32_bf16 a[128:131], a[80:83], a[32:35], a[128:131]
    ds_read_b64_tr_b16 a[78:79], v15 offset:1280
    s_add_u32 m0, s78, 24576
    v_mfma_f32_16x16x32_bf16 a[144:147], a[80:83], a[36:39], a[144:147]
    buffer_load_dwordx4 v3, s[40:43], s72 offen offset:0 lds
    v_mfma_f32_16x16x32_bf16 a[160:163], a[80:83], a[40:43], a[160:163]
    ds_read_b128 a[112:115], v10 offset:34816
    v_mfma_f32_16x16x32_bf16 a[176:179], a[80:83], a[44:47], a[176:179]
    v_mfma_f32_16x16x32_bf16 a[192:195], a[80:83], a[48:51], a[192:195]
    buffer_load_dwordx4 v3, s[36:39], s73 offen offset:1024 lds
    v_mfma_f32_16x16x32_bf16 a[208:211], a[80:83], a[52:55], a[208:211]
    v_mfma_f32_16x16x32_bf16 a[224:227], a[80:83], a[56:59], a[224:227]
    ds_read_b64_tr_b16 a[96:97], v13 offset:4096
    v_mfma_f32_16x16x32_bf16 a[240:243], a[80:83], a[60:63], a[240:243]
    ds_read_b64_tr_b16 a[80:81], v13 offset:2048
    v_mfma_f32_16x16x32_bf16 a[132:135], a[84:87], a[32:35], a[132:135]
    ds_read_b64_tr_b16 a[82:83], v13 offset:2304
    v_mfma_f32_16x16x32_bf16 a[148:151], a[84:87], a[36:39], a[148:151]
    buffer_load_dwordx4 v3, s[40:43], s74 offen offset:2048 lds
    v_mfma_f32_16x16x32_bf16 a[164:167], a[84:87], a[40:43], a[164:167]
    ds_read_b64_tr_b16 a[98:99], v13 offset:4352
    v_mfma_f32_16x16x32_bf16 a[180:183], a[84:87], a[44:47], a[180:183]
    v_mfma_f32_16x16x32_bf16 a[196:199], a[84:87], a[48:51], a[196:199]
    v_mfma_f32_16x16x32_bf16 a[212:215], a[84:87], a[52:55], a[212:215]
    v_mfma_f32_16x16x32_bf16 a[228:231], a[84:87], a[56:59], a[228:231]
    ds_read_b64_tr_b16 a[100:101], v15 offset:4096
    v_mfma_f32_16x16x32_bf16 a[244:247], a[84:87], a[60:63], a[244:247]
    ds_read_b64_tr_b16 a[84:85], v15 offset:2048
    v_mfma_f32_16x16x32_bf16 a[136:139], a[88:91], a[32:35], a[136:139]
    ds_read_b64_tr_b16 a[86:87], v15 offset:2304
    v_mfma_f32_16x16x32_bf16 a[152:155], a[88:91], a[36:39], a[152:155]
    buffer_load_dwordx4 v3, s[36:39], s75 offen offset:3072 lds
    v_mfma_f32_16x16x32_bf16 a[168:171], a[88:91], a[40:43], a[168:171]
    ds_read_b64_tr_b16 a[102:103], v15 offset:4352
    s_add_u32 m0, s78, 28672
    v_mfma_f32_16x16x32_bf16 a[184:187], a[88:91], a[44:47], a[184:187]
    buffer_load_dwordx4 v3, s[40:43], s76 offen offset:0 lds
    v_add_u32 v3, 229376, v3
    v_mfma_f32_16x16x32_bf16 a[200:203], a[88:91], a[48:51], a[200:203]
    v_mfma_f32_16x16x32_bf16 a[216:219], a[88:91], a[52:55], a[216:219]
    v_mfma_f32_16x16x32_bf16 a[232:235], a[88:91], a[56:59], a[232:235]
    ds_read_b64_tr_b16 a[120:121], v45 offset:0
    v_mfma_f32_16x16x32_bf16 a[248:251], a[88:91], a[60:63], a[248:251]
    ds_read_b64_tr_b16 a[88:89], v13 offset:3072
    v_mfma_f32_16x16x32_bf16 a[140:143], a[92:95], a[32:35], a[140:143]
    ds_read_b64_tr_b16 a[90:91], v13 offset:3328
    v_mfma_f32_16x16x32_bf16 a[156:159], a[92:95], a[36:39], a[156:159]
    global_load_lds_dwordx4 v[4:5], off offset:1024
    v_lshl_add_u64 v[4:5], v[4:5], 0, s[80:81]
    v_mfma_f32_16x16x32_bf16 a[172:175], a[92:95], a[40:43], a[172:175]
    ds_read_b64_tr_b16 a[122:123], v45 offset:256
    v_mfma_f32_16x16x32_bf16 a[188:191], a[92:95], a[44:47], a[188:191]
    v_mfma_f32_16x16x32_bf16 a[204:207], a[92:95], a[48:51], a[204:207]
    v_mfma_f32_16x16x32_bf16 a[220:223], a[92:95], a[52:55], a[220:223]
    v_mfma_f32_16x16x32_bf16 a[236:239], a[92:95], a[56:59], a[236:239]
    v_mfma_f32_16x16x32_bf16 a[252:255], a[92:95], a[60:63], a[252:255]
    ds_read_b64_tr_b16 a[92:93], v15 offset:3072
    v_mfma_f32_16x16x32_bf16 v[48:51], a[104:107], a[32:35], v[48:51]
    ds_read_b64_tr_b16 a[94:95], v15 offset:3328
    v_mfma_f32_16x16x32_bf16 v[52:55], a[104:107], a[36:39], v[52:55]
    v_mfma_f32_16x16x32_bf16 v[64:67], a[104:107], a[40:43], v[64:67]
    v_mfma_f32_16x16x32_bf16 v[68:71], a[104:107], a[44:47], v[68:71]
    v_mfma_f32_16x16x32_bf16 v[80:83], a[104:107], a[48:51], v[80:83]
    v_mfma_f32_16x16x32_bf16 v[84:87], a[104:107], a[52:55], v[84:87]
    v_mfma_f32_16x16x32_bf16 v[96:99], a[104:107], a[56:59], v[96:99]
    v_mfma_f32_16x16x32_bf16 v[100:103], a[104:107], a[60:63], v[100:103]
    v_mfma_f32_16x16x32_bf16 v[56:59], a[108:111], a[32:35], v[56:59]
    v_mfma_f32_16x16x32_bf16 v[60:63], a[108:111], a[36:39], v[60:63]
    v_mfma_f32_16x16x32_bf16 v[72:75], a[108:111], a[40:43], v[72:75]
    v_mfma_f32_16x16x32_bf16 v[76:79], a[108:111], a[44:47], v[76:79]
    v_mfma_f32_16x16x32_bf16 v[88:91], a[108:111], a[48:51], v[88:91]
    v_mfma_f32_16x16x32_bf16 v[92:95], a[108:111], a[52:55], v[92:95]
    v_mfma_f32_16x16x32_bf16 v[104:107], a[108:111], a[56:59], v[104:107]
    v_mfma_f32_16x16x32_bf16 v[108:111], a[108:111], a[60:63], v[108:111]
    s_waitcnt vmcnt(24) lgkmcnt(0)
    s_barrier
    v_mfma_f32_16x16x32_bf16 v[120:123], a[112:115], a[120:123], v[120:123]
    s_add_u32 m0, s78, 40960
    buffer_load_dword v7, v6, s[44:47], s4 offen
    v_add_u32_e64 v6, s79, v6
    v_mfma_f32_16x16x32_bf16 v[128:131], a[64:67], a[0:3], v[128:131]
    buffer_load_dwordx4 v2, s[32:35], s68 offen offset:0 lds
    buffer_load_dword v7, v33, s[48:51], 0 offen
    v_add_u32_e64 v33, s52, v33
    v_mfma_f32_16x16x32_bf16 v[144:147], a[64:67], a[4:7], v[144:147]
    v_mfma_f32_16x16x32_bf16 v[160:163], a[64:67], a[8:11], v[160:163]
    ds_read_b128 a[32:35], v9 offset:34816
    v_mfma_f32_16x16x32_bf16 v[176:179], a[64:67], a[12:15], v[176:179]
    v_mfma_f32_16x16x32_bf16 v[192:195], a[64:67], a[16:19], v[192:195]
    v_mfma_f32_16x16x32_bf16 v[208:211], a[64:67], a[20:23], v[208:211]
    v_mfma_f32_16x16x32_bf16 v[224:227], a[64:67], a[24:27], v[224:227]
    ds_read_b128 a[36:39], v9 offset:36864
    v_mfma_f32_16x16x32_bf16 v[240:243], a[64:67], a[28:31], v[240:243]
    ds_read_b64_tr_b16 a[64:65], v13 offset:20480
    v_mfma_f32_16x16x32_bf16 v[132:135], a[68:71], a[0:3], v[132:135]
    ds_read_b64_tr_b16 a[66:67], v13 offset:20736
    v_mfma_f32_16x16x32_bf16 v[148:151], a[68:71], a[4:7], v[148:151]
    buffer_load_dwordx4 v2, s[32:35], s69 offen offset:1024 lds
    v_mfma_f32_16x16x32_bf16 v[164:167], a[68:71], a[8:11], v[164:167]
    ds_read_b128 a[40:43], v9 offset:38912
    v_mfma_f32_16x16x32_bf16 v[180:183], a[68:71], a[12:15], v[180:183]
    v_mfma_f32_16x16x32_bf16 v[196:199], a[68:71], a[16:19], v[196:199]
    buffer_load_dwordx4 v2, s[32:35], s70 offen offset:2048 lds
    v_add_u32 v2, 196608, v2
    v_mfma_f32_16x16x32_bf16 v[212:215], a[68:71], a[20:23], v[212:215]
    v_mfma_f32_16x16x32_bf16 v[228:231], a[68:71], a[24:27], v[228:231]
    ds_read_b128 a[44:47], v9 offset:40960
    v_mfma_f32_16x16x32_bf16 v[244:247], a[68:71], a[28:31], v[244:247]
    ds_read_b64_tr_b16 a[68:69], v15 offset:20480
    v_mfma_f32_16x16x32_bf16 v[136:139], a[72:75], a[0:3], v[136:139]
    ds_read_b64_tr_b16 a[70:71], v15 offset:20736
    v_mfma_f32_16x16x32_bf16 v[152:155], a[72:75], a[4:7], v[152:155]
    v_mfma_f32_16x16x32_bf16 v[168:171], a[72:75], a[8:11], v[168:171]
    ds_read_b128 a[48:51], v9 offset:43008
    v_mfma_f32_16x16x32_bf16 v[184:187], a[72:75], a[12:15], v[184:187]
    buffer_load_dwordx4 v3, s[36:39], s71 offen offset:3072 lds
    v_mfma_f32_16x16x32_bf16 v[200:203], a[72:75], a[16:19], v[200:203]
    v_mfma_f32_16x16x32_bf16 v[216:219], a[72:75], a[20:23], v[216:219]
    v_mfma_f32_16x16x32_bf16 v[232:235], a[72:75], a[24:27], v[232:235]
    ds_read_b128 a[52:55], v9 offset:45056
    v_mfma_f32_16x16x32_bf16 v[248:251], a[72:75], a[28:31], v[248:251]
    ds_read_b64_tr_b16 a[72:73], v13 offset:21504
    v_mfma_f32_16x16x32_bf16 v[140:143], a[76:79], a[0:3], v[140:143]
    ds_read_b64_tr_b16 a[74:75], v13 offset:21760
    s_add_u32 m0, s78, 45056
    v_mfma_f32_16x16x32_bf16 v[156:159], a[76:79], a[4:7], v[156:159]
    buffer_load_dwordx4 v3, s[40:43], s72 offen offset:0 lds
    v_mfma_f32_16x16x32_bf16 v[172:175], a[76:79], a[8:11], v[172:175]
    ds_read_b128 a[56:59], v9 offset:47104
    v_mfma_f32_16x16x32_bf16 v[188:191], a[76:79], a[12:15], v[188:191]
    v_mfma_f32_16x16x32_bf16 v[204:207], a[76:79], a[16:19], v[204:207]
    v_mfma_f32_16x16x32_bf16 v[220:223], a[76:79], a[20:23], v[220:223]
    v_mfma_f32_16x16x32_bf16 v[236:239], a[76:79], a[24:27], v[236:239]
    ds_read_b128 a[60:63], v9 offset:49152
    v_mfma_f32_16x16x32_bf16 v[252:255], a[76:79], a[28:31], v[252:255]
    ds_read_b64_tr_b16 a[76:77], v15 offset:21504
    v_mfma_f32_16x16x32_bf16 a[128:131], a[80:83], a[0:3], a[128:131]
    ds_read_b64_tr_b16 a[78:79], v15 offset:21760
    v_mfma_f32_16x16x32_bf16 a[144:147], a[80:83], a[4:7], a[144:147]
    buffer_load_dwordx4 v3, s[36:39], s73 offen offset:1024 lds
    v_mfma_f32_16x16x32_bf16 a[160:163], a[80:83], a[8:11], a[160:163]
    ds_read_b128 a[116:119], v11 offset:34816
    v_mfma_f32_16x16x32_bf16 a[176:179], a[80:83], a[12:15], a[176:179]
    v_mfma_f32_16x16x32_bf16 a[192:195], a[80:83], a[16:19], a[192:195]
    v_mfma_f32_16x16x32_bf16 a[208:211], a[80:83], a[20:23], a[208:211]
    buffer_load_dwordx4 v3, s[40:43], s74 offen offset:2048 lds
    v_mfma_f32_16x16x32_bf16 a[224:227], a[80:83], a[24:27], a[224:227]
    ds_read_b64_tr_b16 a[104:105], v13 offset:24576
    v_mfma_f32_16x16x32_bf16 a[240:243], a[80:83], a[28:31], a[240:243]
    ds_read_b64_tr_b16 a[80:81], v13 offset:22528
    v_mfma_f32_16x16x32_bf16 a[132:135], a[84:87], a[0:3], a[132:135]
    ds_read_b64_tr_b16 a[82:83], v13 offset:22784
    v_mfma_f32_16x16x32_bf16 a[148:151], a[84:87], a[4:7], a[148:151]
    v_mfma_f32_16x16x32_bf16 a[164:167], a[84:87], a[8:11], a[164:167]
    ds_read_b64_tr_b16 a[106:107], v13 offset:24832
    v_mfma_f32_16x16x32_bf16 a[180:183], a[84:87], a[12:15], a[180:183]
    buffer_load_dwordx4 v3, s[36:39], s75 offen offset:3072 lds
    v_mfma_f32_16x16x32_bf16 a[196:199], a[84:87], a[16:19], a[196:199]
    v_mfma_f32_16x16x32_bf16 a[212:215], a[84:87], a[20:23], a[212:215]
    v_mfma_f32_16x16x32_bf16 a[228:231], a[84:87], a[24:27], a[228:231]
    ds_read_b64_tr_b16 a[108:109], v15 offset:24576
    v_mfma_f32_16x16x32_bf16 a[244:247], a[84:87], a[28:31], a[244:247]
    ds_read_b64_tr_b16 a[84:85], v15 offset:22528
    v_mfma_f32_16x16x32_bf16 a[136:139], a[88:91], a[0:3], a[136:139]
    ds_read_b64_tr_b16 a[86:87], v15 offset:22784
    s_add_u32 m0, s78, 49152
    v_mfma_f32_16x16x32_bf16 a[152:155], a[88:91], a[4:7], a[152:155]
    buffer_load_dwordx4 v3, s[40:43], s76 offen offset:0 lds
    v_add_u32 v3, 229376, v3
    v_mfma_f32_16x16x32_bf16 a[168:171], a[88:91], a[8:11], a[168:171]
    ds_read_b64_tr_b16 a[110:111], v15 offset:24832
    v_mfma_f32_16x16x32_bf16 a[184:187], a[88:91], a[12:15], a[184:187]
    v_mfma_f32_16x16x32_bf16 a[200:203], a[88:91], a[16:19], a[200:203]
    v_mfma_f32_16x16x32_bf16 a[216:219], a[88:91], a[20:23], a[216:219]
    v_mfma_f32_16x16x32_bf16 a[232:235], a[88:91], a[24:27], a[232:235]
    ds_read_b64_tr_b16 a[124:125], v45 offset:20480
    v_mfma_f32_16x16x32_bf16 a[248:251], a[88:91], a[28:31], a[248:251]
    ds_read_b64_tr_b16 a[88:89], v13 offset:23552
    v_mfma_f32_16x16x32_bf16 a[140:143], a[92:95], a[0:3], a[140:143]
    ds_read_b64_tr_b16 a[90:91], v13 offset:23808
    v_mfma_f32_16x16x32_bf16 a[156:159], a[92:95], a[4:7], a[156:159]
    global_load_lds_dwordx4 v[4:5], off offset:1024
    v_lshl_add_u64 v[4:5], v[4:5], 0, s[80:81]
    v_mfma_f32_16x16x32_bf16 a[172:175], a[92:95], a[8:11], a[172:175]
    ds_read_b64_tr_b16 a[126:127], v45 offset:20736
    v_mfma_f32_16x16x32_bf16 a[188:191], a[92:95], a[12:15], a[188:191]
    v_mfma_f32_16x16x32_bf16 a[204:207], a[92:95], a[16:19], a[204:207]
    v_mfma_f32_16x16x32_bf16 a[220:223], a[92:95], a[20:23], a[220:223]
    v_mfma_f32_16x16x32_bf16 a[236:239], a[92:95], a[24:27], a[236:239]
    v_mfma_f32_16x16x32_bf16 a[252:255], a[92:95], a[28:31], a[252:255]
    ds_read_b64_tr_b16 a[92:93], v15 offset:23552
    v_mfma_f32_16x16x32_bf16 v[48:51], a[96:99], a[0:3], v[48:51]
    ds_read_b64_tr_b16 a[94:95], v15 offset:23808
    v_mfma_f32_16x16x32_bf16 v[52:55], a[96:99], a[4:7], v[52:55]
    v_mfma_f32_16x16x32_bf16 v[64:67], a[96:99], a[8:11], v[64:67]
    v_mfma_f32_16x16x32_bf16 v[68:71], a[96:99], a[12:15], v[68:71]
    v_mfma_f32_16x16x32_bf16 v[80:83], a[96:99], a[16:19], v[80:83]
    v_mfma_f32_16x16x32_bf16 v[84:87], a[96:99], a[20:23], v[84:87]
    v_mfma_f32_16x16x32_bf16 v[96:99], a[96:99], a[24:27], v[96:99]
    v_mfma_f32_16x16x32_bf16 v[100:103], a[96:99], a[28:31], v[100:103]
    v_mfma_f32_16x16x32_bf16 v[56:59], a[100:103], a[0:3], v[56:59]
    v_mfma_f32_16x16x32_bf16 v[60:63], a[100:103], a[4:7], v[60:63]
    v_mfma_f32_16x16x32_bf16 v[72:75], a[100:103], a[8:11], v[72:75]
    v_mfma_f32_16x16x32_bf16 v[76:79], a[100:103], a[12:15], v[76:79]
    v_mfma_f32_16x16x32_bf16 v[88:91], a[100:103], a[16:19], v[88:91]
    v_mfma_f32_16x16x32_bf16 v[92:95], a[100:103], a[20:23], v[92:95]
    v_mfma_f32_16x16x32_bf16 v[104:107], a[100:103], a[24:27], v[104:107]
    v_mfma_f32_16x16x32_bf16 v[108:111], a[100:103], a[28:31], v[108:111]
    s_waitcnt vmcnt(22) lgkmcnt(0)
    s_barrier
    v_mfma_f32_16x16x32_bf16 v[120:123], a[116:119], a[124:127], v[120:123]
    s_mov_b32 m0, s15
    s_mov_b32 s77, 4096
    v_mfma_f32_16x16x32_bf16 v[128:131], a[64:67], a[32:35], v[128:131]
    buffer_load_dwordx4 v1, s[28:31], s77 offen sc1 lds
    v_mfma_f32_16x16x32_bf16 v[144:147], a[64:67], a[36:39], v[144:147]
    v_mfma_f32_16x16x32_bf16 v[160:163], a[64:67], a[40:43], v[160:163]
    ds_read_b128 a[0:3], v8 offset:0
    v_mfma_f32_16x16x32_bf16 v[176:179], a[64:67], a[44:47], v[176:179]
    v_mfma_f32_16x16x32_bf16 v[192:195], a[64:67], a[48:51], v[192:195]
    s_mov_b32 s77, 19456
    v_mfma_f32_16x16x32_bf16 v[208:211], a[64:67], a[52:55], v[208:211]
    buffer_load_dwordx4 v1, s[28:31], s77 offen offset:1024 sc1 lds
    v_add_u32 v1, 128, v1
    v_mfma_f32_16x16x32_bf16 v[224:227], a[64:67], a[56:59], v[224:227]
    ds_read_b128 a[4:7], v8 offset:2048
    v_mfma_f32_16x16x32_bf16 v[240:243], a[64:67], a[60:63], v[240:243]
    ds_read_b64_tr_b16 a[64:65], v12 offset:0
    v_mfma_f32_16x16x32_bf16 v[132:135], a[68:71], a[32:35], v[132:135]
    ds_read_b64_tr_b16 a[66:67], v12 offset:256
    v_mfma_f32_16x16x32_bf16 v[148:151], a[68:71], a[36:39], v[148:151]
    v_mfma_f32_16x16x32_bf16 v[164:167], a[68:71], a[40:43], v[164:167]
    ds_read_b128 a[8:11], v8 offset:4096
    s_add_u32 m0, s78, 61440
    v_mfma_f32_16x16x32_bf16 v[180:183], a[68:71], a[44:47], v[180:183]
    buffer_load_dwordx4 v2, s[32:35], s68 offen offset:0 lds
    v_mfma_f32_16x16x32_bf16 v[196:199], a[68:71], a[48:51], v[196:199]
    v_mfma_f32_16x16x32_bf16 v[212:215], a[68:71], a[52:55], v[212:215]
    v_mfma_f32_16x16x32_bf16 v[228:231], a[68:71], a[56:59], v[228:231]
    ds_read_b128 a[12:15], v8 offset:6144
    v_mfma_f32_16x16x32_bf16 v[244:247], a[68:71], a[60:63], v[244:247]
    ds_read_b64_tr_b16 a[68:69], v14 offset:0
    v_mfma_f32_16x16x32_bf16 v[136:139], a[72:75], a[32:35], v[136:139]
    ds_read_b64_tr_b16 a[70:71], v14 offset:256
    v_mfma_f32_16x16x32_bf16 v[152:155], a[72:75], a[36:39], v[152:155]
    buffer_load_dwordx4 v2, s[32:35], s69 offen offset:1024 lds
    v_mfma_f32_16x16x32_bf16 v[168:171], a[72:75], a[40:43], v[168:171]
    ds_read_b128 a[16:19], v8 offset:8192
    v_mfma_f32_16x16x32_bf16 v[184:187], a[72:75], a[44:47], v[184:187]
    v_mfma_f32_16x16x32_bf16 v[200:203], a[72:75], a[48:51], v[200:203]
    buffer_load_dwordx4 v2, s[32:35], s70 offen offset:2048 lds
    v_add_u32 v2, 196608, v2
    v_mfma_f32_16x16x32_bf16 v[216:219], a[72:75], a[52:55], v[216:219]
    v_mfma_f32_16x16x32_bf16 v[232:235], a[72:75], a[56:59], v[232:235]
    ds_read_b128 a[20:23], v8 offset:10240
    v_mfma_f32_16x16x32_bf16 v[248:251], a[72:75], a[60:63], v[248:251]
    ds_read_b64_tr_b16 a[72:73], v12 offset:1024
    v_mfma_f32_16x16x32_bf16 v[140:143], a[76:79], a[32:35], v[140:143]
    ds_read_b64_tr_b16 a[74:75], v12 offset:1280
    v_mfma_f32_16x16x32_bf16 v[156:159], a[76:79], a[36:39], v[156:159]
    buffer_load_dwordx4 v3, s[36:39], s71 offen offset:3072 lds
    v_mfma_f32_16x16x32_bf16 v[172:175], a[76:79], a[40:43], v[172:175]
    ds_read_b128 a[24:27], v8 offset:12288
    v_mfma_f32_16x16x32_bf16 v[188:191], a[76:79], a[44:47], v[188:191]
    v_mfma_f32_16x16x32_bf16 v[204:207], a[76:79], a[48:51], v[204:207]
    v_mfma_f32_16x16x32_bf16 v[220:223], a[76:79], a[52:55], v[220:223]
    v_mfma_f32_16x16x32_bf16 v[236:239], a[76:79], a[56:59], v[236:239]
    ds_read_b128 a[28:31], v8 offset:14336
    v_mfma_f32_16x16x32_bf16 v[252:255], a[76:79], a[60:63], v[252:255]
    ds_read_b64_tr_b16 a[76:77], v14 offset:1024
    v_mfma_f32_16x16x32_bf16 a[128:131], a[80:83], a[32:35], a[128:131]
    ds_read_b64_tr_b16 a[78:79], v14 offset:1280
    s_add_u32 m0, s78, 65536
    v_mfma_f32_16x16x32_bf16 a[144:147], a[80:83], a[36:39], a[144:147]
    buffer_load_dwordx4 v3, s[40:43], s72 offen offset:0 lds
    v_mfma_f32_16x16x32_bf16 a[160:163], a[80:83], a[40:43], a[160:163]
    ds_read_b128 a[112:115], v10 offset:0
    v_mfma_f32_16x16x32_bf16 a[176:179], a[80:83], a[44:47], a[176:179]
    v_mfma_f32_16x16x32_bf16 a[192:195], a[80:83], a[48:51], a[192:195]
    buffer_load_dwordx4 v3, s[36:39], s73 offen offset:1024 lds
    v_mfma_f32_16x16x32_bf16 a[208:211], a[80:83], a[52:55], a[208:211]
    v_mfma_f32_16x16x32_bf16 a[224:227], a[80:83], a[56:59], a[224:227]
    ds_read_b64_tr_b16 a[96:97], v12 offset:4096
    v_mfma_f32_16x16x32_bf16 a[240:243], a[80:83], a[60:63], a[240:243]
    ds_read_b64_tr_b16 a[80:81], v12 offset:2048
    v_mfma_f32_16x16x32_bf16 a[132:135], a[84:87], a[32:35], a[132:135]
    ds_read_b64_tr_b16 a[82:83], v12 offset:2304
    v_mfma_f32_16x16x32_bf16 a[148:151], a[84:87], a[36:39], a[148:151]
    buffer_load_dwordx4 v3, s[40:43], s74 offen offset:2048 lds
    v_mfma_f32_16x16x32_bf16 a[164:167], a[84:87], a[40:43], a[164:167]
    ds_read_b64_tr_b16 a[98:99], v12 offset:4352
    v_mfma_f32_16x16x32_bf16 a[180:183], a[84:87], a[44:47], a[180:183]
    v_mfma_f32_16x16x32_bf16 a[196:199], a[84:87], a[48:51], a[196:199]
    v_mfma_f32_16x16x32_bf16 a[212:215], a[84:87], a[52:55], a[212:215]
    v_mfma_f32_16x16x32_bf16 a[228:231], a[84:87], a[56:59], a[228:231]
    ds_read_b64_tr_b16 a[100:101], v14 offset:4096
    v_mfma_f32_16x16x32_bf16 a[244:247], a[84:87], a[60:63], a[244:247]
    ds_read_b64_tr_b16 a[84:85], v14 offset:2048
    v_mfma_f32_16x16x32_bf16 a[136:139], a[88:91], a[32:35], a[136:139]
    ds_read_b64_tr_b16 a[86:87], v14 offset:2304
    v_mfma_f32_16x16x32_bf16 a[152:155], a[88:91], a[36:39], a[152:155]
    buffer_load_dwordx4 v3, s[36:39], s75 offen offset:3072 lds
    v_mfma_f32_16x16x32_bf16 a[168:171], a[88:91], a[40:43], a[168:171]
    ds_read_b64_tr_b16 a[102:103], v14 offset:4352
    s_add_u32 m0, s78, 69632
    v_mfma_f32_16x16x32_bf16 a[184:187], a[88:91], a[44:47], a[184:187]
    buffer_load_dwordx4 v3, s[40:43], s76 offen offset:0 lds
    v_add_u32 v3, 229376, v3
    v_mfma_f32_16x16x32_bf16 a[200:203], a[88:91], a[48:51], a[200:203]
    v_mfma_f32_16x16x32_bf16 a[216:219], a[88:91], a[52:55], a[216:219]
    v_mfma_f32_16x16x32_bf16 a[232:235], a[88:91], a[56:59], a[232:235]
    ds_read_b64_tr_b16 a[120:121], v44 offset:0
    v_mfma_f32_16x16x32_bf16 a[248:251], a[88:91], a[60:63], a[248:251]
    ds_read_b64_tr_b16 a[88:89], v12 offset:3072
    v_mfma_f32_16x16x32_bf16 a[140:143], a[92:95], a[32:35], a[140:143]
    ds_read_b64_tr_b16 a[90:91], v12 offset:3328
    v_mfma_f32_16x16x32_bf16 a[156:159], a[92:95], a[36:39], a[156:159]
    global_load_lds_dwordx4 v[4:5], off offset:1024
    v_lshl_add_u64 v[4:5], v[4:5], 0, s[80:81]
    v_mfma_f32_16x16x32_bf16 a[172:175], a[92:95], a[40:43], a[172:175]
    ds_read_b64_tr_b16 a[122:123], v44 offset:256
    v_mfma_f32_16x16x32_bf16 a[188:191], a[92:95], a[44:47], a[188:191]
    v_mfma_f32_16x16x32_bf16 a[204:207], a[92:95], a[48:51], a[204:207]
    v_mfma_f32_16x16x32_bf16 a[220:223], a[92:95], a[52:55], a[220:223]
    v_mfma_f32_16x16x32_bf16 a[236:239], a[92:95], a[56:59], a[236:239]
    v_mfma_f32_16x16x32_bf16 a[252:255], a[92:95], a[60:63], a[252:255]
    ds_read_b64_tr_b16 a[92:93], v14 offset:3072
    v_mfma_f32_16x16x32_bf16 v[48:51], a[104:107], a[32:35], v[48:51]
    ds_read_b64_tr_b16 a[94:95], v14 offset:3328
    v_mfma_f32_16x16x32_bf16 v[52:55], a[104:107], a[36:39], v[52:55]
    v_mfma_f32_16x16x32_bf16 v[64:67], a[104:107], a[40:43], v[64:67]
    v_mfma_f32_16x16x32_bf16 v[68:71], a[104:107], a[44:47], v[68:71]
    v_mfma_f32_16x16x32_bf16 v[80:83], a[104:107], a[48:51], v[80:83]
    v_mfma_f32_16x16x32_bf16 v[84:87], a[104:107], a[52:55], v[84:87]
    v_mfma_f32_16x16x32_bf16 v[96:99], a[104:107], a[56:59], v[96:99]
    v_mfma_f32_16x16x32_bf16 v[100:103], a[104:107], a[60:63], v[100:103]
    v_mfma_f32_16x16x32_bf16 v[56:59], a[108:111], a[32:35], v[56:59]
    v_mfma_f32_16x16x32_bf16 v[60:63], a[108:111], a[36:39], v[60:63]
    v_mfma_f32_16x16x32_bf16 v[72:75], a[108:111], a[40:43], v[72:75]
    v_mfma_f32_16x16x32_bf16 v[76:79], a[108:111], a[44:47], v[76:79]
    v_mfma_f32_16x16x32_bf16 v[88:91], a[108:111], a[48:51], v[88:91]
    v_mfma_f32_16x16x32_bf16 v[92:95], a[108:111], a[52:55], v[92:95]
    v_mfma_f32_16x16x32_bf16 v[104:107], a[108:111], a[56:59], v[104:107]
    v_mfma_f32_16x16x32_bf16 v[108:111], a[108:111], a[60:63], v[108:111]
    s_sub_u32 s67, s67, 1
    s_cmp_lg_u32 s67, 0
    s_cbranch_scc1 L_loop1
L_tail1:
    s_waitcnt vmcnt(24) lgkmcnt(0)
    s_barrier
    v_mfma_f32_16x16x32_bf16 v[120:123], a[112:115], a[120:123], v[120:123]
    s_getpc_b64 s[86:87]
L_pc1:
    s_sub_u32 s86, s86, L_pc1-L_tail0
    s_subb_u32 s87, s87, 0
    s_lshr_b32 s82, s2, 3
    s_lshl_b32 s82, s82, 2
    s_add_u32 s82, s82, s60
    s_lshl_b32 s82, s82, 10
    v_add_u32 v34, s82, v16
    v_min_u32 v34, L_code_end-L_tail0-4, v34
    global_load_dword v7, v34, s[86:87]
    v_mfma_f32_16x16x32_bf16 v[128:131], a[64:67], a[0:3], v[128:131]
    v_mfma_f32_16x16x32_bf16 v[144:147], a[64:67], a[4:7], v[144:147]
    v_mfma_f32_16x16x32_bf16 v[160:163], a[64:67], a[8:11], v[160:163]
    ds_read_b128 a[32:35], v9 offset:0
    v_mfma_f32_16x16x32_bf16 v[176:179], a[64:67], a[12:15], v[176:179]
    s_mul_i32 s82, s65, 1835008
    s_lshl_b32 s83, s66, 8
    v_mfma_f32_16x16x32_bf16 v[192:195], a[64:67], a[16:19], v[192:195]
    s_add_u32 s82, s82, s83
    s_add_u32 s48, s20, s82
    v_mfma_f32_16x16x32_bf16 v[208:211], a[64:67], a[20:23], v[208:211]
    s_addc_u32 s49, s21, 0
    s_and_b32 s49, s49, 0xffff
    v_mfma_f32_16x16x32_bf16 v[224:227], a[64:67], a[24:27], v[224:227]
    ds_read_b128 a[36:39], v9 offset:2048
    s_sub_u32 s50, 7340032, s82
    s_mov_b32 s51, 0x20000
    v_mfma_f32_16x16x32_bf16 v[240:243], a[64:67], a[28:31], v[240:243]
    ds_read_b64_tr_b16 a[64:65], v12 offset:20480
    s_add_u32 s52, s12, s83
    s_addc_u32 s53, s13, 0
    v_mfma_f32_16x16x32_bf16 v[132:135], a[68:71], a[0:3], v[132:135]
    ds_read_b64_tr_b16 a[66:67], v12 offset:20736
    s_and_b32 s53, s53, 0xffff
    s_sub_u32 s54, 2097152, s83
    v_mfma_f32_16x16x32_bf16 v[148:151], a[68:71], a[4:7], v[148:151]
    s_mov_b32 s55, 0x20000
    s_lshl_b32 s3, s60, 11
    v_mfma_f32_16x16x32_bf16 v[164:167], a[68:71], a[8:11], v[164:167]
    ds_read_b128 a[40:43], v9 offset:4096
    v_lshrrev_b32 v34, 4, v0
    v_and_b32 v35, 15, v0
    v_mfma_f32_16x16x32_bf16 v[180:183], a[68:71], a[12:15], v[180:183]
    v_lshlrev_b32 v36, 1, v34
    v_add_u32 v36, 0, v36
    v_mfma_f32_16x16x32_bf16 v[196:199], a[68:71], a[16:19], v[196:199]
    v_xor_b32 v36, v36, v35
    v_lshlrev_b32 v36, 4, v36
    v_mfma_f32_16x16x32_bf16 v[212:215], a[68:71], a[20:23], v[212:215]
    v_lshl_add_u32 v36, v34, 11, v36
    s_lshl_b32 s82, s60, 14
    v_mfma_f32_16x16x32_bf16 v[228:231], a[68:71], a[24:27], v[228:231]
    ds_read_b128 a[44:47], v9 offset:6144
    s_add_u32 s82, s82, 0
    v_add_u32 v17, s82, v36
    v_mfma_f32_16x16x32_bf16 v[244:247], a[68:71], a[28:31], v[244:247]
    ds_read_b64_tr_b16 a[68:69], v14 offset:20480
    s_lshl_b32 s82, s62, 1
    s_add_u32 s82, s82, 0
    v_mfma_f32_16x16x32_bf16 v[136:139], a[72:75], a[0:3], v[136:139]
    ds_read_b64_tr_b16 a[70:71], v14 offset:20736
    s_lshl_b32 s82, s82, 3
    s_lshl_b32 s83, s61, 2
    v_mfma_f32_16x16x32_bf16 v[152:155], a[72:75], a[4:7], v[152:155]
    s_add_u32 s82, s82, s83
    s_mul_i32 s83, s62, 96
    v_mfma_f32_16x16x32_bf16 v[168:171], a[72:75], a[8:11], v[168:171]
    ds_read_b128 a[48:51], v9 offset:8192
    s_add_u32 s82, s82, s83
    s_lshl_b32 s82, s82, 11
    v_mfma_f32_16x16x32_bf16 v[184:187], a[72:75], a[12:15], v[184:187]
    s_sub_u32 s82, s82, 0
    v_add_u32 v19, s82, v36
    v_mfma_f32_16x16x32_bf16 v[200:203], a[72:75], a[16:19], v[200:203]
    v_lshlrev_b32 v36, 1, v34
    v_add_u32 v36, 8, v36
    v_mfma_f32_16x16x32_bf16 v[216:219], a[72:75], a[20:23], v[216:219]
    v_xor_b32 v36, v36, v35
    v_lshlrev_b32 v36, 4, v36
    v_mfma_f32_16x16x32_bf16 v[232:235], a[72:75], a[24:27], v[232:235]
    ds_read_b128 a[52:55], v9 offset:10240
    v_lshl_add_u32 v36, v34, 11, v36
    s_lshl_b32 s82, s60, 14
    v_mfma_f32_16x16x32_bf16 v[248:251], a[72:75], a[28:31], v[248:251]
    ds_read_b64_tr_b16 a[72:73], v12 offset:21504
    s_add_u32 s82, s82, 7168
    v_add_u32 v18, s82, v36
    v_mfma_f32_16x16x32_bf16 v[140:143], a[76:79], a[0:3], v[140:143]
    ds_read_b64_tr_b16 a[74:75], v12 offset:21760
    s_lshl_b32 s82, s62, 1
    s_add_u32 s82, s82, 1
    v_mfma_f32_16x16x32_bf16 v[156:159], a[76:79], a[4:7], v[156:159]
    s_lshl_b32 s82, s82, 3
    s_lshl_b32 s83, s61, 2
    v_mfma_f32_16x16x32_bf16 v[172:175], a[76:79], a[8:11], v[172:175]
    ds_read_b128 a[56:59], v9 offset:12288
    s_add_u32 s82, s82, s83
    s_mul_i32 s83, s62, 96
    v_mfma_f32_16x16x32_bf16 v[188:191], a[76:79], a[12:15], v[188:191]
    s_add_u32 s82, s82, s83
    s_lshl_b32 s82, s82, 11
    v_mfma_f32_16x16x32_bf16 v[204:207], a[76:79], a[16:19], v[204:207]
    s_sub_u32 s82, s82, 1024
    v_add_u32 v20, s82, v36
    v_mfma_f32_16x16x32_bf16 v[220:223], a[76:79], a[20:23], v[220:223]
    v_mfma_f32_16x16x32_bf16 v[236:239], a[76:79], a[24:27], v[236:239]
    ds_read_b128 a[60:63], v9 offset:14336
    v_mfma_f32_16x16x32_bf16 v[252:255], a[76:79], a[28:31], v[252:255]
    ds_read_b64_tr_b16 a[76:77], v14 offset:21504
    v_mfma_f32_16x16x32_bf16 a[128:131], a[80:83], a[0:3], a[128:131]
    ds_read_b64_tr_b16 a[78:79], v14 offset:21760
    v_mfma_f32_16x16x32_bf16 a[144:147], a[80:83], a[4:7], a[144:147]
    v_mfma_f32_16x16x32_bf16 a[160:163], a[80:83], a[8:11], a[160:163]
    ds_read_b128 a[116:119], v11 offset:0
    v_mfma_f32_16x16x32_bf16 a[176:179], a[80:83], a[12:15], a[176:179]
    v_mfma_f32_16x16x32_bf16 a[192:195], a[80:83], a[16:19], a[192:195]
    v_mfma_f32_16x16x32_bf16 a[208:211], a[80:83], a[20:23], a[208:211]
    v_mfma_f32_16x16x32_bf16 a[224:227], a[80:83], a[24:27], a[224:227]
    ds_read_b64_tr_b16 a[104:105], v12 offset:24576
    v_mfma_f32_16x16x32_bf16 a[240:243], a[80:83], a[28:31], a[240:243]
    ds_read_b64_tr_b16 a[80:81], v12 offset:22528
    v_mfma_f32_16x16x32_bf16 a[132:135], a[84:87], a[0:3], a[132:135]
    ds_read_b64_tr_b16 a[82:83], v12 offset:22784
    v_mfma_f32_16x16x32_bf16 a[148:151], a[84:87], a[4:7], a[148:151]
    v_mfma_f32_16x16x32_bf16 a[164:167], a[84:87], a[8:11], a[164:167]
    ds_read_b64_tr_b16 a[106:107], v12 offset:24832
    v_mfma_f32_16x16x32_bf16 a[180:183], a[84:87], a[12:15], a[180:183]
    s_mov_b32 s81, 294912
    s_add_u32 m0, s3, 73728
    v_mfma_f32_16x16x32_bf16 a[196:199], a[84:87], a[16:19], a[196:199]
    buffer_load_dwordx4 v17, s[48:51], s81 offen lds
    v_mfma_f32_16x16x32_bf16 a[212:215], a[84:87], a[20:23], a[212:215]
    v_mfma_f32_16x16x32_bf16 a[228:231], a[84:87], a[24:27], a[228:231]
    ds_read_b64_tr_b16 a[108:109], v14 offset:24576
    v_mfma_f32_16x16x32_bf16 a[244:247], a[84:87], a[28:31], a[244:247]
    ds_read_b64_tr_b16 a[84:85], v14 offset:22528
    v_mfma_f32_16x16x32_bf16 a[136:139], a[88:91], a[0:3], a[136:139]
    ds_read_b64_tr_b16 a[86:87], v14 offset:22784
    v_mfma_f32_16x16x32_bf16 a[152:155], a[88:91], a[4:7], a[152:155]
    buffer_load_dwordx4 v18, s[48:51], s81 offen offset:1024 lds
    v_mfma_f32_16x16x32_bf16 a[168:171], a[88:91], a[8:11], a[168:171]
    ds_read_b64_tr_b16 a[110:111], v14 offset:24832
    v_mfma_f32_16x16x32_bf16 a[184:187], a[88:91], a[12:15], a[184:187]
    v_mfma_f32_16x16x32_bf16 a[200:203], a[88:91], a[16:19], a[200:203]
    v_mfma_f32_16x16x32_bf16 a[216:219], a[88:91], a[20:23], a[216:219]
    s_mov_b32 s80, 524288
    s_add_u32 m0, s3, 81920
    v_mfma_f32_16x16x32_bf16 a[232:235], a[88:91], a[24:27], a[232:235]
    ds_read_b64_tr_b16 a[124:125], v44 offset:20480
    buffer_load_dwordx4 v17, s[48:51], s80 offen lds
    v_mfma_f32_16x16x32_bf16 a[248:251], a[88:91], a[28:31], a[248:251]
    ds_read_b64_tr_b16 a[88:89], v12 offset:23552
    v_mfma_f32_16x16x32_bf16 a[140:143], a[92:95], a[0:3], a[140:143]
    ds_read_b64_tr_b16 a[90:91], v12 offset:23808
    v_mfma_f32_16x16x32_bf16 a[156:159], a[92:95], a[4:7], a[156:159]
    v_mfma_f32_16x16x32_bf16 a[172:175], a[92:95], a[8:11], a[172:175]
    ds_read_b64_tr_b16 a[126:127], v44 offset:20736
    v_mfma_f32_16x16x32_bf16 a[188:191], a[92:95], a[12:15], a[188:191]
    buffer_load_dwordx4 v18, s[48:51], s80 offen offset:1024 lds
    v_mfma_f32_16x16x32_bf16 a[204:207], a[92:95], a[16:19], a[204:207]
    v_mfma_f32_16x16x32_bf16 a[220:223], a[92:95], a[20:23], a[220:223]
    v_mfma_f32_16x16x32_bf16 a[236:239], a[92:95], a[24:27], a[236:239]
    v_mfma_f32_16x16x32_bf16 a[252:255], a[92:95], a[28:31], a[252:255]
    ds_read_b64_tr_b16 a[92:93], v14 offset:23552
    s_mov_b32 s81, 819200
    s_add_u32 m0, s3, 155648
    v_mfma_f32_16x16x32_bf16 v[48:51], a[96:99], a[0:3], v[48:51]
    ds_read_b64_tr_b16 a[94:95], v14 offset:23808
    buffer_load_dwordx4 v17, s[48:51], s81 offen lds
    v_mfma_f32_16x16x32_bf16 v[52:55], a[96:99], a[4:7], v[52:55]
    v_mfma_f32_16x16x32_bf16 v[64:67], a[96:99], a[8:11], v[64:67]
    v_mfma_f32_16x16x32_bf16 v[68:71], a[96:99], a[12:15], v[68:71]
    v_mfma_f32_16x16x32_bf16 v[80:83], a[96:99], a[16:19], v[80:83]
    v_mfma_f32_16x16x32_bf16 v[84:87], a[96:99], a[20:23], v[84:87]
    buffer_load_dwordx4 v18, s[48:51], s81 offen offset:1024 lds
    v_mfma_f32_16x16x32_bf16 v[96:99], a[96:99], a[24:27], v[96:99]
    v_mfma_f32_16x16x32_bf16 v[100:103], a[96:99], a[28:31], v[100:103]
    v_mfma_f32_16x16x32_bf16 v[56:59], a[100:103], a[0:3], v[56:59]
    v_mfma_f32_16x16x32_bf16 v[60:63], a[100:103], a[4:7], v[60:63]
    v_mfma_f32_16x16x32_bf16 v[72:75], a[100:103], a[8:11], v[72:75]
    v_mfma_f32_16x16x32_bf16 v[76:79], a[100:103], a[12:15], v[76:79]
    v_mfma_f32_16x16x32_bf16 v[88:91], a[100:103], a[16:19], v[88:91]
    v_mfma_f32_16x16x32_bf16 v[92:95], a[100:103], a[20:23], v[92:95]
    v_mfma_f32_16x16x32_bf16 v[104:107], a[100:103], a[24:27], v[104:107]
    v_mfma_f32_16x16x32_bf16 v[108:111], a[100:103], a[28:31], v[108:111]
    s_waitcnt vmcnt(17) lgkmcnt(0)
    s_barrier
    v_mfma_f32_16x16x32_bf16 v[120:123], a[116:119], a[124:127], v[120:123]
    v_mfma_f32_16x16x32_bf16 v[128:131], a[64:67], a[32:35], v[128:131]
    v_mfma_f32_16x16x32_bf16 v[144:147], a[64:67], a[36:39], v[144:147]
    s_mov_b32 s80, 0
    s_add_u32 m0, s3, 0
    v_mfma_f32_16x16x32_bf16 v[160:163], a[64:67], a[40:43], v[160:163]
    ds_read_b128 a[0:3], v8 offset:34816
    buffer_load_dwordx4 v17, s[48:51], s80 offen lds
    v_mfma_f32_16x16x32_bf16 v[176:179], a[64:67], a[44:47], v[176:179]
    s_xor_b32 s82, s65, 0
    v_mfma_f32_16x16x32_bf16 v[192:195], a[64:67], a[48:51], v[192:195]
    s_lshl_b32 s82, s82, 10
    v_mfma_f32_16x16x32_bf16 v[208:211], a[64:67], a[52:55], v[208:211]
    v_add_u32 v21, s82, v16
    v_mfma_f32_16x16x32_bf16 v[224:227], a[64:67], a[56:59], v[224:227]
    ds_read_b128 a[4:7], v8 offset:36864
    s_xor_b32 s82, s65, 1
    v_mfma_f32_16x16x32_bf16 v[240:243], a[64:67], a[60:63], v[240:243]
    ds_read_b64_tr_b16 a[64:65], v13 offset:0
    s_lshl_b32 s82, s82, 10
    v_mfma_f32_16x16x32_bf16 v[132:135], a[68:71], a[32:35], v[132:135]
    ds_read_b64_tr_b16 a[66:67], v13 offset:256
    v_add_u32 v22, s82, v16
    buffer_load_dwordx4 v18, s[48:51], s80 offen offset:1024 lds
    v_mfma_f32_16x16x32_bf16 v[148:151], a[68:71], a[36:39], v[148:151]
    s_xor_b32 s82, s65, 2
    v_mfma_f32_16x16x32_bf16 v[164:167], a[68:71], a[40:43], v[164:167]
    ds_read_b128 a[8:11], v8 offset:38912
    s_lshl_b32 s82, s82, 10
    v_mfma_f32_16x16x32_bf16 v[180:183], a[68:71], a[44:47], v[180:183]
    v_add_u32 v23, s82, v16
    v_mfma_f32_16x16x32_bf16 v[196:199], a[68:71], a[48:51], v[196:199]
    s_xor_b32 s82, s65, 3
    v_mfma_f32_16x16x32_bf16 v[212:215], a[68:71], a[52:55], v[212:215]
    s_lshl_b32 s82, s82, 10
    s_mov_b32 s81, 229376
    s_add_u32 m0, s3, 8192
    v_mfma_f32_16x16x32_bf16 v[228:231], a[68:71], a[56:59], v[228:231]
    ds_read_b128 a[12:15], v8 offset:40960
    v_add_u32 v24, s82, v16
    buffer_load_dwordx4 v17, s[48:51], s81 offen lds
    v_mfma_f32_16x16x32_bf16 v[244:247], a[68:71], a[60:63], v[244:247]
    ds_read_b64_tr_b16 a[68:69], v15 offset:0
    s_mov_b32 s94, 0xbdd2d3e8
    s_branch L_over3
L_stub3:
    s_branch L_stub7
L_over3:
    v_mfma_f32_16x16x32_bf16 v[136:139], a[72:75], a[32:35], v[136:139]
    ds_read_b64_tr_b16 a[70:71], v15 offset:256
    s_mov_b32 s95, 0xbdd2d3e8
    v_mfma_f32_16x16x32_bf16 v[152:155], a[72:75], a[36:39], v[152:155]
    v_mov_b32 v26, 0xc0135761
    v_mfma_f32_16x16x32_bf16 v[168:171], a[72:75], a[40:43], v[168:171]
    ds_read_b128 a[16:19], v8 offset:43008
    v_mov_b32 v27, 0xc0135761
    v_mfma_f32_16x16x32_bf16 v[184:187], a[72:75], a[44:47], v[184:187]
    v_mov_b32 v25, 1
    v_mfma_f32_16x16x32_bf16 v[200:203], a[72:75], a[48:51], v[200:203]
    s_lshl_b32 s82, s60, 12
    buffer_load_dwordx4 v18, s[48:51], s81 offen offset:1024 lds
    v_mfma_f32_16x16x32_bf16 v[216:219], a[72:75], a[52:55], v[216:219]
    s_add_u32 s68, s88, s82
    v_mfma_f32_16x16x32_bf16 v[232:235], a[72:75], a[56:59], v[232:235]
    ds_read_b128 a[20:23], v8 offset:45056
    s_lshl_b32 s82, s61, 13
    v_mfma_f32_16x16x32_bf16 v[248:251], a[72:75], a[60:63], v[248:251]
    ds_read_b64_tr_b16 a[72:73], v13 offset:1024
    s_add_u32 s88, s88, s82
    v_mfma_f32_16x16x32_bf16 v[140:143], a[76:79], a[32:35], v[140:143]
    ds_read_b64_tr_b16 a[74:75], v13 offset:1280
    s_lshr_b32 s82, s66, 1
    v_mfma_f32_16x16x32_bf16 v[156:159], a[76:79], a[36:39], v[156:159]
    s_add_u32 s82, s82, 24
    s_mov_b32 s80, 458752
    s_add_u32 m0, s3, 16384
    v_mfma_f32_16x16x32_bf16 v[172:175], a[76:79], a[40:43], v[172:175]
    ds_read_b128 a[24:27], v8 offset:47104
    s_lshl_b32 s82, s82, 14
    buffer_load_dwordx4 v17, s[48:51], s80 offen lds
    v_mfma_f32_16x16x32_bf16 v[188:191], a[76:79], a[44:47], v[188:191]
    s_add_u32 s90, s88, s82
    v_mfma_f32_16x16x32_bf16 v[204:207], a[76:79], a[48:51], v[204:207]
    s_lshl_b32 s82, s66, 14
    v_mfma_f32_16x16x32_bf16 v[220:223], a[76:79], a[52:55], v[220:223]
    s_add_u32 s88, s88, s82
    v_mfma_f32_16x16x32_bf16 v[236:239], a[76:79], a[56:59], v[236:239]
    ds_read_b128 a[28:31], v8 offset:49152
    s_add_u32 s89, s88, 262144
    v_mfma_f32_16x16x32_bf16 v[252:255], a[76:79], a[60:63], v[252:255]
    ds_read_b64_tr_b16 a[76:77], v15 offset:1024
    s_add_u32 s88, s88, 131072
    v_mfma_f32_16x16x32_bf16 a[128:131], a[80:83], a[32:35], a[128:131]
    ds_read_b64_tr_b16 a[78:79], v15 offset:1280
    s_mov_b32 s76, s93
    buffer_load_dwordx4 v18, s[48:51], s80 offen offset:1024 lds
    v_mfma_f32_16x16x32_bf16 a[144:147], a[80:83], a[36:39], a[144:147]
    s_lshl_b32 s82, s63, 4
    v_mfma_f32_16x16x32_bf16 a[160:163], a[80:83], a[40:43], a[160:163]
    ds_read_b128 a[112:115], v10 offset:34816
    s_lshl_b32 s83, s61, 3
    v_mfma_f32_16x16x32_bf16 a[176:179], a[80:83], a[44:47], a[176:179]
    s_add_u32 s83, s83, s82
    v_mfma_f32_16x16x32_bf16 a[192:195], a[80:83], a[48:51], a[192:195]
    s_add_u32 s83, s83, s65
    v_mfma_f32_16x16x32_bf16 a[208:211], a[80:83], a[52:55], a[208:211]
    s_lshl_b32 s83, s83, 15
    s_mov_b32 s81, 688128
    s_add_u32 m0, s3, 24576
    v_mfma_f32_16x16x32_bf16 a[224:227], a[80:83], a[56:59], a[224:227]
    ds_read_b64_tr_b16 a[96:97], v13 offset:4096
    s_add_u32 s69, s83, 4194304
    buffer_load_dwordx4 v17, s[48:51], s81 offen lds
    v_mfma_f32_16x16x32_bf16 a[240:243], a[80:83], a[60:63], a[240:243]
    ds_read_b64_tr_b16 a[80:81], v13 offset:2048
    s_lshl_b32 s84, s63, 3
    v_mfma_f32_16x16x32_bf16 a[132:135], a[84:87], a[32:35], a[132:135]
    ds_read_b64_tr_b16 a[82:83], v13 offset:2304
    s_add_u32 s84, s84, s66
    v_mfma_f32_16x16x32_bf16 a[148:151], a[84:87], a[36:39], a[148:151]
    s_lshl_b32 s85, s84, 2
    v_mfma_f32_16x16x32_bf16 a[164:167], a[84:87], a[40:43], a[164:167]
    ds_read_b64_tr_b16 a[98:99], v13 offset:4352
    s_add_u32 s85, s85, s60
    v_mfma_f32_16x16x32_bf16 a[180:183], a[84:87], a[44:47], a[180:183]
    s_lshl_b32 s85, s85, 8
    v_mfma_f32_16x16x32_bf16 a[196:199], a[84:87], a[48:51], a[196:199]
    s_add_u32 s77, s85, 39862272
    buffer_load_dwordx4 v18, s[48:51], s81 offen offset:1024 lds
    v_mfma_f32_16x16x32_bf16 a[212:215], a[84:87], a[52:55], a[212:215]
    s_lshl_b32 s84, s84, 18
    v_mfma_f32_16x16x32_bf16 a[228:231], a[84:87], a[56:59], a[228:231]
    ds_read_b64_tr_b16 a[100:101], v15 offset:4096
    s_lshl_b32 s85, s60, 12
    v_mfma_f32_16x16x32_bf16 a[244:247], a[84:87], a[60:63], a[244:247]
    ds_read_b64_tr_b16 a[84:85], v15 offset:2048
    s_add_u32 s84, s84, s85
    v_mfma_f32_16x16x32_bf16 a[136:139], a[88:91], a[32:35], a[136:139]
    ds_read_b64_tr_b16 a[86:87], v15 offset:2304
    s_add_u32 s84, s84, 23068672
    v_mfma_f32_16x16x32_bf16 a[152:155], a[88:91], a[36:39], a[152:155]
    s_xor_b32 s85, s65, 1
    s_mov_b32 s81, 753664
    s_add_u32 m0, s3, 90112
    v_mfma_f32_16x16x32_bf16 a[168:171], a[88:91], a[40:43], a[168:171]
    ds_read_b64_tr_b16 a[102:103], v15 offset:4352
    s_lshl_b32 s85, s85, 16
    buffer_load_dwordx4 v17, s[48:51], s81 offen lds
    v_mfma_f32_16x16x32_bf16 a[184:187], a[88:91], a[44:47], a[184:187]
    s_add_u32 s70, s84, s85
    v_mfma_f32_16x16x32_bf16 a[200:203], a[88:91], a[48:51], a[200:203]
    v_mfma_f32_16x16x32_bf16 a[216:219], a[88:91], a[52:55], a[216:219]
    v_mfma_f32_16x16x32_bf16 a[232:235], a[88:91], a[56:59], a[232:235]
    ds_read_b64_tr_b16 a[120:121], v45 offset:0
    v_mfma_f32_16x16x32_bf16 a[248:251], a[88:91], a[60:63], a[248:251]
    ds_read_b64_tr_b16 a[88:89], v13 offset:3072
    v_mfma_f32_16x16x32_bf16 a[140:143], a[92:95], a[32:35], a[140:143]
    ds_read_b64_tr_b16 a[90:91], v13 offset:3328
    buffer_load_dwordx4 v18, s[48:51], s81 offen offset:1024 lds
    v_mfma_f32_16x16x32_bf16 a[156:159], a[92:95], a[36:39], a[156:159]
    v_mfma_f32_16x16x32_bf16 a[172:175], a[92:95], a[40:43], a[172:175]
    ds_read_b64_tr_b16 a[122:123], v45 offset:256
    v_mfma_f32_16x16x32_bf16 a[188:191], a[92:95], a[44:47], a[188:191]
    v_mfma_f32_16x16x32_bf16 a[204:207], a[92:95], a[48:51], a[204:207]
    v_mfma_f32_16x16x32_bf16 a[220:223], a[92:95], a[52:55], a[220:223]
    s_mov_b32 s80, 983040
    s_add_u32 m0, s3, 98304
    v_mfma_f32_16x16x32_bf16 a[236:239], a[92:95], a[56:59], a[236:239]
    buffer_load_dwordx4 v17, s[48:51], s80 offen lds
    v_mfma_f32_16x16x32_bf16 a[252:255], a[92:95], a[60:63], a[252:255]
    ds_read_b64_tr_b16 a[92:93], v15 offset:3072
    v_mfma_f32_16x16x32_bf16 v[48:51], a[104:107], a[32:35], v[48:51]
    ds_read_b64_tr_b16 a[94:95], v15 offset:3328
    v_mfma_f32_16x16x32_bf16 v[52:55], a[104:107], a[36:39], v[52:55]
    v_mfma_f32_16x16x32_bf16 v[64:67], a[104:107], a[40:43], v[64:67]
    v_mfma_f32_16x16x32_bf16 v[68:71], a[104:107], a[44:47], v[68:71]
    v_mfma_f32_16x16x32_bf16 v[80:83], a[104:107], a[48:51], v[80:83]
    buffer_load_dwordx4 v18, s[48:51], s80 offen offset:1024 lds
    v_mfma_f32_16x16x32_bf16 v[84:87], a[104:107], a[52:55], v[84:87]
    v_mfma_f32_16x16x32_bf16 v[96:99], a[104:107], a[56:59], v[96:99]
    v_mfma_f32_16x16x32_bf16 v[100:103], a[104:107], a[60:63], v[100:103]
    v_mfma_f32_16x16x32_bf16 v[56:59], a[108:111], a[32:35], v[56:59]
    v_mfma_f32_16x16x32_bf16 v[60:63], a[108:111], a[36:39], v[60:63]
    v_mfma_f32_16x16x32_bf16 v[72:75], a[108:111], a[40:43], v[72:75]
    v_mfma_f32_16x16x32_bf16 v[76:79], a[108:111], a[44:47], v[76:79]
    v_mfma_f32_16x16x32_bf16 v[88:91], a[108:111], a[48:51], v[88:91]
    v_mfma_f32_16x16x32_bf16 v[92:95], a[108:111], a[52:55], v[92:95]
    v_mfma_f32_16x16x32_bf16 v[104:107], a[108:111], a[56:59], v[104:107]
    v_mfma_f32_16x16x32_bf16 v[108:111], a[108:111], a[60:63], v[108:111]
    s_waitcnt vmcnt(19) lgkmcnt(0)
    s_barrier
    v_mfma_f32_16x16x32_bf16 v[120:123], a[112:115], a[120:123], v[120:123]
    v_mfma_f32_16x16x32_bf16 v[128:131], a[64:67], a[0:3], v[128:131]
    v_mfma_f32_16x16x32_bf16 v[144:147], a[64:67], a[4:7], v[144:147]
    s_mov_b32 s81, 1212416
    s_add_u32 m0, s3, 106496
    v_mfma_f32_16x16x32_bf16 v[160:163], a[64:67], a[8:11], v[160:163]
    ds_read_b128 a[32:35], v9 offset:34816
    buffer_load_dwordx4 v17, s[48:51], s81 offen lds
    v_mfma_f32_16x16x32_bf16 v[176:179], a[64:67], a[12:15], v[176:179]
    s_add_u32 s70, s70, 16384
    v_mfma_f32_16x16x32_bf16 v[192:195], a[64:67], a[16:19], v[192:195]
    s_lshl_b32 s85, s65, 16
    v_mfma_f32_16x16x32_bf16 v[208:211], a[64:67], a[20:23], v[208:211]
    s_add_u32 s73, s84, s85
    v_mfma_f32_16x16x32_bf16 v[224:227], a[64:67], a[24:27], v[224:227]
    ds_read_b128 a[36:39], v9 offset:36864
    s_add_u32 s73, s73, 16384
    v_mfma_f32_16x16x32_bf16 v[240:243], a[64:67], a[28:31], v[240:243]
    ds_read_b64_tr_b16 a[64:65], v13 offset:20480
    s_xor_b32 s85, s65, 2
    v_mfma_f32_16x16x32_bf16 v[132:135], a[68:71], a[0:3], v[132:135]
    ds_read_b64_tr_b16 a[66:67], v13 offset:20736
    s_lshl_b32 s85, s85, 16
    v_mfma_f32_16x16x32_bf16 v[148:151], a[68:71], a[4:7], v[148:151]
    s_add_u32 s71, s84, s85
    v_mfma_f32_16x16x32_bf16 v[164:167], a[68:71], a[8:11], v[164:167]
    ds_read_b128 a[40:43], v9 offset:38912
    s_add_u32 s71, s71, 32768
    v_mfma_f32_16x16x32_bf16 v[180:183], a[68:71], a[12:15], v[180:183]
    s_lshl_b32 s85, s65, 16
    v_mfma_f32_16x16x32_bf16 v[196:199], a[68:71], a[16:19], v[196:199]
    s_add_u32 s74, s84, s85
    v_mfma_f32_16x16x32_bf16 v[212:215], a[68:71], a[20:23], v[212:215]
    s_add_u32 s74, s74, 32768
    v_mfma_f32_16x16x32_bf16 v[228:231], a[68:71], a[24:27], v[228:231]
    ds_read_b128 a[44:47], v9 offset:40960
    s_xor_b32 s85, s65, 3
    buffer_load_dwordx4 v18, s[48:51], s81 offen offset:1024 lds
    v_mfma_f32_16x16x32_bf16 v[244:247], a[68:71], a[28:31], v[244:247]
    ds_read_b64_tr_b16 a[68:69], v15 offset:20480
    s_lshl_b32 s85, s85, 16
    v_mfma_f32_16x16x32_bf16 v[136:139], a[72:75], a[0:3], v[136:139]
    ds_read_b64_tr_b16 a[70:71], v15 offset:20736
    s_add_u32 s72, s84, s85
    v_mfma_f32_16x16x32_bf16 v[152:155], a[72:75], a[4:7], v[152:155]
    s_add_u32 s72, s72, 49152
    v_mfma_f32_16x16x32_bf16 v[168:171], a[72:75], a[8:11], v[168:171]
    ds_read_b128 a[48:51], v9 offset:43008
    s_lshl_b32 s85, s65, 16
    v_mfma_f32_16x16x32_bf16 v[184:187], a[72:75], a[12:15], v[184:187]
    s_add_u32 s75, s84, s85
    v_mfma_f32_16x16x32_bf16 v[200:203], a[72:75], a[16:19], v[200:203]
    s_add_u32 s75, s75, 49152
    v_mfma_f32_16x16x32_bf16 v[216:219], a[72:75], a[20:23], v[216:219]
    v_and_b32 v36, 1, v34
    v_mfma_f32_16x16x32_bf16 v[232:235], a[72:75], a[24:27], v[232:235]
    ds_read_b128 a[52:55], v9 offset:45056
    v_lshlrev_b32 v36, 10, v36
    v_mfma_f32_16x16x32_bf16 v[248:251], a[72:75], a[28:31], v[248:251]
    ds_read_b64_tr_b16 a[72:73], v13 offset:21504
    v_lshrrev_b32 v34, 1, v34
    v_mfma_f32_16x16x32_bf16 v[140:143], a[76:79], a[0:3], v[140:143]
    ds_read_b64_tr_b16 a[74:75], v13 offset:21760
    v_lshl_add_u32 v36, v34, 8, v36
    v_mfma_f32_16x16x32_bf16 v[156:159], a[76:79], a[4:7], v[156:159]
    v_lshl_add_u32 v36, v35, 4, v36
    s_mov_b32 s80, 1441792
    s_add_u32 m0, s3, 114688
    v_mfma_f32_16x16x32_bf16 v[172:175], a[76:79], a[8:11], v[172:175]
    ds_read_b128 a[56:59], v9 offset:47104
    s_and_b32 s82, s66, 1
    buffer_load_dwordx4 v17, s[48:51], s80 offen lds
    v_mfma_f32_16x16x32_bf16 v[188:191], a[76:79], a[12:15], v[188:191]
    s_lshl_b32 s82, s82, 9
    v_mfma_f32_16x16x32_bf16 v[204:207], a[76:79], a[16:19], v[204:207]
    v_add_u32 v28, s82, v36
    v_mfma_f32_16x16x32_bf16 v[220:223], a[76:79], a[20:23], v[220:223]
    v_mov_b32 v29, 0x100
    v_mfma_f32_16x16x32_bf16 v[236:239], a[76:79], a[24:27], v[236:239]
    ds_read_b128 a[60:63], v9 offset:49152
    v_mov_b32 v42, 0x10000
    v_mfma_f32_16x16x32_bf16 v[252:255], a[76:79], a[28:31], v[252:255]
    ds_read_b64_tr_b16 a[76:77], v15 offset:21504
    s_mov_b32 s93, s92
    v_mfma_f32_16x16x32_bf16 a[128:131], a[80:83], a[0:3], a[128:131]
    ds_read_b64_tr_b16 a[78:79], v15 offset:21760
    s_lshl_b32 s82, s63, 2
    v_mfma_f32_16x16x32_bf16 a[144:147], a[80:83], a[4:7], a[144:147]
    s_add_u32 s82, s82, s60
    v_mfma_f32_16x16x32_bf16 a[160:163], a[80:83], a[8:11], a[160:163]
    ds_read_b128 a[116:119], v11 offset:34816
    s_lshl_b32 s82, s82, 2
    v_mfma_f32_16x16x32_bf16 a[176:179], a[80:83], a[12:15], a[176:179]
    s_add_u32 s82, s82, s65
    v_mfma_f32_16x16x32_bf16 a[192:195], a[80:83], a[16:19], a[192:195]
    s_lshl_b32 s82, s82, 15
    v_mfma_f32_16x16x32_bf16 a[208:211], a[80:83], a[20:23], a[208:211]
    s_lshl_b32 s83, s66, 8
    v_mfma_f32_16x16x32_bf16 a[224:227], a[80:83], a[24:27], a[224:227]
    ds_read_b64_tr_b16 a[104:105], v13 offset:24576
    s_add_u32 s82, s82, s83
    buffer_load_dwordx4 v18, s[48:51], s80 offen offset:1024 lds
    v_mfma_f32_16x16x32_bf16 a[240:243], a[80:83], a[28:31], a[240:243]
    ds_read_b64_tr_b16 a[80:81], v13 offset:22528
    v_and_b32 v34, 15, v0
    v_mfma_f32_16x16x32_bf16 a[132:135], a[84:87], a[0:3], a[132:135]
    ds_read_b64_tr_b16 a[82:83], v13 offset:22784
    v_lshrrev_b32 v35, 4, v0
    v_mfma_f32_16x16x32_bf16 a[148:151], a[84:87], a[4:7], a[148:151]
    v_lshlrev_b32 v36, 11, v34
    v_mfma_f32_16x16x32_bf16 a[164:167], a[84:87], a[8:11], a[164:167]
    ds_read_b64_tr_b16 a[106:107], v13 offset:24832
    v_add_u32 v36, s82, v36
    v_mfma_f32_16x16x32_bf16 a[180:183], a[84:87], a[12:15], a[180:183]
    v_and_b32 v2, 1, v35
    v_mfma_f32_16x16x32_bf16 a[196:199], a[84:87], a[16:19], a[196:199]
    v_lshl_add_u32 v36, v2, 5, v36
    v_mfma_f32_16x16x32_bf16 a[212:215], a[84:87], a[20:23], a[212:215]
    v_lshrrev_b32 v2, 1, v35
    v_mfma_f32_16x16x32_bf16 a[228:231], a[84:87], a[24:27], a[228:231]
    ds_read_b64_tr_b16 a[108:109], v15 offset:24576
    v_lshl_add_u32 v2, v2, 4, v36
    v_mfma_f32_16x16x32_bf16 a[244:247], a[84:87], a[28:31], a[244:247]
    ds_read_b64_tr_b16 a[84:85], v15 offset:22528
    v_lshrrev_b32 v36, 3, v34
    v_mfma_f32_16x16x32_bf16 a[136:139], a[88:91], a[0:3], a[136:139]
    ds_read_b64_tr_b16 a[86:87], v15 offset:22784
    v_mul_u32_u24 v36, 16320, v36
    v_mfma_f32_16x16x32_bf16 a[152:155], a[88:91], a[4:7], a[152:155]
    v_sub_u32 v1, v2, v36
    s_mov_b32 s81, 1671168
    s_add_u32 m0, s3, 122880
    v_mfma_f32_16x16x32_bf16 a[168:171], a[88:91], a[8:11], a[168:171]
    ds_read_b64_tr_b16 a[110:111], v15 offset:24832
    v_xor_b32 v5, 64, v1
    buffer_load_dwordx4 v17, s[48:51], s81 offen lds
    v_mfma_f32_16x16x32_bf16 a[184:187], a[88:91], a[12:15], a[184:187]
    v_add_u32 v5, 16384, v5
    v_mfma_f32_16x16x32_bf16 a[200:203], a[88:91], a[16:19], a[200:203]
    v_mfma_f32_16x16x32_bf16 a[216:219], a[88:91], a[20:23], a[216:219]
    v_mfma_f32_16x16x32_bf16 a[232:235], a[88:91], a[24:27], a[232:235]
    ds_read_b64_tr_b16 a[124:125], v45 offset:20480
    v_mfma_f32_16x16x32_bf16 a[248:251], a[88:91], a[28:31], a[248:251]
    ds_read_b64_tr_b16 a[88:89], v13 offset:23552
    v_mfma_f32_16x16x32_bf16 a[140:143], a[92:95], a[0:3], a[140:143]
    ds_read_b64_tr_b16 a[90:91], v13 offset:23808
    v_mfma_f32_16x16x32_bf16 a[156:159], a[92:95], a[4:7], a[156:159]
    v_mfma_f32_16x16x32_bf16 a[172:175], a[92:95], a[8:11], a[172:175]
    ds_read_b64_tr_b16 a[126:127], v45 offset:20736
    v_mfma_f32_16x16x32_bf16 a[188:191], a[92:95], a[12:15], a[188:191]
    v_mfma_f32_16x16x32_bf16 a[204:207], a[92:95], a[16:19], a[204:207]
    v_mfma_f32_16x16x32_bf16 a[220:223], a[92:95], a[20:23], a[220:223]
    v_mfma_f32_16x16x32_bf16 a[236:239], a[92:95], a[24:27], a[236:239]
    buffer_load_dwordx4 v18, s[48:51], s81 offen offset:1024 lds
    v_mfma_f32_16x16x32_bf16 a[252:255], a[92:95], a[28:31], a[252:255]
    ds_read_b64_tr_b16 a[92:93], v15 offset:23552
    v_mfma_f32_16x16x32_bf16 v[48:51], a[96:99], a[0:3], v[48:51]
    ds_read_b64_tr_b16 a[94:95], v15 offset:23808
    v_mfma_f32_16x16x32_bf16 v[52:55], a[96:99], a[4:7], v[52:55]
    v_mfma_f32_16x16x32_bf16 v[64:67], a[96:99], a[8:11], v[64:67]
    v_mfma_f32_16x16x32_bf16 v[68:71], a[96:99], a[12:15], v[68:71]
    v_mfma_f32_16x16x32_bf16 v[80:83], a[96:99], a[16:19], v[80:83]
    v_mfma_f32_16x16x32_bf16 v[84:87], a[96:99], a[20:23], v[84:87]
    v_mfma_f32_16x16x32_bf16 v[96:99], a[96:99], a[24:27], v[96:99]
    v_mfma_f32_16x16x32_bf16 v[100:103], a[96:99], a[28:31], v[100:103]
    v_mfma_f32_16x16x32_bf16 v[56:59], a[100:103], a[0:3], v[56:59]
    v_mfma_f32_16x16x32_bf16 v[60:63], a[100:103], a[4:7], v[60:63]
    v_mfma_f32_16x16x32_bf16 v[72:75], a[100:103], a[8:11], v[72:75]
    v_mfma_f32_16x16x32_bf16 v[76:79], a[100:103], a[12:15], v[76:79]
    v_mfma_f32_16x16x32_bf16 v[88:91], a[100:103], a[16:19], v[88:91]
    v_mfma_f32_16x16x32_bf16 v[92:95], a[100:103], a[20:23], v[92:95]
    v_mfma_f32_16x16x32_bf16 v[104:107], a[100:103], a[24:27], v[104:107]
    v_mfma_f32_16x16x32_bf16 v[108:111], a[100:103], a[28:31], v[108:111]
    s_waitcnt lgkmcnt(0)
    s_barrier
    v_mfma_f32_16x16x32_bf16 v[120:123], a[116:119], a[124:127], v[120:123]
    s_lshl_b32 s82, s62, 3
    s_add_u32 s82, s82, s61
    v_mfma_f32_16x16x32_bf16 v[128:131], a[64:67], a[32:35], v[128:131]
    s_lshl_b32 s82, s82, 10
    s_add_u32 s82, s82, 139264
    v_mfma_f32_16x16x32_bf16 v[144:147], a[64:67], a[36:39], v[144:147]
    s_mov_b32 s80, 917504
    s_add_u32 m0, s3, 32768
    v_add_u32 v44, s82, v16
    s_lshl_b32 s82, s61, 12
    v_mfma_f32_16x16x32_bf16 v[160:163], a[64:67], a[40:43], v[160:163]
    buffer_load_dwordx4 v17, s[48:51], s80 offen lds
    s_add_u32 s82, s82, 139264
    v_add_u32 v45, s82, v16
    v_mfma_f32_16x16x32_bf16 v[176:179], a[64:67], a[44:47], v[176:179]
    v_lshrrev_b32 v34, 2, v0
    v_mfma_f32_16x16x32_bf16 v[192:195], a[64:67], a[48:51], v[192:195]
    ds_write_b128 v44, v[120:123]
    v_and_b32 v35, 3, v0
    v_mfma_f32_16x16x32_bf16 v[208:211], a[64:67], a[52:55], v[208:211]
    v_lshlrev_b32 v35, 3, v35
    v_mfma_f32_16x16x32_bf16 v[224:227], a[64:67], a[56:59], v[224:227]
    buffer_load_dwordx4 v18, s[48:51], s80 offen offset:1024 lds
    v_lshl_add_u32 v35, v34, 8, v35
    v_mfma_f32_16x16x32_bf16 v[240:243], a[64:67], a[60:63], v[240:243]
    v_and_b32 v34, 7, v34
    v_mfma_f32_16x16x32_bf16 v[132:135], a[68:71], a[32:35], v[132:135]
    v_xor_b32 v36, 0, v34
    v_mfma_f32_16x16x32_bf16 v[148:151], a[68:71], a[36:39], v[148:151]
    v_lshl_add_u32 v8, v36, 5, v35
    v_mfma_f32_16x16x32_bf16 v[164:167], a[68:71], a[40:43], v[164:167]
    s_mov_b32 s81, 1146880
    s_add_u32 m0, s3, 40960
    v_xor_b32 v36, 1, v34
    v_mfma_f32_16x16x32_bf16 v[180:183], a[68:71], a[44:47], v[180:183]
    buffer_load_dwordx4 v17, s[48:51], s81 offen lds
    v_lshl_add_u32 v9, v36, 5, v35
    v_mfma_f32_16x16x32_bf16 v[196:199], a[68:71], a[48:51], v[196:199]
    v_xor_b32 v36, 2, v34
    v_mfma_f32_16x16x32_bf16 v[212:215], a[68:71], a[52:55], v[212:215]
    v_lshl_add_u32 v10, v36, 5, v35
    v_mfma_f32_16x16x32_bf16 v[228:231], a[68:71], a[56:59], v[228:231]
    v_xor_b32 v36, 3, v34
    v_mfma_f32_16x16x32_bf16 v[244:247], a[68:71], a[60:63], v[244:247]
    buffer_load_dwordx4 v18, s[48:51], s81 offen offset:1024 lds
    v_lshl_add_u32 v11, v36, 5, v35
    v_mfma_f32_16x16x32_bf16 v[136:139], a[72:75], a[32:35], v[136:139]
    v_xor_b32 v36, 4, v34
    v_mfma_f32_16x16x32_bf16 v[152:155], a[72:75], a[36:39], v[152:155]
    v_lshl_add_u32 v12, v36, 5, v35
    v_mfma_f32_16x16x32_bf16 v[168:171], a[72:75], a[40:43], v[168:171]
    v_xor_b32 v36, 5, v34
    v_mfma_f32_16x16x32_bf16 v[184:187], a[72:75], a[44:47], v[184:187]
    s_mov_b32 s80, 1376256
    s_add_u32 m0, s3, 49152
    v_lshl_add_u32 v13, v36, 5, v35
    v_mfma_f32_16x16x32_bf16 v[200:203], a[72:75], a[48:51], v[200:203]
    buffer_load_dwordx4 v17, s[48:51], s80 offen lds
    v_xor_b32 v36, 6, v34
    v_mfma_f32_16x16x32_bf16 v[216:219], a[72:75], a[52:55], v[216:219]
    v_lshl_add_u32 v14, v36, 5, v35
    v_mfma_f32_16x16x32_bf16 v[232:235], a[72:75], a[56:59], v[232:235]
    v_xor_b32 v36, 7, v34
    v_mfma_f32_16x16x32_bf16 v[248:251], a[72:75], a[60:63], v[248:251]
    v_lshl_add_u32 v15, v36, 5, v35
    v_mfma_f32_16x16x32_bf16 v[140:143], a[76:79], a[32:35], v[140:143]
    buffer_load_dwordx4 v18, s[48:51], s80 offen offset:1024 lds
    v_mfma_f32_16x16x32_bf16 v[156:159], a[76:79], a[36:39], v[156:159]
    v_mfma_f32_16x16x32_bf16 v[172:175], a[76:79], a[40:43], v[172:175]
    v_mfma_f32_16x16x32_bf16 v[188:191], a[76:79], a[44:47], v[188:191]
    v_mfma_f32_16x16x32_bf16 v[204:207], a[76:79], a[48:51], v[204:207]
    s_mov_b32 s81, 1605632
    s_add_u32 m0, s3, 57344
    v_mfma_f32_16x16x32_bf16 v[220:223], a[76:79], a[52:55], v[220:223]
    buffer_load_dwordx4 v17, s[48:51], s81 offen lds
    v_mfma_f32_16x16x32_bf16 v[236:239], a[76:79], a[56:59], v[236:239]
    v_mfma_f32_16x16x32_bf16 v[252:255], a[76:79], a[60:63], v[252:255]
    v_mfma_f32_16x16x32_bf16 a[128:131], a[80:83], a[32:35], a[128:131]
    v_mfma_f32_16x16x32_bf16 a[144:147], a[80:83], a[36:39], a[144:147]
    buffer_load_dwordx4 v18, s[48:51], s81 offen offset:1024 lds
    v_mfma_f32_16x16x32_bf16 a[160:163], a[80:83], a[40:43], a[160:163]
    v_mfma_f32_16x16x32_bf16 a[176:179], a[80:83], a[44:47], a[176:179]
    v_mfma_f32_16x16x32_bf16 a[192:195], a[80:83], a[48:51], a[192:195]
    v_mfma_f32_16x16x32_bf16 a[208:211], a[80:83], a[52:55], a[208:211]
    s_mov_b32 s80, 65536
    s_add_u32 m0, s3, 65536
    v_mfma_f32_16x16x32_bf16 a[224:227], a[80:83], a[56:59], a[224:227]
    buffer_load_dwordx4 v17, s[48:51], s80 offen lds
    v_mfma_f32_16x16x32_bf16 a[240:243], a[80:83], a[60:63], a[240:243]
    v_mfma_f32_16x16x32_bf16 a[132:135], a[84:87], a[32:35], a[132:135]
    v_mfma_f32_16x16x32_bf16 a[148:151], a[84:87], a[36:39], a[148:151]
    v_mfma_f32_16x16x32_bf16 a[164:167], a[84:87], a[40:43], a[164:167]
    buffer_load_dwordx4 v18, s[48:51], s80 offen offset:1024 lds
    v_mfma_f32_16x16x32_bf16 a[180:183], a[84:87], a[44:47], a[180:183]
    v_mfma_f32_16x16x32_bf16 a[196:199], a[84:87], a[48:51], a[196:199]
    v_mfma_f32_16x16x32_bf16 a[212:215], a[84:87], a[52:55], a[212:215]
    v_mfma_f32_16x16x32_bf16 a[228:231], a[84:87], a[56:59], a[228:231]
    s_mov_b32 s80, 131072
    s_add_u32 m0, s3, 131072
    v_mfma_f32_16x16x32_bf16 a[244:247], a[84:87], a[60:63], a[244:247]
    buffer_load_dwordx4 v17, s[48:51], s80 offen lds
    v_mfma_f32_16x16x32_bf16 a[136:139], a[88:91], a[32:35], a[136:139]
    v_mfma_f32_16x16x32_bf16 a[152:155], a[88:91], a[36:39], a[152:155]
    v_mfma_f32_16x16x32_bf16 a[168:171], a[88:91], a[40:43], a[168:171]
    v_mfma_f32_16x16x32_bf16 a[184:187], a[88:91], a[44:47], a[184:187]
    buffer_load_dwordx4 v18, s[48:51], s80 offen offset:1024 lds
    v_mfma_f32_16x16x32_bf16 a[200:203], a[88:91], a[48:51], a[200:203]
    v_mfma_f32_16x16x32_bf16 a[216:219], a[88:91], a[52:55], a[216:219]
    v_mfma_f32_16x16x32_bf16 a[232:235], a[88:91], a[56:59], a[232:235]
    v_mfma_f32_16x16x32_bf16 a[248:251], a[88:91], a[60:63], a[248:251]
    s_mov_b32 s81, 360448
    s_add_u32 m0, s3, 139264
    v_mfma_f32_16x16x32_bf16 a[140:143], a[92:95], a[32:35], a[140:143]
    buffer_load_dwordx4 v17, s[48:51], s81 offen lds
    v_mfma_f32_16x16x32_bf16 a[156:159], a[92:95], a[36:39], a[156:159]
    v_mfma_f32_16x16x32_bf16 a[172:175], a[92:95], a[40:43], a[172:175]
    v_mfma_f32_16x16x32_bf16 a[188:191], a[92:95], a[44:47], a[188:191]
    v_mfma_f32_16x16x32_bf16 a[204:207], a[92:95], a[48:51], a[204:207]
    buffer_load_dwordx4 v18, s[48:51], s81 offen offset:1024 lds
    v_mfma_f32_16x16x32_bf16 a[220:223], a[92:95], a[52:55], a[220:223]
    v_mfma_f32_16x16x32_bf16 a[236:239], a[92:95], a[56:59], a[236:239]
    v_mfma_f32_16x16x32_bf16 a[252:255], a[92:95], a[60:63], a[252:255]
    v_mfma_f32_16x16x32_bf16 v[48:51], a[104:107], a[32:35], v[48:51]
    s_mov_b32 s80, 589824
    s_add_u32 m0, s3, 147456
    v_mfma_f32_16x16x32_bf16 v[52:55], a[104:107], a[36:39], v[52:55]
    buffer_load_dwordx4 v17, s[48:51], s80 offen lds
    v_mfma_f32_16x16x32_bf16 v[64:67], a[104:107], a[40:43], v[64:67]
    v_mfma_f32_16x16x32_bf16 v[68:71], a[104:107], a[44:47], v[68:71]
    v_mfma_f32_16x16x32_bf16 v[80:83], a[104:107], a[48:51], v[80:83]
    v_mfma_f32_16x16x32_bf16 v[84:87], a[104:107], a[52:55], v[84:87]
    buffer_load_dwordx4 v18, s[48:51], s80 offen offset:1024 lds
    v_mfma_f32_16x16x32_bf16 v[96:99], a[104:107], a[56:59], v[96:99]
    v_mfma_f32_16x16x32_bf16 v[100:103], a[104:107], a[60:63], v[100:103]
    v_mfma_f32_16x16x32_bf16 v[56:59], a[108:111], a[32:35], v[56:59]
    v_mfma_f32_16x16x32_bf16 v[60:63], a[108:111], a[36:39], v[60:63]
    v_mfma_f32_16x16x32_bf16 v[72:75], a[108:111], a[40:43], v[72:75]
    v_mfma_f32_16x16x32_bf16 v[76:79], a[108:111], a[44:47], v[76:79]
    v_mfma_f32_16x16x32_bf16 v[88:91], a[108:111], a[48:51], v[88:91]
    v_mfma_f32_16x16x32_bf16 v[92:95], a[108:111], a[52:55], v[92:95]
    v_mfma_f32_16x16x32_bf16 v[104:107], a[108:111], a[56:59], v[104:107]
    v_mfma_f32_16x16x32_bf16 v[108:111], a[108:111], a[60:63], v[108:111]
    s_waitcnt lgkmcnt(0)
    s_barrier
L_epi:
    global_load_dwordx4 a[112:115], v1, s[8:9] offset:0
    global_load_dwordx4 a[116:119], v5, s[8:9] offset:0
    global_load_dwordx4 a[120:123], v1, s[8:9] offset:128
    global_load_dwordx4 a[124:127], v5, s[8:9] offset:128
    v_pk_mul_f32 v[34:35], v[128:129], v[128:129]
    v_pk_mul_f32 v[36:37], v[130:131], v[130:131]
    v_pk_mul_f32 v[38:39], v[132:133], v[132:133]
    v_pk_mul_f32 v[40:41], v[134:135], v[134:135]
    v_pk_fma_f32 v[34:35], v[34:35], s[94:95], v[26:27]
    v_pk_fma_f32 v[36:37], v[36:37], s[94:95], v[26:27]
    v_pk_fma_f32 v[38:39], v[38:39], s[94:95], v[26:27]
    v_pk_fma_f32 v[40:41], v[40:41], s[94:95], v[26:27]
    v_pk_mul_f32 v[34:35], v[34:35], v[128:129]
    v_pk_mul_f32 v[36:37], v[36:37], v[130:131]
    v_pk_mul_f32 v[38:39], v[38:39], v[132:133]
    v_pk_mul_f32 v[40:41], v[40:41], v[134:135]
    v_exp_f32 v34, v34
    v_exp_f32 v35, v35
    v_exp_f32 v36, v36
    v_exp_f32 v37, v37
    v_exp_f32 v38, v38
    v_exp_f32 v39, v39
    v_exp_f32 v40, v40
    v_exp_f32 v41, v41
    v_pk_mul_f32 v[136:137], v[136:137], v[128:129]
    v_pk_mul_f32 v[138:139], v[138:139], v[130:131]
    v_pk_mul_f32 v[140:141], v[140:141], v[132:133]
    v_pk_mul_f32 v[142:143], v[142:143], v[134:135]
    v_pk_add_f32 v[34:35], v[34:35], 1.0 op_sel_hi:[1,0]
    v_pk_add_f32 v[36:37], v[36:37], 1.0 op_sel_hi:[1,0]
    v_pk_add_f32 v[38:39], v[38:39], 1.0 op_sel_hi:[1,0]
    v_pk_add_f32 v[40:41], v[40:41], 1.0 op_sel_hi:[1,0]
    v_rcp_f32 v34, v34
    v_rcp_f32 v35, v35
    v_rcp_f32 v36, v36
    v_rcp_f32 v37, v37
    v_rcp_f32 v38, v38
    v_rcp_f32 v39, v39
    v_rcp_f32 v40, v40
    v_rcp_f32 v41, v41
    v_pk_mul_f32 v[136:137], v[136:137], v[34:35]
    v_pk_mul_f32 v[138:139], v[138:139], v[36:37]
    v_pk_mul_f32 v[140:141], v[140:141], v[38:39]
    v_pk_mul_f32 v[142:143], v[142:143], v[40:41]
    v_cvt_pk_bf16_f32 v128, v136, v137
    v_cvt_pk_bf16_f32 v129, v138, v139
    v_cvt_pk_bf16_f32 v130, v140, v141
    v_cvt_pk_bf16_f32 v131, v142, v143
    buffer_store_dwordx4 v[128:131], v16, s[56:59], s88 offen offset:0 sc1
    v_pk_mul_f32 v[34:35], v[144:145], v[144:145]
    v_pk_mul_f32 v[36:37], v[146:147], v[146:147]
    v_pk_mul_f32 v[38:39], v[148:149], v[148:149]
    v_pk_mul_f32 v[40:41], v[150:151], v[150:151]
    v_pk_fma_f32 v[34:35], v[34:35], s[94:95], v[26:27]
    v_pk_fma_f32 v[36:37], v[36:37], s[94:95], v[26:27]
    v_pk_fma_f32 v[38:39], v[38:39], s[94:95], v[26:27]
    v_pk_fma_f32 v[40:41], v[40:41], s[94:95], v[26:27]
    v_pk_mul_f32 v[34:35], v[34:35], v[144:145]
    v_pk_mul_f32 v[36:37], v[36:37], v[146:147]
    v_pk_mul_f32 v[38:39], v[38:39], v[148:149]
    v_pk_mul_f32 v[40:41], v[40:41], v[150:151]
    v_exp_f32 v34, v34
    v_exp_f32 v35, v35
    v_exp_f32 v36, v36
    v_exp_f32 v37, v37
    v_exp_f32 v38, v38
    v_exp_f32 v39, v39
    v_exp_f32 v40, v40
    v_exp_f32 v41, v41
    v_pk_mul_f32 v[152:153], v[152:153], v[144:145]
    v_pk_mul_f32 v[154:155], v[154:155], v[146:147]
    v_pk_mul_f32 v[156:157], v[156:157], v[148:149]
    v_pk_mul_f32 v[158:159], v[158:159], v[150:151]
    v_pk_add_f32 v[34:35], v[34:35], 1.0 op_sel_hi:[1,0]
    v_pk_add_f32 v[36:37], v[36:37], 1.0 op_sel_hi:[1,0]
    v_pk_add_f32 v[38:39], v[38:39], 1.0 op_sel_hi:[1,0]
    v_pk_add_f32 v[40:41], v[40:41], 1.0 op_sel_hi:[1,0]
    v_rcp_f32 v34, v34
    v_rcp_f32 v35, v35
    v_rcp_f32 v36, v36
    v_rcp_f32 v37, v37
    v_rcp_f32 v38, v38
    v_rcp_f32 v39, v39
    v_rcp_f32 v40, v40
    v_rcp_f32 v41, v41
    v_pk_mul_f32 v[152:153], v[152:153], v[34:35]
    v_pk_mul_f32 v[154:155], v[154:155], v[36:37]
    v_pk_mul_f32 v[156:157], v[156:157], v[38:39]
    v_pk_mul_f32 v[158:159], v[158:159], v[40:41]
    v_cvt_pk_bf16_f32 v144, v152, v153
    v_cvt_pk_bf16_f32 v145, v154, v155
    v_cvt_pk_bf16_f32 v146, v156, v157
    v_cvt_pk_bf16_f32 v147, v158, v159
    buffer_store_dwordx4 v[144:147], v16, s[56:59], s88 offen offset:1024 sc1
    v_pk_mul_f32 v[34:35], v[160:161], v[160:161]
    v_pk_mul_f32 v[36:37], v[162:163], v[162:163]
    v_pk_mul_f32 v[38:39], v[164:165], v[164:165]
    v_pk_mul_f32 v[40:41], v[166:167], v[166:167]
    v_pk_fma_f32 v[34:35], v[34:35], s[94:95], v[26:27]
    v_pk_fma_f32 v[36:37], v[36:37], s[94:95], v[26:27]
    v_pk_fma_f32 v[38:39], v[38:39], s[94:95], v[26:27]
    v_pk_fma_f32 v[40:41], v[40:41], s[94:95], v[26:27]
    v_pk_mul_f32 v[34:35], v[34:35], v[160:161]
    v_pk_mul_f32 v[36:37], v[36:37], v[162:163]
    v_pk_mul_f32 v[38:39], v[38:39], v[164:165]
    v_pk_mul_f32 v[40:41], v[40:41], v[166:167]
    v_exp_f32 v34, v34
    v_exp_f32 v35, v35
    v_exp_f32 v36, v36
    s_branch L_over4
L_stub4:
    s_branch L_stub8
L_over4:
    v_exp_f32 v37, v37
    v_exp_f32 v38, v38
    v_exp_f32 v39, v39
    v_exp_f32 v40, v40
    v_exp_f32 v41, v41
    v_pk_mul_f32 v[168:169], v[168:169], v[160:161]
    v_pk_mul_f32 v[170:171], v[170:171], v[162:163]
    v_pk_mul_f32 v[172:173], v[172:173], v[164:165]
    v_pk_mul_f32 v[174:175], v[174:175], v[166:167]
    v_pk_add_f32 v[34:35], v[34:35], 1.0 op_sel_hi:[1,0]
    v_pk_add_f32 v[36:37], v[36:37], 1.0 op_sel_hi:[1,0]
    v_pk_add_f32 v[38:39], v[38:39], 1.0 op_sel_hi:[1,0]
    v_pk_add_f32 v[40:41], v[40:41], 1.0 op_sel_hi:[1,0]
    v_rcp_f32 v34, v34
    v_rcp_f32 v35, v35
    v_rcp_f32 v36, v36
    v_rcp_f32 v37, v37
    v_rcp_f32 v38, v38
    v_rcp_f32 v39, v39
    v_rcp_f32 v40, v40
    v_rcp_f32 v41, v41
    v_pk_mul_f32 v[168:169], v[168:169], v[34:35]
    v_pk_mul_f32 v[170:171], v[170:171], v[36:37]
    v_pk_mul_f32 v[172:173], v[172:173], v[38:39]
    v_pk_mul_f32 v[174:175], v[174:175], v[40:41]
    v_cvt_pk_bf16_f32 v160, v168, v169
    v_cvt_pk_bf16_f32 v161, v170, v171
    v_cvt_pk_bf16_f32 v162, v172, v173
    v_cvt_pk_bf16_f32 v163, v174, v175
    buffer_store_dwordx4 v[160:163], v16, s[56:59], s88 offen offset:2048 sc1
    v_pk_mul_f32 v[34:35], v[176:177], v[176:177]
    v_pk_mul_f32 v[36:37], v[178:179], v[178:179]
    v_pk_mul_f32 v[38:39], v[180:181], v[180:181]
    v_pk_mul_f32 v[40:41], v[182:183], v[182:183]
    v_pk_fma_f32 v[34:35], v[34:35], s[94:95], v[26:27]
    v_pk_fma_f32 v[36:37], v[36:37], s[94:95], v[26:27]
    v_pk_fma_f32 v[38:39], v[38:39], s[94:95], v[26:27]
    v_pk_fma_f32 v[40:41], v[40:41], s[94:95], v[26:27]
    v_pk_mul_f32 v[34:35], v[34:35], v[176:177]
    v_pk_mul_f32 v[36:37], v[36:37], v[178:179]
    v_pk_mul_f32 v[38:39], v[38:39], v[180:181]
    v_pk_mul_f32 v[40:41], v[40:41], v[182:183]
    v_exp_f32 v34, v34
    v_exp_f32 v35, v35
    v_exp_f32 v36, v36
    v_exp_f32 v37, v37
    v_exp_f32 v38, v38
    v_exp_f32 v39, v39
    v_exp_f32 v40, v40
    v_exp_f32 v41, v41
    v_pk_mul_f32 v[184:185], v[184:185], v[176:177]
    v_pk_mul_f32 v[186:187], v[186:187], v[178:179]
    v_pk_mul_f32 v[188:189], v[188:189], v[180:181]
    v_pk_mul_f32 v[190:191], v[190:191], v[182:183]
    v_pk_add_f32 v[34:35], v[34:35], 1.0 op_sel_hi:[1,0]
    v_pk_add_f32 v[36:37], v[36:37], 1.0 op_sel_hi:[1,0]
    v_pk_add_f32 v[38:39], v[38:39], 1.0 op_sel_hi:[1,0]
    v_pk_add_f32 v[40:41], v[40:41], 1.0 op_sel_hi:[1,0]
    v_rcp_f32 v34, v34
    v_rcp_f32 v35, v35
    v_rcp_f32 v36, v36
    v_rcp_f32 v37, v37
    v_rcp_f32 v38, v38
    v_rcp_f32 v39, v39
    v_rcp_f32 v40, v40
    v_rcp_f32 v41, v41
    v_pk_mul_f32 v[184:185], v[184:185], v[34:35]
    v_pk_mul_f32 v[186:187], v[186:187], v[36:37]
    v_pk_mul_f32 v[188:189], v[188:189], v[38:39]
    v_pk_mul_f32 v[190:191], v[190:191], v[40:41]
    v_cvt_pk_bf16_f32 v176, v184, v185
    v_cvt_pk_bf16_f32 v177, v186, v187
    v_cvt_pk_bf16_f32 v178, v188, v189
    v_cvt_pk_bf16_f32 v179, v190, v191
    buffer_store_dwordx4 v[176:179], v16, s[56:59], s88 offen offset:3072 sc1
    v_pk_mul_f32 v[34:35], v[192:193], v[192:193]
    v_pk_mul_f32 v[36:37], v[194:195], v[194:195]
    v_pk_mul_f32 v[38:39], v[196:197], v[196:197]
    v_pk_mul_f32 v[40:41], v[198:199], v[198:199]
    v_pk_fma_f32 v[34:35], v[34:35], s[94:95], v[26:27]
    v_pk_fma_f32 v[36:37], v[36:37], s[94:95], v[26:27]
    v_pk_fma_f32 v[38:39], v[38:39], s[94:95], v[26:27]
    v_pk_fma_f32 v[40:41], v[40:41], s[94:95], v[26:27]
    v_pk_mul_f32 v[34:35], v[34:35], v[192:193]
    v_pk_mul_f32 v[36:37], v[36:37], v[194:195]
    v_pk_mul_f32 v[38:39], v[38:39], v[196:197]
    v_pk_mul_f32 v[40:41], v[40:41], v[198:199]
    v_exp_f32 v34, v34
    v_exp_f32 v35, v35
    v_exp_f32 v36, v36
    v_exp_f32 v37, v37
    v_exp_f32 v38, v38
    v_exp_f32 v39, v39
    v_exp_f32 v40, v40
    v_exp_f32 v41, v41
    v_pk_mul_f32 v[200:201], v[200:201], v[192:193]
    v_pk_mul_f32 v[202:203], v[202:203], v[194:195]
    v_pk_mul_f32 v[204:205], v[204:205], v[196:197]
    v_pk_mul_f32 v[206:207], v[206:207], v[198:199]
    v_pk_add_f32 v[34:35], v[34:35], 1.0 op_sel_hi:[1,0]
    v_pk_add_f32 v[36:37], v[36:37], 1.0 op_sel_hi:[1,0]
    v_pk_add_f32 v[38:39], v[38:39], 1.0 op_sel_hi:[1,0]
    v_pk_add_f32 v[40:41], v[40:41], 1.0 op_sel_hi:[1,0]
    v_rcp_f32 v34, v34
    v_rcp_f32 v35, v35
    v_rcp_f32 v36, v36
    v_rcp_f32 v37, v37
    v_rcp_f32 v38, v38
    v_rcp_f32 v39, v39
    v_rcp_f32 v40, v40
    v_rcp_f32 v41, v41
    v_pk_mul_f32 v[200:201], v[200:201], v[34:35]
    v_pk_mul_f32 v[202:203], v[202:203], v[36:37]
    v_pk_mul_f32 v[204:205], v[204:205], v[38:39]
    v_pk_mul_f32 v[206:207], v[206:207], v[40:41]
    v_cvt_pk_bf16_f32 v192, v200, v201
    v_cvt_pk_bf16_f32 v193, v202, v203
    v_cvt_pk_bf16_f32 v194, v204, v205
    v_cvt_pk_bf16_f32 v195, v206, v207
    s_add_u32 s88, s88, 4096
    buffer_store_dwordx4 v[192:195], v16, s[56:59], s88 offen offset:0 sc1
    v_pk_mul_f32 v[34:35], v[208:209], v[208:209]
    v_pk_mul_f32 v[36:37], v[210:211], v[210:211]
    v_pk_mul_f32 v[38:39], v[212:213], v[212:213]
    v_pk_mul_f32 v[40:41], v[214:215], v[214:215]
    v_pk_fma_f32 v[34:35], v[34:35], s[94:95], v[26:27]
    v_pk_fma_f32 v[36:37], v[36:37], s[94:95], v[26:27]
    v_pk_fma_f32 v[38:39], v[38:39], s[94:95], v[26:27]
    v_pk_fma_f32 v[40:41], v[40:41], s[94:95], v[26:27]
    v_pk_mul_f32 v[34:35], v[34:35], v[208:209]
    v_pk_mul_f32 v[36:37], v[36:37], v[210:211]
    v_pk_mul_f32 v[38:39], v[38:39], v[212:213]
    v_pk_mul_f32 v[40:41], v[40:41], v[214:215]
    v_exp_f32 v34, v34
    v_exp_f32 v35, v35
    v_exp_f32 v36, v36
    v_exp_f32 v37, v37
    v_exp_f32 v38, v38
    v_exp_f32 v39, v39
    v_exp_f32 v40, v40
    v_exp_f32 v41, v41
    v_pk_mul_f32 v[216:217], v[216:217], v[208:209]
    v_pk_mul_f32 v[218:219], v[218:219], v[210:211]
    v_pk_mul_f32 v[220:221], v[220:221], v[212:213]
    v_pk_mul_f32 v[222:223], v[222:223], v[214:215]
    v_pk_add_f32 v[34:35], v[34:35], 1.0 op_sel_hi:[1,0]
    v_pk_add_f32 v[36:37], v[36:37], 1.0 op_sel_hi:[1,0]
    v_pk_add_f32 v[38:39], v[38:39], 1.0 op_sel_hi:[1,0]
    v_pk_add_f32 v[40:41], v[40:41], 1.0 op_sel_hi:[1,0]
    v_rcp_f32 v34, v34
    v_rcp_f32 v35, v35
    v_rcp_f32 v36, v36
    v_rcp_f32 v37, v37
    v_rcp_f32 v38, v38
    v_rcp_f32 v39, v39
    v_rcp_f32 v40, v40
    v_rcp_f32 v41, v41
    v_pk_mul_f32 v[216:217], v[216:217], v[34:35]
    v_pk_mul_f32 v[218:219], v[218:219], v[36:37]
    v_pk_mul_f32 v[220:221], v[220:221], v[38:39]
    v_pk_mul_f32 v[222:223], v[222:223], v[40:41]
    v_cvt_pk_bf16_f32 v208, v216, v217
    v_cvt_pk_bf16_f32 v209, v218, v219
    v_cvt_pk_bf16_f32 v210, v220, v221
    v_cvt_pk_bf16_f32 v211, v222, v223
    buffer_store_dwordx4 v[208:211], v16, s[56:59], s88 offen offset:1024 sc1
    v_pk_mul_f32 v[34:35], v[224:225], v[224:225]
    v_pk_mul_f32 v[36:37], v[226:227], v[226:227]
    v_pk_mul_f32 v[38:39], v[228:229], v[228:229]
    v_pk_mul_f32 v[40:41], v[230:231], v[230:231]
    v_pk_fma_f32 v[34:35], v[34:35], s[94:95], v[26:27]
    v_pk_fma_f32 v[36:37], v[36:37], s[94:95], v[26:27]
    v_pk_fma_f32 v[38:39], v[38:39], s[94:95], v[26:27]
    v_pk_fma_f32 v[40:41], v[40:41], s[94:95], v[26:27]
    v_pk_mul_f32 v[34:35], v[34:35], v[224:225]
    v_pk_mul_f32 v[36:37], v[36:37], v[226:227]
    v_pk_mul_f32 v[38:39], v[38:39], v[228:229]
    v_pk_mul_f32 v[40:41], v[40:41], v[230:231]
    v_exp_f32 v34, v34
    v_exp_f32 v35, v35
    v_exp_f32 v36, v36
    v_exp_f32 v37, v37
    v_exp_f32 v38, v38
    v_exp_f32 v39, v39
    v_exp_f32 v40, v40
    v_exp_f32 v41, v41
    v_pk_mul_f32 v[232:233], v[232:233], v[224:225]
    v_pk_mul_f32 v[234:235], v[234:235], v[226:227]
    v_pk_mul_f32 v[236:237], v[236:237], v[228:229]
    v_pk_mul_f32 v[238:239], v[238:239], v[230:231]
    v_pk_add_f32 v[34:35], v[34:35], 1.0 op_sel_hi:[1,0]
    v_pk_add_f32 v[36:37], v[36:37], 1.0 op_sel_hi:[1,0]
    v_pk_add_f32 v[38:39], v[38:39], 1.0 op_sel_hi:[1,0]
    v_pk_add_f32 v[40:41], v[40:41], 1.0 op_sel_hi:[1,0]
    v_rcp_f32 v34, v34
    v_rcp_f32 v35, v35
    v_rcp_f32 v36, v36
    v_rcp_f32 v37, v37
    v_rcp_f32 v38, v38
    v_rcp_f32 v39, v39
    v_rcp_f32 v40, v40
    v_rcp_f32 v41, v41
    v_pk_mul_f32 v[232:233], v[232:233], v[34:35]
    v_pk_mul_f32 v[234:235], v[234:235], v[36:37]
    v_pk_mul_f32 v[236:237], v[236:237], v[38:39]
    v_pk_mul_f32 v[238:239], v[238:239], v[40:41]
    v_cvt_pk_bf16_f32 v224, v232, v233
    v_cvt_pk_bf16_f32 v225, v234, v235
    v_cvt_pk_bf16_f32 v226, v236, v237
    v_cvt_pk_bf16_f32 v227, v238, v239
    buffer_store_dwordx4 v[224:227], v16, s[56:59], s88 offen offset:2048 sc1
    v_pk_mul_f32 v[34:35], v[240:241], v[240:241]
    v_pk_mul_f32 v[36:37], v[242:243], v[242:243]
    v_pk_mul_f32 v[38:39], v[244:245], v[244:245]
    v_pk_mul_f32 v[40:41], v[246:247], v[246:247]
    v_pk_fma_f32 v[34:35], v[34:35], s[94:95], v[26:27]
    v_pk_fma_f32 v[36:37], v[36:37], s[94:95], v[26:27]
    v_pk_fma_f32 v[38:39], v[38:39], s[94:95], v[26:27]
    v_pk_fma_f32 v[40:41], v[40:41], s[94:95], v[26:27]
    v_pk_mul_f32 v[34:35], v[34:35], v[240:241]
    v_pk_mul_f32 v[36:37], v[36:37], v[242:243]
    v_pk_mul_f32 v[38:39], v[38:39], v[244:245]
    v_pk_mul_f32 v[40:41], v[40:41], v[246:247]
    v_exp_f32 v34, v34
    v_exp_f32 v35, v35
    v_exp_f32 v36, v36
    v_exp_f32 v37, v37
    v_exp_f32 v38, v38
    v_exp_f32 v39, v39
    v_exp_f32 v40, v40
    v_exp_f32 v41, v41
    v_pk_mul_f32 v[248:249], v[248:249], v[240:241]
    v_pk_mul_f32 v[250:251], v[250:251], v[242:243]
    v_pk_mul_f32 v[252:253], v[252:253], v[244:245]
    v_pk_mul_f32 v[254:255], v[254:255], v[246:247]
    v_pk_add_f32 v[34:35], v[34:35], 1.0 op_sel_hi:[1,0]
    v_pk_add_f32 v[36:37], v[36:37], 1.0 op_sel_hi:[1,0]
    v_pk_add_f32 v[38:39], v[38:39], 1.0 op_sel_hi:[1,0]
    v_pk_add_f32 v[40:41], v[40:41], 1.0 op_sel_hi:[1,0]
    v_rcp_f32 v34, v34
    v_rcp_f32 v35, v35
    v_rcp_f32 v36, v36
    v_rcp_f32 v37, v37
    v_rcp_f32 v38, v38
    v_rcp_f32 v39, v39
    v_rcp_f32 v40, v40
    v_rcp_f32 v41, v41
    v_pk_mul_f32 v[248:249], v[248:249], v[34:35]
    v_pk_mul_f32 v[250:251], v[250:251], v[36:37]
    v_pk_mul_f32 v[252:253], v[252:253], v[38:39]
    v_pk_mul_f32 v[254:255], v[254:255], v[40:41]
    v_cvt_pk_bf16_f32 v240, v248, v249
    v_cvt_pk_bf16_f32 v241, v250, v251
    v_cvt_pk_bf16_f32 v242, v252, v253
    v_cvt_pk_bf16_f32 v243, v254, v255
    buffer_store_dwordx4 v[240:243], v16, s[56:59], s88 offen offset:3072 sc1
    s_cmp_eq_u32 s62, 1
    s_cbranch_scc1 L_epi1
    v_mov_b32 v244, 0xce6e6b28
    s_waitcnt lgkmcnt(0)
    s_mov_b32 s83, 360448
    s_add_u32 m0, s3, 139264
    s_nop 0
    buffer_load_dwordx4 v17, s[48:51], s83 offen lds
    buffer_load_dwordx4 v18, s[48:51], s83 offen offset:1024 lds
    s_mov_b32 s82, 589824
    s_add_u32 m0, s3, 147456
    s_nop 0
    buffer_load_dwordx4 v17, s[48:51], s82 offen lds
    buffer_load_dwordx4 v18, s[48:51], s82 offen offset:1024 lds
    v_cvt_pk_bf16_f32 v128, v120, v121
    v_cvt_pk_bf16_f32 v129, v122, v123
    v_cvt_pk_bf16_f32 v130, v124, v125
    v_cvt_pk_bf16_f32 v131, v126, v127
    v_accvgpr_read_b32 v34, a128
    v_accvgpr_read_b32 v35, a129
    v_accvgpr_read_b32 v36, a130
    v_accvgpr_read_b32 v37, a131
    v_accvgpr_read_b32 v38, a132
    v_accvgpr_read_b32 v39, a133
    v_accvgpr_read_b32 v40, a134
    v_accvgpr_read_b32 v41, a135
    v_cvt_pk_bf16_f32 v132, v34, v35
    v_cvt_pk_bf16_f32 v133, v36, v37
    v_cvt_pk_bf16_f32 v134, v38, v39
    v_cvt_pk_bf16_f32 v135, v40, v41
    v_accvgpr_read_b32 v246, a192
    v_accvgpr_read_b32 v247, a193
    v_accvgpr_read_b32 v248, a194
    v_accvgpr_read_b32 v249, a195
    v_accvgpr_read_b32 v250, a196
    v_accvgpr_read_b32 v251, a197
    v_accvgpr_read_b32 v252, a198
    v_accvgpr_read_b32 v253, a199
    v_cvt_pk_bf16_f32 v164, v246, v247
    v_cvt_pk_bf16_f32 v165, v248, v249
    v_cvt_pk_bf16_f32 v166, v250, v251
    v_cvt_pk_bf16_f32 v167, v252, v253
    v_accvgpr_read_b32 v34, a136
    v_accvgpr_read_b32 v35, a137
    v_accvgpr_read_b32 v36, a138
    v_accvgpr_read_b32 v37, a139
    v_accvgpr_read_b32 v38, a140
    v_accvgpr_read_b32 v39, a141
    v_accvgpr_read_b32 v40, a142
    v_accvgpr_read_b32 v41, a143
    v_cvt_pk_bf16_f32 v136, v34, v35
    v_cvt_pk_bf16_f32 v137, v36, v37
    v_cvt_pk_bf16_f32 v138, v38, v39
    v_cvt_pk_bf16_f32 v139, v40, v41
    v_accvgpr_read_b32 v246, a200
    v_accvgpr_read_b32 v247, a201
    v_accvgpr_read_b32 v248, a202
    v_accvgpr_read_b32 v249, a203
    v_accvgpr_read_b32 v250, a204
    v_accvgpr_read_b32 v251, a205
    v_accvgpr_read_b32 v252, a206
    v_accvgpr_read_b32 v253, a207
    v_cvt_pk_bf16_f32 v168, v246, v247
    v_cvt_pk_bf16_f32 v169, v248, v249
    v_cvt_pk_bf16_f32 v170, v250, v251
    v_cvt_pk_bf16_f32 v171, v252, v253
    v_accvgpr_read_b32 v34, a144
    v_accvgpr_read_b32 v35, a145
    v_accvgpr_read_b32 v36, a146
    v_accvgpr_read_b32 v37, a147
    v_accvgpr_read_b32 v38, a148
    v_accvgpr_read_b32 v39, a149
    v_accvgpr_read_b32 v40, a150
    v_accvgpr_read_b32 v41, a151
    v_cvt_pk_bf16_f32 v140, v34, v35
    v_cvt_pk_bf16_f32 v141, v36, v37
    v_cvt_pk_bf16_f32 v142, v38, v39
    v_cvt_pk_bf16_f32 v143, v40, v41
    v_accvgpr_read_b32 v246, a208
    v_accvgpr_read_b32 v247, a209
    v_accvgpr_read_b32 v248, a210
    v_accvgpr_read_b32 v249, a211
    v_accvgpr_read_b32 v250, a212
    v_accvgpr_read_b32 v251, a213
    v_accvgpr_read_b32 v252, a214
    v_accvgpr_read_b32 v253, a215
    v_cvt_pk_bf16_f32 v172, v246, v247
    v_cvt_pk_bf16_f32 v173, v248, v249
    v_cvt_pk_bf16_f32 v174, v250, v251
    v_cvt_pk_bf16_f32 v175, v252, v253
    v_accvgpr_read_b32 v34, a152
    v_accvgpr_read_b32 v35, a153
    v_accvgpr_read_b32 v36, a154
    v_accvgpr_read_b32 v37, a155
    v_accvgpr_read_b32 v38, a156
    v_accvgpr_read_b32 v39, a157
    v_accvgpr_read_b32 v40, a158
    v_accvgpr_read_b32 v41, a159
    v_cvt_pk_bf16_f32 v144, v34, v35
    v_cvt_pk_bf16_f32 v145, v36, v37
    v_cvt_pk_bf16_f32 v146, v38, v39
    v_cvt_pk_bf16_f32 v147, v40, v41
    v_accvgpr_read_b32 v246, a216
    v_accvgpr_read_b32 v247, a217
    v_accvgpr_read_b32 v248, a218
    v_accvgpr_read_b32 v249, a219
    v_accvgpr_read_b32 v250, a220
    v_accvgpr_read_b32 v251, a221
    v_accvgpr_read_b32 v252, a222
    v_accvgpr_read_b32 v253, a223
    v_cvt_pk_bf16_f32 v176, v246, v247
    v_cvt_pk_bf16_f32 v177, v248, v249
    v_cvt_pk_bf16_f32 v178, v250, v251
    v_cvt_pk_bf16_f32 v179, v252, v253
    v_mfma_f32_16x16x32_bf16 v[196:199], v[128:131], v[164:167], 0
    v_mfma_f32_16x16x32_bf16 v[200:203], v[132:135], v[164:167], 0
    v_mfma_f32_16x16x32_bf16 v[204:207], v[132:135], v[168:171], 0
    v_mfma_f32_16x16x32_bf16 v[208:211], v[136:139], v[168:171], 0
    v_mfma_f32_16x16x32_bf16 v[212:215], v[136:139], v[172:175], 0
    v_mfma_f32_16x16x32_bf16 v[216:219], v[140:143], v[172:175], 0
    v_mfma_f32_16x16x32_bf16 v[220:223], v[140:143], v[176:179], 0
    v_mfma_f32_16x16x32_bf16 v[224:227], v[144:147], v[176:179], 0
    s_waitcnt vmcnt(4)
    s_mov_b64 exec, 1
    buffer_atomic_add v25, off, s[56:59], s92 sc1
    s_mov_b64 exec, -1
    v_cvt_pk_bf16_f32 v48, v48, v49
    v_cvt_pk_bf16_f32 v49, v50, v51
    v_cvt_pk_bf16_f32 v84, v84, v85
    v_cvt_pk_bf16_f32 v85, v86, v87
    v_cvt_pk_bf16_f32 v50, v52, v53
    v_cvt_pk_bf16_f32 v51, v54, v55
    v_cvt_pk_bf16_f32 v86, v88, v89
    v_cvt_pk_bf16_f32 v87, v90, v91
    v_cvt_pk_bf16_f32 v52, v56, v57
    v_cvt_pk_bf16_f32 v53, v58, v59
    v_cvt_pk_bf16_f32 v88, v92, v93
    v_cvt_pk_bf16_f32 v89, v94, v95
    v_cvt_pk_bf16_f32 v54, v60, v61
    v_cvt_pk_bf16_f32 v55, v62, v63
    v_cvt_pk_bf16_f32 v90, v96, v97
    v_cvt_pk_bf16_f32 v91, v98, v99
    v_cvt_pk_bf16_f32 v56, v64, v65
    v_cvt_pk_bf16_f32 v57, v66, v67
    v_cvt_pk_bf16_f32 v92, v100, v101
    v_cvt_pk_bf16_f32 v93, v102, v103
    v_cvt_pk_bf16_f32 v58, v68, v69
    v_cvt_pk_bf16_f32 v59, v70, v71
    v_cvt_pk_bf16_f32 v94, v104, v105
    v_cvt_pk_bf16_f32 v95, v106, v107
    v_cvt_pk_bf16_f32 v60, v72, v73
    v_cvt_pk_bf16_f32 v61, v74, v75
    v_cvt_pk_bf16_f32 v96, v108, v109
    v_cvt_pk_bf16_f32 v97, v110, v111
    v_cvt_pk_bf16_f32 v62, v76, v77
    v_cvt_pk_bf16_f32 v63, v78, v79
    v_cvt_pk_bf16_f32 v98, v112, v113
    v_cvt_pk_bf16_f32 v99, v114, v115
    v_cvt_pk_bf16_f32 v64, v80, v81
    v_cvt_pk_bf16_f32 v65, v82, v83
    v_cvt_pk_bf16_f32 v100, v116, v117
    v_cvt_pk_bf16_f32 v101, v118, v119
    v_cvt_pk_bf16_f32 v196, v196, v197
    v_cvt_pk_bf16_f32 v198, v198, v199
    v_cvt_pk_bf16_f32 v200, v200, v201
    v_cvt_pk_bf16_f32 v202, v202, v203
    v_cvt_pk_bf16_f32 v204, v204, v205
    v_cvt_pk_bf16_f32 v206, v206, v207
    v_cvt_pk_bf16_f32 v208, v208, v209
    v_cvt_pk_bf16_f32 v210, v210, v211
    v_cvt_pk_bf16_f32 v212, v212, v213
    v_cvt_pk_bf16_f32 v214, v214, v215
    v_cvt_pk_bf16_f32 v216, v216, v217
    v_cvt_pk_bf16_f32 v218, v218, v219
    v_cvt_pk_bf16_f32 v220, v220, v221
    v_cvt_pk_bf16_f32 v222, v222, v223
    v_cvt_pk_bf16_f32 v224, v224, v225
    v_cvt_pk_bf16_f32 v226, v226, v227
    v_perm_b32 v228, v200, v196, v28
    v_perm_b32 v229, v202, v198, v29
    v_perm_b32 v230, v208, v204, v28
    v_perm_b32 v231, v210, v206, v29
    v_perm_b32 v232, v216, v212, v28
    v_perm_b32 v233, v218, v214, v29
    v_perm_b32 v234, v224, v220, v28
    v_perm_b32 v235, v226, v222, v29
    v_pk_mul_f32 v[228:229], v[228:229], s[14:15]
    v_pk_mul_f32 v[230:231], v[230:231], s[14:15]
    v_pk_mul_f32 v[232:233], v[232:233], s[14:15]
    v_pk_mul_f32 v[234:235], v[234:235], s[14:15]
    v_cvt_pk_bf16_f32 v229, v228, v229
    v_cvt_pk_bf16_f32 v231, v230, v231
    v_cvt_pk_bf16_f32 v233, v232, v233
    v_cvt_pk_bf16_f32 v235, v234, v235
    v_lshlrev_b32 v228, 16, v229
    v_and_b32 v229, 0xffff0000, v229
    v_lshlrev_b32 v230, 16, v231
    v_and_b32 v231, 0xffff0000, v231
    v_lshlrev_b32 v232, 16, v233
    v_and_b32 v233, 0xffff0000, v233
    v_lshlrev_b32 v234, 16, v235
    v_and_b32 v235, 0xffff0000, v235
    v_cndmask_b32 v228, v244, v228, s[4:5]
    v_cndmask_b32 v229, v244, v229, s[6:7]
    v_max_f32 v236, v228, v229
    v_max_f32 v238, v230, v231
    v_max_f32 v240, v232, v233
    v_max_f32 v242, v234, v235
    v_permlane16_swap_b32 v236, v238
    s_nop 0
    v_permlane16_swap_b32 v240, v242
    v_max_f32 v236, v236, v238
    v_max_f32 v240, v240, v242
    s_nop 1
    v_permlane32_swap_b32 v236, v240
    v_max_f32 v236, v236, v240
    v_mul_f32 v236, 0xbfb8aa3b, v236
    v_mov_b32 v240, v236
    s_nop 1
    v_permlane32_swap_b32 v236, v240
    v_mov_b32 v238, v236
    v_mov_b32 v242, v240
    s_nop 0
    v_permlane16_swap_b32 v236, v238
    v_permlane16_swap_b32 v240, v242
    v_pk_fma_f32 v[228:229], v[228:229], s[98:99], v[236:237] op_sel_hi:[1,1,0]
    v_pk_fma_f32 v[230:231], v[230:231], s[98:99], v[238:239] op_sel_hi:[1,1,0]
    v_pk_fma_f32 v[232:233], v[232:233], s[98:99], v[240:241] op_sel_hi:[1,1,0]
    v_pk_fma_f32 v[234:235], v[234:235], s[98:99], v[242:243] op_sel_hi:[1,1,0]
    v_exp_f32 v228, v228
    v_exp_f32 v229, v229
    v_exp_f32 v230, v230
    v_exp_f32 v231, v231
    v_exp_f32 v232, v232
    v_exp_f32 v233, v233
    v_exp_f32 v234, v234
    v_exp_f32 v235, v235
    v_add_f32 v236, v228, v229
    v_add_f32 v238, v230, v231
    v_add_f32 v240, v232, v233
    v_add_f32 v242, v234, v235
    v_permlane16_swap_b32 v236, v238
    s_nop 0
    v_permlane16_swap_b32 v240, v242
    v_add_f32 v236, v236, v238
    v_add_f32 v240, v240, v242
    s_nop 1
    v_permlane32_swap_b32 v236, v240
    v_add_f32 v236, v236, v240
    v_rcp_f32 v236, v236
    s_nop 0
    v_mov_b32 v240, v236
    s_nop 1
    v_permlane32_swap_b32 v236, v240
    v_mov_b32 v238, v236
    v_mov_b32 v242, v240
    s_nop 0
    v_permlane16_swap_b32 v236, v238
    v_permlane16_swap_b32 v240, v242
    v_pk_mul_f32 v[228:229], v[228:229], v[236:237] op_sel_hi:[1,0]
    v_pk_mul_f32 v[230:231], v[230:231], v[238:239] op_sel_hi:[1,0]
    v_pk_mul_f32 v[232:233], v[232:233], v[240:241] op_sel_hi:[1,0]
    v_pk_mul_f32 v[234:235], v[234:235], v[242:243] op_sel_hi:[1,0]
    v_cvt_pk_bf16_f32 v228, v228, v229
    v_cvt_pk_bf16_f32 v230, v230, v231
    v_cvt_pk_bf16_f32 v232, v232, v233
    v_cvt_pk_bf16_f32 v234, v234, v235
    v_perm_b32 v164, v228, v228, v30
    v_perm_b32 v165, v228, v228, v31
    v_perm_b32 v166, v228, v228, v32
    v_perm_b32 v167, v228, v228, v33
    v_perm_b32 v168, v230, v230, v30
    v_perm_b32 v169, v230, v230, v31
    v_perm_b32 v170, v230, v230, v32
    v_perm_b32 v171, v230, v230, v33
    v_perm_b32 v172, v232, v232, v30
    v_perm_b32 v173, v232, v232, v31
    v_perm_b32 v174, v232, v232, v32
    v_perm_b32 v175, v232, v232, v33
    v_perm_b32 v176, v234, v234, v30
    v_perm_b32 v177, v234, v234, v31
    v_perm_b32 v178, v234, v234, v32
    v_perm_b32 v179, v234, v234, v33
    v_mfma_f32_16x16x32_bf16 v[196:199], v[48:51], v[164:167], 0
    v_mfma_f32_16x16x32_bf16 v[200:203], v[84:87], v[164:167], 0
    v_mfma_f32_16x16x32_bf16 v[204:207], v[50:53], v[168:171], 0
    v_mfma_f32_16x16x32_bf16 v[208:211], v[86:89], v[168:171], 0
    v_mfma_f32_16x16x32_bf16 v[212:215], v[52:55], v[172:175], 0
    v_mfma_f32_16x16x32_bf16 v[216:219], v[88:91], v[172:175], 0
    v_mfma_f32_16x16x32_bf16 v[220:223], v[54:57], v[176:179], 0
    v_mfma_f32_16x16x32_bf16 v[224:227], v[90:93], v[176:179], 0
    v_accvgpr_read_b32 v34, a160
    v_accvgpr_read_b32 v35, a161
    v_accvgpr_read_b32 v36, a162
    v_accvgpr_read_b32 v37, a163
    v_accvgpr_read_b32 v38, a164
    v_accvgpr_read_b32 v39, a165
    v_accvgpr_read_b32 v40, a166
    v_accvgpr_read_b32 v41, a167
    v_cvt_pk_bf16_f32 v148, v34, v35
    v_cvt_pk_bf16_f32 v149, v36, v37
    v_cvt_pk_bf16_f32 v150, v38, v39
    v_cvt_pk_bf16_f32 v151, v40, v41
    v_accvgpr_read_b32 v246, a224
    v_accvgpr_read_b32 v247, a225
    v_accvgpr_read_b32 v248, a226
    v_accvgpr_read_b32 v249, a227
    v_accvgpr_read_b32 v250, a228
    v_accvgpr_read_b32 v251, a229
    v_accvgpr_read_b32 v252, a230
    v_accvgpr_read_b32 v253, a231
    v_cvt_pk_bf16_f32 v180, v246, v247
    v_cvt_pk_bf16_f32 v181, v248, v249
    v_cvt_pk_bf16_f32 v182, v250, v251
    v_cvt_pk_bf16_f32 v183, v252, v253
    v_accvgpr_read_b32 v34, a168
    v_accvgpr_read_b32 v35, a169
    v_accvgpr_read_b32 v36, a170
    v_accvgpr_read_b32 v37, a171
    v_accvgpr_read_b32 v38, a172
    v_accvgpr_read_b32 v39, a173
    v_accvgpr_read_b32 v40, a174
    v_accvgpr_read_b32 v41, a175
    v_cvt_pk_bf16_f32 v152, v34, v35
    v_cvt_pk_bf16_f32 v153, v36, v37
    v_cvt_pk_bf16_f32 v154, v38, v39
    v_cvt_pk_bf16_f32 v155, v40, v41
    v_accvgpr_read_b32 v246, a232
    v_accvgpr_read_b32 v247, a233
    v_accvgpr_read_b32 v248, a234
    v_accvgpr_read_b32 v249, a235
    v_accvgpr_read_b32 v250, a236
    v_accvgpr_read_b32 v251, a237
    s_branch L_over5
L_stub5:
    s_branch L_stub9
L_over5:
    v_accvgpr_read_b32 v252, a238
    v_accvgpr_read_b32 v253, a239
    v_cvt_pk_bf16_f32 v184, v246, v247
    v_cvt_pk_bf16_f32 v185, v248, v249
    v_cvt_pk_bf16_f32 v186, v250, v251
    v_cvt_pk_bf16_f32 v187, v252, v253
    v_accvgpr_read_b32 v34, a176
    v_accvgpr_read_b32 v35, a177
    v_accvgpr_read_b32 v36, a178
    v_accvgpr_read_b32 v37, a179
    v_accvgpr_read_b32 v38, a180
    v_accvgpr_read_b32 v39, a181
    v_accvgpr_read_b32 v40, a182
    v_accvgpr_read_b32 v41, a183
    v_cvt_pk_bf16_f32 v156, v34, v35
    v_cvt_pk_bf16_f32 v157, v36, v37
    v_cvt_pk_bf16_f32 v158, v38, v39
    v_cvt_pk_bf16_f32 v159, v40, v41
    v_accvgpr_read_b32 v246, a240
    v_accvgpr_read_b32 v247, a241
    v_accvgpr_read_b32 v248, a242
    v_accvgpr_read_b32 v249, a243
    v_accvgpr_read_b32 v250, a244
    v_accvgpr_read_b32 v251, a245
    v_accvgpr_read_b32 v252, a246
    v_accvgpr_read_b32 v253, a247
    v_cvt_pk_bf16_f32 v188, v246, v247
    v_cvt_pk_bf16_f32 v189, v248, v249
    v_cvt_pk_bf16_f32 v190, v250, v251
    v_cvt_pk_bf16_f32 v191, v252, v253
    v_accvgpr_read_b32 v34, a184
    v_accvgpr_read_b32 v35, a185
    v_accvgpr_read_b32 v36, a186
    v_accvgpr_read_b32 v37, a187
    v_accvgpr_read_b32 v38, a188
    v_accvgpr_read_b32 v39, a189
    v_accvgpr_read_b32 v40, a190
    v_accvgpr_read_b32 v41, a191
    v_cvt_pk_bf16_f32 v160, v34, v35
    v_cvt_pk_bf16_f32 v161, v36, v37
    v_cvt_pk_bf16_f32 v162, v38, v39
    v_cvt_pk_bf16_f32 v163, v40, v41
    v_accvgpr_read_b32 v246, a248
    v_accvgpr_read_b32 v247, a249
    v_accvgpr_read_b32 v248, a250
    v_accvgpr_read_b32 v249, a251
    v_accvgpr_read_b32 v250, a252
    v_accvgpr_read_b32 v251, a253
    v_accvgpr_read_b32 v252, a254
    v_accvgpr_read_b32 v253, a255
    v_cvt_pk_bf16_f32 v192, v246, v247
    v_cvt_pk_bf16_f32 v193, v248, v249
    v_cvt_pk_bf16_f32 v194, v250, v251
    v_cvt_pk_bf16_f32 v195, v252, v253
    v_cvt_pk_bf16_f32 v196, v196, v197
    v_cvt_pk_bf16_f32 v197, v198, v199
    v_cvt_pk_bf16_f32 v198, v200, v201
    v_cvt_pk_bf16_f32 v199, v202, v203
    buffer_store_dwordx4 v[196:199], v16, s[56:59], s91 offen offset:0 sc1
    s_add_u32 s91, s91, 32768
    v_cvt_pk_bf16_f32 v204, v204, v205
    v_cvt_pk_bf16_f32 v205, v206, v207
    v_cvt_pk_bf16_f32 v206, v208, v209
    v_cvt_pk_bf16_f32 v207, v210, v211
    buffer_store_dwordx4 v[204:207], v16, s[56:59], s91 offen offset:0 sc1
    s_add_u32 s91, s91, 32768
    v_cvt_pk_bf16_f32 v212, v212, v213
    v_cvt_pk_bf16_f32 v213, v214, v215
    v_cvt_pk_bf16_f32 v214, v216, v217
    v_cvt_pk_bf16_f32 v215, v218, v219
    buffer_store_dwordx4 v[212:215], v16, s[56:59], s91 offen offset:0 sc1
    s_add_u32 s91, s91, 32768
    v_cvt_pk_bf16_f32 v220, v220, v221
    v_cvt_pk_bf16_f32 v221, v222, v223
    v_cvt_pk_bf16_f32 v222, v224, v225
    v_cvt_pk_bf16_f32 v223, v226, v227
    buffer_store_dwordx4 v[220:223], v16, s[56:59], s91 offen offset:0 sc1
    s_add_u32 s91, s91, 32768
    s_mov_b32 s67, 0
    v_mfma_f32_16x16x32_bf16 v[196:199], v[144:147], v[180:183], 0
    v_mfma_f32_16x16x32_bf16 v[200:203], v[148:151], v[180:183], 0
    v_mfma_f32_16x16x32_bf16 v[204:207], v[148:151], v[184:187], 0
    v_mfma_f32_16x16x32_bf16 v[208:211], v[152:155], v[184:187], 0
    v_mfma_f32_16x16x32_bf16 v[212:215], v[152:155], v[188:191], 0
    v_mfma_f32_16x16x32_bf16 v[216:219], v[156:159], v[188:191], 0
    v_mfma_f32_16x16x32_bf16 v[220:223], v[156:159], v[192:195], 0
    v_mfma_f32_16x16x32_bf16 v[224:227], v[160:163], v[192:195], 0
    s_nop 0
    v_cvt_pk_bf16_f32 v196, v196, v197
    v_cvt_pk_bf16_f32 v198, v198, v199
    v_cvt_pk_bf16_f32 v200, v200, v201
    v_cvt_pk_bf16_f32 v202, v202, v203
    v_cvt_pk_bf16_f32 v204, v204, v205
    v_cvt_pk_bf16_f32 v206, v206, v207
    v_cvt_pk_bf16_f32 v208, v208, v209
    v_cvt_pk_bf16_f32 v210, v210, v211
    v_cvt_pk_bf16_f32 v212, v212, v213
    v_cvt_pk_bf16_f32 v214, v214, v215
    v_cvt_pk_bf16_f32 v216, v216, v217
    v_cvt_pk_bf16_f32 v218, v218, v219
    v_cvt_pk_bf16_f32 v220, v220, v221
    v_cvt_pk_bf16_f32 v222, v222, v223
    v_cvt_pk_bf16_f32 v224, v224, v225
    v_cvt_pk_bf16_f32 v226, v226, v227
    v_perm_b32 v228, v200, v196, v28
    v_perm_b32 v229, v202, v198, v29
    v_perm_b32 v230, v208, v204, v28
    v_perm_b32 v231, v210, v206, v29
    v_perm_b32 v232, v216, v212, v28
    v_perm_b32 v233, v218, v214, v29
    v_perm_b32 v234, v224, v220, v28
    v_perm_b32 v235, v226, v222, v29
    v_pk_mul_f32 v[228:229], v[228:229], s[14:15]
    v_pk_mul_f32 v[230:231], v[230:231], s[14:15]
    v_pk_mul_f32 v[232:233], v[232:233], s[14:15]
    v_pk_mul_f32 v[234:235], v[234:235], s[14:15]
    v_cvt_pk_bf16_f32 v229, v228, v229
    v_cvt_pk_bf16_f32 v231, v230, v231
    v_cvt_pk_bf16_f32 v233, v232, v233
    v_cvt_pk_bf16_f32 v235, v234, v235
    v_lshlrev_b32 v228, 16, v229
    v_and_b32 v229, 0xffff0000, v229
    v_lshlrev_b32 v230, 16, v231
    v_and_b32 v231, 0xffff0000, v231
    v_lshlrev_b32 v232, 16, v233
    v_and_b32 v233, 0xffff0000, v233
    v_lshlrev_b32 v234, 16, v235
    v_and_b32 v235, 0xffff0000, v235
    buffer_load_dword v43, off, s[56:59], s92 sc1
    v_max_f32 v236, v228, v229
    v_max_f32 v238, v230, v231
    v_max_f32 v240, v232, v233
    v_max_f32 v242, v234, v235
    v_permlane16_swap_b32 v236, v238
    s_nop 0
    v_permlane16_swap_b32 v240, v242
    v_max_f32 v236, v236, v238
    v_max_f32 v240, v240, v242
    s_nop 1
    v_permlane32_swap_b32 v236, v240
    v_max_f32 v236, v236, v240
    v_mul_f32 v236, 0xbfb8aa3b, v236
    v_mov_b32 v240, v236
    s_nop 1
    v_permlane32_swap_b32 v236, v240
    v_mov_b32 v238, v236
    v_mov_b32 v242, v240
    s_nop 0
    v_permlane16_swap_b32 v236, v238
    v_permlane16_swap_b32 v240, v242
    v_pk_fma_f32 v[228:229], v[228:229], s[98:99], v[236:237] op_sel_hi:[1,1,0]
    v_pk_fma_f32 v[230:231], v[230:231], s[98:99], v[238:239] op_sel_hi:[1,1,0]
    v_pk_fma_f32 v[232:233], v[232:233], s[98:99], v[240:241] op_sel_hi:[1,1,0]
    v_pk_fma_f32 v[234:235], v[234:235], s[98:99], v[242:243] op_sel_hi:[1,1,0]
    v_exp_f32 v228, v228
    v_exp_f32 v229, v229
    v_exp_f32 v230, v230
    v_exp_f32 v231, v231
    v_exp_f32 v232, v232
    v_exp_f32 v233, v233
    v_exp_f32 v234, v234
    v_exp_f32 v235, v235
    v_add_f32 v236, v228, v229
    v_add_f32 v238, v230, v231
    v_add_f32 v240, v232, v233
    v_add_f32 v242, v234, v235
    v_permlane16_swap_b32 v236, v238
    s_nop 0
    v_permlane16_swap_b32 v240, v242
    v_add_f32 v236, v236, v238
    v_add_f32 v240, v240, v242
    s_nop 1
    v_permlane32_swap_b32 v236, v240
    v_add_f32 v236, v236, v240
    v_rcp_f32 v236, v236
    s_nop 0
    v_mov_b32 v240, v236
    s_nop 1
    v_permlane32_swap_b32 v236, v240
    v_mov_b32 v238, v236
    v_mov_b32 v242, v240
    s_nop 0
    v_permlane16_swap_b32 v236, v238
    v_permlane16_swap_b32 v240, v242
    v_pk_mul_f32 v[228:229], v[228:229], v[236:237] op_sel_hi:[1,0]
    v_pk_mul_f32 v[230:231], v[230:231], v[238:239] op_sel_hi:[1,0]
    v_pk_mul_f32 v[232:233], v[232:233], v[240:241] op_sel_hi:[1,0]
    v_pk_mul_f32 v[234:235], v[234:235], v[242:243] op_sel_hi:[1,0]
    v_cvt_pk_bf16_f32 v228, v228, v229
    v_cvt_pk_bf16_f32 v230, v230, v231
    v_cvt_pk_bf16_f32 v232, v232, v233
    v_cvt_pk_bf16_f32 v234, v234, v235
    v_perm_b32 v180, v228, v228, v30
    v_perm_b32 v181, v228, v228, v31
    v_perm_b32 v182, v228, v228, v32
    v_perm_b32 v183, v228, v228, v33
    v_perm_b32 v184, v230, v230, v30
    v_perm_b32 v185, v230, v230, v31
    v_perm_b32 v186, v230, v230, v32
    v_perm_b32 v187, v230, v230, v33
    v_perm_b32 v188, v232, v232, v30
    v_perm_b32 v189, v232, v232, v31
    v_perm_b32 v190, v232, v232, v32
    v_perm_b32 v191, v232, v232, v33
    v_perm_b32 v192, v234, v234, v30
    v_perm_b32 v193, v234, v234, v31
    v_perm_b32 v194, v234, v234, v32
    v_perm_b32 v195, v234, v234, v33
    v_mfma_f32_16x16x32_bf16 v[196:199], v[56:59], v[180:183], 0
    v_mfma_f32_16x16x32_bf16 v[200:203], v[92:95], v[180:183], 0
    v_mfma_f32_16x16x32_bf16 v[204:207], v[58:61], v[184:187], 0
    v_mfma_f32_16x16x32_bf16 v[208:211], v[94:97], v[184:187], 0
    v_mfma_f32_16x16x32_bf16 v[212:215], v[60:63], v[188:191], 0
    v_mfma_f32_16x16x32_bf16 v[216:219], v[96:99], v[188:191], 0
    v_mfma_f32_16x16x32_bf16 v[220:223], v[62:65], v[192:195], 0
    v_mfma_f32_16x16x32_bf16 v[224:227], v[98:101], v[192:195], 0
    s_nop 0
    v_cvt_pk_bf16_f32 v196, v196, v197
    v_cvt_pk_bf16_f32 v197, v198, v199
    v_cvt_pk_bf16_f32 v198, v200, v201
    v_cvt_pk_bf16_f32 v199, v202, v203
    buffer_store_dwordx4 v[196:199], v16, s[56:59], s91 offen offset:0 sc1
    s_add_u32 s91, s91, 32768
    v_cvt_pk_bf16_f32 v204, v204, v205
    v_cvt_pk_bf16_f32 v205, v206, v207
    v_cvt_pk_bf16_f32 v206, v208, v209
    v_cvt_pk_bf16_f32 v207, v210, v211
    buffer_store_dwordx4 v[204:207], v16, s[56:59], s91 offen offset:0 sc1
    s_add_u32 s91, s91, 32768
    v_cvt_pk_bf16_f32 v212, v212, v213
    v_cvt_pk_bf16_f32 v213, v214, v215
    v_cvt_pk_bf16_f32 v214, v216, v217
    v_cvt_pk_bf16_f32 v215, v218, v219
    buffer_store_dwordx4 v[212:215], v16, s[56:59], s91 offen offset:0 sc1
    s_add_u32 s91, s91, 32768
    v_cvt_pk_bf16_f32 v220, v220, v221
    v_cvt_pk_bf16_f32 v221, v222, v223
    v_cvt_pk_bf16_f32 v222, v224, v225
    v_cvt_pk_bf16_f32 v223, v226, v227
    buffer_store_dwordx4 v[220:223], v16, s[56:59], s91 offen offset:0 sc1
    s_add_u32 s91, s91, 32768
    s_waitcnt vmcnt(4)
    v_readfirstlane_b32 s86, v43
    s_bfe_u32 s86, s86, 0x80000
    s_cmp_eq_u32 s86, 32
    s_cbranch_scc0 L_spA0
L_okA0:
    buffer_load_dwordx4 a[0:3], v21, s[56:59], s68 offen sc1
    buffer_load_dwordx4 a[4:7], v22, s[56:59], s68 offen sc1
    buffer_load_dwordx4 a[8:11], v23, s[56:59], s68 offen sc1
    buffer_load_dwordx4 a[12:15], v24, s[56:59], s68 offen sc1
    s_add_u32 s68, s68, 16384
    buffer_load_dwordx4 a[16:19], v21, s[56:59], s68 offen sc1
    buffer_load_dwordx4 a[20:23], v22, s[56:59], s68 offen sc1
    buffer_load_dwordx4 a[24:27], v23, s[56:59], s68 offen sc1
    buffer_load_dwordx4 a[28:31], v24, s[56:59], s68 offen sc1
    s_add_u32 s68, s68, 16384
    buffer_load_dwordx4 a[32:35], v21, s[56:59], s68 offen sc1
    buffer_load_dwordx4 a[36:39], v22, s[56:59], s68 offen sc1
    buffer_load_dwordx4 a[40:43], v23, s[56:59], s68 offen sc1
    buffer_load_dwordx4 a[44:47], v24, s[56:59], s68 offen sc1
    s_add_u32 s68, s68, 16384
    buffer_load_dwordx4 a[48:51], v21, s[56:59], s68 offen sc1
    buffer_load_dwordx4 a[52:55], v22, s[56:59], s68 offen sc1
    buffer_load_dwordx4 a[56:59], v23, s[56:59], s68 offen sc1
    buffer_load_dwordx4 a[60:63], v24, s[56:59], s68 offen sc1
    s_add_u32 s68, s68, 16384
    s_barrier
    s_branch L_D
L_stub6:
    s_branch L_stub10
L_epi1:
    s_mov_b32 s67, 0
    v_accvgpr_read_b32 v128, a128
    v_accvgpr_read_b32 v129, a129
    v_accvgpr_read_b32 v130, a130
    v_accvgpr_read_b32 v131, a131
    v_accvgpr_read_b32 v132, a132
    v_accvgpr_read_b32 v133, a133
    v_accvgpr_read_b32 v134, a134
    v_accvgpr_read_b32 v135, a135
    v_accvgpr_read_b32 v136, a136
    v_accvgpr_read_b32 v137, a137
    v_accvgpr_read_b32 v138, a138
    v_accvgpr_read_b32 v139, a139
    v_accvgpr_read_b32 v140, a140
    v_accvgpr_read_b32 v141, a141
    v_accvgpr_read_b32 v142, a142
    v_accvgpr_read_b32 v143, a143
    v_pk_mul_f32 v[34:35], v[128:129], v[128:129]
    v_pk_mul_f32 v[36:37], v[130:131], v[130:131]
    v_pk_mul_f32 v[38:39], v[132:133], v[132:133]
    v_pk_mul_f32 v[40:41], v[134:135], v[134:135]
    v_pk_fma_f32 v[34:35], v[34:35], s[94:95], v[26:27]
    v_pk_fma_f32 v[36:37], v[36:37], s[94:95], v[26:27]
    v_pk_fma_f32 v[38:39], v[38:39], s[94:95], v[26:27]
    v_pk_fma_f32 v[40:41], v[40:41], s[94:95], v[26:27]
    v_pk_mul_f32 v[34:35], v[34:35], v[128:129]
    v_pk_mul_f32 v[36:37], v[36:37], v[130:131]
    v_pk_mul_f32 v[38:39], v[38:39], v[132:133]
    v_pk_mul_f32 v[40:41], v[40:41], v[134:135]
    v_exp_f32 v34, v34
    v_exp_f32 v35, v35
    v_exp_f32 v36, v36
    v_exp_f32 v37, v37
    v_exp_f32 v38, v38
    v_exp_f32 v39, v39
    v_exp_f32 v40, v40
    v_exp_f32 v41, v41
    v_pk_mul_f32 v[136:137], v[136:137], v[128:129]
    v_pk_mul_f32 v[138:139], v[138:139], v[130:131]
    v_pk_mul_f32 v[140:141], v[140:141], v[132:133]
    v_pk_mul_f32 v[142:143], v[142:143], v[134:135]
    v_pk_add_f32 v[34:35], v[34:35], 1.0 op_sel_hi:[1,0]
    v_pk_add_f32 v[36:37], v[36:37], 1.0 op_sel_hi:[1,0]
    v_pk_add_f32 v[38:39], v[38:39], 1.0 op_sel_hi:[1,0]
    v_pk_add_f32 v[40:41], v[40:41], 1.0 op_sel_hi:[1,0]
    v_rcp_f32 v34, v34
    v_rcp_f32 v35, v35
    v_rcp_f32 v36, v36
    v_rcp_f32 v37, v37
    v_rcp_f32 v38, v38
    v_rcp_f32 v39, v39
    v_rcp_f32 v40, v40
    v_rcp_f32 v41, v41
    v_pk_mul_f32 v[136:137], v[136:137], v[34:35]
    v_pk_mul_f32 v[138:139], v[138:139], v[36:37]
    v_pk_mul_f32 v[140:141], v[140:141], v[38:39]
    v_pk_mul_f32 v[142:143], v[142:143], v[40:41]
    v_cvt_pk_bf16_f32 v128, v136, v137
    v_cvt_pk_bf16_f32 v129, v138, v139
    v_cvt_pk_bf16_f32 v130, v140, v141
    v_cvt_pk_bf16_f32 v131, v142, v143
    buffer_store_dwordx4 v[128:131], v16, s[56:59], s89 offen offset:0 sc1
    s_waitcnt vmcnt(1)
    s_mov_b64 exec, 1
    buffer_atomic_add v25, off, s[56:59], s92 sc1
    s_mov_b64 exec, -1
    v_accvgpr_read_b32 v144, a144
    v_accvgpr_read_b32 v145, a145
    v_accvgpr_read_b32 v146, a146
    v_accvgpr_read_b32 v147, a147
    v_accvgpr_read_b32 v148, a148
    v_accvgpr_read_b32 v149, a149
    v_accvgpr_read_b32 v150, a150
    v_accvgpr_read_b32 v151, a151
    v_accvgpr_read_b32 v152, a152
    v_accvgpr_read_b32 v153, a153
    v_accvgpr_read_b32 v154, a154
    v_accvgpr_read_b32 v155, a155
    v_accvgpr_read_b32 v156, a156
    v_accvgpr_read_b32 v157, a157
    v_accvgpr_read_b32 v158, a158
    v_accvgpr_read_b32 v159, a159
    v_pk_mul_f32 v[34:35], v[144:145], v[144:145]
    v_pk_mul_f32 v[36:37], v[146:147], v[146:147]
    v_pk_mul_f32 v[38:39], v[148:149], v[148:149]
    v_pk_mul_f32 v[40:41], v[150:151], v[150:151]
    v_pk_fma_f32 v[34:35], v[34:35], s[94:95], v[26:27]
    v_pk_fma_f32 v[36:37], v[36:37], s[94:95], v[26:27]
    v_pk_fma_f32 v[38:39], v[38:39], s[94:95], v[26:27]
    v_pk_fma_f32 v[40:41], v[40:41], s[94:95], v[26:27]
    v_pk_mul_f32 v[34:35], v[34:35], v[144:145]
    v_pk_mul_f32 v[36:37], v[36:37], v[146:147]
    v_pk_mul_f32 v[38:39], v[38:39], v[148:149]
    v_pk_mul_f32 v[40:41], v[40:41], v[150:151]
    v_exp_f32 v34, v34
    v_exp_f32 v35, v35
    v_exp_f32 v36, v36
    v_exp_f32 v37, v37
    v_exp_f32 v38, v38
    v_exp_f32 v39, v39
    v_exp_f32 v40, v40
    v_exp_f32 v41, v41
    v_pk_mul_f32 v[152:153], v[152:153], v[144:145]
    v_pk_mul_f32 v[154:155], v[154:155], v[146:147]
    v_pk_mul_f32 v[156:157], v[156:157], v[148:149]
    v_pk_mul_f32 v[158:159], v[158:159], v[150:151]
    v_pk_add_f32 v[34:35], v[34:35], 1.0 op_sel_hi:[1,0]
    v_pk_add_f32 v[36:37], v[36:37], 1.0 op_sel_hi:[1,0]
    v_pk_add_f32 v[38:39], v[38:39], 1.0 op_sel_hi:[1,0]
    v_pk_add_f32 v[40:41], v[40:41], 1.0 op_sel_hi:[1,0]
    v_rcp_f32 v34, v34
    v_rcp_f32 v35, v35
    v_rcp_f32 v36, v36
    v_rcp_f32 v37, v37
    v_rcp_f32 v38, v38
    v_rcp_f32 v39, v39
    v_rcp_f32 v40, v40
    v_rcp_f32 v41, v41
    v_pk_mul_f32 v[152:153], v[152:153], v[34:35]
    v_pk_mul_f32 v[154:155], v[154:155], v[36:37]
    v_pk_mul_f32 v[156:157], v[156:157], v[38:39]
    v_pk_mul_f32 v[158:159], v[158:159], v[40:41]
    v_cvt_pk_bf16_f32 v144, v152, v153
    v_cvt_pk_bf16_f32 v145, v154, v155
    v_cvt_pk_bf16_f32 v146, v156, v157
    v_cvt_pk_bf16_f32 v147, v158, v159
    buffer_store_dwordx4 v[144:147], v16, s[56:59], s89 offen offset:1024 sc1
    v_accvgpr_read_b32 v160, a160
    v_accvgpr_read_b32 v161, a161
    v_accvgpr_read_b32 v162, a162
    v_accvgpr_read_b32 v163, a163
    v_accvgpr_read_b32 v164, a164
    v_accvgpr_read_b32 v165, a165
    v_accvgpr_read_b32 v166, a166
    v_accvgpr_read_b32 v167, a167
    v_accvgpr_read_b32 v168, a168
    v_accvgpr_read_b32 v169, a169
    v_accvgpr_read_b32 v170, a170
    v_accvgpr_read_b32 v171, a171
    v_accvgpr_read_b32 v172, a172
    v_accvgpr_read_b32 v173, a173
    v_accvgpr_read_b32 v174, a174
    v_accvgpr_read_b32 v175, a175
    v_pk_mul_f32 v[34:35], v[160:161], v[160:161]
    v_pk_mul_f32 v[36:37], v[162:163], v[162:163]
    v_pk_mul_f32 v[38:39], v[164:165], v[164:165]
    v_pk_mul_f32 v[40:41], v[166:167], v[166:167]
    v_pk_fma_f32 v[34:35], v[34:35], s[94:95], v[26:27]
    v_pk_fma_f32 v[36:37], v[36:37], s[94:95], v[26:27]
    v_pk_fma_f32 v[38:39], v[38:39], s[94:95], v[26:27]
    v_pk_fma_f32 v[40:41], v[40:41], s[94:95], v[26:27]
    v_pk_mul_f32 v[34:35], v[34:35], v[160:161]
    v_pk_mul_f32 v[36:37], v[36:37], v[162:163]
    v_pk_mul_f32 v[38:39], v[38:39], v[164:165]
    v_pk_mul_f32 v[40:41], v[40:41], v[166:167]
    v_exp_f32 v34, v34
    v_exp_f32 v35, v35
    v_exp_f32 v36, v36
    v_exp_f32 v37, v37
    v_exp_f32 v38, v38
    v_exp_f32 v39, v39
    v_exp_f32 v40, v40
    v_exp_f32 v41, v41
    v_pk_mul_f32 v[168:169], v[168:169], v[160:161]
    v_pk_mul_f32 v[170:171], v[170:171], v[162:163]
    v_pk_mul_f32 v[172:173], v[172:173], v[164:165]
    v_pk_mul_f32 v[174:175], v[174:175], v[166:167]
    v_pk_add_f32 v[34:35], v[34:35], 1.0 op_sel_hi:[1,0]
    v_pk_add_f32 v[36:37], v[36:37], 1.0 op_sel_hi:[1,0]
    v_pk_add_f32 v[38:39], v[38:39], 1.0 op_sel_hi:[1,0]
    v_pk_add_f32 v[40:41], v[40:41], 1.0 op_sel_hi:[1,0]
    v_rcp_f32 v34, v34
    v_rcp_f32 v35, v35
    v_rcp_f32 v36, v36
    v_rcp_f32 v37, v37
    v_rcp_f32 v38, v38
    v_rcp_f32 v39, v39
    v_rcp_f32 v40, v40
    v_rcp_f32 v41, v41
    v_pk_mul_f32 v[168:169], v[168:169], v[34:35]
    v_pk_mul_f32 v[170:171], v[170:171], v[36:37]
    v_pk_mul_f32 v[172:173], v[172:173], v[38:39]
    v_pk_mul_f32 v[174:175], v[174:175], v[40:41]
    v_cvt_pk_bf16_f32 v160, v168, v169
    v_cvt_pk_bf16_f32 v161, v170, v171
    v_cvt_pk_bf16_f32 v162, v172, v173
    v_cvt_pk_bf16_f32 v163, v174, v175
    buffer_store_dwordx4 v[160:163], v16, s[56:59], s89 offen offset:2048 sc1
    v_accvgpr_read_b32 v176, a176
    v_accvgpr_read_b32 v177, a177
    v_accvgpr_read_b32 v178, a178
    v_accvgpr_read_b32 v179, a179
    v_accvgpr_read_b32 v180, a180
    v_accvgpr_read_b32 v181, a181
    v_accvgpr_read_b32 v182, a182
    v_accvgpr_read_b32 v183, a183
    v_accvgpr_read_b32 v184, a184
    v_accvgpr_read_b32 v185, a185
    v_accvgpr_read_b32 v186, a186
    v_accvgpr_read_b32 v187, a187
    v_accvgpr_read_b32 v188, a188
    v_accvgpr_read_b32 v189, a189
    v_accvgpr_read_b32 v190, a190
    v_accvgpr_read_b32 v191, a191
    v_pk_mul_f32 v[34:35], v[176:177], v[176:177]
    v_pk_mul_f32 v[36:37], v[178:179], v[178:179]
    v_pk_mul_f32 v[38:39], v[180:181], v[180:181]
    v_pk_mul_f32 v[40:41], v[182:183], v[182:183]
    v_pk_fma_f32 v[34:35], v[34:35], s[94:95], v[26:27]
    v_pk_fma_f32 v[36:37], v[36:37], s[94:95], v[26:27]
    v_pk_fma_f32 v[38:39], v[38:39], s[94:95], v[26:27]
    v_pk_fma_f32 v[40:41], v[40:41], s[94:95], v[26:27]
    v_pk_mul_f32 v[34:35], v[34:35], v[176:177]
    v_pk_mul_f32 v[36:37], v[36:37], v[178:179]
    v_pk_mul_f32 v[38:39], v[38:39], v[180:181]
    v_pk_mul_f32 v[40:41], v[40:41], v[182:183]
    v_exp_f32 v34, v34
    v_exp_f32 v35, v35
    v_exp_f32 v36, v36
    v_exp_f32 v37, v37
    v_exp_f32 v38, v38
    v_exp_f32 v39, v39
    v_exp_f32 v40, v40
    v_exp_f32 v41, v41
    v_pk_mul_f32 v[184:185], v[184:185], v[176:177]
    v_pk_mul_f32 v[186:187], v[186:187], v[178:179]
    v_pk_mul_f32 v[188:189], v[188:189], v[180:181]
    v_pk_mul_f32 v[190:191], v[190:191], v[182:183]
    v_pk_add_f32 v[34:35], v[34:35], 1.0 op_sel_hi:[1,0]
    v_pk_add_f32 v[36:37], v[36:37], 1.0 op_sel_hi:[1,0]
    v_pk_add_f32 v[38:39], v[38:39], 1.0 op_sel_hi:[1,0]
    v_pk_add_f32 v[40:41], v[40:41], 1.0 op_sel_hi:[1,0]
    v_rcp_f32 v34, v34
    v_rcp_f32 v35, v35
    v_rcp_f32 v36, v36
    v_rcp_f32 v37, v37
    v_rcp_f32 v38, v38
    v_rcp_f32 v39, v39
    v_rcp_f32 v40, v40
    v_rcp_f32 v41, v41
    v_pk_mul_f32 v[184:185], v[184:185], v[34:35]
    v_pk_mul_f32 v[186:187], v[186:187], v[36:37]
    v_pk_mul_f32 v[188:189], v[188:189], v[38:39]
    v_pk_mul_f32 v[190:191], v[190:191], v[40:41]
    v_cvt_pk_bf16_f32 v176, v184, v185
    v_cvt_pk_bf16_f32 v177, v186, v187
    v_cvt_pk_bf16_f32 v178, v188, v189
    v_cvt_pk_bf16_f32 v179, v190, v191
    buffer_store_dwordx4 v[176:179], v16, s[56:59], s89 offen offset:3072 sc1
    v_accvgpr_read_b32 v128, a192
    v_accvgpr_read_b32 v129, a193
    v_accvgpr_read_b32 v130, a194
    v_accvgpr_read_b32 v131, a195
    v_accvgpr_read_b32 v132, a196
    v_accvgpr_read_b32 v133, a197
    v_accvgpr_read_b32 v134, a198
    v_accvgpr_read_b32 v135, a199
    v_accvgpr_read_b32 v136, a200
    v_accvgpr_read_b32 v137, a201
    v_accvgpr_read_b32 v138, a202
    v_accvgpr_read_b32 v139, a203
    v_accvgpr_read_b32 v140, a204
    v_accvgpr_read_b32 v141, a205
    v_accvgpr_read_b32 v142, a206
    v_accvgpr_read_b32 v143, a207
    v_pk_mul_f32 v[34:35], v[128:129], v[128:129]
    v_pk_mul_f32 v[36:37], v[130:131], v[130:131]
    v_pk_mul_f32 v[38:39], v[132:133], v[132:133]
    v_pk_mul_f32 v[40:41], v[134:135], v[134:135]
    v_pk_fma_f32 v[34:35], v[34:35], s[94:95], v[26:27]
    v_pk_fma_f32 v[36:37], v[36:37], s[94:95], v[26:27]
    v_pk_fma_f32 v[38:39], v[38:39], s[94:95], v[26:27]
    v_pk_fma_f32 v[40:41], v[40:41], s[94:95], v[26:27]
    v_pk_mul_f32 v[34:35], v[34:35], v[128:129]
    v_pk_mul_f32 v[36:37], v[36:37], v[130:131]
    v_pk_mul_f32 v[38:39], v[38:39], v[132:133]
    v_pk_mul_f32 v[40:41], v[40:41], v[134:135]
    v_exp_f32 v34, v34
    v_exp_f32 v35, v35
    v_exp_f32 v36, v36
    v_exp_f32 v37, v37
    v_exp_f32 v38, v38
    v_exp_f32 v39, v39
    v_exp_f32 v40, v40
    v_exp_f32 v41, v41
    v_pk_mul_f32 v[136:137], v[136:137], v[128:129]
    v_pk_mul_f32 v[138:139], v[138:139], v[130:131]
    v_pk_mul_f32 v[140:141], v[140:141], v[132:133]
    v_pk_mul_f32 v[142:143], v[142:143], v[134:135]
    v_pk_add_f32 v[34:35], v[34:35], 1.0 op_sel_hi:[1,0]
    v_pk_add_f32 v[36:37], v[36:37], 1.0 op_sel_hi:[1,0]
    v_pk_add_f32 v[38:39], v[38:39], 1.0 op_sel_hi:[1,0]
    v_pk_add_f32 v[40:41], v[40:41], 1.0 op_sel_hi:[1,0]
    v_rcp_f32 v34, v34
    v_rcp_f32 v35, v35
    v_rcp_f32 v36, v36
    v_rcp_f32 v37, v37
    v_rcp_f32 v38, v38
    v_rcp_f32 v39, v39
    v_rcp_f32 v40, v40
    v_rcp_f32 v41, v41
    v_pk_mul_f32 v[136:137], v[136:137], v[34:35]
    v_pk_mul_f32 v[138:139], v[138:139], v[36:37]
    v_pk_mul_f32 v[140:141], v[140:141], v[38:39]
    v_pk_mul_f32 v[142:143], v[142:143], v[40:41]
    v_cvt_pk_bf16_f32 v128, v136, v137
    v_cvt_pk_bf16_f32 v129, v138, v139
    v_cvt_pk_bf16_f32 v130, v140, v141
    v_cvt_pk_bf16_f32 v131, v142, v143
    s_add_u32 s89, s89, 4096
    buffer_store_dwordx4 v[128:131], v16, s[56:59], s89 offen offset:0 sc1
    v_accvgpr_read_b32 v144, a208
    v_accvgpr_read_b32 v145, a209
    v_accvgpr_read_b32 v146, a210
    v_accvgpr_read_b32 v147, a211
    v_accvgpr_read_b32 v148, a212
    s_branch L_over7
L_stub7:
    s_branch L_stub11
L_over7:
    v_accvgpr_read_b32 v149, a213
    v_accvgpr_read_b32 v150, a214
    v_accvgpr_read_b32 v151, a215
    v_accvgpr_read_b32 v152, a216
    v_accvgpr_read_b32 v153, a217
    v_accvgpr_read_b32 v154, a218
    v_accvgpr_read_b32 v155, a219
    v_accvgpr_read_b32 v156, a220
    v_accvgpr_read_b32 v157, a221
    v_accvgpr_read_b32 v158, a222
    v_accvgpr_read_b32 v159, a223
    v_pk_mul_f32 v[34:35], v[144:145], v[144:145]
    v_pk_mul_f32 v[36:37], v[146:147], v[146:147]
    v_pk_mul_f32 v[38:39], v[148:149], v[148:149]
    v_pk_mul_f32 v[40:41], v[150:151], v[150:151]
    v_pk_fma_f32 v[34:35], v[34:35], s[94:95], v[26:27]
    v_pk_fma_f32 v[36:37], v[36:37], s[94:95], v[26:27]
    v_pk_fma_f32 v[38:39], v[38:39], s[94:95], v[26:27]
    v_pk_fma_f32 v[40:41], v[40:41], s[94:95], v[26:27]
    v_pk_mul_f32 v[34:35], v[34:35], v[144:145]
    v_pk_mul_f32 v[36:37], v[36:37], v[146:147]
    v_pk_mul_f32 v[38:39], v[38:39], v[148:149]
    v_pk_mul_f32 v[40:41], v[40:41], v[150:151]
    v_exp_f32 v34, v34
    v_exp_f32 v35, v35
    v_exp_f32 v36, v36
    v_exp_f32 v37, v37
    v_exp_f32 v38, v38
    v_exp_f32 v39, v39
    v_exp_f32 v40, v40
    v_exp_f32 v41, v41
    v_pk_mul_f32 v[152:153], v[152:153], v[144:145]
    v_pk_mul_f32 v[154:155], v[154:155], v[146:147]
    v_pk_mul_f32 v[156:157], v[156:157], v[148:149]
    v_pk_mul_f32 v[158:159], v[158:159], v[150:151]
    v_pk_add_f32 v[34:35], v[34:35], 1.0 op_sel_hi:[1,0]
    v_pk_add_f32 v[36:37], v[36:37], 1.0 op_sel_hi:[1,0]
    v_pk_add_f32 v[38:39], v[38:39], 1.0 op_sel_hi:[1,0]
    v_pk_add_f32 v[40:41], v[40:41], 1.0 op_sel_hi:[1,0]
    v_rcp_f32 v34, v34
    v_rcp_f32 v35, v35
    v_rcp_f32 v36, v36
    v_rcp_f32 v37, v37
    v_rcp_f32 v38, v38
    v_rcp_f32 v39, v39
    v_rcp_f32 v40, v40
    v_rcp_f32 v41, v41
    v_pk_mul_f32 v[152:153], v[152:153], v[34:35]
    v_pk_mul_f32 v[154:155], v[154:155], v[36:37]
    v_pk_mul_f32 v[156:157], v[156:157], v[38:39]
    v_pk_mul_f32 v[158:159], v[158:159], v[40:41]
    v_cvt_pk_bf16_f32 v144, v152, v153
    v_cvt_pk_bf16_f32 v145, v154, v155
    v_cvt_pk_bf16_f32 v146, v156, v157
    v_cvt_pk_bf16_f32 v147, v158, v159
    buffer_store_dwordx4 v[144:147], v16, s[56:59], s89 offen offset:1024 sc1
    v_accvgpr_read_b32 v160, a224
    v_accvgpr_read_b32 v161, a225
    v_accvgpr_read_b32 v162, a226
    v_accvgpr_read_b32 v163, a227
    v_accvgpr_read_b32 v164, a228
    v_accvgpr_read_b32 v165, a229
    v_accvgpr_read_b32 v166, a230
    v_accvgpr_read_b32 v167, a231
    v_accvgpr_read_b32 v168, a232
    v_accvgpr_read_b32 v169, a233
    v_accvgpr_read_b32 v170, a234
    v_accvgpr_read_b32 v171, a235
    v_accvgpr_read_b32 v172, a236
    v_accvgpr_read_b32 v173, a237
    v_accvgpr_read_b32 v174, a238
    v_accvgpr_read_b32 v175, a239
    v_pk_mul_f32 v[34:35], v[160:161], v[160:161]
    v_pk_mul_f32 v[36:37], v[162:163], v[162:163]
    v_pk_mul_f32 v[38:39], v[164:165], v[164:165]
    v_pk_mul_f32 v[40:41], v[166:167], v[166:167]
    v_pk_fma_f32 v[34:35], v[34:35], s[94:95], v[26:27]
    v_pk_fma_f32 v[36:37], v[36:37], s[94:95], v[26:27]
    v_pk_fma_f32 v[38:39], v[38:39], s[94:95], v[26:27]
    v_pk_fma_f32 v[40:41], v[40:41], s[94:95], v[26:27]
    v_pk_mul_f32 v[34:35], v[34:35], v[160:161]
    v_pk_mul_f32 v[36:37], v[36:37], v[162:163]
    v_pk_mul_f32 v[38:39], v[38:39], v[164:165]
    v_pk_mul_f32 v[40:41], v[40:41], v[166:167]
    v_exp_f32 v34, v34
    v_exp_f32 v35, v35
    v_exp_f32 v36, v36
    v_exp_f32 v37, v37
    v_exp_f32 v38, v38
    v_exp_f32 v39, v39
    v_exp_f32 v40, v40
    v_exp_f32 v41, v41
    v_pk_mul_f32 v[168:169], v[168:169], v[160:161]
    v_pk_mul_f32 v[170:171], v[170:171], v[162:163]
    v_pk_mul_f32 v[172:173], v[172:173], v[164:165]
    v_pk_mul_f32 v[174:175], v[174:175], v[166:167]
    v_pk_add_f32 v[34:35], v[34:35], 1.0 op_sel_hi:[1,0]
    v_pk_add_f32 v[36:37], v[36:37], 1.0 op_sel_hi:[1,0]
    v_pk_add_f32 v[38:39], v[38:39], 1.0 op_sel_hi:[1,0]
    v_pk_add_f32 v[40:41], v[40:41], 1.0 op_sel_hi:[1,0]
    v_rcp_f32 v34, v34
    v_rcp_f32 v35, v35
    v_rcp_f32 v36, v36
    v_rcp_f32 v37, v37
    v_rcp_f32 v38, v38
    v_rcp_f32 v39, v39
    v_rcp_f32 v40, v40
    v_rcp_f32 v41, v41
    v_pk_mul_f32 v[168:169], v[168:169], v[34:35]
    v_pk_mul_f32 v[170:171], v[170:171], v[36:37]
    v_pk_mul_f32 v[172:173], v[172:173], v[38:39]
    v_pk_mul_f32 v[174:175], v[174:175], v[40:41]
    v_cvt_pk_bf16_f32 v160, v168, v169
    v_cvt_pk_bf16_f32 v161, v170, v171
    v_cvt_pk_bf16_f32 v162, v172, v173
    v_cvt_pk_bf16_f32 v163, v174, v175
    buffer_store_dwordx4 v[160:163], v16, s[56:59], s89 offen offset:2048 sc1
    buffer_load_dword v43, off, s[56:59], s92 sc1
    v_accvgpr_read_b32 v176, a240
    v_accvgpr_read_b32 v177, a241
    v_accvgpr_read_b32 v178, a242
    v_accvgpr_read_b32 v179, a243
    v_accvgpr_read_b32 v180, a244
    v_accvgpr_read_b32 v181, a245
    v_accvgpr_read_b32 v182, a246
    v_accvgpr_read_b32 v183, a247
    v_accvgpr_read_b32 v184, a248
    v_accvgpr_read_b32 v185, a249
    v_accvgpr_read_b32 v186, a250
    v_accvgpr_read_b32 v187, a251
    v_accvgpr_read_b32 v188, a252
    v_accvgpr_read_b32 v189, a253
    v_accvgpr_read_b32 v190, a254
    v_accvgpr_read_b32 v191, a255
    v_pk_mul_f32 v[34:35], v[176:177], v[176:177]
    v_pk_mul_f32 v[36:37], v[178:179], v[178:179]
    v_pk_mul_f32 v[38:39], v[180:181], v[180:181]
    v_pk_mul_f32 v[40:41], v[182:183], v[182:183]
    v_pk_fma_f32 v[34:35], v[34:35], s[94:95], v[26:27]
    v_pk_fma_f32 v[36:37], v[36:37], s[94:95], v[26:27]
    v_pk_fma_f32 v[38:39], v[38:39], s[94:95], v[26:27]
    v_pk_fma_f32 v[40:41], v[40:41], s[94:95], v[26:27]
    v_pk_mul_f32 v[34:35], v[34:35], v[176:177]
    v_pk_mul_f32 v[36:37], v[36:37], v[178:179]
    v_pk_mul_f32 v[38:39], v[38:39], v[180:181]
    v_pk_mul_f32 v[40:41], v[40:41], v[182:183]
    v_exp_f32 v34, v34
    v_exp_f32 v35, v35
    v_exp_f32 v36, v36
    v_exp_f32 v37, v37
    v_exp_f32 v38, v38
    v_exp_f32 v39, v39
    v_exp_f32 v40, v40
    v_exp_f32 v41, v41
    v_pk_mul_f32 v[184:185], v[184:185], v[176:177]
    v_pk_mul_f32 v[186:187], v[186:187], v[178:179]
    v_pk_mul_f32 v[188:189], v[188:189], v[180:181]
    v_pk_mul_f32 v[190:191], v[190:191], v[182:183]
    v_pk_add_f32 v[34:35], v[34:35], 1.0 op_sel_hi:[1,0]
    v_pk_add_f32 v[36:37], v[36:37], 1.0 op_sel_hi:[1,0]
    v_pk_add_f32 v[38:39], v[38:39], 1.0 op_sel_hi:[1,0]
    v_pk_add_f32 v[40:41], v[40:41], 1.0 op_sel_hi:[1,0]
    v_rcp_f32 v34, v34
    v_rcp_f32 v35, v35
    v_rcp_f32 v36, v36
    v_rcp_f32 v37, v37
    v_rcp_f32 v38, v38
    v_rcp_f32 v39, v39
    v_rcp_f32 v40, v40
    v_rcp_f32 v41, v41
    v_pk_mul_f32 v[184:185], v[184:185], v[34:35]
    v_pk_mul_f32 v[186:187], v[186:187], v[36:37]
    v_pk_mul_f32 v[188:189], v[188:189], v[38:39]
    v_pk_mul_f32 v[190:191], v[190:191], v[40:41]
    v_cvt_pk_bf16_f32 v176, v184, v185
    v_cvt_pk_bf16_f32 v177, v186, v187
    v_cvt_pk_bf16_f32 v178, v188, v189
    v_cvt_pk_bf16_f32 v179, v190, v191
    buffer_store_dwordx4 v[176:179], v16, s[56:59], s89 offen offset:3072 sc1
    s_waitcnt vmcnt(1)
    v_readfirstlane_b32 s86, v43
    s_bfe_u32 s86, s86, 0x80000
    s_cmp_eq_u32 s86, 32
    s_cbranch_scc0 L_spA1
L_okA1:
    s_waitcnt lgkmcnt(1)
    v_pk_mul_f32 v[34:35], v[48:49], v[48:49]
    buffer_load_dwordx4 a[0:3], v21, s[56:59], s68 offen sc1
    v_pk_mul_f32 v[36:37], v[50:51], v[50:51]
    v_pk_mul_f32 v[38:39], v[52:53], v[52:53]
    v_pk_mul_f32 v[40:41], v[54:55], v[54:55]
    v_pk_fma_f32 v[34:35], v[34:35], s[94:95], v[26:27]
    v_pk_fma_f32 v[36:37], v[36:37], s[94:95], v[26:27]
    v_pk_fma_f32 v[38:39], v[38:39], s[94:95], v[26:27]
    v_pk_fma_f32 v[40:41], v[40:41], s[94:95], v[26:27]
    v_pk_mul_f32 v[34:35], v[34:35], v[48:49]
    buffer_load_dwordx4 a[4:7], v22, s[56:59], s68 offen sc1
    v_pk_mul_f32 v[36:37], v[36:37], v[50:51]
    v_pk_mul_f32 v[38:39], v[38:39], v[52:53]
    v_pk_mul_f32 v[40:41], v[40:41], v[54:55]
    v_exp_f32 v34, v34
    v_exp_f32 v35, v35
    v_exp_f32 v36, v36
    v_exp_f32 v37, v37
    v_exp_f32 v38, v38
    buffer_load_dwordx4 a[8:11], v23, s[56:59], s68 offen sc1
    v_exp_f32 v39, v39
    v_exp_f32 v40, v40
    v_exp_f32 v41, v41
    v_pk_mul_f32 v[56:57], v[56:57], v[48:49]
    v_pk_mul_f32 v[58:59], v[58:59], v[50:51]
    v_pk_mul_f32 v[60:61], v[60:61], v[52:53]
    v_pk_mul_f32 v[62:63], v[62:63], v[54:55]
    v_pk_add_f32 v[34:35], v[34:35], 1.0 op_sel_hi:[1,0]
    buffer_load_dwordx4 a[12:15], v24, s[56:59], s68 offen sc1
    v_pk_add_f32 v[36:37], v[36:37], 1.0 op_sel_hi:[1,0]
    v_pk_add_f32 v[38:39], v[38:39], 1.0 op_sel_hi:[1,0]
    v_pk_add_f32 v[40:41], v[40:41], 1.0 op_sel_hi:[1,0]
    v_rcp_f32 v34, v34
    v_rcp_f32 v35, v35
    v_rcp_f32 v36, v36
    v_rcp_f32 v37, v37
    v_rcp_f32 v38, v38
    s_add_u32 s68, s68, 16384
    v_rcp_f32 v39, v39
    v_rcp_f32 v40, v40
    v_rcp_f32 v41, v41
    v_pk_mul_f32 v[56:57], v[56:57], v[34:35]
    v_pk_mul_f32 v[58:59], v[58:59], v[36:37]
    v_pk_mul_f32 v[60:61], v[60:61], v[38:39]
    v_pk_mul_f32 v[62:63], v[62:63], v[40:41]
    v_cvt_pk_bf16_f32 v48, v56, v57
    v_cvt_pk_bf16_f32 v49, v58, v59
    v_cvt_pk_bf16_f32 v50, v60, v61
    v_cvt_pk_bf16_f32 v51, v62, v63
    s_nop 0
    v_permlane16_swap_b32 v48, v50
    v_permlane16_swap_b32 v49, v51
    buffer_store_dwordx4 v[48:51], v28, s[56:59], s90 offen offset:0 sc1
    v_pk_mul_f32 v[34:35], v[64:65], v[64:65]
    buffer_load_dwordx4 a[16:19], v21, s[56:59], s68 offen sc1
    v_pk_mul_f32 v[36:37], v[66:67], v[66:67]
    v_pk_mul_f32 v[38:39], v[68:69], v[68:69]
    v_pk_mul_f32 v[40:41], v[70:71], v[70:71]
    v_pk_fma_f32 v[34:35], v[34:35], s[94:95], v[26:27]
    v_pk_fma_f32 v[36:37], v[36:37], s[94:95], v[26:27]
    v_pk_fma_f32 v[38:39], v[38:39], s[94:95], v[26:27]
    v_pk_fma_f32 v[40:41], v[40:41], s[94:95], v[26:27]
    v_pk_mul_f32 v[34:35], v[34:35], v[64:65]
    buffer_load_dwordx4 a[20:23], v22, s[56:59], s68 offen sc1
    v_pk_mul_f32 v[36:37], v[36:37], v[66:67]
    v_pk_mul_f32 v[38:39], v[38:39], v[68:69]
    v_pk_mul_f32 v[40:41], v[40:41], v[70:71]
    v_exp_f32 v34, v34
    v_exp_f32 v35, v35
    v_exp_f32 v36, v36
    v_exp_f32 v37, v37
    v_exp_f32 v38, v38
    buffer_load_dwordx4 a[24:27], v23, s[56:59], s68 offen sc1
    v_exp_f32 v39, v39
    v_exp_f32 v40, v40
    v_exp_f32 v41, v41
    v_pk_mul_f32 v[72:73], v[72:73], v[64:65]
    v_pk_mul_f32 v[74:75], v[74:75], v[66:67]
    v_pk_mul_f32 v[76:77], v[76:77], v[68:69]
    v_pk_mul_f32 v[78:79], v[78:79], v[70:71]
    v_pk_add_f32 v[34:35], v[34:35], 1.0 op_sel_hi:[1,0]
    buffer_load_dwordx4 a[28:31], v24, s[56:59], s68 offen sc1
    v_pk_add_f32 v[36:37], v[36:37], 1.0 op_sel_hi:[1,0]
    v_pk_add_f32 v[38:39], v[38:39], 1.0 op_sel_hi:[1,0]
    v_pk_add_f32 v[40:41], v[40:41], 1.0 op_sel_hi:[1,0]
    v_rcp_f32 v34, v34
    v_rcp_f32 v35, v35
    v_rcp_f32 v36, v36
    v_rcp_f32 v37, v37
    v_rcp_f32 v38, v38
    s_add_u32 s68, s68, 16384
    v_rcp_f32 v39, v39
    v_rcp_f32 v40, v40
    v_rcp_f32 v41, v41
    v_pk_mul_f32 v[72:73], v[72:73], v[34:35]
    v_pk_mul_f32 v[74:75], v[74:75], v[36:37]
    v_pk_mul_f32 v[76:77], v[76:77], v[38:39]
    v_pk_mul_f32 v[78:79], v[78:79], v[40:41]
    v_cvt_pk_bf16_f32 v64, v72, v73
    v_cvt_pk_bf16_f32 v65, v74, v75
    v_cvt_pk_bf16_f32 v66, v76, v77
    v_cvt_pk_bf16_f32 v67, v78, v79
    s_nop 0
    v_permlane16_swap_b32 v64, v66
    v_permlane16_swap_b32 v65, v67
    buffer_store_dwordx4 v[64:67], v28, s[56:59], s90 offen offset:2048 sc1
    s_waitcnt vmcnt(10)
    s_mov_b64 exec, 1
    buffer_atomic_add v29, off, s[56:59], s92 sc1
    s_mov_b64 exec, -1
    v_pk_mul_f32 v[34:35], v[80:81], v[80:81]
    buffer_load_dwordx4 a[32:35], v21, s[56:59], s68 offen sc1
    v_pk_mul_f32 v[36:37], v[82:83], v[82:83]
    s_waitcnt lgkmcnt(0)
    v_pk_mul_f32 v[38:39], v[84:85], v[84:85]
    v_pk_mul_f32 v[40:41], v[86:87], v[86:87]
    v_pk_fma_f32 v[34:35], v[34:35], s[94:95], v[26:27]
    v_pk_fma_f32 v[36:37], v[36:37], s[94:95], v[26:27]
    v_pk_fma_f32 v[38:39], v[38:39], s[94:95], v[26:27]
    v_pk_fma_f32 v[40:41], v[40:41], s[94:95], v[26:27]
    v_pk_mul_f32 v[34:35], v[34:35], v[80:81]
    buffer_load_dwordx4 a[36:39], v22, s[56:59], s68 offen sc1
    v_pk_mul_f32 v[36:37], v[36:37], v[82:83]
    v_pk_mul_f32 v[38:39], v[38:39], v[84:85]
    v_pk_mul_f32 v[40:41], v[40:41], v[86:87]
    v_exp_f32 v34, v34
    v_exp_f32 v35, v35
    v_exp_f32 v36, v36
    v_exp_f32 v37, v37
    v_exp_f32 v38, v38
    buffer_load_dwordx4 a[40:43], v23, s[56:59], s68 offen sc1
    v_exp_f32 v39, v39
    v_exp_f32 v40, v40
    v_exp_f32 v41, v41
    v_pk_mul_f32 v[88:89], v[88:89], v[80:81]
    v_pk_mul_f32 v[90:91], v[90:91], v[82:83]
    v_pk_mul_f32 v[92:93], v[92:93], v[84:85]
    v_pk_mul_f32 v[94:95], v[94:95], v[86:87]
    v_pk_add_f32 v[34:35], v[34:35], 1.0 op_sel_hi:[1,0]
    buffer_load_dwordx4 a[44:47], v24, s[56:59], s68 offen sc1
    v_pk_add_f32 v[36:37], v[36:37], 1.0 op_sel_hi:[1,0]
    v_pk_add_f32 v[38:39], v[38:39], 1.0 op_sel_hi:[1,0]
    v_pk_add_f32 v[40:41], v[40:41], 1.0 op_sel_hi:[1,0]
    v_rcp_f32 v34, v34
    v_rcp_f32 v35, v35
    v_rcp_f32 v36, v36
    v_rcp_f32 v37, v37
    v_rcp_f32 v38, v38
    s_add_u32 s68, s68, 16384
    v_rcp_f32 v39, v39
    v_rcp_f32 v40, v40
    v_rcp_f32 v41, v41
    v_pk_mul_f32 v[88:89], v[88:89], v[34:35]
    v_pk_mul_f32 v[90:91], v[90:91], v[36:37]
    v_pk_mul_f32 v[92:93], v[92:93], v[38:39]
    v_pk_mul_f32 v[94:95], v[94:95], v[40:41]
    v_cvt_pk_bf16_f32 v80, v88, v89
    v_cvt_pk_bf16_f32 v81, v90, v91
    v_cvt_pk_bf16_f32 v82, v92, v93
    v_cvt_pk_bf16_f32 v83, v94, v95
    s_nop 0
    v_permlane16_swap_b32 v80, v82
    v_permlane16_swap_b32 v81, v83
    s_add_u32 s90, s90, 4096
    buffer_store_dwordx4 v[80:83], v28, s[56:59], s90 offen offset:0 sc1
    v_pk_mul_f32 v[34:35], v[96:97], v[96:97]
    buffer_load_dwordx4 a[48:51], v21, s[56:59], s68 offen sc1
    v_pk_mul_f32 v[36:37], v[98:99], v[98:99]
    v_pk_mul_f32 v[38:39], v[100:101], v[100:101]
    v_pk_mul_f32 v[40:41], v[102:103], v[102:103]
    v_pk_fma_f32 v[34:35], v[34:35], s[94:95], v[26:27]
    v_pk_fma_f32 v[36:37], v[36:37], s[94:95], v[26:27]
    v_pk_fma_f32 v[38:39], v[38:39], s[94:95], v[26:27]
    v_pk_fma_f32 v[40:41], v[40:41], s[94:95], v[26:27]
    v_pk_mul_f32 v[34:35], v[34:35], v[96:97]
    buffer_load_dwordx4 a[52:55], v22, s[56:59], s68 offen sc1
    v_pk_mul_f32 v[36:37], v[36:37], v[98:99]
    v_pk_mul_f32 v[38:39], v[38:39], v[100:101]
    v_pk_mul_f32 v[40:41], v[40:41], v[102:103]
    v_exp_f32 v34, v34
    v_exp_f32 v35, v35
    v_exp_f32 v36, v36
    v_exp_f32 v37, v37
    v_exp_f32 v38, v38
    buffer_load_dwordx4 a[56:59], v23, s[56:59], s68 offen sc1
    v_exp_f32 v39, v39
    v_exp_f32 v40, v40
    v_exp_f32 v41, v41
    v_pk_mul_f32 v[104:105], v[104:105], v[96:97]
    v_pk_mul_f32 v[106:107], v[106:107], v[98:99]
    v_pk_mul_f32 v[108:109], v[108:109], v[100:101]
    v_pk_mul_f32 v[110:111], v[110:111], v[102:103]
    v_pk_add_f32 v[34:35], v[34:35], 1.0 op_sel_hi:[1,0]
    buffer_load_dwordx4 a[60:63], v24, s[56:59], s68 offen sc1
    v_pk_add_f32 v[36:37], v[36:37], 1.0 op_sel_hi:[1,0]
    v_pk_add_f32 v[38:39], v[38:39], 1.0 op_sel_hi:[1,0]
    v_pk_add_f32 v[40:41], v[40:41], 1.0 op_sel_hi:[1,0]
    v_rcp_f32 v34, v34
    v_rcp_f32 v35, v35
    v_rcp_f32 v36, v36
    v_rcp_f32 v37, v37
    v_rcp_f32 v38, v38
    s_add_u32 s68, s68, 16384
    v_rcp_f32 v39, v39
    v_rcp_f32 v40, v40
    v_rcp_f32 v41, v41
    v_pk_mul_f32 v[104:105], v[104:105], v[34:35]
    v_pk_mul_f32 v[106:107], v[106:107], v[36:37]
    v_pk_mul_f32 v[108:109], v[108:109], v[38:39]
    v_pk_mul_f32 v[110:111], v[110:111], v[40:41]
    v_cvt_pk_bf16_f32 v96, v104, v105
    v_cvt_pk_bf16_f32 v97, v106, v107
    v_cvt_pk_bf16_f32 v98, v108, v109
    v_cvt_pk_bf16_f32 v99, v110, v111
    s_nop 0
    v_permlane16_swap_b32 v96, v98
    v_permlane16_swap_b32 v97, v99
    buffer_store_dwordx4 v[96:99], v28, s[56:59], s90 offen offset:2048 sc1
    s_barrier
L_D:
    ds_read_b64_tr_b16 a[128:129], v8 offset:0
    ds_read_b64_tr_b16 a[130:131], v8 offset:4096
    ds_read_b64_tr_b16 a[132:133], v9 offset:0
    ds_read_b64_tr_b16 a[134:135], v9 offset:4096
    ds_read_b64_tr_b16 a[136:137], v10 offset:0
    ds_read_b64_tr_b16 a[138:139], v10 offset:4096
    ds_read_b64_tr_b16 a[140:141], v11 offset:0
    ds_read_b64_tr_b16 a[142:143], v11 offset:4096
    ds_read_b64_tr_b16 a[144:145], v12 offset:0
    ds_read_b64_tr_b16 a[146:147], v12 offset:4096
    ds_read_b64_tr_b16 a[148:149], v13 offset:0
    ds_read_b64_tr_b16 a[150:151], v13 offset:4096
    ds_read_b64_tr_b16 a[152:153], v14 offset:0
    ds_read_b64_tr_b16 a[154:155], v14 offset:4096
    ds_read_b64_tr_b16 a[156:157], v15 offset:0
    ds_read_b64_tr_b16 a[158:159], v15 offset:4096
    s_waitcnt vmcnt(15) lgkmcnt(14)
    v_mfma_f32_16x16x32_bf16 v[128:131], a[128:131], a[0:3], 0
    buffer_load_dwordx4 a[64:67], v21, s[56:59], s68 offen sc1
    s_waitcnt vmcnt(15)
    v_mfma_f32_16x16x32_bf16 v[160:163], a[128:131], a[4:7], 0
    ds_read_b64_tr_b16 a[160:161], v8 offset:8192
    s_waitcnt vmcnt(14)
    v_mfma_f32_16x16x32_bf16 v[192:195], a[128:131], a[8:11], 0
    ds_read_b64_tr_b16 a[162:163], v8 offset:12288
    s_waitcnt vmcnt(13)
    v_mfma_f32_16x16x32_bf16 v[224:227], a[128:131], a[12:15], 0
    buffer_load_dwordx4 a[68:71], v22, s[56:59], s68 offen sc1
    s_waitcnt lgkmcnt(14)
    v_mfma_f32_16x16x32_bf16 v[132:135], a[132:135], a[0:3], 0
    ds_read_b64_tr_b16 a[164:165], v9 offset:8192
    v_accvgpr_read_b32 v64, a112
    v_mfma_f32_16x16x32_bf16 v[164:167], a[132:135], a[4:7], 0
    ds_read_b64_tr_b16 a[166:167], v9 offset:12288
    v_accvgpr_read_b32 v65, a113
    v_mfma_f32_16x16x32_bf16 v[196:199], a[132:135], a[8:11], 0
    buffer_load_dwordx4 a[72:75], v23, s[56:59], s68 offen sc1
    v_mfma_f32_16x16x32_bf16 v[228:231], a[132:135], a[12:15], 0
    ds_read_b64_tr_b16 a[168:169], v10 offset:8192
    v_accvgpr_read_b32 v66, a114
    s_waitcnt lgkmcnt(15)
    v_mfma_f32_16x16x32_bf16 v[136:139], a[136:139], a[0:3], 0
    ds_read_b64_tr_b16 a[170:171], v10 offset:12288
    v_accvgpr_read_b32 v67, a115
    v_mfma_f32_16x16x32_bf16 v[168:171], a[136:139], a[4:7], 0
    buffer_load_dwordx4 a[76:79], v24, s[56:59], s68 offen sc1
    v_mfma_f32_16x16x32_bf16 v[200:203], a[136:139], a[8:11], 0
    ds_read_b64_tr_b16 a[172:173], v11 offset:8192
    v_accvgpr_read_b32 v68, a116
    v_mfma_f32_16x16x32_bf16 v[232:235], a[136:139], a[12:15], 0
    ds_read_b64_tr_b16 a[174:175], v11 offset:12288
    v_accvgpr_read_b32 v69, a117
    s_waitcnt lgkmcnt(15)
    v_mfma_f32_16x16x32_bf16 v[140:143], a[140:143], a[0:3], 0
    s_add_u32 s68, s68, 16384
    v_mfma_f32_16x16x32_bf16 v[172:175], a[140:143], a[4:7], 0
    ds_read_b64_tr_b16 a[176:177], v12 offset:8192
    v_accvgpr_read_b32 v70, a118
    v_mfma_f32_16x16x32_bf16 v[204:207], a[140:143], a[8:11], 0
    ds_read_b64_tr_b16 a[178:179], v12 offset:12288
    v_accvgpr_read_b32 v71, a119
    v_mfma_f32_16x16x32_bf16 v[236:239], a[140:143], a[12:15], 0
    buffer_load_dwordx4 a[80:83], v21, s[56:59], s68 offen sc1
    s_waitcnt lgkmcnt(15)
    v_mfma_f32_16x16x32_bf16 v[144:147], a[144:147], a[0:3], 0
    ds_read_b64_tr_b16 a[180:181], v13 offset:8192
    v_accvgpr_read_b32 v80, a120
    v_mfma_f32_16x16x32_bf16 v[176:179], a[144:147], a[4:7], 0
    ds_read_b64_tr_b16 a[182:183], v13 offset:12288
    v_accvgpr_read_b32 v81, a121
    v_mfma_f32_16x16x32_bf16 v[208:211], a[144:147], a[8:11], 0
    buffer_load_dwordx4 a[84:87], v22, s[56:59], s68 offen sc1
    v_mfma_f32_16x16x32_bf16 v[240:243], a[144:147], a[12:15], 0
    ds_read_b64_tr_b16 a[184:185], v14 offset:8192
    v_accvgpr_read_b32 v82, a122
    s_waitcnt lgkmcnt(15)
    v_mfma_f32_16x16x32_bf16 v[148:151], a[148:151], a[0:3], 0
    ds_read_b64_tr_b16 a[186:187], v14 offset:12288
    s_waitcnt vmcnt(6)
    s_mov_b64 exec, 1
    buffer_atomic_add v42, off, s[56:59], s93 sc1
    s_mov_b64 exec, -1
    v_accvgpr_read_b32 v83, a123
    v_mfma_f32_16x16x32_bf16 v[180:183], a[148:151], a[4:7], 0
    buffer_load_dwordx4 a[88:91], v23, s[56:59], s68 offen sc1
    v_mfma_f32_16x16x32_bf16 v[212:215], a[148:151], a[8:11], 0
    ds_read_b64_tr_b16 a[188:189], v15 offset:8192
    v_accvgpr_read_b32 v84, a124
    v_mfma_f32_16x16x32_bf16 v[244:247], a[148:151], a[12:15], 0
    ds_read_b64_tr_b16 a[190:191], v15 offset:12288
    v_accvgpr_read_b32 v85, a125
    v_mfma_f32_16x16x32_bf16 v[152:155], a[152:155], a[0:3], 0
    v_mfma_f32_16x16x32_bf16 v[184:187], a[152:155], a[4:7], 0
    v_accvgpr_read_b32 v86, a126
    v_mfma_f32_16x16x32_bf16 v[216:219], a[152:155], a[8:11], 0
    v_accvgpr_read_b32 v87, a127
    v_mfma_f32_16x16x32_bf16 v[248:251], a[152:155], a[12:15], 0
    s_waitcnt lgkmcnt(15)
    v_mfma_f32_16x16x32_bf16 v[156:159], a[156:159], a[0:3], 0
    v_mfma_f32_16x16x32_bf16 v[188:191], a[156:159], a[4:7], 0
    v_mfma_f32_16x16x32_bf16 v[220:223], a[156:159], a[8:11], 0
    v_mfma_f32_16x16x32_bf16 v[252:255], a[156:159], a[12:15], 0
    s_waitcnt lgkmcnt(14)
    v_mfma_f32_16x16x32_bf16 v[128:131], a[160:163], a[16:19], v[128:131]
    buffer_load_dwordx4 a[92:95], v24, s[56:59], s68 offen sc1
    v_mfma_f32_16x16x32_bf16 v[160:163], a[160:163], a[20:23], v[160:163]
    ds_read_b64_tr_b16 a[128:129], v8 offset:16384
    v_mfma_f32_16x16x32_bf16 v[192:195], a[160:163], a[24:27], v[192:195]
    ds_read_b64_tr_b16 a[130:131], v8 offset:20480
    v_add_u32 v48, 0x10000, v8
    v_mfma_f32_16x16x32_bf16 v[224:227], a[160:163], a[28:31], v[224:227]
    s_add_u32 s68, s68, 16384
    v_add_u32 v56, 0x20000, v8
    s_waitcnt lgkmcnt(14)
    v_mfma_f32_16x16x32_bf16 v[132:135], a[164:167], a[16:19], v[132:135]
    ds_read_b64_tr_b16 a[132:133], v9 offset:16384
    v_add_u32 v49, 0x10000, v9
    v_mfma_f32_16x16x32_bf16 v[164:167], a[164:167], a[20:23], v[164:167]
    ds_read_b64_tr_b16 a[134:135], v9 offset:20480
    v_mfma_f32_16x16x32_bf16 v[196:199], a[164:167], a[24:27], v[196:199]
    buffer_load_dwordx4 a[96:99], v21, s[56:59], s68 offen sc1
    v_add_u32 v57, 0x20000, v9
    v_mfma_f32_16x16x32_bf16 v[228:231], a[164:167], a[28:31], v[228:231]
    ds_read_b64_tr_b16 a[136:137], v10 offset:16384
    v_add_u32 v50, 0x10000, v10
    s_waitcnt lgkmcnt(15)
    v_mfma_f32_16x16x32_bf16 v[136:139], a[168:171], a[16:19], v[136:139]
    ds_read_b64_tr_b16 a[138:139], v10 offset:20480
    v_add_u32 v58, 0x20000, v10
    v_mfma_f32_16x16x32_bf16 v[168:171], a[168:171], a[20:23], v[168:171]
    buffer_load_dwordx4 a[100:103], v22, s[56:59], s68 offen sc1
    v_mfma_f32_16x16x32_bf16 v[200:203], a[168:171], a[24:27], v[200:203]
    ds_read_b64_tr_b16 a[140:141], v11 offset:16384
    v_add_u32 v51, 0x10000, v11
    v_mfma_f32_16x16x32_bf16 v[232:235], a[168:171], a[28:31], v[232:235]
    ds_read_b64_tr_b16 a[142:143], v11 offset:20480
    v_add_u32 v59, 0x20000, v11
    s_waitcnt lgkmcnt(15)
    v_mfma_f32_16x16x32_bf16 v[140:143], a[172:175], a[16:19], v[140:143]
    buffer_load_dwordx4 a[104:107], v23, s[56:59], s68 offen sc1
    v_add_u32 v52, 0x10000, v12
    v_mfma_f32_16x16x32_bf16 v[172:175], a[172:175], a[20:23], v[172:175]
    ds_read_b64_tr_b16 a[144:145], v12 offset:16384
    v_mfma_f32_16x16x32_bf16 v[204:207], a[172:175], a[24:27], v[204:207]
    ds_read_b64_tr_b16 a[146:147], v12 offset:20480
    v_add_u32 v60, 0x20000, v12
    v_mfma_f32_16x16x32_bf16 v[236:239], a[172:175], a[28:31], v[236:239]
    buffer_load_dwordx4 a[108:111], v24, s[56:59], s68 offen sc1
    v_add_u32 v53, 0x10000, v13
    s_waitcnt lgkmcnt(15)
    v_mfma_f32_16x16x32_bf16 v[144:147], a[176:179], a[16:19], v[144:147]
    ds_read_b64_tr_b16 a[148:149], v13 offset:16384
    v_add_u32 v61, 0x20000, v13
    v_mfma_f32_16x16x32_bf16 v[176:179], a[176:179], a[20:23], v[176:179]
    ds_read_b64_tr_b16 a[150:151], v13 offset:20480
    v_mfma_f32_16x16x32_bf16 v[208:211], a[176:179], a[24:27], v[208:211]
    s_add_u32 s68, s68, 16384
    v_add_u32 v54, 0x10000, v14
    v_mfma_f32_16x16x32_bf16 v[240:243], a[176:179], a[28:31], v[240:243]
    ds_read_b64_tr_b16 a[152:153], v14 offset:16384
    v_add_u32 v62, 0x20000, v14
    s_waitcnt lgkmcnt(15)
    v_mfma_f32_16x16x32_bf16 v[148:151], a[180:183], a[16:19], v[148:151]
    ds_read_b64_tr_b16 a[154:155], v14 offset:20480
    v_add_u32 v55, 0x10000, v15
    v_mfma_f32_16x16x32_bf16 v[180:183], a[180:183], a[20:23], v[180:183]
    buffer_load_dwordx4 a[112:115], v21, s[56:59], s68 offen sc1
    v_mfma_f32_16x16x32_bf16 v[212:215], a[180:183], a[24:27], v[212:215]
    ds_read_b64_tr_b16 a[156:157], v15 offset:16384
    v_add_u32 v63, 0x20000, v15
    v_mfma_f32_16x16x32_bf16 v[244:247], a[180:183], a[28:31], v[244:247]
    ds_read_b64_tr_b16 a[158:159], v15 offset:20480
    v_and_b32 v34, 15, v0
    v_mfma_f32_16x16x32_bf16 v[152:155], a[184:187], a[16:19], v[152:155]
    buffer_load_dwordx4 a[116:119], v22, s[56:59], s68 offen sc1
    v_lshrrev_b32 v35, 4, v0
    v_mfma_f32_16x16x32_bf16 v[184:187], a[184:187], a[20:23], v[184:187]
    v_mfma_f32_16x16x32_bf16 v[216:219], a[184:187], a[24:27], v[216:219]
    v_cmp_gt_u32 s[4:5], 8, v34
    v_mfma_f32_16x16x32_bf16 v[248:251], a[184:187], a[28:31], v[248:251]
    s_mul_i32 s84, s62, 132096
    s_waitcnt lgkmcnt(15)
    v_mfma_f32_16x16x32_bf16 v[156:159], a[188:191], a[16:19], v[156:159]
    v_add_u32 v3, s84, v16
    v_mfma_f32_16x16x32_bf16 v[188:191], a[188:191], a[20:23], v[188:191]
    s_branch L_over8
L_stub8:
    s_branch L_stub12
L_over8:
    v_mfma_f32_16x16x32_bf16 v[220:223], a[188:191], a[24:27], v[220:223]
    v_mfma_f32_16x16x32_bf16 v[252:255], a[188:191], a[28:31], v[252:255]
    s_waitcnt lgkmcnt(14)
    v_mfma_f32_16x16x32_bf16 v[128:131], a[128:131], a[32:35], v[128:131]
    buffer_load_dwordx4 a[120:123], v23, s[56:59], s68 offen sc1
    v_mfma_f32_16x16x32_bf16 v[160:163], a[128:131], a[36:39], v[160:163]
    ds_read_b64_tr_b16 a[160:161], v8 offset:24576
    v_mfma_f32_16x16x32_bf16 v[192:195], a[128:131], a[40:43], v[192:195]
    ds_read_b64_tr_b16 a[162:163], v8 offset:28672
    s_mul_i32 s84, s62, 130048
    v_mfma_f32_16x16x32_bf16 v[224:227], a[128:131], a[44:47], v[224:227]
    buffer_load_dwordx4 a[124:127], v24, s[56:59], s68 offen sc1
    s_sub_u32 s84, 131072, s84
    s_waitcnt lgkmcnt(14)
    v_mfma_f32_16x16x32_bf16 v[132:135], a[132:135], a[32:35], v[132:135]
    ds_read_b64_tr_b16 a[164:165], v9 offset:24576
    v_add_u32 v4, s84, v16
    v_mfma_f32_16x16x32_bf16 v[164:167], a[132:135], a[36:39], v[164:167]
    ds_read_b64_tr_b16 a[166:167], v9 offset:28672
    v_mfma_f32_16x16x32_bf16 v[196:199], a[132:135], a[40:43], v[196:199]
    s_add_u32 s68, s68, 16384
    v_lshlrev_b32 v35, 2, v35
    v_mfma_f32_16x16x32_bf16 v[228:231], a[132:135], a[44:47], v[228:231]
    ds_read_b64_tr_b16 a[168:169], v10 offset:24576
    v_sub_u32 v34, v34, v35
    s_waitcnt lgkmcnt(15)
    v_mfma_f32_16x16x32_bf16 v[136:139], a[136:139], a[32:35], v[136:139]
    ds_read_b64_tr_b16 a[170:171], v10 offset:28672
    v_mov_b32 v26, 0
    v_mfma_f32_16x16x32_bf16 v[168:171], a[136:139], a[36:39], v[168:171]
    buffer_load_dwordx4 a[0:3], v21, s[56:59], s68 offen sc1
    v_mfma_f32_16x16x32_bf16 v[200:203], a[136:139], a[40:43], v[200:203]
    ds_read_b64_tr_b16 a[172:173], v11 offset:24576
    v_mov_b32 v27, 0
    v_mfma_f32_16x16x32_bf16 v[232:235], a[136:139], a[44:47], v[232:235]
    ds_read_b64_tr_b16 a[174:175], v11 offset:28672
    v_mov_b32 v30, 0
    s_waitcnt lgkmcnt(15)
    v_mfma_f32_16x16x32_bf16 v[140:143], a[140:143], a[32:35], v[140:143]
    buffer_load_dwordx4 a[4:7], v22, s[56:59], s68 offen sc1
    v_mov_b32 v31, 0
    v_mfma_f32_16x16x32_bf16 v[172:175], a[140:143], a[36:39], v[172:175]
    ds_read_b64_tr_b16 a[176:177], v12 offset:24576
    v_mfma_f32_16x16x32_bf16 v[204:207], a[140:143], a[40:43], v[204:207]
    ds_read_b64_tr_b16 a[178:179], v12 offset:28672
    v_mov_b32 v35, 0x3f80
    v_mfma_f32_16x16x32_bf16 v[236:239], a[140:143], a[44:47], v[236:239]
    buffer_load_dwordx4 a[8:11], v23, s[56:59], s68 offen sc1
    v_mov_b32 v36, 0x3f800000
    s_waitcnt lgkmcnt(15)
    v_mfma_f32_16x16x32_bf16 v[144:147], a[144:147], a[32:35], v[144:147]
    ds_read_b64_tr_b16 a[180:181], v13 offset:24576
    v_cmp_eq_u32 vcc, 0, v34
    v_mfma_f32_16x16x32_bf16 v[176:179], a[144:147], a[36:39], v[176:179]
    ds_read_b64_tr_b16 a[182:183], v13 offset:28672
    v_mfma_f32_16x16x32_bf16 v[208:211], a[144:147], a[40:43], v[208:211]
    buffer_load_dwordx4 a[12:15], v24, s[56:59], s68 offen sc1
    v_cndmask_b32 v28, v26, v35, vcc
    v_mfma_f32_16x16x32_bf16 v[240:243], a[144:147], a[44:47], v[240:243]
    ds_read_b64_tr_b16 a[184:185], v14 offset:24576
    v_cmp_eq_u32 vcc, 1, v34
    s_waitcnt lgkmcnt(15)
    v_mfma_f32_16x16x32_bf16 v[148:151], a[148:151], a[32:35], v[148:151]
    ds_read_b64_tr_b16 a[186:187], v14 offset:28672
    v_cndmask_b32 v28, v28, v36, vcc
    v_mfma_f32_16x16x32_bf16 v[180:183], a[148:151], a[36:39], v[180:183]
    s_add_u32 s68, s68, 16384
    v_mfma_f32_16x16x32_bf16 v[212:215], a[148:151], a[40:43], v[212:215]
    ds_read_b64_tr_b16 a[188:189], v15 offset:24576
    v_cmp_eq_u32 vcc, 2, v34
    v_mfma_f32_16x16x32_bf16 v[244:247], a[148:151], a[44:47], v[244:247]
    ds_read_b64_tr_b16 a[190:191], v15 offset:28672
    v_cndmask_b32 v29, v26, v35, vcc
    v_mfma_f32_16x16x32_bf16 v[152:155], a[152:155], a[32:35], v[152:155]
    buffer_load_dwordx4 a[16:19], v21, s[56:59], s68 offen sc1
    v_cmp_eq_u32 vcc, 3, v34
    v_mfma_f32_16x16x32_bf16 v[184:187], a[152:155], a[36:39], v[184:187]
    v_mfma_f32_16x16x32_bf16 v[216:219], a[152:155], a[40:43], v[216:219]
    v_cndmask_b32 v29, v29, v36, vcc
    v_mfma_f32_16x16x32_bf16 v[248:251], a[152:155], a[44:47], v[248:251]
    s_mov_b32 s14, 0xbfb8aa3b
    s_waitcnt lgkmcnt(15)
    v_mfma_f32_16x16x32_bf16 v[156:159], a[156:159], a[32:35], v[156:159]
    s_mov_b32 s15, 0xbfb8aa3b
    v_mfma_f32_16x16x32_bf16 v[188:191], a[156:159], a[36:39], v[188:191]
    v_mfma_f32_16x16x32_bf16 v[220:223], a[156:159], a[40:43], v[220:223]
    v_mfma_f32_16x16x32_bf16 v[252:255], a[156:159], a[44:47], v[252:255]
    s_waitcnt lgkmcnt(14)
    v_mfma_f32_16x16x32_bf16 v[128:131], a[160:163], a[48:51], v[128:131]
    buffer_load_dwordx4 a[20:23], v22, s[56:59], s68 offen sc1
    v_mfma_f32_16x16x32_bf16 v[160:163], a[160:163], a[52:55], v[160:163]
    ds_read_b64_tr_b16 a[128:129], v8 offset:32768
    v_mfma_f32_16x16x32_bf16 v[192:195], a[160:163], a[56:59], v[192:195]
    ds_read_b64_tr_b16 a[130:131], v8 offset:36864
    v_mfma_f32_16x16x32_bf16 v[224:227], a[160:163], a[60:63], v[224:227]
    buffer_load_dwordx4 a[24:27], v23, s[56:59], s68 offen sc1
    s_waitcnt lgkmcnt(14)
    v_mfma_f32_16x16x32_bf16 v[132:135], a[164:167], a[48:51], v[132:135]
    ds_read_b64_tr_b16 a[132:133], v9 offset:32768
    v_mfma_f32_16x16x32_bf16 v[164:167], a[164:167], a[52:55], v[164:167]
    ds_read_b64_tr_b16 a[134:135], v9 offset:36864
    v_mfma_f32_16x16x32_bf16 v[196:199], a[164:167], a[56:59], v[196:199]
    buffer_load_dwordx4 a[28:31], v24, s[56:59], s68 offen sc1
    v_mfma_f32_16x16x32_bf16 v[228:231], a[164:167], a[60:63], v[228:231]
    ds_read_b64_tr_b16 a[136:137], v10 offset:32768
    s_waitcnt lgkmcnt(15)
    v_mfma_f32_16x16x32_bf16 v[136:139], a[168:171], a[48:51], v[136:139]
    ds_read_b64_tr_b16 a[138:139], v10 offset:36864
    v_mfma_f32_16x16x32_bf16 v[168:171], a[168:171], a[52:55], v[168:171]
    s_add_u32 s68, s68, 16384
    v_mfma_f32_16x16x32_bf16 v[200:203], a[168:171], a[56:59], v[200:203]
    ds_read_b64_tr_b16 a[140:141], v11 offset:32768
    v_mfma_f32_16x16x32_bf16 v[232:235], a[168:171], a[60:63], v[232:235]
    ds_read_b64_tr_b16 a[142:143], v11 offset:36864
    s_waitcnt lgkmcnt(15)
    v_mfma_f32_16x16x32_bf16 v[140:143], a[172:175], a[48:51], v[140:143]
    buffer_load_dwordx4 a[32:35], v21, s[56:59], s68 offen sc1
    v_mfma_f32_16x16x32_bf16 v[172:175], a[172:175], a[52:55], v[172:175]
    ds_read_b64_tr_b16 a[144:145], v12 offset:32768
    v_mfma_f32_16x16x32_bf16 v[204:207], a[172:175], a[56:59], v[204:207]
    ds_read_b64_tr_b16 a[146:147], v12 offset:36864
    v_mfma_f32_16x16x32_bf16 v[236:239], a[172:175], a[60:63], v[236:239]
    buffer_load_dwordx4 a[36:39], v22, s[56:59], s68 offen sc1
    s_waitcnt lgkmcnt(15)
    v_mfma_f32_16x16x32_bf16 v[144:147], a[176:179], a[48:51], v[144:147]
    ds_read_b64_tr_b16 a[148:149], v13 offset:32768
    v_mfma_f32_16x16x32_bf16 v[176:179], a[176:179], a[52:55], v[176:179]
    ds_read_b64_tr_b16 a[150:151], v13 offset:36864
    v_mfma_f32_16x16x32_bf16 v[208:211], a[176:179], a[56:59], v[208:211]
    buffer_load_dwordx4 a[40:43], v23, s[56:59], s68 offen sc1
    v_mfma_f32_16x16x32_bf16 v[240:243], a[176:179], a[60:63], v[240:243]
    ds_read_b64_tr_b16 a[152:153], v14 offset:32768
    s_waitcnt lgkmcnt(15)
    v_mfma_f32_16x16x32_bf16 v[148:151], a[180:183], a[48:51], v[148:151]
    ds_read_b64_tr_b16 a[154:155], v14 offset:36864
    v_mfma_f32_16x16x32_bf16 v[180:183], a[180:183], a[52:55], v[180:183]
    buffer_load_dwordx4 a[44:47], v24, s[56:59], s68 offen sc1
    v_mfma_f32_16x16x32_bf16 v[212:215], a[180:183], a[56:59], v[212:215]
    ds_read_b64_tr_b16 a[156:157], v15 offset:32768
    v_mfma_f32_16x16x32_bf16 v[244:247], a[180:183], a[60:63], v[244:247]
    ds_read_b64_tr_b16 a[158:159], v15 offset:36864
    v_mfma_f32_16x16x32_bf16 v[152:155], a[184:187], a[48:51], v[152:155]
    s_add_u32 s68, s68, 16384
    v_mfma_f32_16x16x32_bf16 v[184:187], a[184:187], a[52:55], v[184:187]
    v_mfma_f32_16x16x32_bf16 v[216:219], a[184:187], a[56:59], v[216:219]
    v_mfma_f32_16x16x32_bf16 v[248:251], a[184:187], a[60:63], v[248:251]
    s_waitcnt lgkmcnt(15)
    v_mfma_f32_16x16x32_bf16 v[156:159], a[188:191], a[48:51], v[156:159]
    buffer_load_dword v43, off, s[56:59], s92 sc1
    v_mfma_f32_16x16x32_bf16 v[188:191], a[188:191], a[52:55], v[188:191]
    v_mfma_f32_16x16x32_bf16 v[220:223], a[188:191], a[56:59], v[220:223]
    v_mfma_f32_16x16x32_bf16 v[252:255], a[188:191], a[60:63], v[252:255]
    s_barrier
    s_waitcnt vmcnt(29) lgkmcnt(14)
    v_mfma_f32_16x16x32_bf16 v[128:131], a[128:131], a[64:67], v[128:131]
    buffer_load_dwordx4 a[48:51], v21, s[56:59], s68 offen sc1
    s_waitcnt vmcnt(29)
    v_mfma_f32_16x16x32_bf16 v[160:163], a[128:131], a[68:71], v[160:163]
    ds_read_b64_tr_b16 a[160:161], v8 offset:40960
    s_waitcnt vmcnt(28)
    v_mfma_f32_16x16x32_bf16 v[192:195], a[128:131], a[72:75], v[192:195]
    ds_read_b64_tr_b16 a[162:163], v8 offset:45056
    buffer_load_dwordx4 a[52:55], v22, s[56:59], s68 offen sc1
    s_waitcnt vmcnt(28)
    v_mfma_f32_16x16x32_bf16 v[224:227], a[128:131], a[76:79], v[224:227]
    s_waitcnt lgkmcnt(14)
    v_mfma_f32_16x16x32_bf16 v[132:135], a[132:135], a[64:67], v[132:135]
    ds_read_b64_tr_b16 a[164:165], v9 offset:40960
    buffer_load_dwordx4 a[56:59], v23, s[56:59], s68 offen sc1
    v_mfma_f32_16x16x32_bf16 v[164:167], a[132:135], a[68:71], v[164:167]
    ds_read_b64_tr_b16 a[166:167], v9 offset:45056
    v_mfma_f32_16x16x32_bf16 v[196:199], a[132:135], a[72:75], v[196:199]
    buffer_load_dwordx4 a[60:63], v24, s[56:59], s68 offen sc1
    v_mfma_f32_16x16x32_bf16 v[228:231], a[132:135], a[76:79], v[228:231]
    ds_read_b64_tr_b16 a[168:169], v10 offset:40960
    s_waitcnt lgkmcnt(15)
    v_mfma_f32_16x16x32_bf16 v[136:139], a[136:139], a[64:67], v[136:139]
    ds_read_b64_tr_b16 a[170:171], v10 offset:45056
    s_add_u32 s68, s68, 16384
    v_mfma_f32_16x16x32_bf16 v[168:171], a[136:139], a[68:71], v[168:171]
    v_mfma_f32_16x16x32_bf16 v[200:203], a[136:139], a[72:75], v[200:203]
    ds_read_b64_tr_b16 a[172:173], v11 offset:40960
    v_mfma_f32_16x16x32_bf16 v[232:235], a[136:139], a[76:79], v[232:235]
    ds_read_b64_tr_b16 a[174:175], v11 offset:45056
    s_mov_b32 s82, 1048576
    s_add_u32 m0, s3, 0
    s_waitcnt lgkmcnt(15)
    v_mfma_f32_16x16x32_bf16 v[140:143], a[140:143], a[64:67], v[140:143]
    buffer_load_dwordx4 v17, s[48:51], s82 offen lds
    v_mfma_f32_16x16x32_bf16 v[172:175], a[140:143], a[68:71], v[172:175]
    ds_read_b64_tr_b16 a[176:177], v12 offset:40960
    v_mfma_f32_16x16x32_bf16 v[204:207], a[140:143], a[72:75], v[204:207]
    ds_read_b64_tr_b16 a[178:179], v12 offset:45056
    v_mfma_f32_16x16x32_bf16 v[236:239], a[140:143], a[76:79], v[236:239]
    s_waitcnt lgkmcnt(15)
    v_mfma_f32_16x16x32_bf16 v[144:147], a[144:147], a[64:67], v[144:147]
    ds_read_b64_tr_b16 a[180:181], v13 offset:40960
    buffer_load_dwordx4 v18, s[48:51], s82 offen offset:1024 lds
    v_mfma_f32_16x16x32_bf16 v[176:179], a[144:147], a[68:71], v[176:179]
    ds_read_b64_tr_b16 a[182:183], v13 offset:45056
    v_mfma_f32_16x16x32_bf16 v[208:211], a[144:147], a[72:75], v[208:211]
    v_mfma_f32_16x16x32_bf16 v[240:243], a[144:147], a[76:79], v[240:243]
    ds_read_b64_tr_b16 a[184:185], v14 offset:40960
    s_waitcnt lgkmcnt(15)
    v_mfma_f32_16x16x32_bf16 v[148:151], a[148:151], a[64:67], v[148:151]
    ds_read_b64_tr_b16 a[186:187], v14 offset:45056
    v_mfma_f32_16x16x32_bf16 v[180:183], a[148:151], a[68:71], v[180:183]
    v_mfma_f32_16x16x32_bf16 v[212:215], a[148:151], a[72:75], v[212:215]
    ds_read_b64_tr_b16 a[188:189], v15 offset:40960
    v_mfma_f32_16x16x32_bf16 v[244:247], a[148:151], a[76:79], v[244:247]
    ds_read_b64_tr_b16 a[190:191], v15 offset:45056
    v_mfma_f32_16x16x32_bf16 v[152:155], a[152:155], a[64:67], v[152:155]
    v_mfma_f32_16x16x32_bf16 v[184:187], a[152:155], a[68:71], v[184:187]
    v_mfma_f32_16x16x32_bf16 v[216:219], a[152:155], a[72:75], v[216:219]
    v_mfma_f32_16x16x32_bf16 v[248:251], a[152:155], a[76:79], v[248:251]
    s_waitcnt lgkmcnt(15)
    v_mfma_f32_16x16x32_bf16 v[156:159], a[156:159], a[64:67], v[156:159]
    v_mfma_f32_16x16x32_bf16 v[188:191], a[156:159], a[68:71], v[188:191]
    v_mfma_f32_16x16x32_bf16 v[220:223], a[156:159], a[72:75], v[220:223]
    v_mfma_f32_16x16x32_bf16 v[252:255], a[156:159], a[76:79], v[252:255]
    s_waitcnt vmcnt(31) lgkmcnt(14)
    v_mfma_f32_16x16x32_bf16 v[128:131], a[160:163], a[80:83], v[128:131]
    buffer_load_dwordx4 a[64:67], v21, s[56:59], s68 offen sc1
    s_waitcnt vmcnt(31)
    v_mfma_f32_16x16x32_bf16 v[160:163], a[160:163], a[84:87], v[160:163]
    ds_read_b64_tr_b16 a[128:129], v8 offset:49152
    s_waitcnt vmcnt(29)
    v_mfma_f32_16x16x32_bf16 v[192:195], a[160:163], a[88:91], v[192:195]
    ds_read_b64_tr_b16 a[130:131], v8 offset:53248
    buffer_load_dwordx4 a[68:71], v22, s[56:59], s68 offen sc1
    s_waitcnt vmcnt(29)
    v_mfma_f32_16x16x32_bf16 v[224:227], a[160:163], a[92:95], v[224:227]
    s_waitcnt lgkmcnt(14)
    v_mfma_f32_16x16x32_bf16 v[132:135], a[164:167], a[80:83], v[132:135]
    ds_read_b64_tr_b16 a[132:133], v9 offset:49152
    buffer_load_dwordx4 a[72:75], v23, s[56:59], s68 offen sc1
    v_mfma_f32_16x16x32_bf16 v[164:167], a[164:167], a[84:87], v[164:167]
    ds_read_b64_tr_b16 a[134:135], v9 offset:53248
    v_mfma_f32_16x16x32_bf16 v[196:199], a[164:167], a[88:91], v[196:199]
    buffer_load_dwordx4 a[76:79], v24, s[56:59], s68 offen sc1
    v_mfma_f32_16x16x32_bf16 v[228:231], a[164:167], a[92:95], v[228:231]
    ds_read_b64_tr_b16 a[136:137], v10 offset:49152
    s_waitcnt lgkmcnt(15)
    v_mfma_f32_16x16x32_bf16 v[136:139], a[168:171], a[80:83], v[136:139]
    ds_read_b64_tr_b16 a[138:139], v10 offset:53248
    s_add_u32 s68, s68, 16384
    v_mfma_f32_16x16x32_bf16 v[168:171], a[168:171], a[84:87], v[168:171]
    v_mfma_f32_16x16x32_bf16 v[200:203], a[168:171], a[88:91], v[200:203]
    ds_read_b64_tr_b16 a[140:141], v11 offset:49152
    v_mfma_f32_16x16x32_bf16 v[232:235], a[168:171], a[92:95], v[232:235]
    ds_read_b64_tr_b16 a[142:143], v11 offset:53248
    s_mov_b32 s83, 1277952
    s_add_u32 m0, s3, 8192
    s_waitcnt lgkmcnt(15)
    v_mfma_f32_16x16x32_bf16 v[140:143], a[172:175], a[80:83], v[140:143]
    buffer_load_dwordx4 v17, s[48:51], s83 offen lds
    v_mfma_f32_16x16x32_bf16 v[172:175], a[172:175], a[84:87], v[172:175]
    ds_read_b64_tr_b16 a[144:145], v12 offset:49152
    v_mfma_f32_16x16x32_bf16 v[204:207], a[172:175], a[88:91], v[204:207]
    ds_read_b64_tr_b16 a[146:147], v12 offset:53248
    v_mfma_f32_16x16x32_bf16 v[236:239], a[172:175], a[92:95], v[236:239]
    s_waitcnt lgkmcnt(15)
    v_mfma_f32_16x16x32_bf16 v[144:147], a[176:179], a[80:83], v[144:147]
    ds_read_b64_tr_b16 a[148:149], v13 offset:49152
    buffer_load_dwordx4 v18, s[48:51], s83 offen offset:1024 lds
    v_mfma_f32_16x16x32_bf16 v[176:179], a[176:179], a[84:87], v[176:179]
    ds_read_b64_tr_b16 a[150:151], v13 offset:53248
    v_mfma_f32_16x16x32_bf16 v[208:211], a[176:179], a[88:91], v[208:211]
    v_mfma_f32_16x16x32_bf16 v[240:243], a[176:179], a[92:95], v[240:243]
    ds_read_b64_tr_b16 a[152:153], v14 offset:49152
    s_waitcnt lgkmcnt(15)
    v_mfma_f32_16x16x32_bf16 v[148:151], a[180:183], a[80:83], v[148:151]
    ds_read_b64_tr_b16 a[154:155], v14 offset:53248
    v_mfma_f32_16x16x32_bf16 v[180:183], a[180:183], a[84:87], v[180:183]
    v_mfma_f32_16x16x32_bf16 v[212:215], a[180:183], a[88:91], v[212:215]
    ds_read_b64_tr_b16 a[156:157], v15 offset:49152
    v_mfma_f32_16x16x32_bf16 v[244:247], a[180:183], a[92:95], v[244:247]
    ds_read_b64_tr_b16 a[158:159], v15 offset:53248
    v_mfma_f32_16x16x32_bf16 v[152:155], a[184:187], a[80:83], v[152:155]
    v_mfma_f32_16x16x32_bf16 v[184:187], a[184:187], a[84:87], v[184:187]
    v_mfma_f32_16x16x32_bf16 v[216:219], a[184:187], a[88:91], v[216:219]
    v_mfma_f32_16x16x32_bf16 v[248:251], a[184:187], a[92:95], v[248:251]
    s_waitcnt lgkmcnt(15)
    v_mfma_f32_16x16x32_bf16 v[156:159], a[188:191], a[80:83], v[156:159]
    v_mfma_f32_16x16x32_bf16 v[188:191], a[188:191], a[84:87], v[188:191]
    v_mfma_f32_16x16x32_bf16 v[220:223], a[188:191], a[88:91], v[220:223]
    v_mfma_f32_16x16x32_bf16 v[252:255], a[188:191], a[92:95], v[252:255]
    s_waitcnt vmcnt(32) lgkmcnt(14)
    v_mfma_f32_16x16x32_bf16 v[128:131], a[128:131], a[96:99], v[128:131]
    buffer_load_dwordx4 a[80:83], v21, s[56:59], s68 offen sc1
    s_waitcnt vmcnt(32)
    v_mfma_f32_16x16x32_bf16 v[160:163], a[128:131], a[100:103], v[160:163]
    ds_read_b64_tr_b16 a[160:161], v8 offset:57344
    s_waitcnt vmcnt(31)
    v_mfma_f32_16x16x32_bf16 v[192:195], a[128:131], a[104:107], v[192:195]
    ds_read_b64_tr_b16 a[162:163], v8 offset:61440
    buffer_load_dwordx4 a[84:87], v22, s[56:59], s68 offen sc1
    s_waitcnt vmcnt(31)
    v_mfma_f32_16x16x32_bf16 v[224:227], a[128:131], a[108:111], v[224:227]
    s_waitcnt lgkmcnt(14)
    v_mfma_f32_16x16x32_bf16 v[132:135], a[132:135], a[96:99], v[132:135]
    ds_read_b64_tr_b16 a[164:165], v9 offset:57344
    buffer_load_dwordx4 a[88:91], v23, s[56:59], s68 offen sc1
    v_mfma_f32_16x16x32_bf16 v[164:167], a[132:135], a[100:103], v[164:167]
    ds_read_b64_tr_b16 a[166:167], v9 offset:61440
    v_mfma_f32_16x16x32_bf16 v[196:199], a[132:135], a[104:107], v[196:199]
    buffer_load_dwordx4 a[92:95], v24, s[56:59], s68 offen sc1
    v_mfma_f32_16x16x32_bf16 v[228:231], a[132:135], a[108:111], v[228:231]
    ds_read_b64_tr_b16 a[168:169], v10 offset:57344
    s_waitcnt lgkmcnt(15)
    v_mfma_f32_16x16x32_bf16 v[136:139], a[136:139], a[96:99], v[136:139]
    ds_read_b64_tr_b16 a[170:171], v10 offset:61440
    s_add_u32 s68, s68, 16384
    v_mfma_f32_16x16x32_bf16 v[168:171], a[136:139], a[100:103], v[168:171]
    v_mfma_f32_16x16x32_bf16 v[200:203], a[136:139], a[104:107], v[200:203]
    ds_read_b64_tr_b16 a[172:173], v11 offset:57344
    v_mfma_f32_16x16x32_bf16 v[232:235], a[136:139], a[108:111], v[232:235]
    ds_read_b64_tr_b16 a[174:175], v11 offset:61440
    s_mov_b32 s82, 1507328
    s_add_u32 m0, s3, 16384
    s_waitcnt lgkmcnt(15)
    v_mfma_f32_16x16x32_bf16 v[140:143], a[140:143], a[96:99], v[140:143]
    buffer_load_dwordx4 v17, s[48:51], s82 offen lds
    v_mfma_f32_16x16x32_bf16 v[172:175], a[140:143], a[100:103], v[172:175]
    ds_read_b64_tr_b16 a[176:177], v12 offset:57344
    v_mfma_f32_16x16x32_bf16 v[204:207], a[140:143], a[104:107], v[204:207]
    ds_read_b64_tr_b16 a[178:179], v12 offset:61440
    v_mfma_f32_16x16x32_bf16 v[236:239], a[140:143], a[108:111], v[236:239]
    s_waitcnt lgkmcnt(15)
    v_mfma_f32_16x16x32_bf16 v[144:147], a[144:147], a[96:99], v[144:147]
    ds_read_b64_tr_b16 a[180:181], v13 offset:57344
    buffer_load_dwordx4 v18, s[48:51], s82 offen offset:1024 lds
    v_mfma_f32_16x16x32_bf16 v[176:179], a[144:147], a[100:103], v[176:179]
    ds_read_b64_tr_b16 a[182:183], v13 offset:61440
    v_mfma_f32_16x16x32_bf16 v[208:211], a[144:147], a[104:107], v[208:211]
    v_mfma_f32_16x16x32_bf16 v[240:243], a[144:147], a[108:111], v[240:243]
    ds_read_b64_tr_b16 a[184:185], v14 offset:57344
    s_waitcnt lgkmcnt(15)
    v_mfma_f32_16x16x32_bf16 v[148:151], a[148:151], a[96:99], v[148:151]
    ds_read_b64_tr_b16 a[186:187], v14 offset:61440
    v_mfma_f32_16x16x32_bf16 v[180:183], a[148:151], a[100:103], v[180:183]
    v_mfma_f32_16x16x32_bf16 v[212:215], a[148:151], a[104:107], v[212:215]
    ds_read_b64_tr_b16 a[188:189], v15 offset:57344
    v_mfma_f32_16x16x32_bf16 v[244:247], a[148:151], a[108:111], v[244:247]
    ds_read_b64_tr_b16 a[190:191], v15 offset:61440
    v_mfma_f32_16x16x32_bf16 v[152:155], a[152:155], a[96:99], v[152:155]
    v_mfma_f32_16x16x32_bf16 v[184:187], a[152:155], a[100:103], v[184:187]
    v_mfma_f32_16x16x32_bf16 v[216:219], a[152:155], a[104:107], v[216:219]
    v_mfma_f32_16x16x32_bf16 v[248:251], a[152:155], a[108:111], v[248:251]
    s_waitcnt lgkmcnt(15)
    v_mfma_f32_16x16x32_bf16 v[156:159], a[156:159], a[96:99], v[156:159]
    v_mfma_f32_16x16x32_bf16 v[188:191], a[156:159], a[100:103], v[188:191]
    v_mfma_f32_16x16x32_bf16 v[220:223], a[156:159], a[104:107], v[220:223]
    v_mfma_f32_16x16x32_bf16 v[252:255], a[156:159], a[108:111], v[252:255]
    s_waitcnt vmcnt(34) lgkmcnt(14)
    v_mfma_f32_16x16x32_bf16 v[128:131], a[160:163], a[112:115], v[128:131]
    buffer_load_dwordx4 a[96:99], v21, s[56:59], s68 offen sc1
    s_waitcnt vmcnt(34)
    v_mfma_f32_16x16x32_bf16 v[160:163], a[160:163], a[116:119], v[160:163]
    ds_read_b64_tr_b16 a[128:129], v48 offset:0
    s_waitcnt vmcnt(33)
    v_mfma_f32_16x16x32_bf16 v[192:195], a[160:163], a[120:123], v[192:195]
    ds_read_b64_tr_b16 a[130:131], v48 offset:4096
    buffer_load_dwordx4 a[100:103], v22, s[56:59], s68 offen sc1
    s_waitcnt vmcnt(33)
    v_mfma_f32_16x16x32_bf16 v[224:227], a[160:163], a[124:127], v[224:227]
    s_waitcnt lgkmcnt(14)
    v_mfma_f32_16x16x32_bf16 v[132:135], a[164:167], a[112:115], v[132:135]
    ds_read_b64_tr_b16 a[132:133], v49 offset:0
    buffer_load_dwordx4 a[104:107], v23, s[56:59], s68 offen sc1
    v_mfma_f32_16x16x32_bf16 v[164:167], a[164:167], a[116:119], v[164:167]
    ds_read_b64_tr_b16 a[134:135], v49 offset:4096
    v_mfma_f32_16x16x32_bf16 v[196:199], a[164:167], a[120:123], v[196:199]
    buffer_load_dwordx4 a[108:111], v24, s[56:59], s68 offen sc1
    v_mfma_f32_16x16x32_bf16 v[228:231], a[164:167], a[124:127], v[228:231]
    ds_read_b64_tr_b16 a[136:137], v50 offset:0
    s_waitcnt lgkmcnt(15)
    v_mfma_f32_16x16x32_bf16 v[136:139], a[168:171], a[112:115], v[136:139]
    ds_read_b64_tr_b16 a[138:139], v50 offset:4096
    s_add_u32 s68, s68, 16384
    v_mfma_f32_16x16x32_bf16 v[168:171], a[168:171], a[116:119], v[168:171]
    v_mfma_f32_16x16x32_bf16 v[200:203], a[168:171], a[120:123], v[200:203]
    ds_read_b64_tr_b16 a[140:141], v51 offset:0
    v_mfma_f32_16x16x32_bf16 v[232:235], a[168:171], a[124:127], v[232:235]
    ds_read_b64_tr_b16 a[142:143], v51 offset:4096
    s_mov_b32 s83, 1736704
    s_add_u32 m0, s3, 24576
    s_waitcnt lgkmcnt(15)
    v_mfma_f32_16x16x32_bf16 v[140:143], a[172:175], a[112:115], v[140:143]
    buffer_load_dwordx4 v17, s[48:51], s83 offen lds
    v_mfma_f32_16x16x32_bf16 v[172:175], a[172:175], a[116:119], v[172:175]
    ds_read_b64_tr_b16 a[144:145], v52 offset:0
    v_mfma_f32_16x16x32_bf16 v[204:207], a[172:175], a[120:123], v[204:207]
    ds_read_b64_tr_b16 a[146:147], v52 offset:4096
    v_mfma_f32_16x16x32_bf16 v[236:239], a[172:175], a[124:127], v[236:239]
    s_waitcnt lgkmcnt(15)
    v_mfma_f32_16x16x32_bf16 v[144:147], a[176:179], a[112:115], v[144:147]
    ds_read_b64_tr_b16 a[148:149], v53 offset:0
    buffer_load_dwordx4 v18, s[48:51], s83 offen offset:1024 lds
    v_mfma_f32_16x16x32_bf16 v[176:179], a[176:179], a[116:119], v[176:179]
    ds_read_b64_tr_b16 a[150:151], v53 offset:4096
    v_mfma_f32_16x16x32_bf16 v[208:211], a[176:179], a[120:123], v[208:211]
    v_mfma_f32_16x16x32_bf16 v[240:243], a[176:179], a[124:127], v[240:243]
    ds_read_b64_tr_b16 a[152:153], v54 offset:0
    s_waitcnt lgkmcnt(15)
    v_mfma_f32_16x16x32_bf16 v[148:151], a[180:183], a[112:115], v[148:151]
    ds_read_b64_tr_b16 a[154:155], v54 offset:4096
    v_mfma_f32_16x16x32_bf16 v[180:183], a[180:183], a[116:119], v[180:183]
    v_mfma_f32_16x16x32_bf16 v[212:215], a[180:183], a[120:123], v[212:215]
    ds_read_b64_tr_b16 a[156:157], v55 offset:0
    v_mfma_f32_16x16x32_bf16 v[244:247], a[180:183], a[124:127], v[244:247]
    ds_read_b64_tr_b16 a[158:159], v55 offset:4096
    v_mfma_f32_16x16x32_bf16 v[152:155], a[184:187], a[112:115], v[152:155]
    v_mfma_f32_16x16x32_bf16 v[184:187], a[184:187], a[116:119], v[184:187]
    v_mfma_f32_16x16x32_bf16 v[216:219], a[184:187], a[120:123], v[216:219]
    v_mfma_f32_16x16x32_bf16 v[248:251], a[184:187], a[124:127], v[248:251]
    s_waitcnt lgkmcnt(15)
    v_mfma_f32_16x16x32_bf16 v[156:159], a[188:191], a[112:115], v[156:159]
    v_mfma_f32_16x16x32_bf16 v[188:191], a[188:191], a[116:119], v[188:191]
    v_mfma_f32_16x16x32_bf16 v[220:223], a[188:191], a[120:123], v[220:223]
    v_mfma_f32_16x16x32_bf16 v[252:255], a[188:191], a[124:127], v[252:255]
    s_waitcnt lgkmcnt(0)
    s_barrier
    s_waitcnt vmcnt(36)
    v_mfma_f32_16x16x32_bf16 v[128:131], a[128:131], a[0:3], v[128:131]
    buffer_load_dwordx4 a[112:115], v21, s[56:59], s68 offen sc1
    s_waitcnt vmcnt(36)
    v_mfma_f32_16x16x32_bf16 v[160:163], a[128:131], a[4:7], v[160:163]
    ds_read_b64_tr_b16 a[160:161], v48 offset:8192
    s_waitcnt vmcnt(35)
    v_mfma_f32_16x16x32_bf16 v[192:195], a[128:131], a[8:11], v[192:195]
    ds_read_b64_tr_b16 a[162:163], v48 offset:12288
    buffer_load_dwordx4 a[116:119], v22, s[56:59], s68 offen sc1
    s_waitcnt vmcnt(35)
    v_mfma_f32_16x16x32_bf16 v[224:227], a[128:131], a[12:15], v[224:227]
    v_mfma_f32_16x16x32_bf16 v[132:135], a[132:135], a[0:3], v[132:135]
    ds_read_b64_tr_b16 a[164:165], v49 offset:8192
    buffer_load_dwordx4 a[120:123], v23, s[56:59], s68 offen sc1
    v_mfma_f32_16x16x32_bf16 v[164:167], a[132:135], a[4:7], v[164:167]
    ds_read_b64_tr_b16 a[166:167], v49 offset:12288
    v_mfma_f32_16x16x32_bf16 v[196:199], a[132:135], a[8:11], v[196:199]
    buffer_load_dwordx4 a[124:127], v24, s[56:59], s68 offen sc1
    v_mfma_f32_16x16x32_bf16 v[228:231], a[132:135], a[12:15], v[228:231]
    ds_read_b64_tr_b16 a[168:169], v50 offset:8192
    v_mfma_f32_16x16x32_bf16 v[136:139], a[136:139], a[0:3], v[136:139]
    ds_read_b64_tr_b16 a[170:171], v50 offset:12288
    s_add_u32 s68, s68, 16384
    v_mfma_f32_16x16x32_bf16 v[168:171], a[136:139], a[4:7], v[168:171]
    v_mfma_f32_16x16x32_bf16 v[200:203], a[136:139], a[8:11], v[200:203]
    ds_read_b64_tr_b16 a[172:173], v51 offset:8192
    v_mfma_f32_16x16x32_bf16 v[232:235], a[136:139], a[12:15], v[232:235]
    ds_read_b64_tr_b16 a[174:175], v51 offset:12288
    s_mov_b32 s82, 196608
    s_add_u32 m0, s3, 32768
    v_mfma_f32_16x16x32_bf16 v[140:143], a[140:143], a[0:3], v[140:143]
    buffer_load_dwordx4 v19, s[48:51], s82 offen lds
    v_mfma_f32_16x16x32_bf16 v[172:175], a[140:143], a[4:7], v[172:175]
    ds_read_b64_tr_b16 a[176:177], v52 offset:8192
    v_mfma_f32_16x16x32_bf16 v[204:207], a[140:143], a[8:11], v[204:207]
    ds_read_b64_tr_b16 a[178:179], v52 offset:12288
    v_mfma_f32_16x16x32_bf16 v[236:239], a[140:143], a[12:15], v[236:239]
    v_mfma_f32_16x16x32_bf16 v[144:147], a[144:147], a[0:3], v[144:147]
    ds_read_b64_tr_b16 a[180:181], v53 offset:8192
    buffer_load_dwordx4 v20, s[48:51], s82 offen offset:1024 lds
    v_mfma_f32_16x16x32_bf16 v[176:179], a[144:147], a[4:7], v[176:179]
    ds_read_b64_tr_b16 a[182:183], v53 offset:12288
    v_mfma_f32_16x16x32_bf16 v[208:211], a[144:147], a[8:11], v[208:211]
    v_mfma_f32_16x16x32_bf16 v[240:243], a[144:147], a[12:15], v[240:243]
    ds_read_b64_tr_b16 a[184:185], v54 offset:8192
    v_mfma_f32_16x16x32_bf16 v[148:151], a[148:151], a[0:3], v[148:151]
    ds_read_b64_tr_b16 a[186:187], v54 offset:12288
    v_mfma_f32_16x16x32_bf16 v[180:183], a[148:151], a[4:7], v[180:183]
    s_mov_b32 s83, 655360
    s_add_u32 m0, s3, 40960
    v_mfma_f32_16x16x32_bf16 v[212:215], a[148:151], a[8:11], v[212:215]
    ds_read_b64_tr_b16 a[188:189], v55 offset:8192
    buffer_load_dwordx4 v19, s[48:51], s83 offen lds
    v_mfma_f32_16x16x32_bf16 v[244:247], a[148:151], a[12:15], v[244:247]
    ds_read_b64_tr_b16 a[190:191], v55 offset:12288
    v_mfma_f32_16x16x32_bf16 v[152:155], a[152:155], a[0:3], v[152:155]
    v_mfma_f32_16x16x32_bf16 v[184:187], a[152:155], a[4:7], v[184:187]
    v_mfma_f32_16x16x32_bf16 v[216:219], a[152:155], a[8:11], v[216:219]
    buffer_load_dwordx4 v20, s[48:51], s83 offen offset:1024 lds
    v_mfma_f32_16x16x32_bf16 v[248:251], a[152:155], a[12:15], v[248:251]
    v_mfma_f32_16x16x32_bf16 v[156:159], a[156:159], a[0:3], v[156:159]
    v_mfma_f32_16x16x32_bf16 v[188:191], a[156:159], a[4:7], v[188:191]
    v_mfma_f32_16x16x32_bf16 v[220:223], a[156:159], a[8:11], v[220:223]
    v_mfma_f32_16x16x32_bf16 v[252:255], a[156:159], a[12:15], v[252:255]
    s_waitcnt vmcnt(40) lgkmcnt(14)
    v_mfma_f32_16x16x32_bf16 v[128:131], a[160:163], a[16:19], v[128:131]
    s_waitcnt vmcnt(32)
    v_readfirstlane_b32 s86, v43
    s_bfe_u32 s86, s86, 0x80008
    s_cmp_eq_u32 s86, 16
    s_cbranch_scc0 L_spB
L_okB:
    buffer_load_dwordx4 a[0:3], v21, s[56:59], s68 offen sc1
    v_mfma_f32_16x16x32_bf16 v[160:163], a[160:163], a[20:23], v[160:163]
    ds_read_b64_tr_b16 a[128:129], v48 offset:16384
    v_mfma_f32_16x16x32_bf16 v[192:195], a[160:163], a[24:27], v[192:195]
    ds_read_b64_tr_b16 a[130:131], v48 offset:20480
    buffer_load_dwordx4 a[4:7], v22, s[56:59], s68 offen sc1
    v_mfma_f32_16x16x32_bf16 v[224:227], a[160:163], a[28:31], v[224:227]
    s_waitcnt lgkmcnt(14)
    v_mfma_f32_16x16x32_bf16 v[132:135], a[164:167], a[16:19], v[132:135]
    ds_read_b64_tr_b16 a[132:133], v49 offset:16384
    buffer_load_dwordx4 a[8:11], v23, s[56:59], s68 offen sc1
    v_mfma_f32_16x16x32_bf16 v[164:167], a[164:167], a[20:23], v[164:167]
    ds_read_b64_tr_b16 a[134:135], v49 offset:20480
    v_mfma_f32_16x16x32_bf16 v[196:199], a[164:167], a[24:27], v[196:199]
    buffer_load_dwordx4 a[12:15], v24, s[56:59], s68 offen sc1
    v_mfma_f32_16x16x32_bf16 v[228:231], a[164:167], a[28:31], v[228:231]
    ds_read_b64_tr_b16 a[136:137], v50 offset:16384
    s_waitcnt lgkmcnt(15)
    v_mfma_f32_16x16x32_bf16 v[136:139], a[168:171], a[16:19], v[136:139]
    ds_read_b64_tr_b16 a[138:139], v50 offset:20480
    s_add_u32 s68, s68, 16384
    v_mfma_f32_16x16x32_bf16 v[168:171], a[168:171], a[20:23], v[168:171]
    v_mfma_f32_16x16x32_bf16 v[200:203], a[168:171], a[24:27], v[200:203]
    ds_read_b64_tr_b16 a[140:141], v51 offset:16384
    v_mfma_f32_16x16x32_bf16 v[232:235], a[168:171], a[28:31], v[232:235]
    ds_read_b64_tr_b16 a[142:143], v51 offset:20480
    s_mov_b32 s82, 1114112
    s_add_u32 m0, s3, 49152
    s_waitcnt lgkmcnt(15)
    v_mfma_f32_16x16x32_bf16 v[140:143], a[172:175], a[16:19], v[140:143]
    buffer_load_dwordx4 v19, s[48:51], s82 offen lds
    v_mfma_f32_16x16x32_bf16 v[172:175], a[172:175], a[20:23], v[172:175]
    ds_read_b64_tr_b16 a[144:145], v52 offset:16384
    v_mfma_f32_16x16x32_bf16 v[204:207], a[172:175], a[24:27], v[204:207]
    ds_read_b64_tr_b16 a[146:147], v52 offset:20480
    v_mfma_f32_16x16x32_bf16 v[236:239], a[172:175], a[28:31], v[236:239]
    s_waitcnt lgkmcnt(15)
    v_mfma_f32_16x16x32_bf16 v[144:147], a[176:179], a[16:19], v[144:147]
    ds_read_b64_tr_b16 a[148:149], v53 offset:16384
    buffer_load_dwordx4 v20, s[48:51], s82 offen offset:1024 lds
    v_mfma_f32_16x16x32_bf16 v[176:179], a[176:179], a[20:23], v[176:179]
    ds_read_b64_tr_b16 a[150:151], v53 offset:20480
    v_mfma_f32_16x16x32_bf16 v[208:211], a[176:179], a[24:27], v[208:211]
    v_mfma_f32_16x16x32_bf16 v[240:243], a[176:179], a[28:31], v[240:243]
    ds_read_b64_tr_b16 a[152:153], v54 offset:16384
    s_waitcnt lgkmcnt(15)
    v_mfma_f32_16x16x32_bf16 v[148:151], a[180:183], a[16:19], v[148:151]
    ds_read_b64_tr_b16 a[154:155], v54 offset:20480
    v_mfma_f32_16x16x32_bf16 v[180:183], a[180:183], a[20:23], v[180:183]
    v_mfma_f32_16x16x32_bf16 v[212:215], a[180:183], a[24:27], v[212:215]
    ds_read_b64_tr_b16 a[156:157], v55 offset:16384
    v_mfma_f32_16x16x32_bf16 v[244:247], a[180:183], a[28:31], v[244:247]
    ds_read_b64_tr_b16 a[158:159], v55 offset:20480
    v_mfma_f32_16x16x32_bf16 v[152:155], a[184:187], a[16:19], v[152:155]
    v_mfma_f32_16x16x32_bf16 v[184:187], a[184:187], a[20:23], v[184:187]
    v_mfma_f32_16x16x32_bf16 v[216:219], a[184:187], a[24:27], v[216:219]
    v_mfma_f32_16x16x32_bf16 v[248:251], a[184:187], a[28:31], v[248:251]
    s_waitcnt lgkmcnt(15)
    v_mfma_f32_16x16x32_bf16 v[156:159], a[188:191], a[16:19], v[156:159]
    v_mfma_f32_16x16x32_bf16 v[188:191], a[188:191], a[20:23], v[188:191]
    v_mfma_f32_16x16x32_bf16 v[220:223], a[188:191], a[24:27], v[220:223]
    s_branch L_over9
L_stub9:
    s_branch L_stub13
L_over9:
    v_mfma_f32_16x16x32_bf16 v[252:255], a[188:191], a[28:31], v[252:255]
    s_waitcnt lgkmcnt(14)
    v_mfma_f32_16x16x32_bf16 v[128:131], a[128:131], a[32:35], v[128:131]
    buffer_load_dwordx4 a[16:19], v21, s[56:59], s68 offen sc1
    v_mfma_f32_16x16x32_bf16 v[160:163], a[128:131], a[36:39], v[160:163]
    ds_read_b64_tr_b16 a[160:161], v48 offset:24576
    v_mfma_f32_16x16x32_bf16 v[192:195], a[128:131], a[40:43], v[192:195]
    ds_read_b64_tr_b16 a[162:163], v48 offset:28672
    buffer_load_dwordx4 a[20:23], v22, s[56:59], s68 offen sc1
    v_mfma_f32_16x16x32_bf16 v[224:227], a[128:131], a[44:47], v[224:227]
    s_waitcnt lgkmcnt(14)
    v_mfma_f32_16x16x32_bf16 v[132:135], a[132:135], a[32:35], v[132:135]
    ds_read_b64_tr_b16 a[164:165], v49 offset:24576
    buffer_load_dwordx4 a[24:27], v23, s[56:59], s68 offen sc1
    v_mfma_f32_16x16x32_bf16 v[164:167], a[132:135], a[36:39], v[164:167]
    ds_read_b64_tr_b16 a[166:167], v49 offset:28672
    v_mfma_f32_16x16x32_bf16 v[196:199], a[132:135], a[40:43], v[196:199]
    buffer_load_dwordx4 a[28:31], v24, s[56:59], s68 offen sc1
    v_mfma_f32_16x16x32_bf16 v[228:231], a[132:135], a[44:47], v[228:231]
    ds_read_b64_tr_b16 a[168:169], v50 offset:24576
    s_waitcnt lgkmcnt(15)
    v_mfma_f32_16x16x32_bf16 v[136:139], a[136:139], a[32:35], v[136:139]
    ds_read_b64_tr_b16 a[170:171], v50 offset:28672
    s_add_u32 s68, s68, 16384
    v_mfma_f32_16x16x32_bf16 v[168:171], a[136:139], a[36:39], v[168:171]
    v_mfma_f32_16x16x32_bf16 v[200:203], a[136:139], a[40:43], v[200:203]
    ds_read_b64_tr_b16 a[172:173], v51 offset:24576
    v_mfma_f32_16x16x32_bf16 v[232:235], a[136:139], a[44:47], v[232:235]
    ds_read_b64_tr_b16 a[174:175], v51 offset:28672
    s_mov_b32 s83, 1572864
    s_add_u32 m0, s3, 57344
    s_waitcnt lgkmcnt(15)
    v_mfma_f32_16x16x32_bf16 v[140:143], a[140:143], a[32:35], v[140:143]
    buffer_load_dwordx4 v19, s[48:51], s83 offen lds
    v_mfma_f32_16x16x32_bf16 v[172:175], a[140:143], a[36:39], v[172:175]
    ds_read_b64_tr_b16 a[176:177], v52 offset:24576
    v_mfma_f32_16x16x32_bf16 v[204:207], a[140:143], a[40:43], v[204:207]
    ds_read_b64_tr_b16 a[178:179], v52 offset:28672
    v_mfma_f32_16x16x32_bf16 v[236:239], a[140:143], a[44:47], v[236:239]
    s_waitcnt lgkmcnt(15)
    v_mfma_f32_16x16x32_bf16 v[144:147], a[144:147], a[32:35], v[144:147]
    ds_read_b64_tr_b16 a[180:181], v53 offset:24576
    buffer_load_dwordx4 v20, s[48:51], s83 offen offset:1024 lds
    v_mfma_f32_16x16x32_bf16 v[176:179], a[144:147], a[36:39], v[176:179]
    ds_read_b64_tr_b16 a[182:183], v53 offset:28672
    v_mfma_f32_16x16x32_bf16 v[208:211], a[144:147], a[40:43], v[208:211]
    v_mfma_f32_16x16x32_bf16 v[240:243], a[144:147], a[44:47], v[240:243]
    ds_read_b64_tr_b16 a[184:185], v54 offset:24576
    s_waitcnt lgkmcnt(15)
    v_mfma_f32_16x16x32_bf16 v[148:151], a[148:151], a[32:35], v[148:151]
    ds_read_b64_tr_b16 a[186:187], v54 offset:28672
    v_mfma_f32_16x16x32_bf16 v[180:183], a[148:151], a[36:39], v[180:183]
    v_mfma_f32_16x16x32_bf16 v[212:215], a[148:151], a[40:43], v[212:215]
    ds_read_b64_tr_b16 a[188:189], v55 offset:24576
    v_mfma_f32_16x16x32_bf16 v[244:247], a[148:151], a[44:47], v[244:247]
    ds_read_b64_tr_b16 a[190:191], v55 offset:28672
    v_mfma_f32_16x16x32_bf16 v[152:155], a[152:155], a[32:35], v[152:155]
    v_mfma_f32_16x16x32_bf16 v[184:187], a[152:155], a[36:39], v[184:187]
    v_mfma_f32_16x16x32_bf16 v[216:219], a[152:155], a[40:43], v[216:219]
    v_mfma_f32_16x16x32_bf16 v[248:251], a[152:155], a[44:47], v[248:251]
    s_waitcnt lgkmcnt(15)
    v_mfma_f32_16x16x32_bf16 v[156:159], a[156:159], a[32:35], v[156:159]
    buffer_load_dword v43, off, s[56:59], s92 sc1
    v_mfma_f32_16x16x32_bf16 v[188:191], a[156:159], a[36:39], v[188:191]
    v_mfma_f32_16x16x32_bf16 v[220:223], a[156:159], a[40:43], v[220:223]
    v_mfma_f32_16x16x32_bf16 v[252:255], a[156:159], a[44:47], v[252:255]
    s_waitcnt vmcnt(44) lgkmcnt(14)
    v_mfma_f32_16x16x32_bf16 v[128:131], a[160:163], a[48:51], v[128:131]
    buffer_load_dwordx4 a[32:35], v21, s[56:59], s68 offen sc1
    s_waitcnt vmcnt(44)
    v_mfma_f32_16x16x32_bf16 v[160:163], a[160:163], a[52:55], v[160:163]
    ds_read_b64_tr_b16 a[128:129], v48 offset:32768
    s_waitcnt vmcnt(43)
    v_mfma_f32_16x16x32_bf16 v[192:195], a[160:163], a[56:59], v[192:195]
    ds_read_b64_tr_b16 a[130:131], v48 offset:36864
    buffer_load_dwordx4 a[36:39], v22, s[56:59], s68 offen sc1
    s_waitcnt vmcnt(43)
    v_mfma_f32_16x16x32_bf16 v[224:227], a[160:163], a[60:63], v[224:227]
    s_waitcnt lgkmcnt(14)
    v_mfma_f32_16x16x32_bf16 v[132:135], a[164:167], a[48:51], v[132:135]
    ds_read_b64_tr_b16 a[132:133], v49 offset:32768
    buffer_load_dwordx4 a[40:43], v23, s[56:59], s68 offen sc1
    v_mfma_f32_16x16x32_bf16 v[164:167], a[164:167], a[52:55], v[164:167]
    ds_read_b64_tr_b16 a[134:135], v49 offset:36864
    v_mfma_f32_16x16x32_bf16 v[196:199], a[164:167], a[56:59], v[196:199]
    buffer_load_dwordx4 a[44:47], v24, s[56:59], s68 offen sc1
    v_mfma_f32_16x16x32_bf16 v[228:231], a[164:167], a[60:63], v[228:231]
    ds_read_b64_tr_b16 a[136:137], v50 offset:32768
    s_waitcnt lgkmcnt(15)
    v_mfma_f32_16x16x32_bf16 v[136:139], a[168:171], a[48:51], v[136:139]
    ds_read_b64_tr_b16 a[138:139], v50 offset:36864
    s_add_u32 s68, s68, 16384
    v_mfma_f32_16x16x32_bf16 v[168:171], a[168:171], a[52:55], v[168:171]
    v_mfma_f32_16x16x32_bf16 v[200:203], a[168:171], a[56:59], v[200:203]
    ds_read_b64_tr_b16 a[140:141], v51 offset:32768
    v_mfma_f32_16x16x32_bf16 v[232:235], a[168:171], a[60:63], v[232:235]
    ds_read_b64_tr_b16 a[142:143], v51 offset:36864
    s_mov_b32 s82, 0
    s_add_u32 m0, s3, 65536
    s_waitcnt lgkmcnt(15)
    v_mfma_f32_16x16x32_bf16 v[140:143], a[172:175], a[48:51], v[140:143]
    buffer_load_dwordx4 v17, s[52:55], s82 offen lds
    v_mfma_f32_16x16x32_bf16 v[172:175], a[172:175], a[52:55], v[172:175]
    ds_read_b64_tr_b16 a[144:145], v52 offset:32768
    v_mfma_f32_16x16x32_bf16 v[204:207], a[172:175], a[56:59], v[204:207]
    ds_read_b64_tr_b16 a[146:147], v52 offset:36864
    v_mfma_f32_16x16x32_bf16 v[236:239], a[172:175], a[60:63], v[236:239]
    s_waitcnt lgkmcnt(15)
    v_mfma_f32_16x16x32_bf16 v[144:147], a[176:179], a[48:51], v[144:147]
    ds_read_b64_tr_b16 a[148:149], v53 offset:32768
    buffer_load_dwordx4 v18, s[52:55], s82 offen offset:1024 lds
    v_mfma_f32_16x16x32_bf16 v[176:179], a[176:179], a[52:55], v[176:179]
    ds_read_b64_tr_b16 a[150:151], v53 offset:36864
    v_mfma_f32_16x16x32_bf16 v[208:211], a[176:179], a[56:59], v[208:211]
    v_mfma_f32_16x16x32_bf16 v[240:243], a[176:179], a[60:63], v[240:243]
    ds_read_b64_tr_b16 a[152:153], v54 offset:32768
    s_waitcnt lgkmcnt(15)
    v_mfma_f32_16x16x32_bf16 v[148:151], a[180:183], a[48:51], v[148:151]
    ds_read_b64_tr_b16 a[154:155], v54 offset:36864
    v_mfma_f32_16x16x32_bf16 v[180:183], a[180:183], a[52:55], v[180:183]
    v_mfma_f32_16x16x32_bf16 v[212:215], a[180:183], a[56:59], v[212:215]
    ds_read_b64_tr_b16 a[156:157], v55 offset:32768
    v_mfma_f32_16x16x32_bf16 v[244:247], a[180:183], a[60:63], v[244:247]
    ds_read_b64_tr_b16 a[158:159], v55 offset:36864
    v_mfma_f32_16x16x32_bf16 v[152:155], a[184:187], a[48:51], v[152:155]
    v_mfma_f32_16x16x32_bf16 v[184:187], a[184:187], a[52:55], v[184:187]
    v_mfma_f32_16x16x32_bf16 v[216:219], a[184:187], a[56:59], v[216:219]
    v_mfma_f32_16x16x32_bf16 v[248:251], a[184:187], a[60:63], v[248:251]
    s_waitcnt lgkmcnt(15)
    v_mfma_f32_16x16x32_bf16 v[156:159], a[188:191], a[48:51], v[156:159]
    v_mfma_f32_16x16x32_bf16 v[188:191], a[188:191], a[52:55], v[188:191]
    v_mfma_f32_16x16x32_bf16 v[220:223], a[188:191], a[56:59], v[220:223]
    v_mfma_f32_16x16x32_bf16 v[252:255], a[188:191], a[60:63], v[252:255]
    s_waitcnt lgkmcnt(0)
    s_barrier
    s_waitcnt vmcnt(44)
    v_mfma_f32_16x16x32_bf16 v[128:131], a[128:131], a[64:67], v[128:131]
    buffer_load_dwordx4 a[48:51], v21, s[56:59], s68 offen sc1
    s_waitcnt vmcnt(44)
    v_mfma_f32_16x16x32_bf16 v[160:163], a[128:131], a[68:71], v[160:163]
    ds_read_b64_tr_b16 a[160:161], v48 offset:40960
    s_waitcnt vmcnt(43)
    v_mfma_f32_16x16x32_bf16 v[192:195], a[128:131], a[72:75], v[192:195]
    ds_read_b64_tr_b16 a[162:163], v48 offset:45056
    buffer_load_dwordx4 a[52:55], v22, s[56:59], s68 offen sc1
    s_waitcnt vmcnt(43)
    v_mfma_f32_16x16x32_bf16 v[224:227], a[128:131], a[76:79], v[224:227]
    v_mfma_f32_16x16x32_bf16 v[132:135], a[132:135], a[64:67], v[132:135]
    ds_read_b64_tr_b16 a[164:165], v49 offset:40960
    buffer_load_dwordx4 a[56:59], v23, s[56:59], s68 offen sc1
    v_mfma_f32_16x16x32_bf16 v[164:167], a[132:135], a[68:71], v[164:167]
    ds_read_b64_tr_b16 a[166:167], v49 offset:45056
    v_mfma_f32_16x16x32_bf16 v[196:199], a[132:135], a[72:75], v[196:199]
    buffer_load_dwordx4 a[60:63], v24, s[56:59], s68 offen sc1
    v_mfma_f32_16x16x32_bf16 v[228:231], a[132:135], a[76:79], v[228:231]
    ds_read_b64_tr_b16 a[168:169], v50 offset:40960
    v_mfma_f32_16x16x32_bf16 v[136:139], a[136:139], a[64:67], v[136:139]
    ds_read_b64_tr_b16 a[170:171], v50 offset:45056
    s_add_u32 s68, s68, 16384
    v_mfma_f32_16x16x32_bf16 v[168:171], a[136:139], a[68:71], v[168:171]
    v_mfma_f32_16x16x32_bf16 v[200:203], a[136:139], a[72:75], v[200:203]
    ds_read_b64_tr_b16 a[172:173], v51 offset:40960
    v_cndmask_b32 v72, v64, v68, s[4:5]
    v_mfma_f32_16x16x32_bf16 v[232:235], a[136:139], a[76:79], v[232:235]
    ds_read_b64_tr_b16 a[174:175], v51 offset:45056
    s_mov_b32 s83, 65536
    s_add_u32 m0, s3, 73728
    v_cndmask_b32 v73, v65, v69, s[4:5]
    v_mfma_f32_16x16x32_bf16 v[140:143], a[140:143], a[64:67], v[140:143]
    buffer_load_dwordx4 v17, s[52:55], s83 offen lds
    v_cndmask_b32 v74, v66, v70, s[4:5]
    v_mfma_f32_16x16x32_bf16 v[172:175], a[140:143], a[68:71], v[172:175]
    ds_read_b64_tr_b16 a[176:177], v52 offset:40960
    v_cndmask_b32 v75, v67, v71, s[4:5]
    v_mfma_f32_16x16x32_bf16 v[204:207], a[140:143], a[72:75], v[204:207]
    ds_read_b64_tr_b16 a[178:179], v52 offset:45056
    v_cndmask_b32 v64, v68, v64, s[4:5]
    v_mfma_f32_16x16x32_bf16 v[236:239], a[140:143], a[76:79], v[236:239]
    v_cndmask_b32 v65, v69, v65, s[4:5]
    v_mfma_f32_16x16x32_bf16 v[144:147], a[144:147], a[64:67], v[144:147]
    ds_read_b64_tr_b16 a[180:181], v53 offset:40960
    buffer_load_dwordx4 v18, s[52:55], s83 offen offset:1024 lds
    v_cndmask_b32 v66, v70, v66, s[4:5]
    v_mfma_f32_16x16x32_bf16 v[176:179], a[144:147], a[68:71], v[176:179]
    ds_read_b64_tr_b16 a[182:183], v53 offset:45056
    v_cndmask_b32 v67, v71, v67, s[4:5]
    v_mfma_f32_16x16x32_bf16 v[208:211], a[144:147], a[72:75], v[208:211]
    v_mov_b32_dpp v76, v72 row_ror:8 row_mask:0xf bank_mask:0xf
    v_mfma_f32_16x16x32_bf16 v[240:243], a[144:147], a[76:79], v[240:243]
    ds_read_b64_tr_b16 a[184:185], v54 offset:40960
    v_mov_b32_dpp v77, v73 row_ror:8 row_mask:0xf bank_mask:0xf
    v_mfma_f32_16x16x32_bf16 v[148:151], a[148:151], a[64:67], v[148:151]
    ds_read_b64_tr_b16 a[186:187], v54 offset:45056
    v_mov_b32_dpp v78, v74 row_ror:8 row_mask:0xf bank_mask:0xf
    v_mfma_f32_16x16x32_bf16 v[180:183], a[148:151], a[68:71], v[180:183]
    s_mov_b32 s82, 131072
    s_add_u32 m0, s3, 81920
    v_mov_b32_dpp v79, v75 row_ror:8 row_mask:0xf bank_mask:0xf
    v_mfma_f32_16x16x32_bf16 v[212:215], a[148:151], a[72:75], v[212:215]
    ds_read_b64_tr_b16 a[188:189], v55 offset:40960
    buffer_load_dwordx4 v17, s[52:55], s82 offen lds
    v_permlane16_swap_b32 v64, v66
    v_mfma_f32_16x16x32_bf16 v[244:247], a[148:151], a[76:79], v[244:247]
    ds_read_b64_tr_b16 a[190:191], v55 offset:45056
    v_permlane16_swap_b32 v65, v67
    v_mfma_f32_16x16x32_bf16 v[152:155], a[152:155], a[64:67], v[152:155]
    v_permlane16_swap_b32 v76, v78
    v_mfma_f32_16x16x32_bf16 v[184:187], a[152:155], a[68:71], v[184:187]
    v_permlane16_swap_b32 v77, v79
    v_mfma_f32_16x16x32_bf16 v[216:219], a[152:155], a[72:75], v[216:219]
    buffer_load_dwordx4 v18, s[52:55], s82 offen offset:1024 lds
    v_mfma_f32_16x16x32_bf16 v[248:251], a[152:155], a[76:79], v[248:251]
    v_mfma_f32_16x16x32_bf16 v[156:159], a[156:159], a[64:67], v[156:159]
    v_mfma_f32_16x16x32_bf16 v[188:191], a[156:159], a[68:71], v[188:191]
    v_mfma_f32_16x16x32_bf16 v[220:223], a[156:159], a[72:75], v[220:223]
    v_mfma_f32_16x16x32_bf16 v[252:255], a[156:159], a[76:79], v[252:255]
    s_waitcnt vmcnt(46) lgkmcnt(14)
    v_mfma_f32_16x16x32_bf16 v[128:131], a[160:163], a[80:83], v[128:131]
    buffer_load_dwordx4 a[64:67], v21, s[56:59], s68 offen sc1
    s_waitcnt vmcnt(46)
    v_mfma_f32_16x16x32_bf16 v[160:163], a[160:163], a[84:87], v[160:163]
    ds_read_b64_tr_b16 a[128:129], v48 offset:49152
    s_waitcnt vmcnt(45)
    v_mfma_f32_16x16x32_bf16 v[192:195], a[160:163], a[88:91], v[192:195]
    ds_read_b64_tr_b16 a[130:131], v48 offset:53248
    buffer_load_dwordx4 a[68:71], v22, s[56:59], s68 offen sc1
    s_waitcnt vmcnt(45)
    v_mfma_f32_16x16x32_bf16 v[224:227], a[160:163], a[92:95], v[224:227]
    s_waitcnt lgkmcnt(14)
    v_mfma_f32_16x16x32_bf16 v[132:135], a[164:167], a[80:83], v[132:135]
    ds_read_b64_tr_b16 a[132:133], v49 offset:49152
    buffer_load_dwordx4 a[72:75], v23, s[56:59], s68 offen sc1
    v_mfma_f32_16x16x32_bf16 v[164:167], a[164:167], a[84:87], v[164:167]
    ds_read_b64_tr_b16 a[134:135], v49 offset:53248
    v_mfma_f32_16x16x32_bf16 v[196:199], a[164:167], a[88:91], v[196:199]
    buffer_load_dwordx4 a[76:79], v24, s[56:59], s68 offen sc1
    v_mfma_f32_16x16x32_bf16 v[228:231], a[164:167], a[92:95], v[228:231]
    ds_read_b64_tr_b16 a[136:137], v50 offset:49152
    s_waitcnt lgkmcnt(15)
    v_mfma_f32_16x16x32_bf16 v[136:139], a[168:171], a[80:83], v[136:139]
    ds_read_b64_tr_b16 a[138:139], v50 offset:53248
    s_add_u32 s68, s68, 16384
    v_mfma_f32_16x16x32_bf16 v[168:171], a[168:171], a[84:87], v[168:171]
    v_mfma_f32_16x16x32_bf16 v[200:203], a[168:171], a[88:91], v[200:203]
    ds_read_b64_tr_b16 a[140:141], v51 offset:49152
    v_and_b32 v71, 0xffff0000, v67
    v_mfma_f32_16x16x32_bf16 v[232:235], a[168:171], a[92:95], v[232:235]
    ds_read_b64_tr_b16 a[142:143], v51 offset:53248
    s_mov_b32 s83, 196608
    s_add_u32 m0, s3, 90112
    v_lshlrev_b32 v70, 16, v67
    s_waitcnt lgkmcnt(15)
    v_mfma_f32_16x16x32_bf16 v[140:143], a[172:175], a[80:83], v[140:143]
    buffer_load_dwordx4 v17, s[52:55], s83 offen lds
    v_and_b32 v69, 0xffff0000, v66
    v_mfma_f32_16x16x32_bf16 v[172:175], a[172:175], a[84:87], v[172:175]
    ds_read_b64_tr_b16 a[144:145], v52 offset:49152
    v_lshlrev_b32 v68, 16, v66
    v_mfma_f32_16x16x32_bf16 v[204:207], a[172:175], a[88:91], v[204:207]
    ds_read_b64_tr_b16 a[146:147], v52 offset:53248
    v_and_b32 v67, 0xffff0000, v65
    v_mfma_f32_16x16x32_bf16 v[236:239], a[172:175], a[92:95], v[236:239]
    v_lshlrev_b32 v66, 16, v65
    s_waitcnt lgkmcnt(15)
    v_mfma_f32_16x16x32_bf16 v[144:147], a[176:179], a[80:83], v[144:147]
    ds_read_b64_tr_b16 a[148:149], v53 offset:49152
    buffer_load_dwordx4 v18, s[52:55], s83 offen offset:1024 lds
    v_and_b32 v65, 0xffff0000, v64
    v_mfma_f32_16x16x32_bf16 v[176:179], a[176:179], a[84:87], v[176:179]
    ds_read_b64_tr_b16 a[150:151], v53 offset:53248
    v_lshlrev_b32 v64, 16, v64
    v_mfma_f32_16x16x32_bf16 v[208:211], a[176:179], a[88:91], v[208:211]
    v_lshlrev_b32 v72, 16, v76
    v_mfma_f32_16x16x32_bf16 v[240:243], a[176:179], a[92:95], v[240:243]
    ds_read_b64_tr_b16 a[152:153], v54 offset:49152
    v_and_b32 v73, 0xffff0000, v76
    s_waitcnt lgkmcnt(15)
    v_mfma_f32_16x16x32_bf16 v[148:151], a[180:183], a[80:83], v[148:151]
    ds_read_b64_tr_b16 a[154:155], v54 offset:53248
    v_lshlrev_b32 v74, 16, v77
    v_mfma_f32_16x16x32_bf16 v[180:183], a[180:183], a[84:87], v[180:183]
    v_and_b32 v75, 0xffff0000, v77
    v_mfma_f32_16x16x32_bf16 v[212:215], a[180:183], a[88:91], v[212:215]
    ds_read_b64_tr_b16 a[156:157], v55 offset:49152
    v_lshlrev_b32 v76, 16, v78
    v_mfma_f32_16x16x32_bf16 v[244:247], a[180:183], a[92:95], v[244:247]
    ds_read_b64_tr_b16 a[158:159], v55 offset:53248
    v_and_b32 v77, 0xffff0000, v78
    v_mfma_f32_16x16x32_bf16 v[152:155], a[184:187], a[80:83], v[152:155]
    v_lshlrev_b32 v78, 16, v79
    v_mfma_f32_16x16x32_bf16 v[184:187], a[184:187], a[84:87], v[184:187]
    v_and_b32 v79, 0xffff0000, v79
    v_mfma_f32_16x16x32_bf16 v[216:219], a[184:187], a[88:91], v[216:219]
    v_mfma_f32_16x16x32_bf16 v[248:251], a[184:187], a[92:95], v[248:251]
    s_waitcnt lgkmcnt(15)
    v_mfma_f32_16x16x32_bf16 v[156:159], a[188:191], a[80:83], v[156:159]
    buffer_load_dword v44, off, s[56:59], s76 sc1
    v_mfma_f32_16x16x32_bf16 v[188:191], a[188:191], a[84:87], v[188:191]
    v_mfma_f32_16x16x32_bf16 v[220:223], a[188:191], a[88:91], v[220:223]
    v_mfma_f32_16x16x32_bf16 v[252:255], a[188:191], a[92:95], v[252:255]
    s_waitcnt lgkmcnt(0)
    s_barrier
    s_waitcnt vmcnt(47)
    v_mfma_f32_16x16x32_bf16 v[128:131], a[128:131], a[96:99], v[128:131]
    buffer_load_dwordx4 a[80:83], v21, s[56:59], s68 offen sc1
    s_waitcnt vmcnt(47)
    v_mfma_f32_16x16x32_bf16 v[160:163], a[128:131], a[100:103], v[160:163]
    ds_read_b64_tr_b16 a[160:161], v48 offset:57344
    s_waitcnt vmcnt(46)
    v_mfma_f32_16x16x32_bf16 v[192:195], a[128:131], a[104:107], v[192:195]
    ds_read_b64_tr_b16 a[162:163], v48 offset:61440
    buffer_load_dwordx4 a[84:87], v22, s[56:59], s68 offen sc1
    s_waitcnt vmcnt(46)
    v_mfma_f32_16x16x32_bf16 v[224:227], a[128:131], a[108:111], v[224:227]
    v_mfma_f32_16x16x32_bf16 v[132:135], a[132:135], a[96:99], v[132:135]
    ds_read_b64_tr_b16 a[164:165], v49 offset:57344
    buffer_load_dwordx4 a[88:91], v23, s[56:59], s68 offen sc1
    v_mfma_f32_16x16x32_bf16 v[164:167], a[132:135], a[100:103], v[164:167]
    ds_read_b64_tr_b16 a[166:167], v49 offset:61440
    v_mfma_f32_16x16x32_bf16 v[196:199], a[132:135], a[104:107], v[196:199]
    buffer_load_dwordx4 a[92:95], v24, s[56:59], s68 offen sc1
    v_mfma_f32_16x16x32_bf16 v[228:231], a[132:135], a[108:111], v[228:231]
    ds_read_b64_tr_b16 a[168:169], v50 offset:57344
    v_mfma_f32_16x16x32_bf16 v[136:139], a[136:139], a[96:99], v[136:139]
    ds_read_b64_tr_b16 a[170:171], v50 offset:61440
    s_add_u32 s68, s68, 16384
    v_mfma_f32_16x16x32_bf16 v[168:171], a[136:139], a[100:103], v[168:171]
    v_mfma_f32_16x16x32_bf16 v[200:203], a[136:139], a[104:107], v[200:203]
    ds_read_b64_tr_b16 a[172:173], v51 offset:57344
    v_cndmask_b32 v88, v80, v84, s[4:5]
    v_mfma_f32_16x16x32_bf16 v[232:235], a[136:139], a[108:111], v[232:235]
    ds_read_b64_tr_b16 a[174:175], v51 offset:61440
    s_mov_b32 s82, 262144
    s_add_u32 m0, s3, 98304
    v_cndmask_b32 v89, v81, v85, s[4:5]
    v_mfma_f32_16x16x32_bf16 v[140:143], a[140:143], a[96:99], v[140:143]
    buffer_load_dwordx4 v17, s[52:55], s82 offen lds
    v_cndmask_b32 v90, v82, v86, s[4:5]
    v_mfma_f32_16x16x32_bf16 v[172:175], a[140:143], a[100:103], v[172:175]
    ds_read_b64_tr_b16 a[176:177], v52 offset:57344
    v_cndmask_b32 v91, v83, v87, s[4:5]
    v_mfma_f32_16x16x32_bf16 v[204:207], a[140:143], a[104:107], v[204:207]
    ds_read_b64_tr_b16 a[178:179], v52 offset:61440
    v_cndmask_b32 v80, v84, v80, s[4:5]
    v_mfma_f32_16x16x32_bf16 v[236:239], a[140:143], a[108:111], v[236:239]
    v_cndmask_b32 v81, v85, v81, s[4:5]
    v_mfma_f32_16x16x32_bf16 v[144:147], a[144:147], a[96:99], v[144:147]
    ds_read_b64_tr_b16 a[180:181], v53 offset:57344
    buffer_load_dwordx4 v18, s[52:55], s82 offen offset:1024 lds
    v_cndmask_b32 v82, v86, v82, s[4:5]
    v_mfma_f32_16x16x32_bf16 v[176:179], a[144:147], a[100:103], v[176:179]
    ds_read_b64_tr_b16 a[182:183], v53 offset:61440
    v_cndmask_b32 v83, v87, v83, s[4:5]
    v_mfma_f32_16x16x32_bf16 v[208:211], a[144:147], a[104:107], v[208:211]
    v_mov_b32_dpp v92, v88 row_ror:8 row_mask:0xf bank_mask:0xf
    v_mfma_f32_16x16x32_bf16 v[240:243], a[144:147], a[108:111], v[240:243]
    ds_read_b64_tr_b16 a[184:185], v54 offset:57344
    v_mov_b32_dpp v93, v89 row_ror:8 row_mask:0xf bank_mask:0xf
    v_mfma_f32_16x16x32_bf16 v[148:151], a[148:151], a[96:99], v[148:151]
    ds_read_b64_tr_b16 a[186:187], v54 offset:61440
    v_mov_b32_dpp v94, v90 row_ror:8 row_mask:0xf bank_mask:0xf
    v_mfma_f32_16x16x32_bf16 v[180:183], a[148:151], a[100:103], v[180:183]
    s_mov_b32 s83, 327680
    s_add_u32 m0, s3, 106496
    v_mov_b32_dpp v95, v91 row_ror:8 row_mask:0xf bank_mask:0xf
    v_mfma_f32_16x16x32_bf16 v[212:215], a[148:151], a[104:107], v[212:215]
    ds_read_b64_tr_b16 a[188:189], v55 offset:57344
    buffer_load_dwordx4 v17, s[52:55], s83 offen lds
    v_permlane16_swap_b32 v80, v82
    v_mfma_f32_16x16x32_bf16 v[244:247], a[148:151], a[108:111], v[244:247]
    ds_read_b64_tr_b16 a[190:191], v55 offset:61440
    v_permlane16_swap_b32 v81, v83
    v_mfma_f32_16x16x32_bf16 v[152:155], a[152:155], a[96:99], v[152:155]
    v_permlane16_swap_b32 v92, v94
    v_mfma_f32_16x16x32_bf16 v[184:187], a[152:155], a[100:103], v[184:187]
    v_permlane16_swap_b32 v93, v95
    v_mfma_f32_16x16x32_bf16 v[216:219], a[152:155], a[104:107], v[216:219]
    buffer_load_dwordx4 v18, s[52:55], s83 offen offset:1024 lds
    v_mfma_f32_16x16x32_bf16 v[248:251], a[152:155], a[108:111], v[248:251]
    v_mfma_f32_16x16x32_bf16 v[156:159], a[156:159], a[96:99], v[156:159]
    v_mfma_f32_16x16x32_bf16 v[188:191], a[156:159], a[100:103], v[188:191]
    v_mfma_f32_16x16x32_bf16 v[220:223], a[156:159], a[104:107], v[220:223]
    v_mfma_f32_16x16x32_bf16 v[252:255], a[156:159], a[108:111], v[252:255]
    s_waitcnt vmcnt(49) lgkmcnt(14)
    v_mfma_f32_16x16x32_bf16 v[128:131], a[160:163], a[112:115], v[128:131]
    buffer_load_dwordx4 a[96:99], v21, s[56:59], s68 offen sc1
    s_waitcnt vmcnt(49)
    v_mfma_f32_16x16x32_bf16 v[160:163], a[160:163], a[116:119], v[160:163]
    ds_read_b64_tr_b16 a[128:129], v56 offset:0
    s_waitcnt vmcnt(48)
    v_mfma_f32_16x16x32_bf16 v[192:195], a[160:163], a[120:123], v[192:195]
    ds_read_b64_tr_b16 a[130:131], v56 offset:4096
    buffer_load_dwordx4 a[100:103], v22, s[56:59], s68 offen sc1
    s_waitcnt vmcnt(48)
    v_mfma_f32_16x16x32_bf16 v[224:227], a[160:163], a[124:127], v[224:227]
    s_waitcnt lgkmcnt(14)
    v_mfma_f32_16x16x32_bf16 v[132:135], a[164:167], a[112:115], v[132:135]
    ds_read_b64_tr_b16 a[132:133], v57 offset:0
    buffer_load_dwordx4 a[104:107], v23, s[56:59], s68 offen sc1
    v_mfma_f32_16x16x32_bf16 v[164:167], a[164:167], a[116:119], v[164:167]
    ds_read_b64_tr_b16 a[134:135], v57 offset:4096
    v_mfma_f32_16x16x32_bf16 v[196:199], a[164:167], a[120:123], v[196:199]
    buffer_load_dwordx4 a[108:111], v24, s[56:59], s68 offen sc1
    v_mfma_f32_16x16x32_bf16 v[228:231], a[164:167], a[124:127], v[228:231]
    ds_read_b64_tr_b16 a[136:137], v58 offset:0
    s_waitcnt lgkmcnt(15)
    v_mfma_f32_16x16x32_bf16 v[136:139], a[168:171], a[112:115], v[136:139]
    ds_read_b64_tr_b16 a[138:139], v58 offset:4096
    s_add_u32 s68, s68, 16384
    v_mfma_f32_16x16x32_bf16 v[168:171], a[168:171], a[116:119], v[168:171]
    v_mfma_f32_16x16x32_bf16 v[200:203], a[168:171], a[120:123], v[200:203]
    ds_read_b64_tr_b16 a[140:141], v59 offset:0
    v_and_b32 v87, 0xffff0000, v83
    v_mfma_f32_16x16x32_bf16 v[232:235], a[168:171], a[124:127], v[232:235]
    ds_read_b64_tr_b16 a[142:143], v59 offset:4096
    s_mov_b32 s82, 393216
    s_add_u32 m0, s3, 114688
    v_lshlrev_b32 v86, 16, v83
    s_waitcnt lgkmcnt(15)
    v_mfma_f32_16x16x32_bf16 v[140:143], a[172:175], a[112:115], v[140:143]
    buffer_load_dwordx4 v17, s[52:55], s82 offen lds
    v_and_b32 v85, 0xffff0000, v82
    v_mfma_f32_16x16x32_bf16 v[172:175], a[172:175], a[116:119], v[172:175]
    ds_read_b64_tr_b16 a[144:145], v60 offset:0
    v_lshlrev_b32 v84, 16, v82
    v_mfma_f32_16x16x32_bf16 v[204:207], a[172:175], a[120:123], v[204:207]
    ds_read_b64_tr_b16 a[146:147], v60 offset:4096
    v_and_b32 v83, 0xffff0000, v81
    v_mfma_f32_16x16x32_bf16 v[236:239], a[172:175], a[124:127], v[236:239]
    v_lshlrev_b32 v82, 16, v81
    s_waitcnt lgkmcnt(15)
    v_mfma_f32_16x16x32_bf16 v[144:147], a[176:179], a[112:115], v[144:147]
    ds_read_b64_tr_b16 a[148:149], v61 offset:0
    buffer_load_dwordx4 v18, s[52:55], s82 offen offset:1024 lds
    v_and_b32 v81, 0xffff0000, v80
    v_mfma_f32_16x16x32_bf16 v[176:179], a[176:179], a[116:119], v[176:179]
    ds_read_b64_tr_b16 a[150:151], v61 offset:4096
    v_lshlrev_b32 v80, 16, v80
    v_mfma_f32_16x16x32_bf16 v[208:211], a[176:179], a[120:123], v[208:211]
    v_lshlrev_b32 v88, 16, v92
    v_mfma_f32_16x16x32_bf16 v[240:243], a[176:179], a[124:127], v[240:243]
    ds_read_b64_tr_b16 a[152:153], v62 offset:0
    v_and_b32 v89, 0xffff0000, v92
    s_waitcnt lgkmcnt(15)
    v_mfma_f32_16x16x32_bf16 v[148:151], a[180:183], a[112:115], v[148:151]
    ds_read_b64_tr_b16 a[154:155], v62 offset:4096
    v_lshlrev_b32 v90, 16, v93
    v_mfma_f32_16x16x32_bf16 v[180:183], a[180:183], a[116:119], v[180:183]
    v_and_b32 v91, 0xffff0000, v93
    v_mfma_f32_16x16x32_bf16 v[212:215], a[180:183], a[120:123], v[212:215]
    ds_read_b64_tr_b16 a[156:157], v63 offset:0
    v_lshlrev_b32 v92, 16, v94
    v_mfma_f32_16x16x32_bf16 v[244:247], a[180:183], a[124:127], v[244:247]
    ds_read_b64_tr_b16 a[158:159], v63 offset:4096
    v_and_b32 v93, 0xffff0000, v94
    v_mfma_f32_16x16x32_bf16 v[152:155], a[184:187], a[112:115], v[152:155]
    v_lshlrev_b32 v94, 16, v95
    v_mfma_f32_16x16x32_bf16 v[184:187], a[184:187], a[116:119], v[184:187]
    v_and_b32 v95, 0xffff0000, v95
    v_mfma_f32_16x16x32_bf16 v[216:219], a[184:187], a[120:123], v[216:219]
    v_mfma_f32_16x16x32_bf16 v[248:251], a[184:187], a[124:127], v[248:251]
    s_waitcnt lgkmcnt(15)
    v_mfma_f32_16x16x32_bf16 v[156:159], a[188:191], a[112:115], v[156:159]
    v_mfma_f32_16x16x32_bf16 v[188:191], a[188:191], a[116:119], v[188:191]
    v_mfma_f32_16x16x32_bf16 v[220:223], a[188:191], a[120:123], v[220:223]
    v_mfma_f32_16x16x32_bf16 v[252:255], a[188:191], a[124:127], v[252:255]
    s_waitcnt lgkmcnt(0)
    s_barrier
    s_waitcnt vmcnt(47)
    v_mfma_f32_16x16x32_bf16 v[128:131], a[128:131], a[0:3], v[128:131]
    buffer_load_dwordx4 a[112:115], v21, s[56:59], s68 offen sc1
    s_waitcnt vmcnt(47)
    v_mfma_f32_16x16x32_bf16 v[160:163], a[128:131], a[4:7], v[160:163]
    ds_read_b64_tr_b16 a[160:161], v56 offset:8192
    s_waitcnt vmcnt(46)
    v_mfma_f32_16x16x32_bf16 v[192:195], a[128:131], a[8:11], v[192:195]
    ds_read_b64_tr_b16 a[162:163], v56 offset:12288
    buffer_load_dwordx4 a[116:119], v22, s[56:59], s68 offen sc1
    s_waitcnt vmcnt(46)
    v_mfma_f32_16x16x32_bf16 v[224:227], a[128:131], a[12:15], v[224:227]
    v_mfma_f32_16x16x32_bf16 v[132:135], a[132:135], a[0:3], v[132:135]
    ds_read_b64_tr_b16 a[164:165], v57 offset:8192
    buffer_load_dwordx4 a[120:123], v23, s[56:59], s68 offen sc1
    v_mfma_f32_16x16x32_bf16 v[164:167], a[132:135], a[4:7], v[164:167]
    ds_read_b64_tr_b16 a[166:167], v57 offset:12288
    v_mfma_f32_16x16x32_bf16 v[196:199], a[132:135], a[8:11], v[196:199]
    buffer_load_dwordx4 a[124:127], v24, s[56:59], s68 offen sc1
    v_mfma_f32_16x16x32_bf16 v[228:231], a[132:135], a[12:15], v[228:231]
    ds_read_b64_tr_b16 a[168:169], v58 offset:8192
    v_mfma_f32_16x16x32_bf16 v[136:139], a[136:139], a[0:3], v[136:139]
    ds_read_b64_tr_b16 a[170:171], v58 offset:12288
    s_add_u32 s68, s68, 16384
    v_mfma_f32_16x16x32_bf16 v[168:171], a[136:139], a[4:7], v[168:171]
    v_mfma_f32_16x16x32_bf16 v[200:203], a[136:139], a[8:11], v[200:203]
    ds_read_b64_tr_b16 a[172:173], v59 offset:8192
    v_mfma_f32_16x16x32_bf16 v[232:235], a[136:139], a[12:15], v[232:235]
    ds_read_b64_tr_b16 a[174:175], v59 offset:12288
    s_mov_b32 s83, 458752
    s_add_u32 m0, s3, 122880
    v_mfma_f32_16x16x32_bf16 v[140:143], a[140:143], a[0:3], v[140:143]
    buffer_load_dwordx4 v17, s[52:55], s83 offen lds
    v_mfma_f32_16x16x32_bf16 v[172:175], a[140:143], a[4:7], v[172:175]
    ds_read_b64_tr_b16 a[176:177], v60 offset:8192
    v_mfma_f32_16x16x32_bf16 v[204:207], a[140:143], a[8:11], v[204:207]
    ds_read_b64_tr_b16 a[178:179], v60 offset:12288
    v_mfma_f32_16x16x32_bf16 v[236:239], a[140:143], a[12:15], v[236:239]
    v_mfma_f32_16x16x32_bf16 v[144:147], a[144:147], a[0:3], v[144:147]
    ds_read_b64_tr_b16 a[180:181], v61 offset:8192
    buffer_load_dwordx4 v18, s[52:55], s83 offen offset:1024 lds
    v_mfma_f32_16x16x32_bf16 v[176:179], a[144:147], a[4:7], v[176:179]
    ds_read_b64_tr_b16 a[182:183], v61 offset:12288
    v_mfma_f32_16x16x32_bf16 v[208:211], a[144:147], a[8:11], v[208:211]
    v_mfma_f32_16x16x32_bf16 v[240:243], a[144:147], a[12:15], v[240:243]
    ds_read_b64_tr_b16 a[184:185], v62 offset:8192
    v_mfma_f32_16x16x32_bf16 v[148:151], a[148:151], a[0:3], v[148:151]
    ds_read_b64_tr_b16 a[186:187], v62 offset:12288
    v_mfma_f32_16x16x32_bf16 v[180:183], a[148:151], a[4:7], v[180:183]
    v_mfma_f32_16x16x32_bf16 v[212:215], a[148:151], a[8:11], v[212:215]
    ds_read_b64_tr_b16 a[188:189], v63 offset:8192
    v_mfma_f32_16x16x32_bf16 v[244:247], a[148:151], a[12:15], v[244:247]
    ds_read_b64_tr_b16 a[190:191], v63 offset:12288
    v_mfma_f32_16x16x32_bf16 v[152:155], a[152:155], a[0:3], v[152:155]
    v_mfma_f32_16x16x32_bf16 v[184:187], a[152:155], a[4:7], v[184:187]
    v_mfma_f32_16x16x32_bf16 v[216:219], a[152:155], a[8:11], v[216:219]
    v_mfma_f32_16x16x32_bf16 v[248:251], a[152:155], a[12:15], v[248:251]
    v_mfma_f32_16x16x32_bf16 v[156:159], a[156:159], a[0:3], v[156:159]
    v_mfma_f32_16x16x32_bf16 v[188:191], a[156:159], a[4:7], v[188:191]
    v_mfma_f32_16x16x32_bf16 v[220:223], a[156:159], a[8:11], v[220:223]
    v_mfma_f32_16x16x32_bf16 v[252:255], a[156:159], a[12:15], v[252:255]
    s_waitcnt vmcnt(47) lgkmcnt(14)
    v_mfma_f32_16x16x32_bf16 v[128:131], a[160:163], a[16:19], v[128:131]
    s_waitcnt vmcnt(41)
    v_readfirstlane_b32 s86, v43
    s_bfe_u32 s86, s86, 0x80010
    s_cmp_eq_u32 s86, 16
    s_cbranch_scc0 L_spC
L_okC:
    buffer_load_dwordx4 a[0:3], v21, s[56:59], s68 offen sc1
    v_mfma_f32_16x16x32_bf16 v[160:163], a[160:163], a[20:23], v[160:163]
    ds_read_b64_tr_b16 a[128:129], v56 offset:16384
    v_mfma_f32_16x16x32_bf16 v[192:195], a[160:163], a[24:27], v[192:195]
    ds_read_b64_tr_b16 a[130:131], v56 offset:20480
    buffer_load_dwordx4 a[4:7], v22, s[56:59], s68 offen sc1
    v_mfma_f32_16x16x32_bf16 v[224:227], a[160:163], a[28:31], v[224:227]
    s_waitcnt lgkmcnt(14)
    v_mfma_f32_16x16x32_bf16 v[132:135], a[164:167], a[16:19], v[132:135]
    ds_read_b64_tr_b16 a[132:133], v57 offset:16384
    buffer_load_dwordx4 a[8:11], v23, s[56:59], s68 offen sc1
    v_mfma_f32_16x16x32_bf16 v[164:167], a[164:167], a[20:23], v[164:167]
    ds_read_b64_tr_b16 a[134:135], v57 offset:20480
    v_mfma_f32_16x16x32_bf16 v[196:199], a[164:167], a[24:27], v[196:199]
    buffer_load_dwordx4 a[12:15], v24, s[56:59], s68 offen sc1
    v_mfma_f32_16x16x32_bf16 v[228:231], a[164:167], a[28:31], v[228:231]
    ds_read_b64_tr_b16 a[136:137], v58 offset:16384
    s_waitcnt lgkmcnt(15)
    s_branch L_over10
L_stub10:
    s_branch L_stubret
L_over10:
    v_mfma_f32_16x16x32_bf16 v[136:139], a[168:171], a[16:19], v[136:139]
    ds_read_b64_tr_b16 a[138:139], v58 offset:20480
    s_add_u32 s68, s68, 16384
    v_mfma_f32_16x16x32_bf16 v[168:171], a[168:171], a[20:23], v[168:171]
    v_mfma_f32_16x16x32_bf16 v[200:203], a[168:171], a[24:27], v[200:203]
    ds_read_b64_tr_b16 a[140:141], v59 offset:16384
    v_mfma_f32_16x16x32_bf16 v[232:235], a[168:171], a[28:31], v[232:235]
    ds_read_b64_tr_b16 a[142:143], v59 offset:20480
    s_mov_b32 s82, 524288
    s_add_u32 m0, s3, 131072
    s_waitcnt lgkmcnt(15)
    v_mfma_f32_16x16x32_bf16 v[140:143], a[172:175], a[16:19], v[140:143]
    buffer_load_dwordx4 v17, s[52:55], s82 offen lds
    v_mfma_f32_16x16x32_bf16 v[172:175], a[172:175], a[20:23], v[172:175]
    ds_read_b64_tr_b16 a[144:145], v60 offset:16384
    v_mfma_f32_16x16x32_bf16 v[204:207], a[172:175], a[24:27], v[204:207]
    ds_read_b64_tr_b16 a[146:147], v60 offset:20480
    v_mfma_f32_16x16x32_bf16 v[236:239], a[172:175], a[28:31], v[236:239]
    s_waitcnt lgkmcnt(15)
    v_mfma_f32_16x16x32_bf16 v[144:147], a[176:179], a[16:19], v[144:147]
    ds_read_b64_tr_b16 a[148:149], v61 offset:16384
    buffer_load_dwordx4 v18, s[52:55], s82 offen offset:1024 lds
    v_mfma_f32_16x16x32_bf16 v[176:179], a[176:179], a[20:23], v[176:179]
    ds_read_b64_tr_b16 a[150:151], v61 offset:20480
    v_mfma_f32_16x16x32_bf16 v[208:211], a[176:179], a[24:27], v[208:211]
    v_mfma_f32_16x16x32_bf16 v[240:243], a[176:179], a[28:31], v[240:243]
    ds_read_b64_tr_b16 a[152:153], v62 offset:16384
    s_waitcnt lgkmcnt(15)
    v_mfma_f32_16x16x32_bf16 v[148:151], a[180:183], a[16:19], v[148:151]
    ds_read_b64_tr_b16 a[154:155], v62 offset:20480
    v_mfma_f32_16x16x32_bf16 v[180:183], a[180:183], a[20:23], v[180:183]
    v_mfma_f32_16x16x32_bf16 v[212:215], a[180:183], a[24:27], v[212:215]
    ds_read_b64_tr_b16 a[156:157], v63 offset:16384
    v_mfma_f32_16x16x32_bf16 v[244:247], a[180:183], a[28:31], v[244:247]
    ds_read_b64_tr_b16 a[158:159], v63 offset:20480
    v_mfma_f32_16x16x32_bf16 v[152:155], a[184:187], a[16:19], v[152:155]
    v_mfma_f32_16x16x32_bf16 v[184:187], a[184:187], a[20:23], v[184:187]
    v_mfma_f32_16x16x32_bf16 v[216:219], a[184:187], a[24:27], v[216:219]
    v_mfma_f32_16x16x32_bf16 v[248:251], a[184:187], a[28:31], v[248:251]
    s_waitcnt lgkmcnt(15)
    v_mfma_f32_16x16x32_bf16 v[156:159], a[188:191], a[16:19], v[156:159]
    v_mfma_f32_16x16x32_bf16 v[188:191], a[188:191], a[20:23], v[188:191]
    v_mfma_f32_16x16x32_bf16 v[220:223], a[188:191], a[24:27], v[220:223]
    v_mfma_f32_16x16x32_bf16 v[252:255], a[188:191], a[28:31], v[252:255]
    s_waitcnt lgkmcnt(0)
    s_barrier
    s_waitcnt vmcnt(46)
    v_mfma_f32_16x16x32_bf16 v[128:131], a[128:131], a[32:35], v[128:131]
    buffer_load_dwordx4 a[16:19], v21, s[56:59], s68 offen sc1
    s_waitcnt vmcnt(46)
    v_mfma_f32_16x16x32_bf16 v[160:163], a[128:131], a[36:39], v[160:163]
    ds_read_b64_tr_b16 a[160:161], v56 offset:24576
    s_waitcnt vmcnt(45)
    v_mfma_f32_16x16x32_bf16 v[192:195], a[128:131], a[40:43], v[192:195]
    ds_read_b64_tr_b16 a[162:163], v56 offset:28672
    buffer_load_dwordx4 a[20:23], v22, s[56:59], s68 offen sc1
    s_waitcnt vmcnt(45)
    v_mfma_f32_16x16x32_bf16 v[224:227], a[128:131], a[44:47], v[224:227]
    v_mfma_f32_16x16x32_bf16 v[132:135], a[132:135], a[32:35], v[132:135]
    ds_read_b64_tr_b16 a[164:165], v57 offset:24576
    buffer_load_dwordx4 a[24:27], v23, s[56:59], s68 offen sc1
    v_mfma_f32_16x16x32_bf16 v[164:167], a[132:135], a[36:39], v[164:167]
    ds_read_b64_tr_b16 a[166:167], v57 offset:28672
    v_mfma_f32_16x16x32_bf16 v[196:199], a[132:135], a[40:43], v[196:199]
    buffer_load_dwordx4 a[28:31], v24, s[56:59], s68 offen sc1
    v_mfma_f32_16x16x32_bf16 v[228:231], a[132:135], a[44:47], v[228:231]
    ds_read_b64_tr_b16 a[168:169], v58 offset:24576
    v_mfma_f32_16x16x32_bf16 v[136:139], a[136:139], a[32:35], v[136:139]
    ds_read_b64_tr_b16 a[170:171], v58 offset:28672
    s_add_u32 s68, s68, 16384
    v_mfma_f32_16x16x32_bf16 v[168:171], a[136:139], a[36:39], v[168:171]
    v_mfma_f32_16x16x32_bf16 v[200:203], a[136:139], a[40:43], v[200:203]
    ds_read_b64_tr_b16 a[172:173], v59 offset:24576
    v_mfma_f32_16x16x32_bf16 v[232:235], a[136:139], a[44:47], v[232:235]
    ds_read_b64_tr_b16 a[174:175], v59 offset:28672
    s_mov_b32 s83, 589824
    s_add_u32 m0, s3, 139264
    v_mfma_f32_16x16x32_bf16 v[140:143], a[140:143], a[32:35], v[140:143]
    buffer_load_dwordx4 v17, s[52:55], s83 offen lds
    v_mfma_f32_16x16x32_bf16 v[172:175], a[140:143], a[36:39], v[172:175]
    ds_read_b64_tr_b16 a[176:177], v60 offset:24576
    v_mfma_f32_16x16x32_bf16 v[204:207], a[140:143], a[40:43], v[204:207]
    ds_read_b64_tr_b16 a[178:179], v60 offset:28672
    v_mfma_f32_16x16x32_bf16 v[236:239], a[140:143], a[44:47], v[236:239]
    v_mfma_f32_16x16x32_bf16 v[144:147], a[144:147], a[32:35], v[144:147]
    ds_read_b64_tr_b16 a[180:181], v61 offset:24576
    buffer_load_dwordx4 v18, s[52:55], s83 offen offset:1024 lds
    v_mfma_f32_16x16x32_bf16 v[176:179], a[144:147], a[36:39], v[176:179]
    ds_read_b64_tr_b16 a[182:183], v61 offset:28672
    v_mfma_f32_16x16x32_bf16 v[208:211], a[144:147], a[40:43], v[208:211]
    v_mfma_f32_16x16x32_bf16 v[240:243], a[144:147], a[44:47], v[240:243]
    ds_read_b64_tr_b16 a[184:185], v62 offset:24576
    v_mfma_f32_16x16x32_bf16 v[148:151], a[148:151], a[32:35], v[148:151]
    ds_read_b64_tr_b16 a[186:187], v62 offset:28672
    v_mfma_f32_16x16x32_bf16 v[180:183], a[148:151], a[36:39], v[180:183]
    v_mfma_f32_16x16x32_bf16 v[212:215], a[148:151], a[40:43], v[212:215]
    ds_read_b64_tr_b16 a[188:189], v63 offset:24576
    v_mfma_f32_16x16x32_bf16 v[244:247], a[148:151], a[44:47], v[244:247]
    ds_read_b64_tr_b16 a[190:191], v63 offset:28672
    v_mfma_f32_16x16x32_bf16 v[152:155], a[152:155], a[32:35], v[152:155]
    v_mfma_f32_16x16x32_bf16 v[184:187], a[152:155], a[36:39], v[184:187]
    v_mfma_f32_16x16x32_bf16 v[216:219], a[152:155], a[40:43], v[216:219]
    v_mfma_f32_16x16x32_bf16 v[248:251], a[152:155], a[44:47], v[248:251]
    v_mfma_f32_16x16x32_bf16 v[156:159], a[156:159], a[32:35], v[156:159]
    v_mfma_f32_16x16x32_bf16 v[188:191], a[156:159], a[36:39], v[188:191]
    v_mfma_f32_16x16x32_bf16 v[220:223], a[156:159], a[40:43], v[220:223]
    v_mfma_f32_16x16x32_bf16 v[252:255], a[156:159], a[44:47], v[252:255]
    s_waitcnt vmcnt(46) lgkmcnt(14)
    v_mfma_f32_16x16x32_bf16 v[128:131], a[160:163], a[48:51], v[128:131]
    buffer_load_dwordx4 a[32:35], v21, s[56:59], s68 offen sc1
    s_waitcnt vmcnt(46)
    v_mfma_f32_16x16x32_bf16 v[160:163], a[160:163], a[52:55], v[160:163]
    ds_read_b64_tr_b16 a[128:129], v8 offset:0
    s_waitcnt vmcnt(45)
    v_mfma_f32_16x16x32_bf16 v[192:195], a[160:163], a[56:59], v[192:195]
    ds_read_b64_tr_b16 a[130:131], v8 offset:4096
    buffer_load_dwordx4 a[36:39], v22, s[56:59], s68 offen sc1
    s_waitcnt vmcnt(45)
    v_mfma_f32_16x16x32_bf16 v[224:227], a[160:163], a[60:63], v[224:227]
    s_waitcnt lgkmcnt(14)
    v_mfma_f32_16x16x32_bf16 v[132:135], a[164:167], a[48:51], v[132:135]
    ds_read_b64_tr_b16 a[132:133], v9 offset:0
    buffer_load_dwordx4 a[40:43], v23, s[56:59], s68 offen sc1
    v_mfma_f32_16x16x32_bf16 v[164:167], a[164:167], a[52:55], v[164:167]
    ds_read_b64_tr_b16 a[134:135], v9 offset:4096
    v_mfma_f32_16x16x32_bf16 v[196:199], a[164:167], a[56:59], v[196:199]
    buffer_load_dwordx4 a[44:47], v24, s[56:59], s68 offen sc1
    v_mfma_f32_16x16x32_bf16 v[228:231], a[164:167], a[60:63], v[228:231]
    ds_read_b64_tr_b16 a[136:137], v10 offset:0
    s_waitcnt lgkmcnt(15)
    v_mfma_f32_16x16x32_bf16 v[136:139], a[168:171], a[48:51], v[136:139]
    ds_read_b64_tr_b16 a[138:139], v10 offset:4096
    s_add_u32 s68, s68, 16384
    v_mfma_f32_16x16x32_bf16 v[168:171], a[168:171], a[52:55], v[168:171]
    v_mfma_f32_16x16x32_bf16 v[200:203], a[168:171], a[56:59], v[200:203]
    ds_read_b64_tr_b16 a[140:141], v11 offset:0
    v_mfma_f32_16x16x32_bf16 v[232:235], a[168:171], a[60:63], v[232:235]
    ds_read_b64_tr_b16 a[142:143], v11 offset:4096
    s_mov_b32 s82, 655360
    s_add_u32 m0, s3, 147456
    s_waitcnt lgkmcnt(15)
    v_mfma_f32_16x16x32_bf16 v[140:143], a[172:175], a[48:51], v[140:143]
    buffer_load_dwordx4 v17, s[52:55], s82 offen lds
    v_mfma_f32_16x16x32_bf16 v[172:175], a[172:175], a[52:55], v[172:175]
    ds_read_b64_tr_b16 a[144:145], v12 offset:0
    v_mfma_f32_16x16x32_bf16 v[204:207], a[172:175], a[56:59], v[204:207]
    ds_read_b64_tr_b16 a[146:147], v12 offset:4096
    v_mfma_f32_16x16x32_bf16 v[236:239], a[172:175], a[60:63], v[236:239]
    s_waitcnt lgkmcnt(15)
    v_mfma_f32_16x16x32_bf16 v[144:147], a[176:179], a[48:51], v[144:147]
    ds_read_b64_tr_b16 a[148:149], v13 offset:0
    buffer_load_dwordx4 v18, s[52:55], s82 offen offset:1024 lds
    v_mfma_f32_16x16x32_bf16 v[176:179], a[176:179], a[52:55], v[176:179]
    ds_read_b64_tr_b16 a[150:151], v13 offset:4096
    v_mfma_f32_16x16x32_bf16 v[208:211], a[176:179], a[56:59], v[208:211]
    s_lshl_b32 s88, s62, 13
    v_mfma_f32_16x16x32_bf16 v[240:243], a[176:179], a[60:63], v[240:243]
    ds_read_b64_tr_b16 a[152:153], v14 offset:0
    v_add_u32 v48, s88, v48
    s_waitcnt lgkmcnt(15)
    v_mfma_f32_16x16x32_bf16 v[148:151], a[180:183], a[48:51], v[148:151]
    ds_read_b64_tr_b16 a[154:155], v14 offset:4096
    v_add_u32 v49, s88, v49
    v_mfma_f32_16x16x32_bf16 v[180:183], a[180:183], a[52:55], v[180:183]
    v_add_u32 v50, s88, v50
    v_mfma_f32_16x16x32_bf16 v[212:215], a[180:183], a[56:59], v[212:215]
    ds_read_b64_tr_b16 a[156:157], v15 offset:0
    v_add_u32 v51, s88, v51
    v_mfma_f32_16x16x32_bf16 v[244:247], a[180:183], a[60:63], v[244:247]
    ds_read_b64_tr_b16 a[158:159], v15 offset:4096
    v_add_u32 v52, s88, v52
    v_mfma_f32_16x16x32_bf16 v[152:155], a[184:187], a[48:51], v[152:155]
    v_add_u32 v53, s88, v53
    v_mfma_f32_16x16x32_bf16 v[184:187], a[184:187], a[52:55], v[184:187]
    v_add_u32 v54, s88, v54
    v_mfma_f32_16x16x32_bf16 v[216:219], a[184:187], a[56:59], v[216:219]
    v_add_u32 v55, s88, v55
    v_mfma_f32_16x16x32_bf16 v[248:251], a[184:187], a[60:63], v[248:251]
    s_lshl_b32 s84, s65, 3
    s_waitcnt lgkmcnt(15)
    v_mfma_f32_16x16x32_bf16 v[156:159], a[188:191], a[48:51], v[156:159]
    s_lshl_b32 s90, 1, s84
    v_mfma_f32_16x16x32_bf16 v[188:191], a[188:191], a[52:55], v[188:191]
    v_mov_b32 v25, s90
    v_mfma_f32_16x16x32_bf16 v[220:223], a[188:191], a[56:59], v[220:223]
    v_mfma_f32_16x16x32_bf16 v[252:255], a[188:191], a[60:63], v[252:255]
    s_waitcnt lgkmcnt(0)
    s_barrier
    s_waitcnt vmcnt(44)
    v_mfma_f32_16x16x32_bf16 v[128:131], a[128:131], a[64:67], v[128:131]
    buffer_load_dwordx4 a[48:51], v21, s[56:59], s68 offen sc1
    s_waitcnt vmcnt(44)
    v_mfma_f32_16x16x32_bf16 v[160:163], a[128:131], a[68:71], v[160:163]
    ds_read_b64_tr_b16 a[160:161], v8 offset:8192
    s_waitcnt vmcnt(43)
    v_mfma_f32_16x16x32_bf16 v[192:195], a[128:131], a[72:75], v[192:195]
    ds_read_b64_tr_b16 a[162:163], v8 offset:12288
    buffer_load_dwordx4 a[52:55], v22, s[56:59], s68 offen sc1
    s_waitcnt vmcnt(43)
    v_mfma_f32_16x16x32_bf16 v[224:227], a[128:131], a[76:79], v[224:227]
    v_mfma_f32_16x16x32_bf16 v[132:135], a[132:135], a[64:67], v[132:135]
    ds_read_b64_tr_b16 a[164:165], v9 offset:8192
    buffer_load_dwordx4 a[56:59], v23, s[56:59], s68 offen sc1
    v_mfma_f32_16x16x32_bf16 v[164:167], a[132:135], a[68:71], v[164:167]
    ds_read_b64_tr_b16 a[166:167], v9 offset:12288
    v_mfma_f32_16x16x32_bf16 v[196:199], a[132:135], a[72:75], v[196:199]
    buffer_load_dwordx4 a[60:63], v24, s[56:59], s68 offen sc1
    v_mfma_f32_16x16x32_bf16 v[228:231], a[132:135], a[76:79], v[228:231]
    ds_read_b64_tr_b16 a[168:169], v10 offset:8192
    v_mfma_f32_16x16x32_bf16 v[136:139], a[136:139], a[64:67], v[136:139]
    ds_read_b64_tr_b16 a[170:171], v10 offset:12288
    s_add_u32 s68, s68, 16384
    v_mfma_f32_16x16x32_bf16 v[168:171], a[136:139], a[68:71], v[168:171]
    v_mfma_f32_16x16x32_bf16 v[200:203], a[136:139], a[72:75], v[200:203]
    ds_read_b64_tr_b16 a[172:173], v11 offset:8192
    v_mfma_f32_16x16x32_bf16 v[232:235], a[136:139], a[76:79], v[232:235]
    ds_read_b64_tr_b16 a[174:175], v11 offset:12288
    s_mov_b32 s83, 720896
    s_add_u32 m0, s3, 155648
    v_mfma_f32_16x16x32_bf16 v[140:143], a[140:143], a[64:67], v[140:143]
    buffer_load_dwordx4 v17, s[52:55], s83 offen lds
    v_mfma_f32_16x16x32_bf16 v[172:175], a[140:143], a[68:71], v[172:175]
    ds_read_b64_tr_b16 a[176:177], v12 offset:8192
    v_mfma_f32_16x16x32_bf16 v[204:207], a[140:143], a[72:75], v[204:207]
    ds_read_b64_tr_b16 a[178:179], v12 offset:12288
    v_mfma_f32_16x16x32_bf16 v[236:239], a[140:143], a[76:79], v[236:239]
    v_mfma_f32_16x16x32_bf16 v[144:147], a[144:147], a[64:67], v[144:147]
    ds_read_b64_tr_b16 a[180:181], v13 offset:8192
    buffer_load_dwordx4 v18, s[52:55], s83 offen offset:1024 lds
    v_mfma_f32_16x16x32_bf16 v[176:179], a[144:147], a[68:71], v[176:179]
    ds_read_b64_tr_b16 a[182:183], v13 offset:12288
    v_mfma_f32_16x16x32_bf16 v[208:211], a[144:147], a[72:75], v[208:211]
    v_add_u32 v56, s88, v56
    v_mfma_f32_16x16x32_bf16 v[240:243], a[144:147], a[76:79], v[240:243]
    ds_read_b64_tr_b16 a[184:185], v14 offset:8192
    v_add_u32 v57, s88, v57
    v_mfma_f32_16x16x32_bf16 v[148:151], a[148:151], a[64:67], v[148:151]
    ds_read_b64_tr_b16 a[186:187], v14 offset:12288
    v_add_u32 v58, s88, v58
    v_mfma_f32_16x16x32_bf16 v[180:183], a[148:151], a[68:71], v[180:183]
    v_add_u32 v59, s88, v59
    v_mfma_f32_16x16x32_bf16 v[212:215], a[148:151], a[72:75], v[212:215]
    ds_read_b64_tr_b16 a[188:189], v15 offset:8192
    v_add_u32 v60, s88, v60
    v_mfma_f32_16x16x32_bf16 v[244:247], a[148:151], a[76:79], v[244:247]
    ds_read_b64_tr_b16 a[190:191], v15 offset:12288
    v_add_u32 v61, s88, v61
    v_mfma_f32_16x16x32_bf16 v[152:155], a[152:155], a[64:67], v[152:155]
    v_add_u32 v62, s88, v62
    v_mfma_f32_16x16x32_bf16 v[184:187], a[152:155], a[68:71], v[184:187]
    v_add_u32 v63, s88, v63
    v_mfma_f32_16x16x32_bf16 v[216:219], a[152:155], a[72:75], v[216:219]
    s_lshl_b32 s84, s60, 13
    v_mfma_f32_16x16x32_bf16 v[248:251], a[152:155], a[76:79], v[248:251]
    v_add_u32 v19, s84, v16
    v_mfma_f32_16x16x32_bf16 v[156:159], a[156:159], a[64:67], v[156:159]
    v_xor_b32 v20, 0x2000, v19
    v_mfma_f32_16x16x32_bf16 v[188:191], a[156:159], a[68:71], v[188:191]
    v_mfma_f32_16x16x32_bf16 v[220:223], a[156:159], a[72:75], v[220:223]
    v_mfma_f32_16x16x32_bf16 v[252:255], a[156:159], a[76:79], v[252:255]
    s_waitcnt vmcnt(43) lgkmcnt(14)
    v_mfma_f32_16x16x32_bf16 v[128:131], a[160:163], a[80:83], v[128:131]
    v_readfirstlane_b32 s86, v44
    s_cmp_eq_u32 s86, 64
    s_cbranch_scc0 L_spO
L_okO:
    s_add_u32 s89, s69, 24576
    s_waitcnt vmcnt(42)
    v_mfma_f32_16x16x32_bf16 v[160:163], a[160:163], a[84:87], v[160:163]
    ds_read_b64_tr_b16 a[128:129], v8 offset:16384
    s_waitcnt vmcnt(41)
    v_mfma_f32_16x16x32_bf16 v[192:195], a[160:163], a[88:91], v[192:195]
    ds_read_b64_tr_b16 a[130:131], v8 offset:20480
    s_waitcnt vmcnt(40)
    v_mfma_f32_16x16x32_bf16 v[224:227], a[160:163], a[92:95], v[224:227]
    buffer_load_dwordx4 a[64:67], v3, s[56:59], s69 offen offset:0 sc1
    s_waitcnt lgkmcnt(14)
    v_mfma_f32_16x16x32_bf16 v[132:135], a[164:167], a[80:83], v[132:135]
    ds_read_b64_tr_b16 a[132:133], v9 offset:16384
    v_mfma_f32_16x16x32_bf16 v[164:167], a[164:167], a[84:87], v[164:167]
    ds_read_b64_tr_b16 a[134:135], v9 offset:20480
    v_mfma_f32_16x16x32_bf16 v[196:199], a[164:167], a[88:91], v[196:199]
    buffer_load_dwordx4 a[68:71], v4, s[56:59], s69 offen offset:0 sc1
    v_mfma_f32_16x16x32_bf16 v[228:231], a[164:167], a[92:95], v[228:231]
    ds_read_b64_tr_b16 a[136:137], v10 offset:16384
    s_waitcnt lgkmcnt(15)
    v_mfma_f32_16x16x32_bf16 v[136:139], a[168:171], a[80:83], v[136:139]
    ds_read_b64_tr_b16 a[138:139], v10 offset:20480
    v_mfma_f32_16x16x32_bf16 v[168:171], a[168:171], a[84:87], v[168:171]
    buffer_load_dwordx4 a[72:75], v3, s[56:59], s69 offen offset:2048 sc1
    v_mfma_f32_16x16x32_bf16 v[200:203], a[168:171], a[88:91], v[200:203]
    ds_read_b64_tr_b16 a[140:141], v11 offset:16384
    v_mfma_f32_16x16x32_bf16 v[232:235], a[168:171], a[92:95], v[232:235]
    ds_read_b64_tr_b16 a[142:143], v11 offset:20480
    s_mov_b32 s82, 786432
    s_add_u32 m0, s3, 0
    s_waitcnt lgkmcnt(15)
    v_mfma_f32_16x16x32_bf16 v[140:143], a[172:175], a[80:83], v[140:143]
    buffer_load_dwordx4 a[76:79], v4, s[56:59], s69 offen offset:2048 sc1
    buffer_load_dwordx4 v17, s[52:55], s82 offen lds
    v_mfma_f32_16x16x32_bf16 v[172:175], a[172:175], a[84:87], v[172:175]
    ds_read_b64_tr_b16 a[144:145], v12 offset:16384
    v_mfma_f32_16x16x32_bf16 v[204:207], a[172:175], a[88:91], v[204:207]
    ds_read_b64_tr_b16 a[146:147], v12 offset:20480
    v_mfma_f32_16x16x32_bf16 v[236:239], a[172:175], a[92:95], v[236:239]
    s_add_u32 s69, s69, 4096
    s_waitcnt lgkmcnt(15)
    v_mfma_f32_16x16x32_bf16 v[144:147], a[176:179], a[80:83], v[144:147]
    ds_read_b64_tr_b16 a[148:149], v13 offset:16384
    buffer_load_dwordx4 v18, s[52:55], s82 offen offset:1024 lds
    v_mfma_f32_16x16x32_bf16 v[176:179], a[176:179], a[84:87], v[176:179]
    ds_read_b64_tr_b16 a[150:151], v13 offset:20480
    v_mfma_f32_16x16x32_bf16 v[208:211], a[176:179], a[88:91], v[208:211]
    buffer_load_dwordx4 a[224:227], v3, s[56:59], s89 offen offset:0 sc1
    v_mfma_f32_16x16x32_bf16 v[240:243], a[176:179], a[92:95], v[240:243]
    ds_read_b64_tr_b16 a[152:153], v14 offset:16384
    s_waitcnt lgkmcnt(15)
    v_mfma_f32_16x16x32_bf16 v[148:151], a[180:183], a[80:83], v[148:151]
    ds_read_b64_tr_b16 a[154:155], v14 offset:20480
    v_mfma_f32_16x16x32_bf16 v[180:183], a[180:183], a[84:87], v[180:183]
    buffer_load_dwordx4 a[228:231], v4, s[56:59], s89 offen offset:0 sc1
    v_mfma_f32_16x16x32_bf16 v[212:215], a[180:183], a[88:91], v[212:215]
    ds_read_b64_tr_b16 a[156:157], v15 offset:16384
    v_mfma_f32_16x16x32_bf16 v[244:247], a[180:183], a[92:95], v[244:247]
    ds_read_b64_tr_b16 a[158:159], v15 offset:20480
    v_mfma_f32_16x16x32_bf16 v[152:155], a[184:187], a[80:83], v[152:155]
    v_mfma_f32_16x16x32_bf16 v[184:187], a[184:187], a[84:87], v[184:187]
    v_mfma_f32_16x16x32_bf16 v[216:219], a[184:187], a[88:91], v[216:219]
    v_mfma_f32_16x16x32_bf16 v[248:251], a[184:187], a[92:95], v[248:251]
    s_waitcnt lgkmcnt(15)
    v_mfma_f32_16x16x32_bf16 v[156:159], a[188:191], a[80:83], v[156:159]
    v_mfma_f32_16x16x32_bf16 v[188:191], a[188:191], a[84:87], v[188:191]
    v_mfma_f32_16x16x32_bf16 v[220:223], a[188:191], a[88:91], v[220:223]
    v_mfma_f32_16x16x32_bf16 v[252:255], a[188:191], a[92:95], v[252:255]
    s_waitcnt lgkmcnt(0)
    s_barrier
    s_waitcnt vmcnt(43)
    v_mfma_f32_16x16x32_bf16 v[128:131], a[128:131], a[96:99], v[128:131]
    buffer_load_dwordx4 a[80:83], v3, s[56:59], s69 offen offset:0 sc1
    s_waitcnt vmcnt(43)
    v_mfma_f32_16x16x32_bf16 v[160:163], a[128:131], a[100:103], v[160:163]
    ds_read_b64_tr_b16 a[160:161], v8 offset:24576
    s_waitcnt vmcnt(42)
    v_mfma_f32_16x16x32_bf16 v[192:195], a[128:131], a[104:107], v[192:195]
    ds_read_b64_tr_b16 a[162:163], v8 offset:28672
    s_waitcnt vmcnt(41)
    v_mfma_f32_16x16x32_bf16 v[224:227], a[128:131], a[108:111], v[224:227]
    buffer_load_dwordx4 a[84:87], v4, s[56:59], s69 offen offset:0 sc1
    v_mfma_f32_16x16x32_bf16 v[132:135], a[132:135], a[96:99], v[132:135]
    ds_read_b64_tr_b16 a[164:165], v9 offset:24576
    v_mfma_f32_16x16x32_bf16 v[164:167], a[132:135], a[100:103], v[164:167]
    ds_read_b64_tr_b16 a[166:167], v9 offset:28672
    v_mfma_f32_16x16x32_bf16 v[196:199], a[132:135], a[104:107], v[196:199]
    buffer_load_dwordx4 a[88:91], v3, s[56:59], s69 offen offset:2048 sc1
    v_mfma_f32_16x16x32_bf16 v[228:231], a[132:135], a[108:111], v[228:231]
    ds_read_b64_tr_b16 a[168:169], v10 offset:24576
    v_mfma_f32_16x16x32_bf16 v[136:139], a[136:139], a[96:99], v[136:139]
    ds_read_b64_tr_b16 a[170:171], v10 offset:28672
    v_mfma_f32_16x16x32_bf16 v[168:171], a[136:139], a[100:103], v[168:171]
    buffer_load_dwordx4 a[92:95], v4, s[56:59], s69 offen offset:2048 sc1
    v_mfma_f32_16x16x32_bf16 v[200:203], a[136:139], a[104:107], v[200:203]
    ds_read_b64_tr_b16 a[172:173], v11 offset:24576
    v_mfma_f32_16x16x32_bf16 v[232:235], a[136:139], a[108:111], v[232:235]
    ds_read_b64_tr_b16 a[174:175], v11 offset:28672
    s_mov_b32 s83, 851968
    s_add_u32 m0, s3, 8192
    v_mfma_f32_16x16x32_bf16 v[140:143], a[140:143], a[96:99], v[140:143]
    s_add_u32 s69, s69, 4096
    buffer_load_dwordx4 v17, s[52:55], s83 offen lds
    v_mfma_f32_16x16x32_bf16 v[172:175], a[140:143], a[100:103], v[172:175]
    ds_read_b64_tr_b16 a[176:177], v12 offset:24576
    v_mfma_f32_16x16x32_bf16 v[204:207], a[140:143], a[104:107], v[204:207]
    ds_read_b64_tr_b16 a[178:179], v12 offset:28672
    v_mfma_f32_16x16x32_bf16 v[236:239], a[140:143], a[108:111], v[236:239]
    buffer_load_dwordx4 a[232:235], v3, s[56:59], s89 offen offset:2048 sc1
    v_mfma_f32_16x16x32_bf16 v[144:147], a[144:147], a[96:99], v[144:147]
    ds_read_b64_tr_b16 a[180:181], v13 offset:24576
    buffer_load_dwordx4 v18, s[52:55], s83 offen offset:1024 lds
    v_mfma_f32_16x16x32_bf16 v[176:179], a[144:147], a[100:103], v[176:179]
    ds_read_b64_tr_b16 a[182:183], v13 offset:28672
    v_mfma_f32_16x16x32_bf16 v[208:211], a[144:147], a[104:107], v[208:211]
    v_mfma_f32_16x16x32_bf16 v[240:243], a[144:147], a[108:111], v[240:243]
    ds_read_b64_tr_b16 a[184:185], v14 offset:24576
    v_mfma_f32_16x16x32_bf16 v[148:151], a[148:151], a[96:99], v[148:151]
    ds_read_b64_tr_b16 a[186:187], v14 offset:28672
    v_mfma_f32_16x16x32_bf16 v[180:183], a[148:151], a[100:103], v[180:183]
    v_mfma_f32_16x16x32_bf16 v[212:215], a[148:151], a[104:107], v[212:215]
    ds_read_b64_tr_b16 a[188:189], v15 offset:24576
    v_mfma_f32_16x16x32_bf16 v[244:247], a[148:151], a[108:111], v[244:247]
    ds_read_b64_tr_b16 a[190:191], v15 offset:28672
    v_mfma_f32_16x16x32_bf16 v[152:155], a[152:155], a[96:99], v[152:155]
    v_mfma_f32_16x16x32_bf16 v[184:187], a[152:155], a[100:103], v[184:187]
    v_mfma_f32_16x16x32_bf16 v[216:219], a[152:155], a[104:107], v[216:219]
    v_mfma_f32_16x16x32_bf16 v[248:251], a[152:155], a[108:111], v[248:251]
    v_mfma_f32_16x16x32_bf16 v[156:159], a[156:159], a[96:99], v[156:159]
    v_mfma_f32_16x16x32_bf16 v[188:191], a[156:159], a[100:103], v[188:191]
    v_mfma_f32_16x16x32_bf16 v[220:223], a[156:159], a[104:107], v[220:223]
    v_mfma_f32_16x16x32_bf16 v[252:255], a[156:159], a[108:111], v[252:255]
    s_waitcnt vmcnt(44) lgkmcnt(14)
    v_mfma_f32_16x16x32_bf16 v[128:131], a[160:163], a[112:115], v[128:131]
    buffer_load_dwordx4 a[96:99], v3, s[56:59], s69 offen offset:0 sc1
    s_waitcnt vmcnt(44)
    v_mfma_f32_16x16x32_bf16 v[160:163], a[160:163], a[116:119], v[160:163]
    ds_read_b64_tr_b16 a[128:129], v8 offset:32768
    s_waitcnt vmcnt(43)
    v_mfma_f32_16x16x32_bf16 v[192:195], a[160:163], a[120:123], v[192:195]
    ds_read_b64_tr_b16 a[130:131], v8 offset:36864
    s_waitcnt vmcnt(42)
    v_mfma_f32_16x16x32_bf16 v[224:227], a[160:163], a[124:127], v[224:227]
    buffer_load_dwordx4 a[100:103], v4, s[56:59], s69 offen offset:0 sc1
    s_waitcnt lgkmcnt(14)
    v_mfma_f32_16x16x32_bf16 v[132:135], a[164:167], a[112:115], v[132:135]
    ds_read_b64_tr_b16 a[132:133], v9 offset:32768
    v_mfma_f32_16x16x32_bf16 v[164:167], a[164:167], a[116:119], v[164:167]
    ds_read_b64_tr_b16 a[134:135], v9 offset:36864
    v_mfma_f32_16x16x32_bf16 v[196:199], a[164:167], a[120:123], v[196:199]
    buffer_load_dwordx4 a[104:107], v3, s[56:59], s69 offen offset:2048 sc1
    v_mfma_f32_16x16x32_bf16 v[228:231], a[164:167], a[124:127], v[228:231]
    ds_read_b64_tr_b16 a[136:137], v10 offset:32768
    s_waitcnt lgkmcnt(15)
    v_mfma_f32_16x16x32_bf16 v[136:139], a[168:171], a[112:115], v[136:139]
    ds_read_b64_tr_b16 a[138:139], v10 offset:36864
    v_mfma_f32_16x16x32_bf16 v[168:171], a[168:171], a[116:119], v[168:171]
    buffer_load_dwordx4 a[108:111], v4, s[56:59], s69 offen offset:2048 sc1
    v_mfma_f32_16x16x32_bf16 v[200:203], a[168:171], a[120:123], v[200:203]
    ds_read_b64_tr_b16 a[140:141], v11 offset:32768
    v_mfma_f32_16x16x32_bf16 v[232:235], a[168:171], a[124:127], v[232:235]
    ds_read_b64_tr_b16 a[142:143], v11 offset:36864
    s_mov_b32 s82, 917504
    s_add_u32 m0, s3, 16384
    s_waitcnt lgkmcnt(15)
    v_mfma_f32_16x16x32_bf16 v[140:143], a[172:175], a[112:115], v[140:143]
    s_add_u32 s69, s69, 4096
    buffer_load_dwordx4 v17, s[52:55], s82 offen lds
    v_mfma_f32_16x16x32_bf16 v[172:175], a[172:175], a[116:119], v[172:175]
    ds_read_b64_tr_b16 a[144:145], v12 offset:32768
    v_mfma_f32_16x16x32_bf16 v[204:207], a[172:175], a[120:123], v[204:207]
    ds_read_b64_tr_b16 a[146:147], v12 offset:36864
    v_mfma_f32_16x16x32_bf16 v[236:239], a[172:175], a[124:127], v[236:239]
    buffer_load_dwordx4 a[236:239], v4, s[56:59], s89 offen offset:2048 sc1
    s_waitcnt lgkmcnt(15)
    v_mfma_f32_16x16x32_bf16 v[144:147], a[176:179], a[112:115], v[144:147]
    ds_read_b64_tr_b16 a[148:149], v13 offset:32768
    buffer_load_dwordx4 v18, s[52:55], s82 offen offset:1024 lds
    v_mfma_f32_16x16x32_bf16 v[176:179], a[176:179], a[116:119], v[176:179]
    ds_read_b64_tr_b16 a[150:151], v13 offset:36864
    v_mfma_f32_16x16x32_bf16 v[208:211], a[176:179], a[120:123], v[208:211]
    s_add_u32 s89, s89, 4096
    v_mfma_f32_16x16x32_bf16 v[240:243], a[176:179], a[124:127], v[240:243]
    ds_read_b64_tr_b16 a[152:153], v14 offset:32768
    s_waitcnt lgkmcnt(15)
    v_mfma_f32_16x16x32_bf16 v[148:151], a[180:183], a[112:115], v[148:151]
    ds_read_b64_tr_b16 a[154:155], v14 offset:36864
    v_mfma_f32_16x16x32_bf16 v[180:183], a[180:183], a[116:119], v[180:183]
    v_mfma_f32_16x16x32_bf16 v[212:215], a[180:183], a[120:123], v[212:215]
    ds_read_b64_tr_b16 a[156:157], v15 offset:32768
    v_mfma_f32_16x16x32_bf16 v[244:247], a[180:183], a[124:127], v[244:247]
    ds_read_b64_tr_b16 a[158:159], v15 offset:36864
    v_mfma_f32_16x16x32_bf16 v[152:155], a[184:187], a[112:115], v[152:155]
    v_mfma_f32_16x16x32_bf16 v[184:187], a[184:187], a[116:119], v[184:187]
    v_mfma_f32_16x16x32_bf16 v[216:219], a[184:187], a[120:123], v[216:219]
    v_mfma_f32_16x16x32_bf16 v[248:251], a[184:187], a[124:127], v[248:251]
    s_waitcnt lgkmcnt(15)
    v_mfma_f32_16x16x32_bf16 v[156:159], a[188:191], a[112:115], v[156:159]
    v_mfma_f32_16x16x32_bf16 v[188:191], a[188:191], a[116:119], v[188:191]
    v_mfma_f32_16x16x32_bf16 v[220:223], a[188:191], a[120:123], v[220:223]
    v_mfma_f32_16x16x32_bf16 v[252:255], a[188:191], a[124:127], v[252:255]
    s_waitcnt lgkmcnt(0)
    s_barrier
    s_waitcnt vmcnt(45)
    v_mfma_f32_16x16x32_bf16 v[128:131], a[128:131], a[0:3], v[128:131]
    buffer_load_dwordx4 a[112:115], v3, s[56:59], s69 offen offset:0 sc1
    s_waitcnt vmcnt(45)
    v_mfma_f32_16x16x32_bf16 v[160:163], a[128:131], a[4:7], v[160:163]
    ds_read_b64_tr_b16 a[160:161], v8 offset:40960
    s_waitcnt vmcnt(44)
    v_mfma_f32_16x16x32_bf16 v[192:195], a[128:131], a[8:11], v[192:195]
    ds_read_b64_tr_b16 a[162:163], v8 offset:45056
    s_waitcnt vmcnt(43)
    v_mfma_f32_16x16x32_bf16 v[224:227], a[128:131], a[12:15], v[224:227]
    buffer_load_dwordx4 a[116:119], v4, s[56:59], s69 offen offset:0 sc1
    v_mfma_f32_16x16x32_bf16 v[132:135], a[132:135], a[0:3], v[132:135]
    ds_read_b64_tr_b16 a[164:165], v9 offset:40960
    v_mfma_f32_16x16x32_bf16 v[164:167], a[132:135], a[4:7], v[164:167]
    ds_read_b64_tr_b16 a[166:167], v9 offset:45056
    v_mfma_f32_16x16x32_bf16 v[196:199], a[132:135], a[8:11], v[196:199]
    buffer_load_dwordx4 a[120:123], v3, s[56:59], s69 offen offset:2048 sc1
    v_mfma_f32_16x16x32_bf16 v[228:231], a[132:135], a[12:15], v[228:231]
    ds_read_b64_tr_b16 a[168:169], v10 offset:40960
    v_mfma_f32_16x16x32_bf16 v[136:139], a[136:139], a[0:3], v[136:139]
    ds_read_b64_tr_b16 a[170:171], v10 offset:45056
    v_mfma_f32_16x16x32_bf16 v[168:171], a[136:139], a[4:7], v[168:171]
    buffer_load_dwordx4 a[124:127], v4, s[56:59], s69 offen offset:2048 sc1
    v_mfma_f32_16x16x32_bf16 v[200:203], a[136:139], a[8:11], v[200:203]
    ds_read_b64_tr_b16 a[172:173], v11 offset:40960
    v_mfma_f32_16x16x32_bf16 v[232:235], a[136:139], a[12:15], v[232:235]
    ds_read_b64_tr_b16 a[174:175], v11 offset:45056
    s_mov_b32 s83, 983040
    s_add_u32 m0, s3, 24576
    v_mfma_f32_16x16x32_bf16 v[140:143], a[140:143], a[0:3], v[140:143]
    s_add_u32 s69, s69, 4096
    buffer_load_dwordx4 v17, s[52:55], s83 offen lds
    v_mfma_f32_16x16x32_bf16 v[172:175], a[140:143], a[4:7], v[172:175]
    ds_read_b64_tr_b16 a[176:177], v12 offset:40960
    v_mfma_f32_16x16x32_bf16 v[204:207], a[140:143], a[8:11], v[204:207]
    ds_read_b64_tr_b16 a[178:179], v12 offset:45056
    v_mfma_f32_16x16x32_bf16 v[236:239], a[140:143], a[12:15], v[236:239]
    buffer_load_dwordx4 a[240:243], v3, s[56:59], s89 offen offset:0 sc1
    v_mfma_f32_16x16x32_bf16 v[144:147], a[144:147], a[0:3], v[144:147]
    ds_read_b64_tr_b16 a[180:181], v13 offset:40960
    buffer_load_dwordx4 v18, s[52:55], s83 offen offset:1024 lds
    v_mfma_f32_16x16x32_bf16 v[176:179], a[144:147], a[4:7], v[176:179]
    ds_read_b64_tr_b16 a[182:183], v13 offset:45056
    v_mfma_f32_16x16x32_bf16 v[208:211], a[144:147], a[8:11], v[208:211]
    buffer_load_dwordx4 a[244:247], v4, s[56:59], s89 offen offset:0 sc1
    v_mfma_f32_16x16x32_bf16 v[240:243], a[144:147], a[12:15], v[240:243]
    ds_read_b64_tr_b16 a[184:185], v14 offset:40960
    v_mfma_f32_16x16x32_bf16 v[148:151], a[148:151], a[0:3], v[148:151]
    ds_read_b64_tr_b16 a[186:187], v14 offset:45056
    v_mfma_f32_16x16x32_bf16 v[180:183], a[148:151], a[4:7], v[180:183]
    v_mfma_f32_16x16x32_bf16 v[212:215], a[148:151], a[8:11], v[212:215]
    ds_read_b64_tr_b16 a[188:189], v15 offset:40960
    v_mfma_f32_16x16x32_bf16 v[244:247], a[148:151], a[12:15], v[244:247]
    ds_read_b64_tr_b16 a[190:191], v15 offset:45056
    v_mfma_f32_16x16x32_bf16 v[152:155], a[152:155], a[0:3], v[152:155]
    v_mfma_f32_16x16x32_bf16 v[184:187], a[152:155], a[4:7], v[184:187]
    v_mfma_f32_16x16x32_bf16 v[216:219], a[152:155], a[8:11], v[216:219]
    v_mfma_f32_16x16x32_bf16 v[248:251], a[152:155], a[12:15], v[248:251]
    v_mfma_f32_16x16x32_bf16 v[156:159], a[156:159], a[0:3], v[156:159]
    v_mfma_f32_16x16x32_bf16 v[188:191], a[156:159], a[4:7], v[188:191]
    v_mfma_f32_16x16x32_bf16 v[220:223], a[156:159], a[8:11], v[220:223]
    v_mfma_f32_16x16x32_bf16 v[252:255], a[156:159], a[12:15], v[252:255]
    s_waitcnt vmcnt(47) lgkmcnt(14)
    v_mfma_f32_16x16x32_bf16 v[128:131], a[160:163], a[16:19], v[128:131]
    buffer_load_dwordx4 a[0:3], v3, s[56:59], s69 offen offset:0 sc1
    s_waitcnt vmcnt(47)
    v_mfma_f32_16x16x32_bf16 v[160:163], a[160:163], a[20:23], v[160:163]
    ds_read_b64_tr_b16 a[128:129], v8 offset:49152
    s_waitcnt vmcnt(46)
    v_mfma_f32_16x16x32_bf16 v[192:195], a[160:163], a[24:27], v[192:195]
    ds_read_b64_tr_b16 a[130:131], v8 offset:53248
    s_waitcnt vmcnt(45)
    v_mfma_f32_16x16x32_bf16 v[224:227], a[160:163], a[28:31], v[224:227]
    buffer_load_dwordx4 a[4:7], v4, s[56:59], s69 offen offset:0 sc1
    s_waitcnt lgkmcnt(14)
    v_mfma_f32_16x16x32_bf16 v[132:135], a[164:167], a[16:19], v[132:135]
    ds_read_b64_tr_b16 a[132:133], v9 offset:49152
    v_mfma_f32_16x16x32_bf16 v[164:167], a[164:167], a[20:23], v[164:167]
    ds_read_b64_tr_b16 a[134:135], v9 offset:53248
    v_mfma_f32_16x16x32_bf16 v[196:199], a[164:167], a[24:27], v[196:199]
    buffer_load_dwordx4 a[8:11], v3, s[56:59], s69 offen offset:2048 sc1
    v_mfma_f32_16x16x32_bf16 v[228:231], a[164:167], a[28:31], v[228:231]
    ds_read_b64_tr_b16 a[136:137], v10 offset:49152
    s_waitcnt lgkmcnt(15)
    v_mfma_f32_16x16x32_bf16 v[136:139], a[168:171], a[16:19], v[136:139]
    ds_read_b64_tr_b16 a[138:139], v10 offset:53248
    v_mfma_f32_16x16x32_bf16 v[168:171], a[168:171], a[20:23], v[168:171]
    s_branch L_over11
L_stub11:
    s_branch L_stubret
L_over11:
    buffer_load_dwordx4 a[12:15], v4, s[56:59], s69 offen offset:2048 sc1
    v_mfma_f32_16x16x32_bf16 v[200:203], a[168:171], a[24:27], v[200:203]
    ds_read_b64_tr_b16 a[140:141], v11 offset:49152
    v_mfma_f32_16x16x32_bf16 v[232:235], a[168:171], a[28:31], v[232:235]
    ds_read_b64_tr_b16 a[142:143], v11 offset:53248
    s_mov_b32 s82, 1048576
    s_add_u32 m0, s3, 32768
    s_waitcnt lgkmcnt(15)
    v_mfma_f32_16x16x32_bf16 v[140:143], a[172:175], a[16:19], v[140:143]
    s_add_u32 s69, s69, 4096
    buffer_load_dwordx4 v17, s[52:55], s82 offen lds
    v_mfma_f32_16x16x32_bf16 v[172:175], a[172:175], a[20:23], v[172:175]
    ds_read_b64_tr_b16 a[144:145], v12 offset:49152
    v_mfma_f32_16x16x32_bf16 v[204:207], a[172:175], a[24:27], v[204:207]
    ds_read_b64_tr_b16 a[146:147], v12 offset:53248
    v_mfma_f32_16x16x32_bf16 v[236:239], a[172:175], a[28:31], v[236:239]
    buffer_load_dwordx4 a[248:251], v3, s[56:59], s89 offen offset:2048 sc1
    s_waitcnt lgkmcnt(15)
    v_mfma_f32_16x16x32_bf16 v[144:147], a[176:179], a[16:19], v[144:147]
    ds_read_b64_tr_b16 a[148:149], v13 offset:49152
    buffer_load_dwordx4 v18, s[52:55], s82 offen offset:1024 lds
    v_mfma_f32_16x16x32_bf16 v[176:179], a[176:179], a[20:23], v[176:179]
    ds_read_b64_tr_b16 a[150:151], v13 offset:53248
    v_mfma_f32_16x16x32_bf16 v[208:211], a[176:179], a[24:27], v[208:211]
    v_mfma_f32_16x16x32_bf16 v[240:243], a[176:179], a[28:31], v[240:243]
    ds_read_b64_tr_b16 a[152:153], v14 offset:49152
    s_waitcnt lgkmcnt(15)
    v_mfma_f32_16x16x32_bf16 v[148:151], a[180:183], a[16:19], v[148:151]
    ds_read_b64_tr_b16 a[154:155], v14 offset:53248
    v_mfma_f32_16x16x32_bf16 v[180:183], a[180:183], a[20:23], v[180:183]
    v_mfma_f32_16x16x32_bf16 v[212:215], a[180:183], a[24:27], v[212:215]
    ds_read_b64_tr_b16 a[156:157], v15 offset:49152
    v_mfma_f32_16x16x32_bf16 v[244:247], a[180:183], a[28:31], v[244:247]
    ds_read_b64_tr_b16 a[158:159], v15 offset:53248
    v_mfma_f32_16x16x32_bf16 v[152:155], a[184:187], a[16:19], v[152:155]
    v_mfma_f32_16x16x32_bf16 v[184:187], a[184:187], a[20:23], v[184:187]
    v_mfma_f32_16x16x32_bf16 v[216:219], a[184:187], a[24:27], v[216:219]
    v_mfma_f32_16x16x32_bf16 v[248:251], a[184:187], a[28:31], v[248:251]
    s_waitcnt lgkmcnt(15)
    v_mfma_f32_16x16x32_bf16 v[156:159], a[188:191], a[16:19], v[156:159]
    v_mfma_f32_16x16x32_bf16 v[188:191], a[188:191], a[20:23], v[188:191]
    v_mfma_f32_16x16x32_bf16 v[220:223], a[188:191], a[24:27], v[220:223]
    v_mfma_f32_16x16x32_bf16 v[252:255], a[188:191], a[28:31], v[252:255]
    s_waitcnt lgkmcnt(0)
    s_barrier
    s_waitcnt vmcnt(48)
    v_mfma_f32_16x16x32_bf16 v[128:131], a[128:131], a[32:35], v[128:131]
    buffer_load_dwordx4 a[16:19], v3, s[56:59], s69 offen offset:0 sc1
    s_waitcnt vmcnt(48)
    v_mfma_f32_16x16x32_bf16 v[160:163], a[128:131], a[36:39], v[160:163]
    ds_read_b64_tr_b16 a[160:161], v8 offset:57344
    s_waitcnt vmcnt(47)
    v_mfma_f32_16x16x32_bf16 v[192:195], a[128:131], a[40:43], v[192:195]
    ds_read_b64_tr_b16 a[162:163], v8 offset:61440
    s_waitcnt vmcnt(46)
    v_mfma_f32_16x16x32_bf16 v[224:227], a[128:131], a[44:47], v[224:227]
    buffer_load_dwordx4 a[20:23], v4, s[56:59], s69 offen offset:0 sc1
    v_mfma_f32_16x16x32_bf16 v[132:135], a[132:135], a[32:35], v[132:135]
    ds_read_b64_tr_b16 a[164:165], v9 offset:57344
    v_mfma_f32_16x16x32_bf16 v[164:167], a[132:135], a[36:39], v[164:167]
    ds_read_b64_tr_b16 a[166:167], v9 offset:61440
    v_mfma_f32_16x16x32_bf16 v[196:199], a[132:135], a[40:43], v[196:199]
    buffer_load_dwordx4 a[24:27], v3, s[56:59], s69 offen offset:2048 sc1
    v_mfma_f32_16x16x32_bf16 v[228:231], a[132:135], a[44:47], v[228:231]
    ds_read_b64_tr_b16 a[168:169], v10 offset:57344
    v_mfma_f32_16x16x32_bf16 v[136:139], a[136:139], a[32:35], v[136:139]
    ds_read_b64_tr_b16 a[170:171], v10 offset:61440
    v_mfma_f32_16x16x32_bf16 v[168:171], a[136:139], a[36:39], v[168:171]
    buffer_load_dwordx4 a[28:31], v4, s[56:59], s69 offen offset:2048 sc1
    v_mfma_f32_16x16x32_bf16 v[200:203], a[136:139], a[40:43], v[200:203]
    ds_read_b64_tr_b16 a[172:173], v11 offset:57344
    v_mfma_f32_16x16x32_bf16 v[232:235], a[136:139], a[44:47], v[232:235]
    ds_read_b64_tr_b16 a[174:175], v11 offset:61440
    s_mov_b32 s83, 1114112
    s_add_u32 m0, s3, 40960
    v_mfma_f32_16x16x32_bf16 v[140:143], a[140:143], a[32:35], v[140:143]
    s_add_u32 s69, s69, 4096
    buffer_load_dwordx4 v17, s[52:55], s83 offen lds
    v_mfma_f32_16x16x32_bf16 v[172:175], a[140:143], a[36:39], v[172:175]
    ds_read_b64_tr_b16 a[176:177], v12 offset:57344
    v_mfma_f32_16x16x32_bf16 v[204:207], a[140:143], a[40:43], v[204:207]
    ds_read_b64_tr_b16 a[178:179], v12 offset:61440
    v_mfma_f32_16x16x32_bf16 v[236:239], a[140:143], a[44:47], v[236:239]
    buffer_load_dwordx4 a[252:255], v4, s[56:59], s89 offen offset:2048 sc1
    v_mfma_f32_16x16x32_bf16 v[144:147], a[144:147], a[32:35], v[144:147]
    ds_read_b64_tr_b16 a[180:181], v13 offset:57344
    buffer_load_dwordx4 v18, s[52:55], s83 offen offset:1024 lds
    v_mfma_f32_16x16x32_bf16 v[176:179], a[144:147], a[36:39], v[176:179]
    ds_read_b64_tr_b16 a[182:183], v13 offset:61440
    v_mfma_f32_16x16x32_bf16 v[208:211], a[144:147], a[40:43], v[208:211]
    s_add_u32 s89, s89, 4096
    v_mfma_f32_16x16x32_bf16 v[240:243], a[144:147], a[44:47], v[240:243]
    ds_read_b64_tr_b16 a[184:185], v14 offset:57344
    v_mfma_f32_16x16x32_bf16 v[148:151], a[148:151], a[32:35], v[148:151]
    ds_read_b64_tr_b16 a[186:187], v14 offset:61440
    v_mfma_f32_16x16x32_bf16 v[180:183], a[148:151], a[36:39], v[180:183]
    s_mov_b32 s82, 1179648
    s_add_u32 m0, s3, 49152
    v_mfma_f32_16x16x32_bf16 v[212:215], a[148:151], a[40:43], v[212:215]
    ds_read_b64_tr_b16 a[188:189], v15 offset:57344
    buffer_load_dwordx4 v17, s[52:55], s82 offen lds
    v_mfma_f32_16x16x32_bf16 v[244:247], a[148:151], a[44:47], v[244:247]
    ds_read_b64_tr_b16 a[190:191], v15 offset:61440
    v_mfma_f32_16x16x32_bf16 v[152:155], a[152:155], a[32:35], v[152:155]
    v_mfma_f32_16x16x32_bf16 v[184:187], a[152:155], a[36:39], v[184:187]
    v_mfma_f32_16x16x32_bf16 v[216:219], a[152:155], a[40:43], v[216:219]
    buffer_load_dwordx4 v18, s[52:55], s82 offen offset:1024 lds
    v_mfma_f32_16x16x32_bf16 v[248:251], a[152:155], a[44:47], v[248:251]
    v_mfma_f32_16x16x32_bf16 v[156:159], a[156:159], a[32:35], v[156:159]
    v_mfma_f32_16x16x32_bf16 v[188:191], a[156:159], a[36:39], v[188:191]
    v_mfma_f32_16x16x32_bf16 v[220:223], a[156:159], a[40:43], v[220:223]
    v_mfma_f32_16x16x32_bf16 v[252:255], a[156:159], a[44:47], v[252:255]
    s_waitcnt lgkmcnt(0)
    s_barrier
    s_waitcnt vmcnt(50)
    v_mfma_f32_16x16x32_bf16 v[160:163], a[160:163], a[52:55], v[160:163]
    s_mov_b32 s83, 1245184
    s_add_u32 m0, s3, 57344
    v_mfma_f32_16x16x32_bf16 v[164:167], a[164:167], a[52:55], v[164:167]
    ds_read_b64_tr_b16 a[128:129], v48 offset:0
    buffer_load_dwordx4 v17, s[52:55], s83 offen lds
    v_mfma_f32_16x16x32_bf16 v[168:171], a[168:171], a[52:55], v[168:171]
    ds_read_b64_tr_b16 a[130:131], v48 offset:4096
    v_mfma_f32_16x16x32_bf16 v[172:175], a[172:175], a[52:55], v[172:175]
    ds_read_b64_tr_b16 a[132:133], v49 offset:0
    v_mfma_f32_16x16x32_bf16 v[176:179], a[176:179], a[52:55], v[176:179]
    ds_read_b64_tr_b16 a[134:135], v49 offset:4096
    v_mfma_f32_16x16x32_bf16 v[180:183], a[180:183], a[52:55], v[180:183]
    ds_read_b64_tr_b16 a[136:137], v50 offset:0
    buffer_load_dwordx4 v18, s[52:55], s83 offen offset:1024 lds
    v_mfma_f32_16x16x32_bf16 v[184:187], a[184:187], a[52:55], v[184:187]
    ds_read_b64_tr_b16 a[138:139], v50 offset:4096
    v_mfma_f32_16x16x32_bf16 v[188:191], a[188:191], a[52:55], v[188:191]
    ds_read_b64_tr_b16 a[140:141], v51 offset:0
    s_waitcnt vmcnt(51)
    v_mfma_f32_16x16x32_bf16 v[192:195], a[160:163], a[56:59], v[192:195]
    ds_read_b64_tr_b16 a[142:143], v51 offset:4096
    v_mfma_f32_16x16x32_bf16 v[196:199], a[164:167], a[56:59], v[196:199]
    ds_read_b64_tr_b16 a[144:145], v52 offset:0
    v_mfma_f32_16x16x32_bf16 v[200:203], a[168:171], a[56:59], v[200:203]
    ds_read_b64_tr_b16 a[146:147], v52 offset:4096
    v_mfma_f32_16x16x32_bf16 v[204:207], a[172:175], a[56:59], v[204:207]
    ds_read_b64_tr_b16 a[148:149], v53 offset:0
    v_mfma_f32_16x16x32_bf16 v[208:211], a[176:179], a[56:59], v[208:211]
    ds_read_b64_tr_b16 a[150:151], v53 offset:4096
    v_cvt_pk_bf16_f32 v160, v160, v161
    v_cvt_pk_bf16_f32 v161, v162, v163
    v_mfma_f32_16x16x32_bf16 v[212:215], a[180:183], a[56:59], v[212:215]
    ds_read_b64_tr_b16 a[152:153], v54 offset:0
    v_cvt_pk_bf16_f32 v162, v164, v165
    v_cvt_pk_bf16_f32 v163, v166, v167
    v_mfma_f32_16x16x32_bf16 v[216:219], a[184:187], a[56:59], v[216:219]
    ds_read_b64_tr_b16 a[154:155], v54 offset:4096
    buffer_store_dwordx4 v[160:163], v16, s[56:59], s70 offen offset:0 sc1
    v_mfma_f32_16x16x32_bf16 v[220:223], a[188:191], a[56:59], v[220:223]
    s_waitcnt vmcnt(51)
    v_mfma_f32_16x16x32_bf16 v[224:227], a[160:163], a[60:63], v[224:227]
    v_mfma_f32_16x16x32_bf16 v[228:231], a[164:167], a[60:63], v[228:231]
    v_cvt_pk_bf16_f32 v168, v168, v169
    v_cvt_pk_bf16_f32 v169, v170, v171
    v_mfma_f32_16x16x32_bf16 v[232:235], a[168:171], a[60:63], v[232:235]
    v_add_u32 v8, s88, v8
    v_cvt_pk_bf16_f32 v170, v172, v173
    v_cvt_pk_bf16_f32 v171, v174, v175
    v_mfma_f32_16x16x32_bf16 v[236:239], a[172:175], a[60:63], v[236:239]
    v_add_u32 v9, s88, v9
    buffer_store_dwordx4 v[168:171], v16, s[56:59], s70 offen offset:1024 sc1
    v_mfma_f32_16x16x32_bf16 v[240:243], a[176:179], a[60:63], v[240:243]
    v_add_u32 v10, s88, v10
    v_mfma_f32_16x16x32_bf16 v[244:247], a[180:183], a[60:63], v[244:247]
    v_add_u32 v11, s88, v11
    v_mfma_f32_16x16x32_bf16 v[248:251], a[184:187], a[60:63], v[248:251]
    v_add_u32 v12, s88, v12
    v_cvt_pk_bf16_f32 v176, v176, v177
    v_cvt_pk_bf16_f32 v177, v178, v179
    v_mfma_f32_16x16x32_bf16 v[252:255], a[188:191], a[60:63], v[252:255]
    v_add_u32 v13, s88, v13
    v_cvt_pk_bf16_f32 v178, v180, v181
    v_cvt_pk_bf16_f32 v179, v182, v183
    v_mfma_f32_16x16x32_bf16 v[128:131], a[160:163], a[48:51], v[128:131]
    v_add_u32 v14, s88, v14
    buffer_store_dwordx4 v[176:179], v16, s[56:59], s70 offen offset:2048 sc1
    v_mfma_f32_16x16x32_bf16 v[132:135], a[164:167], a[48:51], v[132:135]
    v_add_u32 v15, s88, v15
    v_mfma_f32_16x16x32_bf16 v[136:139], a[168:171], a[48:51], v[136:139]
    v_mfma_f32_16x16x32_bf16 v[140:143], a[172:175], a[48:51], v[140:143]
    v_cvt_pk_bf16_f32 v184, v184, v185
    v_cvt_pk_bf16_f32 v185, v186, v187
    v_mfma_f32_16x16x32_bf16 v[144:147], a[176:179], a[48:51], v[144:147]
    v_cvt_pk_bf16_f32 v186, v188, v189
    v_cvt_pk_bf16_f32 v187, v190, v191
    v_mfma_f32_16x16x32_bf16 v[148:151], a[180:183], a[48:51], v[148:151]
    buffer_store_dwordx4 v[184:187], v16, s[56:59], s70 offen offset:3072 sc1
    v_mfma_f32_16x16x32_bf16 v[152:155], a[184:187], a[48:51], v[152:155]
    v_mfma_f32_16x16x32_bf16 v[156:159], a[188:191], a[48:51], v[156:159]
    s_waitcnt vmcnt(51) lgkmcnt(12)
    v_mfma_f32_16x16x32_bf16 v[96:99], a[128:131], a[64:67], 0
    ds_read_b64_tr_b16 a[156:157], v55 offset:0
    v_cvt_pk_bf16_f32 v192, v192, v193
    v_cvt_pk_bf16_f32 v193, v194, v195
    s_waitcnt vmcnt(50)
    v_mfma_f32_16x16x32_bf16 a[192:195], a[128:131], a[68:71], 0
    ds_read_b64_tr_b16 a[158:159], v55 offset:4096
    v_cvt_pk_bf16_f32 v194, v196, v197
    v_cvt_pk_bf16_f32 v195, v198, v199
    s_waitcnt lgkmcnt(12)
    v_mfma_f32_16x16x32_bf16 v[100:103], a[132:135], a[64:67], 0
    ds_read_b64_tr_b16 a[160:161], v48 offset:16384
    buffer_store_dwordx4 v[192:195], v16, s[56:59], s71 offen offset:0 sc1
    v_mfma_f32_16x16x32_bf16 a[196:199], a[132:135], a[68:71], 0
    ds_read_b64_tr_b16 a[162:163], v48 offset:20480
    s_waitcnt lgkmcnt(12)
    v_mfma_f32_16x16x32_bf16 v[104:107], a[136:139], a[64:67], 0
    ds_read_b64_tr_b16 a[164:165], v49 offset:16384
    v_mfma_f32_16x16x32_bf16 a[200:203], a[136:139], a[68:71], 0
    ds_read_b64_tr_b16 a[166:167], v49 offset:20480
    v_cvt_pk_bf16_f32 v200, v200, v201
    v_cvt_pk_bf16_f32 v201, v202, v203
    s_waitcnt lgkmcnt(12)
    v_mfma_f32_16x16x32_bf16 v[108:111], a[140:143], a[64:67], 0
    ds_read_b64_tr_b16 a[168:169], v50 offset:16384
    v_cvt_pk_bf16_f32 v202, v204, v205
    v_cvt_pk_bf16_f32 v203, v206, v207
    v_mfma_f32_16x16x32_bf16 a[204:207], a[140:143], a[68:71], 0
    ds_read_b64_tr_b16 a[170:171], v50 offset:20480
    buffer_store_dwordx4 v[200:203], v16, s[56:59], s71 offen offset:1024 sc1
    s_waitcnt lgkmcnt(12)
    v_mfma_f32_16x16x32_bf16 v[112:115], a[144:147], a[64:67], 0
    ds_read_b64_tr_b16 a[172:173], v51 offset:16384
    v_mfma_f32_16x16x32_bf16 a[208:211], a[144:147], a[68:71], 0
    ds_read_b64_tr_b16 a[174:175], v51 offset:20480
    s_waitcnt lgkmcnt(12)
    v_mfma_f32_16x16x32_bf16 v[116:119], a[148:151], a[64:67], 0
    ds_read_b64_tr_b16 a[176:177], v52 offset:16384
    v_cvt_pk_bf16_f32 v208, v208, v209
    v_cvt_pk_bf16_f32 v209, v210, v211
    v_mfma_f32_16x16x32_bf16 a[212:215], a[148:151], a[68:71], 0
    ds_read_b64_tr_b16 a[178:179], v52 offset:20480
    v_cvt_pk_bf16_f32 v210, v212, v213
    v_cvt_pk_bf16_f32 v211, v214, v215
    s_waitcnt lgkmcnt(12)
    v_mfma_f32_16x16x32_bf16 v[120:123], a[152:155], a[64:67], 0
    ds_read_b64_tr_b16 a[180:181], v53 offset:16384
    buffer_store_dwordx4 v[208:211], v16, s[56:59], s71 offen offset:2048 sc1
    v_mfma_f32_16x16x32_bf16 a[216:219], a[152:155], a[68:71], 0
    ds_read_b64_tr_b16 a[182:183], v53 offset:20480
    s_waitcnt lgkmcnt(12)
    v_mfma_f32_16x16x32_bf16 v[124:127], a[156:159], a[64:67], 0
    ds_read_b64_tr_b16 a[184:185], v54 offset:16384
    v_mfma_f32_16x16x32_bf16 a[220:223], a[156:159], a[68:71], 0
    ds_read_b64_tr_b16 a[186:187], v54 offset:20480
    v_cvt_pk_bf16_f32 v216, v216, v217
    v_cvt_pk_bf16_f32 v217, v218, v219
    s_waitcnt vmcnt(52) lgkmcnt(12)
    v_mfma_f32_16x16x32_bf16 v[96:99], a[160:163], a[72:75], v[96:99]
    ds_read_b64_tr_b16 a[188:189], v55 offset:16384
    v_cvt_pk_bf16_f32 v218, v220, v221
    v_cvt_pk_bf16_f32 v219, v222, v223
    s_waitcnt vmcnt(51)
    v_mfma_f32_16x16x32_bf16 a[192:195], a[160:163], a[76:79], a[192:195]
    ds_read_b64_tr_b16 a[190:191], v55 offset:20480
    buffer_store_dwordx4 v[216:219], v16, s[56:59], s71 offen offset:3072 sc1
    s_waitcnt lgkmcnt(12)
    v_mfma_f32_16x16x32_bf16 v[100:103], a[164:167], a[72:75], v[100:103]
    ds_read_b64_tr_b16 a[128:129], v48 offset:32768
    v_mfma_f32_16x16x32_bf16 a[196:199], a[164:167], a[76:79], a[196:199]
    ds_read_b64_tr_b16 a[130:131], v48 offset:36864
    s_waitcnt lgkmcnt(12)
    v_mfma_f32_16x16x32_bf16 v[104:107], a[168:171], a[72:75], v[104:107]
    ds_read_b64_tr_b16 a[132:133], v49 offset:32768
    v_mfma_f32_16x16x32_bf16 a[200:203], a[168:171], a[76:79], a[200:203]
    ds_read_b64_tr_b16 a[134:135], v49 offset:36864
    s_waitcnt lgkmcnt(12)
    v_mfma_f32_16x16x32_bf16 v[108:111], a[172:175], a[72:75], v[108:111]
    ds_read_b64_tr_b16 a[136:137], v50 offset:32768
    v_mfma_f32_16x16x32_bf16 a[204:207], a[172:175], a[76:79], a[204:207]
    ds_read_b64_tr_b16 a[138:139], v50 offset:36864
    s_waitcnt lgkmcnt(12)
    v_mfma_f32_16x16x32_bf16 v[112:115], a[176:179], a[72:75], v[112:115]
    ds_read_b64_tr_b16 a[140:141], v51 offset:32768
    v_mfma_f32_16x16x32_bf16 a[208:211], a[176:179], a[76:79], a[208:211]
    ds_read_b64_tr_b16 a[142:143], v51 offset:36864
    v_cvt_pk_bf16_f32 v224, v224, v225
    v_cvt_pk_bf16_f32 v225, v226, v227
    s_waitcnt lgkmcnt(12)
    v_mfma_f32_16x16x32_bf16 v[116:119], a[180:183], a[72:75], v[116:119]
    ds_read_b64_tr_b16 a[144:145], v52 offset:32768
    v_cvt_pk_bf16_f32 v226, v228, v229
    v_cvt_pk_bf16_f32 v227, v230, v231
    v_mfma_f32_16x16x32_bf16 a[212:215], a[180:183], a[76:79], a[212:215]
    ds_read_b64_tr_b16 a[146:147], v52 offset:36864
    buffer_store_dwordx4 v[224:227], v16, s[56:59], s72 offen offset:0 sc1
    s_waitcnt lgkmcnt(12)
    v_mfma_f32_16x16x32_bf16 v[120:123], a[184:187], a[72:75], v[120:123]
    ds_read_b64_tr_b16 a[148:149], v53 offset:32768
    v_mfma_f32_16x16x32_bf16 a[216:219], a[184:187], a[76:79], a[216:219]
    ds_read_b64_tr_b16 a[150:151], v53 offset:36864
    s_waitcnt lgkmcnt(12)
    v_mfma_f32_16x16x32_bf16 v[124:127], a[188:191], a[72:75], v[124:127]
    ds_read_b64_tr_b16 a[152:153], v54 offset:32768
    v_mfma_f32_16x16x32_bf16 a[220:223], a[188:191], a[76:79], a[220:223]
    ds_read_b64_tr_b16 a[154:155], v54 offset:36864
    s_waitcnt vmcnt(28)
    s_barrier
    s_waitcnt lgkmcnt(12)
    v_mfma_f32_16x16x32_bf16 v[96:99], a[128:131], a[80:83], v[96:99]
    ds_read_b64_tr_b16 a[156:157], v55 offset:32768
    v_mfma_f32_16x16x32_bf16 a[192:195], a[128:131], a[84:87], a[192:195]
    ds_read_b64_tr_b16 a[158:159], v55 offset:36864
    s_waitcnt lgkmcnt(12)
    v_mfma_f32_16x16x32_bf16 v[100:103], a[132:135], a[80:83], v[100:103]
    ds_read_b64_tr_b16 a[160:161], v48 offset:49152
    v_mfma_f32_16x16x32_bf16 a[196:199], a[132:135], a[84:87], a[196:199]
    ds_read_b64_tr_b16 a[162:163], v48 offset:53248
    v_cvt_pk_bf16_f32 v232, v232, v233
    v_cvt_pk_bf16_f32 v233, v234, v235
    s_waitcnt lgkmcnt(12)
    v_mfma_f32_16x16x32_bf16 v[104:107], a[136:139], a[80:83], v[104:107]
    ds_read_b64_tr_b16 a[164:165], v49 offset:49152
    v_cvt_pk_bf16_f32 v234, v236, v237
    v_cvt_pk_bf16_f32 v235, v238, v239
    v_mfma_f32_16x16x32_bf16 a[200:203], a[136:139], a[84:87], a[200:203]
    ds_read_b64_tr_b16 a[166:167], v49 offset:53248
    buffer_store_dwordx4 v[232:235], v16, s[56:59], s72 offen offset:1024 sc1
    s_waitcnt lgkmcnt(12)
    v_mfma_f32_16x16x32_bf16 v[108:111], a[140:143], a[80:83], v[108:111]
    ds_read_b64_tr_b16 a[168:169], v50 offset:49152
    v_mfma_f32_16x16x32_bf16 a[204:207], a[140:143], a[84:87], a[204:207]
    ds_read_b64_tr_b16 a[170:171], v50 offset:53248
    s_waitcnt lgkmcnt(12)
    v_mfma_f32_16x16x32_bf16 v[112:115], a[144:147], a[80:83], v[112:115]
    ds_read_b64_tr_b16 a[172:173], v51 offset:49152
    v_mfma_f32_16x16x32_bf16 a[208:211], a[144:147], a[84:87], a[208:211]
    ds_read_b64_tr_b16 a[174:175], v51 offset:53248
    s_waitcnt lgkmcnt(12)
    v_mfma_f32_16x16x32_bf16 v[116:119], a[148:151], a[80:83], v[116:119]
    ds_read_b64_tr_b16 a[176:177], v52 offset:49152
    v_mfma_f32_16x16x32_bf16 a[212:215], a[148:151], a[84:87], a[212:215]
    ds_read_b64_tr_b16 a[178:179], v52 offset:53248
    s_waitcnt lgkmcnt(12)
    v_mfma_f32_16x16x32_bf16 v[120:123], a[152:155], a[80:83], v[120:123]
    ds_read_b64_tr_b16 a[180:181], v53 offset:49152
    v_mfma_f32_16x16x32_bf16 a[216:219], a[152:155], a[84:87], a[216:219]
    ds_read_b64_tr_b16 a[182:183], v53 offset:53248
    v_cvt_pk_bf16_f32 v240, v240, v241
    v_cvt_pk_bf16_f32 v241, v242, v243
    s_waitcnt lgkmcnt(12)
    v_mfma_f32_16x16x32_bf16 v[124:127], a[156:159], a[80:83], v[124:127]
    ds_read_b64_tr_b16 a[184:185], v54 offset:49152
    v_cvt_pk_bf16_f32 v242, v244, v245
    v_cvt_pk_bf16_f32 v243, v246, v247
    v_mfma_f32_16x16x32_bf16 a[220:223], a[156:159], a[84:87], a[220:223]
    ds_read_b64_tr_b16 a[186:187], v54 offset:53248
    buffer_store_dwordx4 v[240:243], v16, s[56:59], s72 offen offset:2048 sc1
    s_waitcnt lgkmcnt(12)
    v_mfma_f32_16x16x32_bf16 v[96:99], a[160:163], a[88:91], v[96:99]
    ds_read_b64_tr_b16 a[188:189], v55 offset:49152
    v_mfma_f32_16x16x32_bf16 a[192:195], a[160:163], a[92:95], a[192:195]
    ds_read_b64_tr_b16 a[190:191], v55 offset:53248
    s_waitcnt lgkmcnt(12)
    v_mfma_f32_16x16x32_bf16 v[100:103], a[164:167], a[88:91], v[100:103]
    ds_read_b64_tr_b16 a[128:129], v56 offset:0
    v_mfma_f32_16x16x32_bf16 a[196:199], a[164:167], a[92:95], a[196:199]
    ds_read_b64_tr_b16 a[130:131], v56 offset:4096
    s_waitcnt lgkmcnt(12)
    v_mfma_f32_16x16x32_bf16 v[104:107], a[168:171], a[88:91], v[104:107]
    ds_read_b64_tr_b16 a[132:133], v57 offset:0
    v_mfma_f32_16x16x32_bf16 a[200:203], a[168:171], a[92:95], a[200:203]
    ds_read_b64_tr_b16 a[134:135], v57 offset:4096
    s_waitcnt lgkmcnt(12)
    v_mfma_f32_16x16x32_bf16 v[108:111], a[172:175], a[88:91], v[108:111]
    ds_read_b64_tr_b16 a[136:137], v58 offset:0
    v_mfma_f32_16x16x32_bf16 a[204:207], a[172:175], a[92:95], a[204:207]
    ds_read_b64_tr_b16 a[138:139], v58 offset:4096
    v_cvt_pk_bf16_f32 v248, v248, v249
    v_cvt_pk_bf16_f32 v249, v250, v251
    s_waitcnt lgkmcnt(12)
    v_mfma_f32_16x16x32_bf16 v[112:115], a[176:179], a[88:91], v[112:115]
    ds_read_b64_tr_b16 a[140:141], v59 offset:0
    v_cvt_pk_bf16_f32 v250, v252, v253
    v_cvt_pk_bf16_f32 v251, v254, v255
    s_mov_b32 s82, 1310720
    s_add_u32 m0, s3, 65536
    s_nop 0
    buffer_load_dwordx4 v17, s[52:55], s82 offen lds
    v_mfma_f32_16x16x32_bf16 a[208:211], a[176:179], a[92:95], a[208:211]
    ds_read_b64_tr_b16 a[142:143], v59 offset:4096
    buffer_store_dwordx4 v[248:251], v16, s[56:59], s72 offen offset:3072 sc1
    s_waitcnt lgkmcnt(12)
    v_mfma_f32_16x16x32_bf16 v[116:119], a[180:183], a[88:91], v[116:119]
    ds_read_b64_tr_b16 a[144:145], v60 offset:0
    v_mfma_f32_16x16x32_bf16 a[212:215], a[180:183], a[92:95], a[212:215]
    ds_read_b64_tr_b16 a[146:147], v60 offset:4096
    s_waitcnt lgkmcnt(12)
    v_mfma_f32_16x16x32_bf16 v[120:123], a[184:187], a[88:91], v[120:123]
    ds_read_b64_tr_b16 a[148:149], v61 offset:0
    v_mfma_f32_16x16x32_bf16 a[216:219], a[184:187], a[92:95], a[216:219]
    ds_read_b64_tr_b16 a[150:151], v61 offset:4096
    buffer_load_dwordx4 v18, s[52:55], s82 offen offset:1024 lds
    s_waitcnt lgkmcnt(12)
    v_mfma_f32_16x16x32_bf16 v[124:127], a[188:191], a[88:91], v[124:127]
    ds_read_b64_tr_b16 a[152:153], v62 offset:0
    v_mfma_f32_16x16x32_bf16 a[220:223], a[188:191], a[92:95], a[220:223]
    ds_read_b64_tr_b16 a[154:155], v62 offset:4096
    s_barrier
    s_waitcnt lgkmcnt(12)
    v_mfma_f32_16x16x32_bf16 v[96:99], a[128:131], a[96:99], v[96:99]
    ds_read_b64_tr_b16 a[156:157], v63 offset:0
    v_mfma_f32_16x16x32_bf16 a[192:195], a[128:131], a[100:103], a[192:195]
    ds_read_b64_tr_b16 a[158:159], v63 offset:4096
    s_waitcnt lgkmcnt(12)
    v_mfma_f32_16x16x32_bf16 v[100:103], a[132:135], a[96:99], v[100:103]
    ds_read_b64_tr_b16 a[160:161], v56 offset:16384
    s_mov_b32 s83, 1376256
    s_add_u32 m0, s3, 73728
    s_nop 0
    buffer_load_dwordx4 v17, s[52:55], s83 offen lds
    v_mfma_f32_16x16x32_bf16 a[196:199], a[132:135], a[100:103], a[196:199]
    ds_read_b64_tr_b16 a[162:163], v56 offset:20480
    s_waitcnt lgkmcnt(12)
    v_mfma_f32_16x16x32_bf16 v[104:107], a[136:139], a[96:99], v[104:107]
    ds_read_b64_tr_b16 a[164:165], v57 offset:16384
    v_mfma_f32_16x16x32_bf16 a[200:203], a[136:139], a[100:103], a[200:203]
    ds_read_b64_tr_b16 a[166:167], v57 offset:20480
    s_waitcnt lgkmcnt(12)
    v_mfma_f32_16x16x32_bf16 v[108:111], a[140:143], a[96:99], v[108:111]
    ds_read_b64_tr_b16 a[168:169], v58 offset:16384
    v_mfma_f32_16x16x32_bf16 a[204:207], a[140:143], a[100:103], a[204:207]
    ds_read_b64_tr_b16 a[170:171], v58 offset:20480
    buffer_load_dwordx4 v18, s[52:55], s83 offen offset:1024 lds
    s_waitcnt lgkmcnt(12)
    v_mfma_f32_16x16x32_bf16 v[112:115], a[144:147], a[96:99], v[112:115]
    ds_read_b64_tr_b16 a[172:173], v59 offset:16384
    v_mfma_f32_16x16x32_bf16 a[208:211], a[144:147], a[100:103], a[208:211]
    ds_read_b64_tr_b16 a[174:175], v59 offset:20480
    s_waitcnt lgkmcnt(12)
    v_mfma_f32_16x16x32_bf16 v[116:119], a[148:151], a[96:99], v[116:119]
    ds_read_b64_tr_b16 a[176:177], v60 offset:16384
    v_mfma_f32_16x16x32_bf16 a[212:215], a[148:151], a[100:103], a[212:215]
    ds_read_b64_tr_b16 a[178:179], v60 offset:20480
    s_waitcnt lgkmcnt(12)
    v_mfma_f32_16x16x32_bf16 v[120:123], a[152:155], a[96:99], v[120:123]
    ds_read_b64_tr_b16 a[180:181], v61 offset:16384
    s_mov_b32 s82, 1441792
    s_add_u32 m0, s3, 81920
    s_nop 0
    buffer_load_dwordx4 v17, s[52:55], s82 offen lds
    v_mfma_f32_16x16x32_bf16 a[216:219], a[152:155], a[100:103], a[216:219]
    ds_read_b64_tr_b16 a[182:183], v61 offset:20480
    s_waitcnt lgkmcnt(12)
    v_mfma_f32_16x16x32_bf16 v[124:127], a[156:159], a[96:99], v[124:127]
    ds_read_b64_tr_b16 a[184:185], v62 offset:16384
    v_mfma_f32_16x16x32_bf16 a[220:223], a[156:159], a[100:103], a[220:223]
    ds_read_b64_tr_b16 a[186:187], v62 offset:20480
    s_waitcnt lgkmcnt(12)
    v_mfma_f32_16x16x32_bf16 v[96:99], a[160:163], a[104:107], v[96:99]
    ds_read_b64_tr_b16 a[188:189], v63 offset:16384
    v_mfma_f32_16x16x32_bf16 a[192:195], a[160:163], a[108:111], a[192:195]
    ds_read_b64_tr_b16 a[190:191], v63 offset:20480
    buffer_load_dwordx4 v18, s[52:55], s82 offen offset:1024 lds
    s_waitcnt lgkmcnt(12)
    v_mfma_f32_16x16x32_bf16 v[100:103], a[164:167], a[104:107], v[100:103]
    ds_read_b64_tr_b16 a[128:129], v8 offset:0
    v_mfma_f32_16x16x32_bf16 a[196:199], a[164:167], a[108:111], a[196:199]
    ds_read_b64_tr_b16 a[130:131], v8 offset:4096
    s_waitcnt lgkmcnt(12)
    v_mfma_f32_16x16x32_bf16 v[104:107], a[168:171], a[104:107], v[104:107]
    ds_read_b64_tr_b16 a[132:133], v9 offset:0
    v_mfma_f32_16x16x32_bf16 a[200:203], a[168:171], a[108:111], a[200:203]
    ds_read_b64_tr_b16 a[134:135], v9 offset:4096
    s_waitcnt lgkmcnt(12)
    v_mfma_f32_16x16x32_bf16 v[108:111], a[172:175], a[104:107], v[108:111]
    ds_read_b64_tr_b16 a[136:137], v10 offset:0
    s_mov_b32 s83, 1507328
    s_add_u32 m0, s3, 90112
    s_nop 0
    buffer_load_dwordx4 v17, s[52:55], s83 offen lds
    v_mfma_f32_16x16x32_bf16 a[204:207], a[172:175], a[108:111], a[204:207]
    ds_read_b64_tr_b16 a[138:139], v10 offset:4096
    s_waitcnt lgkmcnt(12)
    v_mfma_f32_16x16x32_bf16 v[112:115], a[176:179], a[104:107], v[112:115]
    ds_read_b64_tr_b16 a[140:141], v11 offset:0
    v_mfma_f32_16x16x32_bf16 a[208:211], a[176:179], a[108:111], a[208:211]
    ds_read_b64_tr_b16 a[142:143], v11 offset:4096
    s_waitcnt lgkmcnt(12)
    v_mfma_f32_16x16x32_bf16 v[116:119], a[180:183], a[104:107], v[116:119]
    ds_read_b64_tr_b16 a[144:145], v12 offset:0
    v_mfma_f32_16x16x32_bf16 a[212:215], a[180:183], a[108:111], a[212:215]
    ds_read_b64_tr_b16 a[146:147], v12 offset:4096
    buffer_load_dwordx4 v18, s[52:55], s83 offen offset:1024 lds
    s_waitcnt lgkmcnt(12)
    v_mfma_f32_16x16x32_bf16 v[120:123], a[184:187], a[104:107], v[120:123]
    ds_read_b64_tr_b16 a[148:149], v13 offset:0
    v_mfma_f32_16x16x32_bf16 a[216:219], a[184:187], a[108:111], a[216:219]
    ds_read_b64_tr_b16 a[150:151], v13 offset:4096
    s_waitcnt lgkmcnt(12)
    v_mfma_f32_16x16x32_bf16 v[124:127], a[188:191], a[104:107], v[124:127]
    ds_read_b64_tr_b16 a[152:153], v14 offset:0
    v_mfma_f32_16x16x32_bf16 a[220:223], a[188:191], a[108:111], a[220:223]
    ds_read_b64_tr_b16 a[154:155], v14 offset:4096
    s_waitcnt vmcnt(20)
    s_barrier
    s_waitcnt lgkmcnt(12)
    v_mfma_f32_16x16x32_bf16 v[96:99], a[128:131], a[112:115], v[96:99]
    ds_read_b64_tr_b16 a[156:157], v15 offset:0
    s_mov_b32 s82, 1572864
    s_add_u32 m0, s3, 98304
    s_nop 0
    buffer_load_dwordx4 v17, s[52:55], s82 offen lds
    v_mfma_f32_16x16x32_bf16 a[192:195], a[128:131], a[116:119], a[192:195]
    ds_read_b64_tr_b16 a[158:159], v15 offset:4096
    s_waitcnt lgkmcnt(12)
    v_mfma_f32_16x16x32_bf16 v[100:103], a[132:135], a[112:115], v[100:103]
    ds_read_b64_tr_b16 a[160:161], v8 offset:16384
    v_mfma_f32_16x16x32_bf16 a[196:199], a[132:135], a[116:119], a[196:199]
    ds_read_b64_tr_b16 a[162:163], v8 offset:20480
    s_waitcnt lgkmcnt(12)
    v_mfma_f32_16x16x32_bf16 v[104:107], a[136:139], a[112:115], v[104:107]
    ds_read_b64_tr_b16 a[164:165], v9 offset:16384
    v_mfma_f32_16x16x32_bf16 a[200:203], a[136:139], a[116:119], a[200:203]
    ds_read_b64_tr_b16 a[166:167], v9 offset:20480
    buffer_load_dwordx4 v18, s[52:55], s82 offen offset:1024 lds
    s_waitcnt lgkmcnt(12)
    v_mfma_f32_16x16x32_bf16 v[108:111], a[140:143], a[112:115], v[108:111]
    ds_read_b64_tr_b16 a[168:169], v10 offset:16384
    v_mfma_f32_16x16x32_bf16 a[204:207], a[140:143], a[116:119], a[204:207]
    ds_read_b64_tr_b16 a[170:171], v10 offset:20480
    s_waitcnt lgkmcnt(12)
    v_mfma_f32_16x16x32_bf16 v[112:115], a[144:147], a[112:115], v[112:115]
    ds_read_b64_tr_b16 a[172:173], v11 offset:16384
    v_mfma_f32_16x16x32_bf16 a[208:211], a[144:147], a[116:119], a[208:211]
    ds_read_b64_tr_b16 a[174:175], v11 offset:20480
    s_waitcnt lgkmcnt(12)
    v_mfma_f32_16x16x32_bf16 v[116:119], a[148:151], a[112:115], v[116:119]
    ds_read_b64_tr_b16 a[176:177], v12 offset:16384
    s_mov_b32 s83, 1638400
    s_add_u32 m0, s3, 106496
    s_nop 0
    buffer_load_dwordx4 v17, s[52:55], s83 offen lds
    v_mfma_f32_16x16x32_bf16 a[212:215], a[148:151], a[116:119], a[212:215]
    ds_read_b64_tr_b16 a[178:179], v12 offset:20480
    s_waitcnt lgkmcnt(12)
    v_mfma_f32_16x16x32_bf16 v[120:123], a[152:155], a[112:115], v[120:123]
    ds_read_b64_tr_b16 a[180:181], v13 offset:16384
    v_mfma_f32_16x16x32_bf16 a[216:219], a[152:155], a[116:119], a[216:219]
    ds_read_b64_tr_b16 a[182:183], v13 offset:20480
    s_waitcnt lgkmcnt(12)
    v_mfma_f32_16x16x32_bf16 v[124:127], a[156:159], a[112:115], v[124:127]
    ds_read_b64_tr_b16 a[184:185], v14 offset:16384
    v_mfma_f32_16x16x32_bf16 a[220:223], a[156:159], a[116:119], a[220:223]
    ds_read_b64_tr_b16 a[186:187], v14 offset:20480
    buffer_load_dwordx4 v18, s[52:55], s83 offen offset:1024 lds
    s_waitcnt lgkmcnt(12)
    v_mfma_f32_16x16x32_bf16 v[96:99], a[160:163], a[120:123], v[96:99]
    ds_read_b64_tr_b16 a[188:189], v15 offset:16384
    v_mfma_f32_16x16x32_bf16 a[192:195], a[160:163], a[124:127], a[192:195]
    ds_read_b64_tr_b16 a[190:191], v15 offset:20480
    s_waitcnt lgkmcnt(12)
    s_branch L_over12
L_stub12:
    s_branch L_stubret
L_over12:
    v_mfma_f32_16x16x32_bf16 v[100:103], a[164:167], a[120:123], v[100:103]
    ds_read_b64_tr_b16 a[128:129], v8 offset:32768
    v_mfma_f32_16x16x32_bf16 a[196:199], a[164:167], a[124:127], a[196:199]
    ds_read_b64_tr_b16 a[130:131], v8 offset:36864
    s_waitcnt lgkmcnt(12)
    v_mfma_f32_16x16x32_bf16 v[104:107], a[168:171], a[120:123], v[104:107]
    ds_read_b64_tr_b16 a[132:133], v9 offset:32768
    s_mov_b32 s82, 1703936
    s_add_u32 m0, s3, 114688
    s_nop 0
    buffer_load_dwordx4 v17, s[52:55], s82 offen lds
    v_mfma_f32_16x16x32_bf16 a[200:203], a[168:171], a[124:127], a[200:203]
    ds_read_b64_tr_b16 a[134:135], v9 offset:36864
    s_waitcnt lgkmcnt(12)
    v_mfma_f32_16x16x32_bf16 v[108:111], a[172:175], a[120:123], v[108:111]
    ds_read_b64_tr_b16 a[136:137], v10 offset:32768
    v_mfma_f32_16x16x32_bf16 a[204:207], a[172:175], a[124:127], a[204:207]
    ds_read_b64_tr_b16 a[138:139], v10 offset:36864
    s_waitcnt lgkmcnt(12)
    v_mfma_f32_16x16x32_bf16 v[112:115], a[176:179], a[120:123], v[112:115]
    ds_read_b64_tr_b16 a[140:141], v11 offset:32768
    v_mfma_f32_16x16x32_bf16 a[208:211], a[176:179], a[124:127], a[208:211]
    ds_read_b64_tr_b16 a[142:143], v11 offset:36864
    buffer_load_dwordx4 v18, s[52:55], s82 offen offset:1024 lds
    s_waitcnt lgkmcnt(12)
    v_mfma_f32_16x16x32_bf16 v[116:119], a[180:183], a[120:123], v[116:119]
    ds_read_b64_tr_b16 a[144:145], v12 offset:32768
    v_mfma_f32_16x16x32_bf16 a[212:215], a[180:183], a[124:127], a[212:215]
    ds_read_b64_tr_b16 a[146:147], v12 offset:36864
    s_waitcnt lgkmcnt(12)
    v_mfma_f32_16x16x32_bf16 v[120:123], a[184:187], a[120:123], v[120:123]
    ds_read_b64_tr_b16 a[148:149], v13 offset:32768
    v_mfma_f32_16x16x32_bf16 a[216:219], a[184:187], a[124:127], a[216:219]
    ds_read_b64_tr_b16 a[150:151], v13 offset:36864
    s_waitcnt lgkmcnt(12)
    v_mfma_f32_16x16x32_bf16 v[124:127], a[188:191], a[120:123], v[124:127]
    ds_read_b64_tr_b16 a[152:153], v14 offset:32768
    s_mov_b32 s83, 1769472
    s_add_u32 m0, s3, 122880
    s_nop 0
    buffer_load_dwordx4 v17, s[52:55], s83 offen lds
    v_mfma_f32_16x16x32_bf16 a[220:223], a[188:191], a[124:127], a[220:223]
    ds_read_b64_tr_b16 a[154:155], v14 offset:36864
    s_waitcnt lgkmcnt(12)
    v_mfma_f32_16x16x32_bf16 v[96:99], a[128:131], a[0:3], v[96:99]
    ds_read_b64_tr_b16 a[156:157], v15 offset:32768
    v_mfma_f32_16x16x32_bf16 a[192:195], a[128:131], a[4:7], a[192:195]
    ds_read_b64_tr_b16 a[158:159], v15 offset:36864
    s_waitcnt lgkmcnt(12)
    v_mfma_f32_16x16x32_bf16 v[100:103], a[132:135], a[0:3], v[100:103]
    ds_read_b64_tr_b16 a[160:161], v8 offset:49152
    s_waitcnt vmcnt(14)
    s_mov_b64 exec, 1
    buffer_atomic_add v25, off, s[56:59], s77 sc1
    s_mov_b64 exec, -1
    v_mfma_f32_16x16x32_bf16 a[196:199], a[132:135], a[4:7], a[196:199]
    ds_read_b64_tr_b16 a[162:163], v8 offset:53248
    buffer_load_dwordx4 v18, s[52:55], s83 offen offset:1024 lds
    s_waitcnt lgkmcnt(12)
    v_mfma_f32_16x16x32_bf16 v[104:107], a[136:139], a[0:3], v[104:107]
    ds_read_b64_tr_b16 a[164:165], v9 offset:49152
    v_mfma_f32_16x16x32_bf16 a[200:203], a[136:139], a[4:7], a[200:203]
    ds_read_b64_tr_b16 a[166:167], v9 offset:53248
    s_waitcnt lgkmcnt(12)
    v_mfma_f32_16x16x32_bf16 v[108:111], a[140:143], a[0:3], v[108:111]
    ds_read_b64_tr_b16 a[168:169], v10 offset:49152
    v_mfma_f32_16x16x32_bf16 a[204:207], a[140:143], a[4:7], a[204:207]
    ds_read_b64_tr_b16 a[170:171], v10 offset:53248
    s_waitcnt lgkmcnt(12)
    v_mfma_f32_16x16x32_bf16 v[112:115], a[144:147], a[0:3], v[112:115]
    ds_read_b64_tr_b16 a[172:173], v11 offset:49152
    s_mov_b32 s82, 1835008
    s_add_u32 m0, s3, 131072
    s_nop 0
    buffer_load_dwordx4 v17, s[52:55], s82 offen lds
    v_mfma_f32_16x16x32_bf16 a[208:211], a[144:147], a[4:7], a[208:211]
    ds_read_b64_tr_b16 a[174:175], v11 offset:53248
    s_waitcnt lgkmcnt(12)
    v_mfma_f32_16x16x32_bf16 v[116:119], a[148:151], a[0:3], v[116:119]
    ds_read_b64_tr_b16 a[176:177], v12 offset:49152
    v_mfma_f32_16x16x32_bf16 a[212:215], a[148:151], a[4:7], a[212:215]
    ds_read_b64_tr_b16 a[178:179], v12 offset:53248
    s_waitcnt lgkmcnt(12)
    v_mfma_f32_16x16x32_bf16 v[120:123], a[152:155], a[0:3], v[120:123]
    ds_read_b64_tr_b16 a[180:181], v13 offset:49152
    v_mfma_f32_16x16x32_bf16 a[216:219], a[152:155], a[4:7], a[216:219]
    ds_read_b64_tr_b16 a[182:183], v13 offset:53248
    buffer_load_dwordx4 v18, s[52:55], s82 offen offset:1024 lds
    s_waitcnt lgkmcnt(12)
    v_mfma_f32_16x16x32_bf16 v[124:127], a[156:159], a[0:3], v[124:127]
    ds_read_b64_tr_b16 a[184:185], v14 offset:49152
    v_mfma_f32_16x16x32_bf16 a[220:223], a[156:159], a[4:7], a[220:223]
    ds_read_b64_tr_b16 a[186:187], v14 offset:53248
    s_waitcnt vmcnt(11)
    s_barrier
    s_waitcnt lgkmcnt(12)
    v_mfma_f32_16x16x32_bf16 v[96:99], a[160:163], a[8:11], v[96:99]
    ds_read_b64_tr_b16 a[188:189], v15 offset:49152
    v_mfma_f32_16x16x32_bf16 a[192:195], a[160:163], a[12:15], a[192:195]
    ds_read_b64_tr_b16 a[190:191], v15 offset:53248
    s_waitcnt lgkmcnt(12)
    v_mfma_f32_16x16x32_bf16 v[100:103], a[164:167], a[8:11], v[100:103]
    ds_read_b64_tr_b16 a[128:129], v48 offset:0
    s_mov_b32 s83, 1900544
    s_add_u32 m0, s3, 139264
    s_nop 0
    buffer_load_dwordx4 v17, s[52:55], s83 offen lds
    v_mfma_f32_16x16x32_bf16 a[196:199], a[164:167], a[12:15], a[196:199]
    ds_read_b64_tr_b16 a[130:131], v48 offset:4096
    s_waitcnt lgkmcnt(12)
    v_mfma_f32_16x16x32_bf16 v[104:107], a[168:171], a[8:11], v[104:107]
    ds_read_b64_tr_b16 a[132:133], v49 offset:0
    v_mfma_f32_16x16x32_bf16 a[200:203], a[168:171], a[12:15], a[200:203]
    ds_read_b64_tr_b16 a[134:135], v49 offset:4096
    s_waitcnt lgkmcnt(12)
    v_mfma_f32_16x16x32_bf16 v[108:111], a[172:175], a[8:11], v[108:111]
    ds_read_b64_tr_b16 a[136:137], v50 offset:0
    v_mfma_f32_16x16x32_bf16 a[204:207], a[172:175], a[12:15], a[204:207]
    ds_read_b64_tr_b16 a[138:139], v50 offset:4096
    buffer_load_dwordx4 v18, s[52:55], s83 offen offset:1024 lds
    s_waitcnt lgkmcnt(12)
    v_mfma_f32_16x16x32_bf16 v[112:115], a[176:179], a[8:11], v[112:115]
    ds_read_b64_tr_b16 a[140:141], v51 offset:0
    v_mfma_f32_16x16x32_bf16 a[208:211], a[176:179], a[12:15], a[208:211]
    ds_read_b64_tr_b16 a[142:143], v51 offset:4096
    s_waitcnt lgkmcnt(12)
    v_mfma_f32_16x16x32_bf16 v[116:119], a[180:183], a[8:11], v[116:119]
    ds_read_b64_tr_b16 a[144:145], v52 offset:0
    v_mfma_f32_16x16x32_bf16 a[212:215], a[180:183], a[12:15], a[212:215]
    ds_read_b64_tr_b16 a[146:147], v52 offset:4096
    s_waitcnt lgkmcnt(12)
    v_mfma_f32_16x16x32_bf16 v[120:123], a[184:187], a[8:11], v[120:123]
    ds_read_b64_tr_b16 a[148:149], v53 offset:0
    s_mov_b32 s82, 1966080
    s_add_u32 m0, s3, 147456
    s_nop 0
    buffer_load_dwordx4 v17, s[52:55], s82 offen lds
    v_mfma_f32_16x16x32_bf16 a[216:219], a[184:187], a[12:15], a[216:219]
    ds_read_b64_tr_b16 a[150:151], v53 offset:4096
    s_waitcnt lgkmcnt(12)
    v_mfma_f32_16x16x32_bf16 v[124:127], a[188:191], a[8:11], v[124:127]
    ds_read_b64_tr_b16 a[152:153], v54 offset:0
    v_mfma_f32_16x16x32_bf16 a[220:223], a[188:191], a[12:15], a[220:223]
    ds_read_b64_tr_b16 a[154:155], v54 offset:4096
    s_waitcnt lgkmcnt(12)
    v_mfma_f32_16x16x32_bf16 v[96:99], a[128:131], a[16:19], v[96:99]
    ds_read_b64_tr_b16 a[156:157], v55 offset:0
    buffer_load_dword v43, off, s[56:59], s77 sc1
    v_mfma_f32_16x16x32_bf16 a[192:195], a[128:131], a[20:23], a[192:195]
    ds_read_b64_tr_b16 a[158:159], v55 offset:4096
    buffer_load_dwordx4 v18, s[52:55], s82 offen offset:1024 lds
    s_waitcnt lgkmcnt(12)
    v_mfma_f32_16x16x32_bf16 v[100:103], a[132:135], a[16:19], v[100:103]
    ds_read_b64_tr_b16 a[160:161], v48 offset:16384
    v_mfma_f32_16x16x32_bf16 a[196:199], a[132:135], a[20:23], a[196:199]
    ds_read_b64_tr_b16 a[162:163], v48 offset:20480
    s_waitcnt lgkmcnt(12)
    v_mfma_f32_16x16x32_bf16 v[104:107], a[136:139], a[16:19], v[104:107]
    ds_read_b64_tr_b16 a[164:165], v49 offset:16384
    v_mfma_f32_16x16x32_bf16 a[200:203], a[136:139], a[20:23], a[200:203]
    ds_read_b64_tr_b16 a[166:167], v49 offset:20480
    s_waitcnt lgkmcnt(12)
    v_mfma_f32_16x16x32_bf16 v[108:111], a[140:143], a[16:19], v[108:111]
    ds_read_b64_tr_b16 a[168:169], v50 offset:16384
    s_mov_b32 s83, 2031616
    s_add_u32 m0, s3, 155648
    s_nop 0
    buffer_load_dwordx4 v17, s[52:55], s83 offen lds
    v_mfma_f32_16x16x32_bf16 a[204:207], a[140:143], a[20:23], a[204:207]
    ds_read_b64_tr_b16 a[170:171], v50 offset:20480
    s_waitcnt lgkmcnt(12)
    v_mfma_f32_16x16x32_bf16 v[112:115], a[144:147], a[16:19], v[112:115]
    ds_read_b64_tr_b16 a[172:173], v51 offset:16384
    v_mfma_f32_16x16x32_bf16 a[208:211], a[144:147], a[20:23], a[208:211]
    ds_read_b64_tr_b16 a[174:175], v51 offset:20480
    buffer_load_dwordx4 v18, s[52:55], s83 offen offset:1024 lds
    s_waitcnt lgkmcnt(12)
    v_mfma_f32_16x16x32_bf16 v[116:119], a[148:151], a[16:19], v[116:119]
    ds_read_b64_tr_b16 a[176:177], v52 offset:16384
    v_mfma_f32_16x16x32_bf16 a[212:215], a[148:151], a[20:23], a[212:215]
    ds_read_b64_tr_b16 a[178:179], v52 offset:20480
    s_waitcnt lgkmcnt(12)
    v_mfma_f32_16x16x32_bf16 v[120:123], a[152:155], a[16:19], v[120:123]
    ds_read_b64_tr_b16 a[180:181], v53 offset:16384
    v_mfma_f32_16x16x32_bf16 a[216:219], a[152:155], a[20:23], a[216:219]
    ds_read_b64_tr_b16 a[182:183], v53 offset:20480
    s_waitcnt lgkmcnt(12)
    v_mfma_f32_16x16x32_bf16 v[124:127], a[156:159], a[16:19], v[124:127]
    ds_read_b64_tr_b16 a[184:185], v54 offset:16384
    v_mfma_f32_16x16x32_bf16 a[220:223], a[156:159], a[20:23], a[220:223]
    ds_read_b64_tr_b16 a[186:187], v54 offset:20480
    s_waitcnt vmcnt(9)
    s_barrier
    s_waitcnt lgkmcnt(12)
    v_mfma_f32_16x16x32_bf16 v[96:99], a[160:163], a[24:27], v[96:99]
    ds_read_b64_tr_b16 a[188:189], v55 offset:16384
    v_mfma_f32_16x16x32_bf16 a[192:195], a[160:163], a[28:31], a[192:195]
    ds_read_b64_tr_b16 a[190:191], v55 offset:20480
    s_waitcnt lgkmcnt(12)
    v_mfma_f32_16x16x32_bf16 v[100:103], a[164:167], a[24:27], v[100:103]
    ds_read_b64_tr_b16 a[128:129], v48 offset:32768
    v_mfma_f32_16x16x32_bf16 a[196:199], a[164:167], a[28:31], a[196:199]
    ds_read_b64_tr_b16 a[130:131], v48 offset:36864
    s_waitcnt lgkmcnt(12)
    v_mfma_f32_16x16x32_bf16 v[104:107], a[168:171], a[24:27], v[104:107]
    ds_read_b64_tr_b16 a[132:133], v49 offset:32768
    v_mfma_f32_16x16x32_bf16 a[200:203], a[168:171], a[28:31], a[200:203]
    ds_read_b64_tr_b16 a[134:135], v49 offset:36864
    s_waitcnt lgkmcnt(12)
    v_mfma_f32_16x16x32_bf16 v[108:111], a[172:175], a[24:27], v[108:111]
    ds_read_b64_tr_b16 a[136:137], v50 offset:32768
    v_mfma_f32_16x16x32_bf16 a[204:207], a[172:175], a[28:31], a[204:207]
    ds_read_b64_tr_b16 a[138:139], v50 offset:36864
    s_waitcnt lgkmcnt(12)
    v_mfma_f32_16x16x32_bf16 v[112:115], a[176:179], a[24:27], v[112:115]
    ds_read_b64_tr_b16 a[140:141], v51 offset:32768
    v_mfma_f32_16x16x32_bf16 a[208:211], a[176:179], a[28:31], a[208:211]
    ds_read_b64_tr_b16 a[142:143], v51 offset:36864
    s_waitcnt lgkmcnt(12)
    v_mfma_f32_16x16x32_bf16 v[116:119], a[180:183], a[24:27], v[116:119]
    ds_read_b64_tr_b16 a[144:145], v52 offset:32768
    v_mfma_f32_16x16x32_bf16 a[212:215], a[180:183], a[28:31], a[212:215]
    ds_read_b64_tr_b16 a[146:147], v52 offset:36864
    s_waitcnt lgkmcnt(12)
    v_mfma_f32_16x16x32_bf16 v[120:123], a[184:187], a[24:27], v[120:123]
    ds_read_b64_tr_b16 a[148:149], v53 offset:32768
    v_mfma_f32_16x16x32_bf16 a[216:219], a[184:187], a[28:31], a[216:219]
    ds_read_b64_tr_b16 a[150:151], v53 offset:36864
    s_waitcnt lgkmcnt(12)
    v_mfma_f32_16x16x32_bf16 v[124:127], a[188:191], a[24:27], v[124:127]
    ds_read_b64_tr_b16 a[152:153], v54 offset:32768
    v_mfma_f32_16x16x32_bf16 a[220:223], a[188:191], a[28:31], a[220:223]
    ds_read_b64_tr_b16 a[154:155], v54 offset:36864
    s_waitcnt lgkmcnt(12)
    v_mfma_f32_16x16x32_bf16 v[96:99], a[128:131], a[224:227], v[96:99]
    ds_read_b64_tr_b16 a[156:157], v55 offset:32768
    v_mfma_f32_16x16x32_bf16 a[192:195], a[128:131], a[228:231], a[192:195]
    ds_read_b64_tr_b16 a[158:159], v55 offset:36864
    s_waitcnt lgkmcnt(12)
    v_mfma_f32_16x16x32_bf16 v[100:103], a[132:135], a[224:227], v[100:103]
    ds_read_b64_tr_b16 a[160:161], v48 offset:49152
    v_mfma_f32_16x16x32_bf16 a[196:199], a[132:135], a[228:231], a[196:199]
    ds_read_b64_tr_b16 a[162:163], v48 offset:53248
    s_waitcnt vmcnt(3)
    v_readfirstlane_b32 s86, v43
    s_or_b32 s86, s86, s90
    s_cmp_eq_u32 s86, 0x01010101
    s_cbranch_scc0 L_spP
L_okP:
    buffer_load_dwordx4 v[164:167], v16, s[56:59], s73 offen offset:0 sc1
    s_waitcnt lgkmcnt(12)
    v_mfma_f32_16x16x32_bf16 v[104:107], a[136:139], a[224:227], v[104:107]
    ds_read_b64_tr_b16 a[164:165], v49 offset:49152
    v_mfma_f32_16x16x32_bf16 a[200:203], a[136:139], a[228:231], a[200:203]
    ds_read_b64_tr_b16 a[166:167], v49 offset:53248
    s_waitcnt lgkmcnt(12)
    v_mfma_f32_16x16x32_bf16 v[108:111], a[140:143], a[224:227], v[108:111]
    ds_read_b64_tr_b16 a[168:169], v50 offset:49152
    buffer_load_dwordx4 v[172:175], v16, s[56:59], s73 offen offset:1024 sc1
    v_mfma_f32_16x16x32_bf16 a[204:207], a[140:143], a[228:231], a[204:207]
    ds_read_b64_tr_b16 a[170:171], v50 offset:53248
    s_waitcnt lgkmcnt(12)
    v_mfma_f32_16x16x32_bf16 v[112:115], a[144:147], a[224:227], v[112:115]
    ds_read_b64_tr_b16 a[172:173], v51 offset:49152
    v_mfma_f32_16x16x32_bf16 a[208:211], a[144:147], a[228:231], a[208:211]
    ds_read_b64_tr_b16 a[174:175], v51 offset:53248
    buffer_load_dwordx4 v[180:183], v16, s[56:59], s73 offen offset:2048 sc1
    s_waitcnt lgkmcnt(12)
    v_mfma_f32_16x16x32_bf16 v[116:119], a[148:151], a[224:227], v[116:119]
    ds_read_b64_tr_b16 a[176:177], v52 offset:49152
    v_mfma_f32_16x16x32_bf16 a[212:215], a[148:151], a[228:231], a[212:215]
    ds_read_b64_tr_b16 a[178:179], v52 offset:53248
    s_waitcnt lgkmcnt(12)
    v_mfma_f32_16x16x32_bf16 v[120:123], a[152:155], a[224:227], v[120:123]
    ds_read_b64_tr_b16 a[180:181], v53 offset:49152
    buffer_load_dwordx4 v[188:191], v16, s[56:59], s73 offen offset:3072 sc1
    v_mfma_f32_16x16x32_bf16 a[216:219], a[152:155], a[228:231], a[216:219]
    ds_read_b64_tr_b16 a[182:183], v53 offset:53248
    s_waitcnt lgkmcnt(12)
    v_mfma_f32_16x16x32_bf16 v[124:127], a[156:159], a[224:227], v[124:127]
    ds_read_b64_tr_b16 a[184:185], v54 offset:49152
    v_mfma_f32_16x16x32_bf16 a[220:223], a[156:159], a[228:231], a[220:223]
    ds_read_b64_tr_b16 a[186:187], v54 offset:53248
    buffer_load_dwordx4 v[196:199], v16, s[56:59], s74 offen offset:0 sc1
    s_waitcnt vmcnt(5)
    s_barrier
    s_waitcnt lgkmcnt(12)
    v_mfma_f32_16x16x32_bf16 v[96:99], a[160:163], a[232:235], v[96:99]
    ds_read_b64_tr_b16 a[188:189], v55 offset:49152
    v_mfma_f32_16x16x32_bf16 a[192:195], a[160:163], a[236:239], a[192:195]
    ds_read_b64_tr_b16 a[190:191], v55 offset:53248
    s_waitcnt lgkmcnt(12)
    v_mfma_f32_16x16x32_bf16 v[100:103], a[164:167], a[232:235], v[100:103]
    ds_read_b64_tr_b16 a[128:129], v56 offset:0
    buffer_load_dwordx4 v[204:207], v16, s[56:59], s74 offen offset:1024 sc1
    v_mfma_f32_16x16x32_bf16 a[196:199], a[164:167], a[236:239], a[196:199]
    ds_read_b64_tr_b16 a[130:131], v56 offset:4096
    s_waitcnt lgkmcnt(12)
    v_mfma_f32_16x16x32_bf16 v[104:107], a[168:171], a[232:235], v[104:107]
    ds_read_b64_tr_b16 a[132:133], v57 offset:0
    v_mfma_f32_16x16x32_bf16 a[200:203], a[168:171], a[236:239], a[200:203]
    ds_read_b64_tr_b16 a[134:135], v57 offset:4096
    buffer_load_dwordx4 v[212:215], v16, s[56:59], s74 offen offset:2048 sc1
    s_waitcnt lgkmcnt(12)
    v_mfma_f32_16x16x32_bf16 v[108:111], a[172:175], a[232:235], v[108:111]
    ds_read_b64_tr_b16 a[136:137], v58 offset:0
    v_mfma_f32_16x16x32_bf16 a[204:207], a[172:175], a[236:239], a[204:207]
    ds_read_b64_tr_b16 a[138:139], v58 offset:4096
    s_waitcnt lgkmcnt(12)
    v_mfma_f32_16x16x32_bf16 v[112:115], a[176:179], a[232:235], v[112:115]
    ds_read_b64_tr_b16 a[140:141], v59 offset:0
    buffer_load_dwordx4 v[220:223], v16, s[56:59], s74 offen offset:3072 sc1
    v_mfma_f32_16x16x32_bf16 a[208:211], a[176:179], a[236:239], a[208:211]
    ds_read_b64_tr_b16 a[142:143], v59 offset:4096
    s_waitcnt lgkmcnt(12)
    v_mfma_f32_16x16x32_bf16 v[116:119], a[180:183], a[232:235], v[116:119]
    ds_read_b64_tr_b16 a[144:145], v60 offset:0
    v_mfma_f32_16x16x32_bf16 a[212:215], a[180:183], a[236:239], a[212:215]
    ds_read_b64_tr_b16 a[146:147], v60 offset:4096
    buffer_load_dwordx4 v[228:231], v16, s[56:59], s75 offen offset:0 sc1
    s_waitcnt lgkmcnt(12)
    v_mfma_f32_16x16x32_bf16 v[120:123], a[184:187], a[232:235], v[120:123]
    ds_read_b64_tr_b16 a[148:149], v61 offset:0
    v_mfma_f32_16x16x32_bf16 a[216:219], a[184:187], a[236:239], a[216:219]
    ds_read_b64_tr_b16 a[150:151], v61 offset:4096
    s_waitcnt lgkmcnt(12)
    v_mfma_f32_16x16x32_bf16 v[124:127], a[188:191], a[232:235], v[124:127]
    ds_read_b64_tr_b16 a[152:153], v62 offset:0
    buffer_load_dwordx4 v[236:239], v16, s[56:59], s75 offen offset:1024 sc1
    v_mfma_f32_16x16x32_bf16 a[220:223], a[188:191], a[236:239], a[220:223]
    ds_read_b64_tr_b16 a[154:155], v62 offset:4096
    s_waitcnt lgkmcnt(12)
    v_mfma_f32_16x16x32_bf16 v[96:99], a[128:131], a[240:243], v[96:99]
    ds_read_b64_tr_b16 a[156:157], v63 offset:0
    v_mfma_f32_16x16x32_bf16 a[192:195], a[128:131], a[244:247], a[192:195]
    ds_read_b64_tr_b16 a[158:159], v63 offset:4096
    buffer_load_dwordx4 v[244:247], v16, s[56:59], s75 offen offset:2048 sc1
    s_waitcnt lgkmcnt(12)
    v_mfma_f32_16x16x32_bf16 v[100:103], a[132:135], a[240:243], v[100:103]
    ds_read_b64_tr_b16 a[160:161], v56 offset:16384
    v_mfma_f32_16x16x32_bf16 a[196:199], a[132:135], a[244:247], a[196:199]
    ds_read_b64_tr_b16 a[162:163], v56 offset:20480
    s_waitcnt lgkmcnt(12)
    v_mfma_f32_16x16x32_bf16 v[104:107], a[136:139], a[240:243], v[104:107]
    ds_read_b64_tr_b16 a[164:165], v57 offset:16384
    buffer_load_dwordx4 v[252:255], v16, s[56:59], s75 offen offset:3072 sc1
    v_mfma_f32_16x16x32_bf16 a[200:203], a[136:139], a[244:247], a[200:203]
    ds_read_b64_tr_b16 a[166:167], v57 offset:20480
    s_waitcnt lgkmcnt(12)
    v_mfma_f32_16x16x32_bf16 v[108:111], a[140:143], a[240:243], v[108:111]
    ds_read_b64_tr_b16 a[168:169], v58 offset:16384
    v_mfma_f32_16x16x32_bf16 a[204:207], a[140:143], a[244:247], a[204:207]
    ds_read_b64_tr_b16 a[170:171], v58 offset:20480
    s_waitcnt lgkmcnt(12)
    v_mfma_f32_16x16x32_bf16 v[112:115], a[144:147], a[240:243], v[112:115]
    ds_read_b64_tr_b16 a[172:173], v59 offset:16384
    v_mfma_f32_16x16x32_bf16 a[208:211], a[144:147], a[244:247], a[208:211]
    ds_read_b64_tr_b16 a[174:175], v59 offset:20480
    s_waitcnt lgkmcnt(12)
    v_mfma_f32_16x16x32_bf16 v[116:119], a[148:151], a[240:243], v[116:119]
    ds_read_b64_tr_b16 a[176:177], v60 offset:16384
    v_mfma_f32_16x16x32_bf16 a[212:215], a[148:151], a[244:247], a[212:215]
    ds_read_b64_tr_b16 a[178:179], v60 offset:20480
    s_waitcnt lgkmcnt(12)
    v_mfma_f32_16x16x32_bf16 v[120:123], a[152:155], a[240:243], v[120:123]
    ds_read_b64_tr_b16 a[180:181], v61 offset:16384
    v_mfma_f32_16x16x32_bf16 a[216:219], a[152:155], a[244:247], a[216:219]
    ds_read_b64_tr_b16 a[182:183], v61 offset:20480
    s_waitcnt lgkmcnt(12)
    v_mfma_f32_16x16x32_bf16 v[124:127], a[156:159], a[240:243], v[124:127]
    ds_read_b64_tr_b16 a[184:185], v62 offset:16384
    v_mfma_f32_16x16x32_bf16 a[220:223], a[156:159], a[244:247], a[220:223]
    ds_read_b64_tr_b16 a[186:187], v62 offset:20480
    s_waitcnt lgkmcnt(12)
    v_mfma_f32_16x16x32_bf16 a[192:195], a[160:163], a[252:255], a[192:195]
    ds_read_b64_tr_b16 a[188:189], v63 offset:16384
    s_waitcnt lgkmcnt(11)
    v_mfma_f32_16x16x32_bf16 a[196:199], a[164:167], a[252:255], a[196:199]
    ds_read_b64_tr_b16 a[190:191], v63 offset:20480
    s_waitcnt lgkmcnt(10)
    v_mfma_f32_16x16x32_bf16 a[200:203], a[168:171], a[252:255], a[200:203]
    s_waitcnt lgkmcnt(8)
    v_mfma_f32_16x16x32_bf16 a[204:207], a[172:175], a[252:255], a[204:207]
    s_waitcnt lgkmcnt(6)
    v_mfma_f32_16x16x32_bf16 a[208:211], a[176:179], a[252:255], a[208:211]
    s_waitcnt lgkmcnt(4)
    v_mfma_f32_16x16x32_bf16 a[212:215], a[180:183], a[252:255], a[212:215]
    s_waitcnt lgkmcnt(2)
    v_mfma_f32_16x16x32_bf16 a[216:219], a[184:187], a[252:255], a[216:219]
    s_waitcnt lgkmcnt(0)
    v_mfma_f32_16x16x32_bf16 a[220:223], a[188:191], a[252:255], a[220:223]
    v_mfma_f32_16x16x32_bf16 v[96:99], a[160:163], a[248:251], v[96:99]
    ds_write_b128 v19, a[192:195] offset:0
    v_mfma_f32_16x16x32_bf16 v[100:103], a[164:167], a[248:251], v[100:103]
    ds_write_b128 v19, a[196:199] offset:1024
    v_mfma_f32_16x16x32_bf16 v[104:107], a[168:171], a[248:251], v[104:107]
    ds_write_b128 v19, a[200:203] offset:2048
    v_mfma_f32_16x16x32_bf16 v[108:111], a[172:175], a[248:251], v[108:111]
    ds_write_b128 v19, a[204:207] offset:3072
    v_mfma_f32_16x16x32_bf16 v[112:115], a[176:179], a[248:251], v[112:115]
    ds_write_b128 v19, a[208:211] offset:4096
    v_mfma_f32_16x16x32_bf16 v[116:119], a[180:183], a[248:251], v[116:119]
    ds_write_b128 v19, a[212:215] offset:5120
    v_mfma_f32_16x16x32_bf16 v[120:123], a[184:187], a[248:251], v[120:123]
    ds_write_b128 v19, a[216:219] offset:6144
    v_mfma_f32_16x16x32_bf16 v[124:127], a[188:191], a[248:251], v[124:127]
    ds_write_b128 v19, a[220:223] offset:7168
    s_waitcnt vmcnt(11)
    v_mfma_f32_16x16x32_bf16 v[128:131], v[28:31], v[164:167], v[128:131]
    v_mfma_f32_16x16x32_bf16 v[132:135], v[26:29], v[164:167], v[132:135]
    s_waitcnt vmcnt(10)
    v_mfma_f32_16x16x32_bf16 v[136:139], v[28:31], v[172:175], v[136:139]
    v_mfma_f32_16x16x32_bf16 v[140:143], v[26:29], v[172:175], v[140:143]
    s_waitcnt lgkmcnt(0)
    s_barrier
    ds_read_b128 v[160:163], v20 offset:0
    ds_read_b128 v[168:171], v20 offset:1024
    ds_read_b128 v[176:179], v20 offset:2048
    ds_read_b128 v[184:187], v20 offset:3072
    ds_read_b128 v[192:195], v20 offset:4096
    ds_read_b128 v[200:203], v20 offset:5120
    ds_read_b128 v[208:211], v20 offset:6144
    ds_read_b128 v[216:219], v20 offset:7168
    s_waitcnt vmcnt(9)
    v_mfma_f32_16x16x32_bf16 v[144:147], v[28:31], v[180:183], v[144:147]
    v_mfma_f32_16x16x32_bf16 v[148:151], v[26:29], v[180:183], v[148:151]
    s_waitcnt vmcnt(8)
    v_mfma_f32_16x16x32_bf16 v[152:155], v[28:31], v[188:191], v[152:155]
    v_mfma_f32_16x16x32_bf16 v[156:159], v[26:29], v[188:191], v[156:159]
    s_waitcnt vmcnt(7)
    v_mfma_f32_16x16x32_bf16 v[128:131], v[28:31], v[196:199], v[128:131]
    v_mfma_f32_16x16x32_bf16 v[132:135], v[26:29], v[196:199], v[132:135]
    s_waitcnt vmcnt(6)
    v_mfma_f32_16x16x32_bf16 v[136:139], v[28:31], v[204:207], v[136:139]
    v_mfma_f32_16x16x32_bf16 v[140:143], v[26:29], v[204:207], v[140:143]
    s_waitcnt vmcnt(5)
    v_mfma_f32_16x16x32_bf16 v[144:147], v[28:31], v[212:215], v[144:147]
    v_mfma_f32_16x16x32_bf16 v[148:151], v[26:29], v[212:215], v[148:151]
    s_waitcnt vmcnt(4)
    v_mfma_f32_16x16x32_bf16 v[152:155], v[28:31], v[220:223], v[152:155]
    v_mfma_f32_16x16x32_bf16 v[156:159], v[26:29], v[220:223], v[156:159]
    s_waitcnt vmcnt(3)
    v_mfma_f32_16x16x32_bf16 v[128:131], v[28:31], v[228:231], v[128:131]
    v_mfma_f32_16x16x32_bf16 v[132:135], v[26:29], v[228:231], v[132:135]
    s_waitcnt vmcnt(2)
    v_mfma_f32_16x16x32_bf16 v[136:139], v[28:31], v[236:239], v[136:139]
    v_mfma_f32_16x16x32_bf16 v[140:143], v[26:29], v[236:239], v[140:143]
    s_waitcnt vmcnt(1)
    v_mfma_f32_16x16x32_bf16 v[144:147], v[28:31], v[244:247], v[144:147]
    v_mfma_f32_16x16x32_bf16 v[148:151], v[26:29], v[244:247], v[148:151]
    s_waitcnt vmcnt(0)
    v_mfma_f32_16x16x32_bf16 v[152:155], v[28:31], v[252:255], v[152:155]
    v_mfma_f32_16x16x32_bf16 v[156:159], v[26:29], v[252:255], v[156:159]
    s_waitcnt lgkmcnt(7)
    v_pk_add_f32 v[96:97], v[96:97], v[160:161]
    v_pk_add_f32 v[98:99], v[98:99], v[162:163]
    s_waitcnt lgkmcnt(6)
    v_pk_add_f32 v[100:101], v[100:101], v[168:169]
    v_pk_add_f32 v[102:103], v[102:103], v[170:171]
    v_pk_mul_f32 v[34:35], v[128:129], s[14:15]
    v_pk_mul_f32 v[36:37], v[130:131], s[14:15]
    v_pk_mul_f32 v[38:39], v[132:133], s[14:15]
    v_pk_mul_f32 v[40:41], v[134:135], s[14:15]
    v_exp_f32 v34, v34
    v_exp_f32 v35, v35
    v_exp_f32 v36, v36
    v_exp_f32 v37, v37
    v_exp_f32 v38, v38
    v_exp_f32 v39, v39
    v_exp_f32 v40, v40
    v_exp_f32 v41, v41
    v_pk_mul_f32 v[96:97], v[96:97], v[128:129]
    v_pk_mul_f32 v[98:99], v[98:99], v[130:131]
    v_pk_mul_f32 v[100:101], v[100:101], v[132:133]
    v_pk_mul_f32 v[102:103], v[102:103], v[134:135]
    v_pk_add_f32 v[34:35], v[34:35], 1.0 op_sel_hi:[1,0]
    v_pk_add_f32 v[36:37], v[36:37], 1.0 op_sel_hi:[1,0]
    v_pk_add_f32 v[38:39], v[38:39], 1.0 op_sel_hi:[1,0]
    v_pk_add_f32 v[40:41], v[40:41], 1.0 op_sel_hi:[1,0]
    v_rcp_f32 v34, v34
    v_rcp_f32 v35, v35
    v_rcp_f32 v36, v36
    v_rcp_f32 v37, v37
    v_rcp_f32 v38, v38
    v_rcp_f32 v39, v39
    v_rcp_f32 v40, v40
    v_rcp_f32 v41, v41
    v_pk_fma_f32 v[96:97], v[96:97], v[34:35], v[64:65]
    v_pk_fma_f32 v[98:99], v[98:99], v[36:37], v[66:67]
    v_pk_fma_f32 v[100:101], v[100:101], v[38:39], v[68:69]
    v_pk_fma_f32 v[102:103], v[102:103], v[40:41], v[70:71]
    v_cvt_pk_bf16_f32 v96, v96, v97
    v_cvt_pk_bf16_f32 v97, v98, v99
    v_cvt_pk_bf16_f32 v98, v100, v101
    v_cvt_pk_bf16_f32 v99, v102, v103
    s_nop 0
    v_permlane16_swap_b32 v96, v98
    v_permlane16_swap_b32 v97, v99
    global_store_dwordx4 v2, v[96:99], s[22:23] offset:0 sc1
    s_waitcnt lgkmcnt(5)
    v_pk_add_f32 v[104:105], v[104:105], v[176:177]
    v_pk_add_f32 v[106:107], v[106:107], v[178:179]
    s_waitcnt lgkmcnt(4)
    v_pk_add_f32 v[108:109], v[108:109], v[184:185]
    v_pk_add_f32 v[110:111], v[110:111], v[186:187]
    v_pk_mul_f32 v[34:35], v[136:137], s[14:15]
    v_pk_mul_f32 v[36:37], v[138:139], s[14:15]
    v_pk_mul_f32 v[38:39], v[140:141], s[14:15]
    v_pk_mul_f32 v[40:41], v[142:143], s[14:15]
    v_exp_f32 v34, v34
    v_exp_f32 v35, v35
    v_exp_f32 v36, v36
    v_exp_f32 v37, v37
    v_exp_f32 v38, v38
    v_exp_f32 v39, v39
    v_exp_f32 v40, v40
    v_exp_f32 v41, v41
    v_pk_mul_f32 v[104:105], v[104:105], v[136:137]
    v_pk_mul_f32 v[106:107], v[106:107], v[138:139]
    v_pk_mul_f32 v[108:109], v[108:109], v[140:141]
    v_pk_mul_f32 v[110:111], v[110:111], v[142:143]
    v_pk_add_f32 v[34:35], v[34:35], 1.0 op_sel_hi:[1,0]
    v_pk_add_f32 v[36:37], v[36:37], 1.0 op_sel_hi:[1,0]
    v_pk_add_f32 v[38:39], v[38:39], 1.0 op_sel_hi:[1,0]
    v_pk_add_f32 v[40:41], v[40:41], 1.0 op_sel_hi:[1,0]
    v_rcp_f32 v34, v34
    v_rcp_f32 v35, v35
    v_rcp_f32 v36, v36
    v_rcp_f32 v37, v37
    v_rcp_f32 v38, v38
    v_rcp_f32 v39, v39
    v_rcp_f32 v40, v40
    v_rcp_f32 v41, v41
    v_pk_fma_f32 v[104:105], v[104:105], v[34:35], v[72:73]
    v_pk_fma_f32 v[106:107], v[106:107], v[36:37], v[74:75]
    v_pk_fma_f32 v[108:109], v[108:109], v[38:39], v[76:77]
    v_pk_fma_f32 v[110:111], v[110:111], v[40:41], v[78:79]
    v_cvt_pk_bf16_f32 v104, v104, v105
    v_cvt_pk_bf16_f32 v105, v106, v107
    v_cvt_pk_bf16_f32 v106, v108, v109
    v_cvt_pk_bf16_f32 v107, v110, v111
    s_nop 0
    v_permlane16_swap_b32 v104, v106
    v_permlane16_swap_b32 v105, v107
    global_store_dwordx4 v2, v[104:107], s[22:23] offset:64 sc1
    s_waitcnt lgkmcnt(3)
    v_pk_add_f32 v[112:113], v[112:113], v[192:193]
    v_pk_add_f32 v[114:115], v[114:115], v[194:195]
    s_waitcnt lgkmcnt(2)
    v_pk_add_f32 v[116:117], v[116:117], v[200:201]
    v_pk_add_f32 v[118:119], v[118:119], v[202:203]
    v_pk_mul_f32 v[34:35], v[144:145], s[14:15]
    v_pk_mul_f32 v[36:37], v[146:147], s[14:15]
    v_pk_mul_f32 v[38:39], v[148:149], s[14:15]
    v_pk_mul_f32 v[40:41], v[150:151], s[14:15]
    v_exp_f32 v34, v34
    v_exp_f32 v35, v35
    v_exp_f32 v36, v36
    v_exp_f32 v37, v37
    v_exp_f32 v38, v38
    v_exp_f32 v39, v39
    v_exp_f32 v40, v40
    v_exp_f32 v41, v41
    v_pk_mul_f32 v[112:113], v[112:113], v[144:145]
    v_pk_mul_f32 v[114:115], v[114:115], v[146:147]
    v_pk_mul_f32 v[116:117], v[116:117], v[148:149]
    v_pk_mul_f32 v[118:119], v[118:119], v[150:151]
    v_pk_add_f32 v[34:35], v[34:35], 1.0 op_sel_hi:[1,0]
    v_pk_add_f32 v[36:37], v[36:37], 1.0 op_sel_hi:[1,0]
    v_pk_add_f32 v[38:39], v[38:39], 1.0 op_sel_hi:[1,0]
    v_pk_add_f32 v[40:41], v[40:41], 1.0 op_sel_hi:[1,0]
    v_rcp_f32 v34, v34
    v_rcp_f32 v35, v35
    v_rcp_f32 v36, v36
    v_rcp_f32 v37, v37
    v_rcp_f32 v38, v38
    v_rcp_f32 v39, v39
    v_rcp_f32 v40, v40
    v_rcp_f32 v41, v41
    v_pk_fma_f32 v[112:113], v[112:113], v[34:35], v[80:81]
    v_pk_fma_f32 v[114:115], v[114:115], v[36:37], v[82:83]
    v_pk_fma_f32 v[116:117], v[116:117], v[38:39], v[84:85]
    v_pk_fma_f32 v[118:119], v[118:119], v[40:41], v[86:87]
    v_cvt_pk_bf16_f32 v112, v112, v113
    v_cvt_pk_bf16_f32 v113, v114, v115
    v_cvt_pk_bf16_f32 v114, v116, v117
    v_cvt_pk_bf16_f32 v115, v118, v119
    s_nop 0
    v_permlane16_swap_b32 v112, v114
    v_permlane16_swap_b32 v113, v115
    global_store_dwordx4 v2, v[112:115], s[22:23] offset:128 sc1
    s_waitcnt lgkmcnt(1)
    v_pk_add_f32 v[120:121], v[120:121], v[208:209]
    v_pk_add_f32 v[122:123], v[122:123], v[210:211]
    s_waitcnt lgkmcnt(0)
    v_pk_add_f32 v[124:125], v[124:125], v[216:217]
    s_branch L_over13
L_stub13:
    s_branch L_stubret
L_over13:
    v_pk_add_f32 v[126:127], v[126:127], v[218:219]
    v_pk_mul_f32 v[34:35], v[152:153], s[14:15]
    v_pk_mul_f32 v[36:37], v[154:155], s[14:15]
    v_pk_mul_f32 v[38:39], v[156:157], s[14:15]
    v_pk_mul_f32 v[40:41], v[158:159], s[14:15]
    v_exp_f32 v34, v34
    v_exp_f32 v35, v35
    v_exp_f32 v36, v36
    v_exp_f32 v37, v37
    v_exp_f32 v38, v38
    v_exp_f32 v39, v39
    v_exp_f32 v40, v40
    v_exp_f32 v41, v41
    v_pk_mul_f32 v[120:121], v[120:121], v[152:153]
    v_pk_mul_f32 v[122:123], v[122:123], v[154:155]
    v_pk_mul_f32 v[124:125], v[124:125], v[156:157]
    v_pk_mul_f32 v[126:127], v[126:127], v[158:159]
    v_pk_add_f32 v[34:35], v[34:35], 1.0 op_sel_hi:[1,0]
    v_pk_add_f32 v[36:37], v[36:37], 1.0 op_sel_hi:[1,0]
    v_pk_add_f32 v[38:39], v[38:39], 1.0 op_sel_hi:[1,0]
    v_pk_add_f32 v[40:41], v[40:41], 1.0 op_sel_hi:[1,0]
    v_rcp_f32 v34, v34
    v_rcp_f32 v35, v35
    v_rcp_f32 v36, v36
    v_rcp_f32 v37, v37
    v_rcp_f32 v38, v38
    v_rcp_f32 v39, v39
    v_rcp_f32 v40, v40
    v_rcp_f32 v41, v41
    v_pk_fma_f32 v[120:121], v[120:121], v[34:35], v[88:89]
    v_pk_fma_f32 v[122:123], v[122:123], v[36:37], v[90:91]
    v_pk_fma_f32 v[124:125], v[124:125], v[38:39], v[92:93]
    v_pk_fma_f32 v[126:127], v[126:127], v[40:41], v[94:95]
    v_cvt_pk_bf16_f32 v120, v120, v121
    v_cvt_pk_bf16_f32 v121, v122, v123
    v_cvt_pk_bf16_f32 v122, v124, v125
    v_cvt_pk_bf16_f32 v123, v126, v127
    s_nop 0
    v_permlane16_swap_b32 v120, v122
    v_permlane16_swap_b32 v121, v123
    global_store_dwordx4 v2, v[120:123], s[22:23] offset:192 sc1
L_end:
    s_endpgm
L_spA0:
    buffer_load_dword v43, off, s[56:59], s92 sc1
    s_waitcnt vmcnt(0)
    v_readfirstlane_b32 s86, v43
    s_bfe_u32 s86, s86, 0x80000
    s_cmp_eq_u32 s86, 32
    s_cbranch_scc1 L_okA0
    s_add_u32 s67, s67, 1
    s_cmp_lt_u32 s67, 0x40000
    s_cbranch_scc1 L_spA0
    s_branch L_okA0
L_spA1:
    buffer_load_dword v43, off, s[56:59], s92 sc1
    s_waitcnt vmcnt(0)
    v_readfirstlane_b32 s86, v43
    s_bfe_u32 s86, s86, 0x80000
    s_cmp_eq_u32 s86, 32
    s_cbranch_scc1 L_okA1
    s_add_u32 s67, s67, 1
    s_cmp_lt_u32 s67, 0x40000
    s_cbranch_scc1 L_spA1
    s_branch L_okA1
L_spB:
    buffer_load_dword v43, off, s[56:59], s92 sc1
    s_waitcnt vmcnt(0)
    v_readfirstlane_b32 s86, v43
    s_bfe_u32 s86, s86, 0x80008
    s_cmp_eq_u32 s86, 16
    s_cbranch_scc1 L_okB
    s_add_u32 s67, s67, 1
    s_cmp_lt_u32 s67, 0x40000
    s_cbranch_scc1 L_spB
    s_branch L_okB
L_spC:
    buffer_load_dword v43, off, s[56:59], s92 sc1
    s_waitcnt vmcnt(0)
    v_readfirstlane_b32 s86, v43
    s_bfe_u32 s86, s86, 0x80010
    s_cmp_eq_u32 s86, 16
    s_cbranch_scc1 L_okC
    s_add_u32 s67, s67, 1
    s_cmp_lt_u32 s67, 0x40000
    s_cbranch_scc1 L_spC
    s_branch L_okC
L_spO:
    buffer_load_dword v43, off, s[56:59], s76 sc1
    s_waitcnt vmcnt(0)
    v_readfirstlane_b32 s86, v43
    s_cmp_eq_u32 s86, 64
    s_cbranch_scc1 L_okO
    s_add_u32 s67, s67, 1
    s_cmp_lt_u32 s67, 0x40000
    s_cbranch_scc1 L_spO
    s_branch L_okO
L_spP:
    buffer_load_dword v43, off, s[56:59], s77 sc1
    s_waitcnt vmcnt(0)
    v_readfirstlane_b32 s86, v43
    s_or_b32 s86, s86, s90
    s_cmp_eq_u32 s86, 0x01010101
    s_cbranch_scc1 L_okP
    s_add_u32 s67, s67, 1
    s_cmp_lt_u32 s67, 0x40000
    s_cbranch_scc1 L_spP
    s_branch L_okP
L_code_end:
.section .rodata,"a"
.p2align 6
.amdhsa_kernel recurrent_scan__sliding_local_dilated__glu_gated_geglu__prompt_kernel
  .amdhsa_next_free_vgpr 512
  .amdhsa_next_free_sgpr 102
  .amdhsa_accum_offset 256
  .amdhsa_group_segment_fixed_size 0
  .amdhsa_kernarg_size 80
  .amdhsa_user_sgpr_count 2
  .amdhsa_user_sgpr_kernarg_segment_ptr 1
  .amdhsa_system_sgpr_workgroup_id_x 1
.end_amdhsa_kernel
```

```asm
; @launch grid=(256,1,1) block=(256,1,1) lds=163840
.amdgcn_target "amdgcn-amd-amdhsa--gfx950"
.text
.p2align 8
.globl recurrent_scan__sliding_local_dilated__glu_gated_geglu__prompt_kernel
.type recurrent_scan__sliding_local_dilated__glu_gated_geglu__prompt_kernel,@function
recurrent_scan__sliding_local_dilated__glu_gated_geglu__prompt_kernel:
    s_cmp_ge_u32 s2, 256
    s_cbranch_scc1 L_end
    s_load_dwordx16 s[8:23], s[0:1], 0
    s_load_dwordx4 s[24:27], s[0:1], 64
    v_lshrrev_b32 v1, 6, v0
    v_and_b32 v0, 63, v0
    v_readfirstlane_b32 s60, v1
    s_getpc_b64 s[86:87]
L_pc:
    s_lshr_b32 s82, s2, 3
    s_lshl_b32 s82, s82, 2
    s_add_u32 s82, s82, s60
    s_lshl_b32 s82, s82, 10
    v_lshl_add_u32 v2, v0, 4, s82
    v_min_u32 v2, L_code_end-L_pc-4, v2
    global_load_dword v7, v2, s[86:87]
    s_and_b32 s82, s2, 7
    s_lshr_b32 s83, s2, 3
    s_lshr_b32 s65, s82, 1
    s_and_b32 s63, s82, 1
    s_lshl_b32 s63, s63, 2
    s_and_b32 s84, s83, 3
    s_add_u32 s63, s63, s84
    s_lshr_b32 s66, s83, 2
    s_lshl_b32 s64, s65, 3
    s_add_u32 s64, s64, s66
    s_lshr_b32 s61, s60, 1
    s_and_b32 s62, s60, 1
    v_lshlrev_b32 v16, 4, v0
    s_lshl_b32 s84, s64, 2
    s_add_u32 s84, s84, s60
    s_lshl_b32 s85, s63, 7
    s_add_u32 s84, s84, s85
    s_lshl_b32 s85, s84, 12
    v_add_u32 v36, s85, v16
    s_lshl_b32 s84, s84, 2
    s_add_u32 s84, s84, 39845888
    v_mov_b32 v37, s84
    s_waitcnt lgkmcnt(0)
    global_load_dwordx4 v[48:51], v36, s[8:9] offset:0 nt
    global_load_dwordx4 v[52:55], v36, s[8:9] offset:1024 nt
    global_load_dwordx4 v[56:59], v36, s[8:9] offset:2048 nt
    global_load_dwordx4 v[60:63], v36, s[8:9] offset:3072 nt
    s_lshl_b32 s84, s63, 9
    s_lshl_b32 s85, s61, 8
    s_add_u32 s85, s85, s84
    s_sub_u32 s84, s84, 32
    s_max_i32 s84, s84, 0
    s_cmp_eq_u32 s62, 0
    s_cselect_b32 s85, s85, s84
    s_cselect_b32 s84, 63, 7
    s_add_u32 s85, s85, 39845888
    v_and_b32 v38, s84, v0
    v_lshlrev_b32 v38, 2, v38
    v_add_u32 v38, s85, v38
    global_load_dword v39, v38, s[26:27] sc1
    global_load_dword v40, v37, s[26:27] sc1
    v_lshlrev_b32 v2, 6, v0
    v_sub_u32 v2, v2, v16
    v_add_u32 v2, v2, v36
    s_sub_u32 s84, s63, s62
    s_max_i32 s84, s84, 0
    s_lshl_b32 s84, s84, 5
    v_mov_b32 v41, s84
    s_mov_b32 s56, s26
    s_and_b32 s57, s27, 0xffff
    s_mov_b32 s58, 0x10000000
    s_mov_b32 s59, 0x20000
    s_lshl_b32 s84, s63, 2
    s_add_u32 s84, s84, s65
    s_lshl_b32 s92, s84, 8
    s_add_u32 s92, s92, 39849984
    s_mul_i32 s88, s84, 458752
    s_add_u32 s88, s88, 8388608
    s_lshl_b32 s93, s63, 8
    s_add_u32 s93, s93, 39858176
    s_cmp_lg_u32 s60, 3
    s_cbranch_scc1 L_nozero
    s_lshl_b32 s84, s63, 3
    s_add_u32 s84, s84, s66
    s_lshl_b32 s84, s84, 2
    s_add_u32 s84, s84, s65
    s_lshl_b32 s84, s84, 8
    s_add_u32 s84, s84, 39862272
    v_mov_b32 v2, s84
    v_writelane_b32 v2, s92, 1
    v_writelane_b32 v2, s93, 2
    s_cmp_eq_u32 s66, 0
    s_cselect_b32 s84, 3, 1
    s_cmp_eq_u32 s64, 0
    s_cselect_b32 s84, 7, s84
    v_mov_b32 v3, 0
    s_mov_b32 exec_hi, 0
    s_mov_b32 exec_lo, s84
    global_store_dword v2, v3, s[26:27] sc1
    s_mov_b64 exec, -1
L_nozero:
    v_lshrrev_b32 v20, 2, v0
    v_and_b32 v21, 3, v0
    v_lshrrev_b32 v22, 4, v0
    v_and_b32 v23, 15, v0
    v_lshrrev_b32 v24, 3, v20
    v_lshlrev_b32 v24, 1, v24
    v_xor_b32 v24, v21, v24
    v_mul_u32_u24 v2, 6144, v20
    v_lshl_add_u32 v2, v24, 4, v2
    v_mul_u32_u24 v25, 7168, v20
    v_lshl_add_u32 v3, v24, 4, v25
    s_mul_i32 s84, s61, 98304
    s_lshl_b32 s85, s64, 6
    s_add_u32 s84, s84, s85
    s_add_u32 s32, s10, s84
    s_addc_u32 s33, s11, 0
    s_sub_u32 s32, s32, 4096
    s_subb_u32 s33, s33, 0
    s_and_b32 s33, s33, 0xffff
    s_sub_u32 s34, 6295552, s84
    s_mov_b32 s35, 0x20000
    s_mul_i32 s84, s61, 114688
    s_mul_i32 s85, s64, 224
    s_add_u32 s84, s84, s85
    s_add_u32 s36, s16, s84
    s_addc_u32 s37, s17, 0
    s_sub_u32 s36, s36, 4096
    s_subb_u32 s37, s37, 0
    s_and_b32 s37, s37, 0xffff
    s_sub_u32 s38, 7344128, s84
    s_mov_b32 s39, 0x20000
    s_add_u32 s40, s18, s84
    s_addc_u32 s41, s19, 0
    s_sub_u32 s40, s40, 4096
    s_subb_u32 s41, s41, 0
    s_and_b32 s41, s41, 0xffff
    s_sub_u32 s42, 7344128, s84
    s_mov_b32 s43, 0x20000
    v_cmp_lt_u32 vcc, 1, v24
    v_and_b32 v24, 1, v24
    v_lshl_add_u32 v24, v24, 4, v25
    v_add_u32 v24, 3264, v24
    v_mov_b32 v25, 0
    s_add_u32 s82, s16, s84
    s_addc_u32 s83, s17, 0
    s_sub_u32 s82, s82, 4096
    s_subb_u32 s83, s83, 0
    v_lshl_add_u64 v[4:5], v[24:25], 0, s[82:83]
    s_add_u32 s82, s18, s84
    s_addc_u32 s83, s19, 0
    s_sub_u32 s82, s82, 4096
    s_subb_u32 s83, s83, 0
    v_lshl_add_u64 v[24:25], v[24:25], 0, s[82:83]
    v_cndmask_b32 v4, v4, v24, vcc
    v_cndmask_b32 v5, v5, v25, vcc
    s_mov_b32 s80, 229376
    s_mov_b32 s81, 0
    s_cmp_eq_u32 s62, 1
    s_cbranch_scc1 L_init1
    s_lshl_b32 s78, s61, 14
    s_mov_b32 s68, 4096
    s_mov_b32 s69, 19456
    s_mov_b32 s70, 34816
    s_mov_b32 s71, 50176
    s_mov_b32 s72, 69632
    s_mov_b32 s73, 84992
    s_mov_b32 s74, 100352
    s_mov_b32 s75, 115712
    s_lshl_b32 s84, s63, 1
    s_add_u32 s84, s84, s61
    s_lshl_b32 s84, s84, 18
    s_branch L_init2
L_init1:
    s_mul_i32 s78, s61, 10240
    s_add_u32 s78, s78, 69632
    s_mov_b32 s68, 6144
    s_mov_b32 s69, 7168
    s_mov_b32 s70, 2048
    s_mov_b32 s71, 1024
    s_mov_b32 s72, 4096
    s_mov_b32 s73, 3136
    s_mov_b32 s74, 2112
    s_mov_b32 s75, 1152
    s_mov_b32 s76, 4224
    s_mov_b32 s14, 151552
    s_cmp_eq_u32 s61, 0
    s_cselect_b32 s15, 67584, s14
    s_cselect_b32 s14, 32768, s14
    s_lshl_b32 s84, s63, 19
    s_sub_u32 s84, s84, 32768
    s_max_i32 s84, s84, 0
L_init2:
    s_add_u32 s28, s26, s84
    s_addc_u32 s29, s27, 0
    s_sub_u32 s28, s28, 4096
    s_subb_u32 s29, s29, 0
    s_and_b32 s29, s29, 0xffff
    s_sub_u32 s30, 4198400, s84
    s_mov_b32 s31, 0x20000
    v_lshrrev_b32 v24, 3, v0
    v_and_b32 v25, 6, v24
    v_and_b32 v1, 7, v0
    v_xor_b32 v25, v25, v1
    v_lshlrev_b32 v25, 4, v25
    v_lshl_add_u32 v1, v24, 11, v25
    s_cmp_eq_u32 s63, 0
    s_cselect_b32 s84, 1, 3
    s_and_b32 s85, s60, s84
    s_cmp_eq_u32 s85, s84
    s_cselect_b32 s85, 0x40000000, 0
    s_cselect_b32 s87, 1, 0
    v_add_u32 v1, s85, v1
    s_lshr_b32 s83, s2, 3
    v_lshrrev_b32 v24, 3, v0
    v_and_b32 v25, 7, v0
    s_lshr_b32 s84, s63, 2
    s_lshl_b32 s84, s84, 4
    s_lshr_b32 s85, s83, 1
    s_add_u32 s84, s84, s85
    s_and_b32 s83, s83, 1
    s_cmp_eq_u32 s60, 0
    s_cbranch_scc1 L_pf0
    s_cmp_eq_u32 s60, 1
    s_cselect_b32 s44, s16, s18
    s_cselect_b32 s45, s17, s19
    s_cmp_eq_u32 s60, 3
    s_cselect_b32 s46, 0, 7340032
    s_mov_b32 s79, 229376
    s_mul_i32 s84, s84, 7168
    s_lshl_b32 s85, s65, 1
    s_add_u32 s85, s85, s83
    s_mul_i32 s85, s85, 896
    s_add_u32 s84, s84, s85
    v_cmp_gt_u32 vcc, 7, v25
    v_lshlrev_b32 v25, 7, v25
    s_branch L_pfd
L_pf0:
    s_mov_b32 s44, s10
    s_mov_b32 s45, s11
    s_mov_b32 s46, 6291456
    s_mov_b32 s79, 196608
    s_mul_i32 s84, s84, 6144
    s_lshl_b32 s85, s65, 1
    s_add_u32 s85, s85, s83
    s_lshl_b32 s85, s85, 8
    s_add_u32 s84, s84, s85
    v_cmp_gt_u32 vcc, 6, v25
    v_and_b32 v6, 1, v25
    v_lshrrev_b32 v25, 1, v25
    v_lshlrev_b32 v25, 11, v25
    v_lshl_add_u32 v25, v6, 7, v25
L_pfd:
    v_add_u32 v25, s84, v25
    v_mov_b32 v6, 0x40000000
    v_cndmask_b32 v25, v6, v25, vcc
    v_mul_lo_u32 v42, v24, s79
    v_add_u32 v42, v42, v25
    s_lshr_b32 s84, s79, 1
    s_sub_u32 s85, 0, s84
    s_cmp_lt_u32 s63, 4
    s_cselect_b32 s84, s84, s85
    s_mul_i32 s85, s79, 6
    s_sub_u32 s84, s84, s85
    v_add_u32 v25, s84, v42
    v_cmp_gt_u32 vcc, 4, v24
    s_nop 1
    v_cndmask_b32 v6, v6, v25, vcc
    v_cmp_gt_u32 vcc, 2, v24
    s_nop 1
    v_cndmask_b32 v6, v6, v42, vcc
    s_mul_i32 s84, s79, 8
    v_add_u32 v6, s84, v6
    s_lshl_b32 s86, s79, 3
    s_mul_i32 s79, s79, 2
    s_lshr_b32 s84, s2, 3
    s_and_b32 s84, s84, 0
    s_cmp_eq_u32 s84, 0
    s_cselect_b32 s4, 0, 0x40000000
    s_lshl_b32 s84, s63, 4
    s_add_u32 s84, s84, s65
    s_lshl_b32 s84, s84, 15
    s_lshl_b32 s85, s66, 8
    s_add_u32 s84, s84, s85
    s_add_u32 s48, s8, s84
    s_addc_u32 s49, s9, 0
    s_mov_b32 s50, 424192
    s_mov_b32 s52, 131072
    v_lshrrev_b32 v33, 1, v0
    v_and_b32 v24, 1, v0
    v_lshlrev_b32 v24, 7, v24
    v_lshl_add_u32 v33, v33, 11, v24
    v_subrev_u32 v33, 524288, v33
    v_mov_b32 v24, 0x40000000
    v_cmp_gt_u32 vcc, 32, v0
    s_nop 1
    v_cndmask_b32 v33, v24, v33, vcc
    s_cmp_lg_u32 s60, 3
    s_cbranch_scc1 L_pf3d
    s_lshl_b32 s84, s2, 13
    s_add_u32 s48, s12, s84
    s_addc_u32 s49, s13, 0
    s_mov_b32 s50, 8192
    s_mov_b32 s52, 2048
    v_lshlrev_b32 v25, 7, v0
    v_subrev_u32 v33, 16384, v25
    v_cmp_gt_u32 vcc, 16, v0
    s_nop 1
    v_cndmask_b32 v33, v24, v33, vcc
    s_and_b32 s84, s2, 7
    s_lshl_b32 s84, s84, 5
    s_lshr_b32 s85, s2, 3
    s_add_u32 s84, s84, s85
    s_mul_i32 s84, s84, 28672
    s_add_u32 s44, s20, s84
    s_addc_u32 s45, s21, 0
    s_mov_b32 s46, 28672
    s_mov_b32 s79, 7168
    v_subrev_u32 v6, 71680, v25
    v_mov_b32 v42, 0x40000000
    v_cmp_gt_u32 vcc, 56, v0
    s_nop 1
    v_cndmask_b32 v6, v42, v6, vcc
L_pf3d:
    s_and_b32 s49, s49, 0xffff
    s_mov_b32 s51, 0x20000
    s_and_b32 s45, s45, 0xffff
    s_mov_b32 s47, 0x20000
    v_and_b32 v24, 6, v23
    v_xor_b32 v24, v24, v22
    v_lshlrev_b32 v24, 4, v24
    v_lshl_add_u32 v24, v23, 7, v24
    v_xor_b32 v25, 64, v24
    s_lshl_b32 s84, s61, 14
    v_add_u32 v8, s84, v24
    v_add_u32 v9, s84, v25
    s_mul_i32 s84, s61, 0
    s_add_u32 s84, s84, 32768
    v_add_u32 v10, s84, v24
    v_add_u32 v11, s84, v25
    v_lshrrev_b32 v24, 5, v0
    v_mul_u32_u24 v24, 10240, v24
    v_and_b32 v26, 1, v22
    v_bfe_u32 v25, v0, 2, 2
    v_lshl_add_u32 v25, v26, 3, v25
    v_lshl_add_u32 v24, v25, 6, v24
    v_and_b32 v25, 1, v0
    v_lshl_add_u32 v24, v25, 3, v24
    v_bfe_u32 v27, v0, 1, 1
    v_lshlrev_b32 v26, 1, v26
    s_mul_i32 s84, s62, 5120
    s_add_u32 s84, s84, 69632
    v_add_u32 v24, s84, v24
    v_add_u32 v25, 0, v27
    v_xor_b32 v25, v25, v26
    v_lshl_add_u32 v12, v25, 4, v24
    v_add_u32 v13, 40960, v12
    v_add_u32 v25, 2, v27
    v_xor_b32 v25, v25, v26
    v_lshl_add_u32 v14, v25, 4, v24
    v_add_u32 v15, 40960, v14
    s_cmp_eq_u32 s61, 1
    s_cselect_b64 vcc, -1, 0
    v_cndmask_b32 v44, v12, v14, vcc
    s_lshl_b32 s84, s62, 12
    v_subrev_u32 v44, s84, v44
    v_add_u32 v45, 40960, v44
    v_mov_b32 v28, 0
    v_mov_b32 v29, 0
    v_mov_b32 v30, 0
    v_mov_b32 v31, 0
    s_cmp_eq_u32 s62, 1
    s_cbranch_scc1 L_early1
    s_mov_b32 exec_lo, 0xffffffff
    s_mov_b32 exec_hi, 0x0
    buffer_load_dword v7, v42, s[44:47], 0 offen
    s_mov_b64 exec, -1
    v_mfma_f32_32x32x16_bf16 a[128:143], v[28:31], v[28:31], 0
    v_mfma_f32_32x32x16_bf16 a[144:159], v[28:31], v[28:31], 0
    v_mfma_f32_32x32x16_bf16 a[160:175], v[28:31], v[28:31], 0
    v_mfma_f32_32x32x16_bf16 a[176:191], v[28:31], v[28:31], 0
    v_mfma_f32_32x32x16_bf16 a[192:207], v[28:31], v[28:31], 0
    v_mfma_f32_32x32x16_bf16 a[208:223], v[28:31], v[28:31], 0
    v_mfma_f32_32x32x16_bf16 a[224:239], v[28:31], v[28:31], 0
    v_mfma_f32_32x32x16_bf16 a[240:255], v[28:31], v[28:31], 0
    v_mfma_f32_32x32x16_bf16 v[128:143], v[28:31], v[28:31], 0
    v_mfma_f32_32x32x16_bf16 v[144:159], v[28:31], v[28:31], 0
    v_mfma_f32_32x32x16_bf16 v[160:175], v[28:31], v[28:31], 0
    v_mfma_f32_32x32x16_bf16 v[176:191], v[28:31], v[28:31], 0
    v_mfma_f32_32x32x16_bf16 v[192:207], v[28:31], v[28:31], 0
    v_mfma_f32_32x32x16_bf16 v[208:223], v[28:31], v[28:31], 0
    v_mfma_f32_32x32x16_bf16 v[224:239], v[28:31], v[28:31], 0
    v_mfma_f32_32x32x16_bf16 v[240:255], v[28:31], v[28:31], 0
    s_waitcnt vmcnt(3)
    s_branch L_ln
L_early1:
    s_mov_b32 exec_lo, 0xffffffff
    s_mov_b32 exec_hi, 0x0
    buffer_load_dword v7, v42, s[44:47], 0 offen
    s_mov_b64 exec, -1
    v_mfma_f32_32x32x16_bf16 a[128:143], v[28:31], v[28:31], 0
    v_mfma_f32_32x32x16_bf16 a[144:159], v[28:31], v[28:31], 0
    v_mfma_f32_32x32x16_bf16 a[160:175], v[28:31], v[28:31], 0
    v_mfma_f32_32x32x16_bf16 a[176:191], v[28:31], v[28:31], 0
    v_mfma_f32_32x32x16_bf16 a[192:207], v[28:31], v[28:31], 0
    v_mfma_f32_32x32x16_bf16 a[208:223], v[28:31], v[28:31], 0
    v_mfma_f32_32x32x16_bf16 a[224:239], v[28:31], v[28:31], 0
    v_mfma_f32_32x32x16_bf16 a[240:255], v[28:31], v[28:31], 0
    v_mfma_f32_32x32x16_bf16 v[128:143], v[28:31], v[28:31], 0
    v_mfma_f32_32x32x16_bf16 v[144:159], v[28:31], v[28:31], 0
    v_mfma_f32_32x32x16_bf16 v[160:175], v[28:31], v[28:31], 0
    v_mfma_f32_32x32x16_bf16 v[176:191], v[28:31], v[28:31], 0
    v_mfma_f32_32x32x16_bf16 v[192:207], v[28:31], v[28:31], 0
    v_mfma_f32_32x32x16_bf16 v[208:223], v[28:31], v[28:31], 0
    v_mfma_f32_32x32x16_bf16 v[224:239], v[28:31], v[28:31], 0
    v_mfma_f32_32x32x16_bf16 v[240:255], v[28:31], v[28:31], 0
    s_waitcnt vmcnt(3)
L_ln:
    v_lshlrev_b32 v64, 16, v48
    v_and_b32 v65, 0xffff0000, v48
    v_lshlrev_b32 v66, 16, v49
    v_and_b32 v67, 0xffff0000, v49
    v_lshlrev_b32 v68, 16, v50
    v_and_b32 v69, 0xffff0000, v50
    v_lshlrev_b32 v70, 16, v51
    v_and_b32 v71, 0xffff0000, v51
    v_lshlrev_b32 v72, 16, v52
    v_and_b32 v73, 0xffff0000, v52
    v_lshlrev_b32 v74, 16, v53
    v_and_b32 v75, 0xffff0000, v53
    v_lshlrev_b32 v76, 16, v54
    v_and_b32 v77, 0xffff0000, v54
    v_lshlrev_b32 v78, 16, v55
    v_and_b32 v79, 0xffff0000, v55
    v_lshlrev_b32 v80, 16, v56
    v_and_b32 v81, 0xffff0000, v56
    v_lshlrev_b32 v82, 16, v57
    v_and_b32 v83, 0xffff0000, v57
    v_lshlrev_b32 v84, 16, v58
    v_and_b32 v85, 0xffff0000, v58
    v_lshlrev_b32 v86, 16, v59
    v_and_b32 v87, 0xffff0000, v59
    v_lshlrev_b32 v88, 16, v60
    v_and_b32 v89, 0xffff0000, v60
    v_lshlrev_b32 v90, 16, v61
    v_and_b32 v91, 0xffff0000, v61
    v_lshlrev_b32 v92, 16, v62
    v_and_b32 v93, 0xffff0000, v62
    v_lshlrev_b32 v94, 16, v63
    v_and_b32 v95, 0xffff0000, v63
    v_pk_add_f32 v[96:97], v[64:65], v[66:67]
    v_pk_add_f32 v[98:99], v[80:81], v[82:83]
    v_pk_add_f32 v[96:97], v[96:97], v[68:69]
    v_pk_add_f32 v[98:99], v[98:99], v[84:85]
    v_pk_add_f32 v[96:97], v[96:97], v[70:71]
    v_pk_add_f32 v[98:99], v[98:99], v[86:87]
    v_pk_add_f32 v[96:97], v[96:97], v[72:73]
    v_pk_add_f32 v[98:99], v[98:99], v[88:89]
    v_pk_add_f32 v[96:97], v[96:97], v[74:75]
    v_pk_add_f32 v[98:99], v[98:99], v[90:91]
    v_pk_add_f32 v[96:97], v[96:97], v[76:77]
    v_pk_add_f32 v[98:99], v[98:99], v[92:93]
    v_pk_add_f32 v[96:97], v[96:97], v[78:79]
    v_pk_add_f32 v[98:99], v[98:99], v[94:95]
    v_add_f32 v102, v96, v97
    v_add_f32 v103, v98, v99
    s_nop 1
    v_permlane32_swap_b32 v102, v103
    v_add_f32 v102, v102, v103
    v_mov_b32 v100, v102
    s_nop 1
    v_permlane16_swap_b32 v102, v100
    v_add_f32 v102, v102, v100
    s_nop 1
    v_add_f32_dpp v102, v102, v102 quad_perm:[1,0,3,2] row_mask:0xf bank_mask:0xf
    s_nop 1
    v_add_f32_dpp v102, v102, v102 quad_perm:[2,3,0,1] row_mask:0xf bank_mask:0xf
    s_nop 1
    v_add_f32_dpp v102, v102, v102 row_half_mirror row_mask:0xf bank_mask:0xf
    s_nop 1
    v_add_f32_dpp v102, v102, v102 row_mirror row_mask:0xf bank_mask:0xf
    v_mul_f32 v102, 0xba800000, v102
    v_cvt_pk_bf16_f32 v106, v102, v102
    v_lshlrev_b32 v106, 16, v106
    v_mov_b32 v103, v102
    s_nop 1
    v_permlane32_swap_b32 v102, v103
    v_mov_b32 v107, v106
    s_nop 1
    v_permlane32_swap_b32 v106, v107
    v_pk_add_f32 v[108:109], v[64:65], v[102:103] op_sel_hi:[1,0]
    v_pk_add_f32 v[110:111], v[80:81], v[102:103] op_sel:[0,1] op_sel_hi:[1,1]
    v_pk_mul_f32 v[96:97], v[108:109], v[108:109]
    v_pk_mul_f32 v[98:99], v[110:111], v[110:111]
    v_pk_add_f32 v[108:109], v[66:67], v[102:103] op_sel_hi:[1,0]
    v_pk_add_f32 v[110:111], v[82:83], v[102:103] op_sel:[0,1] op_sel_hi:[1,1]
    v_pk_fma_f32 v[96:97], v[108:109], v[108:109], v[96:97]
    v_pk_fma_f32 v[98:99], v[110:111], v[110:111], v[98:99]
    v_pk_add_f32 v[108:109], v[68:69], v[102:103] op_sel_hi:[1,0]
    v_pk_add_f32 v[110:111], v[84:85], v[102:103] op_sel:[0,1] op_sel_hi:[1,1]
    v_pk_fma_f32 v[96:97], v[108:109], v[108:109], v[96:97]
    v_pk_fma_f32 v[98:99], v[110:111], v[110:111], v[98:99]
    v_pk_add_f32 v[108:109], v[70:71], v[102:103] op_sel_hi:[1,0]
    v_pk_add_f32 v[110:111], v[86:87], v[102:103] op_sel:[0,1] op_sel_hi:[1,1]
    v_pk_fma_f32 v[96:97], v[108:109], v[108:109], v[96:97]
    v_pk_fma_f32 v[98:99], v[110:111], v[110:111], v[98:99]
    v_pk_add_f32 v[108:109], v[72:73], v[102:103] op_sel_hi:[1,0]
    v_pk_add_f32 v[110:111], v[88:89], v[102:103] op_sel:[0,1] op_sel_hi:[1,1]
    v_pk_fma_f32 v[96:97], v[108:109], v[108:109], v[96:97]
    v_pk_fma_f32 v[98:99], v[110:111], v[110:111], v[98:99]
    v_pk_add_f32 v[108:109], v[74:75], v[102:103] op_sel_hi:[1,0]
    v_pk_add_f32 v[110:111], v[90:91], v[102:103] op_sel:[0,1] op_sel_hi:[1,1]
    v_pk_fma_f32 v[96:97], v[108:109], v[108:109], v[96:97]
    v_pk_fma_f32 v[98:99], v[110:111], v[110:111], v[98:99]
    v_pk_add_f32 v[108:109], v[76:77], v[102:103] op_sel_hi:[1,0]
    v_pk_add_f32 v[110:111], v[92:93], v[102:103] op_sel:[0,1] op_sel_hi:[1,1]
    v_pk_fma_f32 v[96:97], v[108:109], v[108:109], v[96:97]
    v_pk_fma_f32 v[98:99], v[110:111], v[110:111], v[98:99]
    v_pk_add_f32 v[108:109], v[78:79], v[102:103] op_sel_hi:[1,0]
    v_pk_add_f32 v[110:111], v[94:95], v[102:103] op_sel:[0,1] op_sel_hi:[1,1]
    v_pk_fma_f32 v[96:97], v[108:109], v[108:109], v[96:97]
    v_pk_fma_f32 v[98:99], v[110:111], v[110:111], v[98:99]
    v_add_f32 v104, v96, v97
    v_pk_add_f32 v[64:65], v[64:65], v[106:107] op_sel_hi:[1,0]
    v_pk_add_f32 v[66:67], v[66:67], v[106:107] op_sel_hi:[1,0]
    v_add_f32 v105, v98, v99
    v_pk_add_f32 v[68:69], v[68:69], v[106:107] op_sel_hi:[1,0]
    v_pk_add_f32 v[70:71], v[70:71], v[106:107] op_sel_hi:[1,0]
    v_cvt_pk_bf16_f32 v65, v64, v65
    v_permlane32_swap_b32 v104, v105
    v_cvt_pk_bf16_f32 v67, v66, v67
    v_cvt_pk_bf16_f32 v69, v68, v69
    v_add_f32 v104, v104, v105
    v_cvt_pk_bf16_f32 v71, v70, v71
    v_lshlrev_b32 v64, 16, v65
    v_and_b32 v65, 0xffff0000, v65
    v_mov_b32 v100, v104
    v_lshlrev_b32 v66, 16, v67
    v_and_b32 v67, 0xffff0000, v67
    v_permlane16_swap_b32 v104, v100
    v_lshlrev_b32 v68, 16, v69
    v_and_b32 v69, 0xffff0000, v69
    v_lshlrev_b32 v70, 16, v71
    v_add_f32 v104, v104, v100
    v_and_b32 v71, 0xffff0000, v71
    v_pk_add_f32 v[72:73], v[72:73], v[106:107] op_sel_hi:[1,0]
    v_add_f32_dpp v104, v104, v104 quad_perm:[1,0,3,2] row_mask:0xf bank_mask:0xf
    v_pk_add_f32 v[74:75], v[74:75], v[106:107] op_sel_hi:[1,0]
    v_pk_add_f32 v[76:77], v[76:77], v[106:107] op_sel_hi:[1,0]
    v_pk_add_f32 v[78:79], v[78:79], v[106:107] op_sel_hi:[1,0]
    v_add_f32_dpp v104, v104, v104 quad_perm:[2,3,0,1] row_mask:0xf bank_mask:0xf
    v_cvt_pk_bf16_f32 v73, v72, v73
    v_cvt_pk_bf16_f32 v75, v74, v75
    v_cvt_pk_bf16_f32 v77, v76, v77
    v_add_f32_dpp v104, v104, v104 row_half_mirror row_mask:0xf bank_mask:0xf
    v_cvt_pk_bf16_f32 v79, v78, v79
    v_lshlrev_b32 v72, 16, v73
    v_add_f32_dpp v104, v104, v104 row_mirror row_mask:0xf bank_mask:0xf
    v_and_b32 v73, 0xffff0000, v73
    v_lshlrev_b32 v74, 16, v75
    v_and_b32 v75, 0xffff0000, v75
    v_mul_f32 v104, 0x3a800000, v104
    v_lshlrev_b32 v76, 16, v77
    v_and_b32 v77, 0xffff0000, v77
    v_cvt_pk_bf16_f32 v104, v104, v104
    v_lshlrev_b32 v78, 16, v79
    v_and_b32 v79, 0xffff0000, v79
    v_pk_add_f32 v[80:81], v[80:81], v[106:107] op_sel:[0,1] op_sel_hi:[1,1]
    v_lshlrev_b32 v104, 16, v104
    v_pk_add_f32 v[82:83], v[82:83], v[106:107] op_sel:[0,1] op_sel_hi:[1,1]
    v_pk_add_f32 v[84:85], v[84:85], v[106:107] op_sel:[0,1] op_sel_hi:[1,1]
    v_add_f32 v104, 0x3727c5ac, v104
    v_pk_add_f32 v[86:87], v[86:87], v[106:107] op_sel:[0,1] op_sel_hi:[1,1]
    v_cvt_pk_bf16_f32 v81, v80, v81
    v_cvt_pk_bf16_f32 v83, v82, v83
    v_cvt_pk_bf16_f32 v104, v104, v104
    v_cvt_pk_bf16_f32 v85, v84, v85
    v_cvt_pk_bf16_f32 v87, v86, v87
    v_lshlrev_b32 v104, 16, v104
    v_lshlrev_b32 v80, 16, v81
    v_and_b32 v81, 0xffff0000, v81
    v_lshlrev_b32 v82, 16, v83
    v_sqrt_f32 v104, v104
    v_and_b32 v83, 0xffff0000, v83
    v_lshlrev_b32 v84, 16, v85
    v_and_b32 v85, 0xffff0000, v85
    v_cvt_pk_bf16_f32 v104, v104, v104
    v_lshlrev_b32 v86, 16, v87
    v_and_b32 v87, 0xffff0000, v87
    v_lshlrev_b32 v104, 16, v104
    v_pk_add_f32 v[88:89], v[88:89], v[106:107] op_sel:[0,1] op_sel_hi:[1,1]
    v_pk_add_f32 v[90:91], v[90:91], v[106:107] op_sel:[0,1] op_sel_hi:[1,1]
    v_pk_add_f32 v[92:93], v[92:93], v[106:107] op_sel:[0,1] op_sel_hi:[1,1]
    v_rcp_f32 v100, v104
    v_pk_add_f32 v[94:95], v[94:95], v[106:107] op_sel:[0,1] op_sel_hi:[1,1]
    v_cvt_pk_bf16_f32 v89, v88, v89
    v_fma_f32 v104, -v104, v100, 1.0
    v_cvt_pk_bf16_f32 v91, v90, v91
    v_cvt_pk_bf16_f32 v93, v92, v93
    v_cvt_pk_bf16_f32 v95, v94, v95
    v_fma_f32 v104, v104, v100, v100
    v_lshlrev_b32 v88, 16, v89
    v_and_b32 v89, 0xffff0000, v89
    v_mov_b32 v105, v104
    v_lshlrev_b32 v90, 16, v91
    v_and_b32 v91, 0xffff0000, v91
    v_lshlrev_b32 v92, 16, v93
    v_permlane32_swap_b32 v104, v105
    v_and_b32 v93, 0xffff0000, v93
    v_lshlrev_b32 v94, 16, v95
    v_and_b32 v95, 0xffff0000, v95
    v_pk_mul_f32 v[64:65], v[64:65], v[104:105] op_sel_hi:[1,0]
    v_pk_mul_f32 v[66:67], v[66:67], v[104:105] op_sel_hi:[1,0]
    v_pk_mul_f32 v[68:69], v[68:69], v[104:105] op_sel_hi:[1,0]
    v_pk_mul_f32 v[70:71], v[70:71], v[104:105] op_sel_hi:[1,0]
    v_cvt_pk_bf16_f32 v48, v64, v65
    v_cvt_pk_bf16_f32 v49, v66, v67
    v_cvt_pk_bf16_f32 v50, v68, v69
    v_cvt_pk_bf16_f32 v51, v70, v71
    global_store_dwordx4 v36, v[48:51], s[26:27] offset:0 sc1
    v_pk_mul_f32 v[72:73], v[72:73], v[104:105] op_sel_hi:[1,0]
    v_pk_mul_f32 v[74:75], v[74:75], v[104:105] op_sel_hi:[1,0]
    v_pk_mul_f32 v[76:77], v[76:77], v[104:105] op_sel_hi:[1,0]
    v_pk_mul_f32 v[78:79], v[78:79], v[104:105] op_sel_hi:[1,0]
    v_cvt_pk_bf16_f32 v52, v72, v73
    v_cvt_pk_bf16_f32 v53, v74, v75
    v_cvt_pk_bf16_f32 v54, v76, v77
    v_cvt_pk_bf16_f32 v55, v78, v79
    global_store_dwordx4 v36, v[52:55], s[26:27] offset:1024 sc1
    v_pk_mul_f32 v[80:81], v[80:81], v[104:105] op_sel:[0,1] op_sel_hi:[1,1]
    v_pk_mul_f32 v[82:83], v[82:83], v[104:105] op_sel:[0,1] op_sel_hi:[1,1]
    v_pk_mul_f32 v[84:85], v[84:85], v[104:105] op_sel:[0,1] op_sel_hi:[1,1]
    v_pk_mul_f32 v[86:87], v[86:87], v[104:105] op_sel:[0,1] op_sel_hi:[1,1]
    v_cvt_pk_bf16_f32 v56, v80, v81
    v_cvt_pk_bf16_f32 v57, v82, v83
    v_cvt_pk_bf16_f32 v58, v84, v85
    v_cvt_pk_bf16_f32 v59, v86, v87
    global_store_dwordx4 v36, v[56:59], s[26:27] offset:2048 sc1
    v_pk_mul_f32 v[88:89], v[88:89], v[104:105] op_sel:[0,1] op_sel_hi:[1,1]
    v_pk_mul_f32 v[90:91], v[90:91], v[104:105] op_sel:[0,1] op_sel_hi:[1,1]
    v_pk_mul_f32 v[92:93], v[92:93], v[104:105] op_sel:[0,1] op_sel_hi:[1,1]
    v_pk_mul_f32 v[94:95], v[94:95], v[104:105] op_sel:[0,1] op_sel_hi:[1,1]
    v_cvt_pk_bf16_f32 v60, v88, v89
    v_cvt_pk_bf16_f32 v61, v90, v91
    v_cvt_pk_bf16_f32 v62, v92, v93
    v_cvt_pk_bf16_f32 v63, v94, v95
    global_store_dwordx4 v36, v[60:63], s[26:27] offset:3072 sc1
    s_waitcnt vmcnt(5)
    v_add_u32 v40, 1, v40
    s_waitcnt vmcnt(0)
    s_mov_b64 exec, 1
    global_store_dword v37, v40, s[26:27] sc1
    s_mov_b64 exec, -1
    buffer_load_dword v7, v42, s[44:47], 0 offen
    v_add_u32_e64 v42, s86, v42
    s_barrier
    v_mfma_f32_32x32x16_bf16 v[48:63], v[28:31], v[28:31], 0
    v_mfma_f32_32x32x16_bf16 v[64:79], v[28:31], v[28:31], 0
    v_mfma_f32_32x32x16_bf16 v[80:95], v[28:31], v[28:31], 0
    v_mfma_f32_32x32x16_bf16 v[96:111], v[28:31], v[28:31], 0
    v_mfma_f32_32x32x16_bf16 v[112:127], v[28:31], v[28:31], 0
    s_mov_b32 s67, 0
    s_cmp_lg_u32 s60, 3
    s_cbranch_scc1 L_noarr
    s_lshl_b32 s84, s63, 5
    v_mov_b32 v20, s84
    v_mov_b32 v21, 1
    s_mov_b64 exec, 1
    global_atomic_add v20, v21, s[24:25] sc1
    s_mov_b64 exec, -1
L_noarr:
    s_cmp_eq_u32 s62, 0
    s_cbranch_scc1 L_now
    s_add_u32 m0, s78, 0
    s_nop 0
    buffer_load_dwordx4 v2, s[32:35], s68 offen offset:0 lds
    buffer_load_dwordx4 v2, s[32:35], s69 offen offset:1024 lds
    buffer_load_dwordx4 v2, s[32:35], s70 offen offset:2048 lds
    v_add_u32 v2, 196608, v2
    buffer_load_dwordx4 v3, s[36:39], s71 offen offset:3072 lds
    s_add_u32 m0, s78, 4096
    s_nop 0
    buffer_load_dwordx4 v3, s[40:43], s72 offen offset:0 lds
    buffer_load_dwordx4 v3, s[36:39], s73 offen offset:1024 lds
    buffer_load_dwordx4 v3, s[40:43], s74 offen offset:2048 lds
    buffer_load_dwordx4 v3, s[36:39], s75 offen offset:3072 lds
    s_add_u32 m0, s78, 8192
    s_nop 0
    buffer_load_dwordx4 v3, s[40:43], s76 offen offset:0 lds
    v_add_u32 v3, 229376, v3
    global_load_lds_dwordx4 v[4:5], off offset:1024
    v_lshl_add_u64 v[4:5], v[4:5], 0, s[80:81]
    s_add_u32 m0, s78, 20480
    s_nop 0
    buffer_load_dwordx4 v2, s[32:35], s68 offen offset:0 lds
    buffer_load_dwordx4 v2, s[32:35], s69 offen offset:1024 lds
    buffer_load_dwordx4 v2, s[32:35], s70 offen offset:2048 lds
    v_add_u32 v2, 196608, v2
    buffer_load_dwordx4 v3, s[36:39], s71 offen offset:3072 lds
    s_add_u32 m0, s78, 24576
    s_nop 0
    buffer_load_dwordx4 v3, s[40:43], s72 offen offset:0 lds
    buffer_load_dwordx4 v3, s[36:39], s73 offen offset:1024 lds
    buffer_load_dwordx4 v3, s[40:43], s74 offen offset:2048 lds
    buffer_load_dwordx4 v3, s[36:39], s75 offen offset:3072 lds
    s_add_u32 m0, s78, 28672
    s_nop 0
    buffer_load_dwordx4 v3, s[40:43], s76 offen offset:0 lds
    v_add_u32 v3, 229376, v3
    global_load_lds_dwordx4 v[4:5], off offset:1024
    v_lshl_add_u64 v[4:5], v[4:5], 0, s[80:81]
L_now:
    s_cmp_eq_u32 s60, 2
    s_cbranch_scc1 L_stub0
    s_cmp_eq_u32 s60, 0
    s_cbranch_scc1 L_stub1
L_stubret:
    s_cmp_eq_u32 s87, 1
    s_cbranch_scc1 L_lnok
L_lnpoll:
    global_load_dword v20, v38, s[26:27] sc1
    s_waitcnt vmcnt(0)
    v_cmp_ne_u32 vcc, v20, v39
    s_cmp_eq_u64 vcc, -1
    s_cbranch_scc1 L_lnok
    s_add_u32 s67, s67, 1
    s_and_b32 s84, s67, 3
    s_cbranch_scc1 L_lnpoll
    global_load_dword v20, v41, s[24:25] sc1
    s_waitcnt vmcnt(0)
    v_readfirstlane_b32 s84, v20
    s_cmp_ge_u32 s84, 32
    s_cbranch_scc1 L_lnok
    s_cmp_lt_u32 s67, 0x40000
    s_cbranch_scc1 L_lnpoll
L_lnok:
    s_cmp_eq_u32 s62, 1
    s_cbranch_scc1 L_g1_1
    s_branch L_g1_0
.p2align 12
L_stub0:
    s_branch L_stub2
L_g1_0:
    v_add_u32 v2, 131072, v1
    s_add_u32 m0, s78, 0
    s_nop 0
    buffer_load_dwordx4 v1, s[28:31], s68 offen offset:0 sc1 lds
    buffer_load_dwordx4 v1, s[28:31], s69 offen offset:1024 sc1 lds
    buffer_load_dwordx4 v1, s[28:31], s70 offen offset:2048 sc1 lds
    buffer_load_dwordx4 v1, s[28:31], s71 offen offset:3072 sc1 lds
    s_add_u32 m0, s78, 4096
    s_nop 0
    buffer_load_dwordx4 v1, s[28:31], s72 offen offset:0 sc1 lds
    buffer_load_dwordx4 v1, s[28:31], s73 offen offset:1024 sc1 lds
    buffer_load_dwordx4 v1, s[28:31], s74 offen offset:2048 sc1 lds
    buffer_load_dwordx4 v1, s[28:31], s75 offen offset:3072 sc1 lds
    v_add_u32 v1, 128, v1
    s_add_u32 m0, s78, 8192
    s_nop 0
    buffer_load_dwordx4 v2, s[28:31], s68 offen offset:0 sc1 lds
    buffer_load_dwordx4 v2, s[28:31], s69 offen offset:1024 sc1 lds
    buffer_load_dwordx4 v2, s[28:31], s70 offen offset:2048 sc1 lds
    buffer_load_dwordx4 v2, s[28:31], s71 offen offset:3072 sc1 lds
    s_add_u32 m0, s78, 12288
    s_nop 0
    buffer_load_dwordx4 v2, s[28:31], s72 offen offset:0 sc1 lds
    buffer_load_dwordx4 v2, s[28:31], s73 offen offset:1024 sc1 lds
    buffer_load_dwordx4 v2, s[28:31], s74 offen offset:2048 sc1 lds
    buffer_load_dwordx4 v2, s[28:31], s75 offen offset:3072 sc1 lds
    v_add_u32 v2, 128, v2
    s_add_u32 m0, s78, 34816
    s_nop 0
    buffer_load_dwordx4 v1, s[28:31], s68 offen offset:0 sc1 lds
    buffer_load_dwordx4 v1, s[28:31], s69 offen offset:1024 sc1 lds
    buffer_load_dwordx4 v1, s[28:31], s70 offen offset:2048 sc1 lds
    buffer_load_dwordx4 v1, s[28:31], s71 offen offset:3072 sc1 lds
    s_add_u32 m0, s78, 38912
    s_nop 0
    buffer_load_dwordx4 v1, s[28:31], s72 offen offset:0 sc1 lds
    buffer_load_dwordx4 v1, s[28:31], s73 offen offset:1024 sc1 lds
    buffer_load_dwordx4 v1, s[28:31], s74 offen offset:2048 sc1 lds
    buffer_load_dwordx4 v1, s[28:31], s75 offen offset:3072 sc1 lds
    v_add_u32 v1, 128, v1
    s_add_u32 m0, s78, 43008
    s_nop 0
    buffer_load_dwordx4 v2, s[28:31], s68 offen offset:0 sc1 lds
    buffer_load_dwordx4 v2, s[28:31], s69 offen offset:1024 sc1 lds
    buffer_load_dwordx4 v2, s[28:31], s70 offen offset:2048 sc1 lds
    buffer_load_dwordx4 v2, s[28:31], s71 offen offset:3072 sc1 lds
    s_add_u32 m0, s78, 47104
    s_nop 0
    buffer_load_dwordx4 v2, s[28:31], s72 offen offset:0 sc1 lds
    buffer_load_dwordx4 v2, s[28:31], s73 offen offset:1024 sc1 lds
    buffer_load_dwordx4 v2, s[28:31], s74 offen offset:2048 sc1 lds
    buffer_load_dwordx4 v2, s[28:31], s75 offen offset:3072 sc1 lds
    v_add_u32 v2, 128, v2
    s_barrier
    s_waitcnt vmcnt(16)
    s_barrier
    ds_read_b64_tr_b16 a[64:65], v12 offset:0
    ds_read_b64_tr_b16 a[66:67], v12 offset:256
    ds_read_b64_tr_b16 a[68:69], v14 offset:0
    ds_read_b64_tr_b16 a[70:71], v14 offset:256
    ds_read_b64_tr_b16 a[72:73], v12 offset:1024
    ds_read_b64_tr_b16 a[74:75], v12 offset:1280
    ds_read_b64_tr_b16 a[76:77], v14 offset:1024
    ds_read_b64_tr_b16 a[78:79], v14 offset:1280
    ds_read_b64_tr_b16 a[80:81], v12 offset:2048
    ds_read_b64_tr_b16 a[82:83], v12 offset:2304
    ds_read_b64_tr_b16 a[84:85], v14 offset:2048
    ds_read_b64_tr_b16 a[86:87], v14 offset:2304
    ds_read_b64_tr_b16 a[88:89], v12 offset:3072
    ds_read_b64_tr_b16 a[90:91], v12 offset:3328
    ds_read_b64_tr_b16 a[92:93], v14 offset:3072
    ds_read_b64_tr_b16 a[94:95], v14 offset:3328
    ds_read_b64_tr_b16 a[96:97], v12 offset:4096
    ds_read_b64_tr_b16 a[98:99], v12 offset:4352
    ds_read_b64_tr_b16 a[100:101], v14 offset:4096
    ds_read_b64_tr_b16 a[102:103], v14 offset:4352
    ds_read_b128 a[0:3], v8 offset:0
    ds_read_b128 a[4:7], v8 offset:2048
    ds_read_b128 a[8:11], v8 offset:4096
    ds_read_b128 a[12:15], v8 offset:6144
    ds_read_b128 a[16:19], v8 offset:8192
    ds_read_b128 a[20:23], v8 offset:10240
    ds_read_b128 a[24:27], v8 offset:12288
    ds_read_b128 a[28:31], v8 offset:14336
    ds_read_b128 a[112:115], v10 offset:0
    ds_read_b64_tr_b16 a[120:121], v44 offset:0
    ds_read_b64_tr_b16 a[122:123], v44 offset:256
    s_mov_b32 s67, 7
    v_mov_b32 v20, 0x7ff00000
.p2align 3
L_loop0:
    s_waitcnt lgkmcnt(0)
    s_barrier
    v_mfma_f32_16x16x32_bf16 v[120:123], a[120:123], a[112:115], v[120:123]
    buffer_load_dword v7, v6, s[44:47], s4 offen
    v_add_u32_e64 v6, s79, v6
    v_mfma_f32_16x16x32_bf16 a[128:131], a[64:67], a[0:3], a[128:131]
    v_mfma_f32_16x16x32_bf16 a[136:139], a[64:67], a[4:7], a[136:139]
    v_mfma_f32_16x16x32_bf16 a[144:147], a[64:67], a[8:11], a[144:147]
    ds_read_b128 a[32:35], v9 offset:0
    v_mfma_f32_16x16x32_bf16 a[152:155], a[64:67], a[12:15], a[152:155]
    v_mfma_f32_16x16x32_bf16 a[160:163], a[64:67], a[16:19], a[160:163]
    v_mfma_f32_16x16x32_bf16 a[168:171], a[64:67], a[20:23], a[168:171]
    v_mfma_f32_16x16x32_bf16 a[176:179], a[64:67], a[24:27], a[176:179]
    ds_read_b128 a[36:39], v9 offset:2048
    v_mfma_f32_16x16x32_bf16 a[184:187], a[64:67], a[28:31], a[184:187]
    ds_read_b64_tr_b16 a[64:65], v12 offset:20480
    v_mfma_f32_16x16x32_bf16 a[132:135], a[68:71], a[0:3], a[132:135]
    ds_read_b64_tr_b16 a[66:67], v12 offset:20736
    v_mfma_f32_16x16x32_bf16 a[140:143], a[68:71], a[4:7], a[140:143]
    v_mfma_f32_16x16x32_bf16 a[148:151], a[68:71], a[8:11], a[148:151]
    ds_read_b128 a[40:43], v9 offset:4096
    v_mfma_f32_16x16x32_bf16 a[156:159], a[68:71], a[12:15], a[156:159]
    v_mfma_f32_16x16x32_bf16 a[164:167], a[68:71], a[16:19], a[164:167]
    v_mfma_f32_16x16x32_bf16 a[172:175], a[68:71], a[20:23], a[172:175]
    v_mfma_f32_16x16x32_bf16 a[180:183], a[68:71], a[24:27], a[180:183]
    ds_read_b128 a[44:47], v9 offset:6144
    v_mfma_f32_16x16x32_bf16 a[188:191], a[68:71], a[28:31], a[188:191]
    ds_read_b64_tr_b16 a[68:69], v14 offset:20480
    v_mfma_f32_16x16x32_bf16 v[52:55], a[0:3], a[72:75], v[52:55]
    ds_read_b64_tr_b16 a[70:71], v14 offset:20736
    v_mfma_f32_16x16x32_bf16 v[56:59], a[4:7], a[72:75], v[56:59]
    v_mfma_f32_16x16x32_bf16 v[60:63], a[8:11], a[72:75], v[60:63]
    ds_read_b128 a[48:51], v9 offset:8192
    v_mfma_f32_16x16x32_bf16 v[64:67], a[12:15], a[72:75], v[64:67]
    v_mfma_f32_16x16x32_bf16 v[68:71], a[16:19], a[72:75], v[68:71]
    v_mfma_f32_16x16x32_bf16 v[72:75], a[20:23], a[72:75], v[72:75]
    v_mfma_f32_16x16x32_bf16 v[76:79], a[24:27], a[72:75], v[76:79]
    ds_read_b128 a[52:55], v9 offset:10240
    v_mfma_f32_16x16x32_bf16 v[80:83], a[28:31], a[72:75], v[80:83]
    ds_read_b64_tr_b16 a[72:73], v12 offset:21504
    v_mfma_f32_16x16x32_bf16 v[88:91], a[0:3], a[76:79], v[88:91]
    ds_read_b64_tr_b16 a[74:75], v12 offset:21760
    v_mfma_f32_16x16x32_bf16 v[92:95], a[4:7], a[76:79], v[92:95]
    v_mfma_f32_16x16x32_bf16 v[96:99], a[8:11], a[76:79], v[96:99]
    ds_read_b128 a[56:59], v9 offset:12288
    v_mfma_f32_16x16x32_bf16 v[100:103], a[12:15], a[76:79], v[100:103]
    v_mfma_f32_16x16x32_bf16 v[104:107], a[16:19], a[76:79], v[104:107]
    v_mfma_f32_16x16x32_bf16 v[108:111], a[20:23], a[76:79], v[108:111]
    v_mfma_f32_16x16x32_bf16 v[112:115], a[24:27], a[76:79], v[112:115]
    ds_read_b128 a[60:63], v9 offset:14336
    v_mfma_f32_16x16x32_bf16 v[116:119], a[28:31], a[76:79], v[116:119]
    ds_read_b64_tr_b16 a[76:77], v14 offset:21504
    v_mfma_f32_16x16x32_bf16 a[192:195], a[80:83], a[0:3], a[192:195]
    ds_read_b64_tr_b16 a[78:79], v14 offset:21760
    v_mfma_f32_16x16x32_bf16 a[200:203], a[80:83], a[4:7], a[200:203]
    v_mfma_f32_16x16x32_bf16 a[208:211], a[80:83], a[8:11], a[208:211]
    ds_read_b128 a[116:119], v11 offset:0
    v_mfma_f32_16x16x32_bf16 a[216:219], a[80:83], a[12:15], a[216:219]
    v_mfma_f32_16x16x32_bf16 a[224:227], a[80:83], a[16:19], a[224:227]
    v_mfma_f32_16x16x32_bf16 a[232:235], a[80:83], a[20:23], a[232:235]
    v_mfma_f32_16x16x32_bf16 a[240:243], a[80:83], a[24:27], a[240:243]
    ds_read_b64_tr_b16 a[104:105], v12 offset:24576
    v_mfma_f32_16x16x32_bf16 a[248:251], a[80:83], a[28:31], a[248:251]
    ds_read_b64_tr_b16 a[80:81], v12 offset:22528
    v_mfma_f32_16x16x32_bf16 a[196:199], a[84:87], a[0:3], a[196:199]
    ds_read_b64_tr_b16 a[82:83], v12 offset:22784
    v_mfma_f32_16x16x32_bf16 a[204:207], a[84:87], a[4:7], a[204:207]
    v_mfma_f32_16x16x32_bf16 a[212:215], a[84:87], a[8:11], a[212:215]
    ds_read_b64_tr_b16 a[106:107], v12 offset:24832
    v_mfma_f32_16x16x32_bf16 a[220:223], a[84:87], a[12:15], a[220:223]
    v_mfma_f32_16x16x32_bf16 a[228:231], a[84:87], a[16:19], a[228:231]
    v_mfma_f32_16x16x32_bf16 a[236:239], a[84:87], a[20:23], a[236:239]
    v_mfma_f32_16x16x32_bf16 a[244:247], a[84:87], a[24:27], a[244:247]
    ds_read_b64_tr_b16 a[108:109], v14 offset:24576
    v_mfma_f32_16x16x32_bf16 a[252:255], a[84:87], a[28:31], a[252:255]
    ds_read_b64_tr_b16 a[84:85], v14 offset:22528
    v_mfma_f32_16x16x32_bf16 v[128:131], a[88:91], a[0:3], v[128:131]
    ds_read_b64_tr_b16 a[86:87], v14 offset:22784
    v_mfma_f32_16x16x32_bf16 v[144:147], a[88:91], a[4:7], v[144:147]
    v_mfma_f32_16x16x32_bf16 v[160:163], a[88:91], a[8:11], v[160:163]
    ds_read_b64_tr_b16 a[110:111], v14 offset:24832
    v_mfma_f32_16x16x32_bf16 v[176:179], a[88:91], a[12:15], v[176:179]
    v_mfma_f32_16x16x32_bf16 v[192:195], a[88:91], a[16:19], v[192:195]
    v_mfma_f32_16x16x32_bf16 v[208:211], a[88:91], a[20:23], v[208:211]
    v_mfma_f32_16x16x32_bf16 v[224:227], a[88:91], a[24:27], v[224:227]
    ds_read_b64_tr_b16 a[124:125], v44 offset:20480
    v_mfma_f32_16x16x32_bf16 v[240:243], a[88:91], a[28:31], v[240:243]
    ds_read_b64_tr_b16 a[88:89], v12 offset:23552
    v_mfma_f32_16x16x32_bf16 v[132:135], a[92:95], a[0:3], v[132:135]
    ds_read_b64_tr_b16 a[90:91], v12 offset:23808
    v_mfma_f32_16x16x32_bf16 v[148:151], a[92:95], a[4:7], v[148:151]
    v_mfma_f32_16x16x32_bf16 v[164:167], a[92:95], a[8:11], v[164:167]
    ds_read_b64_tr_b16 a[126:127], v44 offset:20736
    v_mfma_f32_16x16x32_bf16 v[180:183], a[92:95], a[12:15], v[180:183]
    v_mfma_f32_16x16x32_bf16 v[196:199], a[92:95], a[16:19], v[196:199]
    v_mfma_f32_16x16x32_bf16 v[212:215], a[92:95], a[20:23], v[212:215]
    v_mfma_f32_16x16x32_bf16 v[228:231], a[92:95], a[24:27], v[228:231]
    v_mfma_f32_16x16x32_bf16 v[244:247], a[92:95], a[28:31], v[244:247]
    ds_read_b64_tr_b16 a[92:93], v14 offset:23552
    v_mfma_f32_16x16x32_bf16 v[136:139], a[96:99], a[0:3], v[136:139]
    ds_read_b64_tr_b16 a[94:95], v14 offset:23808
    v_mfma_f32_16x16x32_bf16 v[152:155], a[96:99], a[4:7], v[152:155]
    v_mfma_f32_16x16x32_bf16 v[168:171], a[96:99], a[8:11], v[168:171]
    v_mfma_f32_16x16x32_bf16 v[184:187], a[96:99], a[12:15], v[184:187]
    v_mfma_f32_16x16x32_bf16 v[200:203], a[96:99], a[16:19], v[200:203]
    v_mfma_f32_16x16x32_bf16 v[216:219], a[96:99], a[20:23], v[216:219]
    v_mfma_f32_16x16x32_bf16 v[232:235], a[96:99], a[24:27], v[232:235]
    v_mfma_f32_16x16x32_bf16 v[248:251], a[96:99], a[28:31], v[248:251]
    v_mfma_f32_16x16x32_bf16 v[140:143], a[100:103], a[0:3], v[140:143]
    v_mfma_f32_16x16x32_bf16 v[156:159], a[100:103], a[4:7], v[156:159]
    v_mfma_f32_16x16x32_bf16 v[172:175], a[100:103], a[8:11], v[172:175]
    v_mfma_f32_16x16x32_bf16 v[188:191], a[100:103], a[12:15], v[188:191]
    v_mfma_f32_16x16x32_bf16 v[204:207], a[100:103], a[16:19], v[204:207]
    v_mfma_f32_16x16x32_bf16 v[220:223], a[100:103], a[20:23], v[220:223]
    v_mfma_f32_16x16x32_bf16 v[236:239], a[100:103], a[24:27], v[236:239]
    v_mfma_f32_16x16x32_bf16 v[252:255], a[100:103], a[28:31], v[252:255]
    s_waitcnt vmcnt(1) lgkmcnt(0)
    s_barrier
    v_mfma_f32_16x16x32_bf16 v[120:123], a[124:127], a[116:119], v[120:123]
    s_add_u32 m0, s78, 0
    v_mfma_f32_16x16x32_bf16 a[128:131], a[64:67], a[32:35], a[128:131]
    buffer_load_dwordx4 v1, s[28:31], s68 offen offset:0 sc1 lds
    v_mfma_f32_16x16x32_bf16 a[136:139], a[64:67], a[36:39], a[136:139]
    v_mfma_f32_16x16x32_bf16 a[144:147], a[64:67], a[40:43], a[144:147]
    ds_read_b128 a[0:3], v8 offset:34816
    v_mfma_f32_16x16x32_bf16 a[152:155], a[64:67], a[44:47], a[152:155]
    buffer_load_dwordx4 v1, s[28:31], s69 offen offset:1024 sc1 lds
    v_mfma_f32_16x16x32_bf16 a[160:163], a[64:67], a[48:51], a[160:163]
    v_mfma_f32_16x16x32_bf16 a[168:171], a[64:67], a[52:55], a[168:171]
    v_mfma_f32_16x16x32_bf16 a[176:179], a[64:67], a[56:59], a[176:179]
    ds_read_b128 a[4:7], v8 offset:36864
    v_mfma_f32_16x16x32_bf16 a[184:187], a[64:67], a[60:63], a[184:187]
    ds_read_b64_tr_b16 a[64:65], v13 offset:0
    v_mfma_f32_16x16x32_bf16 a[132:135], a[68:71], a[32:35], a[132:135]
    ds_read_b64_tr_b16 a[66:67], v13 offset:256
    v_mfma_f32_16x16x32_bf16 a[140:143], a[68:71], a[36:39], a[140:143]
    buffer_load_dwordx4 v1, s[28:31], s70 offen offset:2048 sc1 lds
    v_mfma_f32_16x16x32_bf16 a[148:151], a[68:71], a[40:43], a[148:151]
    ds_read_b128 a[8:11], v8 offset:38912
    v_mfma_f32_16x16x32_bf16 a[156:159], a[68:71], a[44:47], a[156:159]
    buffer_load_dwordx4 v1, s[28:31], s71 offen offset:3072 sc1 lds
    v_mfma_f32_16x16x32_bf16 a[164:167], a[68:71], a[48:51], a[164:167]
    v_mfma_f32_16x16x32_bf16 a[172:175], a[68:71], a[52:55], a[172:175]
    v_mfma_f32_16x16x32_bf16 a[180:183], a[68:71], a[56:59], a[180:183]
    ds_read_b128 a[12:15], v8 offset:40960
    v_mfma_f32_16x16x32_bf16 a[188:191], a[68:71], a[60:63], a[188:191]
    ds_read_b64_tr_b16 a[68:69], v15 offset:0
    v_mfma_f32_16x16x32_bf16 v[52:55], a[32:35], a[72:75], v[52:55]
    ds_read_b64_tr_b16 a[70:71], v15 offset:256
    s_add_u32 m0, s78, 4096
    v_mfma_f32_16x16x32_bf16 v[56:59], a[36:39], a[72:75], v[56:59]
    buffer_load_dwordx4 v1, s[28:31], s72 offen offset:0 sc1 lds
    v_mfma_f32_16x16x32_bf16 v[60:63], a[40:43], a[72:75], v[60:63]
    ds_read_b128 a[16:19], v8 offset:43008
    v_mfma_f32_16x16x32_bf16 v[64:67], a[44:47], a[72:75], v[64:67]
    buffer_load_dwordx4 v1, s[28:31], s73 offen offset:1024 sc1 lds
    v_mfma_f32_16x16x32_bf16 v[68:71], a[48:51], a[72:75], v[68:71]
    v_mfma_f32_16x16x32_bf16 v[72:75], a[52:55], a[72:75], v[72:75]
    v_mfma_f32_16x16x32_bf16 v[76:79], a[56:59], a[72:75], v[76:79]
    ds_read_b128 a[20:23], v8 offset:45056
    v_mfma_f32_16x16x32_bf16 v[80:83], a[60:63], a[72:75], v[80:83]
    ds_read_b64_tr_b16 a[72:73], v13 offset:1024
    v_mfma_f32_16x16x32_bf16 v[88:91], a[32:35], a[76:79], v[88:91]
    ds_read_b64_tr_b16 a[74:75], v13 offset:1280
    v_mfma_f32_16x16x32_bf16 v[92:95], a[36:39], a[76:79], v[92:95]
    buffer_load_dwordx4 v1, s[28:31], s74 offen offset:2048 sc1 lds
    v_mfma_f32_16x16x32_bf16 v[96:99], a[40:43], a[76:79], v[96:99]
    ds_read_b128 a[24:27], v8 offset:47104
    v_mfma_f32_16x16x32_bf16 v[100:103], a[44:47], a[76:79], v[100:103]
    buffer_load_dwordx4 v1, s[28:31], s75 offen offset:3072 sc1 lds
    v_add_u32 v1, 128, v1
    v_mfma_f32_16x16x32_bf16 v[104:107], a[48:51], a[76:79], v[104:107]
    v_mfma_f32_16x16x32_bf16 v[108:111], a[52:55], a[76:79], v[108:111]
    v_mfma_f32_16x16x32_bf16 v[112:115], a[56:59], a[76:79], v[112:115]
    ds_read_b128 a[28:31], v8 offset:49152
    v_mfma_f32_16x16x32_bf16 v[116:119], a[60:63], a[76:79], v[116:119]
    ds_read_b64_tr_b16 a[76:77], v15 offset:1024
    v_mfma_f32_16x16x32_bf16 a[192:195], a[80:83], a[32:35], a[192:195]
    ds_read_b64_tr_b16 a[78:79], v15 offset:1280
    s_add_u32 m0, s78, 8192
    v_mfma_f32_16x16x32_bf16 a[200:203], a[80:83], a[36:39], a[200:203]
    buffer_load_dwordx4 v2, s[28:31], s68 offen offset:0 sc1 lds
    v_mfma_f32_16x16x32_bf16 a[208:211], a[80:83], a[40:43], a[208:211]
    ds_read_b128 a[112:115], v10 offset:34816
    v_mfma_f32_16x16x32_bf16 a[216:219], a[80:83], a[44:47], a[216:219]
    buffer_load_dwordx4 v2, s[28:31], s69 offen offset:1024 sc1 lds
    v_mfma_f32_16x16x32_bf16 a[224:227], a[80:83], a[48:51], a[224:227]
    v_mfma_f32_16x16x32_bf16 a[232:235], a[80:83], a[52:55], a[232:235]
    v_mfma_f32_16x16x32_bf16 a[240:243], a[80:83], a[56:59], a[240:243]
    ds_read_b64_tr_b16 a[96:97], v13 offset:4096
    v_mfma_f32_16x16x32_bf16 a[248:251], a[80:83], a[60:63], a[248:251]
    ds_read_b64_tr_b16 a[80:81], v13 offset:2048
    v_mfma_f32_16x16x32_bf16 a[196:199], a[84:87], a[32:35], a[196:199]
    ds_read_b64_tr_b16 a[82:83], v13 offset:2304
    v_mfma_f32_16x16x32_bf16 a[204:207], a[84:87], a[36:39], a[204:207]
    buffer_load_dwordx4 v2, s[28:31], s70 offen offset:2048 sc1 lds
    v_mfma_f32_16x16x32_bf16 a[212:215], a[84:87], a[40:43], a[212:215]
    ds_read_b64_tr_b16 a[98:99], v13 offset:4352
    v_mfma_f32_16x16x32_bf16 a[220:223], a[84:87], a[44:47], a[220:223]
    buffer_load_dwordx4 v2, s[28:31], s71 offen offset:3072 sc1 lds
    v_mfma_f32_16x16x32_bf16 a[228:231], a[84:87], a[48:51], a[228:231]
    v_mfma_f32_16x16x32_bf16 a[236:239], a[84:87], a[52:55], a[236:239]
    v_mfma_f32_16x16x32_bf16 a[244:247], a[84:87], a[56:59], a[244:247]
    ds_read_b64_tr_b16 a[100:101], v15 offset:4096
    v_mfma_f32_16x16x32_bf16 a[252:255], a[84:87], a[60:63], a[252:255]
    ds_read_b64_tr_b16 a[84:85], v15 offset:2048
    v_mfma_f32_16x16x32_bf16 v[128:131], a[88:91], a[32:35], v[128:131]
    ds_read_b64_tr_b16 a[86:87], v15 offset:2304
    s_add_u32 m0, s78, 12288
    v_mfma_f32_16x16x32_bf16 v[144:147], a[88:91], a[36:39], v[144:147]
    buffer_load_dwordx4 v2, s[28:31], s72 offen offset:0 sc1 lds
    v_mfma_f32_16x16x32_bf16 v[160:163], a[88:91], a[40:43], v[160:163]
    ds_read_b64_tr_b16 a[102:103], v15 offset:4352
    v_mfma_f32_16x16x32_bf16 v[176:179], a[88:91], a[44:47], v[176:179]
    buffer_load_dwordx4 v2, s[28:31], s73 offen offset:1024 sc1 lds
    v_mfma_f32_16x16x32_bf16 v[192:195], a[88:91], a[48:51], v[192:195]
    v_mfma_f32_16x16x32_bf16 v[208:211], a[88:91], a[52:55], v[208:211]
    v_mfma_f32_16x16x32_bf16 v[224:227], a[88:91], a[56:59], v[224:227]
    ds_read_b64_tr_b16 a[120:121], v45 offset:0
    v_mfma_f32_16x16x32_bf16 v[240:243], a[88:91], a[60:63], v[240:243]
    ds_read_b64_tr_b16 a[88:89], v13 offset:3072
    v_mfma_f32_16x16x32_bf16 v[132:135], a[92:95], a[32:35], v[132:135]
    ds_read_b64_tr_b16 a[90:91], v13 offset:3328
    v_mfma_f32_16x16x32_bf16 v[148:151], a[92:95], a[36:39], v[148:151]
    buffer_load_dwordx4 v2, s[28:31], s74 offen offset:2048 sc1 lds
    v_mfma_f32_16x16x32_bf16 v[164:167], a[92:95], a[40:43], v[164:167]
    ds_read_b64_tr_b16 a[122:123], v45 offset:256
    v_mfma_f32_16x16x32_bf16 v[180:183], a[92:95], a[44:47], v[180:183]
    buffer_load_dwordx4 v2, s[28:31], s75 offen offset:3072 sc1 lds
    v_add_u32 v2, 128, v2
    v_mfma_f32_16x16x32_bf16 v[196:199], a[92:95], a[48:51], v[196:199]
    v_mfma_f32_16x16x32_bf16 v[212:215], a[92:95], a[52:55], v[212:215]
    v_mfma_f32_16x16x32_bf16 v[228:231], a[92:95], a[56:59], v[228:231]
    v_mfma_f32_16x16x32_bf16 v[244:247], a[92:95], a[60:63], v[244:247]
    ds_read_b64_tr_b16 a[92:93], v15 offset:3072
    v_mfma_f32_16x16x32_bf16 v[136:139], a[104:107], a[32:35], v[136:139]
    ds_read_b64_tr_b16 a[94:95], v15 offset:3328
    v_mfma_f32_16x16x32_bf16 v[152:155], a[104:107], a[36:39], v[152:155]
    v_mfma_f32_16x16x32_bf16 v[168:171], a[104:107], a[40:43], v[168:171]
    v_mfma_f32_16x16x32_bf16 v[184:187], a[104:107], a[44:47], v[184:187]
    v_mfma_f32_16x16x32_bf16 v[200:203], a[104:107], a[48:51], v[200:203]
    v_mfma_f32_16x16x32_bf16 v[216:219], a[104:107], a[52:55], v[216:219]
    v_mfma_f32_16x16x32_bf16 v[232:235], a[104:107], a[56:59], v[232:235]
    v_mfma_f32_16x16x32_bf16 v[248:251], a[104:107], a[60:63], v[248:251]
    v_mfma_f32_16x16x32_bf16 v[140:143], a[108:111], a[32:35], v[140:143]
    v_mfma_f32_16x16x32_bf16 v[156:159], a[108:111], a[36:39], v[156:159]
    v_mfma_f32_16x16x32_bf16 v[172:175], a[108:111], a[40:43], v[172:175]
    v_mfma_f32_16x16x32_bf16 v[188:191], a[108:111], a[44:47], v[188:191]
    v_mfma_f32_16x16x32_bf16 v[204:207], a[108:111], a[48:51], v[204:207]
    v_mfma_f32_16x16x32_bf16 v[220:223], a[108:111], a[52:55], v[220:223]
    v_mfma_f32_16x16x32_bf16 v[236:239], a[108:111], a[56:59], v[236:239]
    v_mfma_f32_16x16x32_bf16 v[252:255], a[108:111], a[60:63], v[252:255]
    s_waitcnt lgkmcnt(0)
    s_barrier
    v_mfma_f32_16x16x32_bf16 v[120:123], a[120:123], a[112:115], v[120:123]
    buffer_load_dword v7, v6, s[44:47], s4 offen
    v_add_u32_e64 v6, s79, v6
    v_mfma_f32_16x16x32_bf16 a[128:131], a[64:67], a[0:3], a[128:131]
    v_mfma_f32_16x16x32_bf16 a[136:139], a[64:67], a[4:7], a[136:139]
    v_mfma_f32_16x16x32_bf16 a[144:147], a[64:67], a[8:11], a[144:147]
    ds_read_b128 a[32:35], v9 offset:34816
    v_mfma_f32_16x16x32_bf16 a[152:155], a[64:67], a[12:15], a[152:155]
    v_mfma_f32_16x16x32_bf16 a[160:163], a[64:67], a[16:19], a[160:163]
    v_mfma_f32_16x16x32_bf16 a[168:171], a[64:67], a[20:23], a[168:171]
    v_mfma_f32_16x16x32_bf16 a[176:179], a[64:67], a[24:27], a[176:179]
    ds_read_b128 a[36:39], v9 offset:36864
    v_mfma_f32_16x16x32_bf16 a[184:187], a[64:67], a[28:31], a[184:187]
    ds_read_b64_tr_b16 a[64:65], v13 offset:20480
    v_mfma_f32_16x16x32_bf16 a[132:135], a[68:71], a[0:3], a[132:135]
    ds_read_b64_tr_b16 a[66:67], v13 offset:20736
    v_mfma_f32_16x16x32_bf16 a[140:143], a[68:71], a[4:7], a[140:143]
    v_mfma_f32_16x16x32_bf16 a[148:151], a[68:71], a[8:11], a[148:151]
    ds_read_b128 a[40:43], v9 offset:38912
    v_mfma_f32_16x16x32_bf16 a[156:159], a[68:71], a[12:15], a[156:159]
    v_mfma_f32_16x16x32_bf16 a[164:167], a[68:71], a[16:19], a[164:167]
    v_mfma_f32_16x16x32_bf16 a[172:175], a[68:71], a[20:23], a[172:175]
    v_mfma_f32_16x16x32_bf16 a[180:183], a[68:71], a[24:27], a[180:183]
    ds_read_b128 a[44:47], v9 offset:40960
    v_mfma_f32_16x16x32_bf16 a[188:191], a[68:71], a[28:31], a[188:191]
    ds_read_b64_tr_b16 a[68:69], v15 offset:20480
    v_mfma_f32_16x16x32_bf16 v[52:55], a[0:3], a[72:75], v[52:55]
    ds_read_b64_tr_b16 a[70:71], v15 offset:20736
    v_mfma_f32_16x16x32_bf16 v[56:59], a[4:7], a[72:75], v[56:59]
    v_mfma_f32_16x16x32_bf16 v[60:63], a[8:11], a[72:75], v[60:63]
    ds_read_b128 a[48:51], v9 offset:43008
    v_mfma_f32_16x16x32_bf16 v[64:67], a[12:15], a[72:75], v[64:67]
    v_mfma_f32_16x16x32_bf16 v[68:71], a[16:19], a[72:75], v[68:71]
    v_mfma_f32_16x16x32_bf16 v[72:75], a[20:23], a[72:75], v[72:75]
    v_mfma_f32_16x16x32_bf16 v[76:79], a[24:27], a[72:75], v[76:79]
    ds_read_b128 a[52:55], v9 offset:45056
    v_mfma_f32_16x16x32_bf16 v[80:83], a[28:31], a[72:75], v[80:83]
    ds_read_b64_tr_b16 a[72:73], v13 offset:21504
    v_mfma_f32_16x16x32_bf16 v[88:91], a[0:3], a[76:79], v[88:91]
    ds_read_b64_tr_b16 a[74:75], v13 offset:21760
    v_mfma_f32_16x16x32_bf16 v[92:95], a[4:7], a[76:79], v[92:95]
    v_mfma_f32_16x16x32_bf16 v[96:99], a[8:11], a[76:79], v[96:99]
    ds_read_b128 a[56:59], v9 offset:47104
    v_mfma_f32_16x16x32_bf16 v[100:103], a[12:15], a[76:79], v[100:103]
    v_mfma_f32_16x16x32_bf16 v[104:107], a[16:19], a[76:79], v[104:107]
    v_mfma_f32_16x16x32_bf16 v[108:111], a[20:23], a[76:79], v[108:111]
    v_mfma_f32_16x16x32_bf16 v[112:115], a[24:27], a[76:79], v[112:115]
    ds_read_b128 a[60:63], v9 offset:49152
    v_mfma_f32_16x16x32_bf16 v[116:119], a[28:31], a[76:79], v[116:119]
    ds_read_b64_tr_b16 a[76:77], v15 offset:21504
    v_mfma_f32_16x16x32_bf16 a[192:195], a[80:83], a[0:3], a[192:195]
    ds_read_b64_tr_b16 a[78:79], v15 offset:21760
    v_mfma_f32_16x16x32_bf16 a[200:203], a[80:83], a[4:7], a[200:203]
    v_mfma_f32_16x16x32_bf16 a[208:211], a[80:83], a[8:11], a[208:211]
    ds_read_b128 a[116:119], v11 offset:34816
    v_mfma_f32_16x16x32_bf16 a[216:219], a[80:83], a[12:15], a[216:219]
    v_mfma_f32_16x16x32_bf16 a[224:227], a[80:83], a[16:19], a[224:227]
    v_mfma_f32_16x16x32_bf16 a[232:235], a[80:83], a[20:23], a[232:235]
    v_mfma_f32_16x16x32_bf16 a[240:243], a[80:83], a[24:27], a[240:243]
    ds_read_b64_tr_b16 a[104:105], v13 offset:24576
    v_mfma_f32_16x16x32_bf16 a[248:251], a[80:83], a[28:31], a[248:251]
    ds_read_b64_tr_b16 a[80:81], v13 offset:22528
    v_mfma_f32_16x16x32_bf16 a[196:199], a[84:87], a[0:3], a[196:199]
    ds_read_b64_tr_b16 a[82:83], v13 offset:22784
    v_mfma_f32_16x16x32_bf16 a[204:207], a[84:87], a[4:7], a[204:207]
    v_mfma_f32_16x16x32_bf16 a[212:215], a[84:87], a[8:11], a[212:215]
    ds_read_b64_tr_b16 a[106:107], v13 offset:24832
    v_mfma_f32_16x16x32_bf16 a[220:223], a[84:87], a[12:15], a[220:223]
    v_mfma_f32_16x16x32_bf16 a[228:231], a[84:87], a[16:19], a[228:231]
    v_mfma_f32_16x16x32_bf16 a[236:239], a[84:87], a[20:23], a[236:239]
    v_mfma_f32_16x16x32_bf16 a[244:247], a[84:87], a[24:27], a[244:247]
    ds_read_b64_tr_b16 a[108:109], v15 offset:24576
    v_mfma_f32_16x16x32_bf16 a[252:255], a[84:87], a[28:31], a[252:255]
    ds_read_b64_tr_b16 a[84:85], v15 offset:22528
    v_mfma_f32_16x16x32_bf16 v[128:131], a[88:91], a[0:3], v[128:131]
    ds_read_b64_tr_b16 a[86:87], v15 offset:22784
    v_mfma_f32_16x16x32_bf16 v[144:147], a[88:91], a[4:7], v[144:147]
    v_mfma_f32_16x16x32_bf16 v[160:163], a[88:91], a[8:11], v[160:163]
    ds_read_b64_tr_b16 a[110:111], v15 offset:24832
    v_mfma_f32_16x16x32_bf16 v[176:179], a[88:91], a[12:15], v[176:179]
    v_mfma_f32_16x16x32_bf16 v[192:195], a[88:91], a[16:19], v[192:195]
    v_mfma_f32_16x16x32_bf16 v[208:211], a[88:91], a[20:23], v[208:211]
    v_mfma_f32_16x16x32_bf16 v[224:227], a[88:91], a[24:27], v[224:227]
    ds_read_b64_tr_b16 a[124:125], v45 offset:20480
    v_mfma_f32_16x16x32_bf16 v[240:243], a[88:91], a[28:31], v[240:243]
    ds_read_b64_tr_b16 a[88:89], v13 offset:23552
    v_mfma_f32_16x16x32_bf16 v[132:135], a[92:95], a[0:3], v[132:135]
    ds_read_b64_tr_b16 a[90:91], v13 offset:23808
    v_mfma_f32_16x16x32_bf16 v[148:151], a[92:95], a[4:7], v[148:151]
    v_mfma_f32_16x16x32_bf16 v[164:167], a[92:95], a[8:11], v[164:167]
    ds_read_b64_tr_b16 a[126:127], v45 offset:20736
    v_mfma_f32_16x16x32_bf16 v[180:183], a[92:95], a[12:15], v[180:183]
    v_mfma_f32_16x16x32_bf16 v[196:199], a[92:95], a[16:19], v[196:199]
    v_mfma_f32_16x16x32_bf16 v[212:215], a[92:95], a[20:23], v[212:215]
    v_mfma_f32_16x16x32_bf16 v[228:231], a[92:95], a[24:27], v[228:231]
    v_mfma_f32_16x16x32_bf16 v[244:247], a[92:95], a[28:31], v[244:247]
    ds_read_b64_tr_b16 a[92:93], v15 offset:23552
    v_mfma_f32_16x16x32_bf16 v[136:139], a[96:99], a[0:3], v[136:139]
    ds_read_b64_tr_b16 a[94:95], v15 offset:23808
    v_mfma_f32_16x16x32_bf16 v[152:155], a[96:99], a[4:7], v[152:155]
    v_mfma_f32_16x16x32_bf16 v[168:171], a[96:99], a[8:11], v[168:171]
    v_mfma_f32_16x16x32_bf16 v[184:187], a[96:99], a[12:15], v[184:187]
    v_mfma_f32_16x16x32_bf16 v[200:203], a[96:99], a[16:19], v[200:203]
    v_mfma_f32_16x16x32_bf16 v[216:219], a[96:99], a[20:23], v[216:219]
    v_mfma_f32_16x16x32_bf16 v[232:235], a[96:99], a[24:27], v[232:235]
    v_mfma_f32_16x16x32_bf16 v[248:251], a[96:99], a[28:31], v[248:251]
    v_mfma_f32_16x16x32_bf16 v[140:143], a[100:103], a[0:3], v[140:143]
    v_mfma_f32_16x16x32_bf16 v[156:159], a[100:103], a[4:7], v[156:159]
    v_mfma_f32_16x16x32_bf16 v[172:175], a[100:103], a[8:11], v[172:175]
    v_mfma_f32_16x16x32_bf16 v[188:191], a[100:103], a[12:15], v[188:191]
    v_mfma_f32_16x16x32_bf16 v[204:207], a[100:103], a[16:19], v[204:207]
    v_mfma_f32_16x16x32_bf16 v[220:223], a[100:103], a[20:23], v[220:223]
    v_mfma_f32_16x16x32_bf16 v[236:239], a[100:103], a[24:27], v[236:239]
    v_mfma_f32_16x16x32_bf16 v[252:255], a[100:103], a[28:31], v[252:255]
    s_waitcnt vmcnt(1) lgkmcnt(0)
    s_barrier
    v_mfma_f32_16x16x32_bf16 v[120:123], a[124:127], a[116:119], v[120:123]
    s_add_u32 m0, s78, 34816
    v_mfma_f32_16x16x32_bf16 a[128:131], a[64:67], a[32:35], a[128:131]
    buffer_load_dwordx4 v1, s[28:31], s68 offen offset:0 sc1 lds
    v_mfma_f32_16x16x32_bf16 a[136:139], a[64:67], a[36:39], a[136:139]
    v_mfma_f32_16x16x32_bf16 a[144:147], a[64:67], a[40:43], a[144:147]
    ds_read_b128 a[0:3], v8 offset:0
    v_mfma_f32_16x16x32_bf16 a[152:155], a[64:67], a[44:47], a[152:155]
    buffer_load_dwordx4 v1, s[28:31], s69 offen offset:1024 sc1 lds
    v_mfma_f32_16x16x32_bf16 a[160:163], a[64:67], a[48:51], a[160:163]
    v_mfma_f32_16x16x32_bf16 a[168:171], a[64:67], a[52:55], a[168:171]
    v_mfma_f32_16x16x32_bf16 a[176:179], a[64:67], a[56:59], a[176:179]
    ds_read_b128 a[4:7], v8 offset:2048
    v_mfma_f32_16x16x32_bf16 a[184:187], a[64:67], a[60:63], a[184:187]
    ds_read_b64_tr_b16 a[64:65], v12 offset:0
    v_mfma_f32_16x16x32_bf16 a[132:135], a[68:71], a[32:35], a[132:135]
    ds_read_b64_tr_b16 a[66:67], v12 offset:256
    v_mfma_f32_16x16x32_bf16 a[140:143], a[68:71], a[36:39], a[140:143]
    buffer_load_dwordx4 v1, s[28:31], s70 offen offset:2048 sc1 lds
    v_mfma_f32_16x16x32_bf16 a[148:151], a[68:71], a[40:43], a[148:151]
    ds_read_b128 a[8:11], v8 offset:4096
    v_mfma_f32_16x16x32_bf16 a[156:159], a[68:71], a[44:47], a[156:159]
    buffer_load_dwordx4 v1, s[28:31], s71 offen offset:3072 sc1 lds
    v_mfma_f32_16x16x32_bf16 a[164:167], a[68:71], a[48:51], a[164:167]
    v_mfma_f32_16x16x32_bf16 a[172:175], a[68:71], a[52:55], a[172:175]
    v_mfma_f32_16x16x32_bf16 a[180:183], a[68:71], a[56:59], a[180:183]
    ds_read_b128 a[12:15], v8 offset:6144
    v_mfma_f32_16x16x32_bf16 a[188:191], a[68:71], a[60:63], a[188:191]
    ds_read_b64_tr_b16 a[68:69], v14 offset:0
    v_mfma_f32_16x16x32_bf16 v[52:55], a[32:35], a[72:75], v[52:55]
    ds_read_b64_tr_b16 a[70:71], v14 offset:256
    s_add_u32 m0, s78, 38912
    v_mfma_f32_16x16x32_bf16 v[56:59], a[36:39], a[72:75], v[56:59]
    buffer_load_dwordx4 v1, s[28:31], s72 offen offset:0 sc1 lds
    v_mfma_f32_16x16x32_bf16 v[60:63], a[40:43], a[72:75], v[60:63]
    ds_read_b128 a[16:19], v8 offset:8192
    v_mfma_f32_16x16x32_bf16 v[64:67], a[44:47], a[72:75], v[64:67]
    buffer_load_dwordx4 v1, s[28:31], s73 offen offset:1024 sc1 lds
    v_mfma_f32_16x16x32_bf16 v[68:71], a[48:51], a[72:75], v[68:71]
    v_mfma_f32_16x16x32_bf16 v[72:75], a[52:55], a[72:75], v[72:75]
    v_mfma_f32_16x16x32_bf16 v[76:79], a[56:59], a[72:75], v[76:79]
    ds_read_b128 a[20:23], v8 offset:10240
    v_mfma_f32_16x16x32_bf16 v[80:83], a[60:63], a[72:75], v[80:83]
    ds_read_b64_tr_b16 a[72:73], v12 offset:1024
    v_mfma_f32_16x16x32_bf16 v[88:91], a[32:35], a[76:79], v[88:91]
    ds_read_b64_tr_b16 a[74:75], v12 offset:1280
    v_mfma_f32_16x16x32_bf16 v[92:95], a[36:39], a[76:79], v[92:95]
    buffer_load_dwordx4 v1, s[28:31], s74 offen offset:2048 sc1 lds
    v_mfma_f32_16x16x32_bf16 v[96:99], a[40:43], a[76:79], v[96:99]
    ds_read_b128 a[24:27], v8 offset:12288
    v_mfma_f32_16x16x32_bf16 v[100:103], a[44:47], a[76:79], v[100:103]
    buffer_load_dwordx4 v1, s[28:31], s75 offen offset:3072 sc1 lds
    v_add_u32 v1, 128, v1
    v_mfma_f32_16x16x32_bf16 v[104:107], a[48:51], a[76:79], v[104:107]
    v_mfma_f32_16x16x32_bf16 v[108:111], a[52:55], a[76:79], v[108:111]
    v_mfma_f32_16x16x32_bf16 v[112:115], a[56:59], a[76:79], v[112:115]
    ds_read_b128 a[28:31], v8 offset:14336
    v_mfma_f32_16x16x32_bf16 v[116:119], a[60:63], a[76:79], v[116:119]
    ds_read_b64_tr_b16 a[76:77], v14 offset:1024
    v_mfma_f32_16x16x32_bf16 a[192:195], a[80:83], a[32:35], a[192:195]
    ds_read_b64_tr_b16 a[78:79], v14 offset:1280
    s_add_u32 m0, s78, 43008
    v_mfma_f32_16x16x32_bf16 a[200:203], a[80:83], a[36:39], a[200:203]
    buffer_load_dwordx4 v2, s[28:31], s68 offen offset:0 sc1 lds
    v_mfma_f32_16x16x32_bf16 a[208:211], a[80:83], a[40:43], a[208:211]
    ds_read_b128 a[112:115], v10 offset:0
    v_mfma_f32_16x16x32_bf16 a[216:219], a[80:83], a[44:47], a[216:219]
    buffer_load_dwordx4 v2, s[28:31], s69 offen offset:1024 sc1 lds
    v_mfma_f32_16x16x32_bf16 a[224:227], a[80:83], a[48:51], a[224:227]
    v_mfma_f32_16x16x32_bf16 a[232:235], a[80:83], a[52:55], a[232:235]
    v_mfma_f32_16x16x32_bf16 a[240:243], a[80:83], a[56:59], a[240:243]
    ds_read_b64_tr_b16 a[96:97], v12 offset:4096
    v_mfma_f32_16x16x32_bf16 a[248:251], a[80:83], a[60:63], a[248:251]
    ds_read_b64_tr_b16 a[80:81], v12 offset:2048
    v_mfma_f32_16x16x32_bf16 a[196:199], a[84:87], a[32:35], a[196:199]
    ds_read_b64_tr_b16 a[82:83], v12 offset:2304
    v_mfma_f32_16x16x32_bf16 a[204:207], a[84:87], a[36:39], a[204:207]
    buffer_load_dwordx4 v2, s[28:31], s70 offen offset:2048 sc1 lds
    v_mfma_f32_16x16x32_bf16 a[212:215], a[84:87], a[40:43], a[212:215]
    ds_read_b64_tr_b16 a[98:99], v12 offset:4352
    v_mfma_f32_16x16x32_bf16 a[220:223], a[84:87], a[44:47], a[220:223]
    buffer_load_dwordx4 v2, s[28:31], s71 offen offset:3072 sc1 lds
    v_mfma_f32_16x16x32_bf16 a[228:231], a[84:87], a[48:51], a[228:231]
    v_mfma_f32_16x16x32_bf16 a[236:239], a[84:87], a[52:55], a[236:239]
    v_mfma_f32_16x16x32_bf16 a[244:247], a[84:87], a[56:59], a[244:247]
    ds_read_b64_tr_b16 a[100:101], v14 offset:4096
    v_mfma_f32_16x16x32_bf16 a[252:255], a[84:87], a[60:63], a[252:255]
    ds_read_b64_tr_b16 a[84:85], v14 offset:2048
    v_mfma_f32_16x16x32_bf16 v[128:131], a[88:91], a[32:35], v[128:131]
    ds_read_b64_tr_b16 a[86:87], v14 offset:2304
    s_add_u32 m0, s78, 47104
    v_mfma_f32_16x16x32_bf16 v[144:147], a[88:91], a[36:39], v[144:147]
    buffer_load_dwordx4 v2, s[28:31], s72 offen offset:0 sc1 lds
    v_mfma_f32_16x16x32_bf16 v[160:163], a[88:91], a[40:43], v[160:163]
    ds_read_b64_tr_b16 a[102:103], v14 offset:4352
    v_mfma_f32_16x16x32_bf16 v[176:179], a[88:91], a[44:47], v[176:179]
    buffer_load_dwordx4 v2, s[28:31], s73 offen offset:1024 sc1 lds
    v_mfma_f32_16x16x32_bf16 v[192:195], a[88:91], a[48:51], v[192:195]
    v_mfma_f32_16x16x32_bf16 v[208:211], a[88:91], a[52:55], v[208:211]
    v_mfma_f32_16x16x32_bf16 v[224:227], a[88:91], a[56:59], v[224:227]
    ds_read_b64_tr_b16 a[120:121], v44 offset:0
    v_mfma_f32_16x16x32_bf16 v[240:243], a[88:91], a[60:63], v[240:243]
    ds_read_b64_tr_b16 a[88:89], v12 offset:3072
    v_mfma_f32_16x16x32_bf16 v[132:135], a[92:95], a[32:35], v[132:135]
    ds_read_b64_tr_b16 a[90:91], v12 offset:3328
    v_mfma_f32_16x16x32_bf16 v[148:151], a[92:95], a[36:39], v[148:151]
    buffer_load_dwordx4 v2, s[28:31], s74 offen offset:2048 sc1 lds
    v_mfma_f32_16x16x32_bf16 v[164:167], a[92:95], a[40:43], v[164:167]
    ds_read_b64_tr_b16 a[122:123], v44 offset:256
    v_mfma_f32_16x16x32_bf16 v[180:183], a[92:95], a[44:47], v[180:183]
    buffer_load_dwordx4 v2, s[28:31], s75 offen offset:3072 sc1 lds
    v_add_u32 v2, 128, v2
    v_mfma_f32_16x16x32_bf16 v[196:199], a[92:95], a[48:51], v[196:199]
    v_mfma_f32_16x16x32_bf16 v[212:215], a[92:95], a[52:55], v[212:215]
    v_mfma_f32_16x16x32_bf16 v[228:231], a[92:95], a[56:59], v[228:231]
    v_mfma_f32_16x16x32_bf16 v[244:247], a[92:95], a[60:63], v[244:247]
    ds_read_b64_tr_b16 a[92:93], v14 offset:3072
    v_mfma_f32_16x16x32_bf16 v[136:139], a[104:107], a[32:35], v[136:139]
    ds_read_b64_tr_b16 a[94:95], v14 offset:3328
    v_mfma_f32_16x16x32_bf16 v[152:155], a[104:107], a[36:39], v[152:155]
    v_mfma_f32_16x16x32_bf16 v[168:171], a[104:107], a[40:43], v[168:171]
    v_mfma_f32_16x16x32_bf16 v[184:187], a[104:107], a[44:47], v[184:187]
    v_mfma_f32_16x16x32_bf16 v[200:203], a[104:107], a[48:51], v[200:203]
    v_mfma_f32_16x16x32_bf16 v[216:219], a[104:107], a[52:55], v[216:219]
    v_mfma_f32_16x16x32_bf16 v[232:235], a[104:107], a[56:59], v[232:235]
    v_mfma_f32_16x16x32_bf16 v[248:251], a[104:107], a[60:63], v[248:251]
    v_mfma_f32_16x16x32_bf16 v[140:143], a[108:111], a[32:35], v[140:143]
    v_mfma_f32_16x16x32_bf16 v[156:159], a[108:111], a[36:39], v[156:159]
    v_mfma_f32_16x16x32_bf16 v[172:175], a[108:111], a[40:43], v[172:175]
    v_mfma_f32_16x16x32_bf16 v[188:191], a[108:111], a[44:47], v[188:191]
    v_mfma_f32_16x16x32_bf16 v[204:207], a[108:111], a[48:51], v[204:207]
    v_mfma_f32_16x16x32_bf16 v[220:223], a[108:111], a[52:55], v[220:223]
    v_mfma_f32_16x16x32_bf16 v[236:239], a[108:111], a[56:59], v[236:239]
    v_mfma_f32_16x16x32_bf16 v[252:255], a[108:111], a[60:63], v[252:255]
    s_sub_u32 s67, s67, 1
    s_cmp_lg_u32 s67, 0
    s_cbranch_scc1 L_loop0
L_tail0:
    s_waitcnt lgkmcnt(0)
    s_barrier
    v_mfma_f32_16x16x32_bf16 v[120:123], a[120:123], a[112:115], v[120:123]
    s_getpc_b64 s[86:87]
L_pc0:
    s_sub_u32 s86, s86, L_pc0-L_tail0
    s_subb_u32 s87, s87, 0
    s_lshr_b32 s82, s2, 3
    s_lshl_b32 s82, s82, 2
    s_add_u32 s82, s82, s60
    s_lshl_b32 s82, s82, 10
    v_add_u32 v34, s82, v16
    v_min_u32 v34, L_code_end-L_tail0-4, v34
    global_load_dword v7, v34, s[86:87]
    v_mfma_f32_16x16x32_bf16 a[128:131], a[64:67], a[0:3], a[128:131]
    v_mfma_f32_16x16x32_bf16 a[136:139], a[64:67], a[4:7], a[136:139]
    v_mfma_f32_16x16x32_bf16 a[144:147], a[64:67], a[8:11], a[144:147]
    ds_read_b128 a[32:35], v9 offset:0
    v_mfma_f32_16x16x32_bf16 a[152:155], a[64:67], a[12:15], a[152:155]
    s_mul_i32 s82, s65, 1835008
    s_lshl_b32 s83, s66, 8
    v_mfma_f32_16x16x32_bf16 a[160:163], a[64:67], a[16:19], a[160:163]
    s_add_u32 s82, s82, s83
    s_add_u32 s48, s20, s82
    v_mfma_f32_16x16x32_bf16 a[168:171], a[64:67], a[20:23], a[168:171]
    s_addc_u32 s49, s21, 0
    s_and_b32 s49, s49, 0xffff
    v_mfma_f32_16x16x32_bf16 a[176:179], a[64:67], a[24:27], a[176:179]
    ds_read_b128 a[36:39], v9 offset:2048
    s_sub_u32 s50, 7340032, s82
    s_mov_b32 s51, 0x20000
    v_mfma_f32_16x16x32_bf16 a[184:187], a[64:67], a[28:31], a[184:187]
    ds_read_b64_tr_b16 a[64:65], v12 offset:20480
    s_add_u32 s52, s12, s83
    s_addc_u32 s53, s13, 0
    v_mfma_f32_16x16x32_bf16 a[132:135], a[68:71], a[0:3], a[132:135]
    ds_read_b64_tr_b16 a[66:67], v12 offset:20736
    s_and_b32 s53, s53, 0xffff
    s_sub_u32 s54, 2097152, s83
    v_mfma_f32_16x16x32_bf16 a[140:143], a[68:71], a[4:7], a[140:143]
    s_mov_b32 s55, 0x20000
    s_lshl_b32 s3, s60, 11
    v_mfma_f32_16x16x32_bf16 a[148:151], a[68:71], a[8:11], a[148:151]
    ds_read_b128 a[40:43], v9 offset:4096
    v_lshrrev_b32 v34, 4, v0
    v_and_b32 v35, 15, v0
    v_mfma_f32_16x16x32_bf16 a[156:159], a[68:71], a[12:15], a[156:159]
    v_lshlrev_b32 v36, 1, v34
    v_add_u32 v36, 0, v36
    v_mfma_f32_16x16x32_bf16 a[164:167], a[68:71], a[16:19], a[164:167]
    v_xor_b32 v36, v36, v35
    v_lshlrev_b32 v36, 4, v36
    v_mfma_f32_16x16x32_bf16 a[172:175], a[68:71], a[20:23], a[172:175]
    v_lshl_add_u32 v36, v34, 11, v36
    s_lshl_b32 s82, s60, 14
    v_mfma_f32_16x16x32_bf16 a[180:183], a[68:71], a[24:27], a[180:183]
    ds_read_b128 a[44:47], v9 offset:6144
    s_add_u32 s82, s82, 0
    v_add_u32 v17, s82, v36
    v_mfma_f32_16x16x32_bf16 a[188:191], a[68:71], a[28:31], a[188:191]
    ds_read_b64_tr_b16 a[68:69], v14 offset:20480
    s_lshl_b32 s82, s62, 1
    s_add_u32 s82, s82, 0
    v_mfma_f32_16x16x32_bf16 v[52:55], a[0:3], a[72:75], v[52:55]
    ds_read_b64_tr_b16 a[70:71], v14 offset:20736
    s_lshl_b32 s82, s82, 3
    s_lshl_b32 s83, s61, 2
    v_mfma_f32_16x16x32_bf16 v[56:59], a[4:7], a[72:75], v[56:59]
    s_add_u32 s82, s82, s83
    s_mul_i32 s83, s62, 96
    v_mfma_f32_16x16x32_bf16 v[60:63], a[8:11], a[72:75], v[60:63]
    ds_read_b128 a[48:51], v9 offset:8192
    s_add_u32 s82, s82, s83
    s_lshl_b32 s82, s82, 11
    v_mfma_f32_16x16x32_bf16 v[64:67], a[12:15], a[72:75], v[64:67]
    s_sub_u32 s82, s82, 0
    v_add_u32 v19, s82, v36
    v_mfma_f32_16x16x32_bf16 v[68:71], a[16:19], a[72:75], v[68:71]
    v_lshlrev_b32 v36, 1, v34
    v_add_u32 v36, 8, v36
    v_mfma_f32_16x16x32_bf16 v[72:75], a[20:23], a[72:75], v[72:75]
    v_xor_b32 v36, v36, v35
    v_lshlrev_b32 v36, 4, v36
    v_mfma_f32_16x16x32_bf16 v[76:79], a[24:27], a[72:75], v[76:79]
    ds_read_b128 a[52:55], v9 offset:10240
    v_lshl_add_u32 v36, v34, 11, v36
    s_lshl_b32 s82, s60, 14
    v_mfma_f32_16x16x32_bf16 v[80:83], a[28:31], a[72:75], v[80:83]
    ds_read_b64_tr_b16 a[72:73], v12 offset:21504
    s_add_u32 s82, s82, 7168
    v_add_u32 v18, s82, v36
    v_mfma_f32_16x16x32_bf16 v[88:91], a[0:3], a[76:79], v[88:91]
    ds_read_b64_tr_b16 a[74:75], v12 offset:21760
    s_lshl_b32 s82, s62, 1
    s_add_u32 s82, s82, 1
    v_mfma_f32_16x16x32_bf16 v[92:95], a[4:7], a[76:79], v[92:95]
    s_lshl_b32 s82, s82, 3
    s_lshl_b32 s83, s61, 2
    v_mfma_f32_16x16x32_bf16 v[96:99], a[8:11], a[76:79], v[96:99]
    ds_read_b128 a[56:59], v9 offset:12288
    s_add_u32 s82, s82, s83
    s_mul_i32 s83, s62, 96
    v_mfma_f32_16x16x32_bf16 v[100:103], a[12:15], a[76:79], v[100:103]
    s_add_u32 s82, s82, s83
    s_lshl_b32 s82, s82, 11
    v_mfma_f32_16x16x32_bf16 v[104:107], a[16:19], a[76:79], v[104:107]
    s_sub_u32 s82, s82, 1024
    v_add_u32 v20, s82, v36
    v_mfma_f32_16x16x32_bf16 v[108:111], a[20:23], a[76:79], v[108:111]
    v_mfma_f32_16x16x32_bf16 v[112:115], a[24:27], a[76:79], v[112:115]
    ds_read_b128 a[60:63], v9 offset:14336
    v_mfma_f32_16x16x32_bf16 v[116:119], a[28:31], a[76:79], v[116:119]
    ds_read_b64_tr_b16 a[76:77], v14 offset:21504
    v_mfma_f32_16x16x32_bf16 a[192:195], a[80:83], a[0:3], a[192:195]
    ds_read_b64_tr_b16 a[78:79], v14 offset:21760
    v_mfma_f32_16x16x32_bf16 a[200:203], a[80:83], a[4:7], a[200:203]
    v_mfma_f32_16x16x32_bf16 a[208:211], a[80:83], a[8:11], a[208:211]
    ds_read_b128 a[116:119], v11 offset:0
    v_mfma_f32_16x16x32_bf16 a[216:219], a[80:83], a[12:15], a[216:219]
    v_mfma_f32_16x16x32_bf16 a[224:227], a[80:83], a[16:19], a[224:227]
    v_mfma_f32_16x16x32_bf16 a[232:235], a[80:83], a[20:23], a[232:235]
    v_mfma_f32_16x16x32_bf16 a[240:243], a[80:83], a[24:27], a[240:243]
    ds_read_b64_tr_b16 a[104:105], v12 offset:24576
    v_mfma_f32_16x16x32_bf16 a[248:251], a[80:83], a[28:31], a[248:251]
    ds_read_b64_tr_b16 a[80:81], v12 offset:22528
    v_mfma_f32_16x16x32_bf16 a[196:199], a[84:87], a[0:3], a[196:199]
    ds_read_b64_tr_b16 a[82:83], v12 offset:22784
    v_mfma_f32_16x16x32_bf16 a[204:207], a[84:87], a[4:7], a[204:207]
    v_mfma_f32_16x16x32_bf16 a[212:215], a[84:87], a[8:11], a[212:215]
    ds_read_b64_tr_b16 a[106:107], v12 offset:24832
    v_mfma_f32_16x16x32_bf16 a[220:223], a[84:87], a[12:15], a[220:223]
    s_mov_b32 s81, 294912
    s_add_u32 m0, s3, 73728
    v_mfma_f32_16x16x32_bf16 a[228:231], a[84:87], a[16:19], a[228:231]
    buffer_load_dwordx4 v17, s[48:51], s81 offen lds
    v_mfma_f32_16x16x32_bf16 a[236:239], a[84:87], a[20:23], a[236:239]
    v_mfma_f32_16x16x32_bf16 a[244:247], a[84:87], a[24:27], a[244:247]
    ds_read_b64_tr_b16 a[108:109], v14 offset:24576
    v_mfma_f32_16x16x32_bf16 a[252:255], a[84:87], a[28:31], a[252:255]
    ds_read_b64_tr_b16 a[84:85], v14 offset:22528
    v_mfma_f32_16x16x32_bf16 v[128:131], a[88:91], a[0:3], v[128:131]
    ds_read_b64_tr_b16 a[86:87], v14 offset:22784
    v_mfma_f32_16x16x32_bf16 v[144:147], a[88:91], a[4:7], v[144:147]
    buffer_load_dwordx4 v18, s[48:51], s81 offen offset:1024 lds
    v_mfma_f32_16x16x32_bf16 v[160:163], a[88:91], a[8:11], v[160:163]
    ds_read_b64_tr_b16 a[110:111], v14 offset:24832
    v_mfma_f32_16x16x32_bf16 v[176:179], a[88:91], a[12:15], v[176:179]
    v_mfma_f32_16x16x32_bf16 v[192:195], a[88:91], a[16:19], v[192:195]
    v_mfma_f32_16x16x32_bf16 v[208:211], a[88:91], a[20:23], v[208:211]
    s_mov_b32 s80, 524288
    s_add_u32 m0, s3, 81920
    v_mfma_f32_16x16x32_bf16 v[224:227], a[88:91], a[24:27], v[224:227]
    ds_read_b64_tr_b16 a[124:125], v44 offset:20480
    buffer_load_dwordx4 v17, s[48:51], s80 offen lds
    v_mfma_f32_16x16x32_bf16 v[240:243], a[88:91], a[28:31], v[240:243]
    ds_read_b64_tr_b16 a[88:89], v12 offset:23552
    v_mfma_f32_16x16x32_bf16 v[132:135], a[92:95], a[0:3], v[132:135]
    ds_read_b64_tr_b16 a[90:91], v12 offset:23808
    v_mfma_f32_16x16x32_bf16 v[148:151], a[92:95], a[4:7], v[148:151]
    v_mfma_f32_16x16x32_bf16 v[164:167], a[92:95], a[8:11], v[164:167]
    ds_read_b64_tr_b16 a[126:127], v44 offset:20736
    v_mfma_f32_16x16x32_bf16 v[180:183], a[92:95], a[12:15], v[180:183]
    buffer_load_dwordx4 v18, s[48:51], s80 offen offset:1024 lds
    v_mfma_f32_16x16x32_bf16 v[196:199], a[92:95], a[16:19], v[196:199]
    v_mfma_f32_16x16x32_bf16 v[212:215], a[92:95], a[20:23], v[212:215]
    v_mfma_f32_16x16x32_bf16 v[228:231], a[92:95], a[24:27], v[228:231]
    v_mfma_f32_16x16x32_bf16 v[244:247], a[92:95], a[28:31], v[244:247]
    ds_read_b64_tr_b16 a[92:93], v14 offset:23552
    s_mov_b32 s81, 819200
    s_add_u32 m0, s3, 155648
    v_mfma_f32_16x16x32_bf16 v[136:139], a[96:99], a[0:3], v[136:139]
    ds_read_b64_tr_b16 a[94:95], v14 offset:23808
    buffer_load_dwordx4 v17, s[48:51], s81 offen lds
    v_mfma_f32_16x16x32_bf16 v[152:155], a[96:99], a[4:7], v[152:155]
    v_mfma_f32_16x16x32_bf16 v[168:171], a[96:99], a[8:11], v[168:171]
    v_mfma_f32_16x16x32_bf16 v[184:187], a[96:99], a[12:15], v[184:187]
    v_mfma_f32_16x16x32_bf16 v[200:203], a[96:99], a[16:19], v[200:203]
    v_mfma_f32_16x16x32_bf16 v[216:219], a[96:99], a[20:23], v[216:219]
    buffer_load_dwordx4 v18, s[48:51], s81 offen offset:1024 lds
    v_mfma_f32_16x16x32_bf16 v[232:235], a[96:99], a[24:27], v[232:235]
    v_mfma_f32_16x16x32_bf16 v[248:251], a[96:99], a[28:31], v[248:251]
    v_mfma_f32_16x16x32_bf16 v[140:143], a[100:103], a[0:3], v[140:143]
    v_mfma_f32_16x16x32_bf16 v[156:159], a[100:103], a[4:7], v[156:159]
    v_mfma_f32_16x16x32_bf16 v[172:175], a[100:103], a[8:11], v[172:175]
    v_mfma_f32_16x16x32_bf16 v[188:191], a[100:103], a[12:15], v[188:191]
    v_mfma_f32_16x16x32_bf16 v[204:207], a[100:103], a[16:19], v[204:207]
    v_mfma_f32_16x16x32_bf16 v[220:223], a[100:103], a[20:23], v[220:223]
    v_mfma_f32_16x16x32_bf16 v[236:239], a[100:103], a[24:27], v[236:239]
    v_mfma_f32_16x16x32_bf16 v[252:255], a[100:103], a[28:31], v[252:255]
    s_waitcnt vmcnt(7) lgkmcnt(0)
    s_barrier
    v_mfma_f32_16x16x32_bf16 v[120:123], a[124:127], a[116:119], v[120:123]
    v_mfma_f32_16x16x32_bf16 a[128:131], a[64:67], a[32:35], a[128:131]
    v_mfma_f32_16x16x32_bf16 a[136:139], a[64:67], a[36:39], a[136:139]
    s_mov_b32 s80, 0
    s_add_u32 m0, s3, 0
    v_mfma_f32_16x16x32_bf16 a[144:147], a[64:67], a[40:43], a[144:147]
    ds_read_b128 a[0:3], v8 offset:34816
    buffer_load_dwordx4 v17, s[48:51], s80 offen lds
    v_mfma_f32_16x16x32_bf16 a[152:155], a[64:67], a[44:47], a[152:155]
    s_xor_b32 s82, s65, 0
    v_mfma_f32_16x16x32_bf16 a[160:163], a[64:67], a[48:51], a[160:163]
    s_lshl_b32 s82, s82, 10
    v_mfma_f32_16x16x32_bf16 a[168:171], a[64:67], a[52:55], a[168:171]
    v_add_u32 v21, s82, v16
    v_mfma_f32_16x16x32_bf16 a[176:179], a[64:67], a[56:59], a[176:179]
    ds_read_b128 a[4:7], v8 offset:36864
    s_xor_b32 s82, s65, 1
    v_mfma_f32_16x16x32_bf16 a[184:187], a[64:67], a[60:63], a[184:187]
    ds_read_b64_tr_b16 a[64:65], v13 offset:0
    s_lshl_b32 s82, s82, 10
    v_mfma_f32_16x16x32_bf16 a[132:135], a[68:71], a[32:35], a[132:135]
    ds_read_b64_tr_b16 a[66:67], v13 offset:256
    v_add_u32 v22, s82, v16
    buffer_load_dwordx4 v18, s[48:51], s80 offen offset:1024 lds
    v_mfma_f32_16x16x32_bf16 a[140:143], a[68:71], a[36:39], a[140:143]
    s_xor_b32 s82, s65, 2
    v_mfma_f32_16x16x32_bf16 a[148:151], a[68:71], a[40:43], a[148:151]
    ds_read_b128 a[8:11], v8 offset:38912
    s_lshl_b32 s82, s82, 10
    v_mfma_f32_16x16x32_bf16 a[156:159], a[68:71], a[44:47], a[156:159]
    v_add_u32 v23, s82, v16
    v_mfma_f32_16x16x32_bf16 a[164:167], a[68:71], a[48:51], a[164:167]
    s_xor_b32 s82, s65, 3
    v_mfma_f32_16x16x32_bf16 a[172:175], a[68:71], a[52:55], a[172:175]
    s_lshl_b32 s82, s82, 10
    s_mov_b32 s81, 229376
    s_add_u32 m0, s3, 8192
    v_mfma_f32_16x16x32_bf16 a[180:183], a[68:71], a[56:59], a[180:183]
    ds_read_b128 a[12:15], v8 offset:40960
    v_add_u32 v24, s82, v16
    buffer_load_dwordx4 v17, s[48:51], s81 offen lds
    v_mfma_f32_16x16x32_bf16 a[188:191], a[68:71], a[60:63], a[188:191]
    ds_read_b64_tr_b16 a[68:69], v15 offset:0
    s_mov_b32 s94, 0xbdd2d3e8
    v_mfma_f32_16x16x32_bf16 v[52:55], a[32:35], a[72:75], v[52:55]
    ds_read_b64_tr_b16 a[70:71], v15 offset:256
    s_mov_b32 s95, 0xbdd2d3e8
    v_mfma_f32_16x16x32_bf16 v[56:59], a[36:39], a[72:75], v[56:59]
    v_mov_b32 v26, 0xc0135761
    v_mfma_f32_16x16x32_bf16 v[60:63], a[40:43], a[72:75], v[60:63]
    ds_read_b128 a[16:19], v8 offset:43008
    v_mov_b32 v27, 0xc0135761
    v_mfma_f32_16x16x32_bf16 v[64:67], a[44:47], a[72:75], v[64:67]
    v_mov_b32 v25, 1
    v_mfma_f32_16x16x32_bf16 v[68:71], a[48:51], a[72:75], v[68:71]
    s_lshl_b32 s82, s60, 12
    buffer_load_dwordx4 v18, s[48:51], s81 offen offset:1024 lds
    v_mfma_f32_16x16x32_bf16 v[72:75], a[52:55], a[72:75], v[72:75]
    s_add_u32 s68, s88, s82
    v_mfma_f32_16x16x32_bf16 v[76:79], a[56:59], a[72:75], v[76:79]
    ds_read_b128 a[20:23], v8 offset:45056
    s_lshl_b32 s82, s61, 13
    v_mfma_f32_16x16x32_bf16 v[80:83], a[60:63], a[72:75], v[80:83]
    ds_read_b64_tr_b16 a[72:73], v13 offset:1024
    s_add_u32 s88, s88, s82
    v_mfma_f32_16x16x32_bf16 v[88:91], a[32:35], a[76:79], v[88:91]
    ds_read_b64_tr_b16 a[74:75], v13 offset:1280
    s_lshr_b32 s82, s66, 1
    v_mfma_f32_16x16x32_bf16 v[92:95], a[36:39], a[76:79], v[92:95]
    s_add_u32 s82, s82, 24
    s_mov_b32 s80, 458752
    s_add_u32 m0, s3, 16384
    v_mfma_f32_16x16x32_bf16 v[96:99], a[40:43], a[76:79], v[96:99]
    ds_read_b128 a[24:27], v8 offset:47104
    s_lshl_b32 s82, s82, 14
    buffer_load_dwordx4 v17, s[48:51], s80 offen lds
    v_mfma_f32_16x16x32_bf16 v[100:103], a[44:47], a[76:79], v[100:103]
    s_add_u32 s90, s88, s82
    v_mfma_f32_16x16x32_bf16 v[104:107], a[48:51], a[76:79], v[104:107]
    s_lshl_b32 s82, s66, 14
    v_mfma_f32_16x16x32_bf16 v[108:111], a[52:55], a[76:79], v[108:111]
    s_add_u32 s88, s88, s82
    v_mfma_f32_16x16x32_bf16 v[112:115], a[56:59], a[76:79], v[112:115]
    ds_read_b128 a[28:31], v8 offset:49152
    s_add_u32 s89, s88, 262144
    v_mfma_f32_16x16x32_bf16 v[116:119], a[60:63], a[76:79], v[116:119]
    ds_read_b64_tr_b16 a[76:77], v15 offset:1024
    s_mov_b32 s76, s93
    v_mfma_f32_16x16x32_bf16 a[192:195], a[80:83], a[32:35], a[192:195]
    ds_read_b64_tr_b16 a[78:79], v15 offset:1280
    s_lshl_b32 s82, s63, 4
    buffer_load_dwordx4 v18, s[48:51], s80 offen offset:1024 lds
    v_mfma_f32_16x16x32_bf16 a[200:203], a[80:83], a[36:39], a[200:203]
    s_lshl_b32 s83, s61, 3
    v_mfma_f32_16x16x32_bf16 a[208:211], a[80:83], a[40:43], a[208:211]
    ds_read_b128 a[112:115], v10 offset:34816
    s_add_u32 s83, s83, s82
    v_mfma_f32_16x16x32_bf16 a[216:219], a[80:83], a[44:47], a[216:219]
    s_add_u32 s83, s83, s65
    v_mfma_f32_16x16x32_bf16 a[224:227], a[80:83], a[48:51], a[224:227]
    s_lshl_b32 s83, s83, 15
    v_mfma_f32_16x16x32_bf16 a[232:235], a[80:83], a[52:55], a[232:235]
    s_add_u32 s69, s83, 4194304
    s_mov_b32 s81, 688128
    s_add_u32 m0, s3, 24576
    v_mfma_f32_16x16x32_bf16 a[240:243], a[80:83], a[56:59], a[240:243]
    ds_read_b64_tr_b16 a[96:97], v13 offset:4096
    s_lshl_b32 s84, s63, 3
    buffer_load_dwordx4 v17, s[48:51], s81 offen lds
    v_mfma_f32_16x16x32_bf16 a[248:251], a[80:83], a[60:63], a[248:251]
    ds_read_b64_tr_b16 a[80:81], v13 offset:2048
    s_add_u32 s84, s84, s66
    v_mfma_f32_16x16x32_bf16 a[196:199], a[84:87], a[32:35], a[196:199]
    ds_read_b64_tr_b16 a[82:83], v13 offset:2304
    s_lshl_b32 s85, s84, 2
    v_mfma_f32_16x16x32_bf16 a[204:207], a[84:87], a[36:39], a[204:207]
    s_add_u32 s85, s85, s60
    v_mfma_f32_16x16x32_bf16 a[212:215], a[84:87], a[40:43], a[212:215]
    ds_read_b64_tr_b16 a[98:99], v13 offset:4352
    s_lshl_b32 s85, s85, 8
    v_mfma_f32_16x16x32_bf16 a[220:223], a[84:87], a[44:47], a[220:223]
    s_add_u32 s77, s85, 39862272
    v_mfma_f32_16x16x32_bf16 a[228:231], a[84:87], a[48:51], a[228:231]
    s_lshl_b32 s84, s84, 18
    buffer_load_dwordx4 v18, s[48:51], s81 offen offset:1024 lds
    v_mfma_f32_16x16x32_bf16 a[236:239], a[84:87], a[52:55], a[236:239]
    s_lshl_b32 s85, s60, 12
    v_mfma_f32_16x16x32_bf16 a[244:247], a[84:87], a[56:59], a[244:247]
    ds_read_b64_tr_b16 a[100:101], v15 offset:4096
    s_add_u32 s84, s84, s85
    v_mfma_f32_16x16x32_bf16 a[252:255], a[84:87], a[60:63], a[252:255]
    ds_read_b64_tr_b16 a[84:85], v15 offset:2048
    s_add_u32 s84, s84, 23068672
    v_mfma_f32_16x16x32_bf16 v[128:131], a[88:91], a[32:35], v[128:131]
    ds_read_b64_tr_b16 a[86:87], v15 offset:2304
    s_xor_b32 s85, s65, 1
    v_mfma_f32_16x16x32_bf16 v[144:147], a[88:91], a[36:39], v[144:147]
    s_lshl_b32 s85, s85, 16
    s_mov_b32 s81, 753664
    s_add_u32 m0, s3, 90112
    v_mfma_f32_16x16x32_bf16 v[160:163], a[88:91], a[40:43], v[160:163]
    ds_read_b64_tr_b16 a[102:103], v15 offset:4352
    s_add_u32 s70, s84, s85
    buffer_load_dwordx4 v17, s[48:51], s81 offen lds
    v_mfma_f32_16x16x32_bf16 v[176:179], a[88:91], a[44:47], v[176:179]
    s_add_u32 s70, s70, 16384
    v_mfma_f32_16x16x32_bf16 v[192:195], a[88:91], a[48:51], v[192:195]
    s_lshl_b32 s85, s65, 16
    v_mfma_f32_16x16x32_bf16 v[208:211], a[88:91], a[52:55], v[208:211]
    s_add_u32 s73, s84, s85
    v_mfma_f32_16x16x32_bf16 v[224:227], a[88:91], a[56:59], v[224:227]
    ds_read_b64_tr_b16 a[120:121], v45 offset:0
    s_add_u32 s73, s73, 16384
    v_mfma_f32_16x16x32_bf16 v[240:243], a[88:91], a[60:63], v[240:243]
    ds_read_b64_tr_b16 a[88:89], v13 offset:3072
    s_xor_b32 s85, s65, 2
    v_mfma_f32_16x16x32_bf16 v[132:135], a[92:95], a[32:35], v[132:135]
    ds_read_b64_tr_b16 a[90:91], v13 offset:3328
    s_lshl_b32 s85, s85, 16
    buffer_load_dwordx4 v18, s[48:51], s81 offen offset:1024 lds
    v_mfma_f32_16x16x32_bf16 v[148:151], a[92:95], a[36:39], v[148:151]
    s_add_u32 s71, s84, s85
    v_mfma_f32_16x16x32_bf16 v[164:167], a[92:95], a[40:43], v[164:167]
    ds_read_b64_tr_b16 a[122:123], v45 offset:256
    s_add_u32 s71, s71, 32768
    v_mfma_f32_16x16x32_bf16 v[180:183], a[92:95], a[44:47], v[180:183]
    s_lshl_b32 s85, s65, 16
    v_mfma_f32_16x16x32_bf16 v[196:199], a[92:95], a[48:51], v[196:199]
    s_add_u32 s74, s84, s85
    v_mfma_f32_16x16x32_bf16 v[212:215], a[92:95], a[52:55], v[212:215]
    s_add_u32 s74, s74, 32768
    s_mov_b32 s80, 983040
    s_add_u32 m0, s3, 98304
    v_mfma_f32_16x16x32_bf16 v[228:231], a[92:95], a[56:59], v[228:231]
    s_xor_b32 s85, s65, 3
    buffer_load_dwordx4 v17, s[48:51], s80 offen lds
    v_mfma_f32_16x16x32_bf16 v[244:247], a[92:95], a[60:63], v[244:247]
    ds_read_b64_tr_b16 a[92:93], v15 offset:3072
    s_lshl_b32 s85, s85, 16
    v_mfma_f32_16x16x32_bf16 v[136:139], a[104:107], a[32:35], v[136:139]
    ds_read_b64_tr_b16 a[94:95], v15 offset:3328
    v_mfma_f32_16x16x32_bf16 v[152:155], a[104:107], a[36:39], v[152:155]
    v_mfma_f32_16x16x32_bf16 v[168:171], a[104:107], a[40:43], v[168:171]
    v_mfma_f32_16x16x32_bf16 v[184:187], a[104:107], a[44:47], v[184:187]
    v_mfma_f32_16x16x32_bf16 v[200:203], a[104:107], a[48:51], v[200:203]
    buffer_load_dwordx4 v18, s[48:51], s80 offen offset:1024 lds
    v_mfma_f32_16x16x32_bf16 v[216:219], a[104:107], a[52:55], v[216:219]
    v_mfma_f32_16x16x32_bf16 v[232:235], a[104:107], a[56:59], v[232:235]
    v_mfma_f32_16x16x32_bf16 v[248:251], a[104:107], a[60:63], v[248:251]
    v_mfma_f32_16x16x32_bf16 v[140:143], a[108:111], a[32:35], v[140:143]
    v_mfma_f32_16x16x32_bf16 v[156:159], a[108:111], a[36:39], v[156:159]
    v_mfma_f32_16x16x32_bf16 v[172:175], a[108:111], a[40:43], v[172:175]
    v_mfma_f32_16x16x32_bf16 v[188:191], a[108:111], a[44:47], v[188:191]
    v_mfma_f32_16x16x32_bf16 v[204:207], a[108:111], a[48:51], v[204:207]
    v_mfma_f32_16x16x32_bf16 v[220:223], a[108:111], a[52:55], v[220:223]
    v_mfma_f32_16x16x32_bf16 v[236:239], a[108:111], a[56:59], v[236:239]
    v_mfma_f32_16x16x32_bf16 v[252:255], a[108:111], a[60:63], v[252:255]
    s_waitcnt lgkmcnt(0)
    s_barrier
    v_mfma_f32_16x16x32_bf16 v[120:123], a[120:123], a[112:115], v[120:123]
    v_mfma_f32_16x16x32_bf16 a[128:131], a[64:67], a[0:3], a[128:131]
    v_mfma_f32_16x16x32_bf16 a[136:139], a[64:67], a[4:7], a[136:139]
    s_mov_b32 s81, 1212416
    s_add_u32 m0, s3, 106496
    v_mfma_f32_16x16x32_bf16 a[144:147], a[64:67], a[8:11], a[144:147]
    ds_read_b128 a[32:35], v9 offset:34816
    buffer_load_dwordx4 v17, s[48:51], s81 offen lds
    v_mfma_f32_16x16x32_bf16 a[152:155], a[64:67], a[12:15], a[152:155]
    s_add_u32 s72, s84, s85
    v_mfma_f32_16x16x32_bf16 a[160:163], a[64:67], a[16:19], a[160:163]
    s_add_u32 s72, s72, 49152
    v_mfma_f32_16x16x32_bf16 a[168:171], a[64:67], a[20:23], a[168:171]
    s_lshl_b32 s85, s65, 16
    v_mfma_f32_16x16x32_bf16 a[176:179], a[64:67], a[24:27], a[176:179]
    ds_read_b128 a[36:39], v9 offset:36864
    s_add_u32 s75, s84, s85
    v_mfma_f32_16x16x32_bf16 a[184:187], a[64:67], a[28:31], a[184:187]
    ds_read_b64_tr_b16 a[64:65], v13 offset:20480
    s_add_u32 s75, s75, 49152
    v_mfma_f32_16x16x32_bf16 a[132:135], a[68:71], a[0:3], a[132:135]
    ds_read_b64_tr_b16 a[66:67], v13 offset:20736
    s_lshl_b32 s83, s61, 3
    v_mfma_f32_16x16x32_bf16 a[140:143], a[68:71], a[4:7], a[140:143]
    s_add_u32 s82, s82, s83
    v_mfma_f32_16x16x32_bf16 a[148:151], a[68:71], a[8:11], a[148:151]
    ds_read_b128 a[40:43], v9 offset:38912
    s_lshl_b32 s82, s82, 5
    v_mfma_f32_16x16x32_bf16 a[156:159], a[68:71], a[12:15], a[156:159]
    s_add_u32 s82, s82, s64
    v_mfma_f32_16x16x32_bf16 a[164:167], a[68:71], a[16:19], a[164:167]
    s_lshl_b32 s82, s82, 10
    v_mfma_f32_16x16x32_bf16 a[172:175], a[68:71], a[20:23], a[172:175]
    s_add_u32 s91, s82, 4194304
    v_mfma_f32_16x16x32_bf16 a[180:183], a[68:71], a[24:27], a[180:183]
    ds_read_b128 a[44:47], v9 offset:40960
    v_mov_b32 v42, 1
    buffer_load_dwordx4 v18, s[48:51], s81 offen offset:1024 lds
    v_mfma_f32_16x16x32_bf16 a[188:191], a[68:71], a[28:31], a[188:191]
    ds_read_b64_tr_b16 a[68:69], v15 offset:20480
    v_and_b32 v37, 1, v35
    v_mfma_f32_16x16x32_bf16 v[52:55], a[0:3], a[72:75], v[52:55]
    ds_read_b64_tr_b16 a[70:71], v15 offset:20736
    v_lshl_add_u32 v36, v34, 2, v37
    v_mfma_f32_16x16x32_bf16 v[56:59], a[4:7], a[72:75], v[56:59]
    v_cmp_le_u32 s[4:5], v36, v35
    v_mfma_f32_16x16x32_bf16 v[60:63], a[8:11], a[72:75], v[60:63]
    ds_read_b128 a[48:51], v9 offset:43008
    v_add_u32 v36, 2, v36
    v_mfma_f32_16x16x32_bf16 v[64:67], a[12:15], a[72:75], v[64:67]
    v_cmp_le_u32 s[6:7], v36, v35
    v_mfma_f32_16x16x32_bf16 v[68:71], a[16:19], a[72:75], v[68:71]
    v_mul_u32_u24 v36, 0x0202, v37
    v_mfma_f32_16x16x32_bf16 v[72:75], a[20:23], a[72:75], v[72:75]
    v_lshlrev_b32 v36, 16, v36
    v_mfma_f32_16x16x32_bf16 v[76:79], a[24:27], a[72:75], v[76:79]
    ds_read_b128 a[52:55], v9 offset:45056
    v_add_u32 v36, 0x01000c0c, v36
    v_mfma_f32_16x16x32_bf16 v[80:83], a[28:31], a[72:75], v[80:83]
    ds_read_b64_tr_b16 a[72:73], v13 offset:21504
    v_add_u32 v38, 0x04040000, v36
    v_mfma_f32_16x16x32_bf16 v[88:91], a[0:3], a[76:79], v[88:91]
    ds_read_b64_tr_b16 a[74:75], v13 offset:21760
    v_cndmask_b32 v28, v36, v38, s[4:5]
    v_mfma_f32_16x16x32_bf16 v[92:95], a[4:7], a[76:79], v[92:95]
    v_cndmask_b32 v29, v36, v38, s[6:7]
    s_mov_b32 s80, 1441792
    s_add_u32 m0, s3, 114688
    v_mfma_f32_16x16x32_bf16 v[96:99], a[8:11], a[76:79], v[96:99]
    ds_read_b128 a[56:59], v9 offset:47104
    v_cmp_eq_u32 vcc, 1, v37
    buffer_load_dwordx4 v17, s[48:51], s80 offen lds
    v_mfma_f32_16x16x32_bf16 v[100:103], a[12:15], a[76:79], v[100:103]
    v_mov_b32 v36, 0x0c0c0100
    v_mfma_f32_16x16x32_bf16 v[104:107], a[16:19], a[76:79], v[104:107]
    v_mov_b32 v38, 0x01000c0c
    v_mfma_f32_16x16x32_bf16 v[108:111], a[20:23], a[76:79], v[108:111]
    v_cndmask_b32 v36, v36, v38, vcc
    v_mfma_f32_16x16x32_bf16 v[112:115], a[24:27], a[76:79], v[112:115]
    ds_read_b128 a[60:63], v9 offset:49152
    v_mov_b32 v38, 0x0c0c0302
    v_mfma_f32_16x16x32_bf16 v[116:119], a[28:31], a[76:79], v[116:119]
    ds_read_b64_tr_b16 a[76:77], v15 offset:21504
    v_mov_b32 v39, 0x03020c0c
    v_mfma_f32_16x16x32_bf16 a[192:195], a[80:83], a[0:3], a[192:195]
    ds_read_b64_tr_b16 a[78:79], v15 offset:21760
    v_cndmask_b32 v38, v38, v39, vcc
    v_mfma_f32_16x16x32_bf16 a[200:203], a[80:83], a[4:7], a[200:203]
    v_mov_b32 v39, 0x0c0c0c0c
    v_mfma_f32_16x16x32_bf16 a[208:211], a[80:83], a[8:11], a[208:211]
    ds_read_b128 a[116:119], v11 offset:34816
    v_cndmask_b32 v30, v36, v39, s[4:5]
    v_mfma_f32_16x16x32_bf16 a[216:219], a[80:83], a[12:15], a[216:219]
    v_cndmask_b32 v31, v38, v39, s[6:7]
    v_mfma_f32_16x16x32_bf16 a[224:227], a[80:83], a[16:19], a[224:227]
    v_cndmask_b32 v32, v39, v36, s[4:5]
    v_mfma_f32_16x16x32_bf16 a[232:235], a[80:83], a[20:23], a[232:235]
    v_cndmask_b32 v33, v39, v38, s[6:7]
    v_mfma_f32_16x16x32_bf16 a[240:243], a[80:83], a[24:27], a[240:243]
    ds_read_b64_tr_b16 a[104:105], v13 offset:24576
    s_or_b32 s82, s63, s61
    buffer_load_dwordx4 v18, s[48:51], s80 offen offset:1024 lds
    v_mfma_f32_16x16x32_bf16 a[248:251], a[80:83], a[28:31], a[248:251]
    ds_read_b64_tr_b16 a[80:81], v13 offset:22528
    s_cmp_eq_u32 s82, 0
    s_cselect_b64 s[4:5], s[4:5], -1
    s_cselect_b64 s[6:7], s[6:7], -1
    v_mfma_f32_16x16x32_bf16 a[196:199], a[84:87], a[0:3], a[196:199]
    ds_read_b64_tr_b16 a[82:83], v13 offset:22784
    s_mov_b32 s14, 0x3e3504f3
    v_mfma_f32_16x16x32_bf16 a[204:207], a[84:87], a[4:7], a[204:207]
    s_mov_b32 s15, 0x3e3504f3
    s_branch L_over1
L_stub1:
    s_branch L_stub3
L_over1:
    v_mfma_f32_16x16x32_bf16 a[212:215], a[84:87], a[8:11], a[212:215]
    ds_read_b64_tr_b16 a[106:107], v13 offset:24832
    s_mov_b32 s98, 0x3fb8aa3b
    v_mfma_f32_16x16x32_bf16 a[220:223], a[84:87], a[12:15], a[220:223]
    s_mov_b32 s99, 0x3fb8aa3b
    v_mfma_f32_16x16x32_bf16 a[228:231], a[84:87], a[16:19], a[228:231]
    s_lshl_b32 s82, s63, 2
    v_mfma_f32_16x16x32_bf16 a[236:239], a[84:87], a[20:23], a[236:239]
    s_add_u32 s82, s82, s60
    v_mfma_f32_16x16x32_bf16 a[244:247], a[84:87], a[24:27], a[244:247]
    ds_read_b64_tr_b16 a[108:109], v15 offset:24576
    s_lshl_b32 s82, s82, 2
    v_mfma_f32_16x16x32_bf16 a[252:255], a[84:87], a[28:31], a[252:255]
    ds_read_b64_tr_b16 a[84:85], v15 offset:22528
    s_add_u32 s82, s82, s65
    v_mfma_f32_16x16x32_bf16 v[128:131], a[88:91], a[0:3], v[128:131]
    ds_read_b64_tr_b16 a[86:87], v15 offset:22784
    s_lshl_b32 s82, s82, 15
    v_mfma_f32_16x16x32_bf16 v[144:147], a[88:91], a[4:7], v[144:147]
    s_lshl_b32 s83, s66, 8
    s_mov_b32 s81, 1671168
    s_add_u32 m0, s3, 122880
    v_mfma_f32_16x16x32_bf16 v[160:163], a[88:91], a[8:11], v[160:163]
    ds_read_b64_tr_b16 a[110:111], v15 offset:24832
    s_add_u32 s82, s82, s83
    buffer_load_dwordx4 v17, s[48:51], s81 offen lds
    v_mfma_f32_16x16x32_bf16 v[176:179], a[88:91], a[12:15], v[176:179]
    v_and_b32 v34, 15, v0
    v_mfma_f32_16x16x32_bf16 v[192:195], a[88:91], a[16:19], v[192:195]
    v_lshrrev_b32 v35, 4, v0
    v_mfma_f32_16x16x32_bf16 v[208:211], a[88:91], a[20:23], v[208:211]
    v_lshlrev_b32 v36, 11, v34
    v_mfma_f32_16x16x32_bf16 v[224:227], a[88:91], a[24:27], v[224:227]
    ds_read_b64_tr_b16 a[124:125], v45 offset:20480
    v_add_u32 v36, s82, v36
    v_mfma_f32_16x16x32_bf16 v[240:243], a[88:91], a[28:31], v[240:243]
    ds_read_b64_tr_b16 a[88:89], v13 offset:23552
    v_and_b32 v2, 1, v35
    v_mfma_f32_16x16x32_bf16 v[132:135], a[92:95], a[0:3], v[132:135]
    ds_read_b64_tr_b16 a[90:91], v13 offset:23808
    v_lshl_add_u32 v36, v2, 5, v36
    v_mfma_f32_16x16x32_bf16 v[148:151], a[92:95], a[4:7], v[148:151]
    v_lshrrev_b32 v2, 1, v35
    v_mfma_f32_16x16x32_bf16 v[164:167], a[92:95], a[8:11], v[164:167]
    ds_read_b64_tr_b16 a[126:127], v45 offset:20736
    v_lshl_add_u32 v2, v2, 4, v36
    v_mfma_f32_16x16x32_bf16 v[180:183], a[92:95], a[12:15], v[180:183]
    v_lshrrev_b32 v36, 3, v34
    v_mfma_f32_16x16x32_bf16 v[196:199], a[92:95], a[16:19], v[196:199]
    v_mul_u32_u24 v36, 16320, v36
    v_mfma_f32_16x16x32_bf16 v[212:215], a[92:95], a[20:23], v[212:215]
    v_sub_u32 v1, v2, v36
    v_mfma_f32_16x16x32_bf16 v[228:231], a[92:95], a[24:27], v[228:231]
    v_xor_b32 v5, 64, v1
    buffer_load_dwordx4 v18, s[48:51], s81 offen offset:1024 lds
    v_mfma_f32_16x16x32_bf16 v[244:247], a[92:95], a[28:31], v[244:247]
    ds_read_b64_tr_b16 a[92:93], v15 offset:23552
    v_add_u32 v5, 16384, v5
    v_mfma_f32_16x16x32_bf16 v[136:139], a[96:99], a[0:3], v[136:139]
    ds_read_b64_tr_b16 a[94:95], v15 offset:23808
    v_mfma_f32_16x16x32_bf16 v[152:155], a[96:99], a[4:7], v[152:155]
    v_mfma_f32_16x16x32_bf16 v[168:171], a[96:99], a[8:11], v[168:171]
    v_mfma_f32_16x16x32_bf16 v[184:187], a[96:99], a[12:15], v[184:187]
    v_mfma_f32_16x16x32_bf16 v[200:203], a[96:99], a[16:19], v[200:203]
    v_mfma_f32_16x16x32_bf16 v[216:219], a[96:99], a[20:23], v[216:219]
    v_mfma_f32_16x16x32_bf16 v[232:235], a[96:99], a[24:27], v[232:235]
    v_mfma_f32_16x16x32_bf16 v[248:251], a[96:99], a[28:31], v[248:251]
    v_mfma_f32_16x16x32_bf16 v[140:143], a[100:103], a[0:3], v[140:143]
    v_mfma_f32_16x16x32_bf16 v[156:159], a[100:103], a[4:7], v[156:159]
    v_mfma_f32_16x16x32_bf16 v[172:175], a[100:103], a[8:11], v[172:175]
    v_mfma_f32_16x16x32_bf16 v[188:191], a[100:103], a[12:15], v[188:191]
    v_mfma_f32_16x16x32_bf16 v[204:207], a[100:103], a[16:19], v[204:207]
    v_mfma_f32_16x16x32_bf16 v[220:223], a[100:103], a[20:23], v[220:223]
    v_mfma_f32_16x16x32_bf16 v[236:239], a[100:103], a[24:27], v[236:239]
    v_mfma_f32_16x16x32_bf16 v[252:255], a[100:103], a[28:31], v[252:255]
    s_waitcnt lgkmcnt(0)
    s_barrier
    v_mfma_f32_16x16x32_bf16 v[120:123], a[124:127], a[116:119], v[120:123]
    s_lshl_b32 s82, s62, 3
    s_add_u32 s82, s82, s61
    v_mfma_f32_16x16x32_bf16 a[128:131], a[64:67], a[32:35], a[128:131]
    s_lshl_b32 s82, s82, 10
    s_add_u32 s82, s82, 139264
    v_mfma_f32_16x16x32_bf16 a[136:139], a[64:67], a[36:39], a[136:139]
    s_mov_b32 s80, 917504
    s_add_u32 m0, s3, 32768
    v_add_u32 v44, s82, v16
    s_lshl_b32 s82, s61, 12
    v_mfma_f32_16x16x32_bf16 a[144:147], a[64:67], a[40:43], a[144:147]
    buffer_load_dwordx4 v17, s[48:51], s80 offen lds
    s_add_u32 s82, s82, 139264
    v_add_u32 v45, s82, v16
    v_mfma_f32_16x16x32_bf16 a[152:155], a[64:67], a[44:47], a[152:155]
    v_lshrrev_b32 v34, 2, v0
    v_mfma_f32_16x16x32_bf16 a[160:163], a[64:67], a[48:51], a[160:163]
    ds_write_b128 v44, v[120:123]
    v_and_b32 v35, 3, v0
    v_mfma_f32_16x16x32_bf16 a[168:171], a[64:67], a[52:55], a[168:171]
    v_lshlrev_b32 v35, 3, v35
    v_mfma_f32_16x16x32_bf16 a[176:179], a[64:67], a[56:59], a[176:179]
    v_lshl_add_u32 v35, v34, 8, v35
    v_mfma_f32_16x16x32_bf16 a[184:187], a[64:67], a[60:63], a[184:187]
    v_and_b32 v34, 7, v34
    v_mfma_f32_16x16x32_bf16 a[132:135], a[68:71], a[32:35], a[132:135]
    buffer_load_dwordx4 v18, s[48:51], s80 offen offset:1024 lds
    v_xor_b32 v36, 0, v34
    v_mfma_f32_16x16x32_bf16 a[140:143], a[68:71], a[36:39], a[140:143]
    v_lshl_add_u32 v8, v36, 5, v35
    v_mfma_f32_16x16x32_bf16 a[148:151], a[68:71], a[40:43], a[148:151]
    v_xor_b32 v36, 1, v34
    v_mfma_f32_16x16x32_bf16 a[156:159], a[68:71], a[44:47], a[156:159]
    v_lshl_add_u32 v9, v36, 5, v35
    v_mfma_f32_16x16x32_bf16 a[164:167], a[68:71], a[48:51], a[164:167]
    v_xor_b32 v36, 2, v34
    v_mfma_f32_16x16x32_bf16 a[172:175], a[68:71], a[52:55], a[172:175]
    s_mov_b32 s81, 1146880
    s_add_u32 m0, s3, 40960
    v_lshl_add_u32 v10, v36, 5, v35
    v_mfma_f32_16x16x32_bf16 a[180:183], a[68:71], a[56:59], a[180:183]
    buffer_load_dwordx4 v17, s[48:51], s81 offen lds
    v_xor_b32 v36, 3, v34
    v_mfma_f32_16x16x32_bf16 a[188:191], a[68:71], a[60:63], a[188:191]
    v_lshl_add_u32 v11, v36, 5, v35
    v_mfma_f32_16x16x32_bf16 v[52:55], a[32:35], a[72:75], v[52:55]
    v_xor_b32 v36, 4, v34
    v_mfma_f32_16x16x32_bf16 v[56:59], a[36:39], a[72:75], v[56:59]
    v_lshl_add_u32 v12, v36, 5, v35
    v_mfma_f32_16x16x32_bf16 v[60:63], a[40:43], a[72:75], v[60:63]
    v_xor_b32 v36, 5, v34
    v_mfma_f32_16x16x32_bf16 v[64:67], a[44:47], a[72:75], v[64:67]
    v_lshl_add_u32 v13, v36, 5, v35
    v_mfma_f32_16x16x32_bf16 v[68:71], a[48:51], a[72:75], v[68:71]
    buffer_load_dwordx4 v18, s[48:51], s81 offen offset:1024 lds
    v_xor_b32 v36, 6, v34
    v_mfma_f32_16x16x32_bf16 v[72:75], a[52:55], a[72:75], v[72:75]
    v_lshl_add_u32 v14, v36, 5, v35
    v_mfma_f32_16x16x32_bf16 v[76:79], a[56:59], a[72:75], v[76:79]
    v_xor_b32 v36, 7, v34
    v_mfma_f32_16x16x32_bf16 v[80:83], a[60:63], a[72:75], v[80:83]
    v_lshl_add_u32 v15, v36, 5, v35
    v_mfma_f32_16x16x32_bf16 v[88:91], a[32:35], a[76:79], v[88:91]
    v_mfma_f32_16x16x32_bf16 v[92:95], a[36:39], a[76:79], v[92:95]
    s_mov_b32 s80, 1376256
    s_add_u32 m0, s3, 49152
    v_mfma_f32_16x16x32_bf16 v[96:99], a[40:43], a[76:79], v[96:99]
    buffer_load_dwordx4 v17, s[48:51], s80 offen lds
    v_mfma_f32_16x16x32_bf16 v[100:103], a[44:47], a[76:79], v[100:103]
    v_mfma_f32_16x16x32_bf16 v[104:107], a[48:51], a[76:79], v[104:107]
    v_mfma_f32_16x16x32_bf16 v[108:111], a[52:55], a[76:79], v[108:111]
    v_mfma_f32_16x16x32_bf16 v[112:115], a[56:59], a[76:79], v[112:115]
    v_mfma_f32_16x16x32_bf16 v[116:119], a[60:63], a[76:79], v[116:119]
    v_mfma_f32_16x16x32_bf16 a[192:195], a[80:83], a[32:35], a[192:195]
    buffer_load_dwordx4 v18, s[48:51], s80 offen offset:1024 lds
    v_mfma_f32_16x16x32_bf16 a[200:203], a[80:83], a[36:39], a[200:203]
    v_mfma_f32_16x16x32_bf16 a[208:211], a[80:83], a[40:43], a[208:211]
    v_mfma_f32_16x16x32_bf16 a[216:219], a[80:83], a[44:47], a[216:219]
    v_mfma_f32_16x16x32_bf16 a[224:227], a[80:83], a[48:51], a[224:227]
    v_mfma_f32_16x16x32_bf16 a[232:235], a[80:83], a[52:55], a[232:235]
    s_mov_b32 s81, 1605632
    s_add_u32 m0, s3, 57344
    v_mfma_f32_16x16x32_bf16 a[240:243], a[80:83], a[56:59], a[240:243]
    buffer_load_dwordx4 v17, s[48:51], s81 offen lds
    v_mfma_f32_16x16x32_bf16 a[248:251], a[80:83], a[60:63], a[248:251]
    s_cmp_lg_u32 s60, 0
    s_cbranch_scc1 L_noxw
    ds_write_b128 v45, a[184:187] offset:4096
    ds_write_b128 v45, a[188:191] offset:5120
    ds_write_b128 v45, v[80:83] offset:12288
    ds_write_b128 v45, v[116:119] offset:13312
L_noxw:
    v_mfma_f32_16x16x32_bf16 a[196:199], a[84:87], a[32:35], a[196:199]
    v_mfma_f32_16x16x32_bf16 a[204:207], a[84:87], a[36:39], a[204:207]
    v_mfma_f32_16x16x32_bf16 a[212:215], a[84:87], a[40:43], a[212:215]
    v_mfma_f32_16x16x32_bf16 a[220:223], a[84:87], a[44:47], a[220:223]
    v_mfma_f32_16x16x32_bf16 a[228:231], a[84:87], a[48:51], a[228:231]
    buffer_load_dwordx4 v18, s[48:51], s81 offen offset:1024 lds
    v_mfma_f32_16x16x32_bf16 a[236:239], a[84:87], a[52:55], a[236:239]
    v_mfma_f32_16x16x32_bf16 a[244:247], a[84:87], a[56:59], a[244:247]
    v_mfma_f32_16x16x32_bf16 a[252:255], a[84:87], a[60:63], a[252:255]
    v_mfma_f32_16x16x32_bf16 v[128:131], a[88:91], a[32:35], v[128:131]
    v_mfma_f32_16x16x32_bf16 v[144:147], a[88:91], a[36:39], v[144:147]
    s_mov_b32 s80, 65536
    s_add_u32 m0, s3, 65536
    v_mfma_f32_16x16x32_bf16 v[160:163], a[88:91], a[40:43], v[160:163]
    buffer_load_dwordx4 v17, s[48:51], s80 offen lds
    v_mfma_f32_16x16x32_bf16 v[176:179], a[88:91], a[44:47], v[176:179]
    v_mfma_f32_16x16x32_bf16 v[192:195], a[88:91], a[48:51], v[192:195]
    v_mfma_f32_16x16x32_bf16 v[208:211], a[88:91], a[52:55], v[208:211]
    v_mfma_f32_16x16x32_bf16 v[224:227], a[88:91], a[56:59], v[224:227]
    v_mfma_f32_16x16x32_bf16 v[240:243], a[88:91], a[60:63], v[240:243]
    v_mfma_f32_16x16x32_bf16 v[132:135], a[92:95], a[32:35], v[132:135]
    buffer_load_dwordx4 v18, s[48:51], s80 offen offset:1024 lds
    v_mfma_f32_16x16x32_bf16 v[148:151], a[92:95], a[36:39], v[148:151]
    v_mfma_f32_16x16x32_bf16 v[164:167], a[92:95], a[40:43], v[164:167]
    v_mfma_f32_16x16x32_bf16 v[180:183], a[92:95], a[44:47], v[180:183]
    v_mfma_f32_16x16x32_bf16 v[196:199], a[92:95], a[48:51], v[196:199]
    v_mfma_f32_16x16x32_bf16 v[212:215], a[92:95], a[52:55], v[212:215]
    s_mov_b32 s80, 131072
    s_add_u32 m0, s3, 131072
    v_mfma_f32_16x16x32_bf16 v[228:231], a[92:95], a[56:59], v[228:231]
    buffer_load_dwordx4 v17, s[48:51], s80 offen lds
    v_mfma_f32_16x16x32_bf16 v[244:247], a[92:95], a[60:63], v[244:247]
    v_mfma_f32_16x16x32_bf16 v[136:139], a[104:107], a[32:35], v[136:139]
    v_mfma_f32_16x16x32_bf16 v[152:155], a[104:107], a[36:39], v[152:155]
    v_mfma_f32_16x16x32_bf16 v[168:171], a[104:107], a[40:43], v[168:171]
    v_mfma_f32_16x16x32_bf16 v[184:187], a[104:107], a[44:47], v[184:187]
    v_mfma_f32_16x16x32_bf16 v[200:203], a[104:107], a[48:51], v[200:203]
    buffer_load_dwordx4 v18, s[48:51], s80 offen offset:1024 lds
    v_mfma_f32_16x16x32_bf16 v[216:219], a[104:107], a[52:55], v[216:219]
    v_mfma_f32_16x16x32_bf16 v[232:235], a[104:107], a[56:59], v[232:235]
    v_mfma_f32_16x16x32_bf16 v[248:251], a[104:107], a[60:63], v[248:251]
    v_mfma_f32_16x16x32_bf16 v[140:143], a[108:111], a[32:35], v[140:143]
    v_mfma_f32_16x16x32_bf16 v[156:159], a[108:111], a[36:39], v[156:159]
    v_mfma_f32_16x16x32_bf16 v[172:175], a[108:111], a[40:43], v[172:175]
    v_mfma_f32_16x16x32_bf16 v[188:191], a[108:111], a[44:47], v[188:191]
    v_mfma_f32_16x16x32_bf16 v[204:207], a[108:111], a[48:51], v[204:207]
    v_mfma_f32_16x16x32_bf16 v[220:223], a[108:111], a[52:55], v[220:223]
    v_mfma_f32_16x16x32_bf16 v[236:239], a[108:111], a[56:59], v[236:239]
    v_mfma_f32_16x16x32_bf16 v[252:255], a[108:111], a[60:63], v[252:255]
    s_waitcnt lgkmcnt(0)
    s_barrier
    ds_read_b128 v[120:123], v45 offset:0
    ds_read_b128 v[124:127], v45 offset:1024
    ds_read_b128 v[48:51], v45 offset:8192
    ds_read_b128 v[84:87], v45 offset:9216
    s_branch L_epi
L_stub2:
    s_branch L_stub4
L_g1_1:
    s_mov_b32 m0, s14
    s_mov_b32 s77, 4096
    buffer_load_dwordx4 v1, s[28:31], s77 offen sc1 lds
    s_mov_b32 s77, 19456
    buffer_load_dwordx4 v1, s[28:31], s77 offen offset:1024 sc1 lds
    v_add_u32 v1, 128, v1
    s_mov_b32 m0, s15
    s_mov_b32 s77, 4096
    buffer_load_dwordx4 v1, s[28:31], s77 offen sc1 lds
    s_mov_b32 s77, 19456
    buffer_load_dwordx4 v1, s[28:31], s77 offen offset:1024 sc1 lds
    v_add_u32 v1, 128, v1
    s_barrier
    s_add_u32 m0, s78, 40960
    s_nop 0
    buffer_load_dwordx4 v2, s[32:35], s68 offen offset:0 lds
    buffer_load_dwordx4 v2, s[32:35], s69 offen offset:1024 lds
    buffer_load_dwordx4 v2, s[32:35], s70 offen offset:2048 lds
    v_add_u32 v2, 196608, v2
    buffer_load_dwordx4 v3, s[36:39], s71 offen offset:3072 lds
    s_add_u32 m0, s78, 45056
    s_nop 0
    buffer_load_dwordx4 v3, s[40:43], s72 offen offset:0 lds
    buffer_load_dwordx4 v3, s[36:39], s73 offen offset:1024 lds
    buffer_load_dwordx4 v3, s[40:43], s74 offen offset:2048 lds
    buffer_load_dwordx4 v3, s[36:39], s75 offen offset:3072 lds
    s_add_u32 m0, s78, 49152
    s_nop 0
    buffer_load_dwordx4 v3, s[40:43], s76 offen offset:0 lds
    v_add_u32 v3, 229376, v3
    global_load_lds_dwordx4 v[4:5], off offset:1024
    v_lshl_add_u64 v[4:5], v[4:5], 0, s[80:81]
    s_waitcnt vmcnt(12)
    s_barrier
    ds_read_b64_tr_b16 a[64:65], v12 offset:0
    ds_read_b64_tr_b16 a[66:67], v12 offset:256
    ds_read_b64_tr_b16 a[68:69], v14 offset:0
    ds_read_b64_tr_b16 a[70:71], v14 offset:256
    ds_read_b64_tr_b16 a[72:73], v12 offset:1024
    ds_read_b64_tr_b16 a[74:75], v12 offset:1280
    ds_read_b64_tr_b16 a[76:77], v14 offset:1024
    ds_read_b64_tr_b16 a[78:79], v14 offset:1280
    ds_read_b64_tr_b16 a[80:81], v12 offset:2048
    ds_read_b64_tr_b16 a[82:83], v12 offset:2304
    ds_read_b64_tr_b16 a[84:85], v14 offset:2048
    ds_read_b64_tr_b16 a[86:87], v14 offset:2304
    ds_read_b64_tr_b16 a[88:89], v12 offset:3072
    ds_read_b64_tr_b16 a[90:91], v12 offset:3328
    ds_read_b64_tr_b16 a[92:93], v14 offset:3072
    ds_read_b64_tr_b16 a[94:95], v14 offset:3328
    ds_read_b64_tr_b16 a[96:97], v12 offset:4096
    ds_read_b64_tr_b16 a[98:99], v12 offset:4352
    ds_read_b64_tr_b16 a[100:101], v14 offset:4096
    ds_read_b64_tr_b16 a[102:103], v14 offset:4352
    ds_read_b128 a[0:3], v8 offset:0
    ds_read_b128 a[4:7], v8 offset:2048
    ds_read_b128 a[8:11], v8 offset:4096
    ds_read_b128 a[12:15], v8 offset:6144
    ds_read_b128 a[16:19], v8 offset:8192
    ds_read_b128 a[20:23], v8 offset:10240
    ds_read_b128 a[24:27], v8 offset:12288
    ds_read_b128 a[28:31], v8 offset:14336
    ds_read_b128 a[112:115], v10 offset:0
    ds_read_b64_tr_b16 a[120:121], v44 offset:0
    ds_read_b64_tr_b16 a[122:123], v44 offset:256
    s_add_u32 m0, s78, 61440
    s_nop 0
    buffer_load_dwordx4 v2, s[32:35], s68 offen offset:0 lds
    buffer_load_dwordx4 v2, s[32:35], s69 offen offset:1024 lds
    buffer_load_dwordx4 v2, s[32:35], s70 offen offset:2048 lds
    v_add_u32 v2, 196608, v2
    buffer_load_dwordx4 v3, s[36:39], s71 offen offset:3072 lds
    s_add_u32 m0, s78, 65536
    s_nop 0
    buffer_load_dwordx4 v3, s[40:43], s72 offen offset:0 lds
    buffer_load_dwordx4 v3, s[36:39], s73 offen offset:1024 lds
    buffer_load_dwordx4 v3, s[40:43], s74 offen offset:2048 lds
    buffer_load_dwordx4 v3, s[36:39], s75 offen offset:3072 lds
    s_add_u32 m0, s78, 69632
    s_nop 0
    buffer_load_dwordx4 v3, s[40:43], s76 offen offset:0 lds
    v_add_u32 v3, 229376, v3
    global_load_lds_dwordx4 v[4:5], off offset:1024
    v_lshl_add_u64 v[4:5], v[4:5], 0, s[80:81]
    s_mov_b32 s67, 7
    v_mov_b32 v20, 0x7ff00000
.p2align 3
L_loop1:
    s_waitcnt vmcnt(24) lgkmcnt(0)
    s_barrier
    v_mfma_f32_16x16x32_bf16 v[120:123], a[112:115], a[120:123], v[120:123]
    s_add_u32 m0, s78, 0
    buffer_load_dword v7, v6, s[44:47], s4 offen
    v_add_u32_e64 v6, s79, v6
    v_mfma_f32_16x16x32_bf16 v[128:131], a[64:67], a[0:3], v[128:131]
    buffer_load_dwordx4 v2, s[32:35], s68 offen offset:0 lds
    buffer_load_dword v7, v33, s[48:51], 0 offen
    v_add_u32_e64 v33, s52, v33
    v_mfma_f32_16x16x32_bf16 v[144:147], a[64:67], a[4:7], v[144:147]
    v_mfma_f32_16x16x32_bf16 v[160:163], a[64:67], a[8:11], v[160:163]
    ds_read_b128 a[32:35], v9 offset:0
    v_mfma_f32_16x16x32_bf16 v[176:179], a[64:67], a[12:15], v[176:179]
    v_mfma_f32_16x16x32_bf16 v[192:195], a[64:67], a[16:19], v[192:195]
    v_mfma_f32_16x16x32_bf16 v[208:211], a[64:67], a[20:23], v[208:211]
    v_mfma_f32_16x16x32_bf16 v[224:227], a[64:67], a[24:27], v[224:227]
    ds_read_b128 a[36:39], v9 offset:2048
    v_mfma_f32_16x16x32_bf16 v[240:243], a[64:67], a[28:31], v[240:243]
    ds_read_b64_tr_b16 a[64:65], v12 offset:20480
    v_mfma_f32_16x16x32_bf16 v[132:135], a[68:71], a[0:3], v[132:135]
    ds_read_b64_tr_b16 a[66:67], v12 offset:20736
    v_mfma_f32_16x16x32_bf16 v[148:151], a[68:71], a[4:7], v[148:151]
    buffer_load_dwordx4 v2, s[32:35], s69 offen offset:1024 lds
    v_mfma_f32_16x16x32_bf16 v[164:167], a[68:71], a[8:11], v[164:167]
    ds_read_b128 a[40:43], v9 offset:4096
    v_mfma_f32_16x16x32_bf16 v[180:183], a[68:71], a[12:15], v[180:183]
    v_mfma_f32_16x16x32_bf16 v[196:199], a[68:71], a[16:19], v[196:199]
    buffer_load_dwordx4 v2, s[32:35], s70 offen offset:2048 lds
    v_add_u32 v2, 196608, v2
    v_mfma_f32_16x16x32_bf16 v[212:215], a[68:71], a[20:23], v[212:215]
    v_mfma_f32_16x16x32_bf16 v[228:231], a[68:71], a[24:27], v[228:231]
    ds_read_b128 a[44:47], v9 offset:6144
    v_mfma_f32_16x16x32_bf16 v[244:247], a[68:71], a[28:31], v[244:247]
    ds_read_b64_tr_b16 a[68:69], v14 offset:20480
    v_mfma_f32_16x16x32_bf16 v[136:139], a[72:75], a[0:3], v[136:139]
    ds_read_b64_tr_b16 a[70:71], v14 offset:20736
    v_mfma_f32_16x16x32_bf16 v[152:155], a[72:75], a[4:7], v[152:155]
    v_mfma_f32_16x16x32_bf16 v[168:171], a[72:75], a[8:11], v[168:171]
    ds_read_b128 a[48:51], v9 offset:8192
    v_mfma_f32_16x16x32_bf16 v[184:187], a[72:75], a[12:15], v[184:187]
    buffer_load_dwordx4 v3, s[36:39], s71 offen offset:3072 lds
    v_mfma_f32_16x16x32_bf16 v[200:203], a[72:75], a[16:19], v[200:203]
    v_mfma_f32_16x16x32_bf16 v[216:219], a[72:75], a[20:23], v[216:219]
    v_mfma_f32_16x16x32_bf16 v[232:235], a[72:75], a[24:27], v[232:235]
    ds_read_b128 a[52:55], v9 offset:10240
    v_mfma_f32_16x16x32_bf16 v[248:251], a[72:75], a[28:31], v[248:251]
    ds_read_b64_tr_b16 a[72:73], v12 offset:21504
    v_mfma_f32_16x16x32_bf16 v[140:143], a[76:79], a[0:3], v[140:143]
    ds_read_b64_tr_b16 a[74:75], v12 offset:21760
    s_add_u32 m0, s78, 4096
    v_mfma_f32_16x16x32_bf16 v[156:159], a[76:79], a[4:7], v[156:159]
    buffer_load_dwordx4 v3, s[40:43], s72 offen offset:0 lds
    v_mfma_f32_16x16x32_bf16 v[172:175], a[76:79], a[8:11], v[172:175]
    ds_read_b128 a[56:59], v9 offset:12288
    v_mfma_f32_16x16x32_bf16 v[188:191], a[76:79], a[12:15], v[188:191]
    v_mfma_f32_16x16x32_bf16 v[204:207], a[76:79], a[16:19], v[204:207]
    v_mfma_f32_16x16x32_bf16 v[220:223], a[76:79], a[20:23], v[220:223]
    v_mfma_f32_16x16x32_bf16 v[236:239], a[76:79], a[24:27], v[236:239]
    ds_read_b128 a[60:63], v9 offset:14336
    v_mfma_f32_16x16x32_bf16 v[252:255], a[76:79], a[28:31], v[252:255]
    ds_read_b64_tr_b16 a[76:77], v14 offset:21504
    v_mfma_f32_16x16x32_bf16 a[128:131], a[80:83], a[0:3], a[128:131]
    ds_read_b64_tr_b16 a[78:79], v14 offset:21760
    v_mfma_f32_16x16x32_bf16 a[144:147], a[80:83], a[4:7], a[144:147]
    buffer_load_dwordx4 v3, s[36:39], s73 offen offset:1024 lds
    v_mfma_f32_16x16x32_bf16 a[160:163], a[80:83], a[8:11], a[160:163]
    ds_read_b128 a[116:119], v11 offset:0
    v_mfma_f32_16x16x32_bf16 a[176:179], a[80:83], a[12:15], a[176:179]
    v_mfma_f32_16x16x32_bf16 a[192:195], a[80:83], a[16:19], a[192:195]
    v_mfma_f32_16x16x32_bf16 a[208:211], a[80:83], a[20:23], a[208:211]
    buffer_load_dwordx4 v3, s[40:43], s74 offen offset:2048 lds
    v_mfma_f32_16x16x32_bf16 a[224:227], a[80:83], a[24:27], a[224:227]
    ds_read_b64_tr_b16 a[104:105], v12 offset:24576
    v_mfma_f32_16x16x32_bf16 a[240:243], a[80:83], a[28:31], a[240:243]
    ds_read_b64_tr_b16 a[80:81], v12 offset:22528
    v_mfma_f32_16x16x32_bf16 a[132:135], a[84:87], a[0:3], a[132:135]
    ds_read_b64_tr_b16 a[82:83], v12 offset:22784
    v_mfma_f32_16x16x32_bf16 a[148:151], a[84:87], a[4:7], a[148:151]
    v_mfma_f32_16x16x32_bf16 a[164:167], a[84:87], a[8:11], a[164:167]
    ds_read_b64_tr_b16 a[106:107], v12 offset:24832
    v_mfma_f32_16x16x32_bf16 a[180:183], a[84:87], a[12:15], a[180:183]
    buffer_load_dwordx4 v3, s[36:39], s75 offen offset:3072 lds
    v_mfma_f32_16x16x32_bf16 a[196:199], a[84:87], a[16:19], a[196:199]
    v_mfma_f32_16x16x32_bf16 a[212:215], a[84:87], a[20:23], a[212:215]
    v_mfma_f32_16x16x32_bf16 a[228:231], a[84:87], a[24:27], a[228:231]
    ds_read_b64_tr_b16 a[108:109], v14 offset:24576
    v_mfma_f32_16x16x32_bf16 a[244:247], a[84:87], a[28:31], a[244:247]
    ds_read_b64_tr_b16 a[84:85], v14 offset:22528
    v_mfma_f32_16x16x32_bf16 a[136:139], a[88:91], a[0:3], a[136:139]
    ds_read_b64_tr_b16 a[86:87], v14 offset:22784
    s_add_u32 m0, s78, 8192
    v_mfma_f32_16x16x32_bf16 a[152:155], a[88:91], a[4:7], a[152:155]
    buffer_load_dwordx4 v3, s[40:43], s76 offen offset:0 lds
    v_add_u32 v3, 229376, v3
    v_mfma_f32_16x16x32_bf16 a[168:171], a[88:91], a[8:11], a[168:171]
    ds_read_b64_tr_b16 a[110:111], v14 offset:24832
    v_mfma_f32_16x16x32_bf16 a[184:187], a[88:91], a[12:15], a[184:187]
    v_mfma_f32_16x16x32_bf16 a[200:203], a[88:91], a[16:19], a[200:203]
    v_mfma_f32_16x16x32_bf16 a[216:219], a[88:91], a[20:23], a[216:219]
    v_mfma_f32_16x16x32_bf16 a[232:235], a[88:91], a[24:27], a[232:235]
    ds_read_b64_tr_b16 a[124:125], v44 offset:20480
    v_mfma_f32_16x16x32_bf16 a[248:251], a[88:91], a[28:31], a[248:251]
    ds_read_b64_tr_b16 a[88:89], v12 offset:23552
    v_mfma_f32_16x16x32_bf16 a[140:143], a[92:95], a[0:3], a[140:143]
    ds_read_b64_tr_b16 a[90:91], v12 offset:23808
    v_mfma_f32_16x16x32_bf16 a[156:159], a[92:95], a[4:7], a[156:159]
    global_load_lds_dwordx4 v[4:5], off offset:1024
    v_lshl_add_u64 v[4:5], v[4:5], 0, s[80:81]
    v_mfma_f32_16x16x32_bf16 a[172:175], a[92:95], a[8:11], a[172:175]
    ds_read_b64_tr_b16 a[126:127], v44 offset:20736
    v_mfma_f32_16x16x32_bf16 a[188:191], a[92:95], a[12:15], a[188:191]
    v_mfma_f32_16x16x32_bf16 a[204:207], a[92:95], a[16:19], a[204:207]
    v_mfma_f32_16x16x32_bf16 a[220:223], a[92:95], a[20:23], a[220:223]
    v_mfma_f32_16x16x32_bf16 a[236:239], a[92:95], a[24:27], a[236:239]
    v_mfma_f32_16x16x32_bf16 a[252:255], a[92:95], a[28:31], a[252:255]
    ds_read_b64_tr_b16 a[92:93], v14 offset:23552
    v_mfma_f32_16x16x32_bf16 v[48:51], a[96:99], a[0:3], v[48:51]
    ds_read_b64_tr_b16 a[94:95], v14 offset:23808
    v_mfma_f32_16x16x32_bf16 v[52:55], a[96:99], a[4:7], v[52:55]
    v_mfma_f32_16x16x32_bf16 v[64:67], a[96:99], a[8:11], v[64:67]
    v_mfma_f32_16x16x32_bf16 v[68:71], a[96:99], a[12:15], v[68:71]
    v_mfma_f32_16x16x32_bf16 v[80:83], a[96:99], a[16:19], v[80:83]
    v_mfma_f32_16x16x32_bf16 v[84:87], a[96:99], a[20:23], v[84:87]
    v_mfma_f32_16x16x32_bf16 v[96:99], a[96:99], a[24:27], v[96:99]
    v_mfma_f32_16x16x32_bf16 v[100:103], a[96:99], a[28:31], v[100:103]
    v_mfma_f32_16x16x32_bf16 v[56:59], a[100:103], a[0:3], v[56:59]
    v_mfma_f32_16x16x32_bf16 v[60:63], a[100:103], a[4:7], v[60:63]
    v_mfma_f32_16x16x32_bf16 v[72:75], a[100:103], a[8:11], v[72:75]
    v_mfma_f32_16x16x32_bf16 v[76:79], a[100:103], a[12:15], v[76:79]
    v_mfma_f32_16x16x32_bf16 v[88:91], a[100:103], a[16:19], v[88:91]
    v_mfma_f32_16x16x32_bf16 v[92:95], a[100:103], a[20:23], v[92:95]
    v_mfma_f32_16x16x32_bf16 v[104:107], a[100:103], a[24:27], v[104:107]
    v_mfma_f32_16x16x32_bf16 v[108:111], a[100:103], a[28:31], v[108:111]
    s_waitcnt vmcnt(22) lgkmcnt(0)
    s_barrier
    v_mfma_f32_16x16x32_bf16 v[120:123], a[116:119], a[124:127], v[120:123]
    s_mov_b32 m0, s14
    s_mov_b32 s77, 4096
    v_mfma_f32_16x16x32_bf16 v[128:131], a[64:67], a[32:35], v[128:131]
    buffer_load_dwordx4 v1, s[28:31], s77 offen sc1 lds
    v_mfma_f32_16x16x32_bf16 v[144:147], a[64:67], a[36:39], v[144:147]
    v_mfma_f32_16x16x32_bf16 v[160:163], a[64:67], a[40:43], v[160:163]
    ds_read_b128 a[0:3], v8 offset:34816
    v_mfma_f32_16x16x32_bf16 v[176:179], a[64:67], a[44:47], v[176:179]
    v_mfma_f32_16x16x32_bf16 v[192:195], a[64:67], a[48:51], v[192:195]
    s_mov_b32 s77, 19456
    v_mfma_f32_16x16x32_bf16 v[208:211], a[64:67], a[52:55], v[208:211]
    buffer_load_dwordx4 v1, s[28:31], s77 offen offset:1024 sc1 lds
    v_add_u32 v1, 128, v1
    v_mfma_f32_16x16x32_bf16 v[224:227], a[64:67], a[56:59], v[224:227]
    ds_read_b128 a[4:7], v8 offset:36864
    v_mfma_f32_16x16x32_bf16 v[240:243], a[64:67], a[60:63], v[240:243]
    ds_read_b64_tr_b16 a[64:65], v13 offset:0
    v_mfma_f32_16x16x32_bf16 v[132:135], a[68:71], a[32:35], v[132:135]
    ds_read_b64_tr_b16 a[66:67], v13 offset:256
    v_mfma_f32_16x16x32_bf16 v[148:151], a[68:71], a[36:39], v[148:151]
    v_mfma_f32_16x16x32_bf16 v[164:167], a[68:71], a[40:43], v[164:167]
    ds_read_b128 a[8:11], v8 offset:38912
    s_add_u32 m0, s78, 20480
    v_mfma_f32_16x16x32_bf16 v[180:183], a[68:71], a[44:47], v[180:183]
    buffer_load_dwordx4 v2, s[32:35], s68 offen offset:0 lds
    v_mfma_f32_16x16x32_bf16 v[196:199], a[68:71], a[48:51], v[196:199]
    v_mfma_f32_16x16x32_bf16 v[212:215], a[68:71], a[52:55], v[212:215]
    v_mfma_f32_16x16x32_bf16 v[228:231], a[68:71], a[56:59], v[228:231]
    ds_read_b128 a[12:15], v8 offset:40960
    v_mfma_f32_16x16x32_bf16 v[244:247], a[68:71], a[60:63], v[244:247]
    ds_read_b64_tr_b16 a[68:69], v15 offset:0
    v_mfma_f32_16x16x32_bf16 v[136:139], a[72:75], a[32:35], v[136:139]
    ds_read_b64_tr_b16 a[70:71], v15 offset:256
    v_mfma_f32_16x16x32_bf16 v[152:155], a[72:75], a[36:39], v[152:155]
    buffer_load_dwordx4 v2, s[32:35], s69 offen offset:1024 lds
    v_mfma_f32_16x16x32_bf16 v[168:171], a[72:75], a[40:43], v[168:171]
    ds_read_b128 a[16:19], v8 offset:43008
    v_mfma_f32_16x16x32_bf16 v[184:187], a[72:75], a[44:47], v[184:187]
    v_mfma_f32_16x16x32_bf16 v[200:203], a[72:75], a[48:51], v[200:203]
    buffer_load_dwordx4 v2, s[32:35], s70 offen offset:2048 lds
    v_add_u32 v2, 196608, v2
    v_mfma_f32_16x16x32_bf16 v[216:219], a[72:75], a[52:55], v[216:219]
    v_mfma_f32_16x16x32_bf16 v[232:235], a[72:75], a[56:59], v[232:235]
    ds_read_b128 a[20:23], v8 offset:45056
    v_mfma_f32_16x16x32_bf16 v[248:251], a[72:75], a[60:63], v[248:251]
    ds_read_b64_tr_b16 a[72:73], v13 offset:1024
    v_mfma_f32_16x16x32_bf16 v[140:143], a[76:79], a[32:35], v[140:143]
    ds_read_b64_tr_b16 a[74:75], v13 offset:1280
    v_mfma_f32_16x16x32_bf16 v[156:159], a[76:79], a[36:39], v[156:159]
    buffer_load_dwordx4 v3, s[36:39], s71 offen offset:3072 lds
    v_mfma_f32_16x16x32_bf16 v[172:175], a[76:79], a[40:43], v[172:175]
    ds_read_b128 a[24:27], v8 offset:47104
    v_mfma_f32_16x16x32_bf16 v[188:191], a[76:79], a[44:47], v[188:191]
    v_mfma_f32_16x16x32_bf16 v[204:207], a[76:79], a[48:51], v[204:207]
    v_mfma_f32_16x16x32_bf16 v[220:223], a[76:79], a[52:55], v[220:223]
    v_mfma_f32_16x16x32_bf16 v[236:239], a[76:79], a[56:59], v[236:239]
    ds_read_b128 a[28:31], v8 offset:49152
    v_mfma_f32_16x16x32_bf16 v[252:255], a[76:79], a[60:63], v[252:255]
    ds_read_b64_tr_b16 a[76:77], v15 offset:1024
    v_mfma_f32_16x16x32_bf16 a[128:131], a[80:83], a[32:35], a[128:131]
    ds_read_b64_tr_b16 a[78:79], v15 offset:1280
    s_add_u32 m0, s78, 24576
    v_mfma_f32_16x16x32_bf16 a[144:147], a[80:83], a[36:39], a[144:147]
    buffer_load_dwordx4 v3, s[40:43], s72 offen offset:0 lds
    v_mfma_f32_16x16x32_bf16 a[160:163], a[80:83], a[40:43], a[160:163]
    ds_read_b128 a[112:115], v10 offset:34816
    v_mfma_f32_16x16x32_bf16 a[176:179], a[80:83], a[44:47], a[176:179]
    v_mfma_f32_16x16x32_bf16 a[192:195], a[80:83], a[48:51], a[192:195]
    buffer_load_dwordx4 v3, s[36:39], s73 offen offset:1024 lds
    v_mfma_f32_16x16x32_bf16 a[208:211], a[80:83], a[52:55], a[208:211]
    v_mfma_f32_16x16x32_bf16 a[224:227], a[80:83], a[56:59], a[224:227]
    ds_read_b64_tr_b16 a[96:97], v13 offset:4096
    v_mfma_f32_16x16x32_bf16 a[240:243], a[80:83], a[60:63], a[240:243]
    ds_read_b64_tr_b16 a[80:81], v13 offset:2048
    v_mfma_f32_16x16x32_bf16 a[132:135], a[84:87], a[32:35], a[132:135]
    ds_read_b64_tr_b16 a[82:83], v13 offset:2304
    v_mfma_f32_16x16x32_bf16 a[148:151], a[84:87], a[36:39], a[148:151]
    buffer_load_dwordx4 v3, s[40:43], s74 offen offset:2048 lds
    v_mfma_f32_16x16x32_bf16 a[164:167], a[84:87], a[40:43], a[164:167]
    ds_read_b64_tr_b16 a[98:99], v13 offset:4352
    v_mfma_f32_16x16x32_bf16 a[180:183], a[84:87], a[44:47], a[180:183]
    v_mfma_f32_16x16x32_bf16 a[196:199], a[84:87], a[48:51], a[196:199]
    v_mfma_f32_16x16x32_bf16 a[212:215], a[84:87], a[52:55], a[212:215]
    v_mfma_f32_16x16x32_bf16 a[228:231], a[84:87], a[56:59], a[228:231]
    ds_read_b64_tr_b16 a[100:101], v15 offset:4096
    v_mfma_f32_16x16x32_bf16 a[244:247], a[84:87], a[60:63], a[244:247]
    ds_read_b64_tr_b16 a[84:85], v15 offset:2048
    v_mfma_f32_16x16x32_bf16 a[136:139], a[88:91], a[32:35], a[136:139]
    ds_read_b64_tr_b16 a[86:87], v15 offset:2304
    v_mfma_f32_16x16x32_bf16 a[152:155], a[88:91], a[36:39], a[152:155]
    buffer_load_dwordx4 v3, s[36:39], s75 offen offset:3072 lds
    v_mfma_f32_16x16x32_bf16 a[168:171], a[88:91], a[40:43], a[168:171]
    ds_read_b64_tr_b16 a[102:103], v15 offset:4352
    s_add_u32 m0, s78, 28672
    v_mfma_f32_16x16x32_bf16 a[184:187], a[88:91], a[44:47], a[184:187]
    buffer_load_dwordx4 v3, s[40:43], s76 offen offset:0 lds
    v_add_u32 v3, 229376, v3
    v_mfma_f32_16x16x32_bf16 a[200:203], a[88:91], a[48:51], a[200:203]
    v_mfma_f32_16x16x32_bf16 a[216:219], a[88:91], a[52:55], a[216:219]
    v_mfma_f32_16x16x32_bf16 a[232:235], a[88:91], a[56:59], a[232:235]
    ds_read_b64_tr_b16 a[120:121], v45 offset:0
    v_mfma_f32_16x16x32_bf16 a[248:251], a[88:91], a[60:63], a[248:251]
    ds_read_b64_tr_b16 a[88:89], v13 offset:3072
    v_mfma_f32_16x16x32_bf16 a[140:143], a[92:95], a[32:35], a[140:143]
    ds_read_b64_tr_b16 a[90:91], v13 offset:3328
    v_mfma_f32_16x16x32_bf16 a[156:159], a[92:95], a[36:39], a[156:159]
    global_load_lds_dwordx4 v[4:5], off offset:1024
    v_lshl_add_u64 v[4:5], v[4:5], 0, s[80:81]
    v_mfma_f32_16x16x32_bf16 a[172:175], a[92:95], a[40:43], a[172:175]
    ds_read_b64_tr_b16 a[122:123], v45 offset:256
    v_mfma_f32_16x16x32_bf16 a[188:191], a[92:95], a[44:47], a[188:191]
    v_mfma_f32_16x16x32_bf16 a[204:207], a[92:95], a[48:51], a[204:207]
    v_mfma_f32_16x16x32_bf16 a[220:223], a[92:95], a[52:55], a[220:223]
    v_mfma_f32_16x16x32_bf16 a[236:239], a[92:95], a[56:59], a[236:239]
    v_mfma_f32_16x16x32_bf16 a[252:255], a[92:95], a[60:63], a[252:255]
    ds_read_b64_tr_b16 a[92:93], v15 offset:3072
    v_mfma_f32_16x16x32_bf16 v[48:51], a[104:107], a[32:35], v[48:51]
    ds_read_b64_tr_b16 a[94:95], v15 offset:3328
    v_mfma_f32_16x16x32_bf16 v[52:55], a[104:107], a[36:39], v[52:55]
    v_mfma_f32_16x16x32_bf16 v[64:67], a[104:107], a[40:43], v[64:67]
    v_mfma_f32_16x16x32_bf16 v[68:71], a[104:107], a[44:47], v[68:71]
    v_mfma_f32_16x16x32_bf16 v[80:83], a[104:107], a[48:51], v[80:83]
    v_mfma_f32_16x16x32_bf16 v[84:87], a[104:107], a[52:55], v[84:87]
    v_mfma_f32_16x16x32_bf16 v[96:99], a[104:107], a[56:59], v[96:99]
    v_mfma_f32_16x16x32_bf16 v[100:103], a[104:107], a[60:63], v[100:103]
    v_mfma_f32_16x16x32_bf16 v[56:59], a[108:111], a[32:35], v[56:59]
    v_mfma_f32_16x16x32_bf16 v[60:63], a[108:111], a[36:39], v[60:63]
    v_mfma_f32_16x16x32_bf16 v[72:75], a[108:111], a[40:43], v[72:75]
    v_mfma_f32_16x16x32_bf16 v[76:79], a[108:111], a[44:47], v[76:79]
    v_mfma_f32_16x16x32_bf16 v[88:91], a[108:111], a[48:51], v[88:91]
    v_mfma_f32_16x16x32_bf16 v[92:95], a[108:111], a[52:55], v[92:95]
    v_mfma_f32_16x16x32_bf16 v[104:107], a[108:111], a[56:59], v[104:107]
    v_mfma_f32_16x16x32_bf16 v[108:111], a[108:111], a[60:63], v[108:111]
    s_waitcnt vmcnt(24) lgkmcnt(0)
    s_barrier
    v_mfma_f32_16x16x32_bf16 v[120:123], a[112:115], a[120:123], v[120:123]
    s_add_u32 m0, s78, 40960
    buffer_load_dword v7, v6, s[44:47], s4 offen
    v_add_u32_e64 v6, s79, v6
    v_mfma_f32_16x16x32_bf16 v[128:131], a[64:67], a[0:3], v[128:131]
    buffer_load_dwordx4 v2, s[32:35], s68 offen offset:0 lds
    buffer_load_dword v7, v33, s[48:51], 0 offen
    v_add_u32_e64 v33, s52, v33
    v_mfma_f32_16x16x32_bf16 v[144:147], a[64:67], a[4:7], v[144:147]
    v_mfma_f32_16x16x32_bf16 v[160:163], a[64:67], a[8:11], v[160:163]
    ds_read_b128 a[32:35], v9 offset:34816
    v_mfma_f32_16x16x32_bf16 v[176:179], a[64:67], a[12:15], v[176:179]
    v_mfma_f32_16x16x32_bf16 v[192:195], a[64:67], a[16:19], v[192:195]
    v_mfma_f32_16x16x32_bf16 v[208:211], a[64:67], a[20:23], v[208:211]
    v_mfma_f32_16x16x32_bf16 v[224:227], a[64:67], a[24:27], v[224:227]
    ds_read_b128 a[36:39], v9 offset:36864
    v_mfma_f32_16x16x32_bf16 v[240:243], a[64:67], a[28:31], v[240:243]
    ds_read_b64_tr_b16 a[64:65], v13 offset:20480
    v_mfma_f32_16x16x32_bf16 v[132:135], a[68:71], a[0:3], v[132:135]
    ds_read_b64_tr_b16 a[66:67], v13 offset:20736
    v_mfma_f32_16x16x32_bf16 v[148:151], a[68:71], a[4:7], v[148:151]
    buffer_load_dwordx4 v2, s[32:35], s69 offen offset:1024 lds
    v_mfma_f32_16x16x32_bf16 v[164:167], a[68:71], a[8:11], v[164:167]
    ds_read_b128 a[40:43], v9 offset:38912
    v_mfma_f32_16x16x32_bf16 v[180:183], a[68:71], a[12:15], v[180:183]
    v_mfma_f32_16x16x32_bf16 v[196:199], a[68:71], a[16:19], v[196:199]
    buffer_load_dwordx4 v2, s[32:35], s70 offen offset:2048 lds
    v_add_u32 v2, 196608, v2
    v_mfma_f32_16x16x32_bf16 v[212:215], a[68:71], a[20:23], v[212:215]
    v_mfma_f32_16x16x32_bf16 v[228:231], a[68:71], a[24:27], v[228:231]
    ds_read_b128 a[44:47], v9 offset:40960
    v_mfma_f32_16x16x32_bf16 v[244:247], a[68:71], a[28:31], v[244:247]
    ds_read_b64_tr_b16 a[68:69], v15 offset:20480
    v_mfma_f32_16x16x32_bf16 v[136:139], a[72:75], a[0:3], v[136:139]
    ds_read_b64_tr_b16 a[70:71], v15 offset:20736
    v_mfma_f32_16x16x32_bf16 v[152:155], a[72:75], a[4:7], v[152:155]
    v_mfma_f32_16x16x32_bf16 v[168:171], a[72:75], a[8:11], v[168:171]
    ds_read_b128 a[48:51], v9 offset:43008
    v_mfma_f32_16x16x32_bf16 v[184:187], a[72:75], a[12:15], v[184:187]
    buffer_load_dwordx4 v3, s[36:39], s71 offen offset:3072 lds
    v_mfma_f32_16x16x32_bf16 v[200:203], a[72:75], a[16:19], v[200:203]
    v_mfma_f32_16x16x32_bf16 v[216:219], a[72:75], a[20:23], v[216:219]
    v_mfma_f32_16x16x32_bf16 v[232:235], a[72:75], a[24:27], v[232:235]
    ds_read_b128 a[52:55], v9 offset:45056
    v_mfma_f32_16x16x32_bf16 v[248:251], a[72:75], a[28:31], v[248:251]
    ds_read_b64_tr_b16 a[72:73], v13 offset:21504
    v_mfma_f32_16x16x32_bf16 v[140:143], a[76:79], a[0:3], v[140:143]
    ds_read_b64_tr_b16 a[74:75], v13 offset:21760
    s_add_u32 m0, s78, 45056
    v_mfma_f32_16x16x32_bf16 v[156:159], a[76:79], a[4:7], v[156:159]
    buffer_load_dwordx4 v3, s[40:43], s72 offen offset:0 lds
    v_mfma_f32_16x16x32_bf16 v[172:175], a[76:79], a[8:11], v[172:175]
    ds_read_b128 a[56:59], v9 offset:47104
    v_mfma_f32_16x16x32_bf16 v[188:191], a[76:79], a[12:15], v[188:191]
    v_mfma_f32_16x16x32_bf16 v[204:207], a[76:79], a[16:19], v[204:207]
    v_mfma_f32_16x16x32_bf16 v[220:223], a[76:79], a[20:23], v[220:223]
    v_mfma_f32_16x16x32_bf16 v[236:239], a[76:79], a[24:27], v[236:239]
    ds_read_b128 a[60:63], v9 offset:49152
    v_mfma_f32_16x16x32_bf16 v[252:255], a[76:79], a[28:31], v[252:255]
    ds_read_b64_tr_b16 a[76:77], v15 offset:21504
    v_mfma_f32_16x16x32_bf16 a[128:131], a[80:83], a[0:3], a[128:131]
    ds_read_b64_tr_b16 a[78:79], v15 offset:21760
    v_mfma_f32_16x16x32_bf16 a[144:147], a[80:83], a[4:7], a[144:147]
    buffer_load_dwordx4 v3, s[36:39], s73 offen offset:1024 lds
    v_mfma_f32_16x16x32_bf16 a[160:163], a[80:83], a[8:11], a[160:163]
    ds_read_b128 a[116:119], v11 offset:34816
    v_mfma_f32_16x16x32_bf16 a[176:179], a[80:83], a[12:15], a[176:179]
    v_mfma_f32_16x16x32_bf16 a[192:195], a[80:83], a[16:19], a[192:195]
    v_mfma_f32_16x16x32_bf16 a[208:211], a[80:83], a[20:23], a[208:211]
    buffer_load_dwordx4 v3, s[40:43], s74 offen offset:2048 lds
    v_mfma_f32_16x16x32_bf16 a[224:227], a[80:83], a[24:27], a[224:227]
    ds_read_b64_tr_b16 a[104:105], v13 offset:24576
    v_mfma_f32_16x16x32_bf16 a[240:243], a[80:83], a[28:31], a[240:243]
    ds_read_b64_tr_b16 a[80:81], v13 offset:22528
    v_mfma_f32_16x16x32_bf16 a[132:135], a[84:87], a[0:3], a[132:135]
    ds_read_b64_tr_b16 a[82:83], v13 offset:22784
    v_mfma_f32_16x16x32_bf16 a[148:151], a[84:87], a[4:7], a[148:151]
    v_mfma_f32_16x16x32_bf16 a[164:167], a[84:87], a[8:11], a[164:167]
    ds_read_b64_tr_b16 a[106:107], v13 offset:24832
    v_mfma_f32_16x16x32_bf16 a[180:183], a[84:87], a[12:15], a[180:183]
    buffer_load_dwordx4 v3, s[36:39], s75 offen offset:3072 lds
    v_mfma_f32_16x16x32_bf16 a[196:199], a[84:87], a[16:19], a[196:199]
    v_mfma_f32_16x16x32_bf16 a[212:215], a[84:87], a[20:23], a[212:215]
    v_mfma_f32_16x16x32_bf16 a[228:231], a[84:87], a[24:27], a[228:231]
    ds_read_b64_tr_b16 a[108:109], v15 offset:24576
    v_mfma_f32_16x16x32_bf16 a[244:247], a[84:87], a[28:31], a[244:247]
    ds_read_b64_tr_b16 a[84:85], v15 offset:22528
    v_mfma_f32_16x16x32_bf16 a[136:139], a[88:91], a[0:3], a[136:139]
    ds_read_b64_tr_b16 a[86:87], v15 offset:22784
    s_add_u32 m0, s78, 49152
    v_mfma_f32_16x16x32_bf16 a[152:155], a[88:91], a[4:7], a[152:155]
    buffer_load_dwordx4 v3, s[40:43], s76 offen offset:0 lds
    v_add_u32 v3, 229376, v3
    v_mfma_f32_16x16x32_bf16 a[168:171], a[88:91], a[8:11], a[168:171]
    ds_read_b64_tr_b16 a[110:111], v15 offset:24832
    v_mfma_f32_16x16x32_bf16 a[184:187], a[88:91], a[12:15], a[184:187]
    v_mfma_f32_16x16x32_bf16 a[200:203], a[88:91], a[16:19], a[200:203]
    v_mfma_f32_16x16x32_bf16 a[216:219], a[88:91], a[20:23], a[216:219]
    v_mfma_f32_16x16x32_bf16 a[232:235], a[88:91], a[24:27], a[232:235]
    ds_read_b64_tr_b16 a[124:125], v45 offset:20480
    v_mfma_f32_16x16x32_bf16 a[248:251], a[88:91], a[28:31], a[248:251]
    ds_read_b64_tr_b16 a[88:89], v13 offset:23552
    v_mfma_f32_16x16x32_bf16 a[140:143], a[92:95], a[0:3], a[140:143]
    ds_read_b64_tr_b16 a[90:91], v13 offset:23808
    v_mfma_f32_16x16x32_bf16 a[156:159], a[92:95], a[4:7], a[156:159]
    global_load_lds_dwordx4 v[4:5], off offset:1024
    v_lshl_add_u64 v[4:5], v[4:5], 0, s[80:81]
    v_mfma_f32_16x16x32_bf16 a[172:175], a[92:95], a[8:11], a[172:175]
    ds_read_b64_tr_b16 a[126:127], v45 offset:20736
    v_mfma_f32_16x16x32_bf16 a[188:191], a[92:95], a[12:15], a[188:191]
    v_mfma_f32_16x16x32_bf16 a[204:207], a[92:95], a[16:19], a[204:207]
    v_mfma_f32_16x16x32_bf16 a[220:223], a[92:95], a[20:23], a[220:223]
    v_mfma_f32_16x16x32_bf16 a[236:239], a[92:95], a[24:27], a[236:239]
    v_mfma_f32_16x16x32_bf16 a[252:255], a[92:95], a[28:31], a[252:255]
    ds_read_b64_tr_b16 a[92:93], v15 offset:23552
    v_mfma_f32_16x16x32_bf16 v[48:51], a[96:99], a[0:3], v[48:51]
    ds_read_b64_tr_b16 a[94:95], v15 offset:23808
    v_mfma_f32_16x16x32_bf16 v[52:55], a[96:99], a[4:7], v[52:55]
    v_mfma_f32_16x16x32_bf16 v[64:67], a[96:99], a[8:11], v[64:67]
    v_mfma_f32_16x16x32_bf16 v[68:71], a[96:99], a[12:15], v[68:71]
    v_mfma_f32_16x16x32_bf16 v[80:83], a[96:99], a[16:19], v[80:83]
    v_mfma_f32_16x16x32_bf16 v[84:87], a[96:99], a[20:23], v[84:87]
    v_mfma_f32_16x16x32_bf16 v[96:99], a[96:99], a[24:27], v[96:99]
    v_mfma_f32_16x16x32_bf16 v[100:103], a[96:99], a[28:31], v[100:103]
    v_mfma_f32_16x16x32_bf16 v[56:59], a[100:103], a[0:3], v[56:59]
    v_mfma_f32_16x16x32_bf16 v[60:63], a[100:103], a[4:7], v[60:63]
    v_mfma_f32_16x16x32_bf16 v[72:75], a[100:103], a[8:11], v[72:75]
    v_mfma_f32_16x16x32_bf16 v[76:79], a[100:103], a[12:15], v[76:79]
    v_mfma_f32_16x16x32_bf16 v[88:91], a[100:103], a[16:19], v[88:91]
    v_mfma_f32_16x16x32_bf16 v[92:95], a[100:103], a[20:23], v[92:95]
    v_mfma_f32_16x16x32_bf16 v[104:107], a[100:103], a[24:27], v[104:107]
    v_mfma_f32_16x16x32_bf16 v[108:111], a[100:103], a[28:31], v[108:111]
    s_waitcnt vmcnt(22) lgkmcnt(0)
    s_barrier
    v_mfma_f32_16x16x32_bf16 v[120:123], a[116:119], a[124:127], v[120:123]
    s_mov_b32 m0, s15
    s_mov_b32 s77, 4096
    v_mfma_f32_16x16x32_bf16 v[128:131], a[64:67], a[32:35], v[128:131]
    buffer_load_dwordx4 v1, s[28:31], s77 offen sc1 lds
    v_mfma_f32_16x16x32_bf16 v[144:147], a[64:67], a[36:39], v[144:147]
    v_mfma_f32_16x16x32_bf16 v[160:163], a[64:67], a[40:43], v[160:163]
    ds_read_b128 a[0:3], v8 offset:0
    v_mfma_f32_16x16x32_bf16 v[176:179], a[64:67], a[44:47], v[176:179]
    v_mfma_f32_16x16x32_bf16 v[192:195], a[64:67], a[48:51], v[192:195]
    s_mov_b32 s77, 19456
    v_mfma_f32_16x16x32_bf16 v[208:211], a[64:67], a[52:55], v[208:211]
    buffer_load_dwordx4 v1, s[28:31], s77 offen offset:1024 sc1 lds
    v_add_u32 v1, 128, v1
    v_mfma_f32_16x16x32_bf16 v[224:227], a[64:67], a[56:59], v[224:227]
    ds_read_b128 a[4:7], v8 offset:2048
    v_mfma_f32_16x16x32_bf16 v[240:243], a[64:67], a[60:63], v[240:243]
    ds_read_b64_tr_b16 a[64:65], v12 offset:0
    v_mfma_f32_16x16x32_bf16 v[132:135], a[68:71], a[32:35], v[132:135]
    ds_read_b64_tr_b16 a[66:67], v12 offset:256
    v_mfma_f32_16x16x32_bf16 v[148:151], a[68:71], a[36:39], v[148:151]
    v_mfma_f32_16x16x32_bf16 v[164:167], a[68:71], a[40:43], v[164:167]
    ds_read_b128 a[8:11], v8 offset:4096
    s_add_u32 m0, s78, 61440
    v_mfma_f32_16x16x32_bf16 v[180:183], a[68:71], a[44:47], v[180:183]
    buffer_load_dwordx4 v2, s[32:35], s68 offen offset:0 lds
    v_mfma_f32_16x16x32_bf16 v[196:199], a[68:71], a[48:51], v[196:199]
    v_mfma_f32_16x16x32_bf16 v[212:215], a[68:71], a[52:55], v[212:215]
    v_mfma_f32_16x16x32_bf16 v[228:231], a[68:71], a[56:59], v[228:231]
    ds_read_b128 a[12:15], v8 offset:6144
    v_mfma_f32_16x16x32_bf16 v[244:247], a[68:71], a[60:63], v[244:247]
    ds_read_b64_tr_b16 a[68:69], v14 offset:0
    v_mfma_f32_16x16x32_bf16 v[136:139], a[72:75], a[32:35], v[136:139]
    ds_read_b64_tr_b16 a[70:71], v14 offset:256
    v_mfma_f32_16x16x32_bf16 v[152:155], a[72:75], a[36:39], v[152:155]
    buffer_load_dwordx4 v2, s[32:35], s69 offen offset:1024 lds
    v_mfma_f32_16x16x32_bf16 v[168:171], a[72:75], a[40:43], v[168:171]
    ds_read_b128 a[16:19], v8 offset:8192
    v_mfma_f32_16x16x32_bf16 v[184:187], a[72:75], a[44:47], v[184:187]
    v_mfma_f32_16x16x32_bf16 v[200:203], a[72:75], a[48:51], v[200:203]
    buffer_load_dwordx4 v2, s[32:35], s70 offen offset:2048 lds
    v_add_u32 v2, 196608, v2
    v_mfma_f32_16x16x32_bf16 v[216:219], a[72:75], a[52:55], v[216:219]
    v_mfma_f32_16x16x32_bf16 v[232:235], a[72:75], a[56:59], v[232:235]
    ds_read_b128 a[20:23], v8 offset:10240
    v_mfma_f32_16x16x32_bf16 v[248:251], a[72:75], a[60:63], v[248:251]
    ds_read_b64_tr_b16 a[72:73], v12 offset:1024
    v_mfma_f32_16x16x32_bf16 v[140:143], a[76:79], a[32:35], v[140:143]
    ds_read_b64_tr_b16 a[74:75], v12 offset:1280
    v_mfma_f32_16x16x32_bf16 v[156:159], a[76:79], a[36:39], v[156:159]
    buffer_load_dwordx4 v3, s[36:39], s71 offen offset:3072 lds
    v_mfma_f32_16x16x32_bf16 v[172:175], a[76:79], a[40:43], v[172:175]
    ds_read_b128 a[24:27], v8 offset:12288
    v_mfma_f32_16x16x32_bf16 v[188:191], a[76:79], a[44:47], v[188:191]
    v_mfma_f32_16x16x32_bf16 v[204:207], a[76:79], a[48:51], v[204:207]
    v_mfma_f32_16x16x32_bf16 v[220:223], a[76:79], a[52:55], v[220:223]
    v_mfma_f32_16x16x32_bf16 v[236:239], a[76:79], a[56:59], v[236:239]
    ds_read_b128 a[28:31], v8 offset:14336
    v_mfma_f32_16x16x32_bf16 v[252:255], a[76:79], a[60:63], v[252:255]
    ds_read_b64_tr_b16 a[76:77], v14 offset:1024
    v_mfma_f32_16x16x32_bf16 a[128:131], a[80:83], a[32:35], a[128:131]
    ds_read_b64_tr_b16 a[78:79], v14 offset:1280
    s_add_u32 m0, s78, 65536
    v_mfma_f32_16x16x32_bf16 a[144:147], a[80:83], a[36:39], a[144:147]
    buffer_load_dwordx4 v3, s[40:43], s72 offen offset:0 lds
    v_mfma_f32_16x16x32_bf16 a[160:163], a[80:83], a[40:43], a[160:163]
    ds_read_b128 a[112:115], v10 offset:0
    v_mfma_f32_16x16x32_bf16 a[176:179], a[80:83], a[44:47], a[176:179]
    v_mfma_f32_16x16x32_bf16 a[192:195], a[80:83], a[48:51], a[192:195]
    buffer_load_dwordx4 v3, s[36:39], s73 offen offset:1024 lds
    v_mfma_f32_16x16x32_bf16 a[208:211], a[80:83], a[52:55], a[208:211]
    v_mfma_f32_16x16x32_bf16 a[224:227], a[80:83], a[56:59], a[224:227]
    ds_read_b64_tr_b16 a[96:97], v12 offset:4096
    v_mfma_f32_16x16x32_bf16 a[240:243], a[80:83], a[60:63], a[240:243]
    ds_read_b64_tr_b16 a[80:81], v12 offset:2048
    v_mfma_f32_16x16x32_bf16 a[132:135], a[84:87], a[32:35], a[132:135]
    ds_read_b64_tr_b16 a[82:83], v12 offset:2304
    v_mfma_f32_16x16x32_bf16 a[148:151], a[84:87], a[36:39], a[148:151]
    buffer_load_dwordx4 v3, s[40:43], s74 offen offset:2048 lds
    v_mfma_f32_16x16x32_bf16 a[164:167], a[84:87], a[40:43], a[164:167]
    ds_read_b64_tr_b16 a[98:99], v12 offset:4352
    v_mfma_f32_16x16x32_bf16 a[180:183], a[84:87], a[44:47], a[180:183]
    v_mfma_f32_16x16x32_bf16 a[196:199], a[84:87], a[48:51], a[196:199]
    v_mfma_f32_16x16x32_bf16 a[212:215], a[84:87], a[52:55], a[212:215]
    v_mfma_f32_16x16x32_bf16 a[228:231], a[84:87], a[56:59], a[228:231]
    ds_read_b64_tr_b16 a[100:101], v14 offset:4096
    v_mfma_f32_16x16x32_bf16 a[244:247], a[84:87], a[60:63], a[244:247]
    ds_read_b64_tr_b16 a[84:85], v14 offset:2048
    v_mfma_f32_16x16x32_bf16 a[136:139], a[88:91], a[32:35], a[136:139]
    ds_read_b64_tr_b16 a[86:87], v14 offset:2304
    v_mfma_f32_16x16x32_bf16 a[152:155], a[88:91], a[36:39], a[152:155]
    buffer_load_dwordx4 v3, s[36:39], s75 offen offset:3072 lds
    v_mfma_f32_16x16x32_bf16 a[168:171], a[88:91], a[40:43], a[168:171]
    ds_read_b64_tr_b16 a[102:103], v14 offset:4352
    s_add_u32 m0, s78, 69632
    v_mfma_f32_16x16x32_bf16 a[184:187], a[88:91], a[44:47], a[184:187]
    buffer_load_dwordx4 v3, s[40:43], s76 offen offset:0 lds
    v_add_u32 v3, 229376, v3
    v_mfma_f32_16x16x32_bf16 a[200:203], a[88:91], a[48:51], a[200:203]
    v_mfma_f32_16x16x32_bf16 a[216:219], a[88:91], a[52:55], a[216:219]
    v_mfma_f32_16x16x32_bf16 a[232:235], a[88:91], a[56:59], a[232:235]
    ds_read_b64_tr_b16 a[120:121], v44 offset:0
    v_mfma_f32_16x16x32_bf16 a[248:251], a[88:91], a[60:63], a[248:251]
    ds_read_b64_tr_b16 a[88:89], v12 offset:3072
    v_mfma_f32_16x16x32_bf16 a[140:143], a[92:95], a[32:35], a[140:143]
    ds_read_b64_tr_b16 a[90:91], v12 offset:3328
    v_mfma_f32_16x16x32_bf16 a[156:159], a[92:95], a[36:39], a[156:159]
    global_load_lds_dwordx4 v[4:5], off offset:1024
    v_lshl_add_u64 v[4:5], v[4:5], 0, s[80:81]
    v_mfma_f32_16x16x32_bf16 a[172:175], a[92:95], a[40:43], a[172:175]
    ds_read_b64_tr_b16 a[122:123], v44 offset:256
    v_mfma_f32_16x16x32_bf16 a[188:191], a[92:95], a[44:47], a[188:191]
    v_mfma_f32_16x16x32_bf16 a[204:207], a[92:95], a[48:51], a[204:207]
    v_mfma_f32_16x16x32_bf16 a[220:223], a[92:95], a[52:55], a[220:223]
    v_mfma_f32_16x16x32_bf16 a[236:239], a[92:95], a[56:59], a[236:239]
    v_mfma_f32_16x16x32_bf16 a[252:255], a[92:95], a[60:63], a[252:255]
    ds_read_b64_tr_b16 a[92:93], v14 offset:3072
    v_mfma_f32_16x16x32_bf16 v[48:51], a[104:107], a[32:35], v[48:51]
    ds_read_b64_tr_b16 a[94:95], v14 offset:3328
    v_mfma_f32_16x16x32_bf16 v[52:55], a[104:107], a[36:39], v[52:55]
    v_mfma_f32_16x16x32_bf16 v[64:67], a[104:107], a[40:43], v[64:67]
    v_mfma_f32_16x16x32_bf16 v[68:71], a[104:107], a[44:47], v[68:71]
    v_mfma_f32_16x16x32_bf16 v[80:83], a[104:107], a[48:51], v[80:83]
    v_mfma_f32_16x16x32_bf16 v[84:87], a[104:107], a[52:55], v[84:87]
    v_mfma_f32_16x16x32_bf16 v[96:99], a[104:107], a[56:59], v[96:99]
    v_mfma_f32_16x16x32_bf16 v[100:103], a[104:107], a[60:63], v[100:103]
    v_mfma_f32_16x16x32_bf16 v[56:59], a[108:111], a[32:35], v[56:59]
    v_mfma_f32_16x16x32_bf16 v[60:63], a[108:111], a[36:39], v[60:63]
    v_mfma_f32_16x16x32_bf16 v[72:75], a[108:111], a[40:43], v[72:75]
    v_mfma_f32_16x16x32_bf16 v[76:79], a[108:111], a[44:47], v[76:79]
    v_mfma_f32_16x16x32_bf16 v[88:91], a[108:111], a[48:51], v[88:91]
    v_mfma_f32_16x16x32_bf16 v[92:95], a[108:111], a[52:55], v[92:95]
    v_mfma_f32_16x16x32_bf16 v[104:107], a[108:111], a[56:59], v[104:107]
    v_mfma_f32_16x16x32_bf16 v[108:111], a[108:111], a[60:63], v[108:111]
    s_sub_u32 s67, s67, 1
    s_cmp_lg_u32 s67, 0
    s_cbranch_scc1 L_loop1
L_tail1:
    s_waitcnt vmcnt(24) lgkmcnt(0)
    s_barrier
    v_mfma_f32_16x16x32_bf16 v[120:123], a[112:115], a[120:123], v[120:123]
    s_getpc_b64 s[86:87]
L_pc1:
    s_sub_u32 s86, s86, L_pc1-L_tail0
    s_subb_u32 s87, s87, 0
    s_lshr_b32 s82, s2, 3
    s_lshl_b32 s82, s82, 2
    s_add_u32 s82, s82, s60
    s_lshl_b32 s82, s82, 10
    v_add_u32 v34, s82, v16
    v_min_u32 v34, L_code_end-L_tail0-4, v34
    global_load_dword v7, v34, s[86:87]
    v_mfma_f32_16x16x32_bf16 v[128:131], a[64:67], a[0:3], v[128:131]
    v_mfma_f32_16x16x32_bf16 v[144:147], a[64:67], a[4:7], v[144:147]
    v_mfma_f32_16x16x32_bf16 v[160:163], a[64:67], a[8:11], v[160:163]
    ds_read_b128 a[32:35], v9 offset:0
    v_mfma_f32_16x16x32_bf16 v[176:179], a[64:67], a[12:15], v[176:179]
    s_mul_i32 s82, s65, 1835008
    s_lshl_b32 s83, s66, 8
    v_mfma_f32_16x16x32_bf16 v[192:195], a[64:67], a[16:19], v[192:195]
    s_add_u32 s82, s82, s83
    s_add_u32 s48, s20, s82
    v_mfma_f32_16x16x32_bf16 v[208:211], a[64:67], a[20:23], v[208:211]
    s_addc_u32 s49, s21, 0
    s_and_b32 s49, s49, 0xffff
    v_mfma_f32_16x16x32_bf16 v[224:227], a[64:67], a[24:27], v[224:227]
    ds_read_b128 a[36:39], v9 offset:2048
    s_sub_u32 s50, 7340032, s82
    s_mov_b32 s51, 0x20000
    v_mfma_f32_16x16x32_bf16 v[240:243], a[64:67], a[28:31], v[240:243]
    ds_read_b64_tr_b16 a[64:65], v12 offset:20480
    s_add_u32 s52, s12, s83
    s_addc_u32 s53, s13, 0
    v_mfma_f32_16x16x32_bf16 v[132:135], a[68:71], a[0:3], v[132:135]
    ds_read_b64_tr_b16 a[66:67], v12 offset:20736
    s_and_b32 s53, s53, 0xffff
    s_sub_u32 s54, 2097152, s83
    v_mfma_f32_16x16x32_bf16 v[148:151], a[68:71], a[4:7], v[148:151]
    s_mov_b32 s55, 0x20000
    s_lshl_b32 s3, s60, 11
    v_mfma_f32_16x16x32_bf16 v[164:167], a[68:71], a[8:11], v[164:167]
    ds_read_b128 a[40:43], v9 offset:4096
    v_lshrrev_b32 v34, 4, v0
    v_and_b32 v35, 15, v0
    v_mfma_f32_16x16x32_bf16 v[180:183], a[68:71], a[12:15], v[180:183]
    v_lshlrev_b32 v36, 1, v34
    v_add_u32 v36, 0, v36
    v_mfma_f32_16x16x32_bf16 v[196:199], a[68:71], a[16:19], v[196:199]
    v_xor_b32 v36, v36, v35
    v_lshlrev_b32 v36, 4, v36
    v_mfma_f32_16x16x32_bf16 v[212:215], a[68:71], a[20:23], v[212:215]
    v_lshl_add_u32 v36, v34, 11, v36
    s_lshl_b32 s82, s60, 14
    v_mfma_f32_16x16x32_bf16 v[228:231], a[68:71], a[24:27], v[228:231]
    ds_read_b128 a[44:47], v9 offset:6144
    s_add_u32 s82, s82, 0
    v_add_u32 v17, s82, v36
    v_mfma_f32_16x16x32_bf16 v[244:247], a[68:71], a[28:31], v[244:247]
    ds_read_b64_tr_b16 a[68:69], v14 offset:20480
    s_lshl_b32 s82, s62, 1
    s_add_u32 s82, s82, 0
    v_mfma_f32_16x16x32_bf16 v[136:139], a[72:75], a[0:3], v[136:139]
    ds_read_b64_tr_b16 a[70:71], v14 offset:20736
    s_lshl_b32 s82, s82, 3
    s_lshl_b32 s83, s61, 2
    v_mfma_f32_16x16x32_bf16 v[152:155], a[72:75], a[4:7], v[152:155]
    s_add_u32 s82, s82, s83
    s_mul_i32 s83, s62, 96
    v_mfma_f32_16x16x32_bf16 v[168:171], a[72:75], a[8:11], v[168:171]
    ds_read_b128 a[48:51], v9 offset:8192
    s_add_u32 s82, s82, s83
    s_lshl_b32 s82, s82, 11
    v_mfma_f32_16x16x32_bf16 v[184:187], a[72:75], a[12:15], v[184:187]
    s_sub_u32 s82, s82, 0
    v_add_u32 v19, s82, v36
    v_mfma_f32_16x16x32_bf16 v[200:203], a[72:75], a[16:19], v[200:203]
    v_lshlrev_b32 v36, 1, v34
    v_add_u32 v36, 8, v36
    v_mfma_f32_16x16x32_bf16 v[216:219], a[72:75], a[20:23], v[216:219]
    v_xor_b32 v36, v36, v35
    v_lshlrev_b32 v36, 4, v36
    v_mfma_f32_16x16x32_bf16 v[232:235], a[72:75], a[24:27], v[232:235]
    ds_read_b128 a[52:55], v9 offset:10240
    v_lshl_add_u32 v36, v34, 11, v36
    s_lshl_b32 s82, s60, 14
    v_mfma_f32_16x16x32_bf16 v[248:251], a[72:75], a[28:31], v[248:251]
    ds_read_b64_tr_b16 a[72:73], v12 offset:21504
    s_add_u32 s82, s82, 7168
    v_add_u32 v18, s82, v36
    v_mfma_f32_16x16x32_bf16 v[140:143], a[76:79], a[0:3], v[140:143]
    ds_read_b64_tr_b16 a[74:75], v12 offset:21760
    s_lshl_b32 s82, s62, 1
    s_add_u32 s82, s82, 1
    v_mfma_f32_16x16x32_bf16 v[156:159], a[76:79], a[4:7], v[156:159]
    s_lshl_b32 s82, s82, 3
    s_lshl_b32 s83, s61, 2
    v_mfma_f32_16x16x32_bf16 v[172:175], a[76:79], a[8:11], v[172:175]
    ds_read_b128 a[56:59], v9 offset:12288
    s_add_u32 s82, s82, s83
    s_mul_i32 s83, s62, 96
    v_mfma_f32_16x16x32_bf16 v[188:191], a[76:79], a[12:15], v[188:191]
    s_add_u32 s82, s82, s83
    s_lshl_b32 s82, s82, 11
    v_mfma_f32_16x16x32_bf16 v[204:207], a[76:79], a[16:19], v[204:207]
    s_sub_u32 s82, s82, 1024
    v_add_u32 v20, s82, v36
    v_mfma_f32_16x16x32_bf16 v[220:223], a[76:79], a[20:23], v[220:223]
    v_mfma_f32_16x16x32_bf16 v[236:239], a[76:79], a[24:27], v[236:239]
    ds_read_b128 a[60:63], v9 offset:14336
    v_mfma_f32_16x16x32_bf16 v[252:255], a[76:79], a[28:31], v[252:255]
    ds_read_b64_tr_b16 a[76:77], v14 offset:21504
    v_mfma_f32_16x16x32_bf16 a[128:131], a[80:83], a[0:3], a[128:131]
    ds_read_b64_tr_b16 a[78:79], v14 offset:21760
    v_mfma_f32_16x16x32_bf16 a[144:147], a[80:83], a[4:7], a[144:147]
    v_mfma_f32_16x16x32_bf16 a[160:163], a[80:83], a[8:11], a[160:163]
    ds_read_b128 a[116:119], v11 offset:0
    v_mfma_f32_16x16x32_bf16 a[176:179], a[80:83], a[12:15], a[176:179]
    v_mfma_f32_16x16x32_bf16 a[192:195], a[80:83], a[16:19], a[192:195]
    v_mfma_f32_16x16x32_bf16 a[208:211], a[80:83], a[20:23], a[208:211]
    v_mfma_f32_16x16x32_bf16 a[224:227], a[80:83], a[24:27], a[224:227]
    ds_read_b64_tr_b16 a[104:105], v12 offset:24576
    v_mfma_f32_16x16x32_bf16 a[240:243], a[80:83], a[28:31], a[240:243]
    ds_read_b64_tr_b16 a[80:81], v12 offset:22528
    v_mfma_f32_16x16x32_bf16 a[132:135], a[84:87], a[0:3], a[132:135]
    ds_read_b64_tr_b16 a[82:83], v12 offset:22784
    v_mfma_f32_16x16x32_bf16 a[148:151], a[84:87], a[4:7], a[148:151]
    v_mfma_f32_16x16x32_bf16 a[164:167], a[84:87], a[8:11], a[164:167]
    ds_read_b64_tr_b16 a[106:107], v12 offset:24832
    v_mfma_f32_16x16x32_bf16 a[180:183], a[84:87], a[12:15], a[180:183]
    s_mov_b32 s81, 294912
    s_add_u32 m0, s3, 73728
    v_mfma_f32_16x16x32_bf16 a[196:199], a[84:87], a[16:19], a[196:199]
    buffer_load_dwordx4 v17, s[48:51], s81 offen lds
    v_mfma_f32_16x16x32_bf16 a[212:215], a[84:87], a[20:23], a[212:215]
    v_mfma_f32_16x16x32_bf16 a[228:231], a[84:87], a[24:27], a[228:231]
    ds_read_b64_tr_b16 a[108:109], v14 offset:24576
    v_mfma_f32_16x16x32_bf16 a[244:247], a[84:87], a[28:31], a[244:247]
    ds_read_b64_tr_b16 a[84:85], v14 offset:22528
    v_mfma_f32_16x16x32_bf16 a[136:139], a[88:91], a[0:3], a[136:139]
    ds_read_b64_tr_b16 a[86:87], v14 offset:22784
    v_mfma_f32_16x16x32_bf16 a[152:155], a[88:91], a[4:7], a[152:155]
    buffer_load_dwordx4 v18, s[48:51], s81 offen offset:1024 lds
    v_mfma_f32_16x16x32_bf16 a[168:171], a[88:91], a[8:11], a[168:171]
    ds_read_b64_tr_b16 a[110:111], v14 offset:24832
    v_mfma_f32_16x16x32_bf16 a[184:187], a[88:91], a[12:15], a[184:187]
    v_mfma_f32_16x16x32_bf16 a[200:203], a[88:91], a[16:19], a[200:203]
    v_mfma_f32_16x16x32_bf16 a[216:219], a[88:91], a[20:23], a[216:219]
    s_mov_b32 s80, 524288
    s_add_u32 m0, s3, 81920
    v_mfma_f32_16x16x32_bf16 a[232:235], a[88:91], a[24:27], a[232:235]
    ds_read_b64_tr_b16 a[124:125], v44 offset:20480
    buffer_load_dwordx4 v17, s[48:51], s80 offen lds
    v_mfma_f32_16x16x32_bf16 a[248:251], a[88:91], a[28:31], a[248:251]
    ds_read_b64_tr_b16 a[88:89], v12 offset:23552
    v_mfma_f32_16x16x32_bf16 a[140:143], a[92:95], a[0:3], a[140:143]
    ds_read_b64_tr_b16 a[90:91], v12 offset:23808
    v_mfma_f32_16x16x32_bf16 a[156:159], a[92:95], a[4:7], a[156:159]
    v_mfma_f32_16x16x32_bf16 a[172:175], a[92:95], a[8:11], a[172:175]
    ds_read_b64_tr_b16 a[126:127], v44 offset:20736
    v_mfma_f32_16x16x32_bf16 a[188:191], a[92:95], a[12:15], a[188:191]
    buffer_load_dwordx4 v18, s[48:51], s80 offen offset:1024 lds
    v_mfma_f32_16x16x32_bf16 a[204:207], a[92:95], a[16:19], a[204:207]
    v_mfma_f32_16x16x32_bf16 a[220:223], a[92:95], a[20:23], a[220:223]
    v_mfma_f32_16x16x32_bf16 a[236:239], a[92:95], a[24:27], a[236:239]
    v_mfma_f32_16x16x32_bf16 a[252:255], a[92:95], a[28:31], a[252:255]
    ds_read_b64_tr_b16 a[92:93], v14 offset:23552
    s_mov_b32 s81, 819200
    s_add_u32 m0, s3, 155648
    v_mfma_f32_16x16x32_bf16 v[48:51], a[96:99], a[0:3], v[48:51]
    ds_read_b64_tr_b16 a[94:95], v14 offset:23808
    buffer_load_dwordx4 v17, s[48:51], s81 offen lds
    v_mfma_f32_16x16x32_bf16 v[52:55], a[96:99], a[4:7], v[52:55]
    v_mfma_f32_16x16x32_bf16 v[64:67], a[96:99], a[8:11], v[64:67]
    v_mfma_f32_16x16x32_bf16 v[68:71], a[96:99], a[12:15], v[68:71]
    v_mfma_f32_16x16x32_bf16 v[80:83], a[96:99], a[16:19], v[80:83]
    v_mfma_f32_16x16x32_bf16 v[84:87], a[96:99], a[20:23], v[84:87]
    buffer_load_dwordx4 v18, s[48:51], s81 offen offset:1024 lds
    v_mfma_f32_16x16x32_bf16 v[96:99], a[96:99], a[24:27], v[96:99]
    v_mfma_f32_16x16x32_bf16 v[100:103], a[96:99], a[28:31], v[100:103]
    v_mfma_f32_16x16x32_bf16 v[56:59], a[100:103], a[0:3], v[56:59]
    v_mfma_f32_16x16x32_bf16 v[60:63], a[100:103], a[4:7], v[60:63]
    v_mfma_f32_16x16x32_bf16 v[72:75], a[100:103], a[8:11], v[72:75]
    v_mfma_f32_16x16x32_bf16 v[76:79], a[100:103], a[12:15], v[76:79]
    v_mfma_f32_16x16x32_bf16 v[88:91], a[100:103], a[16:19], v[88:91]
    v_mfma_f32_16x16x32_bf16 v[92:95], a[100:103], a[20:23], v[92:95]
    v_mfma_f32_16x16x32_bf16 v[104:107], a[100:103], a[24:27], v[104:107]
    v_mfma_f32_16x16x32_bf16 v[108:111], a[100:103], a[28:31], v[108:111]
    s_waitcnt vmcnt(17) lgkmcnt(0)
    s_barrier
    v_mfma_f32_16x16x32_bf16 v[120:123], a[116:119], a[124:127], v[120:123]
    v_mfma_f32_16x16x32_bf16 v[128:131], a[64:67], a[32:35], v[128:131]
    v_mfma_f32_16x16x32_bf16 v[144:147], a[64:67], a[36:39], v[144:147]
    s_mov_b32 s80, 0
    s_add_u32 m0, s3, 0
    v_mfma_f32_16x16x32_bf16 v[160:163], a[64:67], a[40:43], v[160:163]
    ds_read_b128 a[0:3], v8 offset:34816
    buffer_load_dwordx4 v17, s[48:51], s80 offen lds
    v_mfma_f32_16x16x32_bf16 v[176:179], a[64:67], a[44:47], v[176:179]
    s_xor_b32 s82, s65, 0
    v_mfma_f32_16x16x32_bf16 v[192:195], a[64:67], a[48:51], v[192:195]
    s_lshl_b32 s82, s82, 10
    v_mfma_f32_16x16x32_bf16 v[208:211], a[64:67], a[52:55], v[208:211]
    v_add_u32 v21, s82, v16
    v_mfma_f32_16x16x32_bf16 v[224:227], a[64:67], a[56:59], v[224:227]
    ds_read_b128 a[4:7], v8 offset:36864
    s_xor_b32 s82, s65, 1
    v_mfma_f32_16x16x32_bf16 v[240:243], a[64:67], a[60:63], v[240:243]
    ds_read_b64_tr_b16 a[64:65], v13 offset:0
    s_lshl_b32 s82, s82, 10
    v_mfma_f32_16x16x32_bf16 v[132:135], a[68:71], a[32:35], v[132:135]
    ds_read_b64_tr_b16 a[66:67], v13 offset:256
    v_add_u32 v22, s82, v16
    buffer_load_dwordx4 v18, s[48:51], s80 offen offset:1024 lds
    v_mfma_f32_16x16x32_bf16 v[148:151], a[68:71], a[36:39], v[148:151]
    s_xor_b32 s82, s65, 2
    v_mfma_f32_16x16x32_bf16 v[164:167], a[68:71], a[40:43], v[164:167]
    ds_read_b128 a[8:11], v8 offset:38912
    s_lshl_b32 s82, s82, 10
    v_mfma_f32_16x16x32_bf16 v[180:183], a[68:71], a[44:47], v[180:183]
    v_add_u32 v23, s82, v16
    v_mfma_f32_16x16x32_bf16 v[196:199], a[68:71], a[48:51], v[196:199]
    s_xor_b32 s82, s65, 3
    v_mfma_f32_16x16x32_bf16 v[212:215], a[68:71], a[52:55], v[212:215]
    s_lshl_b32 s82, s82, 10
    s_mov_b32 s81, 229376
    s_add_u32 m0, s3, 8192
    v_mfma_f32_16x16x32_bf16 v[228:231], a[68:71], a[56:59], v[228:231]
    ds_read_b128 a[12:15], v8 offset:40960
    v_add_u32 v24, s82, v16
    buffer_load_dwordx4 v17, s[48:51], s81 offen lds
    v_mfma_f32_16x16x32_bf16 v[244:247], a[68:71], a[60:63], v[244:247]
    ds_read_b64_tr_b16 a[68:69], v15 offset:0
    s_mov_b32 s94, 0xbdd2d3e8
    s_branch L_over3
L_stub3:
    s_branch L_stub5
L_over3:
    v_mfma_f32_16x16x32_bf16 v[136:139], a[72:75], a[32:35], v[136:139]
    ds_read_b64_tr_b16 a[70:71], v15 offset:256
    s_mov_b32 s95, 0xbdd2d3e8
    v_mfma_f32_16x16x32_bf16 v[152:155], a[72:75], a[36:39], v[152:155]
    v_mov_b32 v26, 0xc0135761
    v_mfma_f32_16x16x32_bf16 v[168:171], a[72:75], a[40:43], v[168:171]
    ds_read_b128 a[16:19], v8 offset:43008
    v_mov_b32 v27, 0xc0135761
    v_mfma_f32_16x16x32_bf16 v[184:187], a[72:75], a[44:47], v[184:187]
    v_mov_b32 v25, 1
    v_mfma_f32_16x16x32_bf16 v[200:203], a[72:75], a[48:51], v[200:203]
    s_lshl_b32 s82, s60, 12
    buffer_load_dwordx4 v18, s[48:51], s81 offen offset:1024 lds
    v_mfma_f32_16x16x32_bf16 v[216:219], a[72:75], a[52:55], v[216:219]
    s_add_u32 s68, s88, s82
    v_mfma_f32_16x16x32_bf16 v[232:235], a[72:75], a[56:59], v[232:235]
    ds_read_b128 a[20:23], v8 offset:45056
    s_lshl_b32 s82, s61, 13
    v_mfma_f32_16x16x32_bf16 v[248:251], a[72:75], a[60:63], v[248:251]
    ds_read_b64_tr_b16 a[72:73], v13 offset:1024
    s_add_u32 s88, s88, s82
    v_mfma_f32_16x16x32_bf16 v[140:143], a[76:79], a[32:35], v[140:143]
    ds_read_b64_tr_b16 a[74:75], v13 offset:1280
    s_lshr_b32 s82, s66, 1
    v_mfma_f32_16x16x32_bf16 v[156:159], a[76:79], a[36:39], v[156:159]
    s_add_u32 s82, s82, 24
    s_mov_b32 s80, 458752
    s_add_u32 m0, s3, 16384
    v_mfma_f32_16x16x32_bf16 v[172:175], a[76:79], a[40:43], v[172:175]
    ds_read_b128 a[24:27], v8 offset:47104
    s_lshl_b32 s82, s82, 14
    buffer_load_dwordx4 v17, s[48:51], s80 offen lds
    v_mfma_f32_16x16x32_bf16 v[188:191], a[76:79], a[44:47], v[188:191]
    s_add_u32 s90, s88, s82
    v_mfma_f32_16x16x32_bf16 v[204:207], a[76:79], a[48:51], v[204:207]
    s_lshl_b32 s82, s66, 14
    v_mfma_f32_16x16x32_bf16 v[220:223], a[76:79], a[52:55], v[220:223]
    s_add_u32 s88, s88, s82
    v_mfma_f32_16x16x32_bf16 v[236:239], a[76:79], a[56:59], v[236:239]
    ds_read_b128 a[28:31], v8 offset:49152
    s_add_u32 s89, s88, 262144
    v_mfma_f32_16x16x32_bf16 v[252:255], a[76:79], a[60:63], v[252:255]
    ds_read_b64_tr_b16 a[76:77], v15 offset:1024
    s_add_u32 s88, s88, 131072
    v_mfma_f32_16x16x32_bf16 a[128:131], a[80:83], a[32:35], a[128:131]
    ds_read_b64_tr_b16 a[78:79], v15 offset:1280
    s_mov_b32 s76, s93
    buffer_load_dwordx4 v18, s[48:51], s80 offen offset:1024 lds
    v_mfma_f32_16x16x32_bf16 a[144:147], a[80:83], a[36:39], a[144:147]
    s_lshl_b32 s82, s63, 4
    v_mfma_f32_16x16x32_bf16 a[160:163], a[80:83], a[40:43], a[160:163]
    ds_read_b128 a[112:115], v10 offset:34816
    s_lshl_b32 s83, s61, 3
    v_mfma_f32_16x16x32_bf16 a[176:179], a[80:83], a[44:47], a[176:179]
    s_add_u32 s83, s83, s82
    v_mfma_f32_16x16x32_bf16 a[192:195], a[80:83], a[48:51], a[192:195]
    s_add_u32 s83, s83, s65
    v_mfma_f32_16x16x32_bf16 a[208:211], a[80:83], a[52:55], a[208:211]
    s_lshl_b32 s83, s83, 15
    s_mov_b32 s81, 688128
    s_add_u32 m0, s3, 24576
    v_mfma_f32_16x16x32_bf16 a[224:227], a[80:83], a[56:59], a[224:227]
    ds_read_b64_tr_b16 a[96:97], v13 offset:4096
    s_add_u32 s69, s83, 4194304
    buffer_load_dwordx4 v17, s[48:51], s81 offen lds
    v_mfma_f32_16x16x32_bf16 a[240:243], a[80:83], a[60:63], a[240:243]
    ds_read_b64_tr_b16 a[80:81], v13 offset:2048
    s_lshl_b32 s84, s63, 3
    v_mfma_f32_16x16x32_bf16 a[132:135], a[84:87], a[32:35], a[132:135]
    ds_read_b64_tr_b16 a[82:83], v13 offset:2304
    s_add_u32 s84, s84, s66
    v_mfma_f32_16x16x32_bf16 a[148:151], a[84:87], a[36:39], a[148:151]
    s_lshl_b32 s85, s84, 2
    v_mfma_f32_16x16x32_bf16 a[164:167], a[84:87], a[40:43], a[164:167]
    ds_read_b64_tr_b16 a[98:99], v13 offset:4352
    s_add_u32 s85, s85, s60
    v_mfma_f32_16x16x32_bf16 a[180:183], a[84:87], a[44:47], a[180:183]
    s_lshl_b32 s85, s85, 8
    v_mfma_f32_16x16x32_bf16 a[196:199], a[84:87], a[48:51], a[196:199]
    s_add_u32 s77, s85, 39862272
    buffer_load_dwordx4 v18, s[48:51], s81 offen offset:1024 lds
    v_mfma_f32_16x16x32_bf16 a[212:215], a[84:87], a[52:55], a[212:215]
    s_lshl_b32 s84, s84, 18
    v_mfma_f32_16x16x32_bf16 a[228:231], a[84:87], a[56:59], a[228:231]
    ds_read_b64_tr_b16 a[100:101], v15 offset:4096
    s_lshl_b32 s85, s60, 12
    v_mfma_f32_16x16x32_bf16 a[244:247], a[84:87], a[60:63], a[244:247]
    ds_read_b64_tr_b16 a[84:85], v15 offset:2048
    s_add_u32 s84, s84, s85
    v_mfma_f32_16x16x32_bf16 a[136:139], a[88:91], a[32:35], a[136:139]
    ds_read_b64_tr_b16 a[86:87], v15 offset:2304
    s_add_u32 s84, s84, 23068672
    v_mfma_f32_16x16x32_bf16 a[152:155], a[88:91], a[36:39], a[152:155]
    s_xor_b32 s85, s65, 1
    s_mov_b32 s81, 753664
    s_add_u32 m0, s3, 90112
    v_mfma_f32_16x16x32_bf16 a[168:171], a[88:91], a[40:43], a[168:171]
    ds_read_b64_tr_b16 a[102:103], v15 offset:4352
    s_lshl_b32 s85, s85, 16
    buffer_load_dwordx4 v17, s[48:51], s81 offen lds
    v_mfma_f32_16x16x32_bf16 a[184:187], a[88:91], a[44:47], a[184:187]
    s_add_u32 s70, s84, s85
    v_mfma_f32_16x16x32_bf16 a[200:203], a[88:91], a[48:51], a[200:203]
    v_mfma_f32_16x16x32_bf16 a[216:219], a[88:91], a[52:55], a[216:219]
    v_mfma_f32_16x16x32_bf16 a[232:235], a[88:91], a[56:59], a[232:235]
    ds_read_b64_tr_b16 a[120:121], v45 offset:0
    v_mfma_f32_16x16x32_bf16 a[248:251], a[88:91], a[60:63], a[248:251]
    ds_read_b64_tr_b16 a[88:89], v13 offset:3072
    v_mfma_f32_16x16x32_bf16 a[140:143], a[92:95], a[32:35], a[140:143]
    ds_read_b64_tr_b16 a[90:91], v13 offset:3328
    buffer_load_dwordx4 v18, s[48:51], s81 offen offset:1024 lds
    v_mfma_f32_16x16x32_bf16 a[156:159], a[92:95], a[36:39], a[156:159]
    v_mfma_f32_16x16x32_bf16 a[172:175], a[92:95], a[40:43], a[172:175]
    ds_read_b64_tr_b16 a[122:123], v45 offset:256
    v_mfma_f32_16x16x32_bf16 a[188:191], a[92:95], a[44:47], a[188:191]
    v_mfma_f32_16x16x32_bf16 a[204:207], a[92:95], a[48:51], a[204:207]
    v_mfma_f32_16x16x32_bf16 a[220:223], a[92:95], a[52:55], a[220:223]
    s_mov_b32 s80, 983040
    s_add_u32 m0, s3, 98304
    v_mfma_f32_16x16x32_bf16 a[236:239], a[92:95], a[56:59], a[236:239]
    buffer_load_dwordx4 v17, s[48:51], s80 offen lds
    v_mfma_f32_16x16x32_bf16 a[252:255], a[92:95], a[60:63], a[252:255]
    ds_read_b64_tr_b16 a[92:93], v15 offset:3072
    v_mfma_f32_16x16x32_bf16 v[48:51], a[104:107], a[32:35], v[48:51]
    ds_read_b64_tr_b16 a[94:95], v15 offset:3328
    v_mfma_f32_16x16x32_bf16 v[52:55], a[104:107], a[36:39], v[52:55]
    v_mfma_f32_16x16x32_bf16 v[64:67], a[104:107], a[40:43], v[64:67]
    v_mfma_f32_16x16x32_bf16 v[68:71], a[104:107], a[44:47], v[68:71]
    v_mfma_f32_16x16x32_bf16 v[80:83], a[104:107], a[48:51], v[80:83]
    buffer_load_dwordx4 v18, s[48:51], s80 offen offset:1024 lds
    v_mfma_f32_16x16x32_bf16 v[84:87], a[104:107], a[52:55], v[84:87]
    v_mfma_f32_16x16x32_bf16 v[96:99], a[104:107], a[56:59], v[96:99]
    v_mfma_f32_16x16x32_bf16 v[100:103], a[104:107], a[60:63], v[100:103]
    v_mfma_f32_16x16x32_bf16 v[56:59], a[108:111], a[32:35], v[56:59]
    v_mfma_f32_16x16x32_bf16 v[60:63], a[108:111], a[36:39], v[60:63]
    v_mfma_f32_16x16x32_bf16 v[72:75], a[108:111], a[40:43], v[72:75]
    v_mfma_f32_16x16x32_bf16 v[76:79], a[108:111], a[44:47], v[76:79]
    v_mfma_f32_16x16x32_bf16 v[88:91], a[108:111], a[48:51], v[88:91]
    v_mfma_f32_16x16x32_bf16 v[92:95], a[108:111], a[52:55], v[92:95]
    v_mfma_f32_16x16x32_bf16 v[104:107], a[108:111], a[56:59], v[104:107]
    v_mfma_f32_16x16x32_bf16 v[108:111], a[108:111], a[60:63], v[108:111]
    s_waitcnt vmcnt(19) lgkmcnt(0)
    s_barrier
    v_mfma_f32_16x16x32_bf16 v[120:123], a[112:115], a[120:123], v[120:123]
    v_mfma_f32_16x16x32_bf16 v[128:131], a[64:67], a[0:3], v[128:131]
    v_mfma_f32_16x16x32_bf16 v[144:147], a[64:67], a[4:7], v[144:147]
    s_mov_b32 s81, 1212416
    s_add_u32 m0, s3, 106496
    v_mfma_f32_16x16x32_bf16 v[160:163], a[64:67], a[8:11], v[160:163]
    ds_read_b128 a[32:35], v9 offset:34816
    buffer_load_dwordx4 v17, s[48:51], s81 offen lds
    v_mfma_f32_16x16x32_bf16 v[176:179], a[64:67], a[12:15], v[176:179]
    s_add_u32 s70, s70, 16384
    v_mfma_f32_16x16x32_bf16 v[192:195], a[64:67], a[16:19], v[192:195]
    s_lshl_b32 s85, s65, 16
    v_mfma_f32_16x16x32_bf16 v[208:211], a[64:67], a[20:23], v[208:211]
    s_add_u32 s73, s84, s85
    v_mfma_f32_16x16x32_bf16 v[224:227], a[64:67], a[24:27], v[224:227]
    ds_read_b128 a[36:39], v9 offset:36864
    s_add_u32 s73, s73, 16384
    v_mfma_f32_16x16x32_bf16 v[240:243], a[64:67], a[28:31], v[240:243]
    ds_read_b64_tr_b16 a[64:65], v13 offset:20480
    s_xor_b32 s85, s65, 2
    v_mfma_f32_16x16x32_bf16 v[132:135], a[68:71], a[0:3], v[132:135]
    ds_read_b64_tr_b16 a[66:67], v13 offset:20736
    s_lshl_b32 s85, s85, 16
    v_mfma_f32_16x16x32_bf16 v[148:151], a[68:71], a[4:7], v[148:151]
    s_add_u32 s71, s84, s85
    v_mfma_f32_16x16x32_bf16 v[164:167], a[68:71], a[8:11], v[164:167]
    ds_read_b128 a[40:43], v9 offset:38912
    s_add_u32 s71, s71, 32768
    v_mfma_f32_16x16x32_bf16 v[180:183], a[68:71], a[12:15], v[180:183]
    s_lshl_b32 s85, s65, 16
    v_mfma_f32_16x16x32_bf16 v[196:199], a[68:71], a[16:19], v[196:199]
    s_add_u32 s74, s84, s85
    v_mfma_f32_16x16x32_bf16 v[212:215], a[68:71], a[20:23], v[212:215]
    s_add_u32 s74, s74, 32768
    v_mfma_f32_16x16x32_bf16 v[228:231], a[68:71], a[24:27], v[228:231]
    ds_read_b128 a[44:47], v9 offset:40960
    s_xor_b32 s85, s65, 3
    buffer_load_dwordx4 v18, s[48:51], s81 offen offset:1024 lds
    v_mfma_f32_16x16x32_bf16 v[244:247], a[68:71], a[28:31], v[244:247]
    ds_read_b64_tr_b16 a[68:69], v15 offset:20480
    s_lshl_b32 s85, s85, 16
    v_mfma_f32_16x16x32_bf16 v[136:139], a[72:75], a[0:3], v[136:139]
    ds_read_b64_tr_b16 a[70:71], v15 offset:20736
    s_add_u32 s72, s84, s85
    v_mfma_f32_16x16x32_bf16 v[152:155], a[72:75], a[4:7], v[152:155]
    s_add_u32 s72, s72, 49152
    v_mfma_f32_16x16x32_bf16 v[168:171], a[72:75], a[8:11], v[168:171]
    ds_read_b128 a[48:51], v9 offset:43008
    s_lshl_b32 s85, s65, 16
    v_mfma_f32_16x16x32_bf16 v[184:187], a[72:75], a[12:15], v[184:187]
    s_add_u32 s75, s84, s85
    v_mfma_f32_16x16x32_bf16 v[200:203], a[72:75], a[16:19], v[200:203]
    s_add_u32 s75, s75, 49152
    v_mfma_f32_16x16x32_bf16 v[216:219], a[72:75], a[20:23], v[216:219]
    v_and_b32 v36, 1, v34
    v_mfma_f32_16x16x32_bf16 v[232:235], a[72:75], a[24:27], v[232:235]
    ds_read_b128 a[52:55], v9 offset:45056
    v_lshlrev_b32 v36, 10, v36
    v_mfma_f32_16x16x32_bf16 v[248:251], a[72:75], a[28:31], v[248:251]
    ds_read_b64_tr_b16 a[72:73], v13 offset:21504
    v_lshrrev_b32 v34, 1, v34
    v_mfma_f32_16x16x32_bf16 v[140:143], a[76:79], a[0:3], v[140:143]
    ds_read_b64_tr_b16 a[74:75], v13 offset:21760
    v_lshl_add_u32 v36, v34, 8, v36
    v_mfma_f32_16x16x32_bf16 v[156:159], a[76:79], a[4:7], v[156:159]
    v_lshl_add_u32 v36, v35, 4, v36
    s_mov_b32 s80, 1441792
    s_add_u32 m0, s3, 114688
    v_mfma_f32_16x16x32_bf16 v[172:175], a[76:79], a[8:11], v[172:175]
    ds_read_b128 a[56:59], v9 offset:47104
    s_and_b32 s82, s66, 1
    buffer_load_dwordx4 v17, s[48:51], s80 offen lds
    v_mfma_f32_16x16x32_bf16 v[188:191], a[76:79], a[12:15], v[188:191]
    s_lshl_b32 s82, s82, 9
    v_mfma_f32_16x16x32_bf16 v[204:207], a[76:79], a[16:19], v[204:207]
    v_add_u32 v28, s82, v36
    v_mfma_f32_16x16x32_bf16 v[220:223], a[76:79], a[20:23], v[220:223]
    v_mov_b32 v29, 0x100
    v_mfma_f32_16x16x32_bf16 v[236:239], a[76:79], a[24:27], v[236:239]
    ds_read_b128 a[60:63], v9 offset:49152
    v_mov_b32 v42, 0x10000
    v_mfma_f32_16x16x32_bf16 v[252:255], a[76:79], a[28:31], v[252:255]
    ds_read_b64_tr_b16 a[76:77], v15 offset:21504
    s_mov_b32 s93, s92
    v_mfma_f32_16x16x32_bf16 a[128:131], a[80:83], a[0:3], a[128:131]
    ds_read_b64_tr_b16 a[78:79], v15 offset:21760
    s_lshl_b32 s82, s63, 2
    v_mfma_f32_16x16x32_bf16 a[144:147], a[80:83], a[4:7], a[144:147]
    s_add_u32 s82, s82, s60
    v_mfma_f32_16x16x32_bf16 a[160:163], a[80:83], a[8:11], a[160:163]
    ds_read_b128 a[116:119], v11 offset:34816
    s_lshl_b32 s82, s82, 2
    v_mfma_f32_16x16x32_bf16 a[176:179], a[80:83], a[12:15], a[176:179]
    s_add_u32 s82, s82, s65
    v_mfma_f32_16x16x32_bf16 a[192:195], a[80:83], a[16:19], a[192:195]
    s_lshl_b32 s82, s82, 15
    v_mfma_f32_16x16x32_bf16 a[208:211], a[80:83], a[20:23], a[208:211]
    s_lshl_b32 s83, s66, 8
    v_mfma_f32_16x16x32_bf16 a[224:227], a[80:83], a[24:27], a[224:227]
    ds_read_b64_tr_b16 a[104:105], v13 offset:24576
    s_add_u32 s82, s82, s83
    buffer_load_dwordx4 v18, s[48:51], s80 offen offset:1024 lds
    v_mfma_f32_16x16x32_bf16 a[240:243], a[80:83], a[28:31], a[240:243]
    ds_read_b64_tr_b16 a[80:81], v13 offset:22528
    v_and_b32 v34, 15, v0
    v_mfma_f32_16x16x32_bf16 a[132:135], a[84:87], a[0:3], a[132:135]
    ds_read_b64_tr_b16 a[82:83], v13 offset:22784
    v_lshrrev_b32 v35, 4, v0
    v_mfma_f32_16x16x32_bf16 a[148:151], a[84:87], a[4:7], a[148:151]
    v_lshlrev_b32 v36, 11, v34
    v_mfma_f32_16x16x32_bf16 a[164:167], a[84:87], a[8:11], a[164:167]
    ds_read_b64_tr_b16 a[106:107], v13 offset:24832
    v_add_u32 v36, s82, v36
    v_mfma_f32_16x16x32_bf16 a[180:183], a[84:87], a[12:15], a[180:183]
    v_and_b32 v2, 1, v35
    v_mfma_f32_16x16x32_bf16 a[196:199], a[84:87], a[16:19], a[196:199]
    v_lshl_add_u32 v36, v2, 5, v36
    v_mfma_f32_16x16x32_bf16 a[212:215], a[84:87], a[20:23], a[212:215]
    v_lshrrev_b32 v2, 1, v35
    v_mfma_f32_16x16x32_bf16 a[228:231], a[84:87], a[24:27], a[228:231]
    ds_read_b64_tr_b16 a[108:109], v15 offset:24576
    v_lshl_add_u32 v2, v2, 4, v36
    v_mfma_f32_16x16x32_bf16 a[244:247], a[84:87], a[28:31], a[244:247]
    ds_read_b64_tr_b16 a[84:85], v15 offset:22528
    v_lshrrev_b32 v36, 3, v34
    v_mfma_f32_16x16x32_bf16 a[136:139], a[88:91], a[0:3], a[136:139]
    ds_read_b64_tr_b16 a[86:87], v15 offset:22784
    v_mul_u32_u24 v36, 16320, v36
    v_mfma_f32_16x16x32_bf16 a[152:155], a[88:91], a[4:7], a[152:155]
    v_sub_u32 v1, v2, v36
    s_mov_b32 s81, 1671168
    s_add_u32 m0, s3, 122880
    v_mfma_f32_16x16x32_bf16 a[168:171], a[88:91], a[8:11], a[168:171]
    ds_read_b64_tr_b16 a[110:111], v15 offset:24832
    v_xor_b32 v5, 64, v1
    buffer_load_dwordx4 v17, s[48:51], s81 offen lds
    v_mfma_f32_16x16x32_bf16 a[184:187], a[88:91], a[12:15], a[184:187]
    v_add_u32 v5, 16384, v5
    v_mfma_f32_16x16x32_bf16 a[200:203], a[88:91], a[16:19], a[200:203]
    v_mfma_f32_16x16x32_bf16 a[216:219], a[88:91], a[20:23], a[216:219]
    v_mfma_f32_16x16x32_bf16 a[232:235], a[88:91], a[24:27], a[232:235]
    ds_read_b64_tr_b16 a[124:125], v45 offset:20480
    v_mfma_f32_16x16x32_bf16 a[248:251], a[88:91], a[28:31], a[248:251]
    ds_read_b64_tr_b16 a[88:89], v13 offset:23552
    v_mfma_f32_16x16x32_bf16 a[140:143], a[92:95], a[0:3], a[140:143]
    ds_read_b64_tr_b16 a[90:91], v13 offset:23808
    v_mfma_f32_16x16x32_bf16 a[156:159], a[92:95], a[4:7], a[156:159]
    v_mfma_f32_16x16x32_bf16 a[172:175], a[92:95], a[8:11], a[172:175]
    ds_read_b64_tr_b16 a[126:127], v45 offset:20736
    v_mfma_f32_16x16x32_bf16 a[188:191], a[92:95], a[12:15], a[188:191]
    v_mfma_f32_16x16x32_bf16 a[204:207], a[92:95], a[16:19], a[204:207]
    v_mfma_f32_16x16x32_bf16 a[220:223], a[92:95], a[20:23], a[220:223]
    v_mfma_f32_16x16x32_bf16 a[236:239], a[92:95], a[24:27], a[236:239]
    buffer_load_dwordx4 v18, s[48:51], s81 offen offset:1024 lds
    v_mfma_f32_16x16x32_bf16 a[252:255], a[92:95], a[28:31], a[252:255]
    ds_read_b64_tr_b16 a[92:93], v15 offset:23552
    v_mfma_f32_16x16x32_bf16 v[48:51], a[96:99], a[0:3], v[48:51]
    ds_read_b64_tr_b16 a[94:95], v15 offset:23808
    v_mfma_f32_16x16x32_bf16 v[52:55], a[96:99], a[4:7], v[52:55]
    v_mfma_f32_16x16x32_bf16 v[64:67], a[96:99], a[8:11], v[64:67]
    v_mfma_f32_16x16x32_bf16 v[68:71], a[96:99], a[12:15], v[68:71]
    v_mfma_f32_16x16x32_bf16 v[80:83], a[96:99], a[16:19], v[80:83]
    v_mfma_f32_16x16x32_bf16 v[84:87], a[96:99], a[20:23], v[84:87]
    v_mfma_f32_16x16x32_bf16 v[96:99], a[96:99], a[24:27], v[96:99]
    v_mfma_f32_16x16x32_bf16 v[100:103], a[96:99], a[28:31], v[100:103]
    v_mfma_f32_16x16x32_bf16 v[56:59], a[100:103], a[0:3], v[56:59]
    v_mfma_f32_16x16x32_bf16 v[60:63], a[100:103], a[4:7], v[60:63]
    v_mfma_f32_16x16x32_bf16 v[72:75], a[100:103], a[8:11], v[72:75]
    v_mfma_f32_16x16x32_bf16 v[76:79], a[100:103], a[12:15], v[76:79]
    v_mfma_f32_16x16x32_bf16 v[88:91], a[100:103], a[16:19], v[88:91]
    v_mfma_f32_16x16x32_bf16 v[92:95], a[100:103], a[20:23], v[92:95]
    v_mfma_f32_16x16x32_bf16 v[104:107], a[100:103], a[24:27], v[104:107]
    v_mfma_f32_16x16x32_bf16 v[108:111], a[100:103], a[28:31], v[108:111]
    s_waitcnt lgkmcnt(0)
    s_barrier
    v_mfma_f32_16x16x32_bf16 v[120:123], a[116:119], a[124:127], v[120:123]
    s_lshl_b32 s82, s62, 3
    s_add_u32 s82, s82, s61
    v_mfma_f32_16x16x32_bf16 v[128:131], a[64:67], a[32:35], v[128:131]
    s_lshl_b32 s82, s82, 10
    s_add_u32 s82, s82, 139264
    v_mfma_f32_16x16x32_bf16 v[144:147], a[64:67], a[36:39], v[144:147]
    s_mov_b32 s80, 917504
    s_add_u32 m0, s3, 32768
    v_add_u32 v44, s82, v16
    s_lshl_b32 s82, s61, 12
    v_mfma_f32_16x16x32_bf16 v[160:163], a[64:67], a[40:43], v[160:163]
    buffer_load_dwordx4 v17, s[48:51], s80 offen lds
    s_add_u32 s82, s82, 139264
    v_add_u32 v45, s82, v16
    v_mfma_f32_16x16x32_bf16 v[176:179], a[64:67], a[44:47], v[176:179]
    v_lshrrev_b32 v34, 2, v0
    v_mfma_f32_16x16x32_bf16 v[192:195], a[64:67], a[48:51], v[192:195]
    ds_write_b128 v44, v[120:123]
    v_and_b32 v35, 3, v0
    v_mfma_f32_16x16x32_bf16 v[208:211], a[64:67], a[52:55], v[208:211]
    v_lshlrev_b32 v35, 3, v35
    v_mfma_f32_16x16x32_bf16 v[224:227], a[64:67], a[56:59], v[224:227]
    buffer_load_dwordx4 v18, s[48:51], s80 offen offset:1024 lds
    v_lshl_add_u32 v35, v34, 8, v35
    v_mfma_f32_16x16x32_bf16 v[240:243], a[64:67], a[60:63], v[240:243]
    v_and_b32 v34, 7, v34
    v_mfma_f32_16x16x32_bf16 v[132:135], a[68:71], a[32:35], v[132:135]
    v_xor_b32 v36, 0, v34
    v_mfma_f32_16x16x32_bf16 v[148:151], a[68:71], a[36:39], v[148:151]
    v_lshl_add_u32 v8, v36, 5, v35
    v_mfma_f32_16x16x32_bf16 v[164:167], a[68:71], a[40:43], v[164:167]
    s_mov_b32 s81, 1146880
    s_add_u32 m0, s3, 40960
    v_xor_b32 v36, 1, v34
    v_mfma_f32_16x16x32_bf16 v[180:183], a[68:71], a[44:47], v[180:183]
    buffer_load_dwordx4 v17, s[48:51], s81 offen lds
    v_lshl_add_u32 v9, v36, 5, v35
    v_mfma_f32_16x16x32_bf16 v[196:199], a[68:71], a[48:51], v[196:199]
    v_xor_b32 v36, 2, v34
    v_mfma_f32_16x16x32_bf16 v[212:215], a[68:71], a[52:55], v[212:215]
    v_lshl_add_u32 v10, v36, 5, v35
    v_mfma_f32_16x16x32_bf16 v[228:231], a[68:71], a[56:59], v[228:231]
    v_xor_b32 v36, 3, v34
    v_mfma_f32_16x16x32_bf16 v[244:247], a[68:71], a[60:63], v[244:247]
    buffer_load_dwordx4 v18, s[48:51], s81 offen offset:1024 lds
    v_lshl_add_u32 v11, v36, 5, v35
    v_mfma_f32_16x16x32_bf16 v[136:139], a[72:75], a[32:35], v[136:139]
    v_xor_b32 v36, 4, v34
    v_mfma_f32_16x16x32_bf16 v[152:155], a[72:75], a[36:39], v[152:155]
    v_lshl_add_u32 v12, v36, 5, v35
    v_mfma_f32_16x16x32_bf16 v[168:171], a[72:75], a[40:43], v[168:171]
    v_xor_b32 v36, 5, v34
    v_mfma_f32_16x16x32_bf16 v[184:187], a[72:75], a[44:47], v[184:187]
    s_mov_b32 s80, 1376256
    s_add_u32 m0, s3, 49152
    v_lshl_add_u32 v13, v36, 5, v35
    v_mfma_f32_16x16x32_bf16 v[200:203], a[72:75], a[48:51], v[200:203]
    buffer_load_dwordx4 v17, s[48:51], s80 offen lds
    v_xor_b32 v36, 6, v34
    v_mfma_f32_16x16x32_bf16 v[216:219], a[72:75], a[52:55], v[216:219]
    v_lshl_add_u32 v14, v36, 5, v35
    v_mfma_f32_16x16x32_bf16 v[232:235], a[72:75], a[56:59], v[232:235]
    v_xor_b32 v36, 7, v34
    v_mfma_f32_16x16x32_bf16 v[248:251], a[72:75], a[60:63], v[248:251]
    v_lshl_add_u32 v15, v36, 5, v35
    v_mfma_f32_16x16x32_bf16 v[140:143], a[76:79], a[32:35], v[140:143]
    buffer_load_dwordx4 v18, s[48:51], s80 offen offset:1024 lds
    v_mfma_f32_16x16x32_bf16 v[156:159], a[76:79], a[36:39], v[156:159]
    v_mfma_f32_16x16x32_bf16 v[172:175], a[76:79], a[40:43], v[172:175]
    v_mfma_f32_16x16x32_bf16 v[188:191], a[76:79], a[44:47], v[188:191]
    v_mfma_f32_16x16x32_bf16 v[204:207], a[76:79], a[48:51], v[204:207]
    s_mov_b32 s81, 1605632
    s_add_u32 m0, s3, 57344
    v_mfma_f32_16x16x32_bf16 v[220:223], a[76:79], a[52:55], v[220:223]
    buffer_load_dwordx4 v17, s[48:51], s81 offen lds
    v_mfma_f32_16x16x32_bf16 v[236:239], a[76:79], a[56:59], v[236:239]
    v_mfma_f32_16x16x32_bf16 v[252:255], a[76:79], a[60:63], v[252:255]
    v_mfma_f32_16x16x32_bf16 a[128:131], a[80:83], a[32:35], a[128:131]
    v_mfma_f32_16x16x32_bf16 a[144:147], a[80:83], a[36:39], a[144:147]
    buffer_load_dwordx4 v18, s[48:51], s81 offen offset:1024 lds
    v_mfma_f32_16x16x32_bf16 a[160:163], a[80:83], a[40:43], a[160:163]
    v_mfma_f32_16x16x32_bf16 a[176:179], a[80:83], a[44:47], a[176:179]
    v_mfma_f32_16x16x32_bf16 a[192:195], a[80:83], a[48:51], a[192:195]
    v_mfma_f32_16x16x32_bf16 a[208:211], a[80:83], a[52:55], a[208:211]
    s_mov_b32 s80, 65536
    s_add_u32 m0, s3, 65536
    v_mfma_f32_16x16x32_bf16 a[224:227], a[80:83], a[56:59], a[224:227]
    buffer_load_dwordx4 v17, s[48:51], s80 offen lds
    v_mfma_f32_16x16x32_bf16 a[240:243], a[80:83], a[60:63], a[240:243]
    v_mfma_f32_16x16x32_bf16 a[132:135], a[84:87], a[32:35], a[132:135]
    v_mfma_f32_16x16x32_bf16 a[148:151], a[84:87], a[36:39], a[148:151]
    v_mfma_f32_16x16x32_bf16 a[164:167], a[84:87], a[40:43], a[164:167]
    buffer_load_dwordx4 v18, s[48:51], s80 offen offset:1024 lds
    v_mfma_f32_16x16x32_bf16 a[180:183], a[84:87], a[44:47], a[180:183]
    v_mfma_f32_16x16x32_bf16 a[196:199], a[84:87], a[48:51], a[196:199]
    v_mfma_f32_16x16x32_bf16 a[212:215], a[84:87], a[52:55], a[212:215]
    v_mfma_f32_16x16x32_bf16 a[228:231], a[84:87], a[56:59], a[228:231]
    s_mov_b32 s80, 131072
    s_add_u32 m0, s3, 131072
    v_mfma_f32_16x16x32_bf16 a[244:247], a[84:87], a[60:63], a[244:247]
    buffer_load_dwordx4 v17, s[48:51], s80 offen lds
    v_mfma_f32_16x16x32_bf16 a[136:139], a[88:91], a[32:35], a[136:139]
    v_mfma_f32_16x16x32_bf16 a[152:155], a[88:91], a[36:39], a[152:155]
    v_mfma_f32_16x16x32_bf16 a[168:171], a[88:91], a[40:43], a[168:171]
    v_mfma_f32_16x16x32_bf16 a[184:187], a[88:91], a[44:47], a[184:187]
    buffer_load_dwordx4 v18, s[48:51], s80 offen offset:1024 lds
    v_mfma_f32_16x16x32_bf16 a[200:203], a[88:91], a[48:51], a[200:203]
    v_mfma_f32_16x16x32_bf16 a[216:219], a[88:91], a[52:55], a[216:219]
    v_mfma_f32_16x16x32_bf16 a[232:235], a[88:91], a[56:59], a[232:235]
    v_mfma_f32_16x16x32_bf16 a[248:251], a[88:91], a[60:63], a[248:251]
    s_mov_b32 s81, 360448
    s_add_u32 m0, s3, 139264
    v_mfma_f32_16x16x32_bf16 a[140:143], a[92:95], a[32:35], a[140:143]
    buffer_load_dwordx4 v17, s[48:51], s81 offen lds
    v_mfma_f32_16x16x32_bf16 a[156:159], a[92:95], a[36:39], a[156:159]
    v_mfma_f32_16x16x32_bf16 a[172:175], a[92:95], a[40:43], a[172:175]
    v_mfma_f32_16x16x32_bf16 a[188:191], a[92:95], a[44:47], a[188:191]
    v_mfma_f32_16x16x32_bf16 a[204:207], a[92:95], a[48:51], a[204:207]
    buffer_load_dwordx4 v18, s[48:51], s81 offen offset:1024 lds
    v_mfma_f32_16x16x32_bf16 a[220:223], a[92:95], a[52:55], a[220:223]
    v_mfma_f32_16x16x32_bf16 a[236:239], a[92:95], a[56:59], a[236:239]
    v_mfma_f32_16x16x32_bf16 a[252:255], a[92:95], a[60:63], a[252:255]
    v_mfma_f32_16x16x32_bf16 v[48:51], a[104:107], a[32:35], v[48:51]
    s_mov_b32 s80, 589824
    s_add_u32 m0, s3, 147456
    v_mfma_f32_16x16x32_bf16 v[52:55], a[104:107], a[36:39], v[52:55]
    buffer_load_dwordx4 v17, s[48:51], s80 offen lds
    v_mfma_f32_16x16x32_bf16 v[64:67], a[104:107], a[40:43], v[64:67]
    v_mfma_f32_16x16x32_bf16 v[68:71], a[104:107], a[44:47], v[68:71]
    v_mfma_f32_16x16x32_bf16 v[80:83], a[104:107], a[48:51], v[80:83]
    v_mfma_f32_16x16x32_bf16 v[84:87], a[104:107], a[52:55], v[84:87]
    buffer_load_dwordx4 v18, s[48:51], s80 offen offset:1024 lds
    v_mfma_f32_16x16x32_bf16 v[96:99], a[104:107], a[56:59], v[96:99]
    v_mfma_f32_16x16x32_bf16 v[100:103], a[104:107], a[60:63], v[100:103]
    v_mfma_f32_16x16x32_bf16 v[56:59], a[108:111], a[32:35], v[56:59]
    v_mfma_f32_16x16x32_bf16 v[60:63], a[108:111], a[36:39], v[60:63]
    v_mfma_f32_16x16x32_bf16 v[72:75], a[108:111], a[40:43], v[72:75]
    v_mfma_f32_16x16x32_bf16 v[76:79], a[108:111], a[44:47], v[76:79]
    v_mfma_f32_16x16x32_bf16 v[88:91], a[108:111], a[48:51], v[88:91]
    v_mfma_f32_16x16x32_bf16 v[92:95], a[108:111], a[52:55], v[92:95]
    v_mfma_f32_16x16x32_bf16 v[104:107], a[108:111], a[56:59], v[104:107]
    v_mfma_f32_16x16x32_bf16 v[108:111], a[108:111], a[60:63], v[108:111]
    s_waitcnt lgkmcnt(0)
    s_barrier
L_epi:
    global_load_dwordx4 a[112:115], v1, s[8:9] offset:0
    global_load_dwordx4 a[116:119], v5, s[8:9] offset:0
    global_load_dwordx4 a[120:123], v1, s[8:9] offset:128
    global_load_dwordx4 a[124:127], v5, s[8:9] offset:128
    v_pk_mul_f32 v[34:35], v[128:129], v[128:129]
    v_pk_mul_f32 v[36:37], v[130:131], v[130:131]
    v_pk_mul_f32 v[38:39], v[132:133], v[132:133]
    v_pk_mul_f32 v[40:41], v[134:135], v[134:135]
    v_pk_fma_f32 v[34:35], v[34:35], s[94:95], v[26:27]
    v_pk_fma_f32 v[36:37], v[36:37], s[94:95], v[26:27]
    v_pk_fma_f32 v[38:39], v[38:39], s[94:95], v[26:27]
    v_pk_fma_f32 v[40:41], v[40:41], s[94:95], v[26:27]
    v_pk_mul_f32 v[34:35], v[34:35], v[128:129]
    v_pk_mul_f32 v[36:37], v[36:37], v[130:131]
    v_pk_mul_f32 v[38:39], v[38:39], v[132:133]
    v_pk_mul_f32 v[40:41], v[40:41], v[134:135]
    v_exp_f32 v34, v34
    v_exp_f32 v35, v35
    v_exp_f32 v36, v36
    v_exp_f32 v37, v37
    v_exp_f32 v38, v38
    v_exp_f32 v39, v39
    v_exp_f32 v40, v40
    v_exp_f32 v41, v41
    v_pk_mul_f32 v[136:137], v[136:137], v[128:129]
    v_pk_mul_f32 v[138:139], v[138:139], v[130:131]
    v_pk_mul_f32 v[140:141], v[140:141], v[132:133]
    v_pk_mul_f32 v[142:143], v[142:143], v[134:135]
    v_pk_add_f32 v[34:35], v[34:35], 1.0 op_sel_hi:[1,0]
    v_pk_add_f32 v[36:37], v[36:37], 1.0 op_sel_hi:[1,0]
    v_pk_add_f32 v[38:39], v[38:39], 1.0 op_sel_hi:[1,0]
    v_pk_add_f32 v[40:41], v[40:41], 1.0 op_sel_hi:[1,0]
    v_rcp_f32 v34, v34
    v_rcp_f32 v35, v35
    v_rcp_f32 v36, v36
    v_rcp_f32 v37, v37
    v_rcp_f32 v38, v38
    v_rcp_f32 v39, v39
    v_rcp_f32 v40, v40
    v_rcp_f32 v41, v41
    v_pk_mul_f32 v[136:137], v[136:137], v[34:35]
    v_pk_mul_f32 v[138:139], v[138:139], v[36:37]
    v_pk_mul_f32 v[140:141], v[140:141], v[38:39]
    v_pk_mul_f32 v[142:143], v[142:143], v[40:41]
    v_cvt_pk_bf16_f32 v128, v136, v137
    v_cvt_pk_bf16_f32 v129, v138, v139
    v_cvt_pk_bf16_f32 v130, v140, v141
    v_cvt_pk_bf16_f32 v131, v142, v143
    buffer_store_dwordx4 v[128:131], v16, s[56:59], s88 offen offset:0 sc1
    v_pk_mul_f32 v[34:35], v[144:145], v[144:145]
    v_pk_mul_f32 v[36:37], v[146:147], v[146:147]
    v_pk_mul_f32 v[38:39], v[148:149], v[148:149]
    v_pk_mul_f32 v[40:41], v[150:151], v[150:151]
    v_pk_fma_f32 v[34:35], v[34:35], s[94:95], v[26:27]
    v_pk_fma_f32 v[36:37], v[36:37], s[94:95], v[26:27]
    v_pk_fma_f32 v[38:39], v[38:39], s[94:95], v[26:27]
    v_pk_fma_f32 v[40:41], v[40:41], s[94:95], v[26:27]
    v_pk_mul_f32 v[34:35], v[34:35], v[144:145]
    v_pk_mul_f32 v[36:37], v[36:37], v[146:147]
    v_pk_mul_f32 v[38:39], v[38:39], v[148:149]
    v_pk_mul_f32 v[40:41], v[40:41], v[150:151]
    v_exp_f32 v34, v34
    v_exp_f32 v35, v35
    v_exp_f32 v36, v36
    v_exp_f32 v37, v37
    v_exp_f32 v38, v38
    v_exp_f32 v39, v39
    v_exp_f32 v40, v40
    v_exp_f32 v41, v41
    v_pk_mul_f32 v[152:153], v[152:153], v[144:145]
    v_pk_mul_f32 v[154:155], v[154:155], v[146:147]
    v_pk_mul_f32 v[156:157], v[156:157], v[148:149]
    v_pk_mul_f32 v[158:159], v[158:159], v[150:151]
    v_pk_add_f32 v[34:35], v[34:35], 1.0 op_sel_hi:[1,0]
    v_pk_add_f32 v[36:37], v[36:37], 1.0 op_sel_hi:[1,0]
    v_pk_add_f32 v[38:39], v[38:39], 1.0 op_sel_hi:[1,0]
    v_pk_add_f32 v[40:41], v[40:41], 1.0 op_sel_hi:[1,0]
    v_rcp_f32 v34, v34
    v_rcp_f32 v35, v35
    v_rcp_f32 v36, v36
    v_rcp_f32 v37, v37
    v_rcp_f32 v38, v38
    v_rcp_f32 v39, v39
    v_rcp_f32 v40, v40
    v_rcp_f32 v41, v41
    v_pk_mul_f32 v[152:153], v[152:153], v[34:35]
    v_pk_mul_f32 v[154:155], v[154:155], v[36:37]
    v_pk_mul_f32 v[156:157], v[156:157], v[38:39]
    v_pk_mul_f32 v[158:159], v[158:159], v[40:41]
    v_cvt_pk_bf16_f32 v144, v152, v153
    v_cvt_pk_bf16_f32 v145, v154, v155
    v_cvt_pk_bf16_f32 v146, v156, v157
    v_cvt_pk_bf16_f32 v147, v158, v159
    buffer_store_dwordx4 v[144:147], v16, s[56:59], s88 offen offset:1024 sc1
    v_pk_mul_f32 v[34:35], v[160:161], v[160:161]
    v_pk_mul_f32 v[36:37], v[162:163], v[162:163]
    v_pk_mul_f32 v[38:39], v[164:165], v[164:165]
    v_pk_mul_f32 v[40:41], v[166:167], v[166:167]
    v_pk_fma_f32 v[34:35], v[34:35], s[94:95], v[26:27]
    v_pk_fma_f32 v[36:37], v[36:37], s[94:95], v[26:27]
    v_pk_fma_f32 v[38:39], v[38:39], s[94:95], v[26:27]
    v_pk_fma_f32 v[40:41], v[40:41], s[94:95], v[26:27]
    v_pk_mul_f32 v[34:35], v[34:35], v[160:161]
    v_pk_mul_f32 v[36:37], v[36:37], v[162:163]
    v_pk_mul_f32 v[38:39], v[38:39], v[164:165]
    v_pk_mul_f32 v[40:41], v[40:41], v[166:167]
    v_exp_f32 v34, v34
    v_exp_f32 v35, v35
    v_exp_f32 v36, v36
    s_branch L_over4
L_stub4:
    s_branch L_stub6
L_over4:
    v_exp_f32 v37, v37
    v_exp_f32 v38, v38
    v_exp_f32 v39, v39
    v_exp_f32 v40, v40
    v_exp_f32 v41, v41
    v_pk_mul_f32 v[168:169], v[168:169], v[160:161]
    v_pk_mul_f32 v[170:171], v[170:171], v[162:163]
    v_pk_mul_f32 v[172:173], v[172:173], v[164:165]
    v_pk_mul_f32 v[174:175], v[174:175], v[166:167]
    v_pk_add_f32 v[34:35], v[34:35], 1.0 op_sel_hi:[1,0]
    v_pk_add_f32 v[36:37], v[36:37], 1.0 op_sel_hi:[1,0]
    v_pk_add_f32 v[38:39], v[38:39], 1.0 op_sel_hi:[1,0]
    v_pk_add_f32 v[40:41], v[40:41], 1.0 op_sel_hi:[1,0]
    v_rcp_f32 v34, v34
    v_rcp_f32 v35, v35
    v_rcp_f32 v36, v36
    v_rcp_f32 v37, v37
    v_rcp_f32 v38, v38
    v_rcp_f32 v39, v39
    v_rcp_f32 v40, v40
    v_rcp_f32 v41, v41
    v_pk_mul_f32 v[168:169], v[168:169], v[34:35]
    v_pk_mul_f32 v[170:171], v[170:171], v[36:37]
    v_pk_mul_f32 v[172:173], v[172:173], v[38:39]
    v_pk_mul_f32 v[174:175], v[174:175], v[40:41]
    v_cvt_pk_bf16_f32 v160, v168, v169
    v_cvt_pk_bf16_f32 v161, v170, v171
    v_cvt_pk_bf16_f32 v162, v172, v173
    v_cvt_pk_bf16_f32 v163, v174, v175
    buffer_store_dwordx4 v[160:163], v16, s[56:59], s88 offen offset:2048 sc1
    v_pk_mul_f32 v[34:35], v[176:177], v[176:177]
    v_pk_mul_f32 v[36:37], v[178:179], v[178:179]
    v_pk_mul_f32 v[38:39], v[180:181], v[180:181]
    v_pk_mul_f32 v[40:41], v[182:183], v[182:183]
    v_pk_fma_f32 v[34:35], v[34:35], s[94:95], v[26:27]
    v_pk_fma_f32 v[36:37], v[36:37], s[94:95], v[26:27]
    v_pk_fma_f32 v[38:39], v[38:39], s[94:95], v[26:27]
    v_pk_fma_f32 v[40:41], v[40:41], s[94:95], v[26:27]
    v_pk_mul_f32 v[34:35], v[34:35], v[176:177]
    v_pk_mul_f32 v[36:37], v[36:37], v[178:179]
    v_pk_mul_f32 v[38:39], v[38:39], v[180:181]
    v_pk_mul_f32 v[40:41], v[40:41], v[182:183]
    v_exp_f32 v34, v34
    v_exp_f32 v35, v35
    v_exp_f32 v36, v36
    v_exp_f32 v37, v37
    v_exp_f32 v38, v38
    v_exp_f32 v39, v39
    v_exp_f32 v40, v40
    v_exp_f32 v41, v41
    v_pk_mul_f32 v[184:185], v[184:185], v[176:177]
    v_pk_mul_f32 v[186:187], v[186:187], v[178:179]
    v_pk_mul_f32 v[188:189], v[188:189], v[180:181]
    v_pk_mul_f32 v[190:191], v[190:191], v[182:183]
    v_pk_add_f32 v[34:35], v[34:35], 1.0 op_sel_hi:[1,0]
    v_pk_add_f32 v[36:37], v[36:37], 1.0 op_sel_hi:[1,0]
    v_pk_add_f32 v[38:39], v[38:39], 1.0 op_sel_hi:[1,0]
    v_pk_add_f32 v[40:41], v[40:41], 1.0 op_sel_hi:[1,0]
    v_rcp_f32 v34, v34
    v_rcp_f32 v35, v35
    v_rcp_f32 v36, v36
    v_rcp_f32 v37, v37
    v_rcp_f32 v38, v38
    v_rcp_f32 v39, v39
    v_rcp_f32 v40, v40
    v_rcp_f32 v41, v41
    v_pk_mul_f32 v[184:185], v[184:185], v[34:35]
    v_pk_mul_f32 v[186:187], v[186:187], v[36:37]
    v_pk_mul_f32 v[188:189], v[188:189], v[38:39]
    v_pk_mul_f32 v[190:191], v[190:191], v[40:41]
    v_cvt_pk_bf16_f32 v176, v184, v185
    v_cvt_pk_bf16_f32 v177, v186, v187
    v_cvt_pk_bf16_f32 v178, v188, v189
    v_cvt_pk_bf16_f32 v179, v190, v191
    buffer_store_dwordx4 v[176:179], v16, s[56:59], s88 offen offset:3072 sc1
    v_pk_mul_f32 v[34:35], v[192:193], v[192:193]
    v_pk_mul_f32 v[36:37], v[194:195], v[194:195]
    v_pk_mul_f32 v[38:39], v[196:197], v[196:197]
    v_pk_mul_f32 v[40:41], v[198:199], v[198:199]
    v_pk_fma_f32 v[34:35], v[34:35], s[94:95], v[26:27]
    v_pk_fma_f32 v[36:37], v[36:37], s[94:95], v[26:27]
    v_pk_fma_f32 v[38:39], v[38:39], s[94:95], v[26:27]
    v_pk_fma_f32 v[40:41], v[40:41], s[94:95], v[26:27]
    v_pk_mul_f32 v[34:35], v[34:35], v[192:193]
    v_pk_mul_f32 v[36:37], v[36:37], v[194:195]
    v_pk_mul_f32 v[38:39], v[38:39], v[196:197]
    v_pk_mul_f32 v[40:41], v[40:41], v[198:199]
    v_exp_f32 v34, v34
    v_exp_f32 v35, v35
    v_exp_f32 v36, v36
    v_exp_f32 v37, v37
    v_exp_f32 v38, v38
    v_exp_f32 v39, v39
    v_exp_f32 v40, v40
    v_exp_f32 v41, v41
    v_pk_mul_f32 v[200:201], v[200:201], v[192:193]
    v_pk_mul_f32 v[202:203], v[202:203], v[194:195]
    v_pk_mul_f32 v[204:205], v[204:205], v[196:197]
    v_pk_mul_f32 v[206:207], v[206:207], v[198:199]
    v_pk_add_f32 v[34:35], v[34:35], 1.0 op_sel_hi:[1,0]
    v_pk_add_f32 v[36:37], v[36:37], 1.0 op_sel_hi:[1,0]
    v_pk_add_f32 v[38:39], v[38:39], 1.0 op_sel_hi:[1,0]
    v_pk_add_f32 v[40:41], v[40:41], 1.0 op_sel_hi:[1,0]
    v_rcp_f32 v34, v34
    v_rcp_f32 v35, v35
    v_rcp_f32 v36, v36
    v_rcp_f32 v37, v37
    v_rcp_f32 v38, v38
    v_rcp_f32 v39, v39
    v_rcp_f32 v40, v40
    v_rcp_f32 v41, v41
    v_pk_mul_f32 v[200:201], v[200:201], v[34:35]
    v_pk_mul_f32 v[202:203], v[202:203], v[36:37]
    v_pk_mul_f32 v[204:205], v[204:205], v[38:39]
    v_pk_mul_f32 v[206:207], v[206:207], v[40:41]
    v_cvt_pk_bf16_f32 v192, v200, v201
    v_cvt_pk_bf16_f32 v193, v202, v203
    v_cvt_pk_bf16_f32 v194, v204, v205
    v_cvt_pk_bf16_f32 v195, v206, v207
    s_add_u32 s88, s88, 4096
    buffer_store_dwordx4 v[192:195], v16, s[56:59], s88 offen offset:0 sc1
    v_pk_mul_f32 v[34:35], v[208:209], v[208:209]
    v_pk_mul_f32 v[36:37], v[210:211], v[210:211]
    v_pk_mul_f32 v[38:39], v[212:213], v[212:213]
    v_pk_mul_f32 v[40:41], v[214:215], v[214:215]
    v_pk_fma_f32 v[34:35], v[34:35], s[94:95], v[26:27]
    v_pk_fma_f32 v[36:37], v[36:37], s[94:95], v[26:27]
    v_pk_fma_f32 v[38:39], v[38:39], s[94:95], v[26:27]
    v_pk_fma_f32 v[40:41], v[40:41], s[94:95], v[26:27]
    v_pk_mul_f32 v[34:35], v[34:35], v[208:209]
    v_pk_mul_f32 v[36:37], v[36:37], v[210:211]
    v_pk_mul_f32 v[38:39], v[38:39], v[212:213]
    v_pk_mul_f32 v[40:41], v[40:41], v[214:215]
    v_exp_f32 v34, v34
    v_exp_f32 v35, v35
    v_exp_f32 v36, v36
    v_exp_f32 v37, v37
    v_exp_f32 v38, v38
    v_exp_f32 v39, v39
    v_exp_f32 v40, v40
    v_exp_f32 v41, v41
    v_pk_mul_f32 v[216:217], v[216:217], v[208:209]
    v_pk_mul_f32 v[218:219], v[218:219], v[210:211]
    v_pk_mul_f32 v[220:221], v[220:221], v[212:213]
    v_pk_mul_f32 v[222:223], v[222:223], v[214:215]
    v_pk_add_f32 v[34:35], v[34:35], 1.0 op_sel_hi:[1,0]
    v_pk_add_f32 v[36:37], v[36:37], 1.0 op_sel_hi:[1,0]
    v_pk_add_f32 v[38:39], v[38:39], 1.0 op_sel_hi:[1,0]
    v_pk_add_f32 v[40:41], v[40:41], 1.0 op_sel_hi:[1,0]
    v_rcp_f32 v34, v34
    v_rcp_f32 v35, v35
    v_rcp_f32 v36, v36
    v_rcp_f32 v37, v37
    v_rcp_f32 v38, v38
    v_rcp_f32 v39, v39
    v_rcp_f32 v40, v40
    v_rcp_f32 v41, v41
    v_pk_mul_f32 v[216:217], v[216:217], v[34:35]
    v_pk_mul_f32 v[218:219], v[218:219], v[36:37]
    v_pk_mul_f32 v[220:221], v[220:221], v[38:39]
    v_pk_mul_f32 v[222:223], v[222:223], v[40:41]
    v_cvt_pk_bf16_f32 v208, v216, v217
    v_cvt_pk_bf16_f32 v209, v218, v219
    v_cvt_pk_bf16_f32 v210, v220, v221
    v_cvt_pk_bf16_f32 v211, v222, v223
    buffer_store_dwordx4 v[208:211], v16, s[56:59], s88 offen offset:1024 sc1
    v_pk_mul_f32 v[34:35], v[224:225], v[224:225]
    v_pk_mul_f32 v[36:37], v[226:227], v[226:227]
    v_pk_mul_f32 v[38:39], v[228:229], v[228:229]
    v_pk_mul_f32 v[40:41], v[230:231], v[230:231]
    v_pk_fma_f32 v[34:35], v[34:35], s[94:95], v[26:27]
    v_pk_fma_f32 v[36:37], v[36:37], s[94:95], v[26:27]
    v_pk_fma_f32 v[38:39], v[38:39], s[94:95], v[26:27]
    v_pk_fma_f32 v[40:41], v[40:41], s[94:95], v[26:27]
    v_pk_mul_f32 v[34:35], v[34:35], v[224:225]
    v_pk_mul_f32 v[36:37], v[36:37], v[226:227]
    v_pk_mul_f32 v[38:39], v[38:39], v[228:229]
    v_pk_mul_f32 v[40:41], v[40:41], v[230:231]
    v_exp_f32 v34, v34
    v_exp_f32 v35, v35
    v_exp_f32 v36, v36
    v_exp_f32 v37, v37
    v_exp_f32 v38, v38
    v_exp_f32 v39, v39
    v_exp_f32 v40, v40
    v_exp_f32 v41, v41
    v_pk_mul_f32 v[232:233], v[232:233], v[224:225]
    v_pk_mul_f32 v[234:235], v[234:235], v[226:227]
    v_pk_mul_f32 v[236:237], v[236:237], v[228:229]
    v_pk_mul_f32 v[238:239], v[238:239], v[230:231]
    v_pk_add_f32 v[34:35], v[34:35], 1.0 op_sel_hi:[1,0]
    v_pk_add_f32 v[36:37], v[36:37], 1.0 op_sel_hi:[1,0]
    v_pk_add_f32 v[38:39], v[38:39], 1.0 op_sel_hi:[1,0]
    v_pk_add_f32 v[40:41], v[40:41], 1.0 op_sel_hi:[1,0]
    v_rcp_f32 v34, v34
    v_rcp_f32 v35, v35
    v_rcp_f32 v36, v36
    v_rcp_f32 v37, v37
    v_rcp_f32 v38, v38
    v_rcp_f32 v39, v39
    v_rcp_f32 v40, v40
    v_rcp_f32 v41, v41
    v_pk_mul_f32 v[232:233], v[232:233], v[34:35]
    v_pk_mul_f32 v[234:235], v[234:235], v[36:37]
    v_pk_mul_f32 v[236:237], v[236:237], v[38:39]
    v_pk_mul_f32 v[238:239], v[238:239], v[40:41]
    v_cvt_pk_bf16_f32 v224, v232, v233
    v_cvt_pk_bf16_f32 v225, v234, v235
    v_cvt_pk_bf16_f32 v226, v236, v237
    v_cvt_pk_bf16_f32 v227, v238, v239
    buffer_store_dwordx4 v[224:227], v16, s[56:59], s88 offen offset:2048 sc1
    v_pk_mul_f32 v[34:35], v[240:241], v[240:241]
    v_pk_mul_f32 v[36:37], v[242:243], v[242:243]
    v_pk_mul_f32 v[38:39], v[244:245], v[244:245]
    v_pk_mul_f32 v[40:41], v[246:247], v[246:247]
    v_pk_fma_f32 v[34:35], v[34:35], s[94:95], v[26:27]
    v_pk_fma_f32 v[36:37], v[36:37], s[94:95], v[26:27]
    v_pk_fma_f32 v[38:39], v[38:39], s[94:95], v[26:27]
    v_pk_fma_f32 v[40:41], v[40:41], s[94:95], v[26:27]
    v_pk_mul_f32 v[34:35], v[34:35], v[240:241]
    v_pk_mul_f32 v[36:37], v[36:37], v[242:243]
    v_pk_mul_f32 v[38:39], v[38:39], v[244:245]
    v_pk_mul_f32 v[40:41], v[40:41], v[246:247]
    v_exp_f32 v34, v34
    v_exp_f32 v35, v35
    v_exp_f32 v36, v36
    v_exp_f32 v37, v37
    v_exp_f32 v38, v38
    v_exp_f32 v39, v39
    v_exp_f32 v40, v40
    v_exp_f32 v41, v41
    v_pk_mul_f32 v[248:249], v[248:249], v[240:241]
    v_pk_mul_f32 v[250:251], v[250:251], v[242:243]
    v_pk_mul_f32 v[252:253], v[252:253], v[244:245]
    v_pk_mul_f32 v[254:255], v[254:255], v[246:247]
    v_pk_add_f32 v[34:35], v[34:35], 1.0 op_sel_hi:[1,0]
    v_pk_add_f32 v[36:37], v[36:37], 1.0 op_sel_hi:[1,0]
    v_pk_add_f32 v[38:39], v[38:39], 1.0 op_sel_hi:[1,0]
    v_pk_add_f32 v[40:41], v[40:41], 1.0 op_sel_hi:[1,0]
    v_rcp_f32 v34, v34
    v_rcp_f32 v35, v35
    v_rcp_f32 v36, v36
    v_rcp_f32 v37, v37
    v_rcp_f32 v38, v38
    v_rcp_f32 v39, v39
    v_rcp_f32 v40, v40
    v_rcp_f32 v41, v41
    v_pk_mul_f32 v[248:249], v[248:249], v[34:35]
    v_pk_mul_f32 v[250:251], v[250:251], v[36:37]
    v_pk_mul_f32 v[252:253], v[252:253], v[38:39]
    v_pk_mul_f32 v[254:255], v[254:255], v[40:41]
    v_cvt_pk_bf16_f32 v240, v248, v249
    v_cvt_pk_bf16_f32 v241, v250, v251
    v_cvt_pk_bf16_f32 v242, v252, v253
    v_cvt_pk_bf16_f32 v243, v254, v255
    buffer_store_dwordx4 v[240:243], v16, s[56:59], s88 offen offset:3072 sc1
    s_cmp_eq_u32 s62, 1
    s_cbranch_scc1 L_epi1
    v_mov_b32 v244, 0xce6e6b28
    s_waitcnt lgkmcnt(0)
    s_mov_b32 s83, 360448
    s_add_u32 m0, s3, 139264
    s_nop 0
    buffer_load_dwordx4 v17, s[48:51], s83 offen lds
    buffer_load_dwordx4 v18, s[48:51], s83 offen offset:1024 lds
    s_mov_b32 s82, 589824
    s_add_u32 m0, s3, 147456
    s_nop 0
    buffer_load_dwordx4 v17, s[48:51], s82 offen lds
    buffer_load_dwordx4 v18, s[48:51], s82 offen offset:1024 lds
    v_cvt_pk_bf16_f32 v128, v120, v121
    v_cvt_pk_bf16_f32 v129, v122, v123
    v_cvt_pk_bf16_f32 v130, v124, v125
    v_cvt_pk_bf16_f32 v131, v126, v127
    v_accvgpr_read_b32 v34, a128
    v_accvgpr_read_b32 v35, a129
    v_accvgpr_read_b32 v36, a130
    v_accvgpr_read_b32 v37, a131
    v_accvgpr_read_b32 v38, a132
    v_accvgpr_read_b32 v39, a133
    v_accvgpr_read_b32 v40, a134
    v_accvgpr_read_b32 v41, a135
    v_cvt_pk_bf16_f32 v132, v34, v35
    v_cvt_pk_bf16_f32 v133, v36, v37
    v_cvt_pk_bf16_f32 v134, v38, v39
    v_cvt_pk_bf16_f32 v135, v40, v41
    v_accvgpr_read_b32 v246, a192
    v_accvgpr_read_b32 v247, a193
    v_accvgpr_read_b32 v248, a194
    v_accvgpr_read_b32 v249, a195
    v_accvgpr_read_b32 v250, a196
    v_accvgpr_read_b32 v251, a197
    v_accvgpr_read_b32 v252, a198
    v_accvgpr_read_b32 v253, a199
    v_cvt_pk_bf16_f32 v164, v246, v247
    v_cvt_pk_bf16_f32 v165, v248, v249
    v_cvt_pk_bf16_f32 v166, v250, v251
    v_cvt_pk_bf16_f32 v167, v252, v253
    v_accvgpr_read_b32 v34, a136
    v_accvgpr_read_b32 v35, a137
    v_accvgpr_read_b32 v36, a138
    v_accvgpr_read_b32 v37, a139
    v_accvgpr_read_b32 v38, a140
    v_accvgpr_read_b32 v39, a141
    v_accvgpr_read_b32 v40, a142
    v_accvgpr_read_b32 v41, a143
    v_cvt_pk_bf16_f32 v136, v34, v35
    v_cvt_pk_bf16_f32 v137, v36, v37
    v_cvt_pk_bf16_f32 v138, v38, v39
    v_cvt_pk_bf16_f32 v139, v40, v41
    v_accvgpr_read_b32 v246, a200
    v_accvgpr_read_b32 v247, a201
    v_accvgpr_read_b32 v248, a202
    v_accvgpr_read_b32 v249, a203
    v_accvgpr_read_b32 v250, a204
    v_accvgpr_read_b32 v251, a205
    v_accvgpr_read_b32 v252, a206
    v_accvgpr_read_b32 v253, a207
    v_cvt_pk_bf16_f32 v168, v246, v247
    v_cvt_pk_bf16_f32 v169, v248, v249
    v_cvt_pk_bf16_f32 v170, v250, v251
    v_cvt_pk_bf16_f32 v171, v252, v253
    v_accvgpr_read_b32 v34, a144
    v_accvgpr_read_b32 v35, a145
    v_accvgpr_read_b32 v36, a146
    v_accvgpr_read_b32 v37, a147
    v_accvgpr_read_b32 v38, a148
    v_accvgpr_read_b32 v39, a149
    v_accvgpr_read_b32 v40, a150
    v_accvgpr_read_b32 v41, a151
    v_cvt_pk_bf16_f32 v140, v34, v35
    v_cvt_pk_bf16_f32 v141, v36, v37
    v_cvt_pk_bf16_f32 v142, v38, v39
    v_cvt_pk_bf16_f32 v143, v40, v41
    v_accvgpr_read_b32 v246, a208
    v_accvgpr_read_b32 v247, a209
    v_accvgpr_read_b32 v248, a210
    v_accvgpr_read_b32 v249, a211
    v_accvgpr_read_b32 v250, a212
    v_accvgpr_read_b32 v251, a213
    v_accvgpr_read_b32 v252, a214
    v_accvgpr_read_b32 v253, a215
    v_cvt_pk_bf16_f32 v172, v246, v247
    v_cvt_pk_bf16_f32 v173, v248, v249
    v_cvt_pk_bf16_f32 v174, v250, v251
    v_cvt_pk_bf16_f32 v175, v252, v253
    v_accvgpr_read_b32 v34, a152
    v_accvgpr_read_b32 v35, a153
    v_accvgpr_read_b32 v36, a154
    v_accvgpr_read_b32 v37, a155
    v_accvgpr_read_b32 v38, a156
    v_accvgpr_read_b32 v39, a157
    v_accvgpr_read_b32 v40, a158
    v_accvgpr_read_b32 v41, a159
    v_cvt_pk_bf16_f32 v144, v34, v35
    v_cvt_pk_bf16_f32 v145, v36, v37
    v_cvt_pk_bf16_f32 v146, v38, v39
    v_cvt_pk_bf16_f32 v147, v40, v41
    v_accvgpr_read_b32 v246, a216
    v_accvgpr_read_b32 v247, a217
    v_accvgpr_read_b32 v248, a218
    v_accvgpr_read_b32 v249, a219
    v_accvgpr_read_b32 v250, a220
    v_accvgpr_read_b32 v251, a221
    v_accvgpr_read_b32 v252, a222
    v_accvgpr_read_b32 v253, a223
    v_cvt_pk_bf16_f32 v176, v246, v247
    v_cvt_pk_bf16_f32 v177, v248, v249
    v_cvt_pk_bf16_f32 v178, v250, v251
    v_cvt_pk_bf16_f32 v179, v252, v253
    v_mfma_f32_16x16x32_bf16 v[196:199], v[128:131], v[164:167], 0
    v_mfma_f32_16x16x32_bf16 v[200:203], v[132:135], v[164:167], 0
    v_mfma_f32_16x16x32_bf16 v[204:207], v[132:135], v[168:171], 0
    v_mfma_f32_16x16x32_bf16 v[208:211], v[136:139], v[168:171], 0
    v_mfma_f32_16x16x32_bf16 v[212:215], v[136:139], v[172:175], 0
    v_mfma_f32_16x16x32_bf16 v[216:219], v[140:143], v[172:175], 0
    v_mfma_f32_16x16x32_bf16 v[220:223], v[140:143], v[176:179], 0
    v_mfma_f32_16x16x32_bf16 v[224:227], v[144:147], v[176:179], 0
    s_waitcnt vmcnt(4)
    s_mov_b64 exec, 1
    buffer_atomic_add v25, off, s[56:59], s92 sc1
    s_mov_b64 exec, -1
    v_cvt_pk_bf16_f32 v48, v48, v49
    v_cvt_pk_bf16_f32 v49, v50, v51
    v_cvt_pk_bf16_f32 v84, v84, v85
    v_cvt_pk_bf16_f32 v85, v86, v87
    v_cvt_pk_bf16_f32 v50, v52, v53
    v_cvt_pk_bf16_f32 v51, v54, v55
    v_cvt_pk_bf16_f32 v86, v88, v89
    v_cvt_pk_bf16_f32 v87, v90, v91
    v_cvt_pk_bf16_f32 v52, v56, v57
    v_cvt_pk_bf16_f32 v53, v58, v59
    v_cvt_pk_bf16_f32 v88, v92, v93
    v_cvt_pk_bf16_f32 v89, v94, v95
    v_cvt_pk_bf16_f32 v54, v60, v61
    v_cvt_pk_bf16_f32 v55, v62, v63
    v_cvt_pk_bf16_f32 v90, v96, v97
    v_cvt_pk_bf16_f32 v91, v98, v99
    v_cvt_pk_bf16_f32 v56, v64, v65
    v_cvt_pk_bf16_f32 v57, v66, v67
    v_cvt_pk_bf16_f32 v92, v100, v101
    v_cvt_pk_bf16_f32 v93, v102, v103
    v_cvt_pk_bf16_f32 v58, v68, v69
    v_cvt_pk_bf16_f32 v59, v70, v71
    v_cvt_pk_bf16_f32 v94, v104, v105
    v_cvt_pk_bf16_f32 v95, v106, v107
    v_cvt_pk_bf16_f32 v60, v72, v73
    v_cvt_pk_bf16_f32 v61, v74, v75
    v_cvt_pk_bf16_f32 v96, v108, v109
    v_cvt_pk_bf16_f32 v97, v110, v111
    v_cvt_pk_bf16_f32 v62, v76, v77
    v_cvt_pk_bf16_f32 v63, v78, v79
    v_cvt_pk_bf16_f32 v98, v112, v113
    v_cvt_pk_bf16_f32 v99, v114, v115
    v_cvt_pk_bf16_f32 v64, v80, v81
    v_cvt_pk_bf16_f32 v65, v82, v83
    v_cvt_pk_bf16_f32 v100, v116, v117
    v_cvt_pk_bf16_f32 v101, v118, v119
    v_cvt_pk_bf16_f32 v196, v196, v197
    v_cvt_pk_bf16_f32 v198, v198, v199
    v_cvt_pk_bf16_f32 v200, v200, v201
    v_cvt_pk_bf16_f32 v202, v202, v203
    v_cvt_pk_bf16_f32 v204, v204, v205
    v_cvt_pk_bf16_f32 v206, v206, v207
    v_cvt_pk_bf16_f32 v208, v208, v209
    v_cvt_pk_bf16_f32 v210, v210, v211
    v_cvt_pk_bf16_f32 v212, v212, v213
    v_cvt_pk_bf16_f32 v214, v214, v215
    v_cvt_pk_bf16_f32 v216, v216, v217
    v_cvt_pk_bf16_f32 v218, v218, v219
    v_cvt_pk_bf16_f32 v220, v220, v221
    v_cvt_pk_bf16_f32 v222, v222, v223
    v_cvt_pk_bf16_f32 v224, v224, v225
    v_cvt_pk_bf16_f32 v226, v226, v227
    v_perm_b32 v228, v200, v196, v28
    v_perm_b32 v229, v202, v198, v29
    v_perm_b32 v230, v208, v204, v28
    v_perm_b32 v231, v210, v206, v29
    v_perm_b32 v232, v216, v212, v28
    v_perm_b32 v233, v218, v214, v29
    v_perm_b32 v234, v224, v220, v28
    v_perm_b32 v235, v226, v222, v29
    v_pk_mul_f32 v[228:229], v[228:229], s[14:15]
    v_pk_mul_f32 v[230:231], v[230:231], s[14:15]
    v_pk_mul_f32 v[232:233], v[232:233], s[14:15]
    v_pk_mul_f32 v[234:235], v[234:235], s[14:15]
    v_cvt_pk_bf16_f32 v229, v228, v229
    v_cvt_pk_bf16_f32 v231, v230, v231
    v_cvt_pk_bf16_f32 v233, v232, v233
    v_cvt_pk_bf16_f32 v235, v234, v235
    v_lshlrev_b32 v228, 16, v229
    v_and_b32 v229, 0xffff0000, v229
    v_lshlrev_b32 v230, 16, v231
    v_and_b32 v231, 0xffff0000, v231
    v_lshlrev_b32 v232, 16, v233
    v_and_b32 v233, 0xffff0000, v233
    v_lshlrev_b32 v234, 16, v235
    v_and_b32 v235, 0xffff0000, v235
    v_cndmask_b32 v228, v244, v228, s[4:5]
    v_cndmask_b32 v229, v244, v229, s[6:7]
    v_max_f32 v236, v228, v229
    v_max_f32 v238, v230, v231
    v_max_f32 v240, v232, v233
    v_max_f32 v242, v234, v235
    v_permlane16_swap_b32 v236, v238
    s_nop 0
    v_permlane16_swap_b32 v240, v242
    v_max_f32 v236, v236, v238
    v_max_f32 v240, v240, v242
    s_nop 1
    v_permlane32_swap_b32 v236, v240
    v_max_f32 v236, v236, v240
    v_mul_f32 v236, 0xbfb8aa3b, v236
    v_mov_b32 v240, v236
    s_nop 1
    v_permlane32_swap_b32 v236, v240
    v_mov_b32 v238, v236
    v_mov_b32 v242, v240
    s_nop 0
    v_permlane16_swap_b32 v236, v238
    v_permlane16_swap_b32 v240, v242
    v_pk_fma_f32 v[228:229], v[228:229], s[98:99], v[236:237] op_sel_hi:[1,1,0]
    v_pk_fma_f32 v[230:231], v[230:231], s[98:99], v[238:239] op_sel_hi:[1,1,0]
    v_pk_fma_f32 v[232:233], v[232:233], s[98:99], v[240:241] op_sel_hi:[1,1,0]
    v_pk_fma_f32 v[234:235], v[234:235], s[98:99], v[242:243] op_sel_hi:[1,1,0]
    v_exp_f32 v228, v228
    v_exp_f32 v229, v229
    v_exp_f32 v230, v230
    v_exp_f32 v231, v231
    v_exp_f32 v232, v232
    v_exp_f32 v233, v233
    v_exp_f32 v234, v234
    v_exp_f32 v235, v235
    v_add_f32 v236, v228, v229
    v_add_f32 v238, v230, v231
    v_add_f32 v240, v232, v233
    v_add_f32 v242, v234, v235
    v_permlane16_swap_b32 v236, v238
    s_nop 0
    v_permlane16_swap_b32 v240, v242
    v_add_f32 v236, v236, v238
    v_add_f32 v240, v240, v242
    s_nop 1
    v_permlane32_swap_b32 v236, v240
    v_add_f32 v236, v236, v240
    v_rcp_f32 v236, v236
    s_nop 0
    v_mov_b32 v240, v236
    s_nop 1
    v_permlane32_swap_b32 v236, v240
    v_mov_b32 v238, v236
    v_mov_b32 v242, v240
    s_nop 0
    v_permlane16_swap_b32 v236, v238
    v_permlane16_swap_b32 v240, v242
    v_pk_mul_f32 v[228:229], v[228:229], v[236:237] op_sel_hi:[1,0]
    v_pk_mul_f32 v[230:231], v[230:231], v[238:239] op_sel_hi:[1,0]
    v_pk_mul_f32 v[232:233], v[232:233], v[240:241] op_sel_hi:[1,0]
    v_pk_mul_f32 v[234:235], v[234:235], v[242:243] op_sel_hi:[1,0]
    v_cvt_pk_bf16_f32 v228, v228, v229
    v_cvt_pk_bf16_f32 v230, v230, v231
    v_cvt_pk_bf16_f32 v232, v232, v233
    v_cvt_pk_bf16_f32 v234, v234, v235
    v_perm_b32 v164, v228, v228, v30
    v_perm_b32 v165, v228, v228, v31
    v_perm_b32 v166, v228, v228, v32
    v_perm_b32 v167, v228, v228, v33
    v_perm_b32 v168, v230, v230, v30
    v_perm_b32 v169, v230, v230, v31
    v_perm_b32 v170, v230, v230, v32
    v_perm_b32 v171, v230, v230, v33
    v_perm_b32 v172, v232, v232, v30
    v_perm_b32 v173, v232, v232, v31
    v_perm_b32 v174, v232, v232, v32
    v_perm_b32 v175, v232, v232, v33
    v_perm_b32 v176, v234, v234, v30
    v_perm_b32 v177, v234, v234, v31
    v_perm_b32 v178, v234, v234, v32
    v_perm_b32 v179, v234, v234, v33
    v_mfma_f32_16x16x32_bf16 v[196:199], v[48:51], v[164:167], 0
    v_mfma_f32_16x16x32_bf16 v[200:203], v[84:87], v[164:167], 0
    v_mfma_f32_16x16x32_bf16 v[204:207], v[50:53], v[168:171], 0
    v_mfma_f32_16x16x32_bf16 v[208:211], v[86:89], v[168:171], 0
    v_mfma_f32_16x16x32_bf16 v[212:215], v[52:55], v[172:175], 0
    v_mfma_f32_16x16x32_bf16 v[216:219], v[88:91], v[172:175], 0
    v_mfma_f32_16x16x32_bf16 v[220:223], v[54:57], v[176:179], 0
    v_mfma_f32_16x16x32_bf16 v[224:227], v[90:93], v[176:179], 0
    v_accvgpr_read_b32 v34, a160
    v_accvgpr_read_b32 v35, a161
    v_accvgpr_read_b32 v36, a162
    v_accvgpr_read_b32 v37, a163
    v_accvgpr_read_b32 v38, a164
    v_accvgpr_read_b32 v39, a165
    v_accvgpr_read_b32 v40, a166
    v_accvgpr_read_b32 v41, a167
    v_cvt_pk_bf16_f32 v148, v34, v35
    v_cvt_pk_bf16_f32 v149, v36, v37
    v_cvt_pk_bf16_f32 v150, v38, v39
    v_cvt_pk_bf16_f32 v151, v40, v41
    v_accvgpr_read_b32 v246, a224
    v_accvgpr_read_b32 v247, a225
    v_accvgpr_read_b32 v248, a226
    v_accvgpr_read_b32 v249, a227
    v_accvgpr_read_b32 v250, a228
    v_accvgpr_read_b32 v251, a229
    v_accvgpr_read_b32 v252, a230
    v_accvgpr_read_b32 v253, a231
    v_cvt_pk_bf16_f32 v180, v246, v247
    v_cvt_pk_bf16_f32 v181, v248, v249
    v_cvt_pk_bf16_f32 v182, v250, v251
    v_cvt_pk_bf16_f32 v183, v252, v253
    v_accvgpr_read_b32 v34, a168
    v_accvgpr_read_b32 v35, a169
    v_accvgpr_read_b32 v36, a170
    v_accvgpr_read_b32 v37, a171
    v_accvgpr_read_b32 v38, a172
    v_accvgpr_read_b32 v39, a173
    v_accvgpr_read_b32 v40, a174
    v_accvgpr_read_b32 v41, a175
    v_cvt_pk_bf16_f32 v152, v34, v35
    v_cvt_pk_bf16_f32 v153, v36, v37
    v_cvt_pk_bf16_f32 v154, v38, v39
    v_cvt_pk_bf16_f32 v155, v40, v41
    v_accvgpr_read_b32 v246, a232
    v_accvgpr_read_b32 v247, a233
    v_accvgpr_read_b32 v248, a234
    v_accvgpr_read_b32 v249, a235
    v_accvgpr_read_b32 v250, a236
    v_accvgpr_read_b32 v251, a237
    s_branch L_over5
L_stub5:
    s_branch L_stub7
L_over5:
    v_accvgpr_read_b32 v252, a238
    v_accvgpr_read_b32 v253, a239
    v_cvt_pk_bf16_f32 v184, v246, v247
    v_cvt_pk_bf16_f32 v185, v248, v249
    v_cvt_pk_bf16_f32 v186, v250, v251
    v_cvt_pk_bf16_f32 v187, v252, v253
    v_accvgpr_read_b32 v34, a176
    v_accvgpr_read_b32 v35, a177
    v_accvgpr_read_b32 v36, a178
    v_accvgpr_read_b32 v37, a179
    v_accvgpr_read_b32 v38, a180
    v_accvgpr_read_b32 v39, a181
    v_accvgpr_read_b32 v40, a182
    v_accvgpr_read_b32 v41, a183
    v_cvt_pk_bf16_f32 v156, v34, v35
    v_cvt_pk_bf16_f32 v157, v36, v37
    v_cvt_pk_bf16_f32 v158, v38, v39
    v_cvt_pk_bf16_f32 v159, v40, v41
    v_accvgpr_read_b32 v246, a240
    v_accvgpr_read_b32 v247, a241
    v_accvgpr_read_b32 v248, a242
    v_accvgpr_read_b32 v249, a243
    v_accvgpr_read_b32 v250, a244
    v_accvgpr_read_b32 v251, a245
    v_accvgpr_read_b32 v252, a246
    v_accvgpr_read_b32 v253, a247
    v_cvt_pk_bf16_f32 v188, v246, v247
    v_cvt_pk_bf16_f32 v189, v248, v249
    v_cvt_pk_bf16_f32 v190, v250, v251
    v_cvt_pk_bf16_f32 v191, v252, v253
    v_accvgpr_read_b32 v34, a184
    v_accvgpr_read_b32 v35, a185
    v_accvgpr_read_b32 v36, a186
    v_accvgpr_read_b32 v37, a187
    v_accvgpr_read_b32 v38, a188
    v_accvgpr_read_b32 v39, a189
    v_accvgpr_read_b32 v40, a190
    v_accvgpr_read_b32 v41, a191
    v_cvt_pk_bf16_f32 v160, v34, v35
    v_cvt_pk_bf16_f32 v161, v36, v37
    v_cvt_pk_bf16_f32 v162, v38, v39
    v_cvt_pk_bf16_f32 v163, v40, v41
    v_accvgpr_read_b32 v246, a248
    v_accvgpr_read_b32 v247, a249
    v_accvgpr_read_b32 v248, a250
    v_accvgpr_read_b32 v249, a251
    v_accvgpr_read_b32 v250, a252
    v_accvgpr_read_b32 v251, a253
    v_accvgpr_read_b32 v252, a254
    v_accvgpr_read_b32 v253, a255
    v_cvt_pk_bf16_f32 v192, v246, v247
    v_cvt_pk_bf16_f32 v193, v248, v249
    v_cvt_pk_bf16_f32 v194, v250, v251
    v_cvt_pk_bf16_f32 v195, v252, v253
    v_cvt_pk_bf16_f32 v196, v196, v197
    v_cvt_pk_bf16_f32 v197, v198, v199
    v_cvt_pk_bf16_f32 v198, v200, v201
    v_cvt_pk_bf16_f32 v199, v202, v203
    buffer_store_dwordx4 v[196:199], v16, s[56:59], s91 offen offset:0 sc1
    s_add_u32 s91, s91, 32768
    v_cvt_pk_bf16_f32 v204, v204, v205
    v_cvt_pk_bf16_f32 v205, v206, v207
    v_cvt_pk_bf16_f32 v206, v208, v209
    v_cvt_pk_bf16_f32 v207, v210, v211
    buffer_store_dwordx4 v[204:207], v16, s[56:59], s91 offen offset:0 sc1
    s_add_u32 s91, s91, 32768
    v_cvt_pk_bf16_f32 v212, v212, v213
    v_cvt_pk_bf16_f32 v213, v214, v215
    v_cvt_pk_bf16_f32 v214, v216, v217
    v_cvt_pk_bf16_f32 v215, v218, v219
    buffer_store_dwordx4 v[212:215], v16, s[56:59], s91 offen offset:0 sc1
    s_add_u32 s91, s91, 32768
    v_cvt_pk_bf16_f32 v220, v220, v221
    v_cvt_pk_bf16_f32 v221, v222, v223
    v_cvt_pk_bf16_f32 v222, v224, v225
    v_cvt_pk_bf16_f32 v223, v226, v227
    buffer_store_dwordx4 v[220:223], v16, s[56:59], s91 offen offset:0 sc1
    s_add_u32 s91, s91, 32768
    s_mov_b32 s67, 0
    v_mfma_f32_16x16x32_bf16 v[196:199], v[144:147], v[180:183], 0
    v_mfma_f32_16x16x32_bf16 v[200:203], v[148:151], v[180:183], 0
    v_mfma_f32_16x16x32_bf16 v[204:207], v[148:151], v[184:187], 0
    v_mfma_f32_16x16x32_bf16 v[208:211], v[152:155], v[184:187], 0
    v_mfma_f32_16x16x32_bf16 v[212:215], v[152:155], v[188:191], 0
    v_mfma_f32_16x16x32_bf16 v[216:219], v[156:159], v[188:191], 0
    v_mfma_f32_16x16x32_bf16 v[220:223], v[156:159], v[192:195], 0
    v_mfma_f32_16x16x32_bf16 v[224:227], v[160:163], v[192:195], 0
    s_nop 0
    v_cvt_pk_bf16_f32 v196, v196, v197
    v_cvt_pk_bf16_f32 v198, v198, v199
    v_cvt_pk_bf16_f32 v200, v200, v201
    v_cvt_pk_bf16_f32 v202, v202, v203
    v_cvt_pk_bf16_f32 v204, v204, v205
    v_cvt_pk_bf16_f32 v206, v206, v207
    v_cvt_pk_bf16_f32 v208, v208, v209
    v_cvt_pk_bf16_f32 v210, v210, v211
    v_cvt_pk_bf16_f32 v212, v212, v213
    v_cvt_pk_bf16_f32 v214, v214, v215
    v_cvt_pk_bf16_f32 v216, v216, v217
    v_cvt_pk_bf16_f32 v218, v218, v219
    v_cvt_pk_bf16_f32 v220, v220, v221
    v_cvt_pk_bf16_f32 v222, v222, v223
    v_cvt_pk_bf16_f32 v224, v224, v225
    v_cvt_pk_bf16_f32 v226, v226, v227
    v_perm_b32 v228, v200, v196, v28
    v_perm_b32 v229, v202, v198, v29
    v_perm_b32 v230, v208, v204, v28
    v_perm_b32 v231, v210, v206, v29
    v_perm_b32 v232, v216, v212, v28
    v_perm_b32 v233, v218, v214, v29
    v_perm_b32 v234, v224, v220, v28
    v_perm_b32 v235, v226, v222, v29
    v_pk_mul_f32 v[228:229], v[228:229], s[14:15]
    v_pk_mul_f32 v[230:231], v[230:231], s[14:15]
    v_pk_mul_f32 v[232:233], v[232:233], s[14:15]
    v_pk_mul_f32 v[234:235], v[234:235], s[14:15]
    v_cvt_pk_bf16_f32 v229, v228, v229
    v_cvt_pk_bf16_f32 v231, v230, v231
    v_cvt_pk_bf16_f32 v233, v232, v233
    v_cvt_pk_bf16_f32 v235, v234, v235
    v_lshlrev_b32 v228, 16, v229
    v_and_b32 v229, 0xffff0000, v229
    v_lshlrev_b32 v230, 16, v231
    v_and_b32 v231, 0xffff0000, v231
    v_lshlrev_b32 v232, 16, v233
    v_and_b32 v233, 0xffff0000, v233
    v_lshlrev_b32 v234, 16, v235
    v_and_b32 v235, 0xffff0000, v235
    buffer_load_dword v43, off, s[56:59], s92 sc1
    v_max_f32 v236, v228, v229
    v_max_f32 v238, v230, v231
    v_max_f32 v240, v232, v233
    v_max_f32 v242, v234, v235
    v_permlane16_swap_b32 v236, v238
    s_nop 0
    v_permlane16_swap_b32 v240, v242
    v_max_f32 v236, v236, v238
    v_max_f32 v240, v240, v242
    s_nop 1
    v_permlane32_swap_b32 v236, v240
    v_max_f32 v236, v236, v240
    v_mul_f32 v236, 0xbfb8aa3b, v236
    v_mov_b32 v240, v236
    s_nop 1
    v_permlane32_swap_b32 v236, v240
    v_mov_b32 v238, v236
    v_mov_b32 v242, v240
    s_nop 0
    v_permlane16_swap_b32 v236, v238
    v_permlane16_swap_b32 v240, v242
    v_pk_fma_f32 v[228:229], v[228:229], s[98:99], v[236:237] op_sel_hi:[1,1,0]
    v_pk_fma_f32 v[230:231], v[230:231], s[98:99], v[238:239] op_sel_hi:[1,1,0]
    v_pk_fma_f32 v[232:233], v[232:233], s[98:99], v[240:241] op_sel_hi:[1,1,0]
    v_pk_fma_f32 v[234:235], v[234:235], s[98:99], v[242:243] op_sel_hi:[1,1,0]
    v_exp_f32 v228, v228
    v_exp_f32 v229, v229
    v_exp_f32 v230, v230
    v_exp_f32 v231, v231
    v_exp_f32 v232, v232
    v_exp_f32 v233, v233
    v_exp_f32 v234, v234
    v_exp_f32 v235, v235
    v_add_f32 v236, v228, v229
    v_add_f32 v238, v230, v231
    v_add_f32 v240, v232, v233
    v_add_f32 v242, v234, v235
    v_permlane16_swap_b32 v236, v238
    s_nop 0
    v_permlane16_swap_b32 v240, v242
    v_add_f32 v236, v236, v238
    v_add_f32 v240, v240, v242
    s_nop 1
    v_permlane32_swap_b32 v236, v240
    v_add_f32 v236, v236, v240
    v_rcp_f32 v236, v236
    s_nop 0
    v_mov_b32 v240, v236
    s_nop 1
    v_permlane32_swap_b32 v236, v240
    v_mov_b32 v238, v236
    v_mov_b32 v242, v240
    s_nop 0
    v_permlane16_swap_b32 v236, v238
    v_permlane16_swap_b32 v240, v242
    v_pk_mul_f32 v[228:229], v[228:229], v[236:237] op_sel_hi:[1,0]
    v_pk_mul_f32 v[230:231], v[230:231], v[238:239] op_sel_hi:[1,0]
    v_pk_mul_f32 v[232:233], v[232:233], v[240:241] op_sel_hi:[1,0]
    v_pk_mul_f32 v[234:235], v[234:235], v[242:243] op_sel_hi:[1,0]
    v_cvt_pk_bf16_f32 v228, v228, v229
    v_cvt_pk_bf16_f32 v230, v230, v231
    v_cvt_pk_bf16_f32 v232, v232, v233
    v_cvt_pk_bf16_f32 v234, v234, v235
    v_perm_b32 v180, v228, v228, v30
    v_perm_b32 v181, v228, v228, v31
    v_perm_b32 v182, v228, v228, v32
    v_perm_b32 v183, v228, v228, v33
    v_perm_b32 v184, v230, v230, v30
    v_perm_b32 v185, v230, v230, v31
    v_perm_b32 v186, v230, v230, v32
    v_perm_b32 v187, v230, v230, v33
    v_perm_b32 v188, v232, v232, v30
    v_perm_b32 v189, v232, v232, v31
    v_perm_b32 v190, v232, v232, v32
    v_perm_b32 v191, v232, v232, v33
    v_perm_b32 v192, v234, v234, v30
    v_perm_b32 v193, v234, v234, v31
    v_perm_b32 v194, v234, v234, v32
    v_perm_b32 v195, v234, v234, v33
    v_mfma_f32_16x16x32_bf16 v[196:199], v[56:59], v[180:183], 0
    v_mfma_f32_16x16x32_bf16 v[200:203], v[92:95], v[180:183], 0
    v_mfma_f32_16x16x32_bf16 v[204:207], v[58:61], v[184:187], 0
    v_mfma_f32_16x16x32_bf16 v[208:211], v[94:97], v[184:187], 0
    v_mfma_f32_16x16x32_bf16 v[212:215], v[60:63], v[188:191], 0
    v_mfma_f32_16x16x32_bf16 v[216:219], v[96:99], v[188:191], 0
    v_mfma_f32_16x16x32_bf16 v[220:223], v[62:65], v[192:195], 0
    v_mfma_f32_16x16x32_bf16 v[224:227], v[98:101], v[192:195], 0
    s_nop 0
    v_cvt_pk_bf16_f32 v196, v196, v197
    v_cvt_pk_bf16_f32 v197, v198, v199
    v_cvt_pk_bf16_f32 v198, v200, v201
    v_cvt_pk_bf16_f32 v199, v202, v203
    buffer_store_dwordx4 v[196:199], v16, s[56:59], s91 offen offset:0 sc1
    s_add_u32 s91, s91, 32768
    v_cvt_pk_bf16_f32 v204, v204, v205
    v_cvt_pk_bf16_f32 v205, v206, v207
    v_cvt_pk_bf16_f32 v206, v208, v209
    v_cvt_pk_bf16_f32 v207, v210, v211
    buffer_store_dwordx4 v[204:207], v16, s[56:59], s91 offen offset:0 sc1
    s_add_u32 s91, s91, 32768
    v_cvt_pk_bf16_f32 v212, v212, v213
    v_cvt_pk_bf16_f32 v213, v214, v215
    v_cvt_pk_bf16_f32 v214, v216, v217
    v_cvt_pk_bf16_f32 v215, v218, v219
    buffer_store_dwordx4 v[212:215], v16, s[56:59], s91 offen offset:0 sc1
    s_add_u32 s91, s91, 32768
    v_cvt_pk_bf16_f32 v220, v220, v221
    v_cvt_pk_bf16_f32 v221, v222, v223
    v_cvt_pk_bf16_f32 v222, v224, v225
    v_cvt_pk_bf16_f32 v223, v226, v227
    buffer_store_dwordx4 v[220:223], v16, s[56:59], s91 offen offset:0 sc1
    s_add_u32 s91, s91, 32768
    s_waitcnt vmcnt(4)
    v_readfirstlane_b32 s86, v43
    s_bfe_u32 s86, s86, 0x80000
    s_cmp_eq_u32 s86, 32
    s_cbranch_scc0 L_spA0
L_okA0:
    buffer_load_dwordx4 a[0:3], v21, s[56:59], s68 offen sc1
    buffer_load_dwordx4 a[4:7], v22, s[56:59], s68 offen sc1
    buffer_load_dwordx4 a[8:11], v23, s[56:59], s68 offen sc1
    buffer_load_dwordx4 a[12:15], v24, s[56:59], s68 offen sc1
    s_add_u32 s68, s68, 16384
    buffer_load_dwordx4 a[16:19], v21, s[56:59], s68 offen sc1
    buffer_load_dwordx4 a[20:23], v22, s[56:59], s68 offen sc1
    buffer_load_dwordx4 a[24:27], v23, s[56:59], s68 offen sc1
    buffer_load_dwordx4 a[28:31], v24, s[56:59], s68 offen sc1
    s_add_u32 s68, s68, 16384
    buffer_load_dwordx4 a[32:35], v21, s[56:59], s68 offen sc1
    buffer_load_dwordx4 a[36:39], v22, s[56:59], s68 offen sc1
    buffer_load_dwordx4 a[40:43], v23, s[56:59], s68 offen sc1
    buffer_load_dwordx4 a[44:47], v24, s[56:59], s68 offen sc1
    s_add_u32 s68, s68, 16384
    buffer_load_dwordx4 a[48:51], v21, s[56:59], s68 offen sc1
    buffer_load_dwordx4 a[52:55], v22, s[56:59], s68 offen sc1
    buffer_load_dwordx4 a[56:59], v23, s[56:59], s68 offen sc1
    buffer_load_dwordx4 a[60:63], v24, s[56:59], s68 offen sc1
    s_add_u32 s68, s68, 16384
    s_barrier
    s_branch L_D
L_stub6:
    s_branch L_stub8
L_epi1:
    s_mov_b32 s67, 0
    v_accvgpr_read_b32 v128, a128
    v_accvgpr_read_b32 v129, a129
    v_accvgpr_read_b32 v130, a130
    v_accvgpr_read_b32 v131, a131
    v_accvgpr_read_b32 v132, a132
    v_accvgpr_read_b32 v133, a133
    v_accvgpr_read_b32 v134, a134
    v_accvgpr_read_b32 v135, a135
    v_accvgpr_read_b32 v136, a136
    v_accvgpr_read_b32 v137, a137
    v_accvgpr_read_b32 v138, a138
    v_accvgpr_read_b32 v139, a139
    v_accvgpr_read_b32 v140, a140
    v_accvgpr_read_b32 v141, a141
    v_accvgpr_read_b32 v142, a142
    v_accvgpr_read_b32 v143, a143
    v_pk_mul_f32 v[34:35], v[128:129], v[128:129]
    v_pk_mul_f32 v[36:37], v[130:131], v[130:131]
    v_pk_mul_f32 v[38:39], v[132:133], v[132:133]
    v_pk_mul_f32 v[40:41], v[134:135], v[134:135]
    v_pk_fma_f32 v[34:35], v[34:35], s[94:95], v[26:27]
    v_pk_fma_f32 v[36:37], v[36:37], s[94:95], v[26:27]
    v_pk_fma_f32 v[38:39], v[38:39], s[94:95], v[26:27]
    v_pk_fma_f32 v[40:41], v[40:41], s[94:95], v[26:27]
    v_pk_mul_f32 v[34:35], v[34:35], v[128:129]
    v_pk_mul_f32 v[36:37], v[36:37], v[130:131]
    v_pk_mul_f32 v[38:39], v[38:39], v[132:133]
    v_pk_mul_f32 v[40:41], v[40:41], v[134:135]
    v_exp_f32 v34, v34
    v_exp_f32 v35, v35
    v_exp_f32 v36, v36
    v_exp_f32 v37, v37
    v_exp_f32 v38, v38
    v_exp_f32 v39, v39
    v_exp_f32 v40, v40
    v_exp_f32 v41, v41
    v_pk_mul_f32 v[136:137], v[136:137], v[128:129]
    v_pk_mul_f32 v[138:139], v[138:139], v[130:131]
    v_pk_mul_f32 v[140:141], v[140:141], v[132:133]
    v_pk_mul_f32 v[142:143], v[142:143], v[134:135]
    v_pk_add_f32 v[34:35], v[34:35], 1.0 op_sel_hi:[1,0]
    v_pk_add_f32 v[36:37], v[36:37], 1.0 op_sel_hi:[1,0]
    v_pk_add_f32 v[38:39], v[38:39], 1.0 op_sel_hi:[1,0]
    v_pk_add_f32 v[40:41], v[40:41], 1.0 op_sel_hi:[1,0]
    v_rcp_f32 v34, v34
    v_rcp_f32 v35, v35
    v_rcp_f32 v36, v36
    v_rcp_f32 v37, v37
    v_rcp_f32 v38, v38
    v_rcp_f32 v39, v39
    v_rcp_f32 v40, v40
    v_rcp_f32 v41, v41
    v_pk_mul_f32 v[136:137], v[136:137], v[34:35]
    v_pk_mul_f32 v[138:139], v[138:139], v[36:37]
    v_pk_mul_f32 v[140:141], v[140:141], v[38:39]
    v_pk_mul_f32 v[142:143], v[142:143], v[40:41]
    v_cvt_pk_bf16_f32 v128, v136, v137
    v_cvt_pk_bf16_f32 v129, v138, v139
    v_cvt_pk_bf16_f32 v130, v140, v141
    v_cvt_pk_bf16_f32 v131, v142, v143
    buffer_store_dwordx4 v[128:131], v16, s[56:59], s89 offen offset:0 sc1
    s_waitcnt vmcnt(1)
    s_mov_b64 exec, 1
    buffer_atomic_add v25, off, s[56:59], s92 sc1
    s_mov_b64 exec, -1
    v_accvgpr_read_b32 v144, a144
    v_accvgpr_read_b32 v145, a145
    v_accvgpr_read_b32 v146, a146
    v_accvgpr_read_b32 v147, a147
    v_accvgpr_read_b32 v148, a148
    v_accvgpr_read_b32 v149, a149
    v_accvgpr_read_b32 v150, a150
    v_accvgpr_read_b32 v151, a151
    v_accvgpr_read_b32 v152, a152
    v_accvgpr_read_b32 v153, a153
    v_accvgpr_read_b32 v154, a154
    v_accvgpr_read_b32 v155, a155
    v_accvgpr_read_b32 v156, a156
    v_accvgpr_read_b32 v157, a157
    v_accvgpr_read_b32 v158, a158
    v_accvgpr_read_b32 v159, a159
    v_pk_mul_f32 v[34:35], v[144:145], v[144:145]
    v_pk_mul_f32 v[36:37], v[146:147], v[146:147]
    v_pk_mul_f32 v[38:39], v[148:149], v[148:149]
    v_pk_mul_f32 v[40:41], v[150:151], v[150:151]
    v_pk_fma_f32 v[34:35], v[34:35], s[94:95], v[26:27]
    v_pk_fma_f32 v[36:37], v[36:37], s[94:95], v[26:27]
    v_pk_fma_f32 v[38:39], v[38:39], s[94:95], v[26:27]
    v_pk_fma_f32 v[40:41], v[40:41], s[94:95], v[26:27]
    v_pk_mul_f32 v[34:35], v[34:35], v[144:145]
    v_pk_mul_f32 v[36:37], v[36:37], v[146:147]
    v_pk_mul_f32 v[38:39], v[38:39], v[148:149]
    v_pk_mul_f32 v[40:41], v[40:41], v[150:151]
    v_exp_f32 v34, v34
    v_exp_f32 v35, v35
    v_exp_f32 v36, v36
    v_exp_f32 v37, v37
    v_exp_f32 v38, v38
    v_exp_f32 v39, v39
    v_exp_f32 v40, v40
    v_exp_f32 v41, v41
    v_pk_mul_f32 v[152:153], v[152:153], v[144:145]
    v_pk_mul_f32 v[154:155], v[154:155], v[146:147]
    v_pk_mul_f32 v[156:157], v[156:157], v[148:149]
    v_pk_mul_f32 v[158:159], v[158:159], v[150:151]
    v_pk_add_f32 v[34:35], v[34:35], 1.0 op_sel_hi:[1,0]
    v_pk_add_f32 v[36:37], v[36:37], 1.0 op_sel_hi:[1,0]
    v_pk_add_f32 v[38:39], v[38:39], 1.0 op_sel_hi:[1,0]
    v_pk_add_f32 v[40:41], v[40:41], 1.0 op_sel_hi:[1,0]
    v_rcp_f32 v34, v34
    v_rcp_f32 v35, v35
    v_rcp_f32 v36, v36
    v_rcp_f32 v37, v37
    v_rcp_f32 v38, v38
    v_rcp_f32 v39, v39
    v_rcp_f32 v40, v40
    v_rcp_f32 v41, v41
    v_pk_mul_f32 v[152:153], v[152:153], v[34:35]
    v_pk_mul_f32 v[154:155], v[154:155], v[36:37]
    v_pk_mul_f32 v[156:157], v[156:157], v[38:39]
    v_pk_mul_f32 v[158:159], v[158:159], v[40:41]
    v_cvt_pk_bf16_f32 v144, v152, v153
    v_cvt_pk_bf16_f32 v145, v154, v155
    v_cvt_pk_bf16_f32 v146, v156, v157
    v_cvt_pk_bf16_f32 v147, v158, v159
    buffer_store_dwordx4 v[144:147], v16, s[56:59], s89 offen offset:1024 sc1
    v_accvgpr_read_b32 v160, a160
    v_accvgpr_read_b32 v161, a161
    v_accvgpr_read_b32 v162, a162
    v_accvgpr_read_b32 v163, a163
    v_accvgpr_read_b32 v164, a164
    v_accvgpr_read_b32 v165, a165
    v_accvgpr_read_b32 v166, a166
    v_accvgpr_read_b32 v167, a167
    v_accvgpr_read_b32 v168, a168
    v_accvgpr_read_b32 v169, a169
    v_accvgpr_read_b32 v170, a170
    v_accvgpr_read_b32 v171, a171
    v_accvgpr_read_b32 v172, a172
    v_accvgpr_read_b32 v173, a173
    v_accvgpr_read_b32 v174, a174
    v_accvgpr_read_b32 v175, a175
    v_pk_mul_f32 v[34:35], v[160:161], v[160:161]
    v_pk_mul_f32 v[36:37], v[162:163], v[162:163]
    v_pk_mul_f32 v[38:39], v[164:165], v[164:165]
    v_pk_mul_f32 v[40:41], v[166:167], v[166:167]
    v_pk_fma_f32 v[34:35], v[34:35], s[94:95], v[26:27]
    v_pk_fma_f32 v[36:37], v[36:37], s[94:95], v[26:27]
    v_pk_fma_f32 v[38:39], v[38:39], s[94:95], v[26:27]
    v_pk_fma_f32 v[40:41], v[40:41], s[94:95], v[26:27]
    v_pk_mul_f32 v[34:35], v[34:35], v[160:161]
    v_pk_mul_f32 v[36:37], v[36:37], v[162:163]
    v_pk_mul_f32 v[38:39], v[38:39], v[164:165]
    v_pk_mul_f32 v[40:41], v[40:41], v[166:167]
    v_exp_f32 v34, v34
    v_exp_f32 v35, v35
    v_exp_f32 v36, v36
    v_exp_f32 v37, v37
    v_exp_f32 v38, v38
    v_exp_f32 v39, v39
    v_exp_f32 v40, v40
    v_exp_f32 v41, v41
    v_pk_mul_f32 v[168:169], v[168:169], v[160:161]
    v_pk_mul_f32 v[170:171], v[170:171], v[162:163]
    v_pk_mul_f32 v[172:173], v[172:173], v[164:165]
    v_pk_mul_f32 v[174:175], v[174:175], v[166:167]
    v_pk_add_f32 v[34:35], v[34:35], 1.0 op_sel_hi:[1,0]
    v_pk_add_f32 v[36:37], v[36:37], 1.0 op_sel_hi:[1,0]
    v_pk_add_f32 v[38:39], v[38:39], 1.0 op_sel_hi:[1,0]
    v_pk_add_f32 v[40:41], v[40:41], 1.0 op_sel_hi:[1,0]
    v_rcp_f32 v34, v34
    v_rcp_f32 v35, v35
    v_rcp_f32 v36, v36
    v_rcp_f32 v37, v37
    v_rcp_f32 v38, v38
    v_rcp_f32 v39, v39
    v_rcp_f32 v40, v40
    v_rcp_f32 v41, v41
    v_pk_mul_f32 v[168:169], v[168:169], v[34:35]
    v_pk_mul_f32 v[170:171], v[170:171], v[36:37]
    v_pk_mul_f32 v[172:173], v[172:173], v[38:39]
    v_pk_mul_f32 v[174:175], v[174:175], v[40:41]
    v_cvt_pk_bf16_f32 v160, v168, v169
    v_cvt_pk_bf16_f32 v161, v170, v171
    v_cvt_pk_bf16_f32 v162, v172, v173
    v_cvt_pk_bf16_f32 v163, v174, v175
    buffer_store_dwordx4 v[160:163], v16, s[56:59], s89 offen offset:2048 sc1
    v_accvgpr_read_b32 v176, a176
    v_accvgpr_read_b32 v177, a177
    v_accvgpr_read_b32 v178, a178
    v_accvgpr_read_b32 v179, a179
    v_accvgpr_read_b32 v180, a180
    v_accvgpr_read_b32 v181, a181
    v_accvgpr_read_b32 v182, a182
    v_accvgpr_read_b32 v183, a183
    v_accvgpr_read_b32 v184, a184
    v_accvgpr_read_b32 v185, a185
    v_accvgpr_read_b32 v186, a186
    v_accvgpr_read_b32 v187, a187
    v_accvgpr_read_b32 v188, a188
    v_accvgpr_read_b32 v189, a189
    v_accvgpr_read_b32 v190, a190
    v_accvgpr_read_b32 v191, a191
    v_pk_mul_f32 v[34:35], v[176:177], v[176:177]
    v_pk_mul_f32 v[36:37], v[178:179], v[178:179]
    v_pk_mul_f32 v[38:39], v[180:181], v[180:181]
    v_pk_mul_f32 v[40:41], v[182:183], v[182:183]
    v_pk_fma_f32 v[34:35], v[34:35], s[94:95], v[26:27]
    v_pk_fma_f32 v[36:37], v[36:37], s[94:95], v[26:27]
    v_pk_fma_f32 v[38:39], v[38:39], s[94:95], v[26:27]
    v_pk_fma_f32 v[40:41], v[40:41], s[94:95], v[26:27]
    v_pk_mul_f32 v[34:35], v[34:35], v[176:177]
    v_pk_mul_f32 v[36:37], v[36:37], v[178:179]
    v_pk_mul_f32 v[38:39], v[38:39], v[180:181]
    v_pk_mul_f32 v[40:41], v[40:41], v[182:183]
    v_exp_f32 v34, v34
    v_exp_f32 v35, v35
    v_exp_f32 v36, v36
    v_exp_f32 v37, v37
    v_exp_f32 v38, v38
    v_exp_f32 v39, v39
    v_exp_f32 v40, v40
    v_exp_f32 v41, v41
    v_pk_mul_f32 v[184:185], v[184:185], v[176:177]
    v_pk_mul_f32 v[186:187], v[186:187], v[178:179]
    v_pk_mul_f32 v[188:189], v[188:189], v[180:181]
    v_pk_mul_f32 v[190:191], v[190:191], v[182:183]
    v_pk_add_f32 v[34:35], v[34:35], 1.0 op_sel_hi:[1,0]
    v_pk_add_f32 v[36:37], v[36:37], 1.0 op_sel_hi:[1,0]
    v_pk_add_f32 v[38:39], v[38:39], 1.0 op_sel_hi:[1,0]
    v_pk_add_f32 v[40:41], v[40:41], 1.0 op_sel_hi:[1,0]
    v_rcp_f32 v34, v34
    v_rcp_f32 v35, v35
    v_rcp_f32 v36, v36
    v_rcp_f32 v37, v37
    v_rcp_f32 v38, v38
    v_rcp_f32 v39, v39
    v_rcp_f32 v40, v40
    v_rcp_f32 v41, v41
    v_pk_mul_f32 v[184:185], v[184:185], v[34:35]
    v_pk_mul_f32 v[186:187], v[186:187], v[36:37]
    v_pk_mul_f32 v[188:189], v[188:189], v[38:39]
    v_pk_mul_f32 v[190:191], v[190:191], v[40:41]
    v_cvt_pk_bf16_f32 v176, v184, v185
    v_cvt_pk_bf16_f32 v177, v186, v187
    v_cvt_pk_bf16_f32 v178, v188, v189
    v_cvt_pk_bf16_f32 v179, v190, v191
    buffer_store_dwordx4 v[176:179], v16, s[56:59], s89 offen offset:3072 sc1
    v_accvgpr_read_b32 v128, a192
    v_accvgpr_read_b32 v129, a193
    v_accvgpr_read_b32 v130, a194
    v_accvgpr_read_b32 v131, a195
    v_accvgpr_read_b32 v132, a196
    v_accvgpr_read_b32 v133, a197
    v_accvgpr_read_b32 v134, a198
    v_accvgpr_read_b32 v135, a199
    v_accvgpr_read_b32 v136, a200
    v_accvgpr_read_b32 v137, a201
    v_accvgpr_read_b32 v138, a202
    v_accvgpr_read_b32 v139, a203
    v_accvgpr_read_b32 v140, a204
    v_accvgpr_read_b32 v141, a205
    v_accvgpr_read_b32 v142, a206
    v_accvgpr_read_b32 v143, a207
    v_pk_mul_f32 v[34:35], v[128:129], v[128:129]
    v_pk_mul_f32 v[36:37], v[130:131], v[130:131]
    v_pk_mul_f32 v[38:39], v[132:133], v[132:133]
    v_pk_mul_f32 v[40:41], v[134:135], v[134:135]
    v_pk_fma_f32 v[34:35], v[34:35], s[94:95], v[26:27]
    v_pk_fma_f32 v[36:37], v[36:37], s[94:95], v[26:27]
    v_pk_fma_f32 v[38:39], v[38:39], s[94:95], v[26:27]
    v_pk_fma_f32 v[40:41], v[40:41], s[94:95], v[26:27]
    v_pk_mul_f32 v[34:35], v[34:35], v[128:129]
    v_pk_mul_f32 v[36:37], v[36:37], v[130:131]
    v_pk_mul_f32 v[38:39], v[38:39], v[132:133]
    v_pk_mul_f32 v[40:41], v[40:41], v[134:135]
    v_exp_f32 v34, v34
    v_exp_f32 v35, v35
    v_exp_f32 v36, v36
    v_exp_f32 v37, v37
    v_exp_f32 v38, v38
    v_exp_f32 v39, v39
    v_exp_f32 v40, v40
    v_exp_f32 v41, v41
    v_pk_mul_f32 v[136:137], v[136:137], v[128:129]
    v_pk_mul_f32 v[138:139], v[138:139], v[130:131]
    v_pk_mul_f32 v[140:141], v[140:141], v[132:133]
    v_pk_mul_f32 v[142:143], v[142:143], v[134:135]
    v_pk_add_f32 v[34:35], v[34:35], 1.0 op_sel_hi:[1,0]
    v_pk_add_f32 v[36:37], v[36:37], 1.0 op_sel_hi:[1,0]
    v_pk_add_f32 v[38:39], v[38:39], 1.0 op_sel_hi:[1,0]
    v_pk_add_f32 v[40:41], v[40:41], 1.0 op_sel_hi:[1,0]
    v_rcp_f32 v34, v34
    v_rcp_f32 v35, v35
    v_rcp_f32 v36, v36
    v_rcp_f32 v37, v37
    v_rcp_f32 v38, v38
    v_rcp_f32 v39, v39
    v_rcp_f32 v40, v40
    v_rcp_f32 v41, v41
    v_pk_mul_f32 v[136:137], v[136:137], v[34:35]
    v_pk_mul_f32 v[138:139], v[138:139], v[36:37]
    v_pk_mul_f32 v[140:141], v[140:141], v[38:39]
    v_pk_mul_f32 v[142:143], v[142:143], v[40:41]
    v_cvt_pk_bf16_f32 v128, v136, v137
    v_cvt_pk_bf16_f32 v129, v138, v139
    v_cvt_pk_bf16_f32 v130, v140, v141
    v_cvt_pk_bf16_f32 v131, v142, v143
    s_add_u32 s89, s89, 4096
    buffer_store_dwordx4 v[128:131], v16, s[56:59], s89 offen offset:0 sc1
    v_accvgpr_read_b32 v144, a208
    v_accvgpr_read_b32 v145, a209
    v_accvgpr_read_b32 v146, a210
    v_accvgpr_read_b32 v147, a211
    v_accvgpr_read_b32 v148, a212
    s_branch L_over7
L_stub7:
    s_branch L_stub9
L_over7:
    v_accvgpr_read_b32 v149, a213
    v_accvgpr_read_b32 v150, a214
    v_accvgpr_read_b32 v151, a215
    v_accvgpr_read_b32 v152, a216
    v_accvgpr_read_b32 v153, a217
    v_accvgpr_read_b32 v154, a218
    v_accvgpr_read_b32 v155, a219
    v_accvgpr_read_b32 v156, a220
    v_accvgpr_read_b32 v157, a221
    v_accvgpr_read_b32 v158, a222
    v_accvgpr_read_b32 v159, a223
    v_pk_mul_f32 v[34:35], v[144:145], v[144:145]
    v_pk_mul_f32 v[36:37], v[146:147], v[146:147]
    v_pk_mul_f32 v[38:39], v[148:149], v[148:149]
    v_pk_mul_f32 v[40:41], v[150:151], v[150:151]
    v_pk_fma_f32 v[34:35], v[34:35], s[94:95], v[26:27]
    v_pk_fma_f32 v[36:37], v[36:37], s[94:95], v[26:27]
    v_pk_fma_f32 v[38:39], v[38:39], s[94:95], v[26:27]
    v_pk_fma_f32 v[40:41], v[40:41], s[94:95], v[26:27]
    v_pk_mul_f32 v[34:35], v[34:35], v[144:145]
    v_pk_mul_f32 v[36:37], v[36:37], v[146:147]
    v_pk_mul_f32 v[38:39], v[38:39], v[148:149]
    v_pk_mul_f32 v[40:41], v[40:41], v[150:151]
    v_exp_f32 v34, v34
    v_exp_f32 v35, v35
    v_exp_f32 v36, v36
    v_exp_f32 v37, v37
    v_exp_f32 v38, v38
    v_exp_f32 v39, v39
    v_exp_f32 v40, v40
    v_exp_f32 v41, v41
    v_pk_mul_f32 v[152:153], v[152:153], v[144:145]
    v_pk_mul_f32 v[154:155], v[154:155], v[146:147]
    v_pk_mul_f32 v[156:157], v[156:157], v[148:149]
    v_pk_mul_f32 v[158:159], v[158:159], v[150:151]
    v_pk_add_f32 v[34:35], v[34:35], 1.0 op_sel_hi:[1,0]
    v_pk_add_f32 v[36:37], v[36:37], 1.0 op_sel_hi:[1,0]
    v_pk_add_f32 v[38:39], v[38:39], 1.0 op_sel_hi:[1,0]
    v_pk_add_f32 v[40:41], v[40:41], 1.0 op_sel_hi:[1,0]
    v_rcp_f32 v34, v34
    v_rcp_f32 v35, v35
    v_rcp_f32 v36, v36
    v_rcp_f32 v37, v37
    v_rcp_f32 v38, v38
    v_rcp_f32 v39, v39
    v_rcp_f32 v40, v40
    v_rcp_f32 v41, v41
    v_pk_mul_f32 v[152:153], v[152:153], v[34:35]
    v_pk_mul_f32 v[154:155], v[154:155], v[36:37]
    v_pk_mul_f32 v[156:157], v[156:157], v[38:39]
    v_pk_mul_f32 v[158:159], v[158:159], v[40:41]
    v_cvt_pk_bf16_f32 v144, v152, v153
    v_cvt_pk_bf16_f32 v145, v154, v155
    v_cvt_pk_bf16_f32 v146, v156, v157
    v_cvt_pk_bf16_f32 v147, v158, v159
    buffer_store_dwordx4 v[144:147], v16, s[56:59], s89 offen offset:1024 sc1
    v_accvgpr_read_b32 v160, a224
    v_accvgpr_read_b32 v161, a225
    v_accvgpr_read_b32 v162, a226
    v_accvgpr_read_b32 v163, a227
    v_accvgpr_read_b32 v164, a228
    v_accvgpr_read_b32 v165, a229
    v_accvgpr_read_b32 v166, a230
    v_accvgpr_read_b32 v167, a231
    v_accvgpr_read_b32 v168, a232
    v_accvgpr_read_b32 v169, a233
    v_accvgpr_read_b32 v170, a234
    v_accvgpr_read_b32 v171, a235
    v_accvgpr_read_b32 v172, a236
    v_accvgpr_read_b32 v173, a237
    v_accvgpr_read_b32 v174, a238
    v_accvgpr_read_b32 v175, a239
    v_pk_mul_f32 v[34:35], v[160:161], v[160:161]
    v_pk_mul_f32 v[36:37], v[162:163], v[162:163]
    v_pk_mul_f32 v[38:39], v[164:165], v[164:165]
    v_pk_mul_f32 v[40:41], v[166:167], v[166:167]
    v_pk_fma_f32 v[34:35], v[34:35], s[94:95], v[26:27]
    v_pk_fma_f32 v[36:37], v[36:37], s[94:95], v[26:27]
    v_pk_fma_f32 v[38:39], v[38:39], s[94:95], v[26:27]
    v_pk_fma_f32 v[40:41], v[40:41], s[94:95], v[26:27]
    v_pk_mul_f32 v[34:35], v[34:35], v[160:161]
    v_pk_mul_f32 v[36:37], v[36:37], v[162:163]
    v_pk_mul_f32 v[38:39], v[38:39], v[164:165]
    v_pk_mul_f32 v[40:41], v[40:41], v[166:167]
    v_exp_f32 v34, v34
    v_exp_f32 v35, v35
    v_exp_f32 v36, v36
    v_exp_f32 v37, v37
    v_exp_f32 v38, v38
    v_exp_f32 v39, v39
    v_exp_f32 v40, v40
    v_exp_f32 v41, v41
    v_pk_mul_f32 v[168:169], v[168:169], v[160:161]
    v_pk_mul_f32 v[170:171], v[170:171], v[162:163]
    v_pk_mul_f32 v[172:173], v[172:173], v[164:165]
    v_pk_mul_f32 v[174:175], v[174:175], v[166:167]
    v_pk_add_f32 v[34:35], v[34:35], 1.0 op_sel_hi:[1,0]
    v_pk_add_f32 v[36:37], v[36:37], 1.0 op_sel_hi:[1,0]
    v_pk_add_f32 v[38:39], v[38:39], 1.0 op_sel_hi:[1,0]
    v_pk_add_f32 v[40:41], v[40:41], 1.0 op_sel_hi:[1,0]
    v_rcp_f32 v34, v34
    v_rcp_f32 v35, v35
    v_rcp_f32 v36, v36
    v_rcp_f32 v37, v37
    v_rcp_f32 v38, v38
    v_rcp_f32 v39, v39
    v_rcp_f32 v40, v40
    v_rcp_f32 v41, v41
    v_pk_mul_f32 v[168:169], v[168:169], v[34:35]
    v_pk_mul_f32 v[170:171], v[170:171], v[36:37]
    v_pk_mul_f32 v[172:173], v[172:173], v[38:39]
    v_pk_mul_f32 v[174:175], v[174:175], v[40:41]
    v_cvt_pk_bf16_f32 v160, v168, v169
    v_cvt_pk_bf16_f32 v161, v170, v171
    v_cvt_pk_bf16_f32 v162, v172, v173
    v_cvt_pk_bf16_f32 v163, v174, v175
    buffer_store_dwordx4 v[160:163], v16, s[56:59], s89 offen offset:2048 sc1
    buffer_load_dword v43, off, s[56:59], s92 sc1
    v_accvgpr_read_b32 v176, a240
    v_accvgpr_read_b32 v177, a241
    v_accvgpr_read_b32 v178, a242
    v_accvgpr_read_b32 v179, a243
    v_accvgpr_read_b32 v180, a244
    v_accvgpr_read_b32 v181, a245
    v_accvgpr_read_b32 v182, a246
    v_accvgpr_read_b32 v183, a247
    v_accvgpr_read_b32 v184, a248
    v_accvgpr_read_b32 v185, a249
    v_accvgpr_read_b32 v186, a250
    v_accvgpr_read_b32 v187, a251
    v_accvgpr_read_b32 v188, a252
    v_accvgpr_read_b32 v189, a253
    v_accvgpr_read_b32 v190, a254
    v_accvgpr_read_b32 v191, a255
    v_pk_mul_f32 v[34:35], v[176:177], v[176:177]
    v_pk_mul_f32 v[36:37], v[178:179], v[178:179]
    v_pk_mul_f32 v[38:39], v[180:181], v[180:181]
    v_pk_mul_f32 v[40:41], v[182:183], v[182:183]
    v_pk_fma_f32 v[34:35], v[34:35], s[94:95], v[26:27]
    v_pk_fma_f32 v[36:37], v[36:37], s[94:95], v[26:27]
    v_pk_fma_f32 v[38:39], v[38:39], s[94:95], v[26:27]
    v_pk_fma_f32 v[40:41], v[40:41], s[94:95], v[26:27]
    v_pk_mul_f32 v[34:35], v[34:35], v[176:177]
    v_pk_mul_f32 v[36:37], v[36:37], v[178:179]
    v_pk_mul_f32 v[38:39], v[38:39], v[180:181]
    v_pk_mul_f32 v[40:41], v[40:41], v[182:183]
    v_exp_f32 v34, v34
    v_exp_f32 v35, v35
    v_exp_f32 v36, v36
    v_exp_f32 v37, v37
    v_exp_f32 v38, v38
    v_exp_f32 v39, v39
    v_exp_f32 v40, v40
    v_exp_f32 v41, v41
    v_pk_mul_f32 v[184:185], v[184:185], v[176:177]
    v_pk_mul_f32 v[186:187], v[186:187], v[178:179]
    v_pk_mul_f32 v[188:189], v[188:189], v[180:181]
    v_pk_mul_f32 v[190:191], v[190:191], v[182:183]
    v_pk_add_f32 v[34:35], v[34:35], 1.0 op_sel_hi:[1,0]
    v_pk_add_f32 v[36:37], v[36:37], 1.0 op_sel_hi:[1,0]
    v_pk_add_f32 v[38:39], v[38:39], 1.0 op_sel_hi:[1,0]
    v_pk_add_f32 v[40:41], v[40:41], 1.0 op_sel_hi:[1,0]
    v_rcp_f32 v34, v34
    v_rcp_f32 v35, v35
    v_rcp_f32 v36, v36
    v_rcp_f32 v37, v37
    v_rcp_f32 v38, v38
    v_rcp_f32 v39, v39
    v_rcp_f32 v40, v40
    v_rcp_f32 v41, v41
    v_pk_mul_f32 v[184:185], v[184:185], v[34:35]
    v_pk_mul_f32 v[186:187], v[186:187], v[36:37]
    v_pk_mul_f32 v[188:189], v[188:189], v[38:39]
    v_pk_mul_f32 v[190:191], v[190:191], v[40:41]
    v_cvt_pk_bf16_f32 v176, v184, v185
    v_cvt_pk_bf16_f32 v177, v186, v187
    v_cvt_pk_bf16_f32 v178, v188, v189
    v_cvt_pk_bf16_f32 v179, v190, v191
    buffer_store_dwordx4 v[176:179], v16, s[56:59], s89 offen offset:3072 sc1
    s_waitcnt vmcnt(1)
    v_readfirstlane_b32 s86, v43
    s_bfe_u32 s86, s86, 0x80000
    s_cmp_eq_u32 s86, 32
    s_cbranch_scc0 L_spA1
L_okA1:
    s_waitcnt lgkmcnt(1)
    v_pk_mul_f32 v[34:35], v[48:49], v[48:49]
    buffer_load_dwordx4 a[0:3], v21, s[56:59], s68 offen sc1
    v_pk_mul_f32 v[36:37], v[50:51], v[50:51]
    v_pk_mul_f32 v[38:39], v[52:53], v[52:53]
    v_pk_mul_f32 v[40:41], v[54:55], v[54:55]
    v_pk_fma_f32 v[34:35], v[34:35], s[94:95], v[26:27]
    v_pk_fma_f32 v[36:37], v[36:37], s[94:95], v[26:27]
    v_pk_fma_f32 v[38:39], v[38:39], s[94:95], v[26:27]
    v_pk_fma_f32 v[40:41], v[40:41], s[94:95], v[26:27]
    v_pk_mul_f32 v[34:35], v[34:35], v[48:49]
    buffer_load_dwordx4 a[4:7], v22, s[56:59], s68 offen sc1
    v_pk_mul_f32 v[36:37], v[36:37], v[50:51]
    v_pk_mul_f32 v[38:39], v[38:39], v[52:53]
    v_pk_mul_f32 v[40:41], v[40:41], v[54:55]
    v_exp_f32 v34, v34
    v_exp_f32 v35, v35
    v_exp_f32 v36, v36
    v_exp_f32 v37, v37
    v_exp_f32 v38, v38
    buffer_load_dwordx4 a[8:11], v23, s[56:59], s68 offen sc1
    v_exp_f32 v39, v39
    v_exp_f32 v40, v40
    v_exp_f32 v41, v41
    v_pk_mul_f32 v[56:57], v[56:57], v[48:49]
    v_pk_mul_f32 v[58:59], v[58:59], v[50:51]
    v_pk_mul_f32 v[60:61], v[60:61], v[52:53]
    v_pk_mul_f32 v[62:63], v[62:63], v[54:55]
    v_pk_add_f32 v[34:35], v[34:35], 1.0 op_sel_hi:[1,0]
    buffer_load_dwordx4 a[12:15], v24, s[56:59], s68 offen sc1
    v_pk_add_f32 v[36:37], v[36:37], 1.0 op_sel_hi:[1,0]
    v_pk_add_f32 v[38:39], v[38:39], 1.0 op_sel_hi:[1,0]
    v_pk_add_f32 v[40:41], v[40:41], 1.0 op_sel_hi:[1,0]
    v_rcp_f32 v34, v34
    v_rcp_f32 v35, v35
    v_rcp_f32 v36, v36
    v_rcp_f32 v37, v37
    v_rcp_f32 v38, v38
    s_add_u32 s68, s68, 16384
    v_rcp_f32 v39, v39
    v_rcp_f32 v40, v40
    v_rcp_f32 v41, v41
    v_pk_mul_f32 v[56:57], v[56:57], v[34:35]
    v_pk_mul_f32 v[58:59], v[58:59], v[36:37]
    v_pk_mul_f32 v[60:61], v[60:61], v[38:39]
    v_pk_mul_f32 v[62:63], v[62:63], v[40:41]
    v_cvt_pk_bf16_f32 v48, v56, v57
    v_cvt_pk_bf16_f32 v49, v58, v59
    v_cvt_pk_bf16_f32 v50, v60, v61
    v_cvt_pk_bf16_f32 v51, v62, v63
    s_nop 0
    v_permlane16_swap_b32 v48, v50
    v_permlane16_swap_b32 v49, v51
    buffer_store_dwordx4 v[48:51], v28, s[56:59], s90 offen offset:0 sc1
    v_pk_mul_f32 v[34:35], v[64:65], v[64:65]
    buffer_load_dwordx4 a[16:19], v21, s[56:59], s68 offen sc1
    v_pk_mul_f32 v[36:37], v[66:67], v[66:67]
    v_pk_mul_f32 v[38:39], v[68:69], v[68:69]
    v_pk_mul_f32 v[40:41], v[70:71], v[70:71]
    v_pk_fma_f32 v[34:35], v[34:35], s[94:95], v[26:27]
    v_pk_fma_f32 v[36:37], v[36:37], s[94:95], v[26:27]
    v_pk_fma_f32 v[38:39], v[38:39], s[94:95], v[26:27]
    v_pk_fma_f32 v[40:41], v[40:41], s[94:95], v[26:27]
    v_pk_mul_f32 v[34:35], v[34:35], v[64:65]
    buffer_load_dwordx4 a[20:23], v22, s[56:59], s68 offen sc1
    v_pk_mul_f32 v[36:37], v[36:37], v[66:67]
    v_pk_mul_f32 v[38:39], v[38:39], v[68:69]
    v_pk_mul_f32 v[40:41], v[40:41], v[70:71]
    v_exp_f32 v34, v34
    v_exp_f32 v35, v35
    v_exp_f32 v36, v36
    v_exp_f32 v37, v37
    v_exp_f32 v38, v38
    buffer_load_dwordx4 a[24:27], v23, s[56:59], s68 offen sc1
    v_exp_f32 v39, v39
    v_exp_f32 v40, v40
    v_exp_f32 v41, v41
    v_pk_mul_f32 v[72:73], v[72:73], v[64:65]
    v_pk_mul_f32 v[74:75], v[74:75], v[66:67]
    v_pk_mul_f32 v[76:77], v[76:77], v[68:69]
    v_pk_mul_f32 v[78:79], v[78:79], v[70:71]
    v_pk_add_f32 v[34:35], v[34:35], 1.0 op_sel_hi:[1,0]
    buffer_load_dwordx4 a[28:31], v24, s[56:59], s68 offen sc1
    v_pk_add_f32 v[36:37], v[36:37], 1.0 op_sel_hi:[1,0]
    v_pk_add_f32 v[38:39], v[38:39], 1.0 op_sel_hi:[1,0]
    v_pk_add_f32 v[40:41], v[40:41], 1.0 op_sel_hi:[1,0]
    v_rcp_f32 v34, v34
    v_rcp_f32 v35, v35
    v_rcp_f32 v36, v36
    v_rcp_f32 v37, v37
    v_rcp_f32 v38, v38
    s_add_u32 s68, s68, 16384
    v_rcp_f32 v39, v39
    v_rcp_f32 v40, v40
    v_rcp_f32 v41, v41
    v_pk_mul_f32 v[72:73], v[72:73], v[34:35]
    v_pk_mul_f32 v[74:75], v[74:75], v[36:37]
    v_pk_mul_f32 v[76:77], v[76:77], v[38:39]
    v_pk_mul_f32 v[78:79], v[78:79], v[40:41]
    v_cvt_pk_bf16_f32 v64, v72, v73
    v_cvt_pk_bf16_f32 v65, v74, v75
    v_cvt_pk_bf16_f32 v66, v76, v77
    v_cvt_pk_bf16_f32 v67, v78, v79
    s_nop 0
    v_permlane16_swap_b32 v64, v66
    v_permlane16_swap_b32 v65, v67
    buffer_store_dwordx4 v[64:67], v28, s[56:59], s90 offen offset:2048 sc1
    s_waitcnt vmcnt(10)
    s_mov_b64 exec, 1
    buffer_atomic_add v29, off, s[56:59], s92 sc1
    s_mov_b64 exec, -1
    v_pk_mul_f32 v[34:35], v[80:81], v[80:81]
    buffer_load_dwordx4 a[32:35], v21, s[56:59], s68 offen sc1
    v_pk_mul_f32 v[36:37], v[82:83], v[82:83]
    s_waitcnt lgkmcnt(0)
    v_pk_mul_f32 v[38:39], v[84:85], v[84:85]
    v_pk_mul_f32 v[40:41], v[86:87], v[86:87]
    v_pk_fma_f32 v[34:35], v[34:35], s[94:95], v[26:27]
    v_pk_fma_f32 v[36:37], v[36:37], s[94:95], v[26:27]
    v_pk_fma_f32 v[38:39], v[38:39], s[94:95], v[26:27]
    v_pk_fma_f32 v[40:41], v[40:41], s[94:95], v[26:27]
    v_pk_mul_f32 v[34:35], v[34:35], v[80:81]
    buffer_load_dwordx4 a[36:39], v22, s[56:59], s68 offen sc1
    v_pk_mul_f32 v[36:37], v[36:37], v[82:83]
    v_pk_mul_f32 v[38:39], v[38:39], v[84:85]
    v_pk_mul_f32 v[40:41], v[40:41], v[86:87]
    v_exp_f32 v34, v34
    v_exp_f32 v35, v35
    v_exp_f32 v36, v36
    v_exp_f32 v37, v37
    v_exp_f32 v38, v38
    buffer_load_dwordx4 a[40:43], v23, s[56:59], s68 offen sc1
    v_exp_f32 v39, v39
    v_exp_f32 v40, v40
    v_exp_f32 v41, v41
    v_pk_mul_f32 v[88:89], v[88:89], v[80:81]
    v_pk_mul_f32 v[90:91], v[90:91], v[82:83]
    v_pk_mul_f32 v[92:93], v[92:93], v[84:85]
    v_pk_mul_f32 v[94:95], v[94:95], v[86:87]
    v_pk_add_f32 v[34:35], v[34:35], 1.0 op_sel_hi:[1,0]
    buffer_load_dwordx4 a[44:47], v24, s[56:59], s68 offen sc1
    v_pk_add_f32 v[36:37], v[36:37], 1.0 op_sel_hi:[1,0]
    v_pk_add_f32 v[38:39], v[38:39], 1.0 op_sel_hi:[1,0]
    v_pk_add_f32 v[40:41], v[40:41], 1.0 op_sel_hi:[1,0]
    v_rcp_f32 v34, v34
    v_rcp_f32 v35, v35
    v_rcp_f32 v36, v36
    v_rcp_f32 v37, v37
    v_rcp_f32 v38, v38
    s_add_u32 s68, s68, 16384
    v_rcp_f32 v39, v39
    v_rcp_f32 v40, v40
    v_rcp_f32 v41, v41
    v_pk_mul_f32 v[88:89], v[88:89], v[34:35]
    v_pk_mul_f32 v[90:91], v[90:91], v[36:37]
    v_pk_mul_f32 v[92:93], v[92:93], v[38:39]
    v_pk_mul_f32 v[94:95], v[94:95], v[40:41]
    v_cvt_pk_bf16_f32 v80, v88, v89
    v_cvt_pk_bf16_f32 v81, v90, v91
    v_cvt_pk_bf16_f32 v82, v92, v93
    v_cvt_pk_bf16_f32 v83, v94, v95
    s_nop 0
    v_permlane16_swap_b32 v80, v82
    v_permlane16_swap_b32 v81, v83
    s_add_u32 s90, s90, 4096
    buffer_store_dwordx4 v[80:83], v28, s[56:59], s90 offen offset:0 sc1
    v_pk_mul_f32 v[34:35], v[96:97], v[96:97]
    buffer_load_dwordx4 a[48:51], v21, s[56:59], s68 offen sc1
    v_pk_mul_f32 v[36:37], v[98:99], v[98:99]
    v_pk_mul_f32 v[38:39], v[100:101], v[100:101]
    v_pk_mul_f32 v[40:41], v[102:103], v[102:103]
    v_pk_fma_f32 v[34:35], v[34:35], s[94:95], v[26:27]
    v_pk_fma_f32 v[36:37], v[36:37], s[94:95], v[26:27]
    v_pk_fma_f32 v[38:39], v[38:39], s[94:95], v[26:27]
    v_pk_fma_f32 v[40:41], v[40:41], s[94:95], v[26:27]
    v_pk_mul_f32 v[34:35], v[34:35], v[96:97]
    buffer_load_dwordx4 a[52:55], v22, s[56:59], s68 offen sc1
    v_pk_mul_f32 v[36:37], v[36:37], v[98:99]
    v_pk_mul_f32 v[38:39], v[38:39], v[100:101]
    v_pk_mul_f32 v[40:41], v[40:41], v[102:103]
    v_exp_f32 v34, v34
    v_exp_f32 v35, v35
    v_exp_f32 v36, v36
    v_exp_f32 v37, v37
    v_exp_f32 v38, v38
    buffer_load_dwordx4 a[56:59], v23, s[56:59], s68 offen sc1
    v_exp_f32 v39, v39
    v_exp_f32 v40, v40
    v_exp_f32 v41, v41
    v_pk_mul_f32 v[104:105], v[104:105], v[96:97]
    v_pk_mul_f32 v[106:107], v[106:107], v[98:99]
    v_pk_mul_f32 v[108:109], v[108:109], v[100:101]
    v_pk_mul_f32 v[110:111], v[110:111], v[102:103]
    v_pk_add_f32 v[34:35], v[34:35], 1.0 op_sel_hi:[1,0]
    buffer_load_dwordx4 a[60:63], v24, s[56:59], s68 offen sc1
    v_pk_add_f32 v[36:37], v[36:37], 1.0 op_sel_hi:[1,0]
    v_pk_add_f32 v[38:39], v[38:39], 1.0 op_sel_hi:[1,0]
    v_pk_add_f32 v[40:41], v[40:41], 1.0 op_sel_hi:[1,0]
    v_rcp_f32 v34, v34
    v_rcp_f32 v35, v35
    v_rcp_f32 v36, v36
    v_rcp_f32 v37, v37
    v_rcp_f32 v38, v38
    s_add_u32 s68, s68, 16384
    v_rcp_f32 v39, v39
    v_rcp_f32 v40, v40
    v_rcp_f32 v41, v41
    v_pk_mul_f32 v[104:105], v[104:105], v[34:35]
    v_pk_mul_f32 v[106:107], v[106:107], v[36:37]
    v_pk_mul_f32 v[108:109], v[108:109], v[38:39]
    v_pk_mul_f32 v[110:111], v[110:111], v[40:41]
    v_cvt_pk_bf16_f32 v96, v104, v105
    v_cvt_pk_bf16_f32 v97, v106, v107
    v_cvt_pk_bf16_f32 v98, v108, v109
    v_cvt_pk_bf16_f32 v99, v110, v111
    s_nop 0
    v_permlane16_swap_b32 v96, v98
    v_permlane16_swap_b32 v97, v99
    buffer_store_dwordx4 v[96:99], v28, s[56:59], s90 offen offset:2048 sc1
    s_barrier
L_D:
    ds_read_b64_tr_b16 a[128:129], v8 offset:0
    ds_read_b64_tr_b16 a[130:131], v8 offset:4096
    ds_read_b64_tr_b16 a[132:133], v9 offset:0
    ds_read_b64_tr_b16 a[134:135], v9 offset:4096
    ds_read_b64_tr_b16 a[136:137], v10 offset:0
    ds_read_b64_tr_b16 a[138:139], v10 offset:4096
    ds_read_b64_tr_b16 a[140:141], v11 offset:0
    ds_read_b64_tr_b16 a[142:143], v11 offset:4096
    ds_read_b64_tr_b16 a[144:145], v12 offset:0
    ds_read_b64_tr_b16 a[146:147], v12 offset:4096
    ds_read_b64_tr_b16 a[148:149], v13 offset:0
    ds_read_b64_tr_b16 a[150:151], v13 offset:4096
    ds_read_b64_tr_b16 a[152:153], v14 offset:0
    ds_read_b64_tr_b16 a[154:155], v14 offset:4096
    ds_read_b64_tr_b16 a[156:157], v15 offset:0
    ds_read_b64_tr_b16 a[158:159], v15 offset:4096
    s_waitcnt vmcnt(15) lgkmcnt(14)
    v_mfma_f32_16x16x32_bf16 v[128:131], a[128:131], a[0:3], 0
    buffer_load_dwordx4 a[64:67], v21, s[56:59], s68 offen sc1
    s_waitcnt vmcnt(15)
    v_mfma_f32_16x16x32_bf16 v[160:163], a[128:131], a[4:7], 0
    ds_read_b64_tr_b16 a[160:161], v8 offset:8192
    s_waitcnt vmcnt(14)
    v_mfma_f32_16x16x32_bf16 v[192:195], a[128:131], a[8:11], 0
    ds_read_b64_tr_b16 a[162:163], v8 offset:12288
    s_waitcnt vmcnt(13)
    v_mfma_f32_16x16x32_bf16 v[224:227], a[128:131], a[12:15], 0
    buffer_load_dwordx4 a[68:71], v22, s[56:59], s68 offen sc1
    s_waitcnt lgkmcnt(14)
    v_mfma_f32_16x16x32_bf16 v[132:135], a[132:135], a[0:3], 0
    ds_read_b64_tr_b16 a[164:165], v9 offset:8192
    v_accvgpr_read_b32 v64, a112
    v_mfma_f32_16x16x32_bf16 v[164:167], a[132:135], a[4:7], 0
    ds_read_b64_tr_b16 a[166:167], v9 offset:12288
    v_accvgpr_read_b32 v65, a113
    v_mfma_f32_16x16x32_bf16 v[196:199], a[132:135], a[8:11], 0
    buffer_load_dwordx4 a[72:75], v23, s[56:59], s68 offen sc1
    v_mfma_f32_16x16x32_bf16 v[228:231], a[132:135], a[12:15], 0
    ds_read_b64_tr_b16 a[168:169], v10 offset:8192
    v_accvgpr_read_b32 v66, a114
    s_waitcnt lgkmcnt(15)
    v_mfma_f32_16x16x32_bf16 v[136:139], a[136:139], a[0:3], 0
    ds_read_b64_tr_b16 a[170:171], v10 offset:12288
    v_accvgpr_read_b32 v67, a115
    v_mfma_f32_16x16x32_bf16 v[168:171], a[136:139], a[4:7], 0
    buffer_load_dwordx4 a[76:79], v24, s[56:59], s68 offen sc1
    v_mfma_f32_16x16x32_bf16 v[200:203], a[136:139], a[8:11], 0
    ds_read_b64_tr_b16 a[172:173], v11 offset:8192
    v_accvgpr_read_b32 v68, a116
    v_mfma_f32_16x16x32_bf16 v[232:235], a[136:139], a[12:15], 0
    ds_read_b64_tr_b16 a[174:175], v11 offset:12288
    v_accvgpr_read_b32 v69, a117
    s_waitcnt lgkmcnt(15)
    v_mfma_f32_16x16x32_bf16 v[140:143], a[140:143], a[0:3], 0
    s_add_u32 s68, s68, 16384
    v_mfma_f32_16x16x32_bf16 v[172:175], a[140:143], a[4:7], 0
    ds_read_b64_tr_b16 a[176:177], v12 offset:8192
    v_accvgpr_read_b32 v70, a118
    v_mfma_f32_16x16x32_bf16 v[204:207], a[140:143], a[8:11], 0
    ds_read_b64_tr_b16 a[178:179], v12 offset:12288
    v_accvgpr_read_b32 v71, a119
    v_mfma_f32_16x16x32_bf16 v[236:239], a[140:143], a[12:15], 0
    buffer_load_dwordx4 a[80:83], v21, s[56:59], s68 offen sc1
    s_waitcnt lgkmcnt(15)
    v_mfma_f32_16x16x32_bf16 v[144:147], a[144:147], a[0:3], 0
    ds_read_b64_tr_b16 a[180:181], v13 offset:8192
    v_accvgpr_read_b32 v80, a120
    v_mfma_f32_16x16x32_bf16 v[176:179], a[144:147], a[4:7], 0
    ds_read_b64_tr_b16 a[182:183], v13 offset:12288
    v_accvgpr_read_b32 v81, a121
    v_mfma_f32_16x16x32_bf16 v[208:211], a[144:147], a[8:11], 0
    buffer_load_dwordx4 a[84:87], v22, s[56:59], s68 offen sc1
    v_mfma_f32_16x16x32_bf16 v[240:243], a[144:147], a[12:15], 0
    ds_read_b64_tr_b16 a[184:185], v14 offset:8192
    v_accvgpr_read_b32 v82, a122
    s_waitcnt lgkmcnt(15)
    v_mfma_f32_16x16x32_bf16 v[148:151], a[148:151], a[0:3], 0
    ds_read_b64_tr_b16 a[186:187], v14 offset:12288
    s_waitcnt vmcnt(6)
    s_mov_b64 exec, 1
    buffer_atomic_add v42, off, s[56:59], s93 sc1
    s_mov_b64 exec, -1
    v_accvgpr_read_b32 v83, a123
    v_mfma_f32_16x16x32_bf16 v[180:183], a[148:151], a[4:7], 0
    buffer_load_dwordx4 a[88:91], v23, s[56:59], s68 offen sc1
    v_mfma_f32_16x16x32_bf16 v[212:215], a[148:151], a[8:11], 0
    ds_read_b64_tr_b16 a[188:189], v15 offset:8192
    v_accvgpr_read_b32 v84, a124
    v_mfma_f32_16x16x32_bf16 v[244:247], a[148:151], a[12:15], 0
    ds_read_b64_tr_b16 a[190:191], v15 offset:12288
    v_accvgpr_read_b32 v85, a125
    v_mfma_f32_16x16x32_bf16 v[152:155], a[152:155], a[0:3], 0
    v_mfma_f32_16x16x32_bf16 v[184:187], a[152:155], a[4:7], 0
    v_accvgpr_read_b32 v86, a126
    v_mfma_f32_16x16x32_bf16 v[216:219], a[152:155], a[8:11], 0
    v_accvgpr_read_b32 v87, a127
    v_mfma_f32_16x16x32_bf16 v[248:251], a[152:155], a[12:15], 0
    s_waitcnt lgkmcnt(15)
    v_mfma_f32_16x16x32_bf16 v[156:159], a[156:159], a[0:3], 0
    v_mfma_f32_16x16x32_bf16 v[188:191], a[156:159], a[4:7], 0
    v_mfma_f32_16x16x32_bf16 v[220:223], a[156:159], a[8:11], 0
    v_mfma_f32_16x16x32_bf16 v[252:255], a[156:159], a[12:15], 0
    s_waitcnt lgkmcnt(14)
    v_mfma_f32_16x16x32_bf16 v[128:131], a[160:163], a[16:19], v[128:131]
    buffer_load_dwordx4 a[92:95], v24, s[56:59], s68 offen sc1
    v_mfma_f32_16x16x32_bf16 v[160:163], a[160:163], a[20:23], v[160:163]
    ds_read_b64_tr_b16 a[128:129], v8 offset:16384
    v_mfma_f32_16x16x32_bf16 v[192:195], a[160:163], a[24:27], v[192:195]
    ds_read_b64_tr_b16 a[130:131], v8 offset:20480
    v_add_u32 v48, 0x10000, v8
    v_mfma_f32_16x16x32_bf16 v[224:227], a[160:163], a[28:31], v[224:227]
    s_add_u32 s68, s68, 16384
    v_add_u32 v56, 0x20000, v8
    s_waitcnt lgkmcnt(14)
    v_mfma_f32_16x16x32_bf16 v[132:135], a[164:167], a[16:19], v[132:135]
    ds_read_b64_tr_b16 a[132:133], v9 offset:16384
    v_add_u32 v49, 0x10000, v9
    v_mfma_f32_16x16x32_bf16 v[164:167], a[164:167], a[20:23], v[164:167]
    ds_read_b64_tr_b16 a[134:135], v9 offset:20480
    v_mfma_f32_16x16x32_bf16 v[196:199], a[164:167], a[24:27], v[196:199]
    buffer_load_dwordx4 a[96:99], v21, s[56:59], s68 offen sc1
    v_add_u32 v57, 0x20000, v9
    v_mfma_f32_16x16x32_bf16 v[228:231], a[164:167], a[28:31], v[228:231]
    ds_read_b64_tr_b16 a[136:137], v10 offset:16384
    v_add_u32 v50, 0x10000, v10
    s_waitcnt lgkmcnt(15)
    v_mfma_f32_16x16x32_bf16 v[136:139], a[168:171], a[16:19], v[136:139]
    ds_read_b64_tr_b16 a[138:139], v10 offset:20480
    v_add_u32 v58, 0x20000, v10
    v_mfma_f32_16x16x32_bf16 v[168:171], a[168:171], a[20:23], v[168:171]
    buffer_load_dwordx4 a[100:103], v22, s[56:59], s68 offen sc1
    v_mfma_f32_16x16x32_bf16 v[200:203], a[168:171], a[24:27], v[200:203]
    ds_read_b64_tr_b16 a[140:141], v11 offset:16384
    v_add_u32 v51, 0x10000, v11
    v_mfma_f32_16x16x32_bf16 v[232:235], a[168:171], a[28:31], v[232:235]
    ds_read_b64_tr_b16 a[142:143], v11 offset:20480
    v_add_u32 v59, 0x20000, v11
    s_waitcnt lgkmcnt(15)
    v_mfma_f32_16x16x32_bf16 v[140:143], a[172:175], a[16:19], v[140:143]
    buffer_load_dwordx4 a[104:107], v23, s[56:59], s68 offen sc1
    v_add_u32 v52, 0x10000, v12
    v_mfma_f32_16x16x32_bf16 v[172:175], a[172:175], a[20:23], v[172:175]
    ds_read_b64_tr_b16 a[144:145], v12 offset:16384
    v_mfma_f32_16x16x32_bf16 v[204:207], a[172:175], a[24:27], v[204:207]
    ds_read_b64_tr_b16 a[146:147], v12 offset:20480
    v_add_u32 v60, 0x20000, v12
    v_mfma_f32_16x16x32_bf16 v[236:239], a[172:175], a[28:31], v[236:239]
    buffer_load_dwordx4 a[108:111], v24, s[56:59], s68 offen sc1
    v_add_u32 v53, 0x10000, v13
    s_waitcnt lgkmcnt(15)
    v_mfma_f32_16x16x32_bf16 v[144:147], a[176:179], a[16:19], v[144:147]
    ds_read_b64_tr_b16 a[148:149], v13 offset:16384
    v_add_u32 v61, 0x20000, v13
    v_mfma_f32_16x16x32_bf16 v[176:179], a[176:179], a[20:23], v[176:179]
    ds_read_b64_tr_b16 a[150:151], v13 offset:20480
    v_mfma_f32_16x16x32_bf16 v[208:211], a[176:179], a[24:27], v[208:211]
    s_add_u32 s68, s68, 16384
    v_add_u32 v54, 0x10000, v14
    v_mfma_f32_16x16x32_bf16 v[240:243], a[176:179], a[28:31], v[240:243]
    ds_read_b64_tr_b16 a[152:153], v14 offset:16384
    v_add_u32 v62, 0x20000, v14
    s_waitcnt lgkmcnt(15)
    v_mfma_f32_16x16x32_bf16 v[148:151], a[180:183], a[16:19], v[148:151]
    ds_read_b64_tr_b16 a[154:155], v14 offset:20480
    v_add_u32 v55, 0x10000, v15
    v_mfma_f32_16x16x32_bf16 v[180:183], a[180:183], a[20:23], v[180:183]
    buffer_load_dwordx4 a[112:115], v21, s[56:59], s68 offen sc1
    v_mfma_f32_16x16x32_bf16 v[212:215], a[180:183], a[24:27], v[212:215]
    ds_read_b64_tr_b16 a[156:157], v15 offset:16384
    v_add_u32 v63, 0x20000, v15
    v_mfma_f32_16x16x32_bf16 v[244:247], a[180:183], a[28:31], v[244:247]
    ds_read_b64_tr_b16 a[158:159], v15 offset:20480
    v_and_b32 v34, 15, v0
    v_mfma_f32_16x16x32_bf16 v[152:155], a[184:187], a[16:19], v[152:155]
    buffer_load_dwordx4 a[116:119], v22, s[56:59], s68 offen sc1
    v_lshrrev_b32 v35, 4, v0
    v_mfma_f32_16x16x32_bf16 v[184:187], a[184:187], a[20:23], v[184:187]
    v_mfma_f32_16x16x32_bf16 v[216:219], a[184:187], a[24:27], v[216:219]
    v_cmp_gt_u32 s[4:5], 8, v34
    v_mfma_f32_16x16x32_bf16 v[248:251], a[184:187], a[28:31], v[248:251]
    s_mul_i32 s84, s62, 132096
    s_waitcnt lgkmcnt(15)
    v_mfma_f32_16x16x32_bf16 v[156:159], a[188:191], a[16:19], v[156:159]
    v_add_u32 v3, s84, v16
    v_mfma_f32_16x16x32_bf16 v[188:191], a[188:191], a[20:23], v[188:191]
    s_branch L_over8
L_stub8:
    s_branch L_stub10
L_over8:
    v_mfma_f32_16x16x32_bf16 v[220:223], a[188:191], a[24:27], v[220:223]
    v_mfma_f32_16x16x32_bf16 v[252:255], a[188:191], a[28:31], v[252:255]
    s_waitcnt lgkmcnt(14)
    v_mfma_f32_16x16x32_bf16 v[128:131], a[128:131], a[32:35], v[128:131]
    buffer_load_dwordx4 a[120:123], v23, s[56:59], s68 offen sc1
    v_mfma_f32_16x16x32_bf16 v[160:163], a[128:131], a[36:39], v[160:163]
    ds_read_b64_tr_b16 a[160:161], v8 offset:24576
    v_mfma_f32_16x16x32_bf16 v[192:195], a[128:131], a[40:43], v[192:195]
    ds_read_b64_tr_b16 a[162:163], v8 offset:28672
    s_mul_i32 s84, s62, 130048
    v_mfma_f32_16x16x32_bf16 v[224:227], a[128:131], a[44:47], v[224:227]
    buffer_load_dwordx4 a[124:127], v24, s[56:59], s68 offen sc1
    s_sub_u32 s84, 131072, s84
    s_waitcnt lgkmcnt(14)
    v_mfma_f32_16x16x32_bf16 v[132:135], a[132:135], a[32:35], v[132:135]
    ds_read_b64_tr_b16 a[164:165], v9 offset:24576
    v_add_u32 v4, s84, v16
    v_mfma_f32_16x16x32_bf16 v[164:167], a[132:135], a[36:39], v[164:167]
    ds_read_b64_tr_b16 a[166:167], v9 offset:28672
    v_mfma_f32_16x16x32_bf16 v[196:199], a[132:135], a[40:43], v[196:199]
    s_add_u32 s68, s68, 16384
    v_lshlrev_b32 v35, 2, v35
    v_mfma_f32_16x16x32_bf16 v[228:231], a[132:135], a[44:47], v[228:231]
    ds_read_b64_tr_b16 a[168:169], v10 offset:24576
    v_sub_u32 v34, v34, v35
    s_waitcnt lgkmcnt(15)
    v_mfma_f32_16x16x32_bf16 v[136:139], a[136:139], a[32:35], v[136:139]
    ds_read_b64_tr_b16 a[170:171], v10 offset:28672
    v_mov_b32 v26, 0
    v_mfma_f32_16x16x32_bf16 v[168:171], a[136:139], a[36:39], v[168:171]
    buffer_load_dwordx4 a[0:3], v21, s[56:59], s68 offen sc1
    v_mfma_f32_16x16x32_bf16 v[200:203], a[136:139], a[40:43], v[200:203]
    ds_read_b64_tr_b16 a[172:173], v11 offset:24576
    v_mov_b32 v27, 0
    v_mfma_f32_16x16x32_bf16 v[232:235], a[136:139], a[44:47], v[232:235]
    ds_read_b64_tr_b16 a[174:175], v11 offset:28672
    v_mov_b32 v30, 0
    s_waitcnt lgkmcnt(15)
    v_mfma_f32_16x16x32_bf16 v[140:143], a[140:143], a[32:35], v[140:143]
    buffer_load_dwordx4 a[4:7], v22, s[56:59], s68 offen sc1
    v_mov_b32 v31, 0
    v_mfma_f32_16x16x32_bf16 v[172:175], a[140:143], a[36:39], v[172:175]
    ds_read_b64_tr_b16 a[176:177], v12 offset:24576
    v_mfma_f32_16x16x32_bf16 v[204:207], a[140:143], a[40:43], v[204:207]
    ds_read_b64_tr_b16 a[178:179], v12 offset:28672
    v_mov_b32 v35, 0x3f80
    v_mfma_f32_16x16x32_bf16 v[236:239], a[140:143], a[44:47], v[236:239]
    buffer_load_dwordx4 a[8:11], v23, s[56:59], s68 offen sc1
    v_mov_b32 v36, 0x3f800000
    s_waitcnt lgkmcnt(15)
    v_mfma_f32_16x16x32_bf16 v[144:147], a[144:147], a[32:35], v[144:147]
    ds_read_b64_tr_b16 a[180:181], v13 offset:24576
    v_cmp_eq_u32 vcc, 0, v34
    v_mfma_f32_16x16x32_bf16 v[176:179], a[144:147], a[36:39], v[176:179]
    ds_read_b64_tr_b16 a[182:183], v13 offset:28672
    v_mfma_f32_16x16x32_bf16 v[208:211], a[144:147], a[40:43], v[208:211]
    buffer_load_dwordx4 a[12:15], v24, s[56:59], s68 offen sc1
    v_cndmask_b32 v28, v26, v35, vcc
    v_mfma_f32_16x16x32_bf16 v[240:243], a[144:147], a[44:47], v[240:243]
    ds_read_b64_tr_b16 a[184:185], v14 offset:24576
    v_cmp_eq_u32 vcc, 1, v34
    s_waitcnt lgkmcnt(15)
    v_mfma_f32_16x16x32_bf16 v[148:151], a[148:151], a[32:35], v[148:151]
    ds_read_b64_tr_b16 a[186:187], v14 offset:28672
    v_cndmask_b32 v28, v28, v36, vcc
    v_mfma_f32_16x16x32_bf16 v[180:183], a[148:151], a[36:39], v[180:183]
    s_add_u32 s68, s68, 16384
    v_mfma_f32_16x16x32_bf16 v[212:215], a[148:151], a[40:43], v[212:215]
    ds_read_b64_tr_b16 a[188:189], v15 offset:24576
    v_cmp_eq_u32 vcc, 2, v34
    v_mfma_f32_16x16x32_bf16 v[244:247], a[148:151], a[44:47], v[244:247]
    ds_read_b64_tr_b16 a[190:191], v15 offset:28672
    v_cndmask_b32 v29, v26, v35, vcc
    v_mfma_f32_16x16x32_bf16 v[152:155], a[152:155], a[32:35], v[152:155]
    buffer_load_dwordx4 a[16:19], v21, s[56:59], s68 offen sc1
    v_cmp_eq_u32 vcc, 3, v34
    v_mfma_f32_16x16x32_bf16 v[184:187], a[152:155], a[36:39], v[184:187]
    v_mfma_f32_16x16x32_bf16 v[216:219], a[152:155], a[40:43], v[216:219]
    v_cndmask_b32 v29, v29, v36, vcc
    v_mfma_f32_16x16x32_bf16 v[248:251], a[152:155], a[44:47], v[248:251]
    s_mov_b32 s14, 0xbfb8aa3b
    s_waitcnt lgkmcnt(15)
    v_mfma_f32_16x16x32_bf16 v[156:159], a[156:159], a[32:35], v[156:159]
    s_mov_b32 s15, 0xbfb8aa3b
    v_mfma_f32_16x16x32_bf16 v[188:191], a[156:159], a[36:39], v[188:191]
    v_mfma_f32_16x16x32_bf16 v[220:223], a[156:159], a[40:43], v[220:223]
    v_mfma_f32_16x16x32_bf16 v[252:255], a[156:159], a[44:47], v[252:255]
    s_waitcnt lgkmcnt(14)
    v_mfma_f32_16x16x32_bf16 v[128:131], a[160:163], a[48:51], v[128:131]
    buffer_load_dwordx4 a[20:23], v22, s[56:59], s68 offen sc1
    v_mfma_f32_16x16x32_bf16 v[160:163], a[160:163], a[52:55], v[160:163]
    ds_read_b64_tr_b16 a[128:129], v8 offset:32768
    v_mfma_f32_16x16x32_bf16 v[192:195], a[160:163], a[56:59], v[192:195]
    ds_read_b64_tr_b16 a[130:131], v8 offset:36864
    v_mfma_f32_16x16x32_bf16 v[224:227], a[160:163], a[60:63], v[224:227]
    buffer_load_dwordx4 a[24:27], v23, s[56:59], s68 offen sc1
    s_waitcnt lgkmcnt(14)
    v_mfma_f32_16x16x32_bf16 v[132:135], a[164:167], a[48:51], v[132:135]
    ds_read_b64_tr_b16 a[132:133], v9 offset:32768
    v_mfma_f32_16x16x32_bf16 v[164:167], a[164:167], a[52:55], v[164:167]
    ds_read_b64_tr_b16 a[134:135], v9 offset:36864
    v_mfma_f32_16x16x32_bf16 v[196:199], a[164:167], a[56:59], v[196:199]
    buffer_load_dwordx4 a[28:31], v24, s[56:59], s68 offen sc1
    v_mfma_f32_16x16x32_bf16 v[228:231], a[164:167], a[60:63], v[228:231]
    ds_read_b64_tr_b16 a[136:137], v10 offset:32768
    s_waitcnt lgkmcnt(15)
    v_mfma_f32_16x16x32_bf16 v[136:139], a[168:171], a[48:51], v[136:139]
    ds_read_b64_tr_b16 a[138:139], v10 offset:36864
    v_mfma_f32_16x16x32_bf16 v[168:171], a[168:171], a[52:55], v[168:171]
    s_add_u32 s68, s68, 16384
    v_mfma_f32_16x16x32_bf16 v[200:203], a[168:171], a[56:59], v[200:203]
    ds_read_b64_tr_b16 a[140:141], v11 offset:32768
    v_mfma_f32_16x16x32_bf16 v[232:235], a[168:171], a[60:63], v[232:235]
    ds_read_b64_tr_b16 a[142:143], v11 offset:36864
    s_waitcnt lgkmcnt(15)
    v_mfma_f32_16x16x32_bf16 v[140:143], a[172:175], a[48:51], v[140:143]
    buffer_load_dwordx4 a[32:35], v21, s[56:59], s68 offen sc1
    v_mfma_f32_16x16x32_bf16 v[172:175], a[172:175], a[52:55], v[172:175]
    ds_read_b64_tr_b16 a[144:145], v12 offset:32768
    v_mfma_f32_16x16x32_bf16 v[204:207], a[172:175], a[56:59], v[204:207]
    ds_read_b64_tr_b16 a[146:147], v12 offset:36864
    v_mfma_f32_16x16x32_bf16 v[236:239], a[172:175], a[60:63], v[236:239]
    buffer_load_dwordx4 a[36:39], v22, s[56:59], s68 offen sc1
    s_waitcnt lgkmcnt(15)
    v_mfma_f32_16x16x32_bf16 v[144:147], a[176:179], a[48:51], v[144:147]
    ds_read_b64_tr_b16 a[148:149], v13 offset:32768
    v_mfma_f32_16x16x32_bf16 v[176:179], a[176:179], a[52:55], v[176:179]
    ds_read_b64_tr_b16 a[150:151], v13 offset:36864
    v_mfma_f32_16x16x32_bf16 v[208:211], a[176:179], a[56:59], v[208:211]
    buffer_load_dwordx4 a[40:43], v23, s[56:59], s68 offen sc1
    v_mfma_f32_16x16x32_bf16 v[240:243], a[176:179], a[60:63], v[240:243]
    ds_read_b64_tr_b16 a[152:153], v14 offset:32768
    s_waitcnt lgkmcnt(15)
    v_mfma_f32_16x16x32_bf16 v[148:151], a[180:183], a[48:51], v[148:151]
    ds_read_b64_tr_b16 a[154:155], v14 offset:36864
    v_mfma_f32_16x16x32_bf16 v[180:183], a[180:183], a[52:55], v[180:183]
    buffer_load_dwordx4 a[44:47], v24, s[56:59], s68 offen sc1
    v_mfma_f32_16x16x32_bf16 v[212:215], a[180:183], a[56:59], v[212:215]
    ds_read_b64_tr_b16 a[156:157], v15 offset:32768
    v_mfma_f32_16x16x32_bf16 v[244:247], a[180:183], a[60:63], v[244:247]
    ds_read_b64_tr_b16 a[158:159], v15 offset:36864
    v_mfma_f32_16x16x32_bf16 v[152:155], a[184:187], a[48:51], v[152:155]
    s_add_u32 s68, s68, 16384
    v_mfma_f32_16x16x32_bf16 v[184:187], a[184:187], a[52:55], v[184:187]
    v_mfma_f32_16x16x32_bf16 v[216:219], a[184:187], a[56:59], v[216:219]
    v_mfma_f32_16x16x32_bf16 v[248:251], a[184:187], a[60:63], v[248:251]
    s_waitcnt lgkmcnt(15)
    v_mfma_f32_16x16x32_bf16 v[156:159], a[188:191], a[48:51], v[156:159]
    buffer_load_dword v43, off, s[56:59], s92 sc1
    v_mfma_f32_16x16x32_bf16 v[188:191], a[188:191], a[52:55], v[188:191]
    v_mfma_f32_16x16x32_bf16 v[220:223], a[188:191], a[56:59], v[220:223]
    v_mfma_f32_16x16x32_bf16 v[252:255], a[188:191], a[60:63], v[252:255]
    s_barrier
    s_waitcnt vmcnt(29) lgkmcnt(14)
    v_mfma_f32_16x16x32_bf16 v[128:131], a[128:131], a[64:67], v[128:131]
    buffer_load_dwordx4 a[48:51], v21, s[56:59], s68 offen sc1
    s_waitcnt vmcnt(29)
    v_mfma_f32_16x16x32_bf16 v[160:163], a[128:131], a[68:71], v[160:163]
    ds_read_b64_tr_b16 a[160:161], v8 offset:40960
    s_waitcnt vmcnt(28)
    v_mfma_f32_16x16x32_bf16 v[192:195], a[128:131], a[72:75], v[192:195]
    ds_read_b64_tr_b16 a[162:163], v8 offset:45056
    buffer_load_dwordx4 a[52:55], v22, s[56:59], s68 offen sc1
    s_waitcnt vmcnt(28)
    v_mfma_f32_16x16x32_bf16 v[224:227], a[128:131], a[76:79], v[224:227]
    s_waitcnt lgkmcnt(14)
    v_mfma_f32_16x16x32_bf16 v[132:135], a[132:135], a[64:67], v[132:135]
    ds_read_b64_tr_b16 a[164:165], v9 offset:40960
    buffer_load_dwordx4 a[56:59], v23, s[56:59], s68 offen sc1
    v_mfma_f32_16x16x32_bf16 v[164:167], a[132:135], a[68:71], v[164:167]
    ds_read_b64_tr_b16 a[166:167], v9 offset:45056
    v_mfma_f32_16x16x32_bf16 v[196:199], a[132:135], a[72:75], v[196:199]
    buffer_load_dwordx4 a[60:63], v24, s[56:59], s68 offen sc1
    v_mfma_f32_16x16x32_bf16 v[228:231], a[132:135], a[76:79], v[228:231]
    ds_read_b64_tr_b16 a[168:169], v10 offset:40960
    s_waitcnt lgkmcnt(15)
    v_mfma_f32_16x16x32_bf16 v[136:139], a[136:139], a[64:67], v[136:139]
    ds_read_b64_tr_b16 a[170:171], v10 offset:45056
    s_add_u32 s68, s68, 16384
    v_mfma_f32_16x16x32_bf16 v[168:171], a[136:139], a[68:71], v[168:171]
    v_mfma_f32_16x16x32_bf16 v[200:203], a[136:139], a[72:75], v[200:203]
    ds_read_b64_tr_b16 a[172:173], v11 offset:40960
    v_mfma_f32_16x16x32_bf16 v[232:235], a[136:139], a[76:79], v[232:235]
    ds_read_b64_tr_b16 a[174:175], v11 offset:45056
    s_mov_b32 s82, 1048576
    s_add_u32 m0, s3, 0
    s_waitcnt lgkmcnt(15)
    v_mfma_f32_16x16x32_bf16 v[140:143], a[140:143], a[64:67], v[140:143]
    buffer_load_dwordx4 v17, s[48:51], s82 offen lds
    v_mfma_f32_16x16x32_bf16 v[172:175], a[140:143], a[68:71], v[172:175]
    ds_read_b64_tr_b16 a[176:177], v12 offset:40960
    v_mfma_f32_16x16x32_bf16 v[204:207], a[140:143], a[72:75], v[204:207]
    ds_read_b64_tr_b16 a[178:179], v12 offset:45056
    v_mfma_f32_16x16x32_bf16 v[236:239], a[140:143], a[76:79], v[236:239]
    s_waitcnt lgkmcnt(15)
    v_mfma_f32_16x16x32_bf16 v[144:147], a[144:147], a[64:67], v[144:147]
    ds_read_b64_tr_b16 a[180:181], v13 offset:40960
    buffer_load_dwordx4 v18, s[48:51], s82 offen offset:1024 lds
    v_mfma_f32_16x16x32_bf16 v[176:179], a[144:147], a[68:71], v[176:179]
    ds_read_b64_tr_b16 a[182:183], v13 offset:45056
    v_mfma_f32_16x16x32_bf16 v[208:211], a[144:147], a[72:75], v[208:211]
    v_mfma_f32_16x16x32_bf16 v[240:243], a[144:147], a[76:79], v[240:243]
    ds_read_b64_tr_b16 a[184:185], v14 offset:40960
    s_waitcnt lgkmcnt(15)
    v_mfma_f32_16x16x32_bf16 v[148:151], a[148:151], a[64:67], v[148:151]
    ds_read_b64_tr_b16 a[186:187], v14 offset:45056
    v_mfma_f32_16x16x32_bf16 v[180:183], a[148:151], a[68:71], v[180:183]
    v_mfma_f32_16x16x32_bf16 v[212:215], a[148:151], a[72:75], v[212:215]
    ds_read_b64_tr_b16 a[188:189], v15 offset:40960
    v_mfma_f32_16x16x32_bf16 v[244:247], a[148:151], a[76:79], v[244:247]
    ds_read_b64_tr_b16 a[190:191], v15 offset:45056
    v_mfma_f32_16x16x32_bf16 v[152:155], a[152:155], a[64:67], v[152:155]
    v_mfma_f32_16x16x32_bf16 v[184:187], a[152:155], a[68:71], v[184:187]
    v_mfma_f32_16x16x32_bf16 v[216:219], a[152:155], a[72:75], v[216:219]
    v_mfma_f32_16x16x32_bf16 v[248:251], a[152:155], a[76:79], v[248:251]
    s_waitcnt lgkmcnt(15)
    v_mfma_f32_16x16x32_bf16 v[156:159], a[156:159], a[64:67], v[156:159]
    v_mfma_f32_16x16x32_bf16 v[188:191], a[156:159], a[68:71], v[188:191]
    v_mfma_f32_16x16x32_bf16 v[220:223], a[156:159], a[72:75], v[220:223]
    v_mfma_f32_16x16x32_bf16 v[252:255], a[156:159], a[76:79], v[252:255]
    s_waitcnt vmcnt(31) lgkmcnt(14)
    v_mfma_f32_16x16x32_bf16 v[128:131], a[160:163], a[80:83], v[128:131]
    buffer_load_dwordx4 a[64:67], v21, s[56:59], s68 offen sc1
    s_waitcnt vmcnt(31)
    v_mfma_f32_16x16x32_bf16 v[160:163], a[160:163], a[84:87], v[160:163]
    ds_read_b64_tr_b16 a[128:129], v8 offset:49152
    s_waitcnt vmcnt(29)
    v_mfma_f32_16x16x32_bf16 v[192:195], a[160:163], a[88:91], v[192:195]
    ds_read_b64_tr_b16 a[130:131], v8 offset:53248
    buffer_load_dwordx4 a[68:71], v22, s[56:59], s68 offen sc1
    s_waitcnt vmcnt(29)
    v_mfma_f32_16x16x32_bf16 v[224:227], a[160:163], a[92:95], v[224:227]
    s_waitcnt lgkmcnt(14)
    v_mfma_f32_16x16x32_bf16 v[132:135], a[164:167], a[80:83], v[132:135]
    ds_read_b64_tr_b16 a[132:133], v9 offset:49152
    buffer_load_dwordx4 a[72:75], v23, s[56:59], s68 offen sc1
    v_mfma_f32_16x16x32_bf16 v[164:167], a[164:167], a[84:87], v[164:167]
    ds_read_b64_tr_b16 a[134:135], v9 offset:53248
    v_mfma_f32_16x16x32_bf16 v[196:199], a[164:167], a[88:91], v[196:199]
    buffer_load_dwordx4 a[76:79], v24, s[56:59], s68 offen sc1
    v_mfma_f32_16x16x32_bf16 v[228:231], a[164:167], a[92:95], v[228:231]
    ds_read_b64_tr_b16 a[136:137], v10 offset:49152
    s_waitcnt lgkmcnt(15)
    v_mfma_f32_16x16x32_bf16 v[136:139], a[168:171], a[80:83], v[136:139]
    ds_read_b64_tr_b16 a[138:139], v10 offset:53248
    s_add_u32 s68, s68, 16384
    v_mfma_f32_16x16x32_bf16 v[168:171], a[168:171], a[84:87], v[168:171]
    v_mfma_f32_16x16x32_bf16 v[200:203], a[168:171], a[88:91], v[200:203]
    ds_read_b64_tr_b16 a[140:141], v11 offset:49152
    v_mfma_f32_16x16x32_bf16 v[232:235], a[168:171], a[92:95], v[232:235]
    ds_read_b64_tr_b16 a[142:143], v11 offset:53248
    s_mov_b32 s83, 1277952
    s_add_u32 m0, s3, 8192
    s_waitcnt lgkmcnt(15)
    v_mfma_f32_16x16x32_bf16 v[140:143], a[172:175], a[80:83], v[140:143]
    buffer_load_dwordx4 v17, s[48:51], s83 offen lds
    v_mfma_f32_16x16x32_bf16 v[172:175], a[172:175], a[84:87], v[172:175]
    ds_read_b64_tr_b16 a[144:145], v12 offset:49152
    v_mfma_f32_16x16x32_bf16 v[204:207], a[172:175], a[88:91], v[204:207]
    ds_read_b64_tr_b16 a[146:147], v12 offset:53248
    v_mfma_f32_16x16x32_bf16 v[236:239], a[172:175], a[92:95], v[236:239]
    s_waitcnt lgkmcnt(15)
    v_mfma_f32_16x16x32_bf16 v[144:147], a[176:179], a[80:83], v[144:147]
    ds_read_b64_tr_b16 a[148:149], v13 offset:49152
    buffer_load_dwordx4 v18, s[48:51], s83 offen offset:1024 lds
    v_mfma_f32_16x16x32_bf16 v[176:179], a[176:179], a[84:87], v[176:179]
    ds_read_b64_tr_b16 a[150:151], v13 offset:53248
    v_mfma_f32_16x16x32_bf16 v[208:211], a[176:179], a[88:91], v[208:211]
    v_mfma_f32_16x16x32_bf16 v[240:243], a[176:179], a[92:95], v[240:243]
    ds_read_b64_tr_b16 a[152:153], v14 offset:49152
    s_waitcnt lgkmcnt(15)
    v_mfma_f32_16x16x32_bf16 v[148:151], a[180:183], a[80:83], v[148:151]
    ds_read_b64_tr_b16 a[154:155], v14 offset:53248
    v_mfma_f32_16x16x32_bf16 v[180:183], a[180:183], a[84:87], v[180:183]
    v_mfma_f32_16x16x32_bf16 v[212:215], a[180:183], a[88:91], v[212:215]
    ds_read_b64_tr_b16 a[156:157], v15 offset:49152
    v_mfma_f32_16x16x32_bf16 v[244:247], a[180:183], a[92:95], v[244:247]
    ds_read_b64_tr_b16 a[158:159], v15 offset:53248
    v_mfma_f32_16x16x32_bf16 v[152:155], a[184:187], a[80:83], v[152:155]
    v_mfma_f32_16x16x32_bf16 v[184:187], a[184:187], a[84:87], v[184:187]
    v_mfma_f32_16x16x32_bf16 v[216:219], a[184:187], a[88:91], v[216:219]
    v_mfma_f32_16x16x32_bf16 v[248:251], a[184:187], a[92:95], v[248:251]
    s_waitcnt lgkmcnt(15)
    v_mfma_f32_16x16x32_bf16 v[156:159], a[188:191], a[80:83], v[156:159]
    v_mfma_f32_16x16x32_bf16 v[188:191], a[188:191], a[84:87], v[188:191]
    v_mfma_f32_16x16x32_bf16 v[220:223], a[188:191], a[88:91], v[220:223]
    v_mfma_f32_16x16x32_bf16 v[252:255], a[188:191], a[92:95], v[252:255]
    s_waitcnt vmcnt(32) lgkmcnt(14)
    v_mfma_f32_16x16x32_bf16 v[128:131], a[128:131], a[96:99], v[128:131]
    buffer_load_dwordx4 a[80:83], v21, s[56:59], s68 offen sc1
    s_waitcnt vmcnt(32)
    v_mfma_f32_16x16x32_bf16 v[160:163], a[128:131], a[100:103], v[160:163]
    ds_read_b64_tr_b16 a[160:161], v8 offset:57344
    s_waitcnt vmcnt(31)
    v_mfma_f32_16x16x32_bf16 v[192:195], a[128:131], a[104:107], v[192:195]
    ds_read_b64_tr_b16 a[162:163], v8 offset:61440
    buffer_load_dwordx4 a[84:87], v22, s[56:59], s68 offen sc1
    s_waitcnt vmcnt(31)
    v_mfma_f32_16x16x32_bf16 v[224:227], a[128:131], a[108:111], v[224:227]
    s_waitcnt lgkmcnt(14)
    v_mfma_f32_16x16x32_bf16 v[132:135], a[132:135], a[96:99], v[132:135]
    ds_read_b64_tr_b16 a[164:165], v9 offset:57344
    buffer_load_dwordx4 a[88:91], v23, s[56:59], s68 offen sc1
    v_mfma_f32_16x16x32_bf16 v[164:167], a[132:135], a[100:103], v[164:167]
    ds_read_b64_tr_b16 a[166:167], v9 offset:61440
    v_mfma_f32_16x16x32_bf16 v[196:199], a[132:135], a[104:107], v[196:199]
    buffer_load_dwordx4 a[92:95], v24, s[56:59], s68 offen sc1
    v_mfma_f32_16x16x32_bf16 v[228:231], a[132:135], a[108:111], v[228:231]
    ds_read_b64_tr_b16 a[168:169], v10 offset:57344
    s_waitcnt lgkmcnt(15)
    v_mfma_f32_16x16x32_bf16 v[136:139], a[136:139], a[96:99], v[136:139]
    ds_read_b64_tr_b16 a[170:171], v10 offset:61440
    s_add_u32 s68, s68, 16384
    v_mfma_f32_16x16x32_bf16 v[168:171], a[136:139], a[100:103], v[168:171]
    v_mfma_f32_16x16x32_bf16 v[200:203], a[136:139], a[104:107], v[200:203]
    ds_read_b64_tr_b16 a[172:173], v11 offset:57344
    v_mfma_f32_16x16x32_bf16 v[232:235], a[136:139], a[108:111], v[232:235]
    ds_read_b64_tr_b16 a[174:175], v11 offset:61440
    s_mov_b32 s82, 1507328
    s_add_u32 m0, s3, 16384
    s_waitcnt lgkmcnt(15)
    v_mfma_f32_16x16x32_bf16 v[140:143], a[140:143], a[96:99], v[140:143]
    buffer_load_dwordx4 v17, s[48:51], s82 offen lds
    v_mfma_f32_16x16x32_bf16 v[172:175], a[140:143], a[100:103], v[172:175]
    ds_read_b64_tr_b16 a[176:177], v12 offset:57344
    v_mfma_f32_16x16x32_bf16 v[204:207], a[140:143], a[104:107], v[204:207]
    ds_read_b64_tr_b16 a[178:179], v12 offset:61440
    v_mfma_f32_16x16x32_bf16 v[236:239], a[140:143], a[108:111], v[236:239]
    s_waitcnt lgkmcnt(15)
    v_mfma_f32_16x16x32_bf16 v[144:147], a[144:147], a[96:99], v[144:147]
    ds_read_b64_tr_b16 a[180:181], v13 offset:57344
    buffer_load_dwordx4 v18, s[48:51], s82 offen offset:1024 lds
    v_mfma_f32_16x16x32_bf16 v[176:179], a[144:147], a[100:103], v[176:179]
    ds_read_b64_tr_b16 a[182:183], v13 offset:61440
    v_mfma_f32_16x16x32_bf16 v[208:211], a[144:147], a[104:107], v[208:211]
    v_mfma_f32_16x16x32_bf16 v[240:243], a[144:147], a[108:111], v[240:243]
    ds_read_b64_tr_b16 a[184:185], v14 offset:57344
    s_waitcnt lgkmcnt(15)
    v_mfma_f32_16x16x32_bf16 v[148:151], a[148:151], a[96:99], v[148:151]
    ds_read_b64_tr_b16 a[186:187], v14 offset:61440
    v_mfma_f32_16x16x32_bf16 v[180:183], a[148:151], a[100:103], v[180:183]
    v_mfma_f32_16x16x32_bf16 v[212:215], a[148:151], a[104:107], v[212:215]
    ds_read_b64_tr_b16 a[188:189], v15 offset:57344
    v_mfma_f32_16x16x32_bf16 v[244:247], a[148:151], a[108:111], v[244:247]
    ds_read_b64_tr_b16 a[190:191], v15 offset:61440
    v_mfma_f32_16x16x32_bf16 v[152:155], a[152:155], a[96:99], v[152:155]
    v_mfma_f32_16x16x32_bf16 v[184:187], a[152:155], a[100:103], v[184:187]
    v_mfma_f32_16x16x32_bf16 v[216:219], a[152:155], a[104:107], v[216:219]
    v_mfma_f32_16x16x32_bf16 v[248:251], a[152:155], a[108:111], v[248:251]
    s_waitcnt lgkmcnt(15)
    v_mfma_f32_16x16x32_bf16 v[156:159], a[156:159], a[96:99], v[156:159]
    v_mfma_f32_16x16x32_bf16 v[188:191], a[156:159], a[100:103], v[188:191]
    v_mfma_f32_16x16x32_bf16 v[220:223], a[156:159], a[104:107], v[220:223]
    v_mfma_f32_16x16x32_bf16 v[252:255], a[156:159], a[108:111], v[252:255]
    s_waitcnt vmcnt(34) lgkmcnt(14)
    v_mfma_f32_16x16x32_bf16 v[128:131], a[160:163], a[112:115], v[128:131]
    buffer_load_dwordx4 a[96:99], v21, s[56:59], s68 offen sc1
    s_waitcnt vmcnt(34)
    v_mfma_f32_16x16x32_bf16 v[160:163], a[160:163], a[116:119], v[160:163]
    ds_read_b64_tr_b16 a[128:129], v48 offset:0
    s_waitcnt vmcnt(33)
    v_mfma_f32_16x16x32_bf16 v[192:195], a[160:163], a[120:123], v[192:195]
    ds_read_b64_tr_b16 a[130:131], v48 offset:4096
    buffer_load_dwordx4 a[100:103], v22, s[56:59], s68 offen sc1
    s_waitcnt vmcnt(33)
    v_mfma_f32_16x16x32_bf16 v[224:227], a[160:163], a[124:127], v[224:227]
    s_waitcnt lgkmcnt(14)
    v_mfma_f32_16x16x32_bf16 v[132:135], a[164:167], a[112:115], v[132:135]
    ds_read_b64_tr_b16 a[132:133], v49 offset:0
    buffer_load_dwordx4 a[104:107], v23, s[56:59], s68 offen sc1
    v_mfma_f32_16x16x32_bf16 v[164:167], a[164:167], a[116:119], v[164:167]
    ds_read_b64_tr_b16 a[134:135], v49 offset:4096
    v_mfma_f32_16x16x32_bf16 v[196:199], a[164:167], a[120:123], v[196:199]
    buffer_load_dwordx4 a[108:111], v24, s[56:59], s68 offen sc1
    v_mfma_f32_16x16x32_bf16 v[228:231], a[164:167], a[124:127], v[228:231]
    ds_read_b64_tr_b16 a[136:137], v50 offset:0
    s_waitcnt lgkmcnt(15)
    v_mfma_f32_16x16x32_bf16 v[136:139], a[168:171], a[112:115], v[136:139]
    ds_read_b64_tr_b16 a[138:139], v50 offset:4096
    s_add_u32 s68, s68, 16384
    v_mfma_f32_16x16x32_bf16 v[168:171], a[168:171], a[116:119], v[168:171]
    v_mfma_f32_16x16x32_bf16 v[200:203], a[168:171], a[120:123], v[200:203]
    ds_read_b64_tr_b16 a[140:141], v51 offset:0
    v_mfma_f32_16x16x32_bf16 v[232:235], a[168:171], a[124:127], v[232:235]
    ds_read_b64_tr_b16 a[142:143], v51 offset:4096
    s_mov_b32 s83, 1736704
    s_add_u32 m0, s3, 24576
    s_waitcnt lgkmcnt(15)
    v_mfma_f32_16x16x32_bf16 v[140:143], a[172:175], a[112:115], v[140:143]
    buffer_load_dwordx4 v17, s[48:51], s83 offen lds
    v_mfma_f32_16x16x32_bf16 v[172:175], a[172:175], a[116:119], v[172:175]
    ds_read_b64_tr_b16 a[144:145], v52 offset:0
    v_mfma_f32_16x16x32_bf16 v[204:207], a[172:175], a[120:123], v[204:207]
    ds_read_b64_tr_b16 a[146:147], v52 offset:4096
    v_mfma_f32_16x16x32_bf16 v[236:239], a[172:175], a[124:127], v[236:239]
    s_waitcnt lgkmcnt(15)
    v_mfma_f32_16x16x32_bf16 v[144:147], a[176:179], a[112:115], v[144:147]
    ds_read_b64_tr_b16 a[148:149], v53 offset:0
    buffer_load_dwordx4 v18, s[48:51], s83 offen offset:1024 lds
    v_mfma_f32_16x16x32_bf16 v[176:179], a[176:179], a[116:119], v[176:179]
    ds_read_b64_tr_b16 a[150:151], v53 offset:4096
    v_mfma_f32_16x16x32_bf16 v[208:211], a[176:179], a[120:123], v[208:211]
    v_mfma_f32_16x16x32_bf16 v[240:243], a[176:179], a[124:127], v[240:243]
    ds_read_b64_tr_b16 a[152:153], v54 offset:0
    s_waitcnt lgkmcnt(15)
    v_mfma_f32_16x16x32_bf16 v[148:151], a[180:183], a[112:115], v[148:151]
    ds_read_b64_tr_b16 a[154:155], v54 offset:4096
    v_mfma_f32_16x16x32_bf16 v[180:183], a[180:183], a[116:119], v[180:183]
    v_mfma_f32_16x16x32_bf16 v[212:215], a[180:183], a[120:123], v[212:215]
    ds_read_b64_tr_b16 a[156:157], v55 offset:0
    v_mfma_f32_16x16x32_bf16 v[244:247], a[180:183], a[124:127], v[244:247]
    ds_read_b64_tr_b16 a[158:159], v55 offset:4096
    v_mfma_f32_16x16x32_bf16 v[152:155], a[184:187], a[112:115], v[152:155]
    v_mfma_f32_16x16x32_bf16 v[184:187], a[184:187], a[116:119], v[184:187]
    v_mfma_f32_16x16x32_bf16 v[216:219], a[184:187], a[120:123], v[216:219]
    v_mfma_f32_16x16x32_bf16 v[248:251], a[184:187], a[124:127], v[248:251]
    s_waitcnt lgkmcnt(15)
    v_mfma_f32_16x16x32_bf16 v[156:159], a[188:191], a[112:115], v[156:159]
    v_mfma_f32_16x16x32_bf16 v[188:191], a[188:191], a[116:119], v[188:191]
    v_mfma_f32_16x16x32_bf16 v[220:223], a[188:191], a[120:123], v[220:223]
    v_mfma_f32_16x16x32_bf16 v[252:255], a[188:191], a[124:127], v[252:255]
    s_waitcnt lgkmcnt(0)
    s_barrier
    s_waitcnt vmcnt(36)
    v_mfma_f32_16x16x32_bf16 v[128:131], a[128:131], a[0:3], v[128:131]
    buffer_load_dwordx4 a[112:115], v21, s[56:59], s68 offen sc1
    s_waitcnt vmcnt(36)
    v_mfma_f32_16x16x32_bf16 v[160:163], a[128:131], a[4:7], v[160:163]
    ds_read_b64_tr_b16 a[160:161], v48 offset:8192
    s_waitcnt vmcnt(35)
    v_mfma_f32_16x16x32_bf16 v[192:195], a[128:131], a[8:11], v[192:195]
    ds_read_b64_tr_b16 a[162:163], v48 offset:12288
    buffer_load_dwordx4 a[116:119], v22, s[56:59], s68 offen sc1
    s_waitcnt vmcnt(35)
    v_mfma_f32_16x16x32_bf16 v[224:227], a[128:131], a[12:15], v[224:227]
    v_mfma_f32_16x16x32_bf16 v[132:135], a[132:135], a[0:3], v[132:135]
    ds_read_b64_tr_b16 a[164:165], v49 offset:8192
    buffer_load_dwordx4 a[120:123], v23, s[56:59], s68 offen sc1
    v_mfma_f32_16x16x32_bf16 v[164:167], a[132:135], a[4:7], v[164:167]
    ds_read_b64_tr_b16 a[166:167], v49 offset:12288
    v_mfma_f32_16x16x32_bf16 v[196:199], a[132:135], a[8:11], v[196:199]
    buffer_load_dwordx4 a[124:127], v24, s[56:59], s68 offen sc1
    v_mfma_f32_16x16x32_bf16 v[228:231], a[132:135], a[12:15], v[228:231]
    ds_read_b64_tr_b16 a[168:169], v50 offset:8192
    v_mfma_f32_16x16x32_bf16 v[136:139], a[136:139], a[0:3], v[136:139]
    ds_read_b64_tr_b16 a[170:171], v50 offset:12288
    s_add_u32 s68, s68, 16384
    v_mfma_f32_16x16x32_bf16 v[168:171], a[136:139], a[4:7], v[168:171]
    v_mfma_f32_16x16x32_bf16 v[200:203], a[136:139], a[8:11], v[200:203]
    ds_read_b64_tr_b16 a[172:173], v51 offset:8192
    v_mfma_f32_16x16x32_bf16 v[232:235], a[136:139], a[12:15], v[232:235]
    ds_read_b64_tr_b16 a[174:175], v51 offset:12288
    s_mov_b32 s82, 196608
    s_add_u32 m0, s3, 32768
    v_mfma_f32_16x16x32_bf16 v[140:143], a[140:143], a[0:3], v[140:143]
    buffer_load_dwordx4 v19, s[48:51], s82 offen lds
    v_mfma_f32_16x16x32_bf16 v[172:175], a[140:143], a[4:7], v[172:175]
    ds_read_b64_tr_b16 a[176:177], v52 offset:8192
    v_mfma_f32_16x16x32_bf16 v[204:207], a[140:143], a[8:11], v[204:207]
    ds_read_b64_tr_b16 a[178:179], v52 offset:12288
    v_mfma_f32_16x16x32_bf16 v[236:239], a[140:143], a[12:15], v[236:239]
    v_mfma_f32_16x16x32_bf16 v[144:147], a[144:147], a[0:3], v[144:147]
    ds_read_b64_tr_b16 a[180:181], v53 offset:8192
    buffer_load_dwordx4 v20, s[48:51], s82 offen offset:1024 lds
    v_mfma_f32_16x16x32_bf16 v[176:179], a[144:147], a[4:7], v[176:179]
    ds_read_b64_tr_b16 a[182:183], v53 offset:12288
    v_mfma_f32_16x16x32_bf16 v[208:211], a[144:147], a[8:11], v[208:211]
    v_mfma_f32_16x16x32_bf16 v[240:243], a[144:147], a[12:15], v[240:243]
    ds_read_b64_tr_b16 a[184:185], v54 offset:8192
    v_mfma_f32_16x16x32_bf16 v[148:151], a[148:151], a[0:3], v[148:151]
    ds_read_b64_tr_b16 a[186:187], v54 offset:12288
    v_mfma_f32_16x16x32_bf16 v[180:183], a[148:151], a[4:7], v[180:183]
    s_mov_b32 s83, 655360
    s_add_u32 m0, s3, 40960
    v_mfma_f32_16x16x32_bf16 v[212:215], a[148:151], a[8:11], v[212:215]
    ds_read_b64_tr_b16 a[188:189], v55 offset:8192
    buffer_load_dwordx4 v19, s[48:51], s83 offen lds
    v_mfma_f32_16x16x32_bf16 v[244:247], a[148:151], a[12:15], v[244:247]
    ds_read_b64_tr_b16 a[190:191], v55 offset:12288
    v_mfma_f32_16x16x32_bf16 v[152:155], a[152:155], a[0:3], v[152:155]
    v_mfma_f32_16x16x32_bf16 v[184:187], a[152:155], a[4:7], v[184:187]
    v_mfma_f32_16x16x32_bf16 v[216:219], a[152:155], a[8:11], v[216:219]
    buffer_load_dwordx4 v20, s[48:51], s83 offen offset:1024 lds
    v_mfma_f32_16x16x32_bf16 v[248:251], a[152:155], a[12:15], v[248:251]
    v_mfma_f32_16x16x32_bf16 v[156:159], a[156:159], a[0:3], v[156:159]
    v_mfma_f32_16x16x32_bf16 v[188:191], a[156:159], a[4:7], v[188:191]
    v_mfma_f32_16x16x32_bf16 v[220:223], a[156:159], a[8:11], v[220:223]
    v_mfma_f32_16x16x32_bf16 v[252:255], a[156:159], a[12:15], v[252:255]
    s_waitcnt vmcnt(40) lgkmcnt(14)
    v_mfma_f32_16x16x32_bf16 v[128:131], a[160:163], a[16:19], v[128:131]
    s_waitcnt vmcnt(32)
    v_readfirstlane_b32 s86, v43
    s_bfe_u32 s86, s86, 0x80008
    s_cmp_eq_u32 s86, 16
    s_cbranch_scc0 L_spB
L_okB:
    buffer_load_dwordx4 a[0:3], v21, s[56:59], s68 offen sc1
    v_mfma_f32_16x16x32_bf16 v[160:163], a[160:163], a[20:23], v[160:163]
    ds_read_b64_tr_b16 a[128:129], v48 offset:16384
    v_mfma_f32_16x16x32_bf16 v[192:195], a[160:163], a[24:27], v[192:195]
    ds_read_b64_tr_b16 a[130:131], v48 offset:20480
    buffer_load_dwordx4 a[4:7], v22, s[56:59], s68 offen sc1
    v_mfma_f32_16x16x32_bf16 v[224:227], a[160:163], a[28:31], v[224:227]
    s_waitcnt lgkmcnt(14)
    v_mfma_f32_16x16x32_bf16 v[132:135], a[164:167], a[16:19], v[132:135]
    ds_read_b64_tr_b16 a[132:133], v49 offset:16384
    buffer_load_dwordx4 a[8:11], v23, s[56:59], s68 offen sc1
    v_mfma_f32_16x16x32_bf16 v[164:167], a[164:167], a[20:23], v[164:167]
    ds_read_b64_tr_b16 a[134:135], v49 offset:20480
    v_mfma_f32_16x16x32_bf16 v[196:199], a[164:167], a[24:27], v[196:199]
    buffer_load_dwordx4 a[12:15], v24, s[56:59], s68 offen sc1
    v_mfma_f32_16x16x32_bf16 v[228:231], a[164:167], a[28:31], v[228:231]
    ds_read_b64_tr_b16 a[136:137], v50 offset:16384
    s_waitcnt lgkmcnt(15)
    v_mfma_f32_16x16x32_bf16 v[136:139], a[168:171], a[16:19], v[136:139]
    ds_read_b64_tr_b16 a[138:139], v50 offset:20480
    s_add_u32 s68, s68, 16384
    v_mfma_f32_16x16x32_bf16 v[168:171], a[168:171], a[20:23], v[168:171]
    v_mfma_f32_16x16x32_bf16 v[200:203], a[168:171], a[24:27], v[200:203]
    ds_read_b64_tr_b16 a[140:141], v51 offset:16384
    v_mfma_f32_16x16x32_bf16 v[232:235], a[168:171], a[28:31], v[232:235]
    ds_read_b64_tr_b16 a[142:143], v51 offset:20480
    s_mov_b32 s82, 1114112
    s_add_u32 m0, s3, 49152
    s_waitcnt lgkmcnt(15)
    v_mfma_f32_16x16x32_bf16 v[140:143], a[172:175], a[16:19], v[140:143]
    buffer_load_dwordx4 v19, s[48:51], s82 offen lds
    v_mfma_f32_16x16x32_bf16 v[172:175], a[172:175], a[20:23], v[172:175]
    ds_read_b64_tr_b16 a[144:145], v52 offset:16384
    v_mfma_f32_16x16x32_bf16 v[204:207], a[172:175], a[24:27], v[204:207]
    ds_read_b64_tr_b16 a[146:147], v52 offset:20480
    v_mfma_f32_16x16x32_bf16 v[236:239], a[172:175], a[28:31], v[236:239]
    s_waitcnt lgkmcnt(15)
    v_mfma_f32_16x16x32_bf16 v[144:147], a[176:179], a[16:19], v[144:147]
    ds_read_b64_tr_b16 a[148:149], v53 offset:16384
    buffer_load_dwordx4 v20, s[48:51], s82 offen offset:1024 lds
    v_mfma_f32_16x16x32_bf16 v[176:179], a[176:179], a[20:23], v[176:179]
    ds_read_b64_tr_b16 a[150:151], v53 offset:20480
    v_mfma_f32_16x16x32_bf16 v[208:211], a[176:179], a[24:27], v[208:211]
    v_mfma_f32_16x16x32_bf16 v[240:243], a[176:179], a[28:31], v[240:243]
    ds_read_b64_tr_b16 a[152:153], v54 offset:16384
    s_waitcnt lgkmcnt(15)
    v_mfma_f32_16x16x32_bf16 v[148:151], a[180:183], a[16:19], v[148:151]
    ds_read_b64_tr_b16 a[154:155], v54 offset:20480
    v_mfma_f32_16x16x32_bf16 v[180:183], a[180:183], a[20:23], v[180:183]
    v_mfma_f32_16x16x32_bf16 v[212:215], a[180:183], a[24:27], v[212:215]
    ds_read_b64_tr_b16 a[156:157], v55 offset:16384
    v_mfma_f32_16x16x32_bf16 v[244:247], a[180:183], a[28:31], v[244:247]
    ds_read_b64_tr_b16 a[158:159], v55 offset:20480
    v_mfma_f32_16x16x32_bf16 v[152:155], a[184:187], a[16:19], v[152:155]
    v_mfma_f32_16x16x32_bf16 v[184:187], a[184:187], a[20:23], v[184:187]
    v_mfma_f32_16x16x32_bf16 v[216:219], a[184:187], a[24:27], v[216:219]
    v_mfma_f32_16x16x32_bf16 v[248:251], a[184:187], a[28:31], v[248:251]
    s_waitcnt lgkmcnt(15)
    v_mfma_f32_16x16x32_bf16 v[156:159], a[188:191], a[16:19], v[156:159]
    v_mfma_f32_16x16x32_bf16 v[188:191], a[188:191], a[20:23], v[188:191]
    v_mfma_f32_16x16x32_bf16 v[220:223], a[188:191], a[24:27], v[220:223]
    s_branch L_over9
L_stub9:
    s_branch L_stub11
L_over9:
    v_mfma_f32_16x16x32_bf16 v[252:255], a[188:191], a[28:31], v[252:255]
    s_waitcnt lgkmcnt(14)
    v_mfma_f32_16x16x32_bf16 v[128:131], a[128:131], a[32:35], v[128:131]
    buffer_load_dwordx4 a[16:19], v21, s[56:59], s68 offen sc1
    v_mfma_f32_16x16x32_bf16 v[160:163], a[128:131], a[36:39], v[160:163]
    ds_read_b64_tr_b16 a[160:161], v48 offset:24576
    v_mfma_f32_16x16x32_bf16 v[192:195], a[128:131], a[40:43], v[192:195]
    ds_read_b64_tr_b16 a[162:163], v48 offset:28672
    buffer_load_dwordx4 a[20:23], v22, s[56:59], s68 offen sc1
    v_mfma_f32_16x16x32_bf16 v[224:227], a[128:131], a[44:47], v[224:227]
    s_waitcnt lgkmcnt(14)
    v_mfma_f32_16x16x32_bf16 v[132:135], a[132:135], a[32:35], v[132:135]
    ds_read_b64_tr_b16 a[164:165], v49 offset:24576
    buffer_load_dwordx4 a[24:27], v23, s[56:59], s68 offen sc1
    v_mfma_f32_16x16x32_bf16 v[164:167], a[132:135], a[36:39], v[164:167]
    ds_read_b64_tr_b16 a[166:167], v49 offset:28672
    v_mfma_f32_16x16x32_bf16 v[196:199], a[132:135], a[40:43], v[196:199]
    buffer_load_dwordx4 a[28:31], v24, s[56:59], s68 offen sc1
    v_mfma_f32_16x16x32_bf16 v[228:231], a[132:135], a[44:47], v[228:231]
    ds_read_b64_tr_b16 a[168:169], v50 offset:24576
    s_waitcnt lgkmcnt(15)
    v_mfma_f32_16x16x32_bf16 v[136:139], a[136:139], a[32:35], v[136:139]
    ds_read_b64_tr_b16 a[170:171], v50 offset:28672
    s_add_u32 s68, s68, 16384
    v_mfma_f32_16x16x32_bf16 v[168:171], a[136:139], a[36:39], v[168:171]
    v_mfma_f32_16x16x32_bf16 v[200:203], a[136:139], a[40:43], v[200:203]
    ds_read_b64_tr_b16 a[172:173], v51 offset:24576
    v_mfma_f32_16x16x32_bf16 v[232:235], a[136:139], a[44:47], v[232:235]
    ds_read_b64_tr_b16 a[174:175], v51 offset:28672
    s_mov_b32 s83, 1572864
    s_add_u32 m0, s3, 57344
    s_waitcnt lgkmcnt(15)
    v_mfma_f32_16x16x32_bf16 v[140:143], a[140:143], a[32:35], v[140:143]
    buffer_load_dwordx4 v19, s[48:51], s83 offen lds
    v_mfma_f32_16x16x32_bf16 v[172:175], a[140:143], a[36:39], v[172:175]
    ds_read_b64_tr_b16 a[176:177], v52 offset:24576
    v_mfma_f32_16x16x32_bf16 v[204:207], a[140:143], a[40:43], v[204:207]
    ds_read_b64_tr_b16 a[178:179], v52 offset:28672
    v_mfma_f32_16x16x32_bf16 v[236:239], a[140:143], a[44:47], v[236:239]
    s_waitcnt lgkmcnt(15)
    v_mfma_f32_16x16x32_bf16 v[144:147], a[144:147], a[32:35], v[144:147]
    ds_read_b64_tr_b16 a[180:181], v53 offset:24576
    buffer_load_dwordx4 v20, s[48:51], s83 offen offset:1024 lds
    v_mfma_f32_16x16x32_bf16 v[176:179], a[144:147], a[36:39], v[176:179]
    ds_read_b64_tr_b16 a[182:183], v53 offset:28672
    v_mfma_f32_16x16x32_bf16 v[208:211], a[144:147], a[40:43], v[208:211]
    v_mfma_f32_16x16x32_bf16 v[240:243], a[144:147], a[44:47], v[240:243]
    ds_read_b64_tr_b16 a[184:185], v54 offset:24576
    s_waitcnt lgkmcnt(15)
    v_mfma_f32_16x16x32_bf16 v[148:151], a[148:151], a[32:35], v[148:151]
    ds_read_b64_tr_b16 a[186:187], v54 offset:28672
    v_mfma_f32_16x16x32_bf16 v[180:183], a[148:151], a[36:39], v[180:183]
    v_mfma_f32_16x16x32_bf16 v[212:215], a[148:151], a[40:43], v[212:215]
    ds_read_b64_tr_b16 a[188:189], v55 offset:24576
    v_mfma_f32_16x16x32_bf16 v[244:247], a[148:151], a[44:47], v[244:247]
    ds_read_b64_tr_b16 a[190:191], v55 offset:28672
    v_mfma_f32_16x16x32_bf16 v[152:155], a[152:155], a[32:35], v[152:155]
    v_mfma_f32_16x16x32_bf16 v[184:187], a[152:155], a[36:39], v[184:187]
    v_mfma_f32_16x16x32_bf16 v[216:219], a[152:155], a[40:43], v[216:219]
    v_mfma_f32_16x16x32_bf16 v[248:251], a[152:155], a[44:47], v[248:251]
    s_waitcnt lgkmcnt(15)
    v_mfma_f32_16x16x32_bf16 v[156:159], a[156:159], a[32:35], v[156:159]
    buffer_load_dword v43, off, s[56:59], s92 sc1
    v_mfma_f32_16x16x32_bf16 v[188:191], a[156:159], a[36:39], v[188:191]
    v_mfma_f32_16x16x32_bf16 v[220:223], a[156:159], a[40:43], v[220:223]
    v_mfma_f32_16x16x32_bf16 v[252:255], a[156:159], a[44:47], v[252:255]
    s_waitcnt vmcnt(44) lgkmcnt(14)
    v_mfma_f32_16x16x32_bf16 v[128:131], a[160:163], a[48:51], v[128:131]
    buffer_load_dwordx4 a[32:35], v21, s[56:59], s68 offen sc1
    s_waitcnt vmcnt(44)
    v_mfma_f32_16x16x32_bf16 v[160:163], a[160:163], a[52:55], v[160:163]
    ds_read_b64_tr_b16 a[128:129], v48 offset:32768
    s_waitcnt vmcnt(43)
    v_mfma_f32_16x16x32_bf16 v[192:195], a[160:163], a[56:59], v[192:195]
    ds_read_b64_tr_b16 a[130:131], v48 offset:36864
    buffer_load_dwordx4 a[36:39], v22, s[56:59], s68 offen sc1
    s_waitcnt vmcnt(43)
    v_mfma_f32_16x16x32_bf16 v[224:227], a[160:163], a[60:63], v[224:227]
    s_waitcnt lgkmcnt(14)
    v_mfma_f32_16x16x32_bf16 v[132:135], a[164:167], a[48:51], v[132:135]
    ds_read_b64_tr_b16 a[132:133], v49 offset:32768
    buffer_load_dwordx4 a[40:43], v23, s[56:59], s68 offen sc1
    v_mfma_f32_16x16x32_bf16 v[164:167], a[164:167], a[52:55], v[164:167]
    ds_read_b64_tr_b16 a[134:135], v49 offset:36864
    v_mfma_f32_16x16x32_bf16 v[196:199], a[164:167], a[56:59], v[196:199]
    buffer_load_dwordx4 a[44:47], v24, s[56:59], s68 offen sc1
    v_mfma_f32_16x16x32_bf16 v[228:231], a[164:167], a[60:63], v[228:231]
    ds_read_b64_tr_b16 a[136:137], v50 offset:32768
    s_waitcnt lgkmcnt(15)
    v_mfma_f32_16x16x32_bf16 v[136:139], a[168:171], a[48:51], v[136:139]
    ds_read_b64_tr_b16 a[138:139], v50 offset:36864
    s_add_u32 s68, s68, 16384
    v_mfma_f32_16x16x32_bf16 v[168:171], a[168:171], a[52:55], v[168:171]
    v_mfma_f32_16x16x32_bf16 v[200:203], a[168:171], a[56:59], v[200:203]
    ds_read_b64_tr_b16 a[140:141], v51 offset:32768
    v_mfma_f32_16x16x32_bf16 v[232:235], a[168:171], a[60:63], v[232:235]
    ds_read_b64_tr_b16 a[142:143], v51 offset:36864
    s_mov_b32 s82, 0
    s_add_u32 m0, s3, 65536
    s_waitcnt lgkmcnt(15)
    v_mfma_f32_16x16x32_bf16 v[140:143], a[172:175], a[48:51], v[140:143]
    buffer_load_dwordx4 v17, s[52:55], s82 offen lds
    v_mfma_f32_16x16x32_bf16 v[172:175], a[172:175], a[52:55], v[172:175]
    ds_read_b64_tr_b16 a[144:145], v52 offset:32768
    v_mfma_f32_16x16x32_bf16 v[204:207], a[172:175], a[56:59], v[204:207]
    ds_read_b64_tr_b16 a[146:147], v52 offset:36864
    v_mfma_f32_16x16x32_bf16 v[236:239], a[172:175], a[60:63], v[236:239]
    s_waitcnt lgkmcnt(15)
    v_mfma_f32_16x16x32_bf16 v[144:147], a[176:179], a[48:51], v[144:147]
    ds_read_b64_tr_b16 a[148:149], v53 offset:32768
    buffer_load_dwordx4 v18, s[52:55], s82 offen offset:1024 lds
    v_mfma_f32_16x16x32_bf16 v[176:179], a[176:179], a[52:55], v[176:179]
    ds_read_b64_tr_b16 a[150:151], v53 offset:36864
    v_mfma_f32_16x16x32_bf16 v[208:211], a[176:179], a[56:59], v[208:211]
    v_mfma_f32_16x16x32_bf16 v[240:243], a[176:179], a[60:63], v[240:243]
    ds_read_b64_tr_b16 a[152:153], v54 offset:32768
    s_waitcnt lgkmcnt(15)
    v_mfma_f32_16x16x32_bf16 v[148:151], a[180:183], a[48:51], v[148:151]
    ds_read_b64_tr_b16 a[154:155], v54 offset:36864
    v_mfma_f32_16x16x32_bf16 v[180:183], a[180:183], a[52:55], v[180:183]
    v_mfma_f32_16x16x32_bf16 v[212:215], a[180:183], a[56:59], v[212:215]
    ds_read_b64_tr_b16 a[156:157], v55 offset:32768
    v_mfma_f32_16x16x32_bf16 v[244:247], a[180:183], a[60:63], v[244:247]
    ds_read_b64_tr_b16 a[158:159], v55 offset:36864
    v_mfma_f32_16x16x32_bf16 v[152:155], a[184:187], a[48:51], v[152:155]
    v_mfma_f32_16x16x32_bf16 v[184:187], a[184:187], a[52:55], v[184:187]
    v_mfma_f32_16x16x32_bf16 v[216:219], a[184:187], a[56:59], v[216:219]
    v_mfma_f32_16x16x32_bf16 v[248:251], a[184:187], a[60:63], v[248:251]
    s_waitcnt lgkmcnt(15)
    v_mfma_f32_16x16x32_bf16 v[156:159], a[188:191], a[48:51], v[156:159]
    v_mfma_f32_16x16x32_bf16 v[188:191], a[188:191], a[52:55], v[188:191]
    v_mfma_f32_16x16x32_bf16 v[220:223], a[188:191], a[56:59], v[220:223]
    v_mfma_f32_16x16x32_bf16 v[252:255], a[188:191], a[60:63], v[252:255]
    s_waitcnt lgkmcnt(0)
    s_barrier
    s_waitcnt vmcnt(44)
    v_mfma_f32_16x16x32_bf16 v[128:131], a[128:131], a[64:67], v[128:131]
    buffer_load_dwordx4 a[48:51], v21, s[56:59], s68 offen sc1
    s_waitcnt vmcnt(44)
    v_mfma_f32_16x16x32_bf16 v[160:163], a[128:131], a[68:71], v[160:163]
    ds_read_b64_tr_b16 a[160:161], v48 offset:40960
    s_waitcnt vmcnt(43)
    v_mfma_f32_16x16x32_bf16 v[192:195], a[128:131], a[72:75], v[192:195]
    ds_read_b64_tr_b16 a[162:163], v48 offset:45056
    buffer_load_dwordx4 a[52:55], v22, s[56:59], s68 offen sc1
    s_waitcnt vmcnt(43)
    v_mfma_f32_16x16x32_bf16 v[224:227], a[128:131], a[76:79], v[224:227]
    v_mfma_f32_16x16x32_bf16 v[132:135], a[132:135], a[64:67], v[132:135]
    ds_read_b64_tr_b16 a[164:165], v49 offset:40960
    buffer_load_dwordx4 a[56:59], v23, s[56:59], s68 offen sc1
    v_mfma_f32_16x16x32_bf16 v[164:167], a[132:135], a[68:71], v[164:167]
    ds_read_b64_tr_b16 a[166:167], v49 offset:45056
    v_mfma_f32_16x16x32_bf16 v[196:199], a[132:135], a[72:75], v[196:199]
    buffer_load_dwordx4 a[60:63], v24, s[56:59], s68 offen sc1
    v_mfma_f32_16x16x32_bf16 v[228:231], a[132:135], a[76:79], v[228:231]
    ds_read_b64_tr_b16 a[168:169], v50 offset:40960
    v_mfma_f32_16x16x32_bf16 v[136:139], a[136:139], a[64:67], v[136:139]
    ds_read_b64_tr_b16 a[170:171], v50 offset:45056
    s_add_u32 s68, s68, 16384
    v_mfma_f32_16x16x32_bf16 v[168:171], a[136:139], a[68:71], v[168:171]
    v_mfma_f32_16x16x32_bf16 v[200:203], a[136:139], a[72:75], v[200:203]
    ds_read_b64_tr_b16 a[172:173], v51 offset:40960
    v_cndmask_b32 v72, v64, v68, s[4:5]
    v_mfma_f32_16x16x32_bf16 v[232:235], a[136:139], a[76:79], v[232:235]
    ds_read_b64_tr_b16 a[174:175], v51 offset:45056
    s_mov_b32 s83, 65536
    s_add_u32 m0, s3, 73728
    v_cndmask_b32 v73, v65, v69, s[4:5]
    v_mfma_f32_16x16x32_bf16 v[140:143], a[140:143], a[64:67], v[140:143]
    buffer_load_dwordx4 v17, s[52:55], s83 offen lds
    v_cndmask_b32 v74, v66, v70, s[4:5]
    v_mfma_f32_16x16x32_bf16 v[172:175], a[140:143], a[68:71], v[172:175]
    ds_read_b64_tr_b16 a[176:177], v52 offset:40960
    v_cndmask_b32 v75, v67, v71, s[4:5]
    v_mfma_f32_16x16x32_bf16 v[204:207], a[140:143], a[72:75], v[204:207]
    ds_read_b64_tr_b16 a[178:179], v52 offset:45056
    v_cndmask_b32 v64, v68, v64, s[4:5]
    v_mfma_f32_16x16x32_bf16 v[236:239], a[140:143], a[76:79], v[236:239]
    v_cndmask_b32 v65, v69, v65, s[4:5]
    v_mfma_f32_16x16x32_bf16 v[144:147], a[144:147], a[64:67], v[144:147]
    ds_read_b64_tr_b16 a[180:181], v53 offset:40960
    buffer_load_dwordx4 v18, s[52:55], s83 offen offset:1024 lds
    v_cndmask_b32 v66, v70, v66, s[4:5]
    v_mfma_f32_16x16x32_bf16 v[176:179], a[144:147], a[68:71], v[176:179]
    ds_read_b64_tr_b16 a[182:183], v53 offset:45056
    v_cndmask_b32 v67, v71, v67, s[4:5]
    v_mfma_f32_16x16x32_bf16 v[208:211], a[144:147], a[72:75], v[208:211]
    v_mov_b32_dpp v76, v72 row_ror:8 row_mask:0xf bank_mask:0xf
    v_mfma_f32_16x16x32_bf16 v[240:243], a[144:147], a[76:79], v[240:243]
    ds_read_b64_tr_b16 a[184:185], v54 offset:40960
    v_mov_b32_dpp v77, v73 row_ror:8 row_mask:0xf bank_mask:0xf
    v_mfma_f32_16x16x32_bf16 v[148:151], a[148:151], a[64:67], v[148:151]
    ds_read_b64_tr_b16 a[186:187], v54 offset:45056
    v_mov_b32_dpp v78, v74 row_ror:8 row_mask:0xf bank_mask:0xf
    v_mfma_f32_16x16x32_bf16 v[180:183], a[148:151], a[68:71], v[180:183]
    s_mov_b32 s82, 131072
    s_add_u32 m0, s3, 81920
    v_mov_b32_dpp v79, v75 row_ror:8 row_mask:0xf bank_mask:0xf
    v_mfma_f32_16x16x32_bf16 v[212:215], a[148:151], a[72:75], v[212:215]
    ds_read_b64_tr_b16 a[188:189], v55 offset:40960
    buffer_load_dwordx4 v17, s[52:55], s82 offen lds
    v_permlane16_swap_b32 v64, v66
    v_mfma_f32_16x16x32_bf16 v[244:247], a[148:151], a[76:79], v[244:247]
    ds_read_b64_tr_b16 a[190:191], v55 offset:45056
    v_permlane16_swap_b32 v65, v67
    v_mfma_f32_16x16x32_bf16 v[152:155], a[152:155], a[64:67], v[152:155]
    v_permlane16_swap_b32 v76, v78
    v_mfma_f32_16x16x32_bf16 v[184:187], a[152:155], a[68:71], v[184:187]
    v_permlane16_swap_b32 v77, v79
    v_mfma_f32_16x16x32_bf16 v[216:219], a[152:155], a[72:75], v[216:219]
    buffer_load_dwordx4 v18, s[52:55], s82 offen offset:1024 lds
    v_mfma_f32_16x16x32_bf16 v[248:251], a[152:155], a[76:79], v[248:251]
    v_mfma_f32_16x16x32_bf16 v[156:159], a[156:159], a[64:67], v[156:159]
    v_mfma_f32_16x16x32_bf16 v[188:191], a[156:159], a[68:71], v[188:191]
    v_mfma_f32_16x16x32_bf16 v[220:223], a[156:159], a[72:75], v[220:223]
    v_mfma_f32_16x16x32_bf16 v[252:255], a[156:159], a[76:79], v[252:255]
    s_waitcnt vmcnt(46) lgkmcnt(14)
    v_mfma_f32_16x16x32_bf16 v[128:131], a[160:163], a[80:83], v[128:131]
    buffer_load_dwordx4 a[64:67], v21, s[56:59], s68 offen sc1
    s_waitcnt vmcnt(46)
    v_mfma_f32_16x16x32_bf16 v[160:163], a[160:163], a[84:87], v[160:163]
    ds_read_b64_tr_b16 a[128:129], v48 offset:49152
    s_waitcnt vmcnt(45)
    v_mfma_f32_16x16x32_bf16 v[192:195], a[160:163], a[88:91], v[192:195]
    ds_read_b64_tr_b16 a[130:131], v48 offset:53248
    buffer_load_dwordx4 a[68:71], v22, s[56:59], s68 offen sc1
    s_waitcnt vmcnt(45)
    v_mfma_f32_16x16x32_bf16 v[224:227], a[160:163], a[92:95], v[224:227]
    s_waitcnt lgkmcnt(14)
    v_mfma_f32_16x16x32_bf16 v[132:135], a[164:167], a[80:83], v[132:135]
    ds_read_b64_tr_b16 a[132:133], v49 offset:49152
    buffer_load_dwordx4 a[72:75], v23, s[56:59], s68 offen sc1
    v_mfma_f32_16x16x32_bf16 v[164:167], a[164:167], a[84:87], v[164:167]
    ds_read_b64_tr_b16 a[134:135], v49 offset:53248
    v_mfma_f32_16x16x32_bf16 v[196:199], a[164:167], a[88:91], v[196:199]
    buffer_load_dwordx4 a[76:79], v24, s[56:59], s68 offen sc1
    v_mfma_f32_16x16x32_bf16 v[228:231], a[164:167], a[92:95], v[228:231]
    ds_read_b64_tr_b16 a[136:137], v50 offset:49152
    s_waitcnt lgkmcnt(15)
    v_mfma_f32_16x16x32_bf16 v[136:139], a[168:171], a[80:83], v[136:139]
    ds_read_b64_tr_b16 a[138:139], v50 offset:53248
    s_add_u32 s68, s68, 16384
    v_mfma_f32_16x16x32_bf16 v[168:171], a[168:171], a[84:87], v[168:171]
    v_mfma_f32_16x16x32_bf16 v[200:203], a[168:171], a[88:91], v[200:203]
    ds_read_b64_tr_b16 a[140:141], v51 offset:49152
    v_and_b32 v71, 0xffff0000, v67
    v_mfma_f32_16x16x32_bf16 v[232:235], a[168:171], a[92:95], v[232:235]
    ds_read_b64_tr_b16 a[142:143], v51 offset:53248
    s_mov_b32 s83, 196608
    s_add_u32 m0, s3, 90112
    v_lshlrev_b32 v70, 16, v67
    s_waitcnt lgkmcnt(15)
    v_mfma_f32_16x16x32_bf16 v[140:143], a[172:175], a[80:83], v[140:143]
    buffer_load_dwordx4 v17, s[52:55], s83 offen lds
    v_and_b32 v69, 0xffff0000, v66
    v_mfma_f32_16x16x32_bf16 v[172:175], a[172:175], a[84:87], v[172:175]
    ds_read_b64_tr_b16 a[144:145], v52 offset:49152
    v_lshlrev_b32 v68, 16, v66
    v_mfma_f32_16x16x32_bf16 v[204:207], a[172:175], a[88:91], v[204:207]
    ds_read_b64_tr_b16 a[146:147], v52 offset:53248
    v_and_b32 v67, 0xffff0000, v65
    v_mfma_f32_16x16x32_bf16 v[236:239], a[172:175], a[92:95], v[236:239]
    v_lshlrev_b32 v66, 16, v65
    s_waitcnt lgkmcnt(15)
    v_mfma_f32_16x16x32_bf16 v[144:147], a[176:179], a[80:83], v[144:147]
    ds_read_b64_tr_b16 a[148:149], v53 offset:49152
    buffer_load_dwordx4 v18, s[52:55], s83 offen offset:1024 lds
    v_and_b32 v65, 0xffff0000, v64
    v_mfma_f32_16x16x32_bf16 v[176:179], a[176:179], a[84:87], v[176:179]
    ds_read_b64_tr_b16 a[150:151], v53 offset:53248
    v_lshlrev_b32 v64, 16, v64
    v_mfma_f32_16x16x32_bf16 v[208:211], a[176:179], a[88:91], v[208:211]
    v_lshlrev_b32 v72, 16, v76
    v_mfma_f32_16x16x32_bf16 v[240:243], a[176:179], a[92:95], v[240:243]
    ds_read_b64_tr_b16 a[152:153], v54 offset:49152
    v_and_b32 v73, 0xffff0000, v76
    s_waitcnt lgkmcnt(15)
    v_mfma_f32_16x16x32_bf16 v[148:151], a[180:183], a[80:83], v[148:151]
    ds_read_b64_tr_b16 a[154:155], v54 offset:53248
    v_lshlrev_b32 v74, 16, v77
    v_mfma_f32_16x16x32_bf16 v[180:183], a[180:183], a[84:87], v[180:183]
    v_and_b32 v75, 0xffff0000, v77
    v_mfma_f32_16x16x32_bf16 v[212:215], a[180:183], a[88:91], v[212:215]
    ds_read_b64_tr_b16 a[156:157], v55 offset:49152
    v_lshlrev_b32 v76, 16, v78
    v_mfma_f32_16x16x32_bf16 v[244:247], a[180:183], a[92:95], v[244:247]
    ds_read_b64_tr_b16 a[158:159], v55 offset:53248
    v_and_b32 v77, 0xffff0000, v78
    v_mfma_f32_16x16x32_bf16 v[152:155], a[184:187], a[80:83], v[152:155]
    v_lshlrev_b32 v78, 16, v79
    v_mfma_f32_16x16x32_bf16 v[184:187], a[184:187], a[84:87], v[184:187]
    v_and_b32 v79, 0xffff0000, v79
    v_mfma_f32_16x16x32_bf16 v[216:219], a[184:187], a[88:91], v[216:219]
    v_mfma_f32_16x16x32_bf16 v[248:251], a[184:187], a[92:95], v[248:251]
    s_waitcnt lgkmcnt(15)
    v_mfma_f32_16x16x32_bf16 v[156:159], a[188:191], a[80:83], v[156:159]
    buffer_load_dword v44, off, s[56:59], s76 sc1
    v_mfma_f32_16x16x32_bf16 v[188:191], a[188:191], a[84:87], v[188:191]
    v_mfma_f32_16x16x32_bf16 v[220:223], a[188:191], a[88:91], v[220:223]
    v_mfma_f32_16x16x32_bf16 v[252:255], a[188:191], a[92:95], v[252:255]
    s_waitcnt lgkmcnt(0)
    s_barrier
    s_waitcnt vmcnt(47)
    v_mfma_f32_16x16x32_bf16 v[128:131], a[128:131], a[96:99], v[128:131]
    buffer_load_dwordx4 a[80:83], v21, s[56:59], s68 offen sc1
    s_waitcnt vmcnt(47)
    v_mfma_f32_16x16x32_bf16 v[160:163], a[128:131], a[100:103], v[160:163]
    ds_read_b64_tr_b16 a[160:161], v48 offset:57344
    s_waitcnt vmcnt(46)
    v_mfma_f32_16x16x32_bf16 v[192:195], a[128:131], a[104:107], v[192:195]
    ds_read_b64_tr_b16 a[162:163], v48 offset:61440
    buffer_load_dwordx4 a[84:87], v22, s[56:59], s68 offen sc1
    s_waitcnt vmcnt(46)
    v_mfma_f32_16x16x32_bf16 v[224:227], a[128:131], a[108:111], v[224:227]
    v_mfma_f32_16x16x32_bf16 v[132:135], a[132:135], a[96:99], v[132:135]
    ds_read_b64_tr_b16 a[164:165], v49 offset:57344
    buffer_load_dwordx4 a[88:91], v23, s[56:59], s68 offen sc1
    v_mfma_f32_16x16x32_bf16 v[164:167], a[132:135], a[100:103], v[164:167]
    ds_read_b64_tr_b16 a[166:167], v49 offset:61440
    v_mfma_f32_16x16x32_bf16 v[196:199], a[132:135], a[104:107], v[196:199]
    buffer_load_dwordx4 a[92:95], v24, s[56:59], s68 offen sc1
    v_mfma_f32_16x16x32_bf16 v[228:231], a[132:135], a[108:111], v[228:231]
    ds_read_b64_tr_b16 a[168:169], v50 offset:57344
    v_mfma_f32_16x16x32_bf16 v[136:139], a[136:139], a[96:99], v[136:139]
    ds_read_b64_tr_b16 a[170:171], v50 offset:61440
    s_add_u32 s68, s68, 16384
    v_mfma_f32_16x16x32_bf16 v[168:171], a[136:139], a[100:103], v[168:171]
    v_mfma_f32_16x16x32_bf16 v[200:203], a[136:139], a[104:107], v[200:203]
    ds_read_b64_tr_b16 a[172:173], v51 offset:57344
    v_cndmask_b32 v88, v80, v84, s[4:5]
    v_mfma_f32_16x16x32_bf16 v[232:235], a[136:139], a[108:111], v[232:235]
    ds_read_b64_tr_b16 a[174:175], v51 offset:61440
    s_mov_b32 s82, 262144
    s_add_u32 m0, s3, 98304
    v_cndmask_b32 v89, v81, v85, s[4:5]
    v_mfma_f32_16x16x32_bf16 v[140:143], a[140:143], a[96:99], v[140:143]
    buffer_load_dwordx4 v17, s[52:55], s82 offen lds
    v_cndmask_b32 v90, v82, v86, s[4:5]
    v_mfma_f32_16x16x32_bf16 v[172:175], a[140:143], a[100:103], v[172:175]
    ds_read_b64_tr_b16 a[176:177], v52 offset:57344
    v_cndmask_b32 v91, v83, v87, s[4:5]
    v_mfma_f32_16x16x32_bf16 v[204:207], a[140:143], a[104:107], v[204:207]
    ds_read_b64_tr_b16 a[178:179], v52 offset:61440
    v_cndmask_b32 v80, v84, v80, s[4:5]
    v_mfma_f32_16x16x32_bf16 v[236:239], a[140:143], a[108:111], v[236:239]
    v_cndmask_b32 v81, v85, v81, s[4:5]
    v_mfma_f32_16x16x32_bf16 v[144:147], a[144:147], a[96:99], v[144:147]
    ds_read_b64_tr_b16 a[180:181], v53 offset:57344
    buffer_load_dwordx4 v18, s[52:55], s82 offen offset:1024 lds
    v_cndmask_b32 v82, v86, v82, s[4:5]
    v_mfma_f32_16x16x32_bf16 v[176:179], a[144:147], a[100:103], v[176:179]
    ds_read_b64_tr_b16 a[182:183], v53 offset:61440
    v_cndmask_b32 v83, v87, v83, s[4:5]
    v_mfma_f32_16x16x32_bf16 v[208:211], a[144:147], a[104:107], v[208:211]
    v_mov_b32_dpp v92, v88 row_ror:8 row_mask:0xf bank_mask:0xf
    v_mfma_f32_16x16x32_bf16 v[240:243], a[144:147], a[108:111], v[240:243]
    ds_read_b64_tr_b16 a[184:185], v54 offset:57344
    v_mov_b32_dpp v93, v89 row_ror:8 row_mask:0xf bank_mask:0xf
    v_mfma_f32_16x16x32_bf16 v[148:151], a[148:151], a[96:99], v[148:151]
    ds_read_b64_tr_b16 a[186:187], v54 offset:61440
    v_mov_b32_dpp v94, v90 row_ror:8 row_mask:0xf bank_mask:0xf
    v_mfma_f32_16x16x32_bf16 v[180:183], a[148:151], a[100:103], v[180:183]
    s_mov_b32 s83, 327680
    s_add_u32 m0, s3, 106496
    v_mov_b32_dpp v95, v91 row_ror:8 row_mask:0xf bank_mask:0xf
    v_mfma_f32_16x16x32_bf16 v[212:215], a[148:151], a[104:107], v[212:215]
    ds_read_b64_tr_b16 a[188:189], v55 offset:57344
    buffer_load_dwordx4 v17, s[52:55], s83 offen lds
    v_permlane16_swap_b32 v80, v82
    v_mfma_f32_16x16x32_bf16 v[244:247], a[148:151], a[108:111], v[244:247]
    ds_read_b64_tr_b16 a[190:191], v55 offset:61440
    v_permlane16_swap_b32 v81, v83
    v_mfma_f32_16x16x32_bf16 v[152:155], a[152:155], a[96:99], v[152:155]
    v_permlane16_swap_b32 v92, v94
    v_mfma_f32_16x16x32_bf16 v[184:187], a[152:155], a[100:103], v[184:187]
    v_permlane16_swap_b32 v93, v95
    v_mfma_f32_16x16x32_bf16 v[216:219], a[152:155], a[104:107], v[216:219]
    buffer_load_dwordx4 v18, s[52:55], s83 offen offset:1024 lds
    v_mfma_f32_16x16x32_bf16 v[248:251], a[152:155], a[108:111], v[248:251]
    v_mfma_f32_16x16x32_bf16 v[156:159], a[156:159], a[96:99], v[156:159]
    v_mfma_f32_16x16x32_bf16 v[188:191], a[156:159], a[100:103], v[188:191]
    v_mfma_f32_16x16x32_bf16 v[220:223], a[156:159], a[104:107], v[220:223]
    v_mfma_f32_16x16x32_bf16 v[252:255], a[156:159], a[108:111], v[252:255]
    s_waitcnt vmcnt(49) lgkmcnt(14)
    v_mfma_f32_16x16x32_bf16 v[128:131], a[160:163], a[112:115], v[128:131]
    buffer_load_dwordx4 a[96:99], v21, s[56:59], s68 offen sc1
    s_waitcnt vmcnt(49)
    v_mfma_f32_16x16x32_bf16 v[160:163], a[160:163], a[116:119], v[160:163]
    ds_read_b64_tr_b16 a[128:129], v56 offset:0
    s_waitcnt vmcnt(48)
    v_mfma_f32_16x16x32_bf16 v[192:195], a[160:163], a[120:123], v[192:195]
    ds_read_b64_tr_b16 a[130:131], v56 offset:4096
    buffer_load_dwordx4 a[100:103], v22, s[56:59], s68 offen sc1
    s_waitcnt vmcnt(48)
    v_mfma_f32_16x16x32_bf16 v[224:227], a[160:163], a[124:127], v[224:227]
    s_waitcnt lgkmcnt(14)
    v_mfma_f32_16x16x32_bf16 v[132:135], a[164:167], a[112:115], v[132:135]
    ds_read_b64_tr_b16 a[132:133], v57 offset:0
    buffer_load_dwordx4 a[104:107], v23, s[56:59], s68 offen sc1
    v_mfma_f32_16x16x32_bf16 v[164:167], a[164:167], a[116:119], v[164:167]
    ds_read_b64_tr_b16 a[134:135], v57 offset:4096
    v_mfma_f32_16x16x32_bf16 v[196:199], a[164:167], a[120:123], v[196:199]
    buffer_load_dwordx4 a[108:111], v24, s[56:59], s68 offen sc1
    v_mfma_f32_16x16x32_bf16 v[228:231], a[164:167], a[124:127], v[228:231]
    ds_read_b64_tr_b16 a[136:137], v58 offset:0
    s_waitcnt lgkmcnt(15)
    v_mfma_f32_16x16x32_bf16 v[136:139], a[168:171], a[112:115], v[136:139]
    ds_read_b64_tr_b16 a[138:139], v58 offset:4096
    s_add_u32 s68, s68, 16384
    v_mfma_f32_16x16x32_bf16 v[168:171], a[168:171], a[116:119], v[168:171]
    v_mfma_f32_16x16x32_bf16 v[200:203], a[168:171], a[120:123], v[200:203]
    ds_read_b64_tr_b16 a[140:141], v59 offset:0
    v_and_b32 v87, 0xffff0000, v83
    v_mfma_f32_16x16x32_bf16 v[232:235], a[168:171], a[124:127], v[232:235]
    ds_read_b64_tr_b16 a[142:143], v59 offset:4096
    s_mov_b32 s82, 393216
    s_add_u32 m0, s3, 114688
    v_lshlrev_b32 v86, 16, v83
    s_waitcnt lgkmcnt(15)
    v_mfma_f32_16x16x32_bf16 v[140:143], a[172:175], a[112:115], v[140:143]
    buffer_load_dwordx4 v17, s[52:55], s82 offen lds
    v_and_b32 v85, 0xffff0000, v82
    v_mfma_f32_16x16x32_bf16 v[172:175], a[172:175], a[116:119], v[172:175]
    ds_read_b64_tr_b16 a[144:145], v60 offset:0
    v_lshlrev_b32 v84, 16, v82
    v_mfma_f32_16x16x32_bf16 v[204:207], a[172:175], a[120:123], v[204:207]
    ds_read_b64_tr_b16 a[146:147], v60 offset:4096
    v_and_b32 v83, 0xffff0000, v81
    v_mfma_f32_16x16x32_bf16 v[236:239], a[172:175], a[124:127], v[236:239]
    v_lshlrev_b32 v82, 16, v81
    s_waitcnt lgkmcnt(15)
    v_mfma_f32_16x16x32_bf16 v[144:147], a[176:179], a[112:115], v[144:147]
    ds_read_b64_tr_b16 a[148:149], v61 offset:0
    buffer_load_dwordx4 v18, s[52:55], s82 offen offset:1024 lds
    v_and_b32 v81, 0xffff0000, v80
    v_mfma_f32_16x16x32_bf16 v[176:179], a[176:179], a[116:119], v[176:179]
    ds_read_b64_tr_b16 a[150:151], v61 offset:4096
    v_lshlrev_b32 v80, 16, v80
    v_mfma_f32_16x16x32_bf16 v[208:211], a[176:179], a[120:123], v[208:211]
    v_lshlrev_b32 v88, 16, v92
    v_mfma_f32_16x16x32_bf16 v[240:243], a[176:179], a[124:127], v[240:243]
    ds_read_b64_tr_b16 a[152:153], v62 offset:0
    v_and_b32 v89, 0xffff0000, v92
    s_waitcnt lgkmcnt(15)
    v_mfma_f32_16x16x32_bf16 v[148:151], a[180:183], a[112:115], v[148:151]
    ds_read_b64_tr_b16 a[154:155], v62 offset:4096
    v_lshlrev_b32 v90, 16, v93
    v_mfma_f32_16x16x32_bf16 v[180:183], a[180:183], a[116:119], v[180:183]
    v_and_b32 v91, 0xffff0000, v93
    v_mfma_f32_16x16x32_bf16 v[212:215], a[180:183], a[120:123], v[212:215]
    ds_read_b64_tr_b16 a[156:157], v63 offset:0
    v_lshlrev_b32 v92, 16, v94
    v_mfma_f32_16x16x32_bf16 v[244:247], a[180:183], a[124:127], v[244:247]
    ds_read_b64_tr_b16 a[158:159], v63 offset:4096
    v_and_b32 v93, 0xffff0000, v94
    v_mfma_f32_16x16x32_bf16 v[152:155], a[184:187], a[112:115], v[152:155]
    v_lshlrev_b32 v94, 16, v95
    v_mfma_f32_16x16x32_bf16 v[184:187], a[184:187], a[116:119], v[184:187]
    v_and_b32 v95, 0xffff0000, v95
    v_mfma_f32_16x16x32_bf16 v[216:219], a[184:187], a[120:123], v[216:219]
    v_mfma_f32_16x16x32_bf16 v[248:251], a[184:187], a[124:127], v[248:251]
    s_waitcnt lgkmcnt(15)
    v_mfma_f32_16x16x32_bf16 v[156:159], a[188:191], a[112:115], v[156:159]
    v_mfma_f32_16x16x32_bf16 v[188:191], a[188:191], a[116:119], v[188:191]
    v_mfma_f32_16x16x32_bf16 v[220:223], a[188:191], a[120:123], v[220:223]
    v_mfma_f32_16x16x32_bf16 v[252:255], a[188:191], a[124:127], v[252:255]
    s_waitcnt lgkmcnt(0)
    s_barrier
    s_waitcnt vmcnt(47)
    v_mfma_f32_16x16x32_bf16 v[128:131], a[128:131], a[0:3], v[128:131]
    buffer_load_dwordx4 a[112:115], v21, s[56:59], s68 offen sc1
    s_waitcnt vmcnt(47)
    v_mfma_f32_16x16x32_bf16 v[160:163], a[128:131], a[4:7], v[160:163]
    ds_read_b64_tr_b16 a[160:161], v56 offset:8192
    s_waitcnt vmcnt(46)
    v_mfma_f32_16x16x32_bf16 v[192:195], a[128:131], a[8:11], v[192:195]
    ds_read_b64_tr_b16 a[162:163], v56 offset:12288
    buffer_load_dwordx4 a[116:119], v22, s[56:59], s68 offen sc1
    s_waitcnt vmcnt(46)
    v_mfma_f32_16x16x32_bf16 v[224:227], a[128:131], a[12:15], v[224:227]
    v_mfma_f32_16x16x32_bf16 v[132:135], a[132:135], a[0:3], v[132:135]
    ds_read_b64_tr_b16 a[164:165], v57 offset:8192
    buffer_load_dwordx4 a[120:123], v23, s[56:59], s68 offen sc1
    v_mfma_f32_16x16x32_bf16 v[164:167], a[132:135], a[4:7], v[164:167]
    ds_read_b64_tr_b16 a[166:167], v57 offset:12288
    v_mfma_f32_16x16x32_bf16 v[196:199], a[132:135], a[8:11], v[196:199]
    buffer_load_dwordx4 a[124:127], v24, s[56:59], s68 offen sc1
    v_mfma_f32_16x16x32_bf16 v[228:231], a[132:135], a[12:15], v[228:231]
    ds_read_b64_tr_b16 a[168:169], v58 offset:8192
    v_mfma_f32_16x16x32_bf16 v[136:139], a[136:139], a[0:3], v[136:139]
    ds_read_b64_tr_b16 a[170:171], v58 offset:12288
    s_add_u32 s68, s68, 16384
    v_mfma_f32_16x16x32_bf16 v[168:171], a[136:139], a[4:7], v[168:171]
    v_mfma_f32_16x16x32_bf16 v[200:203], a[136:139], a[8:11], v[200:203]
    ds_read_b64_tr_b16 a[172:173], v59 offset:8192
    v_mfma_f32_16x16x32_bf16 v[232:235], a[136:139], a[12:15], v[232:235]
    ds_read_b64_tr_b16 a[174:175], v59 offset:12288
    s_mov_b32 s83, 458752
    s_add_u32 m0, s3, 122880
    v_mfma_f32_16x16x32_bf16 v[140:143], a[140:143], a[0:3], v[140:143]
    buffer_load_dwordx4 v17, s[52:55], s83 offen lds
    v_mfma_f32_16x16x32_bf16 v[172:175], a[140:143], a[4:7], v[172:175]
    ds_read_b64_tr_b16 a[176:177], v60 offset:8192
    v_mfma_f32_16x16x32_bf16 v[204:207], a[140:143], a[8:11], v[204:207]
    ds_read_b64_tr_b16 a[178:179], v60 offset:12288
    v_mfma_f32_16x16x32_bf16 v[236:239], a[140:143], a[12:15], v[236:239]
    v_mfma_f32_16x16x32_bf16 v[144:147], a[144:147], a[0:3], v[144:147]
    ds_read_b64_tr_b16 a[180:181], v61 offset:8192
    buffer_load_dwordx4 v18, s[52:55], s83 offen offset:1024 lds
    v_mfma_f32_16x16x32_bf16 v[176:179], a[144:147], a[4:7], v[176:179]
    ds_read_b64_tr_b16 a[182:183], v61 offset:12288
    v_mfma_f32_16x16x32_bf16 v[208:211], a[144:147], a[8:11], v[208:211]
    v_mfma_f32_16x16x32_bf16 v[240:243], a[144:147], a[12:15], v[240:243]
    ds_read_b64_tr_b16 a[184:185], v62 offset:8192
    v_mfma_f32_16x16x32_bf16 v[148:151], a[148:151], a[0:3], v[148:151]
    ds_read_b64_tr_b16 a[186:187], v62 offset:12288
    v_mfma_f32_16x16x32_bf16 v[180:183], a[148:151], a[4:7], v[180:183]
    v_mfma_f32_16x16x32_bf16 v[212:215], a[148:151], a[8:11], v[212:215]
    ds_read_b64_tr_b16 a[188:189], v63 offset:8192
    v_mfma_f32_16x16x32_bf16 v[244:247], a[148:151], a[12:15], v[244:247]
    ds_read_b64_tr_b16 a[190:191], v63 offset:12288
    v_mfma_f32_16x16x32_bf16 v[152:155], a[152:155], a[0:3], v[152:155]
    v_mfma_f32_16x16x32_bf16 v[184:187], a[152:155], a[4:7], v[184:187]
    v_mfma_f32_16x16x32_bf16 v[216:219], a[152:155], a[8:11], v[216:219]
    v_mfma_f32_16x16x32_bf16 v[248:251], a[152:155], a[12:15], v[248:251]
    v_mfma_f32_16x16x32_bf16 v[156:159], a[156:159], a[0:3], v[156:159]
    v_mfma_f32_16x16x32_bf16 v[188:191], a[156:159], a[4:7], v[188:191]
    v_mfma_f32_16x16x32_bf16 v[220:223], a[156:159], a[8:11], v[220:223]
    v_mfma_f32_16x16x32_bf16 v[252:255], a[156:159], a[12:15], v[252:255]
    s_waitcnt vmcnt(47) lgkmcnt(14)
    v_mfma_f32_16x16x32_bf16 v[128:131], a[160:163], a[16:19], v[128:131]
    s_waitcnt vmcnt(41)
    v_readfirstlane_b32 s86, v43
    s_bfe_u32 s86, s86, 0x80010
    s_cmp_eq_u32 s86, 16
    s_cbranch_scc0 L_spC
L_okC:
    buffer_load_dwordx4 a[0:3], v21, s[56:59], s68 offen sc1
    v_mfma_f32_16x16x32_bf16 v[160:163], a[160:163], a[20:23], v[160:163]
    ds_read_b64_tr_b16 a[128:129], v56 offset:16384
    v_mfma_f32_16x16x32_bf16 v[192:195], a[160:163], a[24:27], v[192:195]
    ds_read_b64_tr_b16 a[130:131], v56 offset:20480
    buffer_load_dwordx4 a[4:7], v22, s[56:59], s68 offen sc1
    v_mfma_f32_16x16x32_bf16 v[224:227], a[160:163], a[28:31], v[224:227]
    s_waitcnt lgkmcnt(14)
    v_mfma_f32_16x16x32_bf16 v[132:135], a[164:167], a[16:19], v[132:135]
    ds_read_b64_tr_b16 a[132:133], v57 offset:16384
    buffer_load_dwordx4 a[8:11], v23, s[56:59], s68 offen sc1
    v_mfma_f32_16x16x32_bf16 v[164:167], a[164:167], a[20:23], v[164:167]
    ds_read_b64_tr_b16 a[134:135], v57 offset:20480
    v_mfma_f32_16x16x32_bf16 v[196:199], a[164:167], a[24:27], v[196:199]
    buffer_load_dwordx4 a[12:15], v24, s[56:59], s68 offen sc1
    v_mfma_f32_16x16x32_bf16 v[228:231], a[164:167], a[28:31], v[228:231]
    ds_read_b64_tr_b16 a[136:137], v58 offset:16384
    s_waitcnt lgkmcnt(15)
    s_branch L_over10
L_stub10:
    s_branch L_stub12
L_over10:
    v_mfma_f32_16x16x32_bf16 v[136:139], a[168:171], a[16:19], v[136:139]
    ds_read_b64_tr_b16 a[138:139], v58 offset:20480
    s_add_u32 s68, s68, 16384
    v_mfma_f32_16x16x32_bf16 v[168:171], a[168:171], a[20:23], v[168:171]
    v_mfma_f32_16x16x32_bf16 v[200:203], a[168:171], a[24:27], v[200:203]
    ds_read_b64_tr_b16 a[140:141], v59 offset:16384
    v_mfma_f32_16x16x32_bf16 v[232:235], a[168:171], a[28:31], v[232:235]
    ds_read_b64_tr_b16 a[142:143], v59 offset:20480
    s_mov_b32 s82, 524288
    s_add_u32 m0, s3, 131072
    s_waitcnt lgkmcnt(15)
    v_mfma_f32_16x16x32_bf16 v[140:143], a[172:175], a[16:19], v[140:143]
    buffer_load_dwordx4 v17, s[52:55], s82 offen lds
    v_mfma_f32_16x16x32_bf16 v[172:175], a[172:175], a[20:23], v[172:175]
    ds_read_b64_tr_b16 a[144:145], v60 offset:16384
    v_mfma_f32_16x16x32_bf16 v[204:207], a[172:175], a[24:27], v[204:207]
    ds_read_b64_tr_b16 a[146:147], v60 offset:20480
    v_mfma_f32_16x16x32_bf16 v[236:239], a[172:175], a[28:31], v[236:239]
    s_waitcnt lgkmcnt(15)
    v_mfma_f32_16x16x32_bf16 v[144:147], a[176:179], a[16:19], v[144:147]
    ds_read_b64_tr_b16 a[148:149], v61 offset:16384
    buffer_load_dwordx4 v18, s[52:55], s82 offen offset:1024 lds
    v_mfma_f32_16x16x32_bf16 v[176:179], a[176:179], a[20:23], v[176:179]
    ds_read_b64_tr_b16 a[150:151], v61 offset:20480
    v_mfma_f32_16x16x32_bf16 v[208:211], a[176:179], a[24:27], v[208:211]
    v_mfma_f32_16x16x32_bf16 v[240:243], a[176:179], a[28:31], v[240:243]
    ds_read_b64_tr_b16 a[152:153], v62 offset:16384
    s_waitcnt lgkmcnt(15)
    v_mfma_f32_16x16x32_bf16 v[148:151], a[180:183], a[16:19], v[148:151]
    ds_read_b64_tr_b16 a[154:155], v62 offset:20480
    v_mfma_f32_16x16x32_bf16 v[180:183], a[180:183], a[20:23], v[180:183]
    v_mfma_f32_16x16x32_bf16 v[212:215], a[180:183], a[24:27], v[212:215]
    ds_read_b64_tr_b16 a[156:157], v63 offset:16384
    v_mfma_f32_16x16x32_bf16 v[244:247], a[180:183], a[28:31], v[244:247]
    ds_read_b64_tr_b16 a[158:159], v63 offset:20480
    v_mfma_f32_16x16x32_bf16 v[152:155], a[184:187], a[16:19], v[152:155]
    v_mfma_f32_16x16x32_bf16 v[184:187], a[184:187], a[20:23], v[184:187]
    v_mfma_f32_16x16x32_bf16 v[216:219], a[184:187], a[24:27], v[216:219]
    v_mfma_f32_16x16x32_bf16 v[248:251], a[184:187], a[28:31], v[248:251]
    s_waitcnt lgkmcnt(15)
    v_mfma_f32_16x16x32_bf16 v[156:159], a[188:191], a[16:19], v[156:159]
    v_mfma_f32_16x16x32_bf16 v[188:191], a[188:191], a[20:23], v[188:191]
    v_mfma_f32_16x16x32_bf16 v[220:223], a[188:191], a[24:27], v[220:223]
    v_mfma_f32_16x16x32_bf16 v[252:255], a[188:191], a[28:31], v[252:255]
    s_waitcnt lgkmcnt(0)
    s_barrier
    s_waitcnt vmcnt(46)
    v_mfma_f32_16x16x32_bf16 v[128:131], a[128:131], a[32:35], v[128:131]
    buffer_load_dwordx4 a[16:19], v21, s[56:59], s68 offen sc1
    s_waitcnt vmcnt(46)
    v_mfma_f32_16x16x32_bf16 v[160:163], a[128:131], a[36:39], v[160:163]
    ds_read_b64_tr_b16 a[160:161], v56 offset:24576
    s_waitcnt vmcnt(45)
    v_mfma_f32_16x16x32_bf16 v[192:195], a[128:131], a[40:43], v[192:195]
    ds_read_b64_tr_b16 a[162:163], v56 offset:28672
    buffer_load_dwordx4 a[20:23], v22, s[56:59], s68 offen sc1
    s_waitcnt vmcnt(45)
    v_mfma_f32_16x16x32_bf16 v[224:227], a[128:131], a[44:47], v[224:227]
    v_mfma_f32_16x16x32_bf16 v[132:135], a[132:135], a[32:35], v[132:135]
    ds_read_b64_tr_b16 a[164:165], v57 offset:24576
    buffer_load_dwordx4 a[24:27], v23, s[56:59], s68 offen sc1
    v_mfma_f32_16x16x32_bf16 v[164:167], a[132:135], a[36:39], v[164:167]
    ds_read_b64_tr_b16 a[166:167], v57 offset:28672
    v_mfma_f32_16x16x32_bf16 v[196:199], a[132:135], a[40:43], v[196:199]
    buffer_load_dwordx4 a[28:31], v24, s[56:59], s68 offen sc1
    v_mfma_f32_16x16x32_bf16 v[228:231], a[132:135], a[44:47], v[228:231]
    ds_read_b64_tr_b16 a[168:169], v58 offset:24576
    v_mfma_f32_16x16x32_bf16 v[136:139], a[136:139], a[32:35], v[136:139]
    ds_read_b64_tr_b16 a[170:171], v58 offset:28672
    s_add_u32 s68, s68, 16384
    v_mfma_f32_16x16x32_bf16 v[168:171], a[136:139], a[36:39], v[168:171]
    v_mfma_f32_16x16x32_bf16 v[200:203], a[136:139], a[40:43], v[200:203]
    ds_read_b64_tr_b16 a[172:173], v59 offset:24576
    v_mfma_f32_16x16x32_bf16 v[232:235], a[136:139], a[44:47], v[232:235]
    ds_read_b64_tr_b16 a[174:175], v59 offset:28672
    s_mov_b32 s83, 589824
    s_add_u32 m0, s3, 139264
    v_mfma_f32_16x16x32_bf16 v[140:143], a[140:143], a[32:35], v[140:143]
    buffer_load_dwordx4 v17, s[52:55], s83 offen lds
    v_mfma_f32_16x16x32_bf16 v[172:175], a[140:143], a[36:39], v[172:175]
    ds_read_b64_tr_b16 a[176:177], v60 offset:24576
    v_mfma_f32_16x16x32_bf16 v[204:207], a[140:143], a[40:43], v[204:207]
    ds_read_b64_tr_b16 a[178:179], v60 offset:28672
    v_mfma_f32_16x16x32_bf16 v[236:239], a[140:143], a[44:47], v[236:239]
    v_mfma_f32_16x16x32_bf16 v[144:147], a[144:147], a[32:35], v[144:147]
    ds_read_b64_tr_b16 a[180:181], v61 offset:24576
    buffer_load_dwordx4 v18, s[52:55], s83 offen offset:1024 lds
    v_mfma_f32_16x16x32_bf16 v[176:179], a[144:147], a[36:39], v[176:179]
    ds_read_b64_tr_b16 a[182:183], v61 offset:28672
    v_mfma_f32_16x16x32_bf16 v[208:211], a[144:147], a[40:43], v[208:211]
    v_mfma_f32_16x16x32_bf16 v[240:243], a[144:147], a[44:47], v[240:243]
    ds_read_b64_tr_b16 a[184:185], v62 offset:24576
    v_mfma_f32_16x16x32_bf16 v[148:151], a[148:151], a[32:35], v[148:151]
    ds_read_b64_tr_b16 a[186:187], v62 offset:28672
    v_mfma_f32_16x16x32_bf16 v[180:183], a[148:151], a[36:39], v[180:183]
    v_mfma_f32_16x16x32_bf16 v[212:215], a[148:151], a[40:43], v[212:215]
    ds_read_b64_tr_b16 a[188:189], v63 offset:24576
    v_mfma_f32_16x16x32_bf16 v[244:247], a[148:151], a[44:47], v[244:247]
    ds_read_b64_tr_b16 a[190:191], v63 offset:28672
    v_mfma_f32_16x16x32_bf16 v[152:155], a[152:155], a[32:35], v[152:155]
    v_mfma_f32_16x16x32_bf16 v[184:187], a[152:155], a[36:39], v[184:187]
    v_mfma_f32_16x16x32_bf16 v[216:219], a[152:155], a[40:43], v[216:219]
    v_mfma_f32_16x16x32_bf16 v[248:251], a[152:155], a[44:47], v[248:251]
    v_mfma_f32_16x16x32_bf16 v[156:159], a[156:159], a[32:35], v[156:159]
    v_mfma_f32_16x16x32_bf16 v[188:191], a[156:159], a[36:39], v[188:191]
    v_mfma_f32_16x16x32_bf16 v[220:223], a[156:159], a[40:43], v[220:223]
    v_mfma_f32_16x16x32_bf16 v[252:255], a[156:159], a[44:47], v[252:255]
    s_waitcnt vmcnt(46) lgkmcnt(14)
    v_mfma_f32_16x16x32_bf16 v[128:131], a[160:163], a[48:51], v[128:131]
    buffer_load_dwordx4 a[32:35], v21, s[56:59], s68 offen sc1
    s_waitcnt vmcnt(46)
    v_mfma_f32_16x16x32_bf16 v[160:163], a[160:163], a[52:55], v[160:163]
    ds_read_b64_tr_b16 a[128:129], v8 offset:0
    s_waitcnt vmcnt(45)
    v_mfma_f32_16x16x32_bf16 v[192:195], a[160:163], a[56:59], v[192:195]
    ds_read_b64_tr_b16 a[130:131], v8 offset:4096
    buffer_load_dwordx4 a[36:39], v22, s[56:59], s68 offen sc1
    s_waitcnt vmcnt(45)
    v_mfma_f32_16x16x32_bf16 v[224:227], a[160:163], a[60:63], v[224:227]
    s_waitcnt lgkmcnt(14)
    v_mfma_f32_16x16x32_bf16 v[132:135], a[164:167], a[48:51], v[132:135]
    ds_read_b64_tr_b16 a[132:133], v9 offset:0
    buffer_load_dwordx4 a[40:43], v23, s[56:59], s68 offen sc1
    v_mfma_f32_16x16x32_bf16 v[164:167], a[164:167], a[52:55], v[164:167]
    ds_read_b64_tr_b16 a[134:135], v9 offset:4096
    v_mfma_f32_16x16x32_bf16 v[196:199], a[164:167], a[56:59], v[196:199]
    buffer_load_dwordx4 a[44:47], v24, s[56:59], s68 offen sc1
    v_mfma_f32_16x16x32_bf16 v[228:231], a[164:167], a[60:63], v[228:231]
    ds_read_b64_tr_b16 a[136:137], v10 offset:0
    s_waitcnt lgkmcnt(15)
    v_mfma_f32_16x16x32_bf16 v[136:139], a[168:171], a[48:51], v[136:139]
    ds_read_b64_tr_b16 a[138:139], v10 offset:4096
    s_add_u32 s68, s68, 16384
    v_mfma_f32_16x16x32_bf16 v[168:171], a[168:171], a[52:55], v[168:171]
    v_mfma_f32_16x16x32_bf16 v[200:203], a[168:171], a[56:59], v[200:203]
    ds_read_b64_tr_b16 a[140:141], v11 offset:0
    v_mfma_f32_16x16x32_bf16 v[232:235], a[168:171], a[60:63], v[232:235]
    ds_read_b64_tr_b16 a[142:143], v11 offset:4096
    s_mov_b32 s82, 655360
    s_add_u32 m0, s3, 147456
    s_waitcnt lgkmcnt(15)
    v_mfma_f32_16x16x32_bf16 v[140:143], a[172:175], a[48:51], v[140:143]
    buffer_load_dwordx4 v17, s[52:55], s82 offen lds
    v_mfma_f32_16x16x32_bf16 v[172:175], a[172:175], a[52:55], v[172:175]
    ds_read_b64_tr_b16 a[144:145], v12 offset:0
    v_mfma_f32_16x16x32_bf16 v[204:207], a[172:175], a[56:59], v[204:207]
    ds_read_b64_tr_b16 a[146:147], v12 offset:4096
    v_mfma_f32_16x16x32_bf16 v[236:239], a[172:175], a[60:63], v[236:239]
    s_waitcnt lgkmcnt(15)
    v_mfma_f32_16x16x32_bf16 v[144:147], a[176:179], a[48:51], v[144:147]
    ds_read_b64_tr_b16 a[148:149], v13 offset:0
    buffer_load_dwordx4 v18, s[52:55], s82 offen offset:1024 lds
    v_mfma_f32_16x16x32_bf16 v[176:179], a[176:179], a[52:55], v[176:179]
    ds_read_b64_tr_b16 a[150:151], v13 offset:4096
    v_mfma_f32_16x16x32_bf16 v[208:211], a[176:179], a[56:59], v[208:211]
    s_lshl_b32 s88, s62, 13
    v_mfma_f32_16x16x32_bf16 v[240:243], a[176:179], a[60:63], v[240:243]
    ds_read_b64_tr_b16 a[152:153], v14 offset:0
    v_add_u32 v48, s88, v48
    s_waitcnt lgkmcnt(15)
    v_mfma_f32_16x16x32_bf16 v[148:151], a[180:183], a[48:51], v[148:151]
    ds_read_b64_tr_b16 a[154:155], v14 offset:4096
    v_add_u32 v49, s88, v49
    v_mfma_f32_16x16x32_bf16 v[180:183], a[180:183], a[52:55], v[180:183]
    v_add_u32 v50, s88, v50
    v_mfma_f32_16x16x32_bf16 v[212:215], a[180:183], a[56:59], v[212:215]
    ds_read_b64_tr_b16 a[156:157], v15 offset:0
    v_add_u32 v51, s88, v51
    v_mfma_f32_16x16x32_bf16 v[244:247], a[180:183], a[60:63], v[244:247]
    ds_read_b64_tr_b16 a[158:159], v15 offset:4096
    v_add_u32 v52, s88, v52
    v_mfma_f32_16x16x32_bf16 v[152:155], a[184:187], a[48:51], v[152:155]
    v_add_u32 v53, s88, v53
    v_mfma_f32_16x16x32_bf16 v[184:187], a[184:187], a[52:55], v[184:187]
    v_add_u32 v54, s88, v54
    v_mfma_f32_16x16x32_bf16 v[216:219], a[184:187], a[56:59], v[216:219]
    v_add_u32 v55, s88, v55
    v_mfma_f32_16x16x32_bf16 v[248:251], a[184:187], a[60:63], v[248:251]
    s_lshl_b32 s84, s65, 3
    s_waitcnt lgkmcnt(15)
    v_mfma_f32_16x16x32_bf16 v[156:159], a[188:191], a[48:51], v[156:159]
    s_lshl_b32 s90, 1, s84
    v_mfma_f32_16x16x32_bf16 v[188:191], a[188:191], a[52:55], v[188:191]
    v_mov_b32 v25, s90
    v_mfma_f32_16x16x32_bf16 v[220:223], a[188:191], a[56:59], v[220:223]
    v_mfma_f32_16x16x32_bf16 v[252:255], a[188:191], a[60:63], v[252:255]
    s_waitcnt lgkmcnt(0)
    s_barrier
    s_waitcnt vmcnt(44)
    v_mfma_f32_16x16x32_bf16 v[128:131], a[128:131], a[64:67], v[128:131]
    buffer_load_dwordx4 a[48:51], v21, s[56:59], s68 offen sc1
    s_waitcnt vmcnt(44)
    v_mfma_f32_16x16x32_bf16 v[160:163], a[128:131], a[68:71], v[160:163]
    ds_read_b64_tr_b16 a[160:161], v8 offset:8192
    s_waitcnt vmcnt(43)
    v_mfma_f32_16x16x32_bf16 v[192:195], a[128:131], a[72:75], v[192:195]
    ds_read_b64_tr_b16 a[162:163], v8 offset:12288
    buffer_load_dwordx4 a[52:55], v22, s[56:59], s68 offen sc1
    s_waitcnt vmcnt(43)
    v_mfma_f32_16x16x32_bf16 v[224:227], a[128:131], a[76:79], v[224:227]
    v_mfma_f32_16x16x32_bf16 v[132:135], a[132:135], a[64:67], v[132:135]
    ds_read_b64_tr_b16 a[164:165], v9 offset:8192
    buffer_load_dwordx4 a[56:59], v23, s[56:59], s68 offen sc1
    v_mfma_f32_16x16x32_bf16 v[164:167], a[132:135], a[68:71], v[164:167]
    ds_read_b64_tr_b16 a[166:167], v9 offset:12288
    v_mfma_f32_16x16x32_bf16 v[196:199], a[132:135], a[72:75], v[196:199]
    buffer_load_dwordx4 a[60:63], v24, s[56:59], s68 offen sc1
    v_mfma_f32_16x16x32_bf16 v[228:231], a[132:135], a[76:79], v[228:231]
    ds_read_b64_tr_b16 a[168:169], v10 offset:8192
    v_mfma_f32_16x16x32_bf16 v[136:139], a[136:139], a[64:67], v[136:139]
    ds_read_b64_tr_b16 a[170:171], v10 offset:12288
    s_add_u32 s68, s68, 16384
    v_mfma_f32_16x16x32_bf16 v[168:171], a[136:139], a[68:71], v[168:171]
    v_mfma_f32_16x16x32_bf16 v[200:203], a[136:139], a[72:75], v[200:203]
    ds_read_b64_tr_b16 a[172:173], v11 offset:8192
    v_mfma_f32_16x16x32_bf16 v[232:235], a[136:139], a[76:79], v[232:235]
    ds_read_b64_tr_b16 a[174:175], v11 offset:12288
    s_mov_b32 s83, 720896
    s_add_u32 m0, s3, 155648
    v_mfma_f32_16x16x32_bf16 v[140:143], a[140:143], a[64:67], v[140:143]
    buffer_load_dwordx4 v17, s[52:55], s83 offen lds
    v_mfma_f32_16x16x32_bf16 v[172:175], a[140:143], a[68:71], v[172:175]
    ds_read_b64_tr_b16 a[176:177], v12 offset:8192
    v_mfma_f32_16x16x32_bf16 v[204:207], a[140:143], a[72:75], v[204:207]
    ds_read_b64_tr_b16 a[178:179], v12 offset:12288
    v_mfma_f32_16x16x32_bf16 v[236:239], a[140:143], a[76:79], v[236:239]
    v_mfma_f32_16x16x32_bf16 v[144:147], a[144:147], a[64:67], v[144:147]
    ds_read_b64_tr_b16 a[180:181], v13 offset:8192
    buffer_load_dwordx4 v18, s[52:55], s83 offen offset:1024 lds
    v_mfma_f32_16x16x32_bf16 v[176:179], a[144:147], a[68:71], v[176:179]
    ds_read_b64_tr_b16 a[182:183], v13 offset:12288
    v_mfma_f32_16x16x32_bf16 v[208:211], a[144:147], a[72:75], v[208:211]
    v_add_u32 v56, s88, v56
    v_mfma_f32_16x16x32_bf16 v[240:243], a[144:147], a[76:79], v[240:243]
    ds_read_b64_tr_b16 a[184:185], v14 offset:8192
    v_add_u32 v57, s88, v57
    v_mfma_f32_16x16x32_bf16 v[148:151], a[148:151], a[64:67], v[148:151]
    ds_read_b64_tr_b16 a[186:187], v14 offset:12288
    v_add_u32 v58, s88, v58
    v_mfma_f32_16x16x32_bf16 v[180:183], a[148:151], a[68:71], v[180:183]
    v_add_u32 v59, s88, v59
    v_mfma_f32_16x16x32_bf16 v[212:215], a[148:151], a[72:75], v[212:215]
    ds_read_b64_tr_b16 a[188:189], v15 offset:8192
    v_add_u32 v60, s88, v60
    v_mfma_f32_16x16x32_bf16 v[244:247], a[148:151], a[76:79], v[244:247]
    ds_read_b64_tr_b16 a[190:191], v15 offset:12288
    v_add_u32 v61, s88, v61
    v_mfma_f32_16x16x32_bf16 v[152:155], a[152:155], a[64:67], v[152:155]
    v_add_u32 v62, s88, v62
    v_mfma_f32_16x16x32_bf16 v[184:187], a[152:155], a[68:71], v[184:187]
    v_add_u32 v63, s88, v63
    v_mfma_f32_16x16x32_bf16 v[216:219], a[152:155], a[72:75], v[216:219]
    s_lshl_b32 s84, s60, 13
    v_mfma_f32_16x16x32_bf16 v[248:251], a[152:155], a[76:79], v[248:251]
    v_add_u32 v19, s84, v16
    v_mfma_f32_16x16x32_bf16 v[156:159], a[156:159], a[64:67], v[156:159]
    v_xor_b32 v20, 0x2000, v19
    v_mfma_f32_16x16x32_bf16 v[188:191], a[156:159], a[68:71], v[188:191]
    v_mfma_f32_16x16x32_bf16 v[220:223], a[156:159], a[72:75], v[220:223]
    v_mfma_f32_16x16x32_bf16 v[252:255], a[156:159], a[76:79], v[252:255]
    s_waitcnt vmcnt(43) lgkmcnt(14)
    v_mfma_f32_16x16x32_bf16 v[128:131], a[160:163], a[80:83], v[128:131]
    v_readfirstlane_b32 s86, v44
    s_cmp_eq_u32 s86, 64
    s_cbranch_scc0 L_spO
L_okO:
    s_add_u32 s89, s69, 24576
    s_waitcnt vmcnt(42)
    v_mfma_f32_16x16x32_bf16 v[160:163], a[160:163], a[84:87], v[160:163]
    ds_read_b64_tr_b16 a[128:129], v8 offset:16384
    s_waitcnt vmcnt(41)
    v_mfma_f32_16x16x32_bf16 v[192:195], a[160:163], a[88:91], v[192:195]
    ds_read_b64_tr_b16 a[130:131], v8 offset:20480
    s_waitcnt vmcnt(40)
    v_mfma_f32_16x16x32_bf16 v[224:227], a[160:163], a[92:95], v[224:227]
    buffer_load_dwordx4 a[64:67], v3, s[56:59], s69 offen offset:0 sc1
    s_waitcnt lgkmcnt(14)
    v_mfma_f32_16x16x32_bf16 v[132:135], a[164:167], a[80:83], v[132:135]
    ds_read_b64_tr_b16 a[132:133], v9 offset:16384
    v_mfma_f32_16x16x32_bf16 v[164:167], a[164:167], a[84:87], v[164:167]
    ds_read_b64_tr_b16 a[134:135], v9 offset:20480
    v_mfma_f32_16x16x32_bf16 v[196:199], a[164:167], a[88:91], v[196:199]
    buffer_load_dwordx4 a[68:71], v4, s[56:59], s69 offen offset:0 sc1
    v_mfma_f32_16x16x32_bf16 v[228:231], a[164:167], a[92:95], v[228:231]
    ds_read_b64_tr_b16 a[136:137], v10 offset:16384
    s_waitcnt lgkmcnt(15)
    v_mfma_f32_16x16x32_bf16 v[136:139], a[168:171], a[80:83], v[136:139]
    ds_read_b64_tr_b16 a[138:139], v10 offset:20480
    v_mfma_f32_16x16x32_bf16 v[168:171], a[168:171], a[84:87], v[168:171]
    buffer_load_dwordx4 a[72:75], v3, s[56:59], s69 offen offset:2048 sc1
    v_mfma_f32_16x16x32_bf16 v[200:203], a[168:171], a[88:91], v[200:203]
    ds_read_b64_tr_b16 a[140:141], v11 offset:16384
    v_mfma_f32_16x16x32_bf16 v[232:235], a[168:171], a[92:95], v[232:235]
    ds_read_b64_tr_b16 a[142:143], v11 offset:20480
    s_mov_b32 s82, 786432
    s_add_u32 m0, s3, 0
    s_waitcnt lgkmcnt(15)
    v_mfma_f32_16x16x32_bf16 v[140:143], a[172:175], a[80:83], v[140:143]
    buffer_load_dwordx4 a[76:79], v4, s[56:59], s69 offen offset:2048 sc1
    buffer_load_dwordx4 v17, s[52:55], s82 offen lds
    v_mfma_f32_16x16x32_bf16 v[172:175], a[172:175], a[84:87], v[172:175]
    ds_read_b64_tr_b16 a[144:145], v12 offset:16384
    v_mfma_f32_16x16x32_bf16 v[204:207], a[172:175], a[88:91], v[204:207]
    ds_read_b64_tr_b16 a[146:147], v12 offset:20480
    v_mfma_f32_16x16x32_bf16 v[236:239], a[172:175], a[92:95], v[236:239]
    s_add_u32 s69, s69, 4096
    s_waitcnt lgkmcnt(15)
    v_mfma_f32_16x16x32_bf16 v[144:147], a[176:179], a[80:83], v[144:147]
    ds_read_b64_tr_b16 a[148:149], v13 offset:16384
    buffer_load_dwordx4 v18, s[52:55], s82 offen offset:1024 lds
    v_mfma_f32_16x16x32_bf16 v[176:179], a[176:179], a[84:87], v[176:179]
    ds_read_b64_tr_b16 a[150:151], v13 offset:20480
    v_mfma_f32_16x16x32_bf16 v[208:211], a[176:179], a[88:91], v[208:211]
    buffer_load_dwordx4 a[224:227], v3, s[56:59], s89 offen offset:0 sc1
    v_mfma_f32_16x16x32_bf16 v[240:243], a[176:179], a[92:95], v[240:243]
    ds_read_b64_tr_b16 a[152:153], v14 offset:16384
    s_waitcnt lgkmcnt(15)
    v_mfma_f32_16x16x32_bf16 v[148:151], a[180:183], a[80:83], v[148:151]
    ds_read_b64_tr_b16 a[154:155], v14 offset:20480
    v_mfma_f32_16x16x32_bf16 v[180:183], a[180:183], a[84:87], v[180:183]
    buffer_load_dwordx4 a[228:231], v4, s[56:59], s89 offen offset:0 sc1
    v_mfma_f32_16x16x32_bf16 v[212:215], a[180:183], a[88:91], v[212:215]
    ds_read_b64_tr_b16 a[156:157], v15 offset:16384
    v_mfma_f32_16x16x32_bf16 v[244:247], a[180:183], a[92:95], v[244:247]
    ds_read_b64_tr_b16 a[158:159], v15 offset:20480
    v_mfma_f32_16x16x32_bf16 v[152:155], a[184:187], a[80:83], v[152:155]
    v_mfma_f32_16x16x32_bf16 v[184:187], a[184:187], a[84:87], v[184:187]
    v_mfma_f32_16x16x32_bf16 v[216:219], a[184:187], a[88:91], v[216:219]
    v_mfma_f32_16x16x32_bf16 v[248:251], a[184:187], a[92:95], v[248:251]
    s_waitcnt lgkmcnt(15)
    v_mfma_f32_16x16x32_bf16 v[156:159], a[188:191], a[80:83], v[156:159]
    v_mfma_f32_16x16x32_bf16 v[188:191], a[188:191], a[84:87], v[188:191]
    v_mfma_f32_16x16x32_bf16 v[220:223], a[188:191], a[88:91], v[220:223]
    v_mfma_f32_16x16x32_bf16 v[252:255], a[188:191], a[92:95], v[252:255]
    s_waitcnt lgkmcnt(0)
    s_barrier
    s_waitcnt vmcnt(43)
    v_mfma_f32_16x16x32_bf16 v[128:131], a[128:131], a[96:99], v[128:131]
    buffer_load_dwordx4 a[80:83], v3, s[56:59], s69 offen offset:0 sc1
    s_waitcnt vmcnt(43)
    v_mfma_f32_16x16x32_bf16 v[160:163], a[128:131], a[100:103], v[160:163]
    ds_read_b64_tr_b16 a[160:161], v8 offset:24576
    s_waitcnt vmcnt(42)
    v_mfma_f32_16x16x32_bf16 v[192:195], a[128:131], a[104:107], v[192:195]
    ds_read_b64_tr_b16 a[162:163], v8 offset:28672
    s_waitcnt vmcnt(41)
    v_mfma_f32_16x16x32_bf16 v[224:227], a[128:131], a[108:111], v[224:227]
    buffer_load_dwordx4 a[84:87], v4, s[56:59], s69 offen offset:0 sc1
    v_mfma_f32_16x16x32_bf16 v[132:135], a[132:135], a[96:99], v[132:135]
    ds_read_b64_tr_b16 a[164:165], v9 offset:24576
    v_mfma_f32_16x16x32_bf16 v[164:167], a[132:135], a[100:103], v[164:167]
    ds_read_b64_tr_b16 a[166:167], v9 offset:28672
    v_mfma_f32_16x16x32_bf16 v[196:199], a[132:135], a[104:107], v[196:199]
    buffer_load_dwordx4 a[88:91], v3, s[56:59], s69 offen offset:2048 sc1
    v_mfma_f32_16x16x32_bf16 v[228:231], a[132:135], a[108:111], v[228:231]
    ds_read_b64_tr_b16 a[168:169], v10 offset:24576
    v_mfma_f32_16x16x32_bf16 v[136:139], a[136:139], a[96:99], v[136:139]
    ds_read_b64_tr_b16 a[170:171], v10 offset:28672
    v_mfma_f32_16x16x32_bf16 v[168:171], a[136:139], a[100:103], v[168:171]
    buffer_load_dwordx4 a[92:95], v4, s[56:59], s69 offen offset:2048 sc1
    v_mfma_f32_16x16x32_bf16 v[200:203], a[136:139], a[104:107], v[200:203]
    ds_read_b64_tr_b16 a[172:173], v11 offset:24576
    v_mfma_f32_16x16x32_bf16 v[232:235], a[136:139], a[108:111], v[232:235]
    ds_read_b64_tr_b16 a[174:175], v11 offset:28672
    s_mov_b32 s83, 851968
    s_add_u32 m0, s3, 8192
    v_mfma_f32_16x16x32_bf16 v[140:143], a[140:143], a[96:99], v[140:143]
    s_add_u32 s69, s69, 4096
    buffer_load_dwordx4 v17, s[52:55], s83 offen lds
    v_mfma_f32_16x16x32_bf16 v[172:175], a[140:143], a[100:103], v[172:175]
    ds_read_b64_tr_b16 a[176:177], v12 offset:24576
    v_mfma_f32_16x16x32_bf16 v[204:207], a[140:143], a[104:107], v[204:207]
    ds_read_b64_tr_b16 a[178:179], v12 offset:28672
    v_mfma_f32_16x16x32_bf16 v[236:239], a[140:143], a[108:111], v[236:239]
    buffer_load_dwordx4 a[232:235], v3, s[56:59], s89 offen offset:2048 sc1
    v_mfma_f32_16x16x32_bf16 v[144:147], a[144:147], a[96:99], v[144:147]
    ds_read_b64_tr_b16 a[180:181], v13 offset:24576
    buffer_load_dwordx4 v18, s[52:55], s83 offen offset:1024 lds
    v_mfma_f32_16x16x32_bf16 v[176:179], a[144:147], a[100:103], v[176:179]
    ds_read_b64_tr_b16 a[182:183], v13 offset:28672
    v_mfma_f32_16x16x32_bf16 v[208:211], a[144:147], a[104:107], v[208:211]
    v_mfma_f32_16x16x32_bf16 v[240:243], a[144:147], a[108:111], v[240:243]
    ds_read_b64_tr_b16 a[184:185], v14 offset:24576
    v_mfma_f32_16x16x32_bf16 v[148:151], a[148:151], a[96:99], v[148:151]
    ds_read_b64_tr_b16 a[186:187], v14 offset:28672
    v_mfma_f32_16x16x32_bf16 v[180:183], a[148:151], a[100:103], v[180:183]
    v_mfma_f32_16x16x32_bf16 v[212:215], a[148:151], a[104:107], v[212:215]
    ds_read_b64_tr_b16 a[188:189], v15 offset:24576
    v_mfma_f32_16x16x32_bf16 v[244:247], a[148:151], a[108:111], v[244:247]
    ds_read_b64_tr_b16 a[190:191], v15 offset:28672
    v_mfma_f32_16x16x32_bf16 v[152:155], a[152:155], a[96:99], v[152:155]
    v_mfma_f32_16x16x32_bf16 v[184:187], a[152:155], a[100:103], v[184:187]
    v_mfma_f32_16x16x32_bf16 v[216:219], a[152:155], a[104:107], v[216:219]
    v_mfma_f32_16x16x32_bf16 v[248:251], a[152:155], a[108:111], v[248:251]
    v_mfma_f32_16x16x32_bf16 v[156:159], a[156:159], a[96:99], v[156:159]
    v_mfma_f32_16x16x32_bf16 v[188:191], a[156:159], a[100:103], v[188:191]
    v_mfma_f32_16x16x32_bf16 v[220:223], a[156:159], a[104:107], v[220:223]
    v_mfma_f32_16x16x32_bf16 v[252:255], a[156:159], a[108:111], v[252:255]
    s_waitcnt vmcnt(44) lgkmcnt(14)
    v_mfma_f32_16x16x32_bf16 v[128:131], a[160:163], a[112:115], v[128:131]
    buffer_load_dwordx4 a[96:99], v3, s[56:59], s69 offen offset:0 sc1
    s_waitcnt vmcnt(44)
    v_mfma_f32_16x16x32_bf16 v[160:163], a[160:163], a[116:119], v[160:163]
    ds_read_b64_tr_b16 a[128:129], v8 offset:32768
    s_waitcnt vmcnt(43)
    v_mfma_f32_16x16x32_bf16 v[192:195], a[160:163], a[120:123], v[192:195]
    ds_read_b64_tr_b16 a[130:131], v8 offset:36864
    s_waitcnt vmcnt(42)
    v_mfma_f32_16x16x32_bf16 v[224:227], a[160:163], a[124:127], v[224:227]
    buffer_load_dwordx4 a[100:103], v4, s[56:59], s69 offen offset:0 sc1
    s_waitcnt lgkmcnt(14)
    v_mfma_f32_16x16x32_bf16 v[132:135], a[164:167], a[112:115], v[132:135]
    ds_read_b64_tr_b16 a[132:133], v9 offset:32768
    v_mfma_f32_16x16x32_bf16 v[164:167], a[164:167], a[116:119], v[164:167]
    ds_read_b64_tr_b16 a[134:135], v9 offset:36864
    v_mfma_f32_16x16x32_bf16 v[196:199], a[164:167], a[120:123], v[196:199]
    buffer_load_dwordx4 a[104:107], v3, s[56:59], s69 offen offset:2048 sc1
    v_mfma_f32_16x16x32_bf16 v[228:231], a[164:167], a[124:127], v[228:231]
    ds_read_b64_tr_b16 a[136:137], v10 offset:32768
    s_waitcnt lgkmcnt(15)
    v_mfma_f32_16x16x32_bf16 v[136:139], a[168:171], a[112:115], v[136:139]
    ds_read_b64_tr_b16 a[138:139], v10 offset:36864
    v_mfma_f32_16x16x32_bf16 v[168:171], a[168:171], a[116:119], v[168:171]
    buffer_load_dwordx4 a[108:111], v4, s[56:59], s69 offen offset:2048 sc1
    v_mfma_f32_16x16x32_bf16 v[200:203], a[168:171], a[120:123], v[200:203]
    ds_read_b64_tr_b16 a[140:141], v11 offset:32768
    v_mfma_f32_16x16x32_bf16 v[232:235], a[168:171], a[124:127], v[232:235]
    ds_read_b64_tr_b16 a[142:143], v11 offset:36864
    s_mov_b32 s82, 917504
    s_add_u32 m0, s3, 16384
    s_waitcnt lgkmcnt(15)
    v_mfma_f32_16x16x32_bf16 v[140:143], a[172:175], a[112:115], v[140:143]
    s_add_u32 s69, s69, 4096
    buffer_load_dwordx4 v17, s[52:55], s82 offen lds
    v_mfma_f32_16x16x32_bf16 v[172:175], a[172:175], a[116:119], v[172:175]
    ds_read_b64_tr_b16 a[144:145], v12 offset:32768
    v_mfma_f32_16x16x32_bf16 v[204:207], a[172:175], a[120:123], v[204:207]
    ds_read_b64_tr_b16 a[146:147], v12 offset:36864
    v_mfma_f32_16x16x32_bf16 v[236:239], a[172:175], a[124:127], v[236:239]
    buffer_load_dwordx4 a[236:239], v4, s[56:59], s89 offen offset:2048 sc1
    s_waitcnt lgkmcnt(15)
    v_mfma_f32_16x16x32_bf16 v[144:147], a[176:179], a[112:115], v[144:147]
    ds_read_b64_tr_b16 a[148:149], v13 offset:32768
    buffer_load_dwordx4 v18, s[52:55], s82 offen offset:1024 lds
    v_mfma_f32_16x16x32_bf16 v[176:179], a[176:179], a[116:119], v[176:179]
    ds_read_b64_tr_b16 a[150:151], v13 offset:36864
    v_mfma_f32_16x16x32_bf16 v[208:211], a[176:179], a[120:123], v[208:211]
    s_add_u32 s89, s89, 4096
    v_mfma_f32_16x16x32_bf16 v[240:243], a[176:179], a[124:127], v[240:243]
    ds_read_b64_tr_b16 a[152:153], v14 offset:32768
    s_waitcnt lgkmcnt(15)
    v_mfma_f32_16x16x32_bf16 v[148:151], a[180:183], a[112:115], v[148:151]
    ds_read_b64_tr_b16 a[154:155], v14 offset:36864
    v_mfma_f32_16x16x32_bf16 v[180:183], a[180:183], a[116:119], v[180:183]
    v_mfma_f32_16x16x32_bf16 v[212:215], a[180:183], a[120:123], v[212:215]
    ds_read_b64_tr_b16 a[156:157], v15 offset:32768
    v_mfma_f32_16x16x32_bf16 v[244:247], a[180:183], a[124:127], v[244:247]
    ds_read_b64_tr_b16 a[158:159], v15 offset:36864
    v_mfma_f32_16x16x32_bf16 v[152:155], a[184:187], a[112:115], v[152:155]
    v_mfma_f32_16x16x32_bf16 v[184:187], a[184:187], a[116:119], v[184:187]
    v_mfma_f32_16x16x32_bf16 v[216:219], a[184:187], a[120:123], v[216:219]
    v_mfma_f32_16x16x32_bf16 v[248:251], a[184:187], a[124:127], v[248:251]
    s_waitcnt lgkmcnt(15)
    v_mfma_f32_16x16x32_bf16 v[156:159], a[188:191], a[112:115], v[156:159]
    v_mfma_f32_16x16x32_bf16 v[188:191], a[188:191], a[116:119], v[188:191]
    v_mfma_f32_16x16x32_bf16 v[220:223], a[188:191], a[120:123], v[220:223]
    v_mfma_f32_16x16x32_bf16 v[252:255], a[188:191], a[124:127], v[252:255]
    s_waitcnt lgkmcnt(0)
    s_barrier
    s_waitcnt vmcnt(45)
    v_mfma_f32_16x16x32_bf16 v[128:131], a[128:131], a[0:3], v[128:131]
    buffer_load_dwordx4 a[112:115], v3, s[56:59], s69 offen offset:0 sc1
    s_waitcnt vmcnt(45)
    v_mfma_f32_16x16x32_bf16 v[160:163], a[128:131], a[4:7], v[160:163]
    ds_read_b64_tr_b16 a[160:161], v8 offset:40960
    s_waitcnt vmcnt(44)
    v_mfma_f32_16x16x32_bf16 v[192:195], a[128:131], a[8:11], v[192:195]
    ds_read_b64_tr_b16 a[162:163], v8 offset:45056
    s_waitcnt vmcnt(43)
    v_mfma_f32_16x16x32_bf16 v[224:227], a[128:131], a[12:15], v[224:227]
    buffer_load_dwordx4 a[116:119], v4, s[56:59], s69 offen offset:0 sc1
    v_mfma_f32_16x16x32_bf16 v[132:135], a[132:135], a[0:3], v[132:135]
    ds_read_b64_tr_b16 a[164:165], v9 offset:40960
    v_mfma_f32_16x16x32_bf16 v[164:167], a[132:135], a[4:7], v[164:167]
    ds_read_b64_tr_b16 a[166:167], v9 offset:45056
    v_mfma_f32_16x16x32_bf16 v[196:199], a[132:135], a[8:11], v[196:199]
    buffer_load_dwordx4 a[120:123], v3, s[56:59], s69 offen offset:2048 sc1
    v_mfma_f32_16x16x32_bf16 v[228:231], a[132:135], a[12:15], v[228:231]
    ds_read_b64_tr_b16 a[168:169], v10 offset:40960
    v_mfma_f32_16x16x32_bf16 v[136:139], a[136:139], a[0:3], v[136:139]
    ds_read_b64_tr_b16 a[170:171], v10 offset:45056
    v_mfma_f32_16x16x32_bf16 v[168:171], a[136:139], a[4:7], v[168:171]
    buffer_load_dwordx4 a[124:127], v4, s[56:59], s69 offen offset:2048 sc1
    v_mfma_f32_16x16x32_bf16 v[200:203], a[136:139], a[8:11], v[200:203]
    ds_read_b64_tr_b16 a[172:173], v11 offset:40960
    v_mfma_f32_16x16x32_bf16 v[232:235], a[136:139], a[12:15], v[232:235]
    ds_read_b64_tr_b16 a[174:175], v11 offset:45056
    s_mov_b32 s83, 983040
    s_add_u32 m0, s3, 24576
    v_mfma_f32_16x16x32_bf16 v[140:143], a[140:143], a[0:3], v[140:143]
    s_add_u32 s69, s69, 4096
    buffer_load_dwordx4 v17, s[52:55], s83 offen lds
    v_mfma_f32_16x16x32_bf16 v[172:175], a[140:143], a[4:7], v[172:175]
    ds_read_b64_tr_b16 a[176:177], v12 offset:40960
    v_mfma_f32_16x16x32_bf16 v[204:207], a[140:143], a[8:11], v[204:207]
    ds_read_b64_tr_b16 a[178:179], v12 offset:45056
    v_mfma_f32_16x16x32_bf16 v[236:239], a[140:143], a[12:15], v[236:239]
    buffer_load_dwordx4 a[240:243], v3, s[56:59], s89 offen offset:0 sc1
    v_mfma_f32_16x16x32_bf16 v[144:147], a[144:147], a[0:3], v[144:147]
    ds_read_b64_tr_b16 a[180:181], v13 offset:40960
    buffer_load_dwordx4 v18, s[52:55], s83 offen offset:1024 lds
    v_mfma_f32_16x16x32_bf16 v[176:179], a[144:147], a[4:7], v[176:179]
    ds_read_b64_tr_b16 a[182:183], v13 offset:45056
    v_mfma_f32_16x16x32_bf16 v[208:211], a[144:147], a[8:11], v[208:211]
    buffer_load_dwordx4 a[244:247], v4, s[56:59], s89 offen offset:0 sc1
    v_mfma_f32_16x16x32_bf16 v[240:243], a[144:147], a[12:15], v[240:243]
    ds_read_b64_tr_b16 a[184:185], v14 offset:40960
    v_mfma_f32_16x16x32_bf16 v[148:151], a[148:151], a[0:3], v[148:151]
    ds_read_b64_tr_b16 a[186:187], v14 offset:45056
    v_mfma_f32_16x16x32_bf16 v[180:183], a[148:151], a[4:7], v[180:183]
    v_mfma_f32_16x16x32_bf16 v[212:215], a[148:151], a[8:11], v[212:215]
    ds_read_b64_tr_b16 a[188:189], v15 offset:40960
    v_mfma_f32_16x16x32_bf16 v[244:247], a[148:151], a[12:15], v[244:247]
    ds_read_b64_tr_b16 a[190:191], v15 offset:45056
    v_mfma_f32_16x16x32_bf16 v[152:155], a[152:155], a[0:3], v[152:155]
    v_mfma_f32_16x16x32_bf16 v[184:187], a[152:155], a[4:7], v[184:187]
    v_mfma_f32_16x16x32_bf16 v[216:219], a[152:155], a[8:11], v[216:219]
    v_mfma_f32_16x16x32_bf16 v[248:251], a[152:155], a[12:15], v[248:251]
    v_mfma_f32_16x16x32_bf16 v[156:159], a[156:159], a[0:3], v[156:159]
    v_mfma_f32_16x16x32_bf16 v[188:191], a[156:159], a[4:7], v[188:191]
    v_mfma_f32_16x16x32_bf16 v[220:223], a[156:159], a[8:11], v[220:223]
    v_mfma_f32_16x16x32_bf16 v[252:255], a[156:159], a[12:15], v[252:255]
    s_waitcnt vmcnt(47) lgkmcnt(14)
    v_mfma_f32_16x16x32_bf16 v[128:131], a[160:163], a[16:19], v[128:131]
    buffer_load_dwordx4 a[0:3], v3, s[56:59], s69 offen offset:0 sc1
    s_waitcnt vmcnt(47)
    v_mfma_f32_16x16x32_bf16 v[160:163], a[160:163], a[20:23], v[160:163]
    ds_read_b64_tr_b16 a[128:129], v8 offset:49152
    s_waitcnt vmcnt(46)
    v_mfma_f32_16x16x32_bf16 v[192:195], a[160:163], a[24:27], v[192:195]
    ds_read_b64_tr_b16 a[130:131], v8 offset:53248
    s_waitcnt vmcnt(45)
    v_mfma_f32_16x16x32_bf16 v[224:227], a[160:163], a[28:31], v[224:227]
    buffer_load_dwordx4 a[4:7], v4, s[56:59], s69 offen offset:0 sc1
    s_waitcnt lgkmcnt(14)
    v_mfma_f32_16x16x32_bf16 v[132:135], a[164:167], a[16:19], v[132:135]
    ds_read_b64_tr_b16 a[132:133], v9 offset:49152
    v_mfma_f32_16x16x32_bf16 v[164:167], a[164:167], a[20:23], v[164:167]
    ds_read_b64_tr_b16 a[134:135], v9 offset:53248
    v_mfma_f32_16x16x32_bf16 v[196:199], a[164:167], a[24:27], v[196:199]
    buffer_load_dwordx4 a[8:11], v3, s[56:59], s69 offen offset:2048 sc1
    v_mfma_f32_16x16x32_bf16 v[228:231], a[164:167], a[28:31], v[228:231]
    ds_read_b64_tr_b16 a[136:137], v10 offset:49152
    s_waitcnt lgkmcnt(15)
    v_mfma_f32_16x16x32_bf16 v[136:139], a[168:171], a[16:19], v[136:139]
    ds_read_b64_tr_b16 a[138:139], v10 offset:53248
    v_mfma_f32_16x16x32_bf16 v[168:171], a[168:171], a[20:23], v[168:171]
    s_branch L_over11
L_stub11:
    s_branch L_stub13
L_over11:
    buffer_load_dwordx4 a[12:15], v4, s[56:59], s69 offen offset:2048 sc1
    v_mfma_f32_16x16x32_bf16 v[200:203], a[168:171], a[24:27], v[200:203]
    ds_read_b64_tr_b16 a[140:141], v11 offset:49152
    v_mfma_f32_16x16x32_bf16 v[232:235], a[168:171], a[28:31], v[232:235]
    ds_read_b64_tr_b16 a[142:143], v11 offset:53248
    s_mov_b32 s82, 1048576
    s_add_u32 m0, s3, 32768
    s_waitcnt lgkmcnt(15)
    v_mfma_f32_16x16x32_bf16 v[140:143], a[172:175], a[16:19], v[140:143]
    s_add_u32 s69, s69, 4096
    buffer_load_dwordx4 v17, s[52:55], s82 offen lds
    v_mfma_f32_16x16x32_bf16 v[172:175], a[172:175], a[20:23], v[172:175]
    ds_read_b64_tr_b16 a[144:145], v12 offset:49152
    v_mfma_f32_16x16x32_bf16 v[204:207], a[172:175], a[24:27], v[204:207]
    ds_read_b64_tr_b16 a[146:147], v12 offset:53248
    v_mfma_f32_16x16x32_bf16 v[236:239], a[172:175], a[28:31], v[236:239]
    buffer_load_dwordx4 a[248:251], v3, s[56:59], s89 offen offset:2048 sc1
    s_waitcnt lgkmcnt(15)
    v_mfma_f32_16x16x32_bf16 v[144:147], a[176:179], a[16:19], v[144:147]
    ds_read_b64_tr_b16 a[148:149], v13 offset:49152
    buffer_load_dwordx4 v18, s[52:55], s82 offen offset:1024 lds
    v_mfma_f32_16x16x32_bf16 v[176:179], a[176:179], a[20:23], v[176:179]
    ds_read_b64_tr_b16 a[150:151], v13 offset:53248
    v_mfma_f32_16x16x32_bf16 v[208:211], a[176:179], a[24:27], v[208:211]
    v_mfma_f32_16x16x32_bf16 v[240:243], a[176:179], a[28:31], v[240:243]
    ds_read_b64_tr_b16 a[152:153], v14 offset:49152
    s_waitcnt lgkmcnt(15)
    v_mfma_f32_16x16x32_bf16 v[148:151], a[180:183], a[16:19], v[148:151]
    ds_read_b64_tr_b16 a[154:155], v14 offset:53248
    v_mfma_f32_16x16x32_bf16 v[180:183], a[180:183], a[20:23], v[180:183]
    v_mfma_f32_16x16x32_bf16 v[212:215], a[180:183], a[24:27], v[212:215]
    ds_read_b64_tr_b16 a[156:157], v15 offset:49152
    v_mfma_f32_16x16x32_bf16 v[244:247], a[180:183], a[28:31], v[244:247]
    ds_read_b64_tr_b16 a[158:159], v15 offset:53248
    v_mfma_f32_16x16x32_bf16 v[152:155], a[184:187], a[16:19], v[152:155]
    v_mfma_f32_16x16x32_bf16 v[184:187], a[184:187], a[20:23], v[184:187]
    v_mfma_f32_16x16x32_bf16 v[216:219], a[184:187], a[24:27], v[216:219]
    v_mfma_f32_16x16x32_bf16 v[248:251], a[184:187], a[28:31], v[248:251]
    s_waitcnt lgkmcnt(15)
    v_mfma_f32_16x16x32_bf16 v[156:159], a[188:191], a[16:19], v[156:159]
    v_mfma_f32_16x16x32_bf16 v[188:191], a[188:191], a[20:23], v[188:191]
    v_mfma_f32_16x16x32_bf16 v[220:223], a[188:191], a[24:27], v[220:223]
    v_mfma_f32_16x16x32_bf16 v[252:255], a[188:191], a[28:31], v[252:255]
    s_waitcnt lgkmcnt(0)
    s_barrier
    s_waitcnt vmcnt(48)
    v_mfma_f32_16x16x32_bf16 v[128:131], a[128:131], a[32:35], v[128:131]
    buffer_load_dwordx4 a[16:19], v3, s[56:59], s69 offen offset:0 sc1
    s_waitcnt vmcnt(48)
    v_mfma_f32_16x16x32_bf16 v[160:163], a[128:131], a[36:39], v[160:163]
    ds_read_b64_tr_b16 a[160:161], v8 offset:57344
    s_waitcnt vmcnt(47)
    v_mfma_f32_16x16x32_bf16 v[192:195], a[128:131], a[40:43], v[192:195]
    ds_read_b64_tr_b16 a[162:163], v8 offset:61440
    s_waitcnt vmcnt(46)
    v_mfma_f32_16x16x32_bf16 v[224:227], a[128:131], a[44:47], v[224:227]
    buffer_load_dwordx4 a[20:23], v4, s[56:59], s69 offen offset:0 sc1
    v_mfma_f32_16x16x32_bf16 v[132:135], a[132:135], a[32:35], v[132:135]
    ds_read_b64_tr_b16 a[164:165], v9 offset:57344
    v_mfma_f32_16x16x32_bf16 v[164:167], a[132:135], a[36:39], v[164:167]
    ds_read_b64_tr_b16 a[166:167], v9 offset:61440
    v_mfma_f32_16x16x32_bf16 v[196:199], a[132:135], a[40:43], v[196:199]
    buffer_load_dwordx4 a[24:27], v3, s[56:59], s69 offen offset:2048 sc1
    v_mfma_f32_16x16x32_bf16 v[228:231], a[132:135], a[44:47], v[228:231]
    ds_read_b64_tr_b16 a[168:169], v10 offset:57344
    v_mfma_f32_16x16x32_bf16 v[136:139], a[136:139], a[32:35], v[136:139]
    ds_read_b64_tr_b16 a[170:171], v10 offset:61440
    v_mfma_f32_16x16x32_bf16 v[168:171], a[136:139], a[36:39], v[168:171]
    buffer_load_dwordx4 a[28:31], v4, s[56:59], s69 offen offset:2048 sc1
    v_mfma_f32_16x16x32_bf16 v[200:203], a[136:139], a[40:43], v[200:203]
    ds_read_b64_tr_b16 a[172:173], v11 offset:57344
    v_mfma_f32_16x16x32_bf16 v[232:235], a[136:139], a[44:47], v[232:235]
    ds_read_b64_tr_b16 a[174:175], v11 offset:61440
    s_mov_b32 s83, 1114112
    s_add_u32 m0, s3, 40960
    v_mfma_f32_16x16x32_bf16 v[140:143], a[140:143], a[32:35], v[140:143]
    s_add_u32 s69, s69, 4096
    buffer_load_dwordx4 v17, s[52:55], s83 offen lds
    v_mfma_f32_16x16x32_bf16 v[172:175], a[140:143], a[36:39], v[172:175]
    ds_read_b64_tr_b16 a[176:177], v12 offset:57344
    v_mfma_f32_16x16x32_bf16 v[204:207], a[140:143], a[40:43], v[204:207]
    ds_read_b64_tr_b16 a[178:179], v12 offset:61440
    v_mfma_f32_16x16x32_bf16 v[236:239], a[140:143], a[44:47], v[236:239]
    buffer_load_dwordx4 a[252:255], v4, s[56:59], s89 offen offset:2048 sc1
    v_mfma_f32_16x16x32_bf16 v[144:147], a[144:147], a[32:35], v[144:147]
    ds_read_b64_tr_b16 a[180:181], v13 offset:57344
    buffer_load_dwordx4 v18, s[52:55], s83 offen offset:1024 lds
    v_mfma_f32_16x16x32_bf16 v[176:179], a[144:147], a[36:39], v[176:179]
    ds_read_b64_tr_b16 a[182:183], v13 offset:61440
    v_mfma_f32_16x16x32_bf16 v[208:211], a[144:147], a[40:43], v[208:211]
    s_add_u32 s89, s89, 4096
    v_mfma_f32_16x16x32_bf16 v[240:243], a[144:147], a[44:47], v[240:243]
    ds_read_b64_tr_b16 a[184:185], v14 offset:57344
    v_mfma_f32_16x16x32_bf16 v[148:151], a[148:151], a[32:35], v[148:151]
    ds_read_b64_tr_b16 a[186:187], v14 offset:61440
    v_mfma_f32_16x16x32_bf16 v[180:183], a[148:151], a[36:39], v[180:183]
    s_mov_b32 s82, 1179648
    s_add_u32 m0, s3, 49152
    v_mfma_f32_16x16x32_bf16 v[212:215], a[148:151], a[40:43], v[212:215]
    ds_read_b64_tr_b16 a[188:189], v15 offset:57344
    buffer_load_dwordx4 v17, s[52:55], s82 offen lds
    v_mfma_f32_16x16x32_bf16 v[244:247], a[148:151], a[44:47], v[244:247]
    ds_read_b64_tr_b16 a[190:191], v15 offset:61440
    v_mfma_f32_16x16x32_bf16 v[152:155], a[152:155], a[32:35], v[152:155]
    v_mfma_f32_16x16x32_bf16 v[184:187], a[152:155], a[36:39], v[184:187]
    v_mfma_f32_16x16x32_bf16 v[216:219], a[152:155], a[40:43], v[216:219]
    buffer_load_dwordx4 v18, s[52:55], s82 offen offset:1024 lds
    v_mfma_f32_16x16x32_bf16 v[248:251], a[152:155], a[44:47], v[248:251]
    v_mfma_f32_16x16x32_bf16 v[156:159], a[156:159], a[32:35], v[156:159]
    v_mfma_f32_16x16x32_bf16 v[188:191], a[156:159], a[36:39], v[188:191]
    v_mfma_f32_16x16x32_bf16 v[220:223], a[156:159], a[40:43], v[220:223]
    v_mfma_f32_16x16x32_bf16 v[252:255], a[156:159], a[44:47], v[252:255]
    s_waitcnt lgkmcnt(0)
    s_barrier
    s_waitcnt vmcnt(50)
    v_mfma_f32_16x16x32_bf16 v[160:163], a[160:163], a[52:55], v[160:163]
    s_mov_b32 s83, 1245184
    s_add_u32 m0, s3, 57344
    v_mfma_f32_16x16x32_bf16 v[164:167], a[164:167], a[52:55], v[164:167]
    ds_read_b64_tr_b16 a[128:129], v48 offset:0
    buffer_load_dwordx4 v17, s[52:55], s83 offen lds
    v_mfma_f32_16x16x32_bf16 v[168:171], a[168:171], a[52:55], v[168:171]
    ds_read_b64_tr_b16 a[130:131], v48 offset:4096
    v_mfma_f32_16x16x32_bf16 v[172:175], a[172:175], a[52:55], v[172:175]
    ds_read_b64_tr_b16 a[132:133], v49 offset:0
    v_mfma_f32_16x16x32_bf16 v[176:179], a[176:179], a[52:55], v[176:179]
    ds_read_b64_tr_b16 a[134:135], v49 offset:4096
    v_mfma_f32_16x16x32_bf16 v[180:183], a[180:183], a[52:55], v[180:183]
    ds_read_b64_tr_b16 a[136:137], v50 offset:0
    buffer_load_dwordx4 v18, s[52:55], s83 offen offset:1024 lds
    v_mfma_f32_16x16x32_bf16 v[184:187], a[184:187], a[52:55], v[184:187]
    ds_read_b64_tr_b16 a[138:139], v50 offset:4096
    v_mfma_f32_16x16x32_bf16 v[188:191], a[188:191], a[52:55], v[188:191]
    ds_read_b64_tr_b16 a[140:141], v51 offset:0
    s_waitcnt vmcnt(51)
    v_mfma_f32_16x16x32_bf16 v[192:195], a[160:163], a[56:59], v[192:195]
    ds_read_b64_tr_b16 a[142:143], v51 offset:4096
    v_mfma_f32_16x16x32_bf16 v[196:199], a[164:167], a[56:59], v[196:199]
    ds_read_b64_tr_b16 a[144:145], v52 offset:0
    v_mfma_f32_16x16x32_bf16 v[200:203], a[168:171], a[56:59], v[200:203]
    ds_read_b64_tr_b16 a[146:147], v52 offset:4096
    v_mfma_f32_16x16x32_bf16 v[204:207], a[172:175], a[56:59], v[204:207]
    ds_read_b64_tr_b16 a[148:149], v53 offset:0
    v_mfma_f32_16x16x32_bf16 v[208:211], a[176:179], a[56:59], v[208:211]
    ds_read_b64_tr_b16 a[150:151], v53 offset:4096
    v_cvt_pk_bf16_f32 v160, v160, v161
    v_cvt_pk_bf16_f32 v161, v162, v163
    v_mfma_f32_16x16x32_bf16 v[212:215], a[180:183], a[56:59], v[212:215]
    ds_read_b64_tr_b16 a[152:153], v54 offset:0
    v_cvt_pk_bf16_f32 v162, v164, v165
    v_cvt_pk_bf16_f32 v163, v166, v167
    v_mfma_f32_16x16x32_bf16 v[216:219], a[184:187], a[56:59], v[216:219]
    ds_read_b64_tr_b16 a[154:155], v54 offset:4096
    buffer_store_dwordx4 v[160:163], v16, s[56:59], s70 offen offset:0 sc1
    v_mfma_f32_16x16x32_bf16 v[220:223], a[188:191], a[56:59], v[220:223]
    s_waitcnt vmcnt(51)
    v_mfma_f32_16x16x32_bf16 v[224:227], a[160:163], a[60:63], v[224:227]
    v_mfma_f32_16x16x32_bf16 v[228:231], a[164:167], a[60:63], v[228:231]
    v_cvt_pk_bf16_f32 v168, v168, v169
    v_cvt_pk_bf16_f32 v169, v170, v171
    v_mfma_f32_16x16x32_bf16 v[232:235], a[168:171], a[60:63], v[232:235]
    v_add_u32 v8, s88, v8
    v_cvt_pk_bf16_f32 v170, v172, v173
    v_cvt_pk_bf16_f32 v171, v174, v175
    v_mfma_f32_16x16x32_bf16 v[236:239], a[172:175], a[60:63], v[236:239]
    v_add_u32 v9, s88, v9
    buffer_store_dwordx4 v[168:171], v16, s[56:59], s70 offen offset:1024 sc1
    v_mfma_f32_16x16x32_bf16 v[240:243], a[176:179], a[60:63], v[240:243]
    v_add_u32 v10, s88, v10
    v_mfma_f32_16x16x32_bf16 v[244:247], a[180:183], a[60:63], v[244:247]
    v_add_u32 v11, s88, v11
    v_mfma_f32_16x16x32_bf16 v[248:251], a[184:187], a[60:63], v[248:251]
    v_add_u32 v12, s88, v12
    v_cvt_pk_bf16_f32 v176, v176, v177
    v_cvt_pk_bf16_f32 v177, v178, v179
    v_mfma_f32_16x16x32_bf16 v[252:255], a[188:191], a[60:63], v[252:255]
    v_add_u32 v13, s88, v13
    v_cvt_pk_bf16_f32 v178, v180, v181
    v_cvt_pk_bf16_f32 v179, v182, v183
    v_mfma_f32_16x16x32_bf16 v[128:131], a[160:163], a[48:51], v[128:131]
    v_add_u32 v14, s88, v14
    buffer_store_dwordx4 v[176:179], v16, s[56:59], s70 offen offset:2048 sc1
    v_mfma_f32_16x16x32_bf16 v[132:135], a[164:167], a[48:51], v[132:135]
    v_add_u32 v15, s88, v15
    v_mfma_f32_16x16x32_bf16 v[136:139], a[168:171], a[48:51], v[136:139]
    v_mfma_f32_16x16x32_bf16 v[140:143], a[172:175], a[48:51], v[140:143]
    v_cvt_pk_bf16_f32 v184, v184, v185
    v_cvt_pk_bf16_f32 v185, v186, v187
    v_mfma_f32_16x16x32_bf16 v[144:147], a[176:179], a[48:51], v[144:147]
    v_cvt_pk_bf16_f32 v186, v188, v189
    v_cvt_pk_bf16_f32 v187, v190, v191
    v_mfma_f32_16x16x32_bf16 v[148:151], a[180:183], a[48:51], v[148:151]
    buffer_store_dwordx4 v[184:187], v16, s[56:59], s70 offen offset:3072 sc1
    v_mfma_f32_16x16x32_bf16 v[152:155], a[184:187], a[48:51], v[152:155]
    v_mfma_f32_16x16x32_bf16 v[156:159], a[188:191], a[48:51], v[156:159]
    s_waitcnt vmcnt(51) lgkmcnt(12)
    v_mfma_f32_16x16x32_bf16 v[96:99], a[128:131], a[64:67], 0
    ds_read_b64_tr_b16 a[156:157], v55 offset:0
    v_cvt_pk_bf16_f32 v192, v192, v193
    v_cvt_pk_bf16_f32 v193, v194, v195
    s_waitcnt vmcnt(50)
    v_mfma_f32_16x16x32_bf16 a[192:195], a[128:131], a[68:71], 0
    ds_read_b64_tr_b16 a[158:159], v55 offset:4096
    v_cvt_pk_bf16_f32 v194, v196, v197
    v_cvt_pk_bf16_f32 v195, v198, v199
    s_waitcnt lgkmcnt(12)
    v_mfma_f32_16x16x32_bf16 v[100:103], a[132:135], a[64:67], 0
    ds_read_b64_tr_b16 a[160:161], v48 offset:16384
    buffer_store_dwordx4 v[192:195], v16, s[56:59], s71 offen offset:0 sc1
    v_mfma_f32_16x16x32_bf16 a[196:199], a[132:135], a[68:71], 0
    ds_read_b64_tr_b16 a[162:163], v48 offset:20480
    s_waitcnt lgkmcnt(12)
    v_mfma_f32_16x16x32_bf16 v[104:107], a[136:139], a[64:67], 0
    ds_read_b64_tr_b16 a[164:165], v49 offset:16384
    v_mfma_f32_16x16x32_bf16 a[200:203], a[136:139], a[68:71], 0
    ds_read_b64_tr_b16 a[166:167], v49 offset:20480
    v_cvt_pk_bf16_f32 v200, v200, v201
    v_cvt_pk_bf16_f32 v201, v202, v203
    s_waitcnt lgkmcnt(12)
    v_mfma_f32_16x16x32_bf16 v[108:111], a[140:143], a[64:67], 0
    ds_read_b64_tr_b16 a[168:169], v50 offset:16384
    v_cvt_pk_bf16_f32 v202, v204, v205
    v_cvt_pk_bf16_f32 v203, v206, v207
    v_mfma_f32_16x16x32_bf16 a[204:207], a[140:143], a[68:71], 0
    ds_read_b64_tr_b16 a[170:171], v50 offset:20480
    buffer_store_dwordx4 v[200:203], v16, s[56:59], s71 offen offset:1024 sc1
    s_waitcnt lgkmcnt(12)
    v_mfma_f32_16x16x32_bf16 v[112:115], a[144:147], a[64:67], 0
    ds_read_b64_tr_b16 a[172:173], v51 offset:16384
    v_mfma_f32_16x16x32_bf16 a[208:211], a[144:147], a[68:71], 0
    ds_read_b64_tr_b16 a[174:175], v51 offset:20480
    s_waitcnt lgkmcnt(12)
    v_mfma_f32_16x16x32_bf16 v[116:119], a[148:151], a[64:67], 0
    ds_read_b64_tr_b16 a[176:177], v52 offset:16384
    v_cvt_pk_bf16_f32 v208, v208, v209
    v_cvt_pk_bf16_f32 v209, v210, v211
    v_mfma_f32_16x16x32_bf16 a[212:215], a[148:151], a[68:71], 0
    ds_read_b64_tr_b16 a[178:179], v52 offset:20480
    v_cvt_pk_bf16_f32 v210, v212, v213
    v_cvt_pk_bf16_f32 v211, v214, v215
    s_waitcnt lgkmcnt(12)
    v_mfma_f32_16x16x32_bf16 v[120:123], a[152:155], a[64:67], 0
    ds_read_b64_tr_b16 a[180:181], v53 offset:16384
    buffer_store_dwordx4 v[208:211], v16, s[56:59], s71 offen offset:2048 sc1
    v_mfma_f32_16x16x32_bf16 a[216:219], a[152:155], a[68:71], 0
    ds_read_b64_tr_b16 a[182:183], v53 offset:20480
    s_waitcnt lgkmcnt(12)
    v_mfma_f32_16x16x32_bf16 v[124:127], a[156:159], a[64:67], 0
    ds_read_b64_tr_b16 a[184:185], v54 offset:16384
    v_mfma_f32_16x16x32_bf16 a[220:223], a[156:159], a[68:71], 0
    ds_read_b64_tr_b16 a[186:187], v54 offset:20480
    v_cvt_pk_bf16_f32 v216, v216, v217
    v_cvt_pk_bf16_f32 v217, v218, v219
    s_waitcnt vmcnt(52) lgkmcnt(12)
    v_mfma_f32_16x16x32_bf16 v[96:99], a[160:163], a[72:75], v[96:99]
    ds_read_b64_tr_b16 a[188:189], v55 offset:16384
    v_cvt_pk_bf16_f32 v218, v220, v221
    v_cvt_pk_bf16_f32 v219, v222, v223
    s_waitcnt vmcnt(51)
    v_mfma_f32_16x16x32_bf16 a[192:195], a[160:163], a[76:79], a[192:195]
    ds_read_b64_tr_b16 a[190:191], v55 offset:20480
    buffer_store_dwordx4 v[216:219], v16, s[56:59], s71 offen offset:3072 sc1
    s_waitcnt lgkmcnt(12)
    v_mfma_f32_16x16x32_bf16 v[100:103], a[164:167], a[72:75], v[100:103]
    ds_read_b64_tr_b16 a[128:129], v48 offset:32768
    v_mfma_f32_16x16x32_bf16 a[196:199], a[164:167], a[76:79], a[196:199]
    ds_read_b64_tr_b16 a[130:131], v48 offset:36864
    s_waitcnt lgkmcnt(12)
    v_mfma_f32_16x16x32_bf16 v[104:107], a[168:171], a[72:75], v[104:107]
    ds_read_b64_tr_b16 a[132:133], v49 offset:32768
    v_mfma_f32_16x16x32_bf16 a[200:203], a[168:171], a[76:79], a[200:203]
    ds_read_b64_tr_b16 a[134:135], v49 offset:36864
    s_waitcnt lgkmcnt(12)
    v_mfma_f32_16x16x32_bf16 v[108:111], a[172:175], a[72:75], v[108:111]
    ds_read_b64_tr_b16 a[136:137], v50 offset:32768
    v_mfma_f32_16x16x32_bf16 a[204:207], a[172:175], a[76:79], a[204:207]
    ds_read_b64_tr_b16 a[138:139], v50 offset:36864
    s_waitcnt lgkmcnt(12)
    v_mfma_f32_16x16x32_bf16 v[112:115], a[176:179], a[72:75], v[112:115]
    ds_read_b64_tr_b16 a[140:141], v51 offset:32768
    v_mfma_f32_16x16x32_bf16 a[208:211], a[176:179], a[76:79], a[208:211]
    ds_read_b64_tr_b16 a[142:143], v51 offset:36864
    v_cvt_pk_bf16_f32 v224, v224, v225
    v_cvt_pk_bf16_f32 v225, v226, v227
    s_waitcnt lgkmcnt(12)
    v_mfma_f32_16x16x32_bf16 v[116:119], a[180:183], a[72:75], v[116:119]
    ds_read_b64_tr_b16 a[144:145], v52 offset:32768
    v_cvt_pk_bf16_f32 v226, v228, v229
    v_cvt_pk_bf16_f32 v227, v230, v231
    v_mfma_f32_16x16x32_bf16 a[212:215], a[180:183], a[76:79], a[212:215]
    ds_read_b64_tr_b16 a[146:147], v52 offset:36864
    buffer_store_dwordx4 v[224:227], v16, s[56:59], s72 offen offset:0 sc1
    s_waitcnt lgkmcnt(12)
    v_mfma_f32_16x16x32_bf16 v[120:123], a[184:187], a[72:75], v[120:123]
    ds_read_b64_tr_b16 a[148:149], v53 offset:32768
    v_mfma_f32_16x16x32_bf16 a[216:219], a[184:187], a[76:79], a[216:219]
    ds_read_b64_tr_b16 a[150:151], v53 offset:36864
    s_waitcnt lgkmcnt(12)
    v_mfma_f32_16x16x32_bf16 v[124:127], a[188:191], a[72:75], v[124:127]
    ds_read_b64_tr_b16 a[152:153], v54 offset:32768
    v_mfma_f32_16x16x32_bf16 a[220:223], a[188:191], a[76:79], a[220:223]
    ds_read_b64_tr_b16 a[154:155], v54 offset:36864
    s_waitcnt vmcnt(28)
    s_barrier
    s_waitcnt lgkmcnt(12)
    v_mfma_f32_16x16x32_bf16 v[96:99], a[128:131], a[80:83], v[96:99]
    ds_read_b64_tr_b16 a[156:157], v55 offset:32768
    v_mfma_f32_16x16x32_bf16 a[192:195], a[128:131], a[84:87], a[192:195]
    ds_read_b64_tr_b16 a[158:159], v55 offset:36864
    s_waitcnt lgkmcnt(12)
    v_mfma_f32_16x16x32_bf16 v[100:103], a[132:135], a[80:83], v[100:103]
    ds_read_b64_tr_b16 a[160:161], v48 offset:49152
    v_mfma_f32_16x16x32_bf16 a[196:199], a[132:135], a[84:87], a[196:199]
    ds_read_b64_tr_b16 a[162:163], v48 offset:53248
    v_cvt_pk_bf16_f32 v232, v232, v233
    v_cvt_pk_bf16_f32 v233, v234, v235
    s_waitcnt lgkmcnt(12)
    v_mfma_f32_16x16x32_bf16 v[104:107], a[136:139], a[80:83], v[104:107]
    ds_read_b64_tr_b16 a[164:165], v49 offset:49152
    v_cvt_pk_bf16_f32 v234, v236, v237
    v_cvt_pk_bf16_f32 v235, v238, v239
    v_mfma_f32_16x16x32_bf16 a[200:203], a[136:139], a[84:87], a[200:203]
    ds_read_b64_tr_b16 a[166:167], v49 offset:53248
    buffer_store_dwordx4 v[232:235], v16, s[56:59], s72 offen offset:1024 sc1
    s_waitcnt lgkmcnt(12)
    v_mfma_f32_16x16x32_bf16 v[108:111], a[140:143], a[80:83], v[108:111]
    ds_read_b64_tr_b16 a[168:169], v50 offset:49152
    v_mfma_f32_16x16x32_bf16 a[204:207], a[140:143], a[84:87], a[204:207]
    ds_read_b64_tr_b16 a[170:171], v50 offset:53248
    s_waitcnt lgkmcnt(12)
    v_mfma_f32_16x16x32_bf16 v[112:115], a[144:147], a[80:83], v[112:115]
    ds_read_b64_tr_b16 a[172:173], v51 offset:49152
    v_mfma_f32_16x16x32_bf16 a[208:211], a[144:147], a[84:87], a[208:211]
    ds_read_b64_tr_b16 a[174:175], v51 offset:53248
    s_waitcnt lgkmcnt(12)
    v_mfma_f32_16x16x32_bf16 v[116:119], a[148:151], a[80:83], v[116:119]
    ds_read_b64_tr_b16 a[176:177], v52 offset:49152
    v_mfma_f32_16x16x32_bf16 a[212:215], a[148:151], a[84:87], a[212:215]
    ds_read_b64_tr_b16 a[178:179], v52 offset:53248
    s_waitcnt lgkmcnt(12)
    v_mfma_f32_16x16x32_bf16 v[120:123], a[152:155], a[80:83], v[120:123]
    ds_read_b64_tr_b16 a[180:181], v53 offset:49152
    v_mfma_f32_16x16x32_bf16 a[216:219], a[152:155], a[84:87], a[216:219]
    ds_read_b64_tr_b16 a[182:183], v53 offset:53248
    v_cvt_pk_bf16_f32 v240, v240, v241
    v_cvt_pk_bf16_f32 v241, v242, v243
    s_waitcnt lgkmcnt(12)
    v_mfma_f32_16x16x32_bf16 v[124:127], a[156:159], a[80:83], v[124:127]
    ds_read_b64_tr_b16 a[184:185], v54 offset:49152
    v_cvt_pk_bf16_f32 v242, v244, v245
    v_cvt_pk_bf16_f32 v243, v246, v247
    v_mfma_f32_16x16x32_bf16 a[220:223], a[156:159], a[84:87], a[220:223]
    ds_read_b64_tr_b16 a[186:187], v54 offset:53248
    buffer_store_dwordx4 v[240:243], v16, s[56:59], s72 offen offset:2048 sc1
    s_waitcnt lgkmcnt(12)
    v_mfma_f32_16x16x32_bf16 v[96:99], a[160:163], a[88:91], v[96:99]
    ds_read_b64_tr_b16 a[188:189], v55 offset:49152
    v_mfma_f32_16x16x32_bf16 a[192:195], a[160:163], a[92:95], a[192:195]
    ds_read_b64_tr_b16 a[190:191], v55 offset:53248
    s_waitcnt lgkmcnt(12)
    v_mfma_f32_16x16x32_bf16 v[100:103], a[164:167], a[88:91], v[100:103]
    ds_read_b64_tr_b16 a[128:129], v56 offset:0
    v_mfma_f32_16x16x32_bf16 a[196:199], a[164:167], a[92:95], a[196:199]
    ds_read_b64_tr_b16 a[130:131], v56 offset:4096
    s_waitcnt lgkmcnt(12)
    v_mfma_f32_16x16x32_bf16 v[104:107], a[168:171], a[88:91], v[104:107]
    ds_read_b64_tr_b16 a[132:133], v57 offset:0
    v_mfma_f32_16x16x32_bf16 a[200:203], a[168:171], a[92:95], a[200:203]
    ds_read_b64_tr_b16 a[134:135], v57 offset:4096
    s_waitcnt lgkmcnt(12)
    v_mfma_f32_16x16x32_bf16 v[108:111], a[172:175], a[88:91], v[108:111]
    ds_read_b64_tr_b16 a[136:137], v58 offset:0
    v_mfma_f32_16x16x32_bf16 a[204:207], a[172:175], a[92:95], a[204:207]
    ds_read_b64_tr_b16 a[138:139], v58 offset:4096
    v_cvt_pk_bf16_f32 v248, v248, v249
    v_cvt_pk_bf16_f32 v249, v250, v251
    s_waitcnt lgkmcnt(12)
    v_mfma_f32_16x16x32_bf16 v[112:115], a[176:179], a[88:91], v[112:115]
    ds_read_b64_tr_b16 a[140:141], v59 offset:0
    v_cvt_pk_bf16_f32 v250, v252, v253
    v_cvt_pk_bf16_f32 v251, v254, v255
    s_mov_b32 s82, 1310720
    s_add_u32 m0, s3, 65536
    s_nop 0
    buffer_load_dwordx4 v17, s[52:55], s82 offen lds
    v_mfma_f32_16x16x32_bf16 a[208:211], a[176:179], a[92:95], a[208:211]
    ds_read_b64_tr_b16 a[142:143], v59 offset:4096
    buffer_store_dwordx4 v[248:251], v16, s[56:59], s72 offen offset:3072 sc1
    s_waitcnt lgkmcnt(12)
    v_mfma_f32_16x16x32_bf16 v[116:119], a[180:183], a[88:91], v[116:119]
    ds_read_b64_tr_b16 a[144:145], v60 offset:0
    v_mfma_f32_16x16x32_bf16 a[212:215], a[180:183], a[92:95], a[212:215]
    ds_read_b64_tr_b16 a[146:147], v60 offset:4096
    s_waitcnt lgkmcnt(12)
    v_mfma_f32_16x16x32_bf16 v[120:123], a[184:187], a[88:91], v[120:123]
    ds_read_b64_tr_b16 a[148:149], v61 offset:0
    v_mfma_f32_16x16x32_bf16 a[216:219], a[184:187], a[92:95], a[216:219]
    ds_read_b64_tr_b16 a[150:151], v61 offset:4096
    buffer_load_dwordx4 v18, s[52:55], s82 offen offset:1024 lds
    s_waitcnt lgkmcnt(12)
    v_mfma_f32_16x16x32_bf16 v[124:127], a[188:191], a[88:91], v[124:127]
    ds_read_b64_tr_b16 a[152:153], v62 offset:0
    v_mfma_f32_16x16x32_bf16 a[220:223], a[188:191], a[92:95], a[220:223]
    ds_read_b64_tr_b16 a[154:155], v62 offset:4096
    s_barrier
    s_waitcnt lgkmcnt(12)
    v_mfma_f32_16x16x32_bf16 v[96:99], a[128:131], a[96:99], v[96:99]
    ds_read_b64_tr_b16 a[156:157], v63 offset:0
    v_mfma_f32_16x16x32_bf16 a[192:195], a[128:131], a[100:103], a[192:195]
    ds_read_b64_tr_b16 a[158:159], v63 offset:4096
    s_waitcnt lgkmcnt(12)
    v_mfma_f32_16x16x32_bf16 v[100:103], a[132:135], a[96:99], v[100:103]
    ds_read_b64_tr_b16 a[160:161], v56 offset:16384
    s_mov_b32 s83, 1376256
    s_add_u32 m0, s3, 73728
    s_nop 0
    buffer_load_dwordx4 v17, s[52:55], s83 offen lds
    v_mfma_f32_16x16x32_bf16 a[196:199], a[132:135], a[100:103], a[196:199]
    ds_read_b64_tr_b16 a[162:163], v56 offset:20480
    s_waitcnt lgkmcnt(12)
    v_mfma_f32_16x16x32_bf16 v[104:107], a[136:139], a[96:99], v[104:107]
    ds_read_b64_tr_b16 a[164:165], v57 offset:16384
    v_mfma_f32_16x16x32_bf16 a[200:203], a[136:139], a[100:103], a[200:203]
    ds_read_b64_tr_b16 a[166:167], v57 offset:20480
    s_waitcnt lgkmcnt(12)
    v_mfma_f32_16x16x32_bf16 v[108:111], a[140:143], a[96:99], v[108:111]
    ds_read_b64_tr_b16 a[168:169], v58 offset:16384
    v_mfma_f32_16x16x32_bf16 a[204:207], a[140:143], a[100:103], a[204:207]
    ds_read_b64_tr_b16 a[170:171], v58 offset:20480
    buffer_load_dwordx4 v18, s[52:55], s83 offen offset:1024 lds
    s_waitcnt lgkmcnt(12)
    v_mfma_f32_16x16x32_bf16 v[112:115], a[144:147], a[96:99], v[112:115]
    ds_read_b64_tr_b16 a[172:173], v59 offset:16384
    v_mfma_f32_16x16x32_bf16 a[208:211], a[144:147], a[100:103], a[208:211]
    ds_read_b64_tr_b16 a[174:175], v59 offset:20480
    s_waitcnt lgkmcnt(12)
    v_mfma_f32_16x16x32_bf16 v[116:119], a[148:151], a[96:99], v[116:119]
    ds_read_b64_tr_b16 a[176:177], v60 offset:16384
    v_mfma_f32_16x16x32_bf16 a[212:215], a[148:151], a[100:103], a[212:215]
    ds_read_b64_tr_b16 a[178:179], v60 offset:20480
    s_waitcnt lgkmcnt(12)
    v_mfma_f32_16x16x32_bf16 v[120:123], a[152:155], a[96:99], v[120:123]
    ds_read_b64_tr_b16 a[180:181], v61 offset:16384
    s_mov_b32 s82, 1441792
    s_add_u32 m0, s3, 81920
    s_nop 0
    buffer_load_dwordx4 v17, s[52:55], s82 offen lds
    v_mfma_f32_16x16x32_bf16 a[216:219], a[152:155], a[100:103], a[216:219]
    ds_read_b64_tr_b16 a[182:183], v61 offset:20480
    s_waitcnt lgkmcnt(12)
    v_mfma_f32_16x16x32_bf16 v[124:127], a[156:159], a[96:99], v[124:127]
    ds_read_b64_tr_b16 a[184:185], v62 offset:16384
    v_mfma_f32_16x16x32_bf16 a[220:223], a[156:159], a[100:103], a[220:223]
    ds_read_b64_tr_b16 a[186:187], v62 offset:20480
    s_waitcnt lgkmcnt(12)
    v_mfma_f32_16x16x32_bf16 v[96:99], a[160:163], a[104:107], v[96:99]
    ds_read_b64_tr_b16 a[188:189], v63 offset:16384
    v_mfma_f32_16x16x32_bf16 a[192:195], a[160:163], a[108:111], a[192:195]
    ds_read_b64_tr_b16 a[190:191], v63 offset:20480
    buffer_load_dwordx4 v18, s[52:55], s82 offen offset:1024 lds
    s_waitcnt lgkmcnt(12)
    v_mfma_f32_16x16x32_bf16 v[100:103], a[164:167], a[104:107], v[100:103]
    ds_read_b64_tr_b16 a[128:129], v8 offset:0
    v_mfma_f32_16x16x32_bf16 a[196:199], a[164:167], a[108:111], a[196:199]
    ds_read_b64_tr_b16 a[130:131], v8 offset:4096
    s_waitcnt lgkmcnt(12)
    v_mfma_f32_16x16x32_bf16 v[104:107], a[168:171], a[104:107], v[104:107]
    ds_read_b64_tr_b16 a[132:133], v9 offset:0
    v_mfma_f32_16x16x32_bf16 a[200:203], a[168:171], a[108:111], a[200:203]
    ds_read_b64_tr_b16 a[134:135], v9 offset:4096
    s_waitcnt lgkmcnt(12)
    v_mfma_f32_16x16x32_bf16 v[108:111], a[172:175], a[104:107], v[108:111]
    ds_read_b64_tr_b16 a[136:137], v10 offset:0
    s_mov_b32 s83, 1507328
    s_add_u32 m0, s3, 90112
    s_nop 0
    buffer_load_dwordx4 v17, s[52:55], s83 offen lds
    v_mfma_f32_16x16x32_bf16 a[204:207], a[172:175], a[108:111], a[204:207]
    ds_read_b64_tr_b16 a[138:139], v10 offset:4096
    s_waitcnt lgkmcnt(12)
    v_mfma_f32_16x16x32_bf16 v[112:115], a[176:179], a[104:107], v[112:115]
    ds_read_b64_tr_b16 a[140:141], v11 offset:0
    v_mfma_f32_16x16x32_bf16 a[208:211], a[176:179], a[108:111], a[208:211]
    ds_read_b64_tr_b16 a[142:143], v11 offset:4096
    s_waitcnt lgkmcnt(12)
    v_mfma_f32_16x16x32_bf16 v[116:119], a[180:183], a[104:107], v[116:119]
    ds_read_b64_tr_b16 a[144:145], v12 offset:0
    v_mfma_f32_16x16x32_bf16 a[212:215], a[180:183], a[108:111], a[212:215]
    ds_read_b64_tr_b16 a[146:147], v12 offset:4096
    buffer_load_dwordx4 v18, s[52:55], s83 offen offset:1024 lds
    s_waitcnt lgkmcnt(12)
    v_mfma_f32_16x16x32_bf16 v[120:123], a[184:187], a[104:107], v[120:123]
    ds_read_b64_tr_b16 a[148:149], v13 offset:0
    v_mfma_f32_16x16x32_bf16 a[216:219], a[184:187], a[108:111], a[216:219]
    ds_read_b64_tr_b16 a[150:151], v13 offset:4096
    s_waitcnt lgkmcnt(12)
    v_mfma_f32_16x16x32_bf16 v[124:127], a[188:191], a[104:107], v[124:127]
    ds_read_b64_tr_b16 a[152:153], v14 offset:0
    v_mfma_f32_16x16x32_bf16 a[220:223], a[188:191], a[108:111], a[220:223]
    ds_read_b64_tr_b16 a[154:155], v14 offset:4096
    s_waitcnt vmcnt(20)
    s_barrier
    s_waitcnt lgkmcnt(12)
    v_mfma_f32_16x16x32_bf16 v[96:99], a[128:131], a[112:115], v[96:99]
    ds_read_b64_tr_b16 a[156:157], v15 offset:0
    s_mov_b32 s82, 1572864
    s_add_u32 m0, s3, 98304
    s_nop 0
    buffer_load_dwordx4 v17, s[52:55], s82 offen lds
    v_mfma_f32_16x16x32_bf16 a[192:195], a[128:131], a[116:119], a[192:195]
    ds_read_b64_tr_b16 a[158:159], v15 offset:4096
    s_waitcnt lgkmcnt(12)
    v_mfma_f32_16x16x32_bf16 v[100:103], a[132:135], a[112:115], v[100:103]
    ds_read_b64_tr_b16 a[160:161], v8 offset:16384
    v_mfma_f32_16x16x32_bf16 a[196:199], a[132:135], a[116:119], a[196:199]
    ds_read_b64_tr_b16 a[162:163], v8 offset:20480
    s_waitcnt lgkmcnt(12)
    v_mfma_f32_16x16x32_bf16 v[104:107], a[136:139], a[112:115], v[104:107]
    ds_read_b64_tr_b16 a[164:165], v9 offset:16384
    v_mfma_f32_16x16x32_bf16 a[200:203], a[136:139], a[116:119], a[200:203]
    ds_read_b64_tr_b16 a[166:167], v9 offset:20480
    buffer_load_dwordx4 v18, s[52:55], s82 offen offset:1024 lds
    s_waitcnt lgkmcnt(12)
    v_mfma_f32_16x16x32_bf16 v[108:111], a[140:143], a[112:115], v[108:111]
    ds_read_b64_tr_b16 a[168:169], v10 offset:16384
    v_mfma_f32_16x16x32_bf16 a[204:207], a[140:143], a[116:119], a[204:207]
    ds_read_b64_tr_b16 a[170:171], v10 offset:20480
    s_waitcnt lgkmcnt(12)
    v_mfma_f32_16x16x32_bf16 v[112:115], a[144:147], a[112:115], v[112:115]
    ds_read_b64_tr_b16 a[172:173], v11 offset:16384
    v_mfma_f32_16x16x32_bf16 a[208:211], a[144:147], a[116:119], a[208:211]
    ds_read_b64_tr_b16 a[174:175], v11 offset:20480
    s_waitcnt vmcnt(9)
    s_mov_b64 exec, 1
    buffer_atomic_add v25, off, s[56:59], s77 sc1
    s_mov_b64 exec, -1
    s_waitcnt lgkmcnt(12)
    v_mfma_f32_16x16x32_bf16 v[116:119], a[148:151], a[112:115], v[116:119]
    ds_read_b64_tr_b16 a[176:177], v12 offset:16384
    s_mov_b32 s83, 1638400
    s_add_u32 m0, s3, 106496
    s_nop 0
    buffer_load_dwordx4 v17, s[52:55], s83 offen lds
    v_mfma_f32_16x16x32_bf16 a[212:215], a[148:151], a[116:119], a[212:215]
    ds_read_b64_tr_b16 a[178:179], v12 offset:20480
    s_waitcnt lgkmcnt(12)
    v_mfma_f32_16x16x32_bf16 v[120:123], a[152:155], a[112:115], v[120:123]
    ds_read_b64_tr_b16 a[180:181], v13 offset:16384
    v_mfma_f32_16x16x32_bf16 a[216:219], a[152:155], a[116:119], a[216:219]
    ds_read_b64_tr_b16 a[182:183], v13 offset:20480
    s_waitcnt lgkmcnt(12)
    v_mfma_f32_16x16x32_bf16 v[124:127], a[156:159], a[112:115], v[124:127]
    ds_read_b64_tr_b16 a[184:185], v14 offset:16384
    v_mfma_f32_16x16x32_bf16 a[220:223], a[156:159], a[116:119], a[220:223]
    ds_read_b64_tr_b16 a[186:187], v14 offset:20480
    buffer_load_dwordx4 v18, s[52:55], s83 offen offset:1024 lds
    s_waitcnt lgkmcnt(12)
    v_mfma_f32_16x16x32_bf16 v[96:99], a[160:163], a[120:123], v[96:99]
    ds_read_b64_tr_b16 a[188:189], v15 offset:16384
    s_branch L_over12
L_stub12:
    s_branch L_stubret
L_over12:
    v_mfma_f32_16x16x32_bf16 a[192:195], a[160:163], a[124:127], a[192:195]
    ds_read_b64_tr_b16 a[190:191], v15 offset:20480
    s_waitcnt lgkmcnt(12)
    v_mfma_f32_16x16x32_bf16 v[100:103], a[164:167], a[120:123], v[100:103]
    ds_read_b64_tr_b16 a[128:129], v8 offset:32768
    v_mfma_f32_16x16x32_bf16 a[196:199], a[164:167], a[124:127], a[196:199]
    ds_read_b64_tr_b16 a[130:131], v8 offset:36864
    s_waitcnt lgkmcnt(12)
    v_mfma_f32_16x16x32_bf16 v[104:107], a[168:171], a[120:123], v[104:107]
    ds_read_b64_tr_b16 a[132:133], v9 offset:32768
    s_mov_b32 s82, 1703936
    s_add_u32 m0, s3, 114688
    s_nop 0
    buffer_load_dwordx4 v17, s[52:55], s82 offen lds
    v_mfma_f32_16x16x32_bf16 a[200:203], a[168:171], a[124:127], a[200:203]
    ds_read_b64_tr_b16 a[134:135], v9 offset:36864
    s_waitcnt lgkmcnt(12)
    v_mfma_f32_16x16x32_bf16 v[108:111], a[172:175], a[120:123], v[108:111]
    ds_read_b64_tr_b16 a[136:137], v10 offset:32768
    v_mfma_f32_16x16x32_bf16 a[204:207], a[172:175], a[124:127], a[204:207]
    ds_read_b64_tr_b16 a[138:139], v10 offset:36864
    s_waitcnt lgkmcnt(12)
    v_mfma_f32_16x16x32_bf16 v[112:115], a[176:179], a[120:123], v[112:115]
    ds_read_b64_tr_b16 a[140:141], v11 offset:32768
    v_mfma_f32_16x16x32_bf16 a[208:211], a[176:179], a[124:127], a[208:211]
    ds_read_b64_tr_b16 a[142:143], v11 offset:36864
    buffer_load_dwordx4 v18, s[52:55], s82 offen offset:1024 lds
    s_waitcnt lgkmcnt(12)
    v_mfma_f32_16x16x32_bf16 v[116:119], a[180:183], a[120:123], v[116:119]
    ds_read_b64_tr_b16 a[144:145], v12 offset:32768
    v_mfma_f32_16x16x32_bf16 a[212:215], a[180:183], a[124:127], a[212:215]
    ds_read_b64_tr_b16 a[146:147], v12 offset:36864
    s_waitcnt lgkmcnt(12)
    v_mfma_f32_16x16x32_bf16 v[120:123], a[184:187], a[120:123], v[120:123]
    ds_read_b64_tr_b16 a[148:149], v13 offset:32768
    v_mfma_f32_16x16x32_bf16 a[216:219], a[184:187], a[124:127], a[216:219]
    ds_read_b64_tr_b16 a[150:151], v13 offset:36864
    s_waitcnt lgkmcnt(12)
    v_mfma_f32_16x16x32_bf16 v[124:127], a[188:191], a[120:123], v[124:127]
    ds_read_b64_tr_b16 a[152:153], v14 offset:32768
    s_mov_b32 s83, 1769472
    s_add_u32 m0, s3, 122880
    s_nop 0
    buffer_load_dwordx4 v17, s[52:55], s83 offen lds
    v_mfma_f32_16x16x32_bf16 a[220:223], a[188:191], a[124:127], a[220:223]
    ds_read_b64_tr_b16 a[154:155], v14 offset:36864
    s_waitcnt lgkmcnt(12)
    v_mfma_f32_16x16x32_bf16 v[96:99], a[128:131], a[0:3], v[96:99]
    ds_read_b64_tr_b16 a[156:157], v15 offset:32768
    v_mfma_f32_16x16x32_bf16 a[192:195], a[128:131], a[4:7], a[192:195]
    ds_read_b64_tr_b16 a[158:159], v15 offset:36864
    s_waitcnt lgkmcnt(12)
    v_mfma_f32_16x16x32_bf16 v[100:103], a[132:135], a[0:3], v[100:103]
    ds_read_b64_tr_b16 a[160:161], v8 offset:49152
    v_mfma_f32_16x16x32_bf16 a[196:199], a[132:135], a[4:7], a[196:199]
    ds_read_b64_tr_b16 a[162:163], v8 offset:53248
    buffer_load_dwordx4 v18, s[52:55], s83 offen offset:1024 lds
    s_waitcnt lgkmcnt(12)
    v_mfma_f32_16x16x32_bf16 v[104:107], a[136:139], a[0:3], v[104:107]
    ds_read_b64_tr_b16 a[164:165], v9 offset:49152
    v_mfma_f32_16x16x32_bf16 a[200:203], a[136:139], a[4:7], a[200:203]
    ds_read_b64_tr_b16 a[166:167], v9 offset:53248
    s_waitcnt lgkmcnt(12)
    v_mfma_f32_16x16x32_bf16 v[108:111], a[140:143], a[0:3], v[108:111]
    ds_read_b64_tr_b16 a[168:169], v10 offset:49152
    v_mfma_f32_16x16x32_bf16 a[204:207], a[140:143], a[4:7], a[204:207]
    ds_read_b64_tr_b16 a[170:171], v10 offset:53248
    s_waitcnt lgkmcnt(12)
    v_mfma_f32_16x16x32_bf16 v[112:115], a[144:147], a[0:3], v[112:115]
    ds_read_b64_tr_b16 a[172:173], v11 offset:49152
    s_mov_b32 s82, 1835008
    s_add_u32 m0, s3, 131072
    s_nop 0
    buffer_load_dwordx4 v17, s[52:55], s82 offen lds
    v_mfma_f32_16x16x32_bf16 a[208:211], a[144:147], a[4:7], a[208:211]
    ds_read_b64_tr_b16 a[174:175], v11 offset:53248
    s_waitcnt lgkmcnt(12)
    v_mfma_f32_16x16x32_bf16 v[116:119], a[148:151], a[0:3], v[116:119]
    ds_read_b64_tr_b16 a[176:177], v12 offset:49152
    v_mfma_f32_16x16x32_bf16 a[212:215], a[148:151], a[4:7], a[212:215]
    ds_read_b64_tr_b16 a[178:179], v12 offset:53248
    s_waitcnt lgkmcnt(12)
    v_mfma_f32_16x16x32_bf16 v[120:123], a[152:155], a[0:3], v[120:123]
    ds_read_b64_tr_b16 a[180:181], v13 offset:49152
    v_mfma_f32_16x16x32_bf16 a[216:219], a[152:155], a[4:7], a[216:219]
    ds_read_b64_tr_b16 a[182:183], v13 offset:53248
    buffer_load_dwordx4 v18, s[52:55], s82 offen offset:1024 lds
    s_waitcnt lgkmcnt(12)
    v_mfma_f32_16x16x32_bf16 v[124:127], a[156:159], a[0:3], v[124:127]
    ds_read_b64_tr_b16 a[184:185], v14 offset:49152
    v_mfma_f32_16x16x32_bf16 a[220:223], a[156:159], a[4:7], a[220:223]
    ds_read_b64_tr_b16 a[186:187], v14 offset:53248
    s_waitcnt vmcnt(11)
    s_barrier
    s_waitcnt lgkmcnt(12)
    v_mfma_f32_16x16x32_bf16 v[96:99], a[160:163], a[8:11], v[96:99]
    ds_read_b64_tr_b16 a[188:189], v15 offset:49152
    v_mfma_f32_16x16x32_bf16 a[192:195], a[160:163], a[12:15], a[192:195]
    ds_read_b64_tr_b16 a[190:191], v15 offset:53248
    s_waitcnt lgkmcnt(12)
    v_mfma_f32_16x16x32_bf16 v[100:103], a[164:167], a[8:11], v[100:103]
    ds_read_b64_tr_b16 a[128:129], v48 offset:0
    s_mov_b32 s83, 1900544
    s_add_u32 m0, s3, 139264
    s_nop 0
    buffer_load_dwordx4 v17, s[52:55], s83 offen lds
    v_mfma_f32_16x16x32_bf16 a[196:199], a[164:167], a[12:15], a[196:199]
    ds_read_b64_tr_b16 a[130:131], v48 offset:4096
    s_waitcnt lgkmcnt(12)
    v_mfma_f32_16x16x32_bf16 v[104:107], a[168:171], a[8:11], v[104:107]
    ds_read_b64_tr_b16 a[132:133], v49 offset:0
    v_mfma_f32_16x16x32_bf16 a[200:203], a[168:171], a[12:15], a[200:203]
    ds_read_b64_tr_b16 a[134:135], v49 offset:4096
    s_waitcnt lgkmcnt(12)
    v_mfma_f32_16x16x32_bf16 v[108:111], a[172:175], a[8:11], v[108:111]
    ds_read_b64_tr_b16 a[136:137], v50 offset:0
    v_mfma_f32_16x16x32_bf16 a[204:207], a[172:175], a[12:15], a[204:207]
    ds_read_b64_tr_b16 a[138:139], v50 offset:4096
    buffer_load_dwordx4 v18, s[52:55], s83 offen offset:1024 lds
    s_waitcnt lgkmcnt(12)
    v_mfma_f32_16x16x32_bf16 v[112:115], a[176:179], a[8:11], v[112:115]
    ds_read_b64_tr_b16 a[140:141], v51 offset:0
    v_mfma_f32_16x16x32_bf16 a[208:211], a[176:179], a[12:15], a[208:211]
    ds_read_b64_tr_b16 a[142:143], v51 offset:4096
    s_waitcnt lgkmcnt(12)
    v_mfma_f32_16x16x32_bf16 v[116:119], a[180:183], a[8:11], v[116:119]
    ds_read_b64_tr_b16 a[144:145], v52 offset:0
    v_mfma_f32_16x16x32_bf16 a[212:215], a[180:183], a[12:15], a[212:215]
    ds_read_b64_tr_b16 a[146:147], v52 offset:4096
    s_waitcnt lgkmcnt(12)
    v_mfma_f32_16x16x32_bf16 v[120:123], a[184:187], a[8:11], v[120:123]
    ds_read_b64_tr_b16 a[148:149], v53 offset:0
    s_mov_b32 s82, 1966080
    s_add_u32 m0, s3, 147456
    s_nop 0
    buffer_load_dwordx4 v17, s[52:55], s82 offen lds
    v_mfma_f32_16x16x32_bf16 a[216:219], a[184:187], a[12:15], a[216:219]
    ds_read_b64_tr_b16 a[150:151], v53 offset:4096
    s_waitcnt lgkmcnt(12)
    v_mfma_f32_16x16x32_bf16 v[124:127], a[188:191], a[8:11], v[124:127]
    ds_read_b64_tr_b16 a[152:153], v54 offset:0
    v_mfma_f32_16x16x32_bf16 a[220:223], a[188:191], a[12:15], a[220:223]
    ds_read_b64_tr_b16 a[154:155], v54 offset:4096
    s_waitcnt lgkmcnt(12)
    v_mfma_f32_16x16x32_bf16 v[96:99], a[128:131], a[16:19], v[96:99]
    ds_read_b64_tr_b16 a[156:157], v55 offset:0
    v_mfma_f32_16x16x32_bf16 a[192:195], a[128:131], a[20:23], a[192:195]
    ds_read_b64_tr_b16 a[158:159], v55 offset:4096
    buffer_load_dwordx4 v18, s[52:55], s82 offen offset:1024 lds
    s_waitcnt lgkmcnt(12)
    v_mfma_f32_16x16x32_bf16 v[100:103], a[132:135], a[16:19], v[100:103]
    ds_read_b64_tr_b16 a[160:161], v48 offset:16384
    v_mfma_f32_16x16x32_bf16 a[196:199], a[132:135], a[20:23], a[196:199]
    ds_read_b64_tr_b16 a[162:163], v48 offset:20480
    s_waitcnt lgkmcnt(12)
    v_mfma_f32_16x16x32_bf16 v[104:107], a[136:139], a[16:19], v[104:107]
    ds_read_b64_tr_b16 a[164:165], v49 offset:16384
    v_mfma_f32_16x16x32_bf16 a[200:203], a[136:139], a[20:23], a[200:203]
    ds_read_b64_tr_b16 a[166:167], v49 offset:20480
    s_waitcnt lgkmcnt(12)
    v_mfma_f32_16x16x32_bf16 v[108:111], a[140:143], a[16:19], v[108:111]
    ds_read_b64_tr_b16 a[168:169], v50 offset:16384
    s_mov_b32 s83, 2031616
    s_add_u32 m0, s3, 155648
    s_nop 0
    buffer_load_dwordx4 v17, s[52:55], s83 offen lds
    v_mfma_f32_16x16x32_bf16 a[204:207], a[140:143], a[20:23], a[204:207]
    ds_read_b64_tr_b16 a[170:171], v50 offset:20480
    s_waitcnt lgkmcnt(12)
    v_mfma_f32_16x16x32_bf16 v[112:115], a[144:147], a[16:19], v[112:115]
    ds_read_b64_tr_b16 a[172:173], v51 offset:16384
    v_mfma_f32_16x16x32_bf16 a[208:211], a[144:147], a[20:23], a[208:211]
    ds_read_b64_tr_b16 a[174:175], v51 offset:20480
    buffer_load_dwordx4 v18, s[52:55], s83 offen offset:1024 lds
    s_waitcnt lgkmcnt(12)
    v_mfma_f32_16x16x32_bf16 v[116:119], a[148:151], a[16:19], v[116:119]
    ds_read_b64_tr_b16 a[176:177], v52 offset:16384
    v_mfma_f32_16x16x32_bf16 a[212:215], a[148:151], a[20:23], a[212:215]
    ds_read_b64_tr_b16 a[178:179], v52 offset:20480
    s_waitcnt lgkmcnt(12)
    v_mfma_f32_16x16x32_bf16 v[120:123], a[152:155], a[16:19], v[120:123]
    ds_read_b64_tr_b16 a[180:181], v53 offset:16384
    buffer_load_dword v43, off, s[56:59], s77 sc1
    v_mfma_f32_16x16x32_bf16 a[216:219], a[152:155], a[20:23], a[216:219]
    ds_read_b64_tr_b16 a[182:183], v53 offset:20480
    s_waitcnt lgkmcnt(12)
    v_mfma_f32_16x16x32_bf16 v[124:127], a[156:159], a[16:19], v[124:127]
    ds_read_b64_tr_b16 a[184:185], v54 offset:16384
    v_mfma_f32_16x16x32_bf16 a[220:223], a[156:159], a[20:23], a[220:223]
    ds_read_b64_tr_b16 a[186:187], v54 offset:20480
    s_waitcnt vmcnt(9)
    s_barrier
    s_waitcnt lgkmcnt(12)
    v_mfma_f32_16x16x32_bf16 v[96:99], a[160:163], a[24:27], v[96:99]
    ds_read_b64_tr_b16 a[188:189], v55 offset:16384
    v_mfma_f32_16x16x32_bf16 a[192:195], a[160:163], a[28:31], a[192:195]
    ds_read_b64_tr_b16 a[190:191], v55 offset:20480
    s_waitcnt lgkmcnt(12)
    v_mfma_f32_16x16x32_bf16 v[100:103], a[164:167], a[24:27], v[100:103]
    ds_read_b64_tr_b16 a[128:129], v48 offset:32768
    v_mfma_f32_16x16x32_bf16 a[196:199], a[164:167], a[28:31], a[196:199]
    ds_read_b64_tr_b16 a[130:131], v48 offset:36864
    s_waitcnt lgkmcnt(12)
    v_mfma_f32_16x16x32_bf16 v[104:107], a[168:171], a[24:27], v[104:107]
    ds_read_b64_tr_b16 a[132:133], v49 offset:32768
    v_mfma_f32_16x16x32_bf16 a[200:203], a[168:171], a[28:31], a[200:203]
    ds_read_b64_tr_b16 a[134:135], v49 offset:36864
    s_waitcnt lgkmcnt(12)
    v_mfma_f32_16x16x32_bf16 v[108:111], a[172:175], a[24:27], v[108:111]
    ds_read_b64_tr_b16 a[136:137], v50 offset:32768
    v_mfma_f32_16x16x32_bf16 a[204:207], a[172:175], a[28:31], a[204:207]
    ds_read_b64_tr_b16 a[138:139], v50 offset:36864
    s_waitcnt lgkmcnt(12)
    v_mfma_f32_16x16x32_bf16 v[112:115], a[176:179], a[24:27], v[112:115]
    ds_read_b64_tr_b16 a[140:141], v51 offset:32768
    v_mfma_f32_16x16x32_bf16 a[208:211], a[176:179], a[28:31], a[208:211]
    ds_read_b64_tr_b16 a[142:143], v51 offset:36864
    s_waitcnt lgkmcnt(12)
    v_mfma_f32_16x16x32_bf16 v[116:119], a[180:183], a[24:27], v[116:119]
    ds_read_b64_tr_b16 a[144:145], v52 offset:32768
    v_mfma_f32_16x16x32_bf16 a[212:215], a[180:183], a[28:31], a[212:215]
    ds_read_b64_tr_b16 a[146:147], v52 offset:36864
    s_waitcnt lgkmcnt(12)
    v_mfma_f32_16x16x32_bf16 v[120:123], a[184:187], a[24:27], v[120:123]
    ds_read_b64_tr_b16 a[148:149], v53 offset:32768
    v_mfma_f32_16x16x32_bf16 a[216:219], a[184:187], a[28:31], a[216:219]
    ds_read_b64_tr_b16 a[150:151], v53 offset:36864
    s_waitcnt lgkmcnt(12)
    v_mfma_f32_16x16x32_bf16 v[124:127], a[188:191], a[24:27], v[124:127]
    ds_read_b64_tr_b16 a[152:153], v54 offset:32768
    v_mfma_f32_16x16x32_bf16 a[220:223], a[188:191], a[28:31], a[220:223]
    ds_read_b64_tr_b16 a[154:155], v54 offset:36864
    s_waitcnt lgkmcnt(12)
    v_mfma_f32_16x16x32_bf16 v[96:99], a[128:131], a[224:227], v[96:99]
    ds_read_b64_tr_b16 a[156:157], v55 offset:32768
    v_mfma_f32_16x16x32_bf16 a[192:195], a[128:131], a[228:231], a[192:195]
    ds_read_b64_tr_b16 a[158:159], v55 offset:36864
    s_waitcnt lgkmcnt(12)
    v_mfma_f32_16x16x32_bf16 v[100:103], a[132:135], a[224:227], v[100:103]
    ds_read_b64_tr_b16 a[160:161], v48 offset:49152
    v_mfma_f32_16x16x32_bf16 a[196:199], a[132:135], a[228:231], a[196:199]
    ds_read_b64_tr_b16 a[162:163], v48 offset:53248
    s_waitcnt lgkmcnt(12)
    v_mfma_f32_16x16x32_bf16 v[104:107], a[136:139], a[224:227], v[104:107]
    ds_read_b64_tr_b16 a[164:165], v49 offset:49152
    v_mfma_f32_16x16x32_bf16 a[200:203], a[136:139], a[228:231], a[200:203]
    ds_read_b64_tr_b16 a[166:167], v49 offset:53248
    s_waitcnt lgkmcnt(12)
    v_mfma_f32_16x16x32_bf16 v[108:111], a[140:143], a[224:227], v[108:111]
    ds_read_b64_tr_b16 a[168:169], v50 offset:49152
    v_mfma_f32_16x16x32_bf16 a[204:207], a[140:143], a[228:231], a[204:207]
    ds_read_b64_tr_b16 a[170:171], v50 offset:53248
    s_waitcnt lgkmcnt(12)
    v_mfma_f32_16x16x32_bf16 v[112:115], a[144:147], a[224:227], v[112:115]
    ds_read_b64_tr_b16 a[172:173], v51 offset:49152
    v_mfma_f32_16x16x32_bf16 a[208:211], a[144:147], a[228:231], a[208:211]
    ds_read_b64_tr_b16 a[174:175], v51 offset:53248
    s_waitcnt lgkmcnt(12)
    v_mfma_f32_16x16x32_bf16 v[116:119], a[148:151], a[224:227], v[116:119]
    ds_read_b64_tr_b16 a[176:177], v52 offset:49152
    v_mfma_f32_16x16x32_bf16 a[212:215], a[148:151], a[228:231], a[212:215]
    ds_read_b64_tr_b16 a[178:179], v52 offset:53248
    s_waitcnt lgkmcnt(12)
    v_mfma_f32_16x16x32_bf16 v[120:123], a[152:155], a[224:227], v[120:123]
    ds_read_b64_tr_b16 a[180:181], v53 offset:49152
    v_mfma_f32_16x16x32_bf16 a[216:219], a[152:155], a[228:231], a[216:219]
    ds_read_b64_tr_b16 a[182:183], v53 offset:53248
    s_waitcnt vmcnt(0)
    v_readfirstlane_b32 s86, v43
    s_or_b32 s86, s86, s90
    s_cmp_eq_u32 s86, 0x01010101
    s_cbranch_scc0 L_spP
L_okP:
    buffer_load_dwordx4 v[164:167], v16, s[56:59], s73 offen offset:0 sc1
    s_waitcnt lgkmcnt(12)
    v_mfma_f32_16x16x32_bf16 v[124:127], a[156:159], a[224:227], v[124:127]
    ds_read_b64_tr_b16 a[184:185], v54 offset:49152
    buffer_load_dwordx4 v[196:199], v16, s[56:59], s74 offen offset:0 sc1
    v_mfma_f32_16x16x32_bf16 a[220:223], a[156:159], a[228:231], a[220:223]
    ds_read_b64_tr_b16 a[186:187], v54 offset:53248
    buffer_load_dwordx4 v[228:231], v16, s[56:59], s75 offen offset:0 sc1
    s_barrier
    s_waitcnt lgkmcnt(12)
    v_mfma_f32_16x16x32_bf16 v[96:99], a[160:163], a[232:235], v[96:99]
    ds_read_b64_tr_b16 a[188:189], v55 offset:49152
    buffer_load_dwordx4 v[172:175], v16, s[56:59], s73 offen offset:1024 sc1
    v_mfma_f32_16x16x32_bf16 a[192:195], a[160:163], a[236:239], a[192:195]
    ds_read_b64_tr_b16 a[190:191], v55 offset:53248
    buffer_load_dwordx4 v[204:207], v16, s[56:59], s74 offen offset:1024 sc1
    s_waitcnt lgkmcnt(12)
    v_mfma_f32_16x16x32_bf16 v[100:103], a[164:167], a[232:235], v[100:103]
    ds_read_b64_tr_b16 a[128:129], v56 offset:0
    buffer_load_dwordx4 v[236:239], v16, s[56:59], s75 offen offset:1024 sc1
    v_mfma_f32_16x16x32_bf16 a[196:199], a[164:167], a[236:239], a[196:199]
    ds_read_b64_tr_b16 a[130:131], v56 offset:4096
    buffer_load_dwordx4 v[180:183], v16, s[56:59], s73 offen offset:2048 sc1
    s_waitcnt lgkmcnt(12)
    v_mfma_f32_16x16x32_bf16 v[104:107], a[168:171], a[232:235], v[104:107]
    ds_read_b64_tr_b16 a[132:133], v57 offset:0
    buffer_load_dwordx4 v[212:215], v16, s[56:59], s74 offen offset:2048 sc1
    v_mfma_f32_16x16x32_bf16 a[200:203], a[168:171], a[236:239], a[200:203]
    ds_read_b64_tr_b16 a[134:135], v57 offset:4096
    buffer_load_dwordx4 v[244:247], v16, s[56:59], s75 offen offset:2048 sc1
    s_waitcnt lgkmcnt(12)
    v_mfma_f32_16x16x32_bf16 v[108:111], a[172:175], a[232:235], v[108:111]
    ds_read_b64_tr_b16 a[136:137], v58 offset:0
    buffer_load_dwordx4 v[188:191], v16, s[56:59], s73 offen offset:3072 sc1
    v_mfma_f32_16x16x32_bf16 a[204:207], a[172:175], a[236:239], a[204:207]
    ds_read_b64_tr_b16 a[138:139], v58 offset:4096
    buffer_load_dwordx4 v[220:223], v16, s[56:59], s74 offen offset:3072 sc1
    s_waitcnt lgkmcnt(12)
    v_mfma_f32_16x16x32_bf16 v[112:115], a[176:179], a[232:235], v[112:115]
    ds_read_b64_tr_b16 a[140:141], v59 offset:0
    buffer_load_dwordx4 v[252:255], v16, s[56:59], s75 offen offset:3072 sc1
    v_mfma_f32_16x16x32_bf16 a[208:211], a[176:179], a[236:239], a[208:211]
    ds_read_b64_tr_b16 a[142:143], v59 offset:4096
    s_waitcnt lgkmcnt(12)
    v_mfma_f32_16x16x32_bf16 v[116:119], a[180:183], a[232:235], v[116:119]
    ds_read_b64_tr_b16 a[144:145], v60 offset:0
    v_mfma_f32_16x16x32_bf16 a[212:215], a[180:183], a[236:239], a[212:215]
    ds_read_b64_tr_b16 a[146:147], v60 offset:4096
    s_waitcnt lgkmcnt(12)
    v_mfma_f32_16x16x32_bf16 v[120:123], a[184:187], a[232:235], v[120:123]
    ds_read_b64_tr_b16 a[148:149], v61 offset:0
    v_mfma_f32_16x16x32_bf16 a[216:219], a[184:187], a[236:239], a[216:219]
    ds_read_b64_tr_b16 a[150:151], v61 offset:4096
    s_waitcnt lgkmcnt(12)
    v_mfma_f32_16x16x32_bf16 v[124:127], a[188:191], a[232:235], v[124:127]
    ds_read_b64_tr_b16 a[152:153], v62 offset:0
    v_mfma_f32_16x16x32_bf16 a[220:223], a[188:191], a[236:239], a[220:223]
    ds_read_b64_tr_b16 a[154:155], v62 offset:4096
    s_waitcnt lgkmcnt(12)
    v_mfma_f32_16x16x32_bf16 v[96:99], a[128:131], a[240:243], v[96:99]
    ds_read_b64_tr_b16 a[156:157], v63 offset:0
    v_mfma_f32_16x16x32_bf16 a[192:195], a[128:131], a[244:247], a[192:195]
    ds_read_b64_tr_b16 a[158:159], v63 offset:4096
    s_waitcnt lgkmcnt(12)
    v_mfma_f32_16x16x32_bf16 v[100:103], a[132:135], a[240:243], v[100:103]
    ds_read_b64_tr_b16 a[160:161], v56 offset:16384
    v_mfma_f32_16x16x32_bf16 a[196:199], a[132:135], a[244:247], a[196:199]
    ds_read_b64_tr_b16 a[162:163], v56 offset:20480
    s_waitcnt lgkmcnt(12)
    v_mfma_f32_16x16x32_bf16 v[104:107], a[136:139], a[240:243], v[104:107]
    ds_read_b64_tr_b16 a[164:165], v57 offset:16384
    v_mfma_f32_16x16x32_bf16 a[200:203], a[136:139], a[244:247], a[200:203]
    ds_read_b64_tr_b16 a[166:167], v57 offset:20480
    s_waitcnt lgkmcnt(12)
    v_mfma_f32_16x16x32_bf16 v[108:111], a[140:143], a[240:243], v[108:111]
    ds_read_b64_tr_b16 a[168:169], v58 offset:16384
    v_mfma_f32_16x16x32_bf16 a[204:207], a[140:143], a[244:247], a[204:207]
    ds_read_b64_tr_b16 a[170:171], v58 offset:20480
    s_waitcnt lgkmcnt(12)
    v_mfma_f32_16x16x32_bf16 v[112:115], a[144:147], a[240:243], v[112:115]
    ds_read_b64_tr_b16 a[172:173], v59 offset:16384
    v_mfma_f32_16x16x32_bf16 a[208:211], a[144:147], a[244:247], a[208:211]
    ds_read_b64_tr_b16 a[174:175], v59 offset:20480
    s_waitcnt lgkmcnt(12)
    v_mfma_f32_16x16x32_bf16 v[116:119], a[148:151], a[240:243], v[116:119]
    ds_read_b64_tr_b16 a[176:177], v60 offset:16384
    v_mfma_f32_16x16x32_bf16 a[212:215], a[148:151], a[244:247], a[212:215]
    ds_read_b64_tr_b16 a[178:179], v60 offset:20480
    s_waitcnt lgkmcnt(12)
    v_mfma_f32_16x16x32_bf16 v[120:123], a[152:155], a[240:243], v[120:123]
    ds_read_b64_tr_b16 a[180:181], v61 offset:16384
    v_mfma_f32_16x16x32_bf16 a[216:219], a[152:155], a[244:247], a[216:219]
    ds_read_b64_tr_b16 a[182:183], v61 offset:20480
    s_waitcnt lgkmcnt(12)
    v_mfma_f32_16x16x32_bf16 v[124:127], a[156:159], a[240:243], v[124:127]
    ds_read_b64_tr_b16 a[184:185], v62 offset:16384
    v_mfma_f32_16x16x32_bf16 a[220:223], a[156:159], a[244:247], a[220:223]
    ds_read_b64_tr_b16 a[186:187], v62 offset:20480
    s_waitcnt lgkmcnt(12)
    v_mfma_f32_16x16x32_bf16 a[192:195], a[160:163], a[252:255], a[192:195]
    ds_read_b64_tr_b16 a[188:189], v63 offset:16384
    s_waitcnt lgkmcnt(11)
    v_mfma_f32_16x16x32_bf16 a[196:199], a[164:167], a[252:255], a[196:199]
    ds_read_b64_tr_b16 a[190:191], v63 offset:20480
    s_waitcnt lgkmcnt(10)
    v_mfma_f32_16x16x32_bf16 a[200:203], a[168:171], a[252:255], a[200:203]
    s_waitcnt lgkmcnt(8)
    v_mfma_f32_16x16x32_bf16 a[204:207], a[172:175], a[252:255], a[204:207]
    s_waitcnt lgkmcnt(6)
    v_mfma_f32_16x16x32_bf16 a[208:211], a[176:179], a[252:255], a[208:211]
    s_waitcnt lgkmcnt(4)
    v_mfma_f32_16x16x32_bf16 a[212:215], a[180:183], a[252:255], a[212:215]
    s_waitcnt lgkmcnt(2)
    v_mfma_f32_16x16x32_bf16 a[216:219], a[184:187], a[252:255], a[216:219]
    s_waitcnt lgkmcnt(0)
    v_mfma_f32_16x16x32_bf16 a[220:223], a[188:191], a[252:255], a[220:223]
    v_mfma_f32_16x16x32_bf16 v[96:99], a[160:163], a[248:251], v[96:99]
    ds_write_b128 v19, a[192:195] offset:0
    v_mfma_f32_16x16x32_bf16 v[100:103], a[164:167], a[248:251], v[100:103]
    ds_write_b128 v19, a[196:199] offset:1024
    v_mfma_f32_16x16x32_bf16 v[104:107], a[168:171], a[248:251], v[104:107]
    ds_write_b128 v19, a[200:203] offset:2048
    v_mfma_f32_16x16x32_bf16 v[108:111], a[172:175], a[248:251], v[108:111]
    ds_write_b128 v19, a[204:207] offset:3072
    v_mfma_f32_16x16x32_bf16 v[112:115], a[176:179], a[248:251], v[112:115]
    ds_write_b128 v19, a[208:211] offset:4096
    v_mfma_f32_16x16x32_bf16 v[116:119], a[180:183], a[248:251], v[116:119]
    ds_write_b128 v19, a[212:215] offset:5120
    v_mfma_f32_16x16x32_bf16 v[120:123], a[184:187], a[248:251], v[120:123]
    ds_write_b128 v19, a[216:219] offset:6144
    v_mfma_f32_16x16x32_bf16 v[124:127], a[188:191], a[248:251], v[124:127]
    ds_write_b128 v19, a[220:223] offset:7168
    s_waitcnt vmcnt(11)
    v_mfma_f32_16x16x32_bf16 v[128:131], v[28:31], v[164:167], v[128:131]
    v_mfma_f32_16x16x32_bf16 v[132:135], v[26:29], v[164:167], v[132:135]
    s_waitcnt vmcnt(10)
    v_mfma_f32_16x16x32_bf16 v[128:131], v[28:31], v[196:199], v[128:131]
    v_mfma_f32_16x16x32_bf16 v[132:135], v[26:29], v[196:199], v[132:135]
    s_waitcnt vmcnt(9)
    v_mfma_f32_16x16x32_bf16 v[128:131], v[28:31], v[228:231], v[128:131]
    v_mfma_f32_16x16x32_bf16 v[132:135], v[26:29], v[228:231], v[132:135]
    s_nop 6
    v_pk_mul_f32 v[34:35], v[128:129], s[14:15]
    v_pk_mul_f32 v[36:37], v[130:131], s[14:15]
    s_waitcnt vmcnt(8)
    v_mfma_f32_16x16x32_bf16 v[136:139], v[28:31], v[172:175], v[136:139]
    v_pk_mul_f32 v[38:39], v[132:133], s[14:15]
    v_pk_mul_f32 v[40:41], v[134:135], s[14:15]
    v_mfma_f32_16x16x32_bf16 v[140:143], v[26:29], v[172:175], v[140:143]
    v_exp_f32 v34, v34
    v_exp_f32 v35, v35
    s_waitcnt vmcnt(7)
    v_mfma_f32_16x16x32_bf16 v[136:139], v[28:31], v[204:207], v[136:139]
    v_exp_f32 v36, v36
    v_exp_f32 v37, v37
    v_mfma_f32_16x16x32_bf16 v[140:143], v[26:29], v[204:207], v[140:143]
    v_exp_f32 v38, v38
    v_exp_f32 v39, v39
    s_waitcnt lgkmcnt(0)
    s_barrier
    ds_read_b128 v[160:163], v20 offset:0
    ds_read_b128 v[168:171], v20 offset:1024
    ds_read_b128 v[176:179], v20 offset:2048
    ds_read_b128 v[184:187], v20 offset:3072
    ds_read_b128 v[192:195], v20 offset:4096
    ds_read_b128 v[200:203], v20 offset:5120
    ds_read_b128 v[208:211], v20 offset:6144
    ds_read_b128 v[216:219], v20 offset:7168
    s_waitcnt vmcnt(6)
    v_mfma_f32_16x16x32_bf16 v[136:139], v[28:31], v[236:239], v[136:139]
    v_exp_f32 v40, v40
    v_exp_f32 v41, v41
    v_mfma_f32_16x16x32_bf16 v[140:143], v[26:29], v[236:239], v[140:143]
    v_pk_add_f32 v[34:35], v[34:35], 1.0 op_sel_hi:[1,0]
    v_pk_add_f32 v[36:37], v[36:37], 1.0 op_sel_hi:[1,0]
    s_waitcnt vmcnt(5)
    v_mfma_f32_16x16x32_bf16 v[144:147], v[28:31], v[180:183], v[144:147]
    v_pk_add_f32 v[38:39], v[38:39], 1.0 op_sel_hi:[1,0]
    v_pk_add_f32 v[40:41], v[40:41], 1.0 op_sel_hi:[1,0]
    v_mfma_f32_16x16x32_bf16 v[148:151], v[26:29], v[180:183], v[148:151]
    v_rcp_f32 v34, v34
    v_rcp_f32 v35, v35
    s_waitcnt vmcnt(4)
    v_mfma_f32_16x16x32_bf16 v[144:147], v[28:31], v[212:215], v[144:147]
    v_rcp_f32 v36, v36
    v_rcp_f32 v37, v37
    v_mfma_f32_16x16x32_bf16 v[148:151], v[26:29], v[212:215], v[148:151]
    v_rcp_f32 v38, v38
    v_rcp_f32 v39, v39
    s_waitcnt vmcnt(3)
    v_mfma_f32_16x16x32_bf16 v[144:147], v[28:31], v[244:247], v[144:147]
    v_rcp_f32 v40, v40
    v_rcp_f32 v41, v41
    v_mfma_f32_16x16x32_bf16 v[148:151], v[26:29], v[244:247], v[148:151]
    v_pk_mul_f32 v[164:165], v[128:129], v[34:35]
    v_pk_mul_f32 v[166:167], v[130:131], v[36:37]
    s_waitcnt vmcnt(2)
    v_mfma_f32_16x16x32_bf16 v[152:155], v[28:31], v[188:191], v[152:155]
    v_pk_mul_f32 v[196:197], v[132:133], v[38:39]
    v_pk_mul_f32 v[198:199], v[134:135], v[40:41]
    v_mfma_f32_16x16x32_bf16 v[156:159], v[26:29], v[188:191], v[156:159]
    s_waitcnt vmcnt(1)
    v_mfma_f32_16x16x32_bf16 v[152:155], v[28:31], v[220:223], v[152:155]
    v_mfma_f32_16x16x32_bf16 v[156:159], v[26:29], v[220:223], v[156:159]
    s_waitcnt vmcnt(0)
    v_mfma_f32_16x16x32_bf16 v[152:155], v[28:31], v[252:255], v[152:155]
    v_mfma_f32_16x16x32_bf16 v[156:159], v[26:29], v[252:255], v[156:159]
    s_waitcnt lgkmcnt(7)
    v_pk_add_f32 v[96:97], v[96:97], v[160:161]
    v_pk_add_f32 v[98:99], v[98:99], v[162:163]
    s_waitcnt lgkmcnt(6)
    v_pk_add_f32 v[100:101], v[100:101], v[168:169]
    v_pk_add_f32 v[102:103], v[102:103], v[170:171]
    v_pk_fma_f32 v[96:97], v[96:97], v[164:165], v[64:65]
    v_pk_fma_f32 v[98:99], v[98:99], v[166:167], v[66:67]
    v_pk_fma_f32 v[100:101], v[100:101], v[196:197], v[68:69]
    v_pk_fma_f32 v[102:103], v[102:103], v[198:199], v[70:71]
    v_cvt_pk_bf16_f32 v96, v96, v97
    v_cvt_pk_bf16_f32 v97, v98, v99
    v_cvt_pk_bf16_f32 v98, v100, v101
    v_cvt_pk_bf16_f32 v99, v102, v103
    s_nop 0
    v_permlane16_swap_b32 v96, v98
    v_permlane16_swap_b32 v97, v99
    global_store_dwordx4 v2, v[96:99], s[22:23] offset:0 sc1
    v_pk_mul_f32 v[34:35], v[136:137], s[14:15]
    v_pk_mul_f32 v[36:37], v[138:139], s[14:15]
    v_pk_mul_f32 v[38:39], v[140:141], s[14:15]
    v_pk_mul_f32 v[40:41], v[142:143], s[14:15]
    v_exp_f32 v34, v34
    v_exp_f32 v35, v35
    v_exp_f32 v36, v36
    v_exp_f32 v37, v37
    v_exp_f32 v38, v38
    v_exp_f32 v39, v39
    v_exp_f32 v40, v40
    v_exp_f32 v41, v41
    v_pk_add_f32 v[34:35], v[34:35], 1.0 op_sel_hi:[1,0]
    v_pk_add_f32 v[36:37], v[36:37], 1.0 op_sel_hi:[1,0]
    v_pk_add_f32 v[38:39], v[38:39], 1.0 op_sel_hi:[1,0]
    v_pk_add_f32 v[40:41], v[40:41], 1.0 op_sel_hi:[1,0]
    v_rcp_f32 v34, v34
    v_rcp_f32 v35, v35
    v_rcp_f32 v36, v36
    v_rcp_f32 v37, v37
    v_rcp_f32 v38, v38
    v_rcp_f32 v39, v39
    v_rcp_f32 v40, v40
    v_rcp_f32 v41, v41
    v_pk_mul_f32 v[172:173], v[136:137], v[34:35]
    v_pk_mul_f32 v[174:175], v[138:139], v[36:37]
    v_pk_mul_f32 v[204:205], v[140:141], v[38:39]
    v_pk_mul_f32 v[206:207], v[142:143], v[40:41]
    s_waitcnt lgkmcnt(5)
    v_pk_add_f32 v[104:105], v[104:105], v[176:177]
    v_pk_add_f32 v[106:107], v[106:107], v[178:179]
    s_waitcnt lgkmcnt(4)
    v_pk_add_f32 v[108:109], v[108:109], v[184:185]
    v_pk_add_f32 v[110:111], v[110:111], v[186:187]
    v_pk_fma_f32 v[104:105], v[104:105], v[172:173], v[72:73]
    v_pk_fma_f32 v[106:107], v[106:107], v[174:175], v[74:75]
    v_pk_fma_f32 v[108:109], v[108:109], v[204:205], v[76:77]
    v_pk_fma_f32 v[110:111], v[110:111], v[206:207], v[78:79]
    v_cvt_pk_bf16_f32 v104, v104, v105
    v_cvt_pk_bf16_f32 v105, v106, v107
    v_cvt_pk_bf16_f32 v106, v108, v109
    v_cvt_pk_bf16_f32 v107, v110, v111
    s_nop 0
    v_permlane16_swap_b32 v104, v106
    v_permlane16_swap_b32 v105, v107
    global_store_dwordx4 v2, v[104:107], s[22:23] offset:64 sc1
    v_pk_mul_f32 v[34:35], v[144:145], s[14:15]
    v_pk_mul_f32 v[36:37], v[146:147], s[14:15]
    v_pk_mul_f32 v[38:39], v[148:149], s[14:15]
    v_pk_mul_f32 v[40:41], v[150:151], s[14:15]
    v_exp_f32 v34, v34
    v_exp_f32 v35, v35
    v_exp_f32 v36, v36
    v_exp_f32 v37, v37
    v_exp_f32 v38, v38
    v_exp_f32 v39, v39
    v_exp_f32 v40, v40
    v_exp_f32 v41, v41
    v_pk_add_f32 v[34:35], v[34:35], 1.0 op_sel_hi:[1,0]
    v_pk_add_f32 v[36:37], v[36:37], 1.0 op_sel_hi:[1,0]
    v_pk_add_f32 v[38:39], v[38:39], 1.0 op_sel_hi:[1,0]
    v_pk_add_f32 v[40:41], v[40:41], 1.0 op_sel_hi:[1,0]
    v_rcp_f32 v34, v34
    v_rcp_f32 v35, v35
    v_rcp_f32 v36, v36
    v_rcp_f32 v37, v37
    v_rcp_f32 v38, v38
    v_rcp_f32 v39, v39
    v_rcp_f32 v40, v40
    v_rcp_f32 v41, v41
    v_pk_mul_f32 v[180:181], v[144:145], v[34:35]
    v_pk_mul_f32 v[182:183], v[146:147], v[36:37]
    v_pk_mul_f32 v[212:213], v[148:149], v[38:39]
    v_pk_mul_f32 v[214:215], v[150:151], v[40:41]
    s_waitcnt lgkmcnt(3)
    v_pk_add_f32 v[112:113], v[112:113], v[192:193]
    v_pk_add_f32 v[114:115], v[114:115], v[194:195]
    s_waitcnt lgkmcnt(2)
    v_pk_add_f32 v[116:117], v[116:117], v[200:201]
    v_pk_add_f32 v[118:119], v[118:119], v[202:203]
    v_pk_fma_f32 v[112:113], v[112:113], v[180:181], v[80:81]
    v_pk_fma_f32 v[114:115], v[114:115], v[182:183], v[82:83]
    v_pk_fma_f32 v[116:117], v[116:117], v[212:213], v[84:85]
    v_pk_fma_f32 v[118:119], v[118:119], v[214:215], v[86:87]
    v_cvt_pk_bf16_f32 v112, v112, v113
    v_cvt_pk_bf16_f32 v113, v114, v115
    v_cvt_pk_bf16_f32 v114, v116, v117
    v_cvt_pk_bf16_f32 v115, v118, v119
    s_nop 0
    v_permlane16_swap_b32 v112, v114
    v_permlane16_swap_b32 v113, v115
    global_store_dwordx4 v2, v[112:115], s[22:23] offset:128 sc1
    v_pk_mul_f32 v[34:35], v[152:153], s[14:15]
    v_pk_mul_f32 v[36:37], v[154:155], s[14:15]
    v_pk_mul_f32 v[38:39], v[156:157], s[14:15]
    v_pk_mul_f32 v[40:41], v[158:159], s[14:15]
    s_branch L_over13
L_stub13:
    s_branch L_stubret
L_over13:
    v_exp_f32 v34, v34
    v_exp_f32 v35, v35
    v_exp_f32 v36, v36
    v_exp_f32 v37, v37
    v_exp_f32 v38, v38
    v_exp_f32 v39, v39
    v_exp_f32 v40, v40
    v_exp_f32 v41, v41
    v_pk_add_f32 v[34:35], v[34:35], 1.0 op_sel_hi:[1,0]
    v_pk_add_f32 v[36:37], v[36:37], 1.0 op_sel_hi:[1,0]
    v_pk_add_f32 v[38:39], v[38:39], 1.0 op_sel_hi:[1,0]
    v_pk_add_f32 v[40:41], v[40:41], 1.0 op_sel_hi:[1,0]
    v_rcp_f32 v34, v34
    v_rcp_f32 v35, v35
    v_rcp_f32 v36, v36
    v_rcp_f32 v37, v37
    v_rcp_f32 v38, v38
    v_rcp_f32 v39, v39
    v_rcp_f32 v40, v40
    v_rcp_f32 v41, v41
    v_pk_mul_f32 v[188:189], v[152:153], v[34:35]
    v_pk_mul_f32 v[190:191], v[154:155], v[36:37]
    v_pk_mul_f32 v[220:221], v[156:157], v[38:39]
    v_pk_mul_f32 v[222:223], v[158:159], v[40:41]
    s_waitcnt lgkmcnt(1)
    v_pk_add_f32 v[120:121], v[120:121], v[208:209]
    v_pk_add_f32 v[122:123], v[122:123], v[210:211]
    s_waitcnt lgkmcnt(0)
    v_pk_add_f32 v[124:125], v[124:125], v[216:217]
    v_pk_add_f32 v[126:127], v[126:127], v[218:219]
    v_pk_fma_f32 v[120:121], v[120:121], v[188:189], v[88:89]
    v_pk_fma_f32 v[122:123], v[122:123], v[190:191], v[90:91]
    v_pk_fma_f32 v[124:125], v[124:125], v[220:221], v[92:93]
    v_pk_fma_f32 v[126:127], v[126:127], v[222:223], v[94:95]
    v_cvt_pk_bf16_f32 v120, v120, v121
    v_cvt_pk_bf16_f32 v121, v122, v123
    v_cvt_pk_bf16_f32 v122, v124, v125
    v_cvt_pk_bf16_f32 v123, v126, v127
    s_nop 0
    v_permlane16_swap_b32 v120, v122
    v_permlane16_swap_b32 v121, v123
    global_store_dwordx4 v2, v[120:123], s[22:23] offset:192 sc1
L_end:
    s_endpgm
L_spA0:
    buffer_load_dword v43, off, s[56:59], s92 sc1
    s_waitcnt vmcnt(0)
    v_readfirstlane_b32 s86, v43
    s_bfe_u32 s86, s86, 0x80000
    s_cmp_eq_u32 s86, 32
    s_cbranch_scc1 L_okA0
    s_add_u32 s67, s67, 1
    s_cmp_lt_u32 s67, 0x40000
    s_cbranch_scc1 L_spA0
    s_branch L_okA0
L_spA1:
    buffer_load_dword v43, off, s[56:59], s92 sc1
    s_waitcnt vmcnt(0)
    v_readfirstlane_b32 s86, v43
    s_bfe_u32 s86, s86, 0x80000
    s_cmp_eq_u32 s86, 32
    s_cbranch_scc1 L_okA1
    s_add_u32 s67, s67, 1
    s_cmp_lt_u32 s67, 0x40000
    s_cbranch_scc1 L_spA1
    s_branch L_okA1
L_spB:
    buffer_load_dword v43, off, s[56:59], s92 sc1
    s_waitcnt vmcnt(0)
    v_readfirstlane_b32 s86, v43
    s_bfe_u32 s86, s86, 0x80008
    s_cmp_eq_u32 s86, 16
    s_cbranch_scc1 L_okB
    s_add_u32 s67, s67, 1
    s_cmp_lt_u32 s67, 0x40000
    s_cbranch_scc1 L_spB
    s_branch L_okB
L_spC:
    buffer_load_dword v43, off, s[56:59], s92 sc1
    s_waitcnt vmcnt(0)
    v_readfirstlane_b32 s86, v43
    s_bfe_u32 s86, s86, 0x80010
    s_cmp_eq_u32 s86, 16
    s_cbranch_scc1 L_okC
    s_add_u32 s67, s67, 1
    s_cmp_lt_u32 s67, 0x40000
    s_cbranch_scc1 L_spC
    s_branch L_okC
L_spO:
    buffer_load_dword v43, off, s[56:59], s76 sc1
    s_waitcnt vmcnt(0)
    v_readfirstlane_b32 s86, v43
    s_cmp_eq_u32 s86, 64
    s_cbranch_scc1 L_okO
    s_add_u32 s67, s67, 1
    s_cmp_lt_u32 s67, 0x40000
    s_cbranch_scc1 L_spO
    s_branch L_okO
L_spP:
    buffer_load_dword v43, off, s[56:59], s77 sc1
    s_waitcnt vmcnt(0)
    v_readfirstlane_b32 s86, v43
    s_or_b32 s86, s86, s90
    s_cmp_eq_u32 s86, 0x01010101
    s_cbranch_scc1 L_okP
    s_add_u32 s67, s67, 1
    s_cmp_lt_u32 s67, 0x40000
    s_cbranch_scc1 L_spP
    s_branch L_okP
L_code_end:
.section .rodata,"a"
.p2align 6
.amdhsa_kernel recurrent_scan__sliding_local_dilated__glu_gated_geglu__prompt_kernel
  .amdhsa_next_free_vgpr 512
  .amdhsa_next_free_sgpr 102
  .amdhsa_accum_offset 256
  .amdhsa_group_segment_fixed_size 0
  .amdhsa_kernarg_size 80
  .amdhsa_user_sgpr_count 2
  .amdhsa_user_sgpr_kernarg_segment_ptr 1
  .amdhsa_system_sgpr_workgroup_id_x 1
.end_amdhsa_kernel
```
